```python
import torch

def _softmax(x, axis=-1):
    return torch.softmax(x, dim=axis)

def _gelu(x):
    return torch.nn.functional.gelu(x, approximate='tanh')

def _silu(x):
    return torch.nn.functional.silu(x)

def _sigmoid(x):
    return torch.sigmoid(x)

def _layernorm(x, axis=-1, eps=1e-05):
    m = x.mean(dim=axis, keepdim=True)
    v = x.var(dim=axis, keepdim=True, unbiased=False)
    return (x - m) / torch.sqrt(v + eps)

def _scatter_add(tgt, idx, src, axis=0):
    return tgt.clone().index_add_(axis, idx, src)

def _segment_sum(src, seg, n):
    out = torch.zeros((n,) + src.shape[1:], dtype=src.dtype)
    return out.index_add_(0, seg, src)

def _pad(x, pw):
    flat = tuple((v for pair in reversed(pw) for v in pair))
    return torch.nn.functional.pad(x, flat)
kernel_name = 'concat_heads__ssm_conv_s5__memory_aug_recurrent_mem_tr__prompt'

def setup_inputs():

    _w = lambda a: (lambda t: t.to(torch.bfloat16) if t.is_floating_point() else t)(torch.as_tensor(a))

    def _A_setup():
        B, S, D = (1, 2048, 1024)
        P = D
        Lambda_re = -0.5 * (lambda _x: torch.exp(torch.as_tensor(_x)))((lambda *s: torch.randn(*s, dtype=torch.bfloat16) * 0.8)(P))
        Lambda_im = (lambda *s: torch.randn(*s, dtype=torch.bfloat16) * 0.8)(P) * 1.0
        B_re = (lambda *s: torch.randn(*s, dtype=torch.bfloat16) * 0.8)(P, D) * D ** (-0.5)
        B_im = (lambda *s: torch.randn(*s, dtype=torch.bfloat16) * 0.8)(P, D) * D ** (-0.5)
        C_re = (lambda *s: torch.randn(*s, dtype=torch.bfloat16) * 0.8)(D, P) * P ** (-0.5)
        C_im = (lambda *s: torch.randn(*s, dtype=torch.bfloat16) * 0.8)(D, P) * P ** (-0.5)
        log_dt = (lambda *s: torch.randn(*s, dtype=torch.bfloat16) * 0.8)(P) * 0.3 - 2.0
        Dskip = (lambda *s: torch.randn(*s, dtype=torch.bfloat16) * 0.8)(D)
        return {'x': _w((lambda *s: torch.randn(*s, dtype=torch.bfloat16) * 0.05)(B, S, D)), 'Lambda_re': _w(Lambda_re), 'Lambda_im': _w(Lambda_im), 'B_re': _w(B_re), 'B_im': _w(B_im), 'C_re': _w(C_re), 'C_im': _w(C_im), 'log_dt': _w(log_dt), 'Dskip': _w(Dskip)}
    _A_in = _A_setup()

    def _B_setup():
        B, S, Dm = (1, 2048, 1024)
        H, Dh = (32, 128)
        M, seg = (8, 32)
        seg = min(seg, S)
        S = S // seg * seg
        return {'x': _w((lambda *s: torch.randn(*s, dtype=torch.bfloat16) * 0.05)(B, S, Dm)), 'mem0': _w((lambda *s: torch.randn(*s, dtype=torch.bfloat16) * 0.8)(B, M, Dm)), 'Wq': _w((lambda *s: torch.randn(*s, dtype=torch.bfloat16) * 3.2)(Dm, H, Dh) * Dm ** (-0.5)), 'Wk': _w((lambda *s: torch.randn(*s, dtype=torch.bfloat16) * 3.2)(Dm, H, Dh) * Dm ** (-0.5)), 'Wv': _w((lambda *s: torch.randn(*s, dtype=torch.bfloat16) * 0.8)(Dm, H, Dh) * Dm ** (-0.5)), 'Wo': _w((lambda *s: torch.randn(*s, dtype=torch.bfloat16) * 0.8)(H, Dh, Dm) * (H * Dh) ** (-0.5)), 'seg_len': seg}
    _B_in = _B_setup()
    return {'A_x': _A_in['x'], 'A_Lambda_re': _A_in['Lambda_re'], 'A_Lambda_im': _A_in['Lambda_im'], 'A_B_re': _A_in['B_re'], 'A_B_im': _A_in['B_im'], 'A_C_re': _A_in['C_re'], 'A_C_im': _A_in['C_im'], 'A_log_dt': _A_in['log_dt'], 'A_Dskip': _A_in['Dskip'], 'B_x': _B_in['x'], 'B_mem0': _B_in['mem0'], 'B_Wq': _B_in['Wq'], 'B_Wk': _B_in['Wk'], 'B_Wv': _B_in['Wv'], 'B_Wo': _B_in['Wo'], 'B_seg_len': _B_in['seg_len']}

def reference(A_x, A_Lambda_re, A_Lambda_im, A_B_re, A_B_im, A_C_re, A_C_im, A_log_dt, A_Dskip, B_x, B_mem0, B_Wq, B_Wk, B_Wv, B_Wo, B_seg_len):

    def _A_ref(x, Lambda_re, Lambda_im, B_re, B_im, C_re, C_im, log_dt, Dskip):
        Bsz, L, H = x.shape
        Lam = Lambda_re + 1j * Lambda_im
        Bmat = B_re + 1j * B_im
        Cmat = C_re + 1j * C_im
        dt = torch.exp(log_dt)
        Lam_bar = torch.exp(dt * Lam)
        B_bar = ((Lam_bar - 1.0) / Lam)[:, None] * Bmat
        Bu = torch.einsum('bld,pd->blp', x + 0j, B_bar)
        h = torch.zeros_like(Bu[:, 0, :])
        hs = []
        for t in range(L):
            h = Lam_bar[None, :] * h + Bu[:, t, :]
            hs.append(h)
        hseq = torch.stack(hs, 1)
        y = 2.0 * torch.einsum('blp,dp->bld', hseq, Cmat).real + x * Dskip[None, None, :]
        return y

    def _B_ref(x, mem0, Wq, Wk, Wv, Wo, seg_len):
        B, S, Dm = x.shape
        H, Dh = (Wq.shape[1], Wq.shape[2])
        M = mem0.shape[1]
        scale = Dh ** (-0.5)
        n_seg = S // seg_len
        L = M + seg_len
        idx = torch.arange(L)
        mask = (idx[:, None] < M) | (idx[:, None] >= idx[None, :])
        mem = mem0
        outs = []
        for s in range(n_seg):
            xs = x[:, s * seg_len:(s + 1) * seg_len, :].clone()
            h = torch.concatenate([mem, xs], axis=1)
            q = torch.einsum('btd,dhe->bhte', h, Wq)
            k = torch.einsum('btd,dhe->bhte', h, Wk)
            v = torch.einsum('btd,dhe->bhte', h, Wv)
            scores = torch.einsum('bhqe,bhke->bhqk', q, k) * scale
            scores = torch.where(mask[None, None], scores, -1000000000.0)
            p = _softmax(scores, axis=-1)
            o = torch.einsum('bhqk,bhke->bhqe', p, v)
            o = torch.einsum('bhte,hed->btd', o, Wo)
            mem = o[:, :M, :].clone()
            outs.append(o[:, M:, :])
        return torch.concatenate(outs, axis=1)
    a = _A_ref(A_x, A_Lambda_re, A_Lambda_im, A_B_re, A_B_im, A_C_re, A_C_im, A_log_dt, A_Dskip)
    b = _B_ref(B_x, B_mem0, B_Wq, B_Wk, B_Wv, B_Wo, B_seg_len)
    return torch.concatenate([a, b], axis=-1)
```

```asm
; @launch kernel=chain_kernel grid=(256,1,1) block=(256,1,1) lds=163840
.amdgcn_target "amdgcn-amd-amdhsa--gfx950"
.text
.globl chain_kernel
.p2align 8
.type chain_kernel,@function
chain_kernel:
    s_cmp_ge_u32 s2, 256
    s_cbranch_scc1 chain_kernel_end
    s_load_dwordx4 s[96:99], s[0:1], 128
    s_load_dwordx2 s[100:101], s[0:1], 144
    s_load_dwordx16 s[64:79], s[0:1], 0
    s_load_dwordx16 s[80:95], s[0:1], 64
    s_getreg_b32 s16, hwreg(HW_REG_XCC_ID)
    s_and_b32 s16, s16, 7
    v_lshrrev_b32 v1, 6, v0
    s_nop 0
    v_readfirstlane_b32 s18, v1
    s_waitcnt lgkmcnt(0)
    s_cmp_lg_u32 s18, 0
    s_cbranch_scc1 L_cal_2
    s_lshl_b32 s3, s16, 2
    s_add_u32 s3, s3, 128
    s_mov_b32 s17, 1
    s_atomic_add s17, s[98:99], s3 glc
    v_mov_b32 v2, 31744
    s_waitcnt lgkmcnt(0)
    v_mov_b32 v1, s17
    ds_write_b32 v2, v1
    s_waitcnt lgkmcnt(0)
    s_branch L_role_1
L_cal_2:
    s_cmp_lg_u32 s18, 1
    s_cbranch_scc1 L_role_1
    s_cmp_ge_u32 s2, 15
    s_cbranch_scc1 L_role_1
    s_lshl_b32 s3, s2, 14
    s_add_u32 s3, s3, 0x5c00000
    s_add_u32 s4, s100, s3
    s_addc_u32 s5, s101, 0
    s_mov_b32 s6, 0
    s_atomic_or s6, s[4:5], 0
    s_atomic_or s6, s[4:5], 0x2000
    s_waitcnt lgkmcnt(0)
    s_memtime s[8:9]
    s_atomic_or s6, s[4:5], 0
    s_waitcnt lgkmcnt(0)
    s_memtime s[10:11]
    s_atomic_or s6, s[4:5], 0x2000
    s_waitcnt lgkmcnt(0)
    s_memtime s[12:13]
    s_waitcnt lgkmcnt(0)
    s_sub_u32 s12, s12, s10
    s_sub_u32 s10, s10, s8
    s_cmp_lt_u32 s12, s10
    s_cselect_b32 s6, 0x100, 0
    s_lshl_b32 s7, s16, 6
    s_and_b32 s7, s7, 0x100
    s_xor_b32 s6, s6, s7
    s_add_u32 s6, s6, 1
    s_atomic_add s6, s[98:99], 4
L_role_1:
    s_barrier
    v_mov_b32 v2, 31744
    ds_read_b32 v1, v2
    s_waitcnt lgkmcnt(0)
    v_readfirstlane_b32 s17, v1
    s_barrier
    s_cmp_ge_u32 s17, 32
    s_cbranch_scc1 chain_kernel_end
    s_cmp_ge_u32 s16, 4
    s_cbranch_scc1 chain_kernel_worker
    s_mov_b32 s8, s100
    s_and_b32 s9, s101, 0xffff
    s_mov_b32 s10, 0x10000000
    s_mov_b32 s11, 0x00020000
    s_mov_b32 s33, 0
    s_mov_b32 s24, 0x00ff00ff
    s_mov_b32 s25, 0x00ff00ff
    s_mov_b32 s26, 0x55555555
    s_mov_b32 s27, 0x55555555
    s_mov_b32 s56, 0x3fb8aa3b
    s_mov_b32 s57, 0x3fb8aa3b
    s_mov_b32 s58, 0x3db504f3
    s_mov_b32 s59, 0x3db504f3
    s_lshl_b32 s53, s16, 16
    s_add_u32 s53, s53, 0x5800000
    s_xor_b32 s29, s17, 8
    s_and_b32 s28, s17, 1
    s_bfe_u32 s20, s17, 0x10001
    s_xor_b32 s20, s20, 1
    s_lshl1_add_u32 s28, s28, s20
    s_lshl_b32 s47, s16, 5
    s_add_u32 s47, s47, s17
    s_mov_b64 s[60:61], s[98:99]
    v_mov_b32 v28, -1
    v_mov_b32 v29, -1
    v_mov_b32 v30, -1
    v_mov_b32 v31, -1
    v_and_b32 v210, 63, v0
    v_and_b32 v208, 15, v0
    v_bfe_u32 v209, v0, 4, 2
    v_lshlrev_b32 v1, 4, v210
    v_lshlrev_b32 v26, 3, v210
    s_lshl_b32 s21, s18, 12
    v_add_u32 v2, s21, v1
    s_xor_b32 s22, s18, 3
    s_lshl_b32 s22, s22, 4
    v_xor_b32 v3, s22, v2
    v_add_u32 v3, 16384, v3
    s_and_b32 s22, s22, 16
    s_lshl_b32 s22, s22, 1
    v_xor_b32 v2, s22, v2
    v_mov_b32 v19, 0xeeeeeeee
    v_mov_b32 v212, 0x44444444
    v_cndmask_b32 v19, v19, v212, s[24:25]
    v_mov_b32 v18, 0x03020706
    v_mov_b32 v212, 0x05040100
    v_cndmask_b32 v18, v18, v212, s[26:27]
    s_lshr_b32 s21, s17, 2
    s_lshl_b32 s21, s21, 12
    s_add_u32 s21, s21, 32768
    v_add_u32 v5, s21, v1
    s_and_b32 s22, s28, 1
    s_lshl_b32 s22, s22, 11
    s_add_u32 s21, s21, s22
    s_bfe_u32 s22, s28, 0x10001
    s_lshl_b32 s22, s22, 7
    s_add_u32 s23, s21, s22
    v_and_b32 v212, 1, v209
    v_lshlrev_b32 v234, 6, v212
    v_and_b32 v212, 1, v208
    v_lshl_add_u32 v234, v212, 4, v234
    v_bfe_u32 v212, v208, 1, 2
    v_lshl_add_u32 v234, v212, 2, v234
    s_and_b32 s22, s18, 1
    s_lshl_b32 s22, s22, 5
    v_add_u32 v234, s22, v234
    v_lshrrev_b32 v212, 3, v208
    v_and_b32 v213, 2, v209
    v_add_u32 v212, v212, v213
    s_and_b32 s22, s18, 2
    s_lshl_b32 s22, s22, 1
    v_add_u32 v212, s22, v212
    v_lshl_add_u32 v4, v212, 8, v234
    v_lshl_add_u32 v234, v212, 7, v234
    v_add_u32 v4, s23, v4
    v_lshrrev_b32 v212, 3, v210
    v_and_b32 v213, 7, v210
    v_lshlrev_b32 v22, 8, v212
    v_lshl_add_u32 v22, v213, 4, v22
    v_add_u32 v22, s23, v22
    s_lshr_b32 s20, s47, 2
    s_lshl_b32 s48, s20, 15
    s_lshr_b32 s21, s20, 1
    s_lshl_b32 s49, s21, 14
    s_and_b32 s21, s20, 1
    s_lshl_b32 s21, s21, 12
    s_add_u32 s49, s49, s21
    s_add_u32 s49, s49, 0x4800000
    s_and_b32 s21, s28, 1
    s_lshl_b32 s21, s21, 10
    v_add_u32 v23, s21, v1
    s_and_b32 s21, s17, 3
    s_lshl_b32 s22, s21, 9
    s_add_u32 s22, s22, 2048
    v_add_u32 v24, s22, v26
    s_lshl_b32 s22, s21, 11
    s_add_u32 s22, s22, 0x4000
    v_add_u32 v237, s22, v1
    v_add_u32 v236, 4096, v1
    v_and_b32 v212, 7, v208
    v_lshlrev_b32 v6, 4, v212
    v_lshl_add_u32 v6, v209, 7, v6
    s_lshl_b32 s21, s17, 9
    s_add_u32 s22, s21, 16384
    v_add_u32 v6, s22, v6
    v_lshrrev_b32 v212, 3, v208
    v_and_b32 v213, 2, v209
    v_add_u32 v212, v212, v213
    v_lshlrev_b32 v7, 7, v212
    v_and_b32 v212, 1, v209
    v_lshl_add_u32 v7, v212, 6, v7
    v_bfe_u32 v212, v208, 1, 2
    v_lshl_add_u32 v7, v212, 2, v7
    s_lshl_b32 s21, s29, 9
    s_lshl_b32 s22, s18, 4
    s_add_u32 s21, s21, s22
    v_add_u32 v7, s21, v7
    v_bfe_u32 v212, v210, 1, 3
    v_and_b32 v213, 1, v210
    v_lshlrev_b32 v27, 11, v212
    v_lshl_add_u32 v27, v213, 3, v27
    v_lshl_add_u32 v27, v209, 4, v27
    s_lshl_b32 s21, s29, 6
    v_add_u32 v27, s21, v27
    v_lshlrev_b32 v212, 2, v210
    s_xor_b32 s21, s18, 3
    s_mul_i32 s21, s21, 768
    s_add_u32 s21, s21, 0
    v_add_u32 v238, s21, v212
    v_lshlrev_b32 v12, 1, v238
    s_xor_b32 s21, s18, 2
    s_mul_i32 s21, s21, 768
    s_add_u32 s21, s21, 256
    v_add_u32 v239, s21, v212
    v_lshlrev_b32 v13, 1, v239
    s_xor_b32 s21, s18, 1
    s_mul_i32 s21, s21, 768
    s_add_u32 s21, s21, 512
    v_add_u32 v240, s21, v212
    v_lshlrev_b32 v14, 1, v240
    s_mul_i32 s21, s18, 768
    v_add_u32 v17, s21, v212
    v_lshlrev_b32 v15, 1, v17
    s_lshl_b32 s21, s18, 10
    v_add_u32 v16, s21, v1
    s_lshl_b32 s42, s18, 18
    s_add_u32 s42, s42, s53
    buffer_store_dwordx4 v[28:31], v22, s[8:11], s42 offen
    s_lshl_b32 s21, s29, 9
    s_add_u32 s21, s21, s42
    buffer_store_dwordx2 v[28:29], v26, s[8:11], s21 offen
    s_xor_b32 s21, s21, 20480
    buffer_store_dwordx2 v[28:29], v26, s[8:11], s21 offen
    s_lshl_b32 s62, s16, 8
    s_add_u32 s62, s62, 0x5a00000
    s_cmp_eq_u32 s17, 1
    s_cselect_b32 s21, s62, 0x10000000
    v_mov_b32 v248, 0
    buffer_store_dword v248, v248, s[8:11], s21 offen
    s_mov_b32 s12, s84
    s_and_b32 s13, s85, 0xffff
    s_mov_b32 s14, 0x4000
    s_mov_b32 s15, 0x00020000
    buffer_load_dwordx2 v[232:233], v27, s[12:15], 0 offen
    s_lshl_b32 s20, s16, 10
    s_lshr_b32 s21, s17, 2
    s_lshl_b32 s21, s21, 7
    s_add_u32 s20, s20, s21
    v_bfe_u32 v208, v0, 5, 1
    v_lshlrev_b32 v210, 1, v208
    v_bfe_u32 v208, v0, 3, 1
    v_add_u32 v210, v210, v208
    v_bfe_u32 v208, v0, 4, 1
    v_lshl_add_u32 v210, v208, 3, v210
    v_lshrrev_b32 v208, 6, v0
    v_lshl_add_u32 v210, v208, 8, v210
    v_and_b32 v209, 7, v0
    v_lshlrev_b32 v211, 13, v210
    v_lshl_add_u32 v211, v209, 4, v211
    s_and_b32 s21, s28, 1
    s_lshl_b32 s21, s21, 6
    s_add_u32 s21, s21, s20
    s_lshl_b32 s21, s21, 1
    v_add_u32 v211, s21, v211
    v_add_u32 v212, 0x8000, v211
    v_bfe_u32 v208, v0, 4, 2
    v_lshlrev_b32 v210, 1, v208
    v_bfe_u32 v208, v0, 2, 1
    v_add_u32 v210, v210, v208
    v_bfe_u32 v208, v0, 3, 1
    v_lshl_add_u32 v210, v208, 3, v210
    v_lshrrev_b32 v208, 6, v0
    v_lshl_add_u32 v210, v208, 8, v210
    v_and_b32 v209, 3, v0
    v_lshlrev_b32 v213, 13, v210
    v_lshl_add_u32 v213, v209, 4, v213
    s_and_b32 s21, s17, 3
    s_lshl_b32 s21, s21, 5
    s_add_u32 s21, s21, s20
    s_lshl_b32 s21, s21, 1
    v_add_u32 v213, s21, v213
    v_bfe_u32 v214, v0, 2, 1
    v_bfe_u32 v208, v0, 4, 1
    v_lshl_add_u32 v214, v208, 1, v214
    v_bfe_u32 v208, v0, 3, 1
    v_lshl_add_u32 v214, v208, 2, v214
    v_bfe_u32 v208, v0, 5, 1
    v_lshl_add_u32 v214, v208, 4, v214
    v_lshrrev_b32 v208, 6, v0
    v_lshl_add_u32 v214, v208, 8, v214
    s_lshl_b32 s21, s16, 10
    v_add_u32 v214, s21, v214
    v_lshlrev_b32 v214, 11, v214
    v_lshl_add_u32 v214, v209, 4, v214
    s_lshl_b32 s21, s29, 6
    v_add_u32 v214, s21, v214
    s_lshl_b32 s22, s18, 15
    s_add_u32 s22, s22, 32768
    s_mov_b32 s12, s90
    s_and_b32 s13, s91, 0xffff
    s_mov_b32 s14, 0x800000
    s_mov_b32 s15, 0x00020000
    s_and_b32 s21, s17, 1
    s_mul_i32 s21, s21, 1048576
    s_xor_b32 s23, s21, 0x0
    buffer_load_dwordx4 v[32:35], v213, s[12:15], s23 offen nt
    s_xor_b32 s23, s21, 0x20000
    buffer_load_dwordx4 v[36:39], v213, s[12:15], s23 offen nt
    s_xor_b32 s23, s21, 0x40000
    buffer_load_dwordx4 v[40:43], v213, s[12:15], s23 offen nt
    s_xor_b32 s23, s21, 0x60000
    buffer_load_dwordx4 v[44:47], v213, s[12:15], s23 offen nt
    s_xor_b32 s23, s21, 0x80000
    buffer_load_dwordx4 v[48:51], v213, s[12:15], s23 offen nt
    s_xor_b32 s23, s21, 0xa0000
    buffer_load_dwordx4 v[52:55], v213, s[12:15], s23 offen nt
    s_xor_b32 s23, s21, 0xc0000
    buffer_load_dwordx4 v[56:59], v213, s[12:15], s23 offen nt
    s_xor_b32 s23, s21, 0xe0000
    buffer_load_dwordx4 v[60:63], v213, s[12:15], s23 offen nt
    s_mov_b32 s12, s92
    s_and_b32 s13, s93, 0xffff
    s_mov_b32 s14, 0x800000
    s_mov_b32 s15, 0x00020000
    s_and_b32 s21, s17, 1
    s_mul_i32 s21, s21, 262144
    s_xor_b32 s23, s21, 0x0
    buffer_load_dwordx4 v[96:99], v214, s[12:15], s23 offen nt
    s_xor_b32 s23, s21, 0x4000
    buffer_load_dwordx4 v[100:103], v214, s[12:15], s23 offen nt
    s_xor_b32 s23, s21, 0x10000
    buffer_load_dwordx4 v[104:107], v214, s[12:15], s23 offen nt
    s_xor_b32 s23, s21, 0x14000
    buffer_load_dwordx4 v[108:111], v214, s[12:15], s23 offen nt
    s_xor_b32 s23, s21, 0x20000
    buffer_load_dwordx4 v[112:115], v214, s[12:15], s23 offen nt
    s_xor_b32 s23, s21, 0x24000
    buffer_load_dwordx4 v[116:119], v214, s[12:15], s23 offen nt
    s_xor_b32 s23, s21, 0x30000
    buffer_load_dwordx4 v[120:123], v214, s[12:15], s23 offen nt
    s_xor_b32 s23, s21, 0x34000
    buffer_load_dwordx4 v[124:127], v214, s[12:15], s23 offen nt
    s_bitcmp1_b32 s28, 1
    s_cselect_b32 s12, s88, s86
    s_cselect_b32 s13, s89, s87
    s_and_b32 s13, s13, 0xffff
    s_mov_b32 s14, 0x800000
    s_mov_b32 s15, 0x00020000
    s_add_u32 m0, s22, 0
    s_mov_b32 s23, 0
    buffer_load_dwordx4 v211, s[12:15], s23 offen nt lds
    s_add_u32 m0, s22, 1024
    s_mov_b32 s23, 0
    buffer_load_dwordx4 v212, s[12:15], s23 offen nt lds
    s_add_u32 m0, s22, 2048
    s_mov_b32 s23, 131072
    buffer_load_dwordx4 v211, s[12:15], s23 offen nt lds
    s_add_u32 m0, s22, 3072
    s_mov_b32 s23, 131072
    buffer_load_dwordx4 v212, s[12:15], s23 offen nt lds
    s_add_u32 m0, s22, 4096
    s_mov_b32 s23, 262144
    buffer_load_dwordx4 v211, s[12:15], s23 offen nt lds
    s_add_u32 m0, s22, 5120
    s_mov_b32 s23, 262144
    buffer_load_dwordx4 v212, s[12:15], s23 offen nt lds
    s_add_u32 m0, s22, 6144
    s_mov_b32 s23, 393216
    buffer_load_dwordx4 v211, s[12:15], s23 offen nt lds
    s_add_u32 m0, s22, 7168
    s_mov_b32 s23, 393216
    buffer_load_dwordx4 v212, s[12:15], s23 offen nt lds
    s_add_u32 m0, s22, 8192
    s_mov_b32 s23, 524288
    buffer_load_dwordx4 v211, s[12:15], s23 offen nt lds
    s_add_u32 m0, s22, 9216
    s_mov_b32 s23, 524288
    buffer_load_dwordx4 v212, s[12:15], s23 offen nt lds
    s_add_u32 m0, s22, 10240
    s_mov_b32 s23, 655360
    buffer_load_dwordx4 v211, s[12:15], s23 offen nt lds
    s_add_u32 m0, s22, 11264
    s_mov_b32 s23, 655360
    buffer_load_dwordx4 v212, s[12:15], s23 offen nt lds
    s_add_u32 m0, s22, 12288
    s_mov_b32 s23, 786432
    buffer_load_dwordx4 v211, s[12:15], s23 offen nt lds
    s_add_u32 m0, s22, 13312
    s_mov_b32 s23, 786432
    buffer_load_dwordx4 v212, s[12:15], s23 offen nt lds
    s_add_u32 m0, s22, 14336
    s_mov_b32 s23, 917504
    buffer_load_dwordx4 v211, s[12:15], s23 offen nt lds
    s_add_u32 m0, s22, 15360
    s_mov_b32 s23, 917504
    buffer_load_dwordx4 v212, s[12:15], s23 offen nt lds
    s_add_u32 m0, s22, 16384
    s_mov_b32 s23, 1048576
    buffer_load_dwordx4 v211, s[12:15], s23 offen nt lds
    s_add_u32 m0, s22, 17408
    s_mov_b32 s23, 1048576
    buffer_load_dwordx4 v212, s[12:15], s23 offen nt lds
    s_add_u32 m0, s22, 18432
    s_mov_b32 s23, 1179648
    buffer_load_dwordx4 v211, s[12:15], s23 offen nt lds
    s_add_u32 m0, s22, 19456
    s_mov_b32 s23, 1179648
    buffer_load_dwordx4 v212, s[12:15], s23 offen nt lds
    s_add_u32 m0, s22, 20480
    s_mov_b32 s23, 1310720
    buffer_load_dwordx4 v211, s[12:15], s23 offen nt lds
    s_add_u32 m0, s22, 21504
    s_mov_b32 s23, 1310720
    buffer_load_dwordx4 v212, s[12:15], s23 offen nt lds
    s_add_u32 m0, s22, 22528
    s_mov_b32 s23, 1441792
    buffer_load_dwordx4 v211, s[12:15], s23 offen nt lds
    s_add_u32 m0, s22, 23552
    s_mov_b32 s23, 1441792
    buffer_load_dwordx4 v212, s[12:15], s23 offen nt lds
    s_add_u32 m0, s22, 24576
    s_mov_b32 s23, 1572864
    buffer_load_dwordx4 v211, s[12:15], s23 offen nt lds
    s_add_u32 m0, s22, 25600
    s_mov_b32 s23, 1572864
    buffer_load_dwordx4 v212, s[12:15], s23 offen nt lds
    s_add_u32 m0, s22, 26624
    s_mov_b32 s23, 1703936
    buffer_load_dwordx4 v211, s[12:15], s23 offen nt lds
    s_add_u32 m0, s22, 27648
    s_mov_b32 s23, 1703936
    buffer_load_dwordx4 v212, s[12:15], s23 offen nt lds
    s_add_u32 m0, s22, 28672
    s_mov_b32 s23, 1835008
    buffer_load_dwordx4 v211, s[12:15], s23 offen nt lds
    s_add_u32 m0, s22, 29696
    s_mov_b32 s23, 1835008
    buffer_load_dwordx4 v212, s[12:15], s23 offen nt lds
    s_add_u32 m0, s22, 30720
    s_mov_b32 s23, 1966080
    buffer_load_dwordx4 v211, s[12:15], s23 offen nt lds
    s_add_u32 m0, s22, 31744
    s_mov_b32 s23, 1966080
    buffer_load_dwordx4 v212, s[12:15], s23 offen nt lds
    s_waitcnt vmcnt(40)
    s_mov_b32 s12, s90
    s_and_b32 s13, s91, 0xffff
    s_mov_b32 s14, 0x800000
    s_mov_b32 s15, 0x00020000
    s_and_b32 s21, s17, 1
    s_mul_i32 s21, s21, 1048576
    s_xor_b32 s23, s21, 0x100000
    buffer_load_dwordx4 v[64:67], v213, s[12:15], s23 offen nt
    s_xor_b32 s23, s21, 0x120000
    buffer_load_dwordx4 v[68:71], v213, s[12:15], s23 offen nt
    s_xor_b32 s23, s21, 0x140000
    buffer_load_dwordx4 v[72:75], v213, s[12:15], s23 offen nt
    s_xor_b32 s23, s21, 0x160000
    buffer_load_dwordx4 v[76:79], v213, s[12:15], s23 offen nt
    s_xor_b32 s23, s21, 0x180000
    buffer_load_dwordx4 v[80:83], v213, s[12:15], s23 offen nt
    s_xor_b32 s23, s21, 0x1a0000
    buffer_load_dwordx4 v[84:87], v213, s[12:15], s23 offen nt
    s_xor_b32 s23, s21, 0x1c0000
    buffer_load_dwordx4 v[88:91], v213, s[12:15], s23 offen nt
    s_xor_b32 s23, s21, 0x1e0000
    buffer_load_dwordx4 v[92:95], v213, s[12:15], s23 offen nt
    s_mov_b32 s12, s92
    s_and_b32 s13, s93, 0xffff
    s_mov_b32 s14, 0x800000
    s_mov_b32 s15, 0x00020000
    s_and_b32 s21, s17, 1
    s_mul_i32 s21, s21, 262144
    s_xor_b32 s23, s21, 0x40000
    buffer_load_dwordx4 v[128:131], v214, s[12:15], s23 offen nt
    s_xor_b32 s23, s21, 0x44000
    buffer_load_dwordx4 v[132:135], v214, s[12:15], s23 offen nt
    s_xor_b32 s23, s21, 0x50000
    buffer_load_dwordx4 v[136:139], v214, s[12:15], s23 offen nt
    s_xor_b32 s23, s21, 0x54000
    buffer_load_dwordx4 v[140:143], v214, s[12:15], s23 offen nt
    s_xor_b32 s23, s21, 0x60000
    buffer_load_dwordx4 v[144:147], v214, s[12:15], s23 offen nt
    s_xor_b32 s23, s21, 0x64000
    buffer_load_dwordx4 v[148:151], v214, s[12:15], s23 offen nt
    s_xor_b32 s23, s21, 0x70000
    buffer_load_dwordx4 v[152:155], v214, s[12:15], s23 offen nt
    s_xor_b32 s23, s21, 0x74000
    buffer_load_dwordx4 v[156:159], v214, s[12:15], s23 offen nt
    s_barrier
    s_cmp_lg_u32 s18, 0
    s_cbranch_scc1 L_m0_3
    s_lshl_b32 s23, s16, 2
    s_add_u32 s23, s23, 160
    s_mov_b32 s21, 1
    s_atomic_add s21, s[60:61], s23
L_m0_3:
    v_bfe_u32 v208, v0, 4, 2
    v_lshlrev_b32 v208, 3, v208
    v_bfe_u32 v210, v0, 2, 2
    v_add_u32 v208, v208, v210
    v_and_b32 v209, 3, v0
    v_bfe_u32 v211, v0, 3, 1
    v_lshlrev_b32 v210, 7, v208
    v_and_b32 v212, 1, v0
    v_lshl_add_u32 v210, v212, 5, v210
    v_bfe_u32 v212, v0, 1, 1
    v_lshl_add_u32 v210, v212, 3, v210
    v_lshl_add_u32 v210, v211, 4, v210
    s_lshr_b32 s21, s18, 1
    s_xor_b32 s21, s21, 1
    s_lshl_b32 s21, s21, 6
    s_add_u32 s21, s21, s22
    v_add_u32 v215, s21, v210
    v_xor_b32 v216, 256, v215
    s_lshr_b32 s21, s18, 1
    s_xor_b32 s21, s21, 0
    s_lshl_b32 s21, s21, 6
    s_add_u32 s21, s21, s22
    v_add_u32 v217, s21, v210
    v_xor_b32 v218, 256, v217
    s_waitcnt vmcnt(16)
    ds_read_b64_tr_b16 a[0:1], v215 offset:0
    ds_read_b64_tr_b16 a[2:3], v215 offset:512
    ds_read_b64_tr_b16 a[4:5], v215 offset:4096
    ds_read_b64_tr_b16 a[6:7], v215 offset:4608
    ds_read_b64_tr_b16 a[32:33], v216 offset:0
    ds_read_b64_tr_b16 a[34:35], v216 offset:512
    ds_read_b64_tr_b16 a[36:37], v216 offset:4096
    ds_read_b64_tr_b16 a[38:39], v216 offset:4608
    s_waitcnt lgkmcnt(0)
    ds_read_b64_tr_b16 a[64:65], v217 offset:0
    ds_read_b64_tr_b16 a[66:67], v217 offset:512
    ds_read_b64_tr_b16 a[68:69], v217 offset:4096
    ds_read_b64_tr_b16 a[70:71], v217 offset:4608
    ds_read_b64_tr_b16 a[96:97], v218 offset:0
    ds_read_b64_tr_b16 a[98:99], v218 offset:512
    ds_read_b64_tr_b16 a[100:101], v218 offset:4096
    ds_read_b64_tr_b16 a[102:103], v218 offset:4608
    s_waitcnt lgkmcnt(0)
    ds_read_b64_tr_b16 a[8:9], v215 offset:8192
    ds_read_b64_tr_b16 a[10:11], v215 offset:8704
    ds_read_b64_tr_b16 a[12:13], v215 offset:12288
    ds_read_b64_tr_b16 a[14:15], v215 offset:12800
    ds_read_b64_tr_b16 a[40:41], v216 offset:8192
    ds_read_b64_tr_b16 a[42:43], v216 offset:8704
    ds_read_b64_tr_b16 a[44:45], v216 offset:12288
    ds_read_b64_tr_b16 a[46:47], v216 offset:12800
    s_waitcnt lgkmcnt(0)
    ds_read_b64_tr_b16 a[72:73], v217 offset:8192
    ds_read_b64_tr_b16 a[74:75], v217 offset:8704
    ds_read_b64_tr_b16 a[76:77], v217 offset:12288
    ds_read_b64_tr_b16 a[78:79], v217 offset:12800
    ds_read_b64_tr_b16 a[104:105], v218 offset:8192
    ds_read_b64_tr_b16 a[106:107], v218 offset:8704
    ds_read_b64_tr_b16 a[108:109], v218 offset:12288
    ds_read_b64_tr_b16 a[110:111], v218 offset:12800
    s_waitcnt lgkmcnt(0)
    ds_read_b64_tr_b16 a[16:17], v215 offset:16384
    ds_read_b64_tr_b16 a[18:19], v215 offset:16896
    ds_read_b64_tr_b16 a[20:21], v215 offset:20480
    ds_read_b64_tr_b16 a[22:23], v215 offset:20992
    ds_read_b64_tr_b16 a[48:49], v216 offset:16384
    ds_read_b64_tr_b16 a[50:51], v216 offset:16896
    ds_read_b64_tr_b16 a[52:53], v216 offset:20480
    ds_read_b64_tr_b16 a[54:55], v216 offset:20992
    s_waitcnt lgkmcnt(0)
    ds_read_b64_tr_b16 a[80:81], v217 offset:16384
    ds_read_b64_tr_b16 a[82:83], v217 offset:16896
    ds_read_b64_tr_b16 a[84:85], v217 offset:20480
    ds_read_b64_tr_b16 a[86:87], v217 offset:20992
    ds_read_b64_tr_b16 a[112:113], v218 offset:16384
    ds_read_b64_tr_b16 a[114:115], v218 offset:16896
    ds_read_b64_tr_b16 a[116:117], v218 offset:20480
    ds_read_b64_tr_b16 a[118:119], v218 offset:20992
    s_waitcnt lgkmcnt(0)
    ds_read_b64_tr_b16 a[24:25], v215 offset:24576
    ds_read_b64_tr_b16 a[26:27], v215 offset:25088
    ds_read_b64_tr_b16 a[28:29], v215 offset:28672
    ds_read_b64_tr_b16 a[30:31], v215 offset:29184
    ds_read_b64_tr_b16 a[56:57], v216 offset:24576
    ds_read_b64_tr_b16 a[58:59], v216 offset:25088
    ds_read_b64_tr_b16 a[60:61], v216 offset:28672
    ds_read_b64_tr_b16 a[62:63], v216 offset:29184
    s_waitcnt lgkmcnt(0)
    ds_read_b64_tr_b16 a[88:89], v217 offset:24576
    ds_read_b64_tr_b16 a[90:91], v217 offset:25088
    ds_read_b64_tr_b16 a[92:93], v217 offset:28672
    ds_read_b64_tr_b16 a[94:95], v217 offset:29184
    ds_read_b64_tr_b16 a[120:121], v218 offset:24576
    ds_read_b64_tr_b16 a[122:123], v218 offset:25088
    ds_read_b64_tr_b16 a[124:125], v218 offset:28672
    ds_read_b64_tr_b16 a[126:127], v218 offset:29184
    s_waitcnt lgkmcnt(0)
    s_and_b32 s21, s17, 1
    s_lshl_b32 s21, s21, 13
    s_add_u32 s21, s21, s22
    v_add_u32 v219, s21, v1
    v_xor_b32 v215, 0x2000, v219
    v_lshlrev_b32 v210, 6, v208
    v_add_u32 v210, s22, v210
    v_lshl_add_u32 v217, v209, 3, v210
    v_lshl_add_u32 v217, v211, 5, v217
    v_xor_b32 v218, 128, v217
    s_waitcnt vmcnt(8)
    ds_write_b128 v219, v[32:35] offset:0
    ds_write_b128 v219, v[36:39] offset:1024
    ds_write_b128 v219, v[40:43] offset:2048
    ds_write_b128 v219, v[44:47] offset:3072
    ds_write_b128 v219, v[48:51] offset:4096
    ds_write_b128 v219, v[52:55] offset:5120
    ds_write_b128 v219, v[56:59] offset:6144
    ds_write_b128 v219, v[60:63] offset:7168
    ds_write_b128 v215, v[64:67] offset:0
    ds_write_b128 v215, v[68:71] offset:1024
    ds_write_b128 v215, v[72:75] offset:2048
    ds_write_b128 v215, v[76:79] offset:3072
    ds_write_b128 v215, v[80:83] offset:4096
    ds_write_b128 v215, v[84:87] offset:5120
    ds_write_b128 v215, v[88:91] offset:6144
    ds_write_b128 v215, v[92:95] offset:7168
    s_waitcnt lgkmcnt(0)
    ds_read_b64_tr_b16 a[128:129], v217 offset:0
    ds_read_b64_tr_b16 a[130:131], v217 offset:256
    ds_read_b64_tr_b16 a[132:133], v217 offset:2048
    ds_read_b64_tr_b16 a[134:135], v217 offset:2304
    ds_read_b64_tr_b16 a[160:161], v218 offset:0
    ds_read_b64_tr_b16 a[162:163], v218 offset:256
    ds_read_b64_tr_b16 a[164:165], v218 offset:2048
    ds_read_b64_tr_b16 a[166:167], v218 offset:2304
    s_waitcnt lgkmcnt(0)
    ds_read_b64_tr_b16 a[136:137], v217 offset:4096
    ds_read_b64_tr_b16 a[138:139], v217 offset:4352
    ds_read_b64_tr_b16 a[140:141], v217 offset:6144
    ds_read_b64_tr_b16 a[142:143], v217 offset:6400
    ds_read_b64_tr_b16 a[168:169], v218 offset:4096
    ds_read_b64_tr_b16 a[170:171], v218 offset:4352
    ds_read_b64_tr_b16 a[172:173], v218 offset:6144
    ds_read_b64_tr_b16 a[174:175], v218 offset:6400
    s_waitcnt lgkmcnt(0)
    ds_read_b64_tr_b16 a[144:145], v217 offset:8192
    ds_read_b64_tr_b16 a[146:147], v217 offset:8448
    ds_read_b64_tr_b16 a[148:149], v217 offset:10240
    ds_read_b64_tr_b16 a[150:151], v217 offset:10496
    ds_read_b64_tr_b16 a[176:177], v218 offset:8192
    ds_read_b64_tr_b16 a[178:179], v218 offset:8448
    ds_read_b64_tr_b16 a[180:181], v218 offset:10240
    ds_read_b64_tr_b16 a[182:183], v218 offset:10496
    s_waitcnt lgkmcnt(0)
    ds_read_b64_tr_b16 a[152:153], v217 offset:12288
    ds_read_b64_tr_b16 a[154:155], v217 offset:12544
    ds_read_b64_tr_b16 a[156:157], v217 offset:14336
    ds_read_b64_tr_b16 a[158:159], v217 offset:14592
    ds_read_b64_tr_b16 a[184:185], v218 offset:12288
    ds_read_b64_tr_b16 a[186:187], v218 offset:12544
    ds_read_b64_tr_b16 a[188:189], v218 offset:14336
    ds_read_b64_tr_b16 a[190:191], v218 offset:14592
    s_waitcnt lgkmcnt(0)
    s_waitcnt vmcnt(0)
    ds_write_b128 v219, v[96:99] offset:16384
    ds_write_b128 v219, v[100:103] offset:17408
    ds_write_b128 v219, v[104:107] offset:18432
    ds_write_b128 v219, v[108:111] offset:19456
    ds_write_b128 v219, v[112:115] offset:20480
    ds_write_b128 v219, v[116:119] offset:21504
    ds_write_b128 v219, v[120:123] offset:22528
    ds_write_b128 v219, v[124:127] offset:23552
    ds_write_b128 v215, v[128:131] offset:16384
    ds_write_b128 v215, v[132:135] offset:17408
    ds_write_b128 v215, v[136:139] offset:18432
    ds_write_b128 v215, v[140:143] offset:19456
    ds_write_b128 v215, v[144:147] offset:20480
    ds_write_b128 v215, v[148:151] offset:21504
    ds_write_b128 v215, v[152:155] offset:22528
    ds_write_b128 v215, v[156:159] offset:23552
    s_waitcnt lgkmcnt(0)
    ds_read_b64_tr_b16 a[192:193], v217 offset:16384
    ds_read_b64_tr_b16 a[194:195], v217 offset:16640
    ds_read_b64_tr_b16 a[196:197], v217 offset:18432
    ds_read_b64_tr_b16 a[198:199], v217 offset:18688
    ds_read_b64_tr_b16 a[224:225], v218 offset:16384
    ds_read_b64_tr_b16 a[226:227], v218 offset:16640
    ds_read_b64_tr_b16 a[228:229], v218 offset:18432
    ds_read_b64_tr_b16 a[230:231], v218 offset:18688
    s_waitcnt lgkmcnt(0)
    ds_read_b64_tr_b16 a[200:201], v217 offset:20480
    ds_read_b64_tr_b16 a[202:203], v217 offset:20736
    ds_read_b64_tr_b16 a[204:205], v217 offset:22528
    ds_read_b64_tr_b16 a[206:207], v217 offset:22784
    ds_read_b64_tr_b16 a[232:233], v218 offset:20480
    ds_read_b64_tr_b16 a[234:235], v218 offset:20736
    ds_read_b64_tr_b16 a[236:237], v218 offset:22528
    ds_read_b64_tr_b16 a[238:239], v218 offset:22784
    s_waitcnt lgkmcnt(0)
    ds_read_b64_tr_b16 a[208:209], v217 offset:24576
    ds_read_b64_tr_b16 a[210:211], v217 offset:24832
    ds_read_b64_tr_b16 a[212:213], v217 offset:26624
    ds_read_b64_tr_b16 a[214:215], v217 offset:26880
    ds_read_b64_tr_b16 a[240:241], v218 offset:24576
    ds_read_b64_tr_b16 a[242:243], v218 offset:24832
    ds_read_b64_tr_b16 a[244:245], v218 offset:26624
    ds_read_b64_tr_b16 a[246:247], v218 offset:26880
    s_waitcnt lgkmcnt(0)
    ds_read_b64_tr_b16 a[216:217], v217 offset:28672
    ds_read_b64_tr_b16 a[218:219], v217 offset:28928
    ds_read_b64_tr_b16 a[220:221], v217 offset:30720
    ds_read_b64_tr_b16 a[222:223], v217 offset:30976
    ds_read_b64_tr_b16 a[248:249], v218 offset:28672
    ds_read_b64_tr_b16 a[250:251], v218 offset:28928
    ds_read_b64_tr_b16 a[252:253], v218 offset:30720
    ds_read_b64_tr_b16 a[254:255], v218 offset:30976
    s_waitcnt lgkmcnt(0)
    v_and_b32 v208, 15, v0
    v_lshlrev_b32 v208, 7, v208
    s_lshl_b32 s21, s17, 11
    s_add_u32 s21, s21, s42
    buffer_load_dword v209, v208, s[8:11], s21 offen sc1
    s_cmp_lg_u32 s18, 0
    s_cbranch_scc1 L_init_4
    s_lshl_b32 s21, s29, 9
    s_add_u32 s21, s21, s53
    v_min_u32 v232, 0xfffffffe, v232
    v_min_u32 v233, 0xfffffffe, v233
    buffer_store_dwordx2 v[232:233], v26, s[8:11], s21 offen
L_init_4:
    s_lshl_b32 s23, s16, 2
    s_add_u32 s23, s23, 160
    v_mov_b32 v248, s23
L_kvw_5:
    global_load_dword v249, v248, s[60:61] sc1
    s_add_u32 s33, s33, 1
    s_cmp_gt_u32 s33, 0x100000
    s_cbranch_scc1 chain_kernel_abort
    s_waitcnt vmcnt(0)
    v_readfirstlane_b32 s20, v249
    s_cmp_ge_u32 s20, 32
    s_cbranch_scc1 L_kvok_6
    s_sleep 16
    s_branch L_kvw_5
L_kvok_6:
    s_mov_b32 s19, 0
    s_mov_b32 s55, 0
    s_lshl_b32 s54, s18, 11
    s_add_u32 s54, s54, 32768
    s_and_b32 s51, s18, 1
    s_lshl_b32 s51, s51, 10
    s_add_u32 s51, s51, 40960
    s_mov_b32 s30, 0xc0000
    s_mov_b32 s41, s53
    v_mov_b32 v197, 0
    v_mov_b32 v198, 0
    v_mov_b32 v248, 4
L_kvw_7:
    global_load_dword v249, v248, s[60:61] sc1
    s_add_u32 s33, s33, 1
    s_cmp_gt_u32 s33, 0x100000
    s_cbranch_scc1 chain_kernel_abort
    s_waitcnt vmcnt(0)
    v_readfirstlane_b32 s20, v249
    s_and_b32 s21, s20, 0xff
    s_cmp_ge_u32 s21, 15
    s_cbranch_scc1 L_kvok_8
    s_sleep 16
    s_branch L_kvw_7
L_kvok_8:
    s_cmp_ge_u32 s20, 0x800
    s_cselect_b32 s50, 0x2000, 0
    s_add_u32 s52, s50, 0x8000000
    s_add_u32 s48, s48, s50
    s_add_u32 s49, s49, s50
    v_and_b32 v208, 63, v0
    v_lshlrev_b32 v208, 2, v208
    s_lshr_b32 s22, s17, 3
    s_lshl_b32 s22, s22, 14
    s_and_b32 s23, s17, 7
    s_lshl_b32 s23, s23, 10
    s_add_u32 s22, s22, s23
    s_lshl_b32 s23, s18, 8
    s_add_u32 s22, s22, s23
    s_xor_b32 s21, s16, 0
    s_lshl_b32 s21, s21, 16
    s_add_u32 s21, s21, s22
    v_add_u32 v8, s21, v208
    s_xor_b32 s21, s16, 1
    s_lshl_b32 s21, s21, 16
    s_add_u32 s21, s21, s22
    v_add_u32 v9, s21, v208
    s_xor_b32 s21, s16, 2
    s_lshl_b32 s21, s21, 16
    s_add_u32 s21, s21, s22
    v_add_u32 v10, s21, v208
    s_xor_b32 s21, s16, 3
    s_lshl_b32 s21, s21, 16
    s_add_u32 s21, s21, s22
    v_add_u32 v11, s21, v208
    s_barrier
    s_cmp_lg_u32 s18, 3
    s_cbranch_scc1 L_init3_9
    v_mov_b32 v248, 0
    s_lshl2_add_u32 s20, s17, s18
    s_cmp_lg_u32 s20, 7
    s_cbranch_scc1 L_rlo_11
L_rl_10:
    s_load_dword s20, s[60:61], 64 glc
    s_add_u32 s33, s33, 1
    s_cmp_gt_u32 s33, 0x100000
    s_cbranch_scc1 chain_kernel_abort
    s_waitcnt lgkmcnt(0)
    s_cmp_lt_u32 s20, 64
    s_cbranch_scc1 L_rl_10
    v_mov_b32 v249, 1
    buffer_store_dword v249, v248, s[8:11], s62 offen
    s_branch L_rlok_12
L_rlo_11:
    buffer_load_dword v249, v248, s[8:11], s62 offen sc1
    s_add_u32 s33, s33, 1
    s_cmp_gt_u32 s33, 0x100000
    s_cbranch_scc1 chain_kernel_abort
    s_waitcnt vmcnt(0)
    v_readfirstlane_b32 s20, v249
    s_cmp_ge_u32 s20, 1
    s_cbranch_scc1 L_rlok_12
    s_sleep 1
    s_branch L_rlo_11
L_rlok_12:
    s_add_u32 s21, s19, 0
    s_min_u32 s21, s21, 63
    s_lshl_b32 s31, s21, 20
    s_lshl_b32 s21, s21, 12
    s_and_b32 s21, s21, 0x2000
    s_xor_b32 s21, s21, s48
    s_mov_b32 m0, 32768
    s_add_u32 s31, s31, s21
    buffer_load_dwordx4 v1, s[8:11], s31 offen offset:0 lds
    buffer_load_dwordx4 v1, s[8:11], s31 offen offset:1024 lds
    buffer_load_dwordx4 v1, s[8:11], s31 offen offset:2048 lds
    buffer_load_dwordx4 v1, s[8:11], s31 offen offset:3072 lds
    s_mov_b32 m0, 36864
    s_nop 0
    buffer_load_dwordx4 v236, s[8:11], s31 offen offset:0 lds
    buffer_load_dwordx4 v236, s[8:11], s31 offen offset:1024 lds
    buffer_load_dwordx4 v236, s[8:11], s31 offen offset:2048 lds
    buffer_load_dwordx4 v236, s[8:11], s31 offen offset:3072 lds
    s_mov_b32 m0, 40960
    s_nop 0
    buffer_load_dwordx4 v237, s[8:11], s31 offen offset:0 lds
    buffer_load_dwordx4 v237, s[8:11], s31 offen offset:1024 lds
L_init3_9:
    s_waitcnt vmcnt(0) lgkmcnt(0)
    s_barrier
chain_kernel_loop:
    s_mov_b32 s40, s41
    s_add_u32 s30, s30, 0x40000
    s_and_b32 s30, s30, 0xc0000
    s_xor_b32 s20, s30, 0x80000
    s_add_u32 s42, s53, s20
    s_lshl_b32 s43, s19, 19
    s_lshl_b32 s20, s19, 11
    s_and_b32 s20, s20, 0x2000
    s_xor_b32 s20, s20, s52
    s_add_u32 s43, s43, s20
    s_add_u32 s44, s43, 0x40000
    s_add_u32 s20, s30, 0x40000
    s_and_b32 s20, s20, 0xc0000
    s_add_u32 s41, s53, s20
    v_mov_b32 v64, 0
    v_mov_b32 v65, 0
    v_mov_b32 v66, 0
    v_mov_b32 v67, 0
    v_mov_b32 v68, 0
    v_mov_b32 v69, 0
    v_mov_b32 v70, 0
    v_mov_b32 v71, 0
    v_mov_b32 v72, 0
    v_mov_b32 v73, 0
    v_mov_b32 v74, 0
    v_mov_b32 v75, 0
    v_mov_b32 v76, 0
    v_mov_b32 v77, 0
    v_mov_b32 v78, 0
    v_mov_b32 v79, 0
    s_nop 13
    buffer_load_dwordx4 v[32:35], v2, s[8:11], s40 offen offset:0 sc1
    s_nop 13
    buffer_load_dwordx4 v[36:39], v2, s[8:11], s40 offen offset:1024 sc1
    s_nop 13
    buffer_load_dwordx4 v[40:43], v2, s[8:11], s40 offen offset:2048 sc1
    s_nop 13
    buffer_load_dwordx4 v[44:47], v2, s[8:11], s40 offen offset:3072 sc1
Gq_15_s0123:
    s_waitcnt vmcnt(3)
    v_cmp_eq_u32 vcc, -1, v32
    v_mov_b32_dpp v48, v32 row_ror:8 row_mask:0xf bank_mask:0xf
    v_mov_b32_dpp v49, v33 row_ror:8 row_mask:0xf bank_mask:0xf
    v_mov_b32_dpp v50, v34 row_ror:8 row_mask:0xf bank_mask:0xf
    v_mov_b32_dpp v51, v35 row_ror:8 row_mask:0xf bank_mask:0xf
    s_cbranch_vccnz Gq_15_f0123
    v_smfmac_f32_16x16x64_bf16 v[64:67], v[32:35], a[0:7], v19
    v_smfmac_f32_16x16x64_bf16 v[68:71], v[32:35], a[64:71], v19
Gq_15_s123p0:
    s_waitcnt vmcnt(2)
    v_cmp_eq_u32 vcc, -1, v36
    v_smfmac_f32_16x16x64_bf16 v[64:67], v[48:51], a[32:39], v19
    v_mov_b32_dpp v52, v36 row_ror:8 row_mask:0xf bank_mask:0xf
    v_mov_b32_dpp v53, v37 row_ror:8 row_mask:0xf bank_mask:0xf
    v_smfmac_f32_16x16x64_bf16 v[68:71], v[48:51], a[96:103], v19
    v_mov_b32_dpp v54, v38 row_ror:8 row_mask:0xf bank_mask:0xf
    v_mov_b32_dpp v55, v39 row_ror:8 row_mask:0xf bank_mask:0xf
    s_cbranch_vccnz Gq_15_f123p0
    v_smfmac_f32_16x16x64_bf16 v[64:67], v[36:39], a[8:15], v19
    v_smfmac_f32_16x16x64_bf16 v[68:71], v[36:39], a[72:79], v19
Gq_15_s23p1:
    s_waitcnt vmcnt(1)
    v_cmp_eq_u32 vcc, -1, v40
    v_smfmac_f32_16x16x64_bf16 v[64:67], v[52:55], a[40:47], v19
    v_mov_b32_dpp v56, v40 row_ror:8 row_mask:0xf bank_mask:0xf
    v_mov_b32_dpp v57, v41 row_ror:8 row_mask:0xf bank_mask:0xf
    v_smfmac_f32_16x16x64_bf16 v[68:71], v[52:55], a[104:111], v19
    v_mov_b32_dpp v58, v42 row_ror:8 row_mask:0xf bank_mask:0xf
    v_mov_b32_dpp v59, v43 row_ror:8 row_mask:0xf bank_mask:0xf
    s_cbranch_vccnz Gq_15_f23p1
    v_smfmac_f32_16x16x64_bf16 v[64:67], v[40:43], a[16:23], v19
    v_smfmac_f32_16x16x64_bf16 v[68:71], v[40:43], a[80:87], v19
Gq_15_s3p2:
    s_waitcnt vmcnt(0)
    v_cmp_eq_u32 vcc, -1, v44
    v_smfmac_f32_16x16x64_bf16 v[64:67], v[56:59], a[48:55], v19
    v_mov_b32_dpp v60, v44 row_ror:8 row_mask:0xf bank_mask:0xf
    v_mov_b32_dpp v61, v45 row_ror:8 row_mask:0xf bank_mask:0xf
    v_smfmac_f32_16x16x64_bf16 v[68:71], v[56:59], a[112:119], v19
    v_mov_b32_dpp v62, v46 row_ror:8 row_mask:0xf bank_mask:0xf
    v_mov_b32_dpp v63, v47 row_ror:8 row_mask:0xf bank_mask:0xf
    s_cbranch_vccnz Gq_15_f3p2
    v_smfmac_f32_16x16x64_bf16 v[64:67], v[44:47], a[24:31], v19
    v_smfmac_f32_16x16x64_bf16 v[68:71], v[44:47], a[88:95], v19
    v_smfmac_f32_16x16x64_bf16 v[64:67], v[60:63], a[56:63], v19
    v_smfmac_f32_16x16x64_bf16 v[68:71], v[60:63], a[120:127], v19
Gq_15_done:
    v_max3_u32 v20, v33, v34, v35
    v_max3_u32 v208, v37, v38, v39
    v_max3_u32 v209, v41, v42, v43
    v_max3_u32 v210, v45, v46, v47
    ds_write_b64 v12, v[64:65] offset:0
    ds_write_b64 v13, v[66:67] offset:0
    v_max_u32 v20, v20, v208
    v_max3_u32 v20, v20, v209, v210
    ds_write_b64 v14, v[68:69] offset:0
    v_cmp_eq_u32 vcc, -1, v20
    v_smfmac_f32_16x16x64_bf16 v[72:75], v[32:35], a[128:135], v19
    v_smfmac_f32_16x16x64_bf16 v[72:75], v[48:51], a[160:167], v19
    s_cbranch_vccnz Gq_15_redo
    s_waitcnt lgkmcnt(0)
    s_barrier
    ds_read_b64 v[80:81], v15 offset:0
    ds_read_b64 v[82:83], v15 offset:512
    ds_read_b64 v[84:85], v15 offset:1024
    v_smfmac_f32_16x16x64_bf16 v[72:75], v[36:39], a[136:143], v19
    v_smfmac_f32_16x16x64_bf16 v[72:75], v[52:55], a[168:175], v19
    v_smfmac_f32_16x16x64_bf16 v[72:75], v[40:43], a[144:151], v19
    s_waitcnt lgkmcnt(2)
    v_pk_add_f32 v[70:71], v[70:71], v[80:81]
    s_waitcnt lgkmcnt(0)
    v_pk_add_f32 v[82:83], v[82:83], v[84:85]
    v_pk_add_f32 v[70:71], v[70:71], v[82:83]
    v_cvt_pk_bf16_f32 v70, v70, v71
    s_cmp_lg_u32 s18, 0
    s_nop 0
    v_mov_b32_dpp v71, v70 quad_perm:[1,0,3,2] row_mask:0xf bank_mask:0xf
    v_perm_b32 v70, v71, v70, v18
    v_min_u32 v70, 0xfffffffe, v70
    buffer_store_dword v70, v4, s[8:11], s40 offen
    v_smfmac_f32_16x16x64_bf16 v[72:75], v[56:59], a[176:183], v19
    v_smfmac_f32_16x16x64_bf16 v[72:75], v[44:47], a[152:159], v19
    v_smfmac_f32_16x16x64_bf16 v[72:75], v[60:63], a[184:191], v19
    ds_write_b32 v234, v70 offset:29696
    s_nop 6
    ds_write_b128 v16, v[72:75] offset:12288
    s_cbranch_scc1 L_help_13
    s_cmp_eq_u32 s19, 63
    s_nop 15
    s_nop 2
    buffer_load_dwordx4 v[148:151], v5, s[8:11], s40 offen offset:0 sc1
    buffer_load_dwordx4 v[152:155], v5, s[8:11], s40 offen offset:1024 sc1
    buffer_load_dwordx4 v[156:159], v5, s[8:11], s40 offen offset:2048 sc1
    buffer_load_dwordx4 v[160:163], v5, s[8:11], s40 offen offset:3072 sc1
    s_waitcnt lgkmcnt(0)
    s_barrier
    s_cbranch_scc1 chain_kernel_fin0
    ds_read_b128 v[104:107], v1 offset:32768
    ds_read_b128 v[108:111], v1 offset:33792
    ds_read_b128 v[112:115], v1 offset:34816
    ds_read_b128 v[116:119], v1 offset:35840
    ds_read_b128 v[120:123], v1 offset:36864
    ds_read_b128 v[124:127], v1 offset:37888
    ds_read_b128 v[128:131], v1 offset:38912
    ds_read_b128 v[132:135], v1 offset:39936
    ds_read_b128 v[136:139], v1 offset:40960
    ds_read_b128 v[140:143], v1 offset:41984
    buffer_load_dwordx4 v[164:167], v5, s[8:11], s40 offen offset:0 sc1
    buffer_load_dwordx4 v[168:171], v5, s[8:11], s40 offen offset:1024 sc1
    buffer_load_dwordx4 v[172:175], v5, s[8:11], s40 offen offset:2048 sc1
    buffer_load_dwordx4 v[176:179], v5, s[8:11], s40 offen offset:3072 sc1
    s_nop 13
    buffer_load_dwordx4 v[32:35], v5, s[8:11], s40 offen offset:0 sc1
    buffer_load_dwordx4 v[36:39], v5, s[8:11], s40 offen offset:1024 sc1
    buffer_load_dwordx4 v[40:43], v5, s[8:11], s40 offen offset:2048 sc1
    buffer_load_dwordx4 v[44:47], v5, s[8:11], s40 offen offset:3072 sc1
    s_waitcnt lgkmcnt(0)
L_sd_16_0_0:
    s_waitcnt vmcnt(11)
    v_max3_u32 v20, v148, v149, v150
    v_mfma_f32_16x16x32_bf16 v[88:91], v[148:151], v[148:151], 0
    v_max_u32 v20, v20, v151
    v_cmp_eq_u32 vcc, -1, v20
    v_mfma_f32_16x16x32_bf16 v[84:87], v[120:123], v[148:151], 0
    v_mfma_f32_16x16x32_bf16 v[80:83], v[104:107], v[148:151], 0
    s_cbranch_vccnz L_sd_16_1_0
L_sd_16_0_1:
    s_waitcnt vmcnt(10)
    v_max3_u32 v20, v152, v153, v154
    v_mfma_f32_16x16x32_bf16 v[100:103], v[152:155], v[152:155], v[88:91]
    v_max_u32 v20, v20, v155
    v_cmp_eq_u32 vcc, -1, v20
    v_mfma_f32_16x16x32_bf16 v[96:99], v[124:127], v[152:155], v[84:87]
    v_mfma_f32_16x16x32_bf16 v[92:95], v[108:111], v[152:155], v[80:83]
    s_cbranch_vccnz L_sd_16_1_1
L_sd_16_0_2:
    s_waitcnt vmcnt(9)
    v_max3_u32 v20, v156, v157, v158
    v_mfma_f32_16x16x32_bf16 v[228:231], v[156:159], v[156:159], v[100:103]
    v_max_u32 v20, v20, v159
    v_cmp_eq_u32 vcc, -1, v20
    v_mfma_f32_16x16x32_bf16 v[224:227], v[128:131], v[156:159], v[96:99]
    v_mfma_f32_16x16x32_bf16 v[220:223], v[112:115], v[156:159], v[92:95]
    s_cbranch_vccnz L_sd_16_1_2
L_sd_16_0_3:
    s_waitcnt vmcnt(8)
    v_max3_u32 v20, v160, v161, v162
    v_mfma_f32_16x16x32_bf16 v[188:191], v[160:163], v[160:163], v[228:231]
    v_max_u32 v20, v20, v163
    v_cmp_eq_u32 vcc, -1, v20
    v_mfma_f32_16x16x32_bf16 v[184:187], v[132:135], v[160:163], v[224:227]
    v_mfma_f32_16x16x32_bf16 v[180:183], v[116:119], v[160:163], v[220:223]
    v_mov_b32_dpp v188, v189 row_ror:8 row_mask:0xf bank_mask:0xc
    v_mov_b32_dpp v190, v191 row_ror:8 row_mask:0xf bank_mask:0xc
    s_cbranch_vccnz L_sd_16_1_3
L_sd_16:
    s_barrier
    v_permlane32_swap_b32 v188, v190
    ds_read_b64 v[144:145], v26 offset:28672
    s_nop 1
    v_mov_b32_dpp v180, v184 row_ror:8 row_mask:0xf bank_mask:0xc
    v_mov_b32_dpp v181, v185 row_ror:8 row_mask:0xf bank_mask:0xc
    v_mov_b32_dpp v182, v186 row_ror:8 row_mask:0xf bank_mask:0xc
    v_mov_b32_dpp v183, v187 row_ror:8 row_mask:0xf bank_mask:0xc
    v_max3_f32 v208, v190, v180, v181
    v_max3_f32 v208, v208, v182, v183
    v_cvt_pk_bf16_f32 v180, 0, v180
    v_cvt_pk_bf16_f32 v181, 0, v181
    v_max_f32_dpp v208, v208, v208 row_ror:8 row_mask:0xf bank_mask:0xf
    v_mov_b32 v209, v208
    v_cvt_pk_bf16_f32 v182, 0, v182
    v_cvt_pk_bf16_f32 v183, 0, v183
    v_permlane16_swap_b32 v208, v209
    v_cvt_pk_bf16_f32 v190, 0, v190
    v_max_f32 v208, v208, v209
    v_mov_b32 v209, v208
    v_pk_mul_f32 v[180:181], v[180:181], s[58:59]
    v_pk_mul_f32 v[182:183], v[182:183], s[58:59]
    v_permlane32_swap_b32 v208, v209
    v_mul_f32 v190, s58, v190
    v_max_f32 v208, v208, v209
    v_cvt_pk_bf16_f32 v180, 0, v180
    v_cvt_pk_bf16_f32 v208, 0, v208
    v_cvt_pk_bf16_f32 v181, 0, v181
    v_mul_f32 v208, s58, v208
    v_cvt_pk_bf16_f32 v182, 0, v182
    v_cvt_pk_bf16_f32 v208, 0, v208
    v_cvt_pk_bf16_f32 v183, 0, v183
    v_mul_f32 v208, s56, v208
    v_cvt_pk_bf16_f32 v190, 0, v190
    v_pk_fma_f32 v[180:181], v[180:181], s[56:57], v[208:209] op_sel_hi:[1,1,0] neg_lo:[0,0,1] neg_hi:[0,0,1]
    v_pk_fma_f32 v[182:183], v[182:183], s[56:57], v[208:209] op_sel_hi:[1,1,0] neg_lo:[0,0,1] neg_hi:[0,0,1]
    v_fma_f32 v190, v190, s56, -v208
    v_exp_f32 v180, v180
    v_exp_f32 v181, v181
    v_exp_f32 v182, v182
    v_exp_f32 v183, v183
    v_exp_f32 v190, v190
    v_cvt_pk_bf16_f32 v192, v180, v181
    v_cvt_pk_bf16_f32 v193, v182, v183
    v_mov_b32_dpp v209, v190 row_ror:8 row_mask:0xf bank_mask:0xf
    v_mov_b32_dpp v194, v192 row_ror:8 row_mask:0xf bank_mask:0xf
    v_mov_b32_dpp v195, v193 row_ror:8 row_mask:0xf bank_mask:0xf
    v_cvt_pk_bf16_f32 v196, v190, v209
    v_pk_add_f32 v[210:211], v[180:181], v[182:183]
    v_mfma_f32_16x16x32_bf16 v[200:203], v[136:139], v[192:195], 0
    v_add_f32 v210, v210, v190
    v_add_f32 v210, v210, v211
    v_mfma_f32_16x16x32_bf16 v[204:207], v[140:143], v[192:195], 0
    v_cvt_pk_bf16_f32 v199, v190, v209
    s_waitcnt lgkmcnt(0)
    v_add_f32_dpp v210, v210, v210 row_ror:8 row_mask:0xf bank_mask:0xf
    v_mfma_f32_16x16x16_bf16 v[200:203], v[144:145], v[196:197], v[200:203]
    v_mov_b32 v209, v210
    s_nop 0
    v_mfma_f32_16x16x16_bf16 v[204:207], v[144:145], v[198:199], v[204:207]
    v_permlane16_swap_b32 v210, v209
    v_add_f32 v210, v210, v209
    v_mov_b32 v209, v210
    s_nop 1
    v_permlane32_swap_b32 v210, v209
    v_add_f32 v210, v210, v209
    v_rcp_f32 v210, v210
    s_mov_b64 exec, s[24:25]
    v_pk_mul_f32 v[200:201], v[200:201], v[210:211] op_sel_hi:[1,0]
    v_pk_mul_f32 v[202:203], v[202:203], v[210:211] op_sel_hi:[1,0]
    v_pk_mul_f32 v[204:205], v[204:205], v[210:211] op_sel_hi:[1,0]
    v_pk_mul_f32 v[206:207], v[206:207], v[210:211] op_sel_hi:[1,0]
    v_cvt_pk_bf16_f32 v200, v200, v201
    v_cvt_pk_bf16_f32 v201, v202, v203
    v_cvt_pk_bf16_f32 v202, v204, v205
    v_cvt_pk_bf16_f32 v203, v206, v207
    v_min_u32 v200, 0xfffffffe, v200
    v_min_u32 v201, 0xfffffffe, v201
    v_min_u32 v202, 0xfffffffe, v202
    v_min_u32 v203, 0xfffffffe, v203
    buffer_store_dwordx4 v[200:203], v6, s[8:11], s40 offen
    s_mov_b64 exec, -1
L_b4_14:
    s_barrier
    s_add_u32 s19, s19, 1
    s_nop 15
    s_nop 15
    s_nop 2
    buffer_load_dwordx4 v[32:35], v3, s[8:11], s40 offen offset:0 sc1
    s_nop 13
    buffer_load_dwordx4 v[36:39], v3, s[8:11], s40 offen offset:1024 sc1
    s_nop 13
    buffer_load_dwordx4 v[40:43], v3, s[8:11], s40 offen offset:2048 sc1
    s_nop 13
    buffer_load_dwordx4 v[44:47], v3, s[8:11], s40 offen offset:3072 sc1
Go_17_s0123:
    s_waitcnt vmcnt(3)
    v_cmp_eq_u32 vcc, -1, v32
    v_mov_b32_dpp v48, v32 row_ror:8 row_mask:0xf bank_mask:0xf
    v_mov_b32_dpp v49, v33 row_ror:8 row_mask:0xf bank_mask:0xf
    v_mov_b32_dpp v50, v34 row_ror:8 row_mask:0xf bank_mask:0xf
    v_mov_b32_dpp v51, v35 row_ror:8 row_mask:0xf bank_mask:0xf
    s_cbranch_vccnz Go_17_f0123
    v_smfmac_f32_16x16x64_bf16 v[76:79], v[32:35], a[192:199], v19
    v_smfmac_f32_16x16x64_bf16 v[76:79], v[48:51], a[224:231], v19
Go_17_s123:
    s_waitcnt vmcnt(2)
    v_cmp_eq_u32 vcc, -1, v36
    v_mov_b32_dpp v52, v36 row_ror:8 row_mask:0xf bank_mask:0xf
    v_mov_b32_dpp v53, v37 row_ror:8 row_mask:0xf bank_mask:0xf
    v_mov_b32_dpp v54, v38 row_ror:8 row_mask:0xf bank_mask:0xf
    v_mov_b32_dpp v55, v39 row_ror:8 row_mask:0xf bank_mask:0xf
    s_cbranch_vccnz Go_17_f123
    v_smfmac_f32_16x16x64_bf16 v[76:79], v[36:39], a[200:207], v19
    v_smfmac_f32_16x16x64_bf16 v[76:79], v[52:55], a[232:239], v19
Go_17_s23:
    s_waitcnt vmcnt(1)
    v_cmp_eq_u32 vcc, -1, v40
    v_mov_b32_dpp v56, v40 row_ror:8 row_mask:0xf bank_mask:0xf
    v_mov_b32_dpp v57, v41 row_ror:8 row_mask:0xf bank_mask:0xf
    v_mov_b32_dpp v58, v42 row_ror:8 row_mask:0xf bank_mask:0xf
    v_mov_b32_dpp v59, v43 row_ror:8 row_mask:0xf bank_mask:0xf
    s_cbranch_vccnz Go_17_f23
    v_smfmac_f32_16x16x64_bf16 v[76:79], v[40:43], a[208:215], v19
    v_smfmac_f32_16x16x64_bf16 v[76:79], v[56:59], a[240:247], v19
Go_17_s3:
    s_waitcnt vmcnt(0)
    v_cmp_eq_u32 vcc, -1, v44
    v_mov_b32_dpp v60, v44 row_ror:8 row_mask:0xf bank_mask:0xf
    v_mov_b32_dpp v61, v45 row_ror:8 row_mask:0xf bank_mask:0xf
    v_mov_b32_dpp v62, v46 row_ror:8 row_mask:0xf bank_mask:0xf
    v_mov_b32_dpp v63, v47 row_ror:8 row_mask:0xf bank_mask:0xf
    s_cbranch_vccnz Go_17_f3
    v_smfmac_f32_16x16x64_bf16 v[76:79], v[44:47], a[216:223], v19
    v_smfmac_f32_16x16x64_bf16 v[76:79], v[60:63], a[248:255], v19
Go_17_done:
    v_max3_u32 v20, v33, v34, v35
    v_max3_u32 v208, v37, v38, v39
    v_max3_u32 v209, v41, v42, v43
    v_max3_u32 v210, v45, v46, v47
    v_max_u32 v20, v20, v208
    v_max3_u32 v20, v20, v209, v210
    v_cmp_eq_u32 vcc, -1, v20
    s_nop 0
    ds_write_b32 v238, v76 offset:20480
    ds_write_b32 v239, v77 offset:20480
    ds_write_b32 v240, v78 offset:20480
    s_cbranch_vccnz Go_17_redo
    s_waitcnt lgkmcnt(0)
    s_barrier
    ds_read_b32 v80, v17 offset:20480
    ds_read_b32 v81, v17 offset:20736
    ds_read_b32 v82, v17 offset:20992
    s_waitcnt lgkmcnt(2)
    v_add_f32 v80, v80, v79
    s_waitcnt lgkmcnt(0)
    v_add_f32 v81, v81, v82
    v_add_f32 v80, v80, v81
    v_min_u32 v80, 0xfffffffe, v80
    buffer_store_dword v80, v8, s[8:11], s43 offen sc1
    buffer_store_dword v80, v8, s[8:11], s44 offen sc1
    s_nop 15
    s_nop 15
    s_nop 15
    s_nop 11
    buffer_load_dword v220, v9, s[8:11], s43 offen sc1
    buffer_load_dword v221, v10, s[8:11], s43 offen sc1
    buffer_load_dword v222, v11, s[8:11], s43 offen sc1
    s_nop 15
    s_nop 13
    buffer_load_dword v223, v9, s[8:11], s44 offen sc1
    buffer_load_dword v224, v10, s[8:11], s44 offen sc1
    buffer_load_dword v225, v11, s[8:11], s44 offen sc1
    s_waitcnt vmcnt(5)
    v_add_f32 v208, v80, v220
    s_waitcnt vmcnt(3)
    v_add_f32 v209, v221, v222
    v_max3_u32 v20, v220, v221, v222
    v_add_f32 v208, v208, v209
    v_cmp_eq_u32 vcc, -1, v20
    s_nop 0
    v_mov_b32_dpp v209, v208 quad_perm:[1,0,3,2] row_mask:0xf bank_mask:0xf
    s_mov_b64 exec, s[26:27]
    v_cvt_pk_bf16_f32 v208, v208, v209
    v_min_u32 v208, 0xfffffffe, v208
    s_cbranch_vccnz L_pf_22
L_pd_21:
    buffer_store_dword v208, v7, s[8:11], s41 offen
    s_mov_b64 exec, -1
    s_branch chain_kernel_loop
L_help_13:
    s_waitcnt lgkmcnt(0)
    s_barrier
    s_cmp_eq_u32 s18, 2
    s_cbranch_scc1 L_w2_26
    s_cmp_eq_u32 s18, 3
    s_cbranch_scc1 L_w3_27
    ds_read_b128 v[80:83], v1 offset:12288
    ds_read_b128 v[84:87], v1 offset:14336
    ds_read_b128 v[88:91], v1 offset:15360
    s_waitcnt lgkmcnt(2)
    v_pk_add_f32 v[72:73], v[72:73], v[82:83]
    v_pk_add_f32 v[74:75], v[74:75], v[80:81]
    s_waitcnt lgkmcnt(1)
    v_pk_add_f32 v[72:73], v[72:73], v[86:87]
    v_pk_add_f32 v[74:75], v[74:75], v[84:85]
    s_waitcnt lgkmcnt(0)
    v_pk_add_f32 v[72:73], v[72:73], v[88:89]
    v_pk_add_f32 v[74:75], v[74:75], v[90:91]
    v_cvt_pk_bf16_f32 v144, v72, v73
    v_cvt_pk_bf16_f32 v145, v74, v75
    v_min_u32 v144, 0xfffffffe, v144
    v_min_u32 v145, 0xfffffffe, v145
    s_nop 1
    v_permlane32_swap_b32 v144, v145
    s_nop 1
    ds_write_b64 v26, v[144:145] offset:28672
    s_lshl_b32 s32, s19, 18
    s_lshl_b32 s23, s19, 10
    s_and_b32 s23, s23, 0x2000
    s_xor_b32 s23, s23, s49
    s_add_u32 s32, s32, s23
    s_waitcnt lgkmcnt(0)
    s_barrier
    buffer_store_dwordx2 v[144:145], v24, s[8:11], s32 offen sc1
    buffer_store_dwordx4 v[28:31], v22, s[8:11], s42 offen
    s_lshl_b32 s21, s29, 9
    s_add_u32 s21, s21, s42
    buffer_store_dwordx2 v[28:29], v26, s[8:11], s21 offen
    s_xor_b32 s21, s21, 20480
    buffer_store_dwordx2 v[28:29], v26, s[8:11], s21 offen
    s_branch L_he_28
L_w2_26:
    ds_read_b128 v[80:83], v1 offset:29696
    s_add_u32 s20, s19, 2
    s_min_u32 s20, s20, 63
    s_bfm_b64 s[22:23], s20, 0
    s_and_b32 s22, s22, 0x808088af
    s_and_b32 s23, s23, 0x80808080
    s_bcnt1_i32_b64 s21, s[22:23]
    s_lshl_b32 s21, s21, 2
    s_add_u32 s21, s21, 64
    s_cmp_eq_u32 s47, 1
    s_cselect_b32 s21, s21, s55
    s_lshl_b32 s32, s19, 18
    s_lshl_b32 s23, s19, 10
    s_and_b32 s23, s23, 0x2000
    s_xor_b32 s23, s23, s49
    s_add_u32 s32, s32, s23
    s_waitcnt lgkmcnt(0)
    s_cmp_eq_u32 s21, s55
    s_cbranch_scc1 L_nog_30
    s_load_dword s22, s[60:61], s21 glc
L_nog_30:
    s_barrier
    s_bitcmp1_b32 s28, 1
    s_cbranch_scc0 L_nok_29
    buffer_store_dwordx4 v[80:83], v23, s[8:11], s32 offen sc1
L_nok_29:
    s_cmp_eq_u32 s21, s55
    s_cbranch_scc1 L_he_28
    s_mov_b32 s55, s21
L_gr_31:
    s_waitcnt lgkmcnt(0)
    s_cmp_ge_u32 s22, 64
    s_cbranch_scc1 L_he_28
    s_add_u32 s33, s33, 1
    s_cmp_gt_u32 s33, 0x100000
    s_cbranch_scc1 chain_kernel_abort
    s_load_dword s22, s[60:61], s21 glc
    s_branch L_gr_31
L_w3_27:
    s_add_u32 s21, s19, 1
    s_min_u32 s21, s21, 63
    s_lshl_b32 s31, s21, 20
    s_lshl_b32 s21, s21, 12
    s_and_b32 s21, s21, 0x2000
    s_xor_b32 s21, s21, s48
    s_mov_b32 m0, 32768
    s_add_u32 s31, s31, s21
    s_mov_b32 s22, 1
    s_barrier
    s_cmp_lg_u32 s47, 0
    s_cbranch_scc1 L_nof_32
    s_atomic_add s22, s[60:61], 176
L_nof_32:
    s_cmp_lg_u32 s19, 0
    s_cbranch_scc1 L_ns0_33
    v_mov_b32 v248, 0
    s_lshl2_add_u32 s20, s17, s18
    s_cmp_lg_u32 s20, 7
    s_cbranch_scc1 L_rlo_35
L_rl_34:
    s_load_dword s20, s[60:61], 68 glc
    s_add_u32 s33, s33, 1
    s_cmp_gt_u32 s33, 0x100000
    s_cbranch_scc1 chain_kernel_abort
    s_waitcnt lgkmcnt(0)
    s_cmp_lt_u32 s20, 64
    s_cbranch_scc1 L_rl_34
    v_mov_b32 v249, 2
    buffer_store_dword v249, v248, s[8:11], s62 offen
    s_branch L_rlok_36
L_rlo_35:
    buffer_load_dword v249, v248, s[8:11], s62 offen sc1
    s_add_u32 s33, s33, 1
    s_cmp_gt_u32 s33, 0x100000
    s_cbranch_scc1 chain_kernel_abort
    s_waitcnt vmcnt(0)
    v_readfirstlane_b32 s20, v249
    s_cmp_ge_u32 s20, 2
    s_cbranch_scc1 L_rlok_36
    s_sleep 1
    s_branch L_rlo_35
L_rlok_36:
L_ns0_33:
    buffer_load_dwordx4 v1, s[8:11], s31 offen offset:0 lds
    buffer_load_dwordx4 v1, s[8:11], s31 offen offset:1024 lds
    buffer_load_dwordx4 v1, s[8:11], s31 offen offset:2048 lds
    buffer_load_dwordx4 v1, s[8:11], s31 offen offset:3072 lds
    s_mov_b32 m0, 36864
    s_nop 0
    buffer_load_dwordx4 v236, s[8:11], s31 offen offset:0 lds
    buffer_load_dwordx4 v236, s[8:11], s31 offen offset:1024 lds
    buffer_load_dwordx4 v236, s[8:11], s31 offen offset:2048 lds
    buffer_load_dwordx4 v236, s[8:11], s31 offen offset:3072 lds
    s_mov_b32 m0, 40960
    s_nop 0
    buffer_load_dwordx4 v237, s[8:11], s31 offen offset:0 lds
    buffer_load_dwordx4 v237, s[8:11], s31 offen offset:1024 lds
L_he_28:
    s_cmp_lg_u32 s19, 63
    s_cbranch_scc1 L_b4_14
    s_branch chain_kernel_done
chain_kernel_fin0:
    s_barrier
    s_branch chain_kernel_done
Gq_15_f0123:
    buffer_load_dwordx4 v[32:35], v2, s[8:11], s40 offen offset:0 sc1
    s_branch Gq_15_s1230
Gq_15_f123p0:
    buffer_load_dwordx4 v[36:39], v2, s[8:11], s40 offen offset:1024 sc1
    s_add_u32 s33, s33, 1
    s_cmp_gt_u32 s33, 0x100000
    s_cbranch_scc1 chain_kernel_abort
    s_branch Gq_15_s231
Gq_15_f23p1:
    buffer_load_dwordx4 v[40:43], v2, s[8:11], s40 offen offset:2048 sc1
    s_add_u32 s33, s33, 1
    s_cmp_gt_u32 s33, 0x100000
    s_cbranch_scc1 chain_kernel_abort
    s_branch Gq_15_s32
Gq_15_f3p2:
    buffer_load_dwordx4 v[44:47], v2, s[8:11], s40 offen offset:3072 sc1
    s_add_u32 s33, s33, 1
    s_cmp_gt_u32 s33, 0x100000
    s_cbranch_scc1 chain_kernel_abort
    s_branch Gq_15_s3
Gq_15_redo:
    buffer_load_dwordx4 v[32:35], v2, s[8:11], s40 offen offset:0 sc1
    buffer_load_dwordx4 v[36:39], v2, s[8:11], s40 offen offset:1024 sc1
    buffer_load_dwordx4 v[40:43], v2, s[8:11], s40 offen offset:2048 sc1
    buffer_load_dwordx4 v[44:47], v2, s[8:11], s40 offen offset:3072 sc1
    s_add_u32 s33, s33, 1
    s_cmp_gt_u32 s33, 0x100000
    s_cbranch_scc1 chain_kernel_abort
    s_nop 5
    v_mov_b32 v64, 0
    v_mov_b32 v65, 0
    v_mov_b32 v66, 0
    v_mov_b32 v67, 0
    v_mov_b32 v68, 0
    v_mov_b32 v69, 0
    v_mov_b32 v70, 0
    v_mov_b32 v71, 0
    v_mov_b32 v72, 0
    v_mov_b32 v73, 0
    v_mov_b32 v74, 0
    v_mov_b32 v75, 0
    s_branch Gq_15_s0123
Gq_15_s1230:
    s_waitcnt vmcnt(3)
    v_cmp_eq_u32 vcc, -1, v36
    v_mov_b32_dpp v52, v36 row_ror:8 row_mask:0xf bank_mask:0xf
    v_mov_b32_dpp v53, v37 row_ror:8 row_mask:0xf bank_mask:0xf
    v_mov_b32_dpp v54, v38 row_ror:8 row_mask:0xf bank_mask:0xf
    v_mov_b32_dpp v55, v39 row_ror:8 row_mask:0xf bank_mask:0xf
    s_cbranch_vccnz Gq_15_f1230
    v_smfmac_f32_16x16x64_bf16 v[64:67], v[36:39], a[8:15], v19
    v_smfmac_f32_16x16x64_bf16 v[68:71], v[36:39], a[72:79], v19
Gq_15_s230p1:
    s_waitcnt vmcnt(2)
    v_cmp_eq_u32 vcc, -1, v40
    v_smfmac_f32_16x16x64_bf16 v[64:67], v[52:55], a[40:47], v19
    v_mov_b32_dpp v56, v40 row_ror:8 row_mask:0xf bank_mask:0xf
    v_mov_b32_dpp v57, v41 row_ror:8 row_mask:0xf bank_mask:0xf
    v_smfmac_f32_16x16x64_bf16 v[68:71], v[52:55], a[104:111], v19
    v_mov_b32_dpp v58, v42 row_ror:8 row_mask:0xf bank_mask:0xf
    v_mov_b32_dpp v59, v43 row_ror:8 row_mask:0xf bank_mask:0xf
    s_cbranch_vccnz Gq_15_f230p1
    v_smfmac_f32_16x16x64_bf16 v[64:67], v[40:43], a[16:23], v19
    v_smfmac_f32_16x16x64_bf16 v[68:71], v[40:43], a[80:87], v19
Gq_15_s30p2:
    s_waitcnt vmcnt(1)
    v_cmp_eq_u32 vcc, -1, v44
    v_smfmac_f32_16x16x64_bf16 v[64:67], v[56:59], a[48:55], v19
    v_mov_b32_dpp v60, v44 row_ror:8 row_mask:0xf bank_mask:0xf
    v_mov_b32_dpp v61, v45 row_ror:8 row_mask:0xf bank_mask:0xf
    v_smfmac_f32_16x16x64_bf16 v[68:71], v[56:59], a[112:119], v19
    v_mov_b32_dpp v62, v46 row_ror:8 row_mask:0xf bank_mask:0xf
    v_mov_b32_dpp v63, v47 row_ror:8 row_mask:0xf bank_mask:0xf
    s_cbranch_vccnz Gq_15_f30p2
    v_smfmac_f32_16x16x64_bf16 v[64:67], v[44:47], a[24:31], v19
    v_smfmac_f32_16x16x64_bf16 v[68:71], v[44:47], a[88:95], v19
Gq_15_s0p3:
    s_waitcnt vmcnt(0)
    v_cmp_eq_u32 vcc, -1, v32
    v_smfmac_f32_16x16x64_bf16 v[64:67], v[60:63], a[56:63], v19
    v_mov_b32_dpp v48, v32 row_ror:8 row_mask:0xf bank_mask:0xf
    v_mov_b32_dpp v49, v33 row_ror:8 row_mask:0xf bank_mask:0xf
    v_smfmac_f32_16x16x64_bf16 v[68:71], v[60:63], a[120:127], v19
    v_mov_b32_dpp v50, v34 row_ror:8 row_mask:0xf bank_mask:0xf
    v_mov_b32_dpp v51, v35 row_ror:8 row_mask:0xf bank_mask:0xf
    s_cbranch_vccnz Gq_15_f0p3
    v_smfmac_f32_16x16x64_bf16 v[64:67], v[32:35], a[0:7], v19
    v_smfmac_f32_16x16x64_bf16 v[68:71], v[32:35], a[64:71], v19
    v_smfmac_f32_16x16x64_bf16 v[64:67], v[48:51], a[32:39], v19
    v_smfmac_f32_16x16x64_bf16 v[68:71], v[48:51], a[96:103], v19
    s_branch Gq_15_done
Gq_15_f1230:
    buffer_load_dwordx4 v[36:39], v2, s[8:11], s40 offen offset:1024 sc1
    s_add_u32 s33, s33, 1
    s_cmp_gt_u32 s33, 0x100000
    s_cbranch_scc1 chain_kernel_abort
    s_branch Gq_15_s2301
Gq_15_f230p1:
    buffer_load_dwordx4 v[40:43], v2, s[8:11], s40 offen offset:2048 sc1
    s_add_u32 s33, s33, 1
    s_cmp_gt_u32 s33, 0x100000
    s_cbranch_scc1 chain_kernel_abort
    s_branch Gq_15_s302
Gq_15_f30p2:
    buffer_load_dwordx4 v[44:47], v2, s[8:11], s40 offen offset:3072 sc1
    s_add_u32 s33, s33, 1
    s_cmp_gt_u32 s33, 0x100000
    s_cbranch_scc1 chain_kernel_abort
    s_branch Gq_15_s03
Gq_15_f0p3:
    buffer_load_dwordx4 v[32:35], v2, s[8:11], s40 offen offset:0 sc1
    s_add_u32 s33, s33, 1
    s_cmp_gt_u32 s33, 0x100000
    s_cbranch_scc1 chain_kernel_abort
    s_branch Gq_15_s0
Gq_15_s231:
    s_waitcnt vmcnt(2)
    v_cmp_eq_u32 vcc, -1, v40
    v_mov_b32_dpp v56, v40 row_ror:8 row_mask:0xf bank_mask:0xf
    v_mov_b32_dpp v57, v41 row_ror:8 row_mask:0xf bank_mask:0xf
    v_mov_b32_dpp v58, v42 row_ror:8 row_mask:0xf bank_mask:0xf
    v_mov_b32_dpp v59, v43 row_ror:8 row_mask:0xf bank_mask:0xf
    s_cbranch_vccnz Gq_15_f231
    v_smfmac_f32_16x16x64_bf16 v[64:67], v[40:43], a[16:23], v19
    v_smfmac_f32_16x16x64_bf16 v[68:71], v[40:43], a[80:87], v19
Gq_15_s31p2:
    s_waitcnt vmcnt(1)
    v_cmp_eq_u32 vcc, -1, v44
    v_smfmac_f32_16x16x64_bf16 v[64:67], v[56:59], a[48:55], v19
    v_mov_b32_dpp v60, v44 row_ror:8 row_mask:0xf bank_mask:0xf
    v_mov_b32_dpp v61, v45 row_ror:8 row_mask:0xf bank_mask:0xf
    v_smfmac_f32_16x16x64_bf16 v[68:71], v[56:59], a[112:119], v19
    v_mov_b32_dpp v62, v46 row_ror:8 row_mask:0xf bank_mask:0xf
    v_mov_b32_dpp v63, v47 row_ror:8 row_mask:0xf bank_mask:0xf
    s_cbranch_vccnz Gq_15_f31p2
    v_smfmac_f32_16x16x64_bf16 v[64:67], v[44:47], a[24:31], v19
    v_smfmac_f32_16x16x64_bf16 v[68:71], v[44:47], a[88:95], v19
Gq_15_s1p3:
    s_waitcnt vmcnt(0)
    v_cmp_eq_u32 vcc, -1, v36
    v_smfmac_f32_16x16x64_bf16 v[64:67], v[60:63], a[56:63], v19
    v_mov_b32_dpp v52, v36 row_ror:8 row_mask:0xf bank_mask:0xf
    v_mov_b32_dpp v53, v37 row_ror:8 row_mask:0xf bank_mask:0xf
    v_smfmac_f32_16x16x64_bf16 v[68:71], v[60:63], a[120:127], v19
    v_mov_b32_dpp v54, v38 row_ror:8 row_mask:0xf bank_mask:0xf
    v_mov_b32_dpp v55, v39 row_ror:8 row_mask:0xf bank_mask:0xf
    s_cbranch_vccnz Gq_15_f1p3
    v_smfmac_f32_16x16x64_bf16 v[64:67], v[36:39], a[8:15], v19
    v_smfmac_f32_16x16x64_bf16 v[68:71], v[36:39], a[72:79], v19
    v_smfmac_f32_16x16x64_bf16 v[64:67], v[52:55], a[40:47], v19
    v_smfmac_f32_16x16x64_bf16 v[68:71], v[52:55], a[104:111], v19
    s_branch Gq_15_done
Gq_15_f231:
    buffer_load_dwordx4 v[40:43], v2, s[8:11], s40 offen offset:2048 sc1
    s_add_u32 s33, s33, 1
    s_cmp_gt_u32 s33, 0x100000
    s_cbranch_scc1 chain_kernel_abort
    s_branch Gq_15_s312
Gq_15_f31p2:
    buffer_load_dwordx4 v[44:47], v2, s[8:11], s40 offen offset:3072 sc1
    s_add_u32 s33, s33, 1
    s_cmp_gt_u32 s33, 0x100000
    s_cbranch_scc1 chain_kernel_abort
    s_branch Gq_15_s13
Gq_15_f1p3:
    buffer_load_dwordx4 v[36:39], v2, s[8:11], s40 offen offset:1024 sc1
    s_add_u32 s33, s33, 1
    s_cmp_gt_u32 s33, 0x100000
    s_cbranch_scc1 chain_kernel_abort
    s_branch Gq_15_s1
Gq_15_s32:
    s_waitcnt vmcnt(1)
    v_cmp_eq_u32 vcc, -1, v44
    v_mov_b32_dpp v60, v44 row_ror:8 row_mask:0xf bank_mask:0xf
    v_mov_b32_dpp v61, v45 row_ror:8 row_mask:0xf bank_mask:0xf
    v_mov_b32_dpp v62, v46 row_ror:8 row_mask:0xf bank_mask:0xf
    v_mov_b32_dpp v63, v47 row_ror:8 row_mask:0xf bank_mask:0xf
    s_cbranch_vccnz Gq_15_f32
    v_smfmac_f32_16x16x64_bf16 v[64:67], v[44:47], a[24:31], v19
    v_smfmac_f32_16x16x64_bf16 v[68:71], v[44:47], a[88:95], v19
Gq_15_s2p3:
    s_waitcnt vmcnt(0)
    v_cmp_eq_u32 vcc, -1, v40
    v_smfmac_f32_16x16x64_bf16 v[64:67], v[60:63], a[56:63], v19
    v_mov_b32_dpp v56, v40 row_ror:8 row_mask:0xf bank_mask:0xf
    v_mov_b32_dpp v57, v41 row_ror:8 row_mask:0xf bank_mask:0xf
    v_smfmac_f32_16x16x64_bf16 v[68:71], v[60:63], a[120:127], v19
    v_mov_b32_dpp v58, v42 row_ror:8 row_mask:0xf bank_mask:0xf
    v_mov_b32_dpp v59, v43 row_ror:8 row_mask:0xf bank_mask:0xf
    s_cbranch_vccnz Gq_15_f2p3
    v_smfmac_f32_16x16x64_bf16 v[64:67], v[40:43], a[16:23], v19
    v_smfmac_f32_16x16x64_bf16 v[68:71], v[40:43], a[80:87], v19
    v_smfmac_f32_16x16x64_bf16 v[64:67], v[56:59], a[48:55], v19
    v_smfmac_f32_16x16x64_bf16 v[68:71], v[56:59], a[112:119], v19
    s_branch Gq_15_done
Gq_15_f32:
    buffer_load_dwordx4 v[44:47], v2, s[8:11], s40 offen offset:3072 sc1
    s_add_u32 s33, s33, 1
    s_cmp_gt_u32 s33, 0x100000
    s_cbranch_scc1 chain_kernel_abort
    s_branch Gq_15_s23
Gq_15_f2p3:
    buffer_load_dwordx4 v[40:43], v2, s[8:11], s40 offen offset:2048 sc1
    s_add_u32 s33, s33, 1
    s_cmp_gt_u32 s33, 0x100000
    s_cbranch_scc1 chain_kernel_abort
    s_branch Gq_15_s2
Gq_15_s3:
    s_waitcnt vmcnt(0)
    v_cmp_eq_u32 vcc, -1, v44
    v_mov_b32_dpp v60, v44 row_ror:8 row_mask:0xf bank_mask:0xf
    v_mov_b32_dpp v61, v45 row_ror:8 row_mask:0xf bank_mask:0xf
    v_mov_b32_dpp v62, v46 row_ror:8 row_mask:0xf bank_mask:0xf
    v_mov_b32_dpp v63, v47 row_ror:8 row_mask:0xf bank_mask:0xf
    s_cbranch_vccnz Gq_15_f3
    v_smfmac_f32_16x16x64_bf16 v[64:67], v[44:47], a[24:31], v19
    v_smfmac_f32_16x16x64_bf16 v[68:71], v[44:47], a[88:95], v19
    v_smfmac_f32_16x16x64_bf16 v[64:67], v[60:63], a[56:63], v19
    v_smfmac_f32_16x16x64_bf16 v[68:71], v[60:63], a[120:127], v19
    s_branch Gq_15_done
Gq_15_f3:
    buffer_load_dwordx4 v[44:47], v2, s[8:11], s40 offen offset:3072 sc1
    s_add_u32 s33, s33, 1
    s_cmp_gt_u32 s33, 0x100000
    s_cbranch_scc1 chain_kernel_abort
    s_branch Gq_15_s3
Gq_15_s2301:
    s_waitcnt vmcnt(3)
    v_cmp_eq_u32 vcc, -1, v40
    v_mov_b32_dpp v56, v40 row_ror:8 row_mask:0xf bank_mask:0xf
    v_mov_b32_dpp v57, v41 row_ror:8 row_mask:0xf bank_mask:0xf
    v_mov_b32_dpp v58, v42 row_ror:8 row_mask:0xf bank_mask:0xf
    v_mov_b32_dpp v59, v43 row_ror:8 row_mask:0xf bank_mask:0xf
    s_cbranch_vccnz Gq_15_f2301
    v_smfmac_f32_16x16x64_bf16 v[64:67], v[40:43], a[16:23], v19
    v_smfmac_f32_16x16x64_bf16 v[68:71], v[40:43], a[80:87], v19
Gq_15_s301p2:
    s_waitcnt vmcnt(2)
    v_cmp_eq_u32 vcc, -1, v44
    v_smfmac_f32_16x16x64_bf16 v[64:67], v[56:59], a[48:55], v19
    v_mov_b32_dpp v60, v44 row_ror:8 row_mask:0xf bank_mask:0xf
    v_mov_b32_dpp v61, v45 row_ror:8 row_mask:0xf bank_mask:0xf
    v_smfmac_f32_16x16x64_bf16 v[68:71], v[56:59], a[112:119], v19
    v_mov_b32_dpp v62, v46 row_ror:8 row_mask:0xf bank_mask:0xf
    v_mov_b32_dpp v63, v47 row_ror:8 row_mask:0xf bank_mask:0xf
    s_cbranch_vccnz Gq_15_f301p2
    v_smfmac_f32_16x16x64_bf16 v[64:67], v[44:47], a[24:31], v19
    v_smfmac_f32_16x16x64_bf16 v[68:71], v[44:47], a[88:95], v19
Gq_15_s01p3:
    s_waitcnt vmcnt(1)
    v_cmp_eq_u32 vcc, -1, v32
    v_smfmac_f32_16x16x64_bf16 v[64:67], v[60:63], a[56:63], v19
    v_mov_b32_dpp v48, v32 row_ror:8 row_mask:0xf bank_mask:0xf
    v_mov_b32_dpp v49, v33 row_ror:8 row_mask:0xf bank_mask:0xf
    v_smfmac_f32_16x16x64_bf16 v[68:71], v[60:63], a[120:127], v19
    v_mov_b32_dpp v50, v34 row_ror:8 row_mask:0xf bank_mask:0xf
    v_mov_b32_dpp v51, v35 row_ror:8 row_mask:0xf bank_mask:0xf
    s_cbranch_vccnz Gq_15_f01p3
    v_smfmac_f32_16x16x64_bf16 v[64:67], v[32:35], a[0:7], v19
    v_smfmac_f32_16x16x64_bf16 v[68:71], v[32:35], a[64:71], v19
Gq_15_s1p0:
    s_waitcnt vmcnt(0)
    v_cmp_eq_u32 vcc, -1, v36
    v_smfmac_f32_16x16x64_bf16 v[64:67], v[48:51], a[32:39], v19
    v_mov_b32_dpp v52, v36 row_ror:8 row_mask:0xf bank_mask:0xf
    v_mov_b32_dpp v53, v37 row_ror:8 row_mask:0xf bank_mask:0xf
    v_smfmac_f32_16x16x64_bf16 v[68:71], v[48:51], a[96:103], v19
    v_mov_b32_dpp v54, v38 row_ror:8 row_mask:0xf bank_mask:0xf
    v_mov_b32_dpp v55, v39 row_ror:8 row_mask:0xf bank_mask:0xf
    s_cbranch_vccnz Gq_15_f1p0
    v_smfmac_f32_16x16x64_bf16 v[64:67], v[36:39], a[8:15], v19
    v_smfmac_f32_16x16x64_bf16 v[68:71], v[36:39], a[72:79], v19
    v_smfmac_f32_16x16x64_bf16 v[64:67], v[52:55], a[40:47], v19
    v_smfmac_f32_16x16x64_bf16 v[68:71], v[52:55], a[104:111], v19
    s_branch Gq_15_done
Gq_15_f2301:
    buffer_load_dwordx4 v[40:43], v2, s[8:11], s40 offen offset:2048 sc1
    s_add_u32 s33, s33, 1
    s_cmp_gt_u32 s33, 0x100000
    s_cbranch_scc1 chain_kernel_abort
    s_branch Gq_15_s3012
Gq_15_f301p2:
    buffer_load_dwordx4 v[44:47], v2, s[8:11], s40 offen offset:3072 sc1
    s_add_u32 s33, s33, 1
    s_cmp_gt_u32 s33, 0x100000
    s_cbranch_scc1 chain_kernel_abort
    s_branch Gq_15_s013
Gq_15_f01p3:
    buffer_load_dwordx4 v[32:35], v2, s[8:11], s40 offen offset:0 sc1
    s_add_u32 s33, s33, 1
    s_cmp_gt_u32 s33, 0x100000
    s_cbranch_scc1 chain_kernel_abort
    s_branch Gq_15_s10
Gq_15_f1p0:
    buffer_load_dwordx4 v[36:39], v2, s[8:11], s40 offen offset:1024 sc1
    s_add_u32 s33, s33, 1
    s_cmp_gt_u32 s33, 0x100000
    s_cbranch_scc1 chain_kernel_abort
    s_branch Gq_15_s1
Gq_15_s302:
    s_waitcnt vmcnt(2)
    v_cmp_eq_u32 vcc, -1, v44
    v_mov_b32_dpp v60, v44 row_ror:8 row_mask:0xf bank_mask:0xf
    v_mov_b32_dpp v61, v45 row_ror:8 row_mask:0xf bank_mask:0xf
    v_mov_b32_dpp v62, v46 row_ror:8 row_mask:0xf bank_mask:0xf
    v_mov_b32_dpp v63, v47 row_ror:8 row_mask:0xf bank_mask:0xf
    s_cbranch_vccnz Gq_15_f302
    v_smfmac_f32_16x16x64_bf16 v[64:67], v[44:47], a[24:31], v19
    v_smfmac_f32_16x16x64_bf16 v[68:71], v[44:47], a[88:95], v19
Gq_15_s02p3:
    s_waitcnt vmcnt(1)
    v_cmp_eq_u32 vcc, -1, v32
    v_smfmac_f32_16x16x64_bf16 v[64:67], v[60:63], a[56:63], v19
    v_mov_b32_dpp v48, v32 row_ror:8 row_mask:0xf bank_mask:0xf
    v_mov_b32_dpp v49, v33 row_ror:8 row_mask:0xf bank_mask:0xf
    v_smfmac_f32_16x16x64_bf16 v[68:71], v[60:63], a[120:127], v19
    v_mov_b32_dpp v50, v34 row_ror:8 row_mask:0xf bank_mask:0xf
    v_mov_b32_dpp v51, v35 row_ror:8 row_mask:0xf bank_mask:0xf
    s_cbranch_vccnz Gq_15_f02p3
    v_smfmac_f32_16x16x64_bf16 v[64:67], v[32:35], a[0:7], v19
    v_smfmac_f32_16x16x64_bf16 v[68:71], v[32:35], a[64:71], v19
Gq_15_s2p0:
    s_waitcnt vmcnt(0)
    v_cmp_eq_u32 vcc, -1, v40
    v_smfmac_f32_16x16x64_bf16 v[64:67], v[48:51], a[32:39], v19
    v_mov_b32_dpp v56, v40 row_ror:8 row_mask:0xf bank_mask:0xf
    v_mov_b32_dpp v57, v41 row_ror:8 row_mask:0xf bank_mask:0xf
    v_smfmac_f32_16x16x64_bf16 v[68:71], v[48:51], a[96:103], v19
    v_mov_b32_dpp v58, v42 row_ror:8 row_mask:0xf bank_mask:0xf
    v_mov_b32_dpp v59, v43 row_ror:8 row_mask:0xf bank_mask:0xf
    s_cbranch_vccnz Gq_15_f2p0
    v_smfmac_f32_16x16x64_bf16 v[64:67], v[40:43], a[16:23], v19
    v_smfmac_f32_16x16x64_bf16 v[68:71], v[40:43], a[80:87], v19
    v_smfmac_f32_16x16x64_bf16 v[64:67], v[56:59], a[48:55], v19
    v_smfmac_f32_16x16x64_bf16 v[68:71], v[56:59], a[112:119], v19
    s_branch Gq_15_done
Gq_15_f302:
    buffer_load_dwordx4 v[44:47], v2, s[8:11], s40 offen offset:3072 sc1
    s_add_u32 s33, s33, 1
    s_cmp_gt_u32 s33, 0x100000
    s_cbranch_scc1 chain_kernel_abort
    s_branch Gq_15_s023
Gq_15_f02p3:
    buffer_load_dwordx4 v[32:35], v2, s[8:11], s40 offen offset:0 sc1
    s_add_u32 s33, s33, 1
    s_cmp_gt_u32 s33, 0x100000
    s_cbranch_scc1 chain_kernel_abort
    s_branch Gq_15_s20
Gq_15_f2p0:
    buffer_load_dwordx4 v[40:43], v2, s[8:11], s40 offen offset:2048 sc1
    s_add_u32 s33, s33, 1
    s_cmp_gt_u32 s33, 0x100000
    s_cbranch_scc1 chain_kernel_abort
    s_branch Gq_15_s2
Gq_15_s03:
    s_waitcnt vmcnt(1)
    v_cmp_eq_u32 vcc, -1, v32
    v_mov_b32_dpp v48, v32 row_ror:8 row_mask:0xf bank_mask:0xf
    v_mov_b32_dpp v49, v33 row_ror:8 row_mask:0xf bank_mask:0xf
    v_mov_b32_dpp v50, v34 row_ror:8 row_mask:0xf bank_mask:0xf
    v_mov_b32_dpp v51, v35 row_ror:8 row_mask:0xf bank_mask:0xf
    s_cbranch_vccnz Gq_15_f03
    v_smfmac_f32_16x16x64_bf16 v[64:67], v[32:35], a[0:7], v19
    v_smfmac_f32_16x16x64_bf16 v[68:71], v[32:35], a[64:71], v19
Gq_15_s3p0:
    s_waitcnt vmcnt(0)
    v_cmp_eq_u32 vcc, -1, v44
    v_smfmac_f32_16x16x64_bf16 v[64:67], v[48:51], a[32:39], v19
    v_mov_b32_dpp v60, v44 row_ror:8 row_mask:0xf bank_mask:0xf
    v_mov_b32_dpp v61, v45 row_ror:8 row_mask:0xf bank_mask:0xf
    v_smfmac_f32_16x16x64_bf16 v[68:71], v[48:51], a[96:103], v19
    v_mov_b32_dpp v62, v46 row_ror:8 row_mask:0xf bank_mask:0xf
    v_mov_b32_dpp v63, v47 row_ror:8 row_mask:0xf bank_mask:0xf
    s_cbranch_vccnz Gq_15_f3p0
    v_smfmac_f32_16x16x64_bf16 v[64:67], v[44:47], a[24:31], v19
    v_smfmac_f32_16x16x64_bf16 v[68:71], v[44:47], a[88:95], v19
    v_smfmac_f32_16x16x64_bf16 v[64:67], v[60:63], a[56:63], v19
    v_smfmac_f32_16x16x64_bf16 v[68:71], v[60:63], a[120:127], v19
    s_branch Gq_15_done
Gq_15_f03:
    buffer_load_dwordx4 v[32:35], v2, s[8:11], s40 offen offset:0 sc1
    s_add_u32 s33, s33, 1
    s_cmp_gt_u32 s33, 0x100000
    s_cbranch_scc1 chain_kernel_abort
    s_branch Gq_15_s30
Gq_15_f3p0:
    buffer_load_dwordx4 v[44:47], v2, s[8:11], s40 offen offset:3072 sc1
    s_add_u32 s33, s33, 1
    s_cmp_gt_u32 s33, 0x100000
    s_cbranch_scc1 chain_kernel_abort
    s_branch Gq_15_s3
Gq_15_s0:
    s_waitcnt vmcnt(0)
    v_cmp_eq_u32 vcc, -1, v32
    v_mov_b32_dpp v48, v32 row_ror:8 row_mask:0xf bank_mask:0xf
    v_mov_b32_dpp v49, v33 row_ror:8 row_mask:0xf bank_mask:0xf
    v_mov_b32_dpp v50, v34 row_ror:8 row_mask:0xf bank_mask:0xf
    v_mov_b32_dpp v51, v35 row_ror:8 row_mask:0xf bank_mask:0xf
    s_cbranch_vccnz Gq_15_f0
    v_smfmac_f32_16x16x64_bf16 v[64:67], v[32:35], a[0:7], v19
    v_smfmac_f32_16x16x64_bf16 v[68:71], v[32:35], a[64:71], v19
    v_smfmac_f32_16x16x64_bf16 v[64:67], v[48:51], a[32:39], v19
    v_smfmac_f32_16x16x64_bf16 v[68:71], v[48:51], a[96:103], v19
    s_branch Gq_15_done
Gq_15_f0:
    buffer_load_dwordx4 v[32:35], v2, s[8:11], s40 offen offset:0 sc1
    s_add_u32 s33, s33, 1
    s_cmp_gt_u32 s33, 0x100000
    s_cbranch_scc1 chain_kernel_abort
    s_branch Gq_15_s0
Gq_15_s312:
    s_waitcnt vmcnt(2)
    v_cmp_eq_u32 vcc, -1, v44
    v_mov_b32_dpp v60, v44 row_ror:8 row_mask:0xf bank_mask:0xf
    v_mov_b32_dpp v61, v45 row_ror:8 row_mask:0xf bank_mask:0xf
    v_mov_b32_dpp v62, v46 row_ror:8 row_mask:0xf bank_mask:0xf
    v_mov_b32_dpp v63, v47 row_ror:8 row_mask:0xf bank_mask:0xf
    s_cbranch_vccnz Gq_15_f312
    v_smfmac_f32_16x16x64_bf16 v[64:67], v[44:47], a[24:31], v19
    v_smfmac_f32_16x16x64_bf16 v[68:71], v[44:47], a[88:95], v19
Gq_15_s12p3:
    s_waitcnt vmcnt(1)
    v_cmp_eq_u32 vcc, -1, v36
    v_smfmac_f32_16x16x64_bf16 v[64:67], v[60:63], a[56:63], v19
    v_mov_b32_dpp v52, v36 row_ror:8 row_mask:0xf bank_mask:0xf
    v_mov_b32_dpp v53, v37 row_ror:8 row_mask:0xf bank_mask:0xf
    v_smfmac_f32_16x16x64_bf16 v[68:71], v[60:63], a[120:127], v19
    v_mov_b32_dpp v54, v38 row_ror:8 row_mask:0xf bank_mask:0xf
    v_mov_b32_dpp v55, v39 row_ror:8 row_mask:0xf bank_mask:0xf
    s_cbranch_vccnz Gq_15_f12p3
    v_smfmac_f32_16x16x64_bf16 v[64:67], v[36:39], a[8:15], v19
    v_smfmac_f32_16x16x64_bf16 v[68:71], v[36:39], a[72:79], v19
Gq_15_s2p1:
    s_waitcnt vmcnt(0)
    v_cmp_eq_u32 vcc, -1, v40
    v_smfmac_f32_16x16x64_bf16 v[64:67], v[52:55], a[40:47], v19
    v_mov_b32_dpp v56, v40 row_ror:8 row_mask:0xf bank_mask:0xf
    v_mov_b32_dpp v57, v41 row_ror:8 row_mask:0xf bank_mask:0xf
    v_smfmac_f32_16x16x64_bf16 v[68:71], v[52:55], a[104:111], v19
    v_mov_b32_dpp v58, v42 row_ror:8 row_mask:0xf bank_mask:0xf
    v_mov_b32_dpp v59, v43 row_ror:8 row_mask:0xf bank_mask:0xf
    s_cbranch_vccnz Gq_15_f2p1
    v_smfmac_f32_16x16x64_bf16 v[64:67], v[40:43], a[16:23], v19
    v_smfmac_f32_16x16x64_bf16 v[68:71], v[40:43], a[80:87], v19
    v_smfmac_f32_16x16x64_bf16 v[64:67], v[56:59], a[48:55], v19
    v_smfmac_f32_16x16x64_bf16 v[68:71], v[56:59], a[112:119], v19
    s_branch Gq_15_done
Gq_15_f312:
    buffer_load_dwordx4 v[44:47], v2, s[8:11], s40 offen offset:3072 sc1
    s_add_u32 s33, s33, 1
    s_cmp_gt_u32 s33, 0x100000
    s_cbranch_scc1 chain_kernel_abort
    s_branch Gq_15_s123
Gq_15_f12p3:
    buffer_load_dwordx4 v[36:39], v2, s[8:11], s40 offen offset:1024 sc1
    s_add_u32 s33, s33, 1
    s_cmp_gt_u32 s33, 0x100000
    s_cbranch_scc1 chain_kernel_abort
    s_branch Gq_15_s21
Gq_15_f2p1:
    buffer_load_dwordx4 v[40:43], v2, s[8:11], s40 offen offset:2048 sc1
    s_add_u32 s33, s33, 1
    s_cmp_gt_u32 s33, 0x100000
    s_cbranch_scc1 chain_kernel_abort
    s_branch Gq_15_s2
Gq_15_s13:
    s_waitcnt vmcnt(1)
    v_cmp_eq_u32 vcc, -1, v36
    v_mov_b32_dpp v52, v36 row_ror:8 row_mask:0xf bank_mask:0xf
    v_mov_b32_dpp v53, v37 row_ror:8 row_mask:0xf bank_mask:0xf
    v_mov_b32_dpp v54, v38 row_ror:8 row_mask:0xf bank_mask:0xf
    v_mov_b32_dpp v55, v39 row_ror:8 row_mask:0xf bank_mask:0xf
    s_cbranch_vccnz Gq_15_f13
    v_smfmac_f32_16x16x64_bf16 v[64:67], v[36:39], a[8:15], v19
    v_smfmac_f32_16x16x64_bf16 v[68:71], v[36:39], a[72:79], v19
Gq_15_s3p1:
    s_waitcnt vmcnt(0)
    v_cmp_eq_u32 vcc, -1, v44
    v_smfmac_f32_16x16x64_bf16 v[64:67], v[52:55], a[40:47], v19
    v_mov_b32_dpp v60, v44 row_ror:8 row_mask:0xf bank_mask:0xf
    v_mov_b32_dpp v61, v45 row_ror:8 row_mask:0xf bank_mask:0xf
    v_smfmac_f32_16x16x64_bf16 v[68:71], v[52:55], a[104:111], v19
    v_mov_b32_dpp v62, v46 row_ror:8 row_mask:0xf bank_mask:0xf
    v_mov_b32_dpp v63, v47 row_ror:8 row_mask:0xf bank_mask:0xf
    s_cbranch_vccnz Gq_15_f3p1
    v_smfmac_f32_16x16x64_bf16 v[64:67], v[44:47], a[24:31], v19
    v_smfmac_f32_16x16x64_bf16 v[68:71], v[44:47], a[88:95], v19
    v_smfmac_f32_16x16x64_bf16 v[64:67], v[60:63], a[56:63], v19
    v_smfmac_f32_16x16x64_bf16 v[68:71], v[60:63], a[120:127], v19
    s_branch Gq_15_done
Gq_15_f13:
    buffer_load_dwordx4 v[36:39], v2, s[8:11], s40 offen offset:1024 sc1
    s_add_u32 s33, s33, 1
    s_cmp_gt_u32 s33, 0x100000
    s_cbranch_scc1 chain_kernel_abort
    s_branch Gq_15_s31
Gq_15_f3p1:
    buffer_load_dwordx4 v[44:47], v2, s[8:11], s40 offen offset:3072 sc1
    s_add_u32 s33, s33, 1
    s_cmp_gt_u32 s33, 0x100000
    s_cbranch_scc1 chain_kernel_abort
    s_branch Gq_15_s3
Gq_15_s1:
    s_waitcnt vmcnt(0)
    v_cmp_eq_u32 vcc, -1, v36
    v_mov_b32_dpp v52, v36 row_ror:8 row_mask:0xf bank_mask:0xf
    v_mov_b32_dpp v53, v37 row_ror:8 row_mask:0xf bank_mask:0xf
    v_mov_b32_dpp v54, v38 row_ror:8 row_mask:0xf bank_mask:0xf
    v_mov_b32_dpp v55, v39 row_ror:8 row_mask:0xf bank_mask:0xf
    s_cbranch_vccnz Gq_15_f1
    v_smfmac_f32_16x16x64_bf16 v[64:67], v[36:39], a[8:15], v19
    v_smfmac_f32_16x16x64_bf16 v[68:71], v[36:39], a[72:79], v19
    v_smfmac_f32_16x16x64_bf16 v[64:67], v[52:55], a[40:47], v19
    v_smfmac_f32_16x16x64_bf16 v[68:71], v[52:55], a[104:111], v19
    s_branch Gq_15_done
Gq_15_f1:
    buffer_load_dwordx4 v[36:39], v2, s[8:11], s40 offen offset:1024 sc1
    s_add_u32 s33, s33, 1
    s_cmp_gt_u32 s33, 0x100000
    s_cbranch_scc1 chain_kernel_abort
    s_branch Gq_15_s1
Gq_15_s23:
    s_waitcnt vmcnt(1)
    v_cmp_eq_u32 vcc, -1, v40
    v_mov_b32_dpp v56, v40 row_ror:8 row_mask:0xf bank_mask:0xf
    v_mov_b32_dpp v57, v41 row_ror:8 row_mask:0xf bank_mask:0xf
    v_mov_b32_dpp v58, v42 row_ror:8 row_mask:0xf bank_mask:0xf
    v_mov_b32_dpp v59, v43 row_ror:8 row_mask:0xf bank_mask:0xf
    s_cbranch_vccnz Gq_15_f23
    v_smfmac_f32_16x16x64_bf16 v[64:67], v[40:43], a[16:23], v19
    v_smfmac_f32_16x16x64_bf16 v[68:71], v[40:43], a[80:87], v19
    s_branch Gq_15_s3p2
Gq_15_f23:
    buffer_load_dwordx4 v[40:43], v2, s[8:11], s40 offen offset:2048 sc1
    s_add_u32 s33, s33, 1
    s_cmp_gt_u32 s33, 0x100000
    s_cbranch_scc1 chain_kernel_abort
    s_branch Gq_15_s32
Gq_15_s2:
    s_waitcnt vmcnt(0)
    v_cmp_eq_u32 vcc, -1, v40
    v_mov_b32_dpp v56, v40 row_ror:8 row_mask:0xf bank_mask:0xf
    v_mov_b32_dpp v57, v41 row_ror:8 row_mask:0xf bank_mask:0xf
    v_mov_b32_dpp v58, v42 row_ror:8 row_mask:0xf bank_mask:0xf
    v_mov_b32_dpp v59, v43 row_ror:8 row_mask:0xf bank_mask:0xf
    s_cbranch_vccnz Gq_15_f2
    v_smfmac_f32_16x16x64_bf16 v[64:67], v[40:43], a[16:23], v19
    v_smfmac_f32_16x16x64_bf16 v[68:71], v[40:43], a[80:87], v19
    v_smfmac_f32_16x16x64_bf16 v[64:67], v[56:59], a[48:55], v19
    v_smfmac_f32_16x16x64_bf16 v[68:71], v[56:59], a[112:119], v19
    s_branch Gq_15_done
Gq_15_f2:
    buffer_load_dwordx4 v[40:43], v2, s[8:11], s40 offen offset:2048 sc1
    s_add_u32 s33, s33, 1
    s_cmp_gt_u32 s33, 0x100000
    s_cbranch_scc1 chain_kernel_abort
    s_branch Gq_15_s2
Gq_15_s3012:
    s_waitcnt vmcnt(3)
    v_cmp_eq_u32 vcc, -1, v44
    v_mov_b32_dpp v60, v44 row_ror:8 row_mask:0xf bank_mask:0xf
    v_mov_b32_dpp v61, v45 row_ror:8 row_mask:0xf bank_mask:0xf
    v_mov_b32_dpp v62, v46 row_ror:8 row_mask:0xf bank_mask:0xf
    v_mov_b32_dpp v63, v47 row_ror:8 row_mask:0xf bank_mask:0xf
    s_cbranch_vccnz Gq_15_f3012
    v_smfmac_f32_16x16x64_bf16 v[64:67], v[44:47], a[24:31], v19
    v_smfmac_f32_16x16x64_bf16 v[68:71], v[44:47], a[88:95], v19
Gq_15_s012p3:
    s_waitcnt vmcnt(2)
    v_cmp_eq_u32 vcc, -1, v32
    v_smfmac_f32_16x16x64_bf16 v[64:67], v[60:63], a[56:63], v19
    v_mov_b32_dpp v48, v32 row_ror:8 row_mask:0xf bank_mask:0xf
    v_mov_b32_dpp v49, v33 row_ror:8 row_mask:0xf bank_mask:0xf
    v_smfmac_f32_16x16x64_bf16 v[68:71], v[60:63], a[120:127], v19
    v_mov_b32_dpp v50, v34 row_ror:8 row_mask:0xf bank_mask:0xf
    v_mov_b32_dpp v51, v35 row_ror:8 row_mask:0xf bank_mask:0xf
    s_cbranch_vccnz Gq_15_f012p3
    v_smfmac_f32_16x16x64_bf16 v[64:67], v[32:35], a[0:7], v19
    v_smfmac_f32_16x16x64_bf16 v[68:71], v[32:35], a[64:71], v19
Gq_15_s12p0:
    s_waitcnt vmcnt(1)
    v_cmp_eq_u32 vcc, -1, v36
    v_smfmac_f32_16x16x64_bf16 v[64:67], v[48:51], a[32:39], v19
    v_mov_b32_dpp v52, v36 row_ror:8 row_mask:0xf bank_mask:0xf
    v_mov_b32_dpp v53, v37 row_ror:8 row_mask:0xf bank_mask:0xf
    v_smfmac_f32_16x16x64_bf16 v[68:71], v[48:51], a[96:103], v19
    v_mov_b32_dpp v54, v38 row_ror:8 row_mask:0xf bank_mask:0xf
    v_mov_b32_dpp v55, v39 row_ror:8 row_mask:0xf bank_mask:0xf
    s_cbranch_vccnz Gq_15_f12p0
    v_smfmac_f32_16x16x64_bf16 v[64:67], v[36:39], a[8:15], v19
    v_smfmac_f32_16x16x64_bf16 v[68:71], v[36:39], a[72:79], v19
    s_branch Gq_15_s2p1
Gq_15_f3012:
    buffer_load_dwordx4 v[44:47], v2, s[8:11], s40 offen offset:3072 sc1
    s_add_u32 s33, s33, 1
    s_cmp_gt_u32 s33, 0x100000
    s_cbranch_scc1 chain_kernel_abort
    s_branch Gq_15_s0123
Gq_15_f012p3:
    buffer_load_dwordx4 v[32:35], v2, s[8:11], s40 offen offset:0 sc1
    s_add_u32 s33, s33, 1
    s_cmp_gt_u32 s33, 0x100000
    s_cbranch_scc1 chain_kernel_abort
    s_branch Gq_15_s120
Gq_15_f12p0:
    buffer_load_dwordx4 v[36:39], v2, s[8:11], s40 offen offset:1024 sc1
    s_add_u32 s33, s33, 1
    s_cmp_gt_u32 s33, 0x100000
    s_cbranch_scc1 chain_kernel_abort
    s_branch Gq_15_s21
Gq_15_s013:
    s_waitcnt vmcnt(2)
    v_cmp_eq_u32 vcc, -1, v32
    v_mov_b32_dpp v48, v32 row_ror:8 row_mask:0xf bank_mask:0xf
    v_mov_b32_dpp v49, v33 row_ror:8 row_mask:0xf bank_mask:0xf
    v_mov_b32_dpp v50, v34 row_ror:8 row_mask:0xf bank_mask:0xf
    v_mov_b32_dpp v51, v35 row_ror:8 row_mask:0xf bank_mask:0xf
    s_cbranch_vccnz Gq_15_f013
    v_smfmac_f32_16x16x64_bf16 v[64:67], v[32:35], a[0:7], v19
    v_smfmac_f32_16x16x64_bf16 v[68:71], v[32:35], a[64:71], v19
Gq_15_s13p0:
    s_waitcnt vmcnt(1)
    v_cmp_eq_u32 vcc, -1, v36
    v_smfmac_f32_16x16x64_bf16 v[64:67], v[48:51], a[32:39], v19
    v_mov_b32_dpp v52, v36 row_ror:8 row_mask:0xf bank_mask:0xf
    v_mov_b32_dpp v53, v37 row_ror:8 row_mask:0xf bank_mask:0xf
    v_smfmac_f32_16x16x64_bf16 v[68:71], v[48:51], a[96:103], v19
    v_mov_b32_dpp v54, v38 row_ror:8 row_mask:0xf bank_mask:0xf
    v_mov_b32_dpp v55, v39 row_ror:8 row_mask:0xf bank_mask:0xf
    s_cbranch_vccnz Gq_15_f13p0
    v_smfmac_f32_16x16x64_bf16 v[64:67], v[36:39], a[8:15], v19
    v_smfmac_f32_16x16x64_bf16 v[68:71], v[36:39], a[72:79], v19
    s_branch Gq_15_s3p1
Gq_15_f013:
    buffer_load_dwordx4 v[32:35], v2, s[8:11], s40 offen offset:0 sc1
    s_add_u32 s33, s33, 1
    s_cmp_gt_u32 s33, 0x100000
    s_cbranch_scc1 chain_kernel_abort
    s_branch Gq_15_s130
Gq_15_f13p0:
    buffer_load_dwordx4 v[36:39], v2, s[8:11], s40 offen offset:1024 sc1
    s_add_u32 s33, s33, 1
    s_cmp_gt_u32 s33, 0x100000
    s_cbranch_scc1 chain_kernel_abort
    s_branch Gq_15_s31
Gq_15_s10:
    s_waitcnt vmcnt(1)
    v_cmp_eq_u32 vcc, -1, v36
    v_mov_b32_dpp v52, v36 row_ror:8 row_mask:0xf bank_mask:0xf
    v_mov_b32_dpp v53, v37 row_ror:8 row_mask:0xf bank_mask:0xf
    v_mov_b32_dpp v54, v38 row_ror:8 row_mask:0xf bank_mask:0xf
    v_mov_b32_dpp v55, v39 row_ror:8 row_mask:0xf bank_mask:0xf
    s_cbranch_vccnz Gq_15_f10
    v_smfmac_f32_16x16x64_bf16 v[64:67], v[36:39], a[8:15], v19
    v_smfmac_f32_16x16x64_bf16 v[68:71], v[36:39], a[72:79], v19
Gq_15_s0p1:
    s_waitcnt vmcnt(0)
    v_cmp_eq_u32 vcc, -1, v32
    v_smfmac_f32_16x16x64_bf16 v[64:67], v[52:55], a[40:47], v19
    v_mov_b32_dpp v48, v32 row_ror:8 row_mask:0xf bank_mask:0xf
    v_mov_b32_dpp v49, v33 row_ror:8 row_mask:0xf bank_mask:0xf
    v_smfmac_f32_16x16x64_bf16 v[68:71], v[52:55], a[104:111], v19
    v_mov_b32_dpp v50, v34 row_ror:8 row_mask:0xf bank_mask:0xf
    v_mov_b32_dpp v51, v35 row_ror:8 row_mask:0xf bank_mask:0xf
    s_cbranch_vccnz Gq_15_f0p1
    v_smfmac_f32_16x16x64_bf16 v[64:67], v[32:35], a[0:7], v19
    v_smfmac_f32_16x16x64_bf16 v[68:71], v[32:35], a[64:71], v19
    v_smfmac_f32_16x16x64_bf16 v[64:67], v[48:51], a[32:39], v19
    v_smfmac_f32_16x16x64_bf16 v[68:71], v[48:51], a[96:103], v19
    s_branch Gq_15_done
Gq_15_f10:
    buffer_load_dwordx4 v[36:39], v2, s[8:11], s40 offen offset:1024 sc1
    s_add_u32 s33, s33, 1
    s_cmp_gt_u32 s33, 0x100000
    s_cbranch_scc1 chain_kernel_abort
    s_branch Gq_15_s01
Gq_15_f0p1:
    buffer_load_dwordx4 v[32:35], v2, s[8:11], s40 offen offset:0 sc1
    s_add_u32 s33, s33, 1
    s_cmp_gt_u32 s33, 0x100000
    s_cbranch_scc1 chain_kernel_abort
    s_branch Gq_15_s0
Gq_15_s023:
    s_waitcnt vmcnt(2)
    v_cmp_eq_u32 vcc, -1, v32
    v_mov_b32_dpp v48, v32 row_ror:8 row_mask:0xf bank_mask:0xf
    v_mov_b32_dpp v49, v33 row_ror:8 row_mask:0xf bank_mask:0xf
    v_mov_b32_dpp v50, v34 row_ror:8 row_mask:0xf bank_mask:0xf
    v_mov_b32_dpp v51, v35 row_ror:8 row_mask:0xf bank_mask:0xf
    s_cbranch_vccnz Gq_15_f023
    v_smfmac_f32_16x16x64_bf16 v[64:67], v[32:35], a[0:7], v19
    v_smfmac_f32_16x16x64_bf16 v[68:71], v[32:35], a[64:71], v19
Gq_15_s23p0:
    s_waitcnt vmcnt(1)
    v_cmp_eq_u32 vcc, -1, v40
    v_smfmac_f32_16x16x64_bf16 v[64:67], v[48:51], a[32:39], v19
    v_mov_b32_dpp v56, v40 row_ror:8 row_mask:0xf bank_mask:0xf
    v_mov_b32_dpp v57, v41 row_ror:8 row_mask:0xf bank_mask:0xf
    v_smfmac_f32_16x16x64_bf16 v[68:71], v[48:51], a[96:103], v19
    v_mov_b32_dpp v58, v42 row_ror:8 row_mask:0xf bank_mask:0xf
    v_mov_b32_dpp v59, v43 row_ror:8 row_mask:0xf bank_mask:0xf
    s_cbranch_vccnz Gq_15_f23p0
    v_smfmac_f32_16x16x64_bf16 v[64:67], v[40:43], a[16:23], v19
    v_smfmac_f32_16x16x64_bf16 v[68:71], v[40:43], a[80:87], v19
    s_branch Gq_15_s3p2
Gq_15_f023:
    buffer_load_dwordx4 v[32:35], v2, s[8:11], s40 offen offset:0 sc1
    s_add_u32 s33, s33, 1
    s_cmp_gt_u32 s33, 0x100000
    s_cbranch_scc1 chain_kernel_abort
    s_branch Gq_15_s230
Gq_15_f23p0:
    buffer_load_dwordx4 v[40:43], v2, s[8:11], s40 offen offset:2048 sc1
    s_add_u32 s33, s33, 1
    s_cmp_gt_u32 s33, 0x100000
    s_cbranch_scc1 chain_kernel_abort
    s_branch Gq_15_s32
Gq_15_s20:
    s_waitcnt vmcnt(1)
    v_cmp_eq_u32 vcc, -1, v40
    v_mov_b32_dpp v56, v40 row_ror:8 row_mask:0xf bank_mask:0xf
    v_mov_b32_dpp v57, v41 row_ror:8 row_mask:0xf bank_mask:0xf
    v_mov_b32_dpp v58, v42 row_ror:8 row_mask:0xf bank_mask:0xf
    v_mov_b32_dpp v59, v43 row_ror:8 row_mask:0xf bank_mask:0xf
    s_cbranch_vccnz Gq_15_f20
    v_smfmac_f32_16x16x64_bf16 v[64:67], v[40:43], a[16:23], v19
    v_smfmac_f32_16x16x64_bf16 v[68:71], v[40:43], a[80:87], v19
Gq_15_s0p2:
    s_waitcnt vmcnt(0)
    v_cmp_eq_u32 vcc, -1, v32
    v_smfmac_f32_16x16x64_bf16 v[64:67], v[56:59], a[48:55], v19
    v_mov_b32_dpp v48, v32 row_ror:8 row_mask:0xf bank_mask:0xf
    v_mov_b32_dpp v49, v33 row_ror:8 row_mask:0xf bank_mask:0xf
    v_smfmac_f32_16x16x64_bf16 v[68:71], v[56:59], a[112:119], v19
    v_mov_b32_dpp v50, v34 row_ror:8 row_mask:0xf bank_mask:0xf
    v_mov_b32_dpp v51, v35 row_ror:8 row_mask:0xf bank_mask:0xf
    s_cbranch_vccnz Gq_15_f0p2
    v_smfmac_f32_16x16x64_bf16 v[64:67], v[32:35], a[0:7], v19
    v_smfmac_f32_16x16x64_bf16 v[68:71], v[32:35], a[64:71], v19
    v_smfmac_f32_16x16x64_bf16 v[64:67], v[48:51], a[32:39], v19
    v_smfmac_f32_16x16x64_bf16 v[68:71], v[48:51], a[96:103], v19
    s_branch Gq_15_done
Gq_15_f20:
    buffer_load_dwordx4 v[40:43], v2, s[8:11], s40 offen offset:2048 sc1
    s_add_u32 s33, s33, 1
    s_cmp_gt_u32 s33, 0x100000
    s_cbranch_scc1 chain_kernel_abort
    s_branch Gq_15_s02
Gq_15_f0p2:
    buffer_load_dwordx4 v[32:35], v2, s[8:11], s40 offen offset:0 sc1
    s_add_u32 s33, s33, 1
    s_cmp_gt_u32 s33, 0x100000
    s_cbranch_scc1 chain_kernel_abort
    s_branch Gq_15_s0
Gq_15_s30:
    s_waitcnt vmcnt(1)
    v_cmp_eq_u32 vcc, -1, v44
    v_mov_b32_dpp v60, v44 row_ror:8 row_mask:0xf bank_mask:0xf
    v_mov_b32_dpp v61, v45 row_ror:8 row_mask:0xf bank_mask:0xf
    v_mov_b32_dpp v62, v46 row_ror:8 row_mask:0xf bank_mask:0xf
    v_mov_b32_dpp v63, v47 row_ror:8 row_mask:0xf bank_mask:0xf
    s_cbranch_vccnz Gq_15_f30
    v_smfmac_f32_16x16x64_bf16 v[64:67], v[44:47], a[24:31], v19
    v_smfmac_f32_16x16x64_bf16 v[68:71], v[44:47], a[88:95], v19
    s_branch Gq_15_s0p3
Gq_15_f30:
    buffer_load_dwordx4 v[44:47], v2, s[8:11], s40 offen offset:3072 sc1
    s_add_u32 s33, s33, 1
    s_cmp_gt_u32 s33, 0x100000
    s_cbranch_scc1 chain_kernel_abort
    s_branch Gq_15_s03
Gq_15_s123:
    s_waitcnt vmcnt(2)
    v_cmp_eq_u32 vcc, -1, v36
    v_mov_b32_dpp v52, v36 row_ror:8 row_mask:0xf bank_mask:0xf
    v_mov_b32_dpp v53, v37 row_ror:8 row_mask:0xf bank_mask:0xf
    v_mov_b32_dpp v54, v38 row_ror:8 row_mask:0xf bank_mask:0xf
    v_mov_b32_dpp v55, v39 row_ror:8 row_mask:0xf bank_mask:0xf
    s_cbranch_vccnz Gq_15_f123
    v_smfmac_f32_16x16x64_bf16 v[64:67], v[36:39], a[8:15], v19
    v_smfmac_f32_16x16x64_bf16 v[68:71], v[36:39], a[72:79], v19
    s_branch Gq_15_s23p1
Gq_15_f123:
    buffer_load_dwordx4 v[36:39], v2, s[8:11], s40 offen offset:1024 sc1
    s_add_u32 s33, s33, 1
    s_cmp_gt_u32 s33, 0x100000
    s_cbranch_scc1 chain_kernel_abort
    s_branch Gq_15_s231
Gq_15_s21:
    s_waitcnt vmcnt(1)
    v_cmp_eq_u32 vcc, -1, v40
    v_mov_b32_dpp v56, v40 row_ror:8 row_mask:0xf bank_mask:0xf
    v_mov_b32_dpp v57, v41 row_ror:8 row_mask:0xf bank_mask:0xf
    v_mov_b32_dpp v58, v42 row_ror:8 row_mask:0xf bank_mask:0xf
    v_mov_b32_dpp v59, v43 row_ror:8 row_mask:0xf bank_mask:0xf
    s_cbranch_vccnz Gq_15_f21
    v_smfmac_f32_16x16x64_bf16 v[64:67], v[40:43], a[16:23], v19
    v_smfmac_f32_16x16x64_bf16 v[68:71], v[40:43], a[80:87], v19
Gq_15_s1p2:
    s_waitcnt vmcnt(0)
    v_cmp_eq_u32 vcc, -1, v36
    v_smfmac_f32_16x16x64_bf16 v[64:67], v[56:59], a[48:55], v19
    v_mov_b32_dpp v52, v36 row_ror:8 row_mask:0xf bank_mask:0xf
    v_mov_b32_dpp v53, v37 row_ror:8 row_mask:0xf bank_mask:0xf
    v_smfmac_f32_16x16x64_bf16 v[68:71], v[56:59], a[112:119], v19
    v_mov_b32_dpp v54, v38 row_ror:8 row_mask:0xf bank_mask:0xf
    v_mov_b32_dpp v55, v39 row_ror:8 row_mask:0xf bank_mask:0xf
    s_cbranch_vccnz Gq_15_f1p2
    v_smfmac_f32_16x16x64_bf16 v[64:67], v[36:39], a[8:15], v19
    v_smfmac_f32_16x16x64_bf16 v[68:71], v[36:39], a[72:79], v19
    v_smfmac_f32_16x16x64_bf16 v[64:67], v[52:55], a[40:47], v19
    v_smfmac_f32_16x16x64_bf16 v[68:71], v[52:55], a[104:111], v19
    s_branch Gq_15_done
Gq_15_f21:
    buffer_load_dwordx4 v[40:43], v2, s[8:11], s40 offen offset:2048 sc1
    s_add_u32 s33, s33, 1
    s_cmp_gt_u32 s33, 0x100000
    s_cbranch_scc1 chain_kernel_abort
    s_branch Gq_15_s12
Gq_15_f1p2:
    buffer_load_dwordx4 v[36:39], v2, s[8:11], s40 offen offset:1024 sc1
    s_add_u32 s33, s33, 1
    s_cmp_gt_u32 s33, 0x100000
    s_cbranch_scc1 chain_kernel_abort
    s_branch Gq_15_s1
Gq_15_s31:
    s_waitcnt vmcnt(1)
    v_cmp_eq_u32 vcc, -1, v44
    v_mov_b32_dpp v60, v44 row_ror:8 row_mask:0xf bank_mask:0xf
    v_mov_b32_dpp v61, v45 row_ror:8 row_mask:0xf bank_mask:0xf
    v_mov_b32_dpp v62, v46 row_ror:8 row_mask:0xf bank_mask:0xf
    v_mov_b32_dpp v63, v47 row_ror:8 row_mask:0xf bank_mask:0xf
    s_cbranch_vccnz Gq_15_f31
    v_smfmac_f32_16x16x64_bf16 v[64:67], v[44:47], a[24:31], v19
    v_smfmac_f32_16x16x64_bf16 v[68:71], v[44:47], a[88:95], v19
    s_branch Gq_15_s1p3
Gq_15_f31:
    buffer_load_dwordx4 v[44:47], v2, s[8:11], s40 offen offset:3072 sc1
    s_add_u32 s33, s33, 1
    s_cmp_gt_u32 s33, 0x100000
    s_cbranch_scc1 chain_kernel_abort
    s_branch Gq_15_s13
Gq_15_s120:
    s_waitcnt vmcnt(2)
    v_cmp_eq_u32 vcc, -1, v36
    v_mov_b32_dpp v52, v36 row_ror:8 row_mask:0xf bank_mask:0xf
    v_mov_b32_dpp v53, v37 row_ror:8 row_mask:0xf bank_mask:0xf
    v_mov_b32_dpp v54, v38 row_ror:8 row_mask:0xf bank_mask:0xf
    v_mov_b32_dpp v55, v39 row_ror:8 row_mask:0xf bank_mask:0xf
    s_cbranch_vccnz Gq_15_f120
    v_smfmac_f32_16x16x64_bf16 v[64:67], v[36:39], a[8:15], v19
    v_smfmac_f32_16x16x64_bf16 v[68:71], v[36:39], a[72:79], v19
Gq_15_s20p1:
    s_waitcnt vmcnt(1)
    v_cmp_eq_u32 vcc, -1, v40
    v_smfmac_f32_16x16x64_bf16 v[64:67], v[52:55], a[40:47], v19
    v_mov_b32_dpp v56, v40 row_ror:8 row_mask:0xf bank_mask:0xf
    v_mov_b32_dpp v57, v41 row_ror:8 row_mask:0xf bank_mask:0xf
    v_smfmac_f32_16x16x64_bf16 v[68:71], v[52:55], a[104:111], v19
    v_mov_b32_dpp v58, v42 row_ror:8 row_mask:0xf bank_mask:0xf
    v_mov_b32_dpp v59, v43 row_ror:8 row_mask:0xf bank_mask:0xf
    s_cbranch_vccnz Gq_15_f20p1
    v_smfmac_f32_16x16x64_bf16 v[64:67], v[40:43], a[16:23], v19
    v_smfmac_f32_16x16x64_bf16 v[68:71], v[40:43], a[80:87], v19
    s_branch Gq_15_s0p2
Gq_15_f120:
    buffer_load_dwordx4 v[36:39], v2, s[8:11], s40 offen offset:1024 sc1
    s_add_u32 s33, s33, 1
    s_cmp_gt_u32 s33, 0x100000
    s_cbranch_scc1 chain_kernel_abort
    s_branch Gq_15_s201
Gq_15_f20p1:
    buffer_load_dwordx4 v[40:43], v2, s[8:11], s40 offen offset:2048 sc1
    s_add_u32 s33, s33, 1
    s_cmp_gt_u32 s33, 0x100000
    s_cbranch_scc1 chain_kernel_abort
    s_branch Gq_15_s02
Gq_15_s130:
    s_waitcnt vmcnt(2)
    v_cmp_eq_u32 vcc, -1, v36
    v_mov_b32_dpp v52, v36 row_ror:8 row_mask:0xf bank_mask:0xf
    v_mov_b32_dpp v53, v37 row_ror:8 row_mask:0xf bank_mask:0xf
    v_mov_b32_dpp v54, v38 row_ror:8 row_mask:0xf bank_mask:0xf
    v_mov_b32_dpp v55, v39 row_ror:8 row_mask:0xf bank_mask:0xf
    s_cbranch_vccnz Gq_15_f130
    v_smfmac_f32_16x16x64_bf16 v[64:67], v[36:39], a[8:15], v19
    v_smfmac_f32_16x16x64_bf16 v[68:71], v[36:39], a[72:79], v19
Gq_15_s30p1:
    s_waitcnt vmcnt(1)
    v_cmp_eq_u32 vcc, -1, v44
    v_smfmac_f32_16x16x64_bf16 v[64:67], v[52:55], a[40:47], v19
    v_mov_b32_dpp v60, v44 row_ror:8 row_mask:0xf bank_mask:0xf
    v_mov_b32_dpp v61, v45 row_ror:8 row_mask:0xf bank_mask:0xf
    v_smfmac_f32_16x16x64_bf16 v[68:71], v[52:55], a[104:111], v19
    v_mov_b32_dpp v62, v46 row_ror:8 row_mask:0xf bank_mask:0xf
    v_mov_b32_dpp v63, v47 row_ror:8 row_mask:0xf bank_mask:0xf
    s_cbranch_vccnz Gq_15_f30p1
    v_smfmac_f32_16x16x64_bf16 v[64:67], v[44:47], a[24:31], v19
    v_smfmac_f32_16x16x64_bf16 v[68:71], v[44:47], a[88:95], v19
    s_branch Gq_15_s0p3
Gq_15_f130:
    buffer_load_dwordx4 v[36:39], v2, s[8:11], s40 offen offset:1024 sc1
    s_add_u32 s33, s33, 1
    s_cmp_gt_u32 s33, 0x100000
    s_cbranch_scc1 chain_kernel_abort
    s_branch Gq_15_s301
Gq_15_f30p1:
    buffer_load_dwordx4 v[44:47], v2, s[8:11], s40 offen offset:3072 sc1
    s_add_u32 s33, s33, 1
    s_cmp_gt_u32 s33, 0x100000
    s_cbranch_scc1 chain_kernel_abort
    s_branch Gq_15_s03
Gq_15_s01:
    s_waitcnt vmcnt(1)
    v_cmp_eq_u32 vcc, -1, v32
    v_mov_b32_dpp v48, v32 row_ror:8 row_mask:0xf bank_mask:0xf
    v_mov_b32_dpp v49, v33 row_ror:8 row_mask:0xf bank_mask:0xf
    v_mov_b32_dpp v50, v34 row_ror:8 row_mask:0xf bank_mask:0xf
    v_mov_b32_dpp v51, v35 row_ror:8 row_mask:0xf bank_mask:0xf
    s_cbranch_vccnz Gq_15_f01
    v_smfmac_f32_16x16x64_bf16 v[64:67], v[32:35], a[0:7], v19
    v_smfmac_f32_16x16x64_bf16 v[68:71], v[32:35], a[64:71], v19
    s_branch Gq_15_s1p0
Gq_15_f01:
    buffer_load_dwordx4 v[32:35], v2, s[8:11], s40 offen offset:0 sc1
    s_add_u32 s33, s33, 1
    s_cmp_gt_u32 s33, 0x100000
    s_cbranch_scc1 chain_kernel_abort
    s_branch Gq_15_s10
Gq_15_s230:
    s_waitcnt vmcnt(2)
    v_cmp_eq_u32 vcc, -1, v40
    v_mov_b32_dpp v56, v40 row_ror:8 row_mask:0xf bank_mask:0xf
    v_mov_b32_dpp v57, v41 row_ror:8 row_mask:0xf bank_mask:0xf
    v_mov_b32_dpp v58, v42 row_ror:8 row_mask:0xf bank_mask:0xf
    v_mov_b32_dpp v59, v43 row_ror:8 row_mask:0xf bank_mask:0xf
    s_cbranch_vccnz Gq_15_f230
    v_smfmac_f32_16x16x64_bf16 v[64:67], v[40:43], a[16:23], v19
    v_smfmac_f32_16x16x64_bf16 v[68:71], v[40:43], a[80:87], v19
    s_branch Gq_15_s30p2
Gq_15_f230:
    buffer_load_dwordx4 v[40:43], v2, s[8:11], s40 offen offset:2048 sc1
    s_add_u32 s33, s33, 1
    s_cmp_gt_u32 s33, 0x100000
    s_cbranch_scc1 chain_kernel_abort
    s_branch Gq_15_s302
Gq_15_s02:
    s_waitcnt vmcnt(1)
    v_cmp_eq_u32 vcc, -1, v32
    v_mov_b32_dpp v48, v32 row_ror:8 row_mask:0xf bank_mask:0xf
    v_mov_b32_dpp v49, v33 row_ror:8 row_mask:0xf bank_mask:0xf
    v_mov_b32_dpp v50, v34 row_ror:8 row_mask:0xf bank_mask:0xf
    v_mov_b32_dpp v51, v35 row_ror:8 row_mask:0xf bank_mask:0xf
    s_cbranch_vccnz Gq_15_f02
    v_smfmac_f32_16x16x64_bf16 v[64:67], v[32:35], a[0:7], v19
    v_smfmac_f32_16x16x64_bf16 v[68:71], v[32:35], a[64:71], v19
    s_branch Gq_15_s2p0
Gq_15_f02:
    buffer_load_dwordx4 v[32:35], v2, s[8:11], s40 offen offset:0 sc1
    s_add_u32 s33, s33, 1
    s_cmp_gt_u32 s33, 0x100000
    s_cbranch_scc1 chain_kernel_abort
    s_branch Gq_15_s20
Gq_15_s12:
    s_waitcnt vmcnt(1)
    v_cmp_eq_u32 vcc, -1, v36
    v_mov_b32_dpp v52, v36 row_ror:8 row_mask:0xf bank_mask:0xf
    v_mov_b32_dpp v53, v37 row_ror:8 row_mask:0xf bank_mask:0xf
    v_mov_b32_dpp v54, v38 row_ror:8 row_mask:0xf bank_mask:0xf
    v_mov_b32_dpp v55, v39 row_ror:8 row_mask:0xf bank_mask:0xf
    s_cbranch_vccnz Gq_15_f12
    v_smfmac_f32_16x16x64_bf16 v[64:67], v[36:39], a[8:15], v19
    v_smfmac_f32_16x16x64_bf16 v[68:71], v[36:39], a[72:79], v19
    s_branch Gq_15_s2p1
Gq_15_f12:
    buffer_load_dwordx4 v[36:39], v2, s[8:11], s40 offen offset:1024 sc1
    s_add_u32 s33, s33, 1
    s_cmp_gt_u32 s33, 0x100000
    s_cbranch_scc1 chain_kernel_abort
    s_branch Gq_15_s21
Gq_15_s201:
    s_waitcnt vmcnt(2)
    v_cmp_eq_u32 vcc, -1, v40
    v_mov_b32_dpp v56, v40 row_ror:8 row_mask:0xf bank_mask:0xf
    v_mov_b32_dpp v57, v41 row_ror:8 row_mask:0xf bank_mask:0xf
    v_mov_b32_dpp v58, v42 row_ror:8 row_mask:0xf bank_mask:0xf
    v_mov_b32_dpp v59, v43 row_ror:8 row_mask:0xf bank_mask:0xf
    s_cbranch_vccnz Gq_15_f201
    v_smfmac_f32_16x16x64_bf16 v[64:67], v[40:43], a[16:23], v19
    v_smfmac_f32_16x16x64_bf16 v[68:71], v[40:43], a[80:87], v19
Gq_15_s01p2:
    s_waitcnt vmcnt(1)
    v_cmp_eq_u32 vcc, -1, v32
    v_smfmac_f32_16x16x64_bf16 v[64:67], v[56:59], a[48:55], v19
    v_mov_b32_dpp v48, v32 row_ror:8 row_mask:0xf bank_mask:0xf
    v_mov_b32_dpp v49, v33 row_ror:8 row_mask:0xf bank_mask:0xf
    v_smfmac_f32_16x16x64_bf16 v[68:71], v[56:59], a[112:119], v19
    v_mov_b32_dpp v50, v34 row_ror:8 row_mask:0xf bank_mask:0xf
    v_mov_b32_dpp v51, v35 row_ror:8 row_mask:0xf bank_mask:0xf
    s_cbranch_vccnz Gq_15_f01p2
    v_smfmac_f32_16x16x64_bf16 v[64:67], v[32:35], a[0:7], v19
    v_smfmac_f32_16x16x64_bf16 v[68:71], v[32:35], a[64:71], v19
    s_branch Gq_15_s1p0
Gq_15_f201:
    buffer_load_dwordx4 v[40:43], v2, s[8:11], s40 offen offset:2048 sc1
    s_add_u32 s33, s33, 1
    s_cmp_gt_u32 s33, 0x100000
    s_cbranch_scc1 chain_kernel_abort
    s_branch Gq_15_s012
Gq_15_f01p2:
    buffer_load_dwordx4 v[32:35], v2, s[8:11], s40 offen offset:0 sc1
    s_add_u32 s33, s33, 1
    s_cmp_gt_u32 s33, 0x100000
    s_cbranch_scc1 chain_kernel_abort
    s_branch Gq_15_s10
Gq_15_s301:
    s_waitcnt vmcnt(2)
    v_cmp_eq_u32 vcc, -1, v44
    v_mov_b32_dpp v60, v44 row_ror:8 row_mask:0xf bank_mask:0xf
    v_mov_b32_dpp v61, v45 row_ror:8 row_mask:0xf bank_mask:0xf
    v_mov_b32_dpp v62, v46 row_ror:8 row_mask:0xf bank_mask:0xf
    v_mov_b32_dpp v63, v47 row_ror:8 row_mask:0xf bank_mask:0xf
    s_cbranch_vccnz Gq_15_f301
    v_smfmac_f32_16x16x64_bf16 v[64:67], v[44:47], a[24:31], v19
    v_smfmac_f32_16x16x64_bf16 v[68:71], v[44:47], a[88:95], v19
    s_branch Gq_15_s01p3
Gq_15_f301:
    buffer_load_dwordx4 v[44:47], v2, s[8:11], s40 offen offset:3072 sc1
    s_add_u32 s33, s33, 1
    s_cmp_gt_u32 s33, 0x100000
    s_cbranch_scc1 chain_kernel_abort
    s_branch Gq_15_s013
Gq_15_s012:
    s_waitcnt vmcnt(2)
    v_cmp_eq_u32 vcc, -1, v32
    v_mov_b32_dpp v48, v32 row_ror:8 row_mask:0xf bank_mask:0xf
    v_mov_b32_dpp v49, v33 row_ror:8 row_mask:0xf bank_mask:0xf
    v_mov_b32_dpp v50, v34 row_ror:8 row_mask:0xf bank_mask:0xf
    v_mov_b32_dpp v51, v35 row_ror:8 row_mask:0xf bank_mask:0xf
    s_cbranch_vccnz Gq_15_f012
    v_smfmac_f32_16x16x64_bf16 v[64:67], v[32:35], a[0:7], v19
    v_smfmac_f32_16x16x64_bf16 v[68:71], v[32:35], a[64:71], v19
    s_branch Gq_15_s12p0
Gq_15_f012:
    buffer_load_dwordx4 v[32:35], v2, s[8:11], s40 offen offset:0 sc1
    s_add_u32 s33, s33, 1
    s_cmp_gt_u32 s33, 0x100000
    s_cbranch_scc1 chain_kernel_abort
    s_branch Gq_15_s120
L_sd_16_0_0f:
    s_branch L_sd_16_1_0
L_sd_16_0_1f:
    s_branch L_sd_16_1_1
L_sd_16_0_2f:
    s_branch L_sd_16_1_2
L_sd_16_0_3f:
    s_branch L_sd_16_1_3
L_sd_16_1_0:
    s_waitcnt vmcnt(7)
    v_max3_u32 v20, v164, v165, v166
    v_mfma_f32_16x16x32_bf16 v[88:91], v[164:167], v[164:167], 0
    v_max_u32 v20, v20, v167
    v_cmp_eq_u32 vcc, -1, v20
    v_mfma_f32_16x16x32_bf16 v[84:87], v[120:123], v[164:167], 0
    v_mfma_f32_16x16x32_bf16 v[80:83], v[104:107], v[164:167], 0
    s_cbranch_vccnz L_sd_16_2_0
L_sd_16_1_1:
    s_waitcnt vmcnt(6)
    v_max3_u32 v20, v168, v169, v170
    v_mfma_f32_16x16x32_bf16 v[100:103], v[168:171], v[168:171], v[88:91]
    v_max_u32 v20, v20, v171
    v_cmp_eq_u32 vcc, -1, v20
    v_mfma_f32_16x16x32_bf16 v[96:99], v[124:127], v[168:171], v[84:87]
    v_mfma_f32_16x16x32_bf16 v[92:95], v[108:111], v[168:171], v[80:83]
    s_cbranch_vccnz L_sd_16_2_1
L_sd_16_1_2:
    s_waitcnt vmcnt(5)
    v_max3_u32 v20, v172, v173, v174
    v_mfma_f32_16x16x32_bf16 v[228:231], v[172:175], v[172:175], v[100:103]
    v_max_u32 v20, v20, v175
    v_cmp_eq_u32 vcc, -1, v20
    v_mfma_f32_16x16x32_bf16 v[224:227], v[128:131], v[172:175], v[96:99]
    v_mfma_f32_16x16x32_bf16 v[220:223], v[112:115], v[172:175], v[92:95]
    s_cbranch_vccnz L_sd_16_2_2
L_sd_16_1_3:
    s_waitcnt vmcnt(4)
    v_max3_u32 v20, v176, v177, v178
    v_mfma_f32_16x16x32_bf16 v[188:191], v[176:179], v[176:179], v[228:231]
    v_max_u32 v20, v20, v179
    v_cmp_eq_u32 vcc, -1, v20
    v_mfma_f32_16x16x32_bf16 v[184:187], v[132:135], v[176:179], v[224:227]
    v_mfma_f32_16x16x32_bf16 v[180:183], v[116:119], v[176:179], v[220:223]
    v_mov_b32_dpp v188, v189 row_ror:8 row_mask:0xf bank_mask:0xc
    v_mov_b32_dpp v190, v191 row_ror:8 row_mask:0xf bank_mask:0xc
    s_cbranch_vccnz L_sd_16_2_3
    s_branch L_sd_16
L_sd_16_1_0f:
    s_branch L_sd_16_2_0
L_sd_16_1_1f:
    s_branch L_sd_16_2_1
L_sd_16_1_2f:
    s_branch L_sd_16_2_2
L_sd_16_1_3f:
    s_branch L_sd_16_2_3
L_sd_16_2_0:
    s_waitcnt vmcnt(3)
    v_max3_u32 v20, v32, v33, v34
    v_mfma_f32_16x16x32_bf16 v[88:91], v[32:35], v[32:35], 0
    v_max_u32 v20, v20, v35
    v_cmp_eq_u32 vcc, -1, v20
    v_mfma_f32_16x16x32_bf16 v[84:87], v[120:123], v[32:35], 0
    v_mfma_f32_16x16x32_bf16 v[80:83], v[104:107], v[32:35], 0
    s_cbranch_vccnz L_sd_16_2_0f
L_sd_16_2_1:
    s_waitcnt vmcnt(2)
    v_max3_u32 v20, v36, v37, v38
    v_mfma_f32_16x16x32_bf16 v[100:103], v[36:39], v[36:39], v[88:91]
    v_max_u32 v20, v20, v39
    v_cmp_eq_u32 vcc, -1, v20
    v_mfma_f32_16x16x32_bf16 v[96:99], v[124:127], v[36:39], v[84:87]
    v_mfma_f32_16x16x32_bf16 v[92:95], v[108:111], v[36:39], v[80:83]
    s_cbranch_vccnz L_sd_16_2_1f
L_sd_16_2_2:
    s_waitcnt vmcnt(1)
    v_max3_u32 v20, v40, v41, v42
    v_mfma_f32_16x16x32_bf16 v[228:231], v[40:43], v[40:43], v[100:103]
    v_max_u32 v20, v20, v43
    v_cmp_eq_u32 vcc, -1, v20
    v_mfma_f32_16x16x32_bf16 v[224:227], v[128:131], v[40:43], v[96:99]
    v_mfma_f32_16x16x32_bf16 v[220:223], v[112:115], v[40:43], v[92:95]
    s_cbranch_vccnz L_sd_16_2_2f
L_sd_16_2_3:
    s_waitcnt vmcnt(0)
    v_max3_u32 v20, v44, v45, v46
    v_mfma_f32_16x16x32_bf16 v[188:191], v[44:47], v[44:47], v[228:231]
    v_max_u32 v20, v20, v47
    v_cmp_eq_u32 vcc, -1, v20
    v_mfma_f32_16x16x32_bf16 v[184:187], v[132:135], v[44:47], v[224:227]
    v_mfma_f32_16x16x32_bf16 v[180:183], v[116:119], v[44:47], v[220:223]
    v_mov_b32_dpp v188, v189 row_ror:8 row_mask:0xf bank_mask:0xc
    v_mov_b32_dpp v190, v191 row_ror:8 row_mask:0xf bank_mask:0xc
    s_cbranch_vccnz L_sd_16_2_3f
    s_branch L_sd_16
L_sd_16_2_0f:
    buffer_load_dwordx4 v[148:151], v5, s[8:11], s40 offen offset:0 sc1
    buffer_load_dwordx4 v[152:155], v5, s[8:11], s40 offen offset:1024 sc1
    buffer_load_dwordx4 v[156:159], v5, s[8:11], s40 offen offset:2048 sc1
    buffer_load_dwordx4 v[160:163], v5, s[8:11], s40 offen offset:3072 sc1
    s_add_u32 s33, s33, 1
    s_cmp_gt_u32 s33, 0x100000
    s_cbranch_scc1 chain_kernel_abort
    s_branch L_sd_16_3_0
L_sd_16_2_1f:
    buffer_load_dwordx4 v[152:155], v5, s[8:11], s40 offen offset:1024 sc1
    buffer_load_dwordx4 v[156:159], v5, s[8:11], s40 offen offset:2048 sc1
    buffer_load_dwordx4 v[160:163], v5, s[8:11], s40 offen offset:3072 sc1
    s_add_u32 s33, s33, 1
    s_cmp_gt_u32 s33, 0x100000
    s_cbranch_scc1 chain_kernel_abort
    s_branch L_sd_16_3_1
L_sd_16_2_2f:
    buffer_load_dwordx4 v[156:159], v5, s[8:11], s40 offen offset:2048 sc1
    buffer_load_dwordx4 v[160:163], v5, s[8:11], s40 offen offset:3072 sc1
    s_add_u32 s33, s33, 1
    s_cmp_gt_u32 s33, 0x100000
    s_cbranch_scc1 chain_kernel_abort
    s_branch L_sd_16_3_2
L_sd_16_2_3f:
    buffer_load_dwordx4 v[160:163], v5, s[8:11], s40 offen offset:3072 sc1
    s_add_u32 s33, s33, 1
    s_cmp_gt_u32 s33, 0x100000
    s_cbranch_scc1 chain_kernel_abort
    s_branch L_sd_16_3_3
L_sd_16_3_0:
    s_waitcnt vmcnt(3)
    v_max3_u32 v20, v148, v149, v150
    v_mfma_f32_16x16x32_bf16 v[88:91], v[148:151], v[148:151], 0
    v_max_u32 v20, v20, v151
    v_cmp_eq_u32 vcc, -1, v20
    v_mfma_f32_16x16x32_bf16 v[84:87], v[120:123], v[148:151], 0
    v_mfma_f32_16x16x32_bf16 v[80:83], v[104:107], v[148:151], 0
    s_cbranch_vccnz L_sd_16_3_0f
L_sd_16_3_1:
    s_waitcnt vmcnt(2)
    v_max3_u32 v20, v152, v153, v154
    v_mfma_f32_16x16x32_bf16 v[100:103], v[152:155], v[152:155], v[88:91]
    v_max_u32 v20, v20, v155
    v_cmp_eq_u32 vcc, -1, v20
    v_mfma_f32_16x16x32_bf16 v[96:99], v[124:127], v[152:155], v[84:87]
    v_mfma_f32_16x16x32_bf16 v[92:95], v[108:111], v[152:155], v[80:83]
    s_cbranch_vccnz L_sd_16_3_1f
L_sd_16_3_2:
    s_waitcnt vmcnt(1)
    v_max3_u32 v20, v156, v157, v158
    v_mfma_f32_16x16x32_bf16 v[228:231], v[156:159], v[156:159], v[100:103]
    v_max_u32 v20, v20, v159
    v_cmp_eq_u32 vcc, -1, v20
    v_mfma_f32_16x16x32_bf16 v[224:227], v[128:131], v[156:159], v[96:99]
    v_mfma_f32_16x16x32_bf16 v[220:223], v[112:115], v[156:159], v[92:95]
    s_cbranch_vccnz L_sd_16_3_2f
L_sd_16_3_3:
    s_waitcnt vmcnt(0)
    v_max3_u32 v20, v160, v161, v162
    v_mfma_f32_16x16x32_bf16 v[188:191], v[160:163], v[160:163], v[228:231]
    v_max_u32 v20, v20, v163
    v_cmp_eq_u32 vcc, -1, v20
    v_mfma_f32_16x16x32_bf16 v[184:187], v[132:135], v[160:163], v[224:227]
    v_mfma_f32_16x16x32_bf16 v[180:183], v[116:119], v[160:163], v[220:223]
    v_mov_b32_dpp v188, v189 row_ror:8 row_mask:0xf bank_mask:0xc
    v_mov_b32_dpp v190, v191 row_ror:8 row_mask:0xf bank_mask:0xc
    s_cbranch_vccnz L_sd_16_3_3f
    s_branch L_sd_16
L_sd_16_3_0f:
    buffer_load_dwordx4 v[148:151], v5, s[8:11], s40 offen offset:0 sc1
    buffer_load_dwordx4 v[152:155], v5, s[8:11], s40 offen offset:1024 sc1
    buffer_load_dwordx4 v[156:159], v5, s[8:11], s40 offen offset:2048 sc1
    buffer_load_dwordx4 v[160:163], v5, s[8:11], s40 offen offset:3072 sc1
    s_add_u32 s33, s33, 1
    s_cmp_gt_u32 s33, 0x100000
    s_cbranch_scc1 chain_kernel_abort
    s_branch L_sd_16_3_0
L_sd_16_3_1f:
    buffer_load_dwordx4 v[152:155], v5, s[8:11], s40 offen offset:1024 sc1
    buffer_load_dwordx4 v[156:159], v5, s[8:11], s40 offen offset:2048 sc1
    buffer_load_dwordx4 v[160:163], v5, s[8:11], s40 offen offset:3072 sc1
    s_add_u32 s33, s33, 1
    s_cmp_gt_u32 s33, 0x100000
    s_cbranch_scc1 chain_kernel_abort
    s_branch L_sd_16_3_1
L_sd_16_3_2f:
    buffer_load_dwordx4 v[156:159], v5, s[8:11], s40 offen offset:2048 sc1
    buffer_load_dwordx4 v[160:163], v5, s[8:11], s40 offen offset:3072 sc1
    s_add_u32 s33, s33, 1
    s_cmp_gt_u32 s33, 0x100000
    s_cbranch_scc1 chain_kernel_abort
    s_branch L_sd_16_3_2
L_sd_16_3_3f:
    buffer_load_dwordx4 v[160:163], v5, s[8:11], s40 offen offset:3072 sc1
    s_add_u32 s33, s33, 1
    s_cmp_gt_u32 s33, 0x100000
    s_cbranch_scc1 chain_kernel_abort
    s_branch L_sd_16_3_3
Go_17_f0123:
    buffer_load_dwordx4 v[32:35], v3, s[8:11], s40 offen offset:0 sc1
    s_branch Go_17_s1230
Go_17_f123:
    buffer_load_dwordx4 v[36:39], v3, s[8:11], s40 offen offset:1024 sc1
    s_add_u32 s33, s33, 1
    s_cmp_gt_u32 s33, 0x100000
    s_cbranch_scc1 chain_kernel_abort
    s_branch Go_17_s231
Go_17_f23:
    buffer_load_dwordx4 v[40:43], v3, s[8:11], s40 offen offset:2048 sc1
    s_add_u32 s33, s33, 1
    s_cmp_gt_u32 s33, 0x100000
    s_cbranch_scc1 chain_kernel_abort
    s_branch Go_17_s32
Go_17_f3:
    buffer_load_dwordx4 v[44:47], v3, s[8:11], s40 offen offset:3072 sc1
    s_add_u32 s33, s33, 1
    s_cmp_gt_u32 s33, 0x100000
    s_cbranch_scc1 chain_kernel_abort
    s_branch Go_17_s3
Go_17_redo:
    buffer_load_dwordx4 v[32:35], v3, s[8:11], s40 offen offset:0 sc1
    buffer_load_dwordx4 v[36:39], v3, s[8:11], s40 offen offset:1024 sc1
    buffer_load_dwordx4 v[40:43], v3, s[8:11], s40 offen offset:2048 sc1
    buffer_load_dwordx4 v[44:47], v3, s[8:11], s40 offen offset:3072 sc1
    s_add_u32 s33, s33, 1
    s_cmp_gt_u32 s33, 0x100000
    s_cbranch_scc1 chain_kernel_abort
    s_nop 5
    v_mov_b32 v76, 0
    v_mov_b32 v77, 0
    v_mov_b32 v78, 0
    v_mov_b32 v79, 0
    s_branch Go_17_s0123
Go_17_s1230:
    s_waitcnt vmcnt(3)
    v_cmp_eq_u32 vcc, -1, v36
    v_mov_b32_dpp v52, v36 row_ror:8 row_mask:0xf bank_mask:0xf
    v_mov_b32_dpp v53, v37 row_ror:8 row_mask:0xf bank_mask:0xf
    v_mov_b32_dpp v54, v38 row_ror:8 row_mask:0xf bank_mask:0xf
    v_mov_b32_dpp v55, v39 row_ror:8 row_mask:0xf bank_mask:0xf
    s_cbranch_vccnz Go_17_f1230
    v_smfmac_f32_16x16x64_bf16 v[76:79], v[36:39], a[200:207], v19
    v_smfmac_f32_16x16x64_bf16 v[76:79], v[52:55], a[232:239], v19
Go_17_s230:
    s_waitcnt vmcnt(2)
    v_cmp_eq_u32 vcc, -1, v40
    v_mov_b32_dpp v56, v40 row_ror:8 row_mask:0xf bank_mask:0xf
    v_mov_b32_dpp v57, v41 row_ror:8 row_mask:0xf bank_mask:0xf
    v_mov_b32_dpp v58, v42 row_ror:8 row_mask:0xf bank_mask:0xf
    v_mov_b32_dpp v59, v43 row_ror:8 row_mask:0xf bank_mask:0xf
    s_cbranch_vccnz Go_17_f230
    v_smfmac_f32_16x16x64_bf16 v[76:79], v[40:43], a[208:215], v19
    v_smfmac_f32_16x16x64_bf16 v[76:79], v[56:59], a[240:247], v19
Go_17_s30:
    s_waitcnt vmcnt(1)
    v_cmp_eq_u32 vcc, -1, v44
    v_mov_b32_dpp v60, v44 row_ror:8 row_mask:0xf bank_mask:0xf
    v_mov_b32_dpp v61, v45 row_ror:8 row_mask:0xf bank_mask:0xf
    v_mov_b32_dpp v62, v46 row_ror:8 row_mask:0xf bank_mask:0xf
    v_mov_b32_dpp v63, v47 row_ror:8 row_mask:0xf bank_mask:0xf
    s_cbranch_vccnz Go_17_f30
    v_smfmac_f32_16x16x64_bf16 v[76:79], v[44:47], a[216:223], v19
    v_smfmac_f32_16x16x64_bf16 v[76:79], v[60:63], a[248:255], v19
Go_17_s0:
    s_waitcnt vmcnt(0)
    v_cmp_eq_u32 vcc, -1, v32
    v_mov_b32_dpp v48, v32 row_ror:8 row_mask:0xf bank_mask:0xf
    v_mov_b32_dpp v49, v33 row_ror:8 row_mask:0xf bank_mask:0xf
    v_mov_b32_dpp v50, v34 row_ror:8 row_mask:0xf bank_mask:0xf
    v_mov_b32_dpp v51, v35 row_ror:8 row_mask:0xf bank_mask:0xf
    s_cbranch_vccnz Go_17_f0
    v_smfmac_f32_16x16x64_bf16 v[76:79], v[32:35], a[192:199], v19
    v_smfmac_f32_16x16x64_bf16 v[76:79], v[48:51], a[224:231], v19
    s_branch Go_17_done
Go_17_f1230:
    buffer_load_dwordx4 v[36:39], v3, s[8:11], s40 offen offset:1024 sc1
    s_add_u32 s33, s33, 1
    s_cmp_gt_u32 s33, 0x100000
    s_cbranch_scc1 chain_kernel_abort
    s_branch Go_17_s2301
Go_17_f230:
    buffer_load_dwordx4 v[40:43], v3, s[8:11], s40 offen offset:2048 sc1
    s_add_u32 s33, s33, 1
    s_cmp_gt_u32 s33, 0x100000
    s_cbranch_scc1 chain_kernel_abort
    s_branch Go_17_s302
Go_17_f30:
    buffer_load_dwordx4 v[44:47], v3, s[8:11], s40 offen offset:3072 sc1
    s_add_u32 s33, s33, 1
    s_cmp_gt_u32 s33, 0x100000
    s_cbranch_scc1 chain_kernel_abort
    s_branch Go_17_s03
Go_17_f0:
    buffer_load_dwordx4 v[32:35], v3, s[8:11], s40 offen offset:0 sc1
    s_add_u32 s33, s33, 1
    s_cmp_gt_u32 s33, 0x100000
    s_cbranch_scc1 chain_kernel_abort
    s_branch Go_17_s0
Go_17_s231:
    s_waitcnt vmcnt(2)
    v_cmp_eq_u32 vcc, -1, v40
    v_mov_b32_dpp v56, v40 row_ror:8 row_mask:0xf bank_mask:0xf
    v_mov_b32_dpp v57, v41 row_ror:8 row_mask:0xf bank_mask:0xf
    v_mov_b32_dpp v58, v42 row_ror:8 row_mask:0xf bank_mask:0xf
    v_mov_b32_dpp v59, v43 row_ror:8 row_mask:0xf bank_mask:0xf
    s_cbranch_vccnz Go_17_f231
    v_smfmac_f32_16x16x64_bf16 v[76:79], v[40:43], a[208:215], v19
    v_smfmac_f32_16x16x64_bf16 v[76:79], v[56:59], a[240:247], v19
Go_17_s31:
    s_waitcnt vmcnt(1)
    v_cmp_eq_u32 vcc, -1, v44
    v_mov_b32_dpp v60, v44 row_ror:8 row_mask:0xf bank_mask:0xf
    v_mov_b32_dpp v61, v45 row_ror:8 row_mask:0xf bank_mask:0xf
    v_mov_b32_dpp v62, v46 row_ror:8 row_mask:0xf bank_mask:0xf
    v_mov_b32_dpp v63, v47 row_ror:8 row_mask:0xf bank_mask:0xf
    s_cbranch_vccnz Go_17_f31
    v_smfmac_f32_16x16x64_bf16 v[76:79], v[44:47], a[216:223], v19
    v_smfmac_f32_16x16x64_bf16 v[76:79], v[60:63], a[248:255], v19
Go_17_s1:
    s_waitcnt vmcnt(0)
    v_cmp_eq_u32 vcc, -1, v36
    v_mov_b32_dpp v52, v36 row_ror:8 row_mask:0xf bank_mask:0xf
    v_mov_b32_dpp v53, v37 row_ror:8 row_mask:0xf bank_mask:0xf
    v_mov_b32_dpp v54, v38 row_ror:8 row_mask:0xf bank_mask:0xf
    v_mov_b32_dpp v55, v39 row_ror:8 row_mask:0xf bank_mask:0xf
    s_cbranch_vccnz Go_17_f1
    v_smfmac_f32_16x16x64_bf16 v[76:79], v[36:39], a[200:207], v19
    v_smfmac_f32_16x16x64_bf16 v[76:79], v[52:55], a[232:239], v19
    s_branch Go_17_done
Go_17_f231:
    buffer_load_dwordx4 v[40:43], v3, s[8:11], s40 offen offset:2048 sc1
    s_add_u32 s33, s33, 1
    s_cmp_gt_u32 s33, 0x100000
    s_cbranch_scc1 chain_kernel_abort
    s_branch Go_17_s312
Go_17_f31:
    buffer_load_dwordx4 v[44:47], v3, s[8:11], s40 offen offset:3072 sc1
    s_add_u32 s33, s33, 1
    s_cmp_gt_u32 s33, 0x100000
    s_cbranch_scc1 chain_kernel_abort
    s_branch Go_17_s13
Go_17_f1:
    buffer_load_dwordx4 v[36:39], v3, s[8:11], s40 offen offset:1024 sc1
    s_add_u32 s33, s33, 1
    s_cmp_gt_u32 s33, 0x100000
    s_cbranch_scc1 chain_kernel_abort
    s_branch Go_17_s1
Go_17_s32:
    s_waitcnt vmcnt(1)
    v_cmp_eq_u32 vcc, -1, v44
    v_mov_b32_dpp v60, v44 row_ror:8 row_mask:0xf bank_mask:0xf
    v_mov_b32_dpp v61, v45 row_ror:8 row_mask:0xf bank_mask:0xf
    v_mov_b32_dpp v62, v46 row_ror:8 row_mask:0xf bank_mask:0xf
    v_mov_b32_dpp v63, v47 row_ror:8 row_mask:0xf bank_mask:0xf
    s_cbranch_vccnz Go_17_f32
    v_smfmac_f32_16x16x64_bf16 v[76:79], v[44:47], a[216:223], v19
    v_smfmac_f32_16x16x64_bf16 v[76:79], v[60:63], a[248:255], v19
Go_17_s2:
    s_waitcnt vmcnt(0)
    v_cmp_eq_u32 vcc, -1, v40
    v_mov_b32_dpp v56, v40 row_ror:8 row_mask:0xf bank_mask:0xf
    v_mov_b32_dpp v57, v41 row_ror:8 row_mask:0xf bank_mask:0xf
    v_mov_b32_dpp v58, v42 row_ror:8 row_mask:0xf bank_mask:0xf
    v_mov_b32_dpp v59, v43 row_ror:8 row_mask:0xf bank_mask:0xf
    s_cbranch_vccnz Go_17_f2
    v_smfmac_f32_16x16x64_bf16 v[76:79], v[40:43], a[208:215], v19
    v_smfmac_f32_16x16x64_bf16 v[76:79], v[56:59], a[240:247], v19
    s_branch Go_17_done
Go_17_f32:
    buffer_load_dwordx4 v[44:47], v3, s[8:11], s40 offen offset:3072 sc1
    s_add_u32 s33, s33, 1
    s_cmp_gt_u32 s33, 0x100000
    s_cbranch_scc1 chain_kernel_abort
    s_branch Go_17_s23
Go_17_f2:
    buffer_load_dwordx4 v[40:43], v3, s[8:11], s40 offen offset:2048 sc1
    s_add_u32 s33, s33, 1
    s_cmp_gt_u32 s33, 0x100000
    s_cbranch_scc1 chain_kernel_abort
    s_branch Go_17_s2
Go_17_s2301:
    s_waitcnt vmcnt(3)
    v_cmp_eq_u32 vcc, -1, v40
    v_mov_b32_dpp v56, v40 row_ror:8 row_mask:0xf bank_mask:0xf
    v_mov_b32_dpp v57, v41 row_ror:8 row_mask:0xf bank_mask:0xf
    v_mov_b32_dpp v58, v42 row_ror:8 row_mask:0xf bank_mask:0xf
    v_mov_b32_dpp v59, v43 row_ror:8 row_mask:0xf bank_mask:0xf
    s_cbranch_vccnz Go_17_f2301
    v_smfmac_f32_16x16x64_bf16 v[76:79], v[40:43], a[208:215], v19
    v_smfmac_f32_16x16x64_bf16 v[76:79], v[56:59], a[240:247], v19
Go_17_s301:
    s_waitcnt vmcnt(2)
    v_cmp_eq_u32 vcc, -1, v44
    v_mov_b32_dpp v60, v44 row_ror:8 row_mask:0xf bank_mask:0xf
    v_mov_b32_dpp v61, v45 row_ror:8 row_mask:0xf bank_mask:0xf
    v_mov_b32_dpp v62, v46 row_ror:8 row_mask:0xf bank_mask:0xf
    v_mov_b32_dpp v63, v47 row_ror:8 row_mask:0xf bank_mask:0xf
    s_cbranch_vccnz Go_17_f301
    v_smfmac_f32_16x16x64_bf16 v[76:79], v[44:47], a[216:223], v19
    v_smfmac_f32_16x16x64_bf16 v[76:79], v[60:63], a[248:255], v19
Go_17_s01:
    s_waitcnt vmcnt(1)
    v_cmp_eq_u32 vcc, -1, v32
    v_mov_b32_dpp v48, v32 row_ror:8 row_mask:0xf bank_mask:0xf
    v_mov_b32_dpp v49, v33 row_ror:8 row_mask:0xf bank_mask:0xf
    v_mov_b32_dpp v50, v34 row_ror:8 row_mask:0xf bank_mask:0xf
    v_mov_b32_dpp v51, v35 row_ror:8 row_mask:0xf bank_mask:0xf
    s_cbranch_vccnz Go_17_f01
    v_smfmac_f32_16x16x64_bf16 v[76:79], v[32:35], a[192:199], v19
    v_smfmac_f32_16x16x64_bf16 v[76:79], v[48:51], a[224:231], v19
    s_branch Go_17_s1
Go_17_f2301:
    buffer_load_dwordx4 v[40:43], v3, s[8:11], s40 offen offset:2048 sc1
    s_add_u32 s33, s33, 1
    s_cmp_gt_u32 s33, 0x100000
    s_cbranch_scc1 chain_kernel_abort
    s_branch Go_17_s3012
Go_17_f301:
    buffer_load_dwordx4 v[44:47], v3, s[8:11], s40 offen offset:3072 sc1
    s_add_u32 s33, s33, 1
    s_cmp_gt_u32 s33, 0x100000
    s_cbranch_scc1 chain_kernel_abort
    s_branch Go_17_s013
Go_17_f01:
    buffer_load_dwordx4 v[32:35], v3, s[8:11], s40 offen offset:0 sc1
    s_add_u32 s33, s33, 1
    s_cmp_gt_u32 s33, 0x100000
    s_cbranch_scc1 chain_kernel_abort
    s_branch Go_17_s10
Go_17_s302:
    s_waitcnt vmcnt(2)
    v_cmp_eq_u32 vcc, -1, v44
    v_mov_b32_dpp v60, v44 row_ror:8 row_mask:0xf bank_mask:0xf
    v_mov_b32_dpp v61, v45 row_ror:8 row_mask:0xf bank_mask:0xf
    v_mov_b32_dpp v62, v46 row_ror:8 row_mask:0xf bank_mask:0xf
    v_mov_b32_dpp v63, v47 row_ror:8 row_mask:0xf bank_mask:0xf
    s_cbranch_vccnz Go_17_f302
    v_smfmac_f32_16x16x64_bf16 v[76:79], v[44:47], a[216:223], v19
    v_smfmac_f32_16x16x64_bf16 v[76:79], v[60:63], a[248:255], v19
Go_17_s02:
    s_waitcnt vmcnt(1)
    v_cmp_eq_u32 vcc, -1, v32
    v_mov_b32_dpp v48, v32 row_ror:8 row_mask:0xf bank_mask:0xf
    v_mov_b32_dpp v49, v33 row_ror:8 row_mask:0xf bank_mask:0xf
    v_mov_b32_dpp v50, v34 row_ror:8 row_mask:0xf bank_mask:0xf
    v_mov_b32_dpp v51, v35 row_ror:8 row_mask:0xf bank_mask:0xf
    s_cbranch_vccnz Go_17_f02
    v_smfmac_f32_16x16x64_bf16 v[76:79], v[32:35], a[192:199], v19
    v_smfmac_f32_16x16x64_bf16 v[76:79], v[48:51], a[224:231], v19
    s_branch Go_17_s2
Go_17_f302:
    buffer_load_dwordx4 v[44:47], v3, s[8:11], s40 offen offset:3072 sc1
    s_add_u32 s33, s33, 1
    s_cmp_gt_u32 s33, 0x100000
    s_cbranch_scc1 chain_kernel_abort
    s_branch Go_17_s023
Go_17_f02:
    buffer_load_dwordx4 v[32:35], v3, s[8:11], s40 offen offset:0 sc1
    s_add_u32 s33, s33, 1
    s_cmp_gt_u32 s33, 0x100000
    s_cbranch_scc1 chain_kernel_abort
    s_branch Go_17_s20
Go_17_s03:
    s_waitcnt vmcnt(1)
    v_cmp_eq_u32 vcc, -1, v32
    v_mov_b32_dpp v48, v32 row_ror:8 row_mask:0xf bank_mask:0xf
    v_mov_b32_dpp v49, v33 row_ror:8 row_mask:0xf bank_mask:0xf
    v_mov_b32_dpp v50, v34 row_ror:8 row_mask:0xf bank_mask:0xf
    v_mov_b32_dpp v51, v35 row_ror:8 row_mask:0xf bank_mask:0xf
    s_cbranch_vccnz Go_17_f03
    v_smfmac_f32_16x16x64_bf16 v[76:79], v[32:35], a[192:199], v19
    v_smfmac_f32_16x16x64_bf16 v[76:79], v[48:51], a[224:231], v19
    s_branch Go_17_s3
Go_17_f03:
    buffer_load_dwordx4 v[32:35], v3, s[8:11], s40 offen offset:0 sc1
    s_add_u32 s33, s33, 1
    s_cmp_gt_u32 s33, 0x100000
    s_cbranch_scc1 chain_kernel_abort
    s_branch Go_17_s30
Go_17_s312:
    s_waitcnt vmcnt(2)
    v_cmp_eq_u32 vcc, -1, v44
    v_mov_b32_dpp v60, v44 row_ror:8 row_mask:0xf bank_mask:0xf
    v_mov_b32_dpp v61, v45 row_ror:8 row_mask:0xf bank_mask:0xf
    v_mov_b32_dpp v62, v46 row_ror:8 row_mask:0xf bank_mask:0xf
    v_mov_b32_dpp v63, v47 row_ror:8 row_mask:0xf bank_mask:0xf
    s_cbranch_vccnz Go_17_f312
    v_smfmac_f32_16x16x64_bf16 v[76:79], v[44:47], a[216:223], v19
    v_smfmac_f32_16x16x64_bf16 v[76:79], v[60:63], a[248:255], v19
Go_17_s12:
    s_waitcnt vmcnt(1)
    v_cmp_eq_u32 vcc, -1, v36
    v_mov_b32_dpp v52, v36 row_ror:8 row_mask:0xf bank_mask:0xf
    v_mov_b32_dpp v53, v37 row_ror:8 row_mask:0xf bank_mask:0xf
    v_mov_b32_dpp v54, v38 row_ror:8 row_mask:0xf bank_mask:0xf
    v_mov_b32_dpp v55, v39 row_ror:8 row_mask:0xf bank_mask:0xf
    s_cbranch_vccnz Go_17_f12
    v_smfmac_f32_16x16x64_bf16 v[76:79], v[36:39], a[200:207], v19
    v_smfmac_f32_16x16x64_bf16 v[76:79], v[52:55], a[232:239], v19
    s_branch Go_17_s2
Go_17_f312:
    buffer_load_dwordx4 v[44:47], v3, s[8:11], s40 offen offset:3072 sc1
    s_add_u32 s33, s33, 1
    s_cmp_gt_u32 s33, 0x100000
    s_cbranch_scc1 chain_kernel_abort
    s_branch Go_17_s123
Go_17_f12:
    buffer_load_dwordx4 v[36:39], v3, s[8:11], s40 offen offset:1024 sc1
    s_add_u32 s33, s33, 1
    s_cmp_gt_u32 s33, 0x100000
    s_cbranch_scc1 chain_kernel_abort
    s_branch Go_17_s21
Go_17_s13:
    s_waitcnt vmcnt(1)
    v_cmp_eq_u32 vcc, -1, v36
    v_mov_b32_dpp v52, v36 row_ror:8 row_mask:0xf bank_mask:0xf
    v_mov_b32_dpp v53, v37 row_ror:8 row_mask:0xf bank_mask:0xf
    v_mov_b32_dpp v54, v38 row_ror:8 row_mask:0xf bank_mask:0xf
    v_mov_b32_dpp v55, v39 row_ror:8 row_mask:0xf bank_mask:0xf
    s_cbranch_vccnz Go_17_f13
    v_smfmac_f32_16x16x64_bf16 v[76:79], v[36:39], a[200:207], v19
    v_smfmac_f32_16x16x64_bf16 v[76:79], v[52:55], a[232:239], v19
    s_branch Go_17_s3
Go_17_f13:
    buffer_load_dwordx4 v[36:39], v3, s[8:11], s40 offen offset:1024 sc1
    s_add_u32 s33, s33, 1
    s_cmp_gt_u32 s33, 0x100000
    s_cbranch_scc1 chain_kernel_abort
    s_branch Go_17_s31
Go_17_s3012:
    s_waitcnt vmcnt(3)
    v_cmp_eq_u32 vcc, -1, v44
    v_mov_b32_dpp v60, v44 row_ror:8 row_mask:0xf bank_mask:0xf
    v_mov_b32_dpp v61, v45 row_ror:8 row_mask:0xf bank_mask:0xf
    v_mov_b32_dpp v62, v46 row_ror:8 row_mask:0xf bank_mask:0xf
    v_mov_b32_dpp v63, v47 row_ror:8 row_mask:0xf bank_mask:0xf
    s_cbranch_vccnz Go_17_f3012
    v_smfmac_f32_16x16x64_bf16 v[76:79], v[44:47], a[216:223], v19
    v_smfmac_f32_16x16x64_bf16 v[76:79], v[60:63], a[248:255], v19
Go_17_s012:
    s_waitcnt vmcnt(2)
    v_cmp_eq_u32 vcc, -1, v32
    v_mov_b32_dpp v48, v32 row_ror:8 row_mask:0xf bank_mask:0xf
    v_mov_b32_dpp v49, v33 row_ror:8 row_mask:0xf bank_mask:0xf
    v_mov_b32_dpp v50, v34 row_ror:8 row_mask:0xf bank_mask:0xf
    v_mov_b32_dpp v51, v35 row_ror:8 row_mask:0xf bank_mask:0xf
    s_cbranch_vccnz Go_17_f012
    v_smfmac_f32_16x16x64_bf16 v[76:79], v[32:35], a[192:199], v19
    v_smfmac_f32_16x16x64_bf16 v[76:79], v[48:51], a[224:231], v19
    s_branch Go_17_s12
Go_17_f3012:
    buffer_load_dwordx4 v[44:47], v3, s[8:11], s40 offen offset:3072 sc1
    s_add_u32 s33, s33, 1
    s_cmp_gt_u32 s33, 0x100000
    s_cbranch_scc1 chain_kernel_abort
    s_branch Go_17_s0123
Go_17_f012:
    buffer_load_dwordx4 v[32:35], v3, s[8:11], s40 offen offset:0 sc1
    s_add_u32 s33, s33, 1
    s_cmp_gt_u32 s33, 0x100000
    s_cbranch_scc1 chain_kernel_abort
    s_branch Go_17_s120
Go_17_s013:
    s_waitcnt vmcnt(2)
    v_cmp_eq_u32 vcc, -1, v32
    v_mov_b32_dpp v48, v32 row_ror:8 row_mask:0xf bank_mask:0xf
    v_mov_b32_dpp v49, v33 row_ror:8 row_mask:0xf bank_mask:0xf
    v_mov_b32_dpp v50, v34 row_ror:8 row_mask:0xf bank_mask:0xf
    v_mov_b32_dpp v51, v35 row_ror:8 row_mask:0xf bank_mask:0xf
    s_cbranch_vccnz Go_17_f013
    v_smfmac_f32_16x16x64_bf16 v[76:79], v[32:35], a[192:199], v19
    v_smfmac_f32_16x16x64_bf16 v[76:79], v[48:51], a[224:231], v19
    s_branch Go_17_s13
Go_17_f013:
    buffer_load_dwordx4 v[32:35], v3, s[8:11], s40 offen offset:0 sc1
    s_add_u32 s33, s33, 1
    s_cmp_gt_u32 s33, 0x100000
    s_cbranch_scc1 chain_kernel_abort
    s_branch Go_17_s130
Go_17_s10:
    s_waitcnt vmcnt(1)
    v_cmp_eq_u32 vcc, -1, v36
    v_mov_b32_dpp v52, v36 row_ror:8 row_mask:0xf bank_mask:0xf
    v_mov_b32_dpp v53, v37 row_ror:8 row_mask:0xf bank_mask:0xf
    v_mov_b32_dpp v54, v38 row_ror:8 row_mask:0xf bank_mask:0xf
    v_mov_b32_dpp v55, v39 row_ror:8 row_mask:0xf bank_mask:0xf
    s_cbranch_vccnz Go_17_f10
    v_smfmac_f32_16x16x64_bf16 v[76:79], v[36:39], a[200:207], v19
    v_smfmac_f32_16x16x64_bf16 v[76:79], v[52:55], a[232:239], v19
    s_branch Go_17_s0
Go_17_f10:
    buffer_load_dwordx4 v[36:39], v3, s[8:11], s40 offen offset:1024 sc1
    s_add_u32 s33, s33, 1
    s_cmp_gt_u32 s33, 0x100000
    s_cbranch_scc1 chain_kernel_abort
    s_branch Go_17_s01
Go_17_s023:
    s_waitcnt vmcnt(2)
    v_cmp_eq_u32 vcc, -1, v32
    v_mov_b32_dpp v48, v32 row_ror:8 row_mask:0xf bank_mask:0xf
    v_mov_b32_dpp v49, v33 row_ror:8 row_mask:0xf bank_mask:0xf
    v_mov_b32_dpp v50, v34 row_ror:8 row_mask:0xf bank_mask:0xf
    v_mov_b32_dpp v51, v35 row_ror:8 row_mask:0xf bank_mask:0xf
    s_cbranch_vccnz Go_17_f023
    v_smfmac_f32_16x16x64_bf16 v[76:79], v[32:35], a[192:199], v19
    v_smfmac_f32_16x16x64_bf16 v[76:79], v[48:51], a[224:231], v19
    s_branch Go_17_s23
Go_17_f023:
    buffer_load_dwordx4 v[32:35], v3, s[8:11], s40 offen offset:0 sc1
    s_add_u32 s33, s33, 1
    s_cmp_gt_u32 s33, 0x100000
    s_cbranch_scc1 chain_kernel_abort
    s_branch Go_17_s230
Go_17_s20:
    s_waitcnt vmcnt(1)
    v_cmp_eq_u32 vcc, -1, v40
    v_mov_b32_dpp v56, v40 row_ror:8 row_mask:0xf bank_mask:0xf
    v_mov_b32_dpp v57, v41 row_ror:8 row_mask:0xf bank_mask:0xf
    v_mov_b32_dpp v58, v42 row_ror:8 row_mask:0xf bank_mask:0xf
    v_mov_b32_dpp v59, v43 row_ror:8 row_mask:0xf bank_mask:0xf
    s_cbranch_vccnz Go_17_f20
    v_smfmac_f32_16x16x64_bf16 v[76:79], v[40:43], a[208:215], v19
    v_smfmac_f32_16x16x64_bf16 v[76:79], v[56:59], a[240:247], v19
    s_branch Go_17_s0
Go_17_f20:
    buffer_load_dwordx4 v[40:43], v3, s[8:11], s40 offen offset:2048 sc1
    s_add_u32 s33, s33, 1
    s_cmp_gt_u32 s33, 0x100000
    s_cbranch_scc1 chain_kernel_abort
    s_branch Go_17_s02
Go_17_s21:
    s_waitcnt vmcnt(1)
    v_cmp_eq_u32 vcc, -1, v40
    v_mov_b32_dpp v56, v40 row_ror:8 row_mask:0xf bank_mask:0xf
    v_mov_b32_dpp v57, v41 row_ror:8 row_mask:0xf bank_mask:0xf
    v_mov_b32_dpp v58, v42 row_ror:8 row_mask:0xf bank_mask:0xf
    v_mov_b32_dpp v59, v43 row_ror:8 row_mask:0xf bank_mask:0xf
    s_cbranch_vccnz Go_17_f21
    v_smfmac_f32_16x16x64_bf16 v[76:79], v[40:43], a[208:215], v19
    v_smfmac_f32_16x16x64_bf16 v[76:79], v[56:59], a[240:247], v19
    s_branch Go_17_s1
Go_17_f21:
    buffer_load_dwordx4 v[40:43], v3, s[8:11], s40 offen offset:2048 sc1
    s_add_u32 s33, s33, 1
    s_cmp_gt_u32 s33, 0x100000
    s_cbranch_scc1 chain_kernel_abort
    s_branch Go_17_s12
Go_17_s120:
    s_waitcnt vmcnt(2)
    v_cmp_eq_u32 vcc, -1, v36
    v_mov_b32_dpp v52, v36 row_ror:8 row_mask:0xf bank_mask:0xf
    v_mov_b32_dpp v53, v37 row_ror:8 row_mask:0xf bank_mask:0xf
    v_mov_b32_dpp v54, v38 row_ror:8 row_mask:0xf bank_mask:0xf
    v_mov_b32_dpp v55, v39 row_ror:8 row_mask:0xf bank_mask:0xf
    s_cbranch_vccnz Go_17_f120
    v_smfmac_f32_16x16x64_bf16 v[76:79], v[36:39], a[200:207], v19
    v_smfmac_f32_16x16x64_bf16 v[76:79], v[52:55], a[232:239], v19
    s_branch Go_17_s20
Go_17_f120:
    buffer_load_dwordx4 v[36:39], v3, s[8:11], s40 offen offset:1024 sc1
    s_add_u32 s33, s33, 1
    s_cmp_gt_u32 s33, 0x100000
    s_cbranch_scc1 chain_kernel_abort
    s_branch Go_17_s201
Go_17_s130:
    s_waitcnt vmcnt(2)
    v_cmp_eq_u32 vcc, -1, v36
    v_mov_b32_dpp v52, v36 row_ror:8 row_mask:0xf bank_mask:0xf
    v_mov_b32_dpp v53, v37 row_ror:8 row_mask:0xf bank_mask:0xf
    v_mov_b32_dpp v54, v38 row_ror:8 row_mask:0xf bank_mask:0xf
    v_mov_b32_dpp v55, v39 row_ror:8 row_mask:0xf bank_mask:0xf
    s_cbranch_vccnz Go_17_f130
    v_smfmac_f32_16x16x64_bf16 v[76:79], v[36:39], a[200:207], v19
    v_smfmac_f32_16x16x64_bf16 v[76:79], v[52:55], a[232:239], v19
    s_branch Go_17_s30
Go_17_f130:
    buffer_load_dwordx4 v[36:39], v3, s[8:11], s40 offen offset:1024 sc1
    s_add_u32 s33, s33, 1
    s_cmp_gt_u32 s33, 0x100000
    s_cbranch_scc1 chain_kernel_abort
    s_branch Go_17_s301
Go_17_s201:
    s_waitcnt vmcnt(2)
    v_cmp_eq_u32 vcc, -1, v40
    v_mov_b32_dpp v56, v40 row_ror:8 row_mask:0xf bank_mask:0xf
    v_mov_b32_dpp v57, v41 row_ror:8 row_mask:0xf bank_mask:0xf
    v_mov_b32_dpp v58, v42 row_ror:8 row_mask:0xf bank_mask:0xf
    v_mov_b32_dpp v59, v43 row_ror:8 row_mask:0xf bank_mask:0xf
    s_cbranch_vccnz Go_17_f201
    v_smfmac_f32_16x16x64_bf16 v[76:79], v[40:43], a[208:215], v19
    v_smfmac_f32_16x16x64_bf16 v[76:79], v[56:59], a[240:247], v19
    s_branch Go_17_s01
Go_17_f201:
    buffer_load_dwordx4 v[40:43], v3, s[8:11], s40 offen offset:2048 sc1
    s_add_u32 s33, s33, 1
    s_cmp_gt_u32 s33, 0x100000
    s_cbranch_scc1 chain_kernel_abort
    s_branch Go_17_s012
L_pf_22:
    s_mov_b64 exec, -1
    buffer_load_dword v220, v9, s[8:11], s43 offen sc1
    buffer_load_dword v221, v10, s[8:11], s43 offen sc1
    buffer_load_dword v222, v11, s[8:11], s43 offen sc1
    s_add_u32 s33, s33, 1
    s_cmp_gt_u32 s33, 0x100000
    s_cbranch_scc1 chain_kernel_abort
    s_branch L_pb1_20
L_pb1_20:
    s_waitcnt vmcnt(5)
    v_add_f32 v208, v80, v223
    s_waitcnt vmcnt(3)
    v_add_f32 v209, v224, v225
    v_max3_u32 v20, v223, v224, v225
    v_add_f32 v208, v208, v209
    v_cmp_eq_u32 vcc, -1, v20
    s_nop 0
    v_mov_b32_dpp v209, v208 quad_perm:[1,0,3,2] row_mask:0xf bank_mask:0xf
    s_mov_b64 exec, s[26:27]
    v_cvt_pk_bf16_f32 v208, v208, v209
    v_min_u32 v208, 0xfffffffe, v208
    s_cbranch_vccnz L_pf_23
    s_branch L_pd_21
L_pf_23:
    s_mov_b64 exec, -1
    buffer_load_dword v223, v9, s[8:11], s44 offen sc1
    buffer_load_dword v224, v10, s[8:11], s44 offen sc1
    buffer_load_dword v225, v11, s[8:11], s44 offen sc1
    s_add_u32 s33, s33, 1
    s_cmp_gt_u32 s33, 0x100000
    s_cbranch_scc1 chain_kernel_abort
    s_branch L_pa_18
L_pa_18:
    s_waitcnt vmcnt(5)
    v_add_f32 v208, v80, v220
    s_waitcnt vmcnt(3)
    v_add_f32 v209, v221, v222
    v_max3_u32 v20, v220, v221, v222
    v_add_f32 v208, v208, v209
    v_cmp_eq_u32 vcc, -1, v20
    s_nop 0
    v_mov_b32_dpp v209, v208 quad_perm:[1,0,3,2] row_mask:0xf bank_mask:0xf
    s_mov_b64 exec, s[26:27]
    v_cvt_pk_bf16_f32 v208, v208, v209
    v_min_u32 v208, 0xfffffffe, v208
    s_cbranch_vccnz L_pf_24
    s_branch L_pd_21
L_pf_24:
    s_mov_b64 exec, -1
    buffer_load_dword v220, v9, s[8:11], s43 offen sc1
    buffer_load_dword v221, v10, s[8:11], s43 offen sc1
    buffer_load_dword v222, v11, s[8:11], s43 offen sc1
    s_add_u32 s33, s33, 1
    s_cmp_gt_u32 s33, 0x100000
    s_cbranch_scc1 chain_kernel_abort
    s_branch L_pb_19
L_pb_19:
    s_waitcnt vmcnt(5)
    v_add_f32 v208, v80, v223
    s_waitcnt vmcnt(3)
    v_add_f32 v209, v224, v225
    v_max3_u32 v20, v223, v224, v225
    v_add_f32 v208, v208, v209
    v_cmp_eq_u32 vcc, -1, v20
    s_nop 0
    v_mov_b32_dpp v209, v208 quad_perm:[1,0,3,2] row_mask:0xf bank_mask:0xf
    s_mov_b64 exec, s[26:27]
    v_cvt_pk_bf16_f32 v208, v208, v209
    v_min_u32 v208, 0xfffffffe, v208
    s_cbranch_vccnz L_pf_25
    s_branch L_pd_21
L_pf_25:
    s_mov_b64 exec, -1
    buffer_load_dword v223, v9, s[8:11], s44 offen sc1
    buffer_load_dword v224, v10, s[8:11], s44 offen sc1
    buffer_load_dword v225, v11, s[8:11], s44 offen sc1
    s_add_u32 s33, s33, 1
    s_cmp_gt_u32 s33, 0x100000
    s_cbranch_scc1 chain_kernel_abort
    s_branch L_pa_18
chain_kernel_abort:
    s_mov_b32 s12, s98
    s_and_b32 s13, s99, 0xffff
    s_mov_b32 s14, 0x100
    s_mov_b32 s15, 0x00020000
    s_mov_b64 exec, 1
    v_mov_b32 v1, s19
    v_or_b32 v1, 0xdead0000, v1
    v_mov_b32 v2, 124
    buffer_store_dword v1, v2, s[12:15], 0 offen
chain_kernel_done:
    s_endpgm
chain_kernel_end:
    s_endpgm
chain_kernel_worker:
    s_sub_u32 s56, s16, 4
    s_mov_b32 s57, s17
    s_mov_b32 s58, s18
    s_cmp_lt_u32 s56, 2
    s_cbranch_scc1 L_big_37
    s_cmp_eq_u32 s56, 3
    s_cselect_b32 s12, s90, s88
    s_cselect_b32 s13, s91, s89
    s_and_b32 s13, s13, 0xffff
    s_mov_b32 s14, 0x800000
    s_mov_b32 s15, 0x00020000
    s_lshl_b32 s28, s57, 8
    v_bfe_u32 v24, v0, 4, 3
    v_lshlrev_b32 v24, 1, v24
    v_and_b32 v25, 15, v0
    v_xor_b32 v24, v24, v25
    v_lshlrev_b32 v6, 4, v24
    v_bfe_u32 v24, v0, 4, 2
    v_lshl_add_u32 v6, v24, 13, v6
    v_bfe_u32 v24, v0, 6, 1
    v_lshl_add_u32 v6, v24, 16, v6
    v_bfe_u32 v24, v0, 7, 1
    v_lshl_add_u32 v6, v24, 15, v6
    s_and_b32 s60, s58, 1
    s_lshl_b32 s61, s60, 11
    s_lshr_b32 s60, s58, 1
    s_lshl_b32 s60, s60, 10
    s_add_u32 s32, s60, s61
    s_add_u32 m0, s32, 0
    s_add_u32 s61, s28, 0x0
    buffer_load_dwordx4 v6, s[12:15], s61 offen nt lds
    s_add_u32 m0, s32, 4096
    s_add_u32 s61, s28, 0x20000
    buffer_load_dwordx4 v6, s[12:15], s61 offen nt lds
    s_add_u32 m0, s32, 8192
    s_add_u32 s61, s28, 0x40000
    buffer_load_dwordx4 v6, s[12:15], s61 offen nt lds
    s_add_u32 m0, s32, 12288
    s_add_u32 s61, s28, 0x60000
    buffer_load_dwordx4 v6, s[12:15], s61 offen nt lds
    s_add_u32 m0, s32, 16384
    s_add_u32 s61, s28, 0x80000
    buffer_load_dwordx4 v6, s[12:15], s61 offen nt lds
    s_add_u32 m0, s32, 20480
    s_add_u32 s61, s28, 0xa0000
    buffer_load_dwordx4 v6, s[12:15], s61 offen nt lds
    s_add_u32 m0, s32, 24576
    s_add_u32 s61, s28, 0xc0000
    buffer_load_dwordx4 v6, s[12:15], s61 offen nt lds
    s_add_u32 m0, s32, 28672
    s_add_u32 s61, s28, 0xe0000
    buffer_load_dwordx4 v6, s[12:15], s61 offen nt lds
    s_mov_b32 s8, s82
    s_and_b32 s9, s83, 0xffff
    s_mov_b32 s10, 0x400000
    s_mov_b32 s11, 0x00020000
    s_mov_b32 s16, s100
    s_and_b32 s17, s101, 0xffff
    s_mov_b32 s18, 0xa000000
    s_mov_b32 s19, 0x00020000
    v_and_b32 v24, 63, v0
    v_lshlrev_b32 v1, 4, v24
    v_add_u32 v12, 4096, v1
    v_lshlrev_b32 v10, 7, v24
    s_lshl_b32 s27, s57, 13
    s_and_b32 s60, s58, 1
    s_lshl_b32 s60, s60, 18
    s_add_u32 s60, s60, s27
    buffer_load_dword v13, v10, s[8:11], s60 offen
    s_add_u32 s27, s27, 0x80000
    s_add_u32 m0, s32, 32768
    s_add_u32 s61, s28, 0x100000
    buffer_load_dwordx4 v6, s[12:15], s61 offen nt lds
    s_add_u32 m0, s32, 36864
    s_add_u32 s61, s28, 0x120000
    buffer_load_dwordx4 v6, s[12:15], s61 offen nt lds
    s_add_u32 m0, s32, 40960
    s_add_u32 s61, s28, 0x140000
    buffer_load_dwordx4 v6, s[12:15], s61 offen nt lds
    s_add_u32 m0, s32, 45056
    s_add_u32 s61, s28, 0x160000
    buffer_load_dwordx4 v6, s[12:15], s61 offen nt lds
    s_add_u32 m0, s32, 49152
    s_add_u32 s61, s28, 0x180000
    buffer_load_dwordx4 v6, s[12:15], s61 offen nt lds
    s_add_u32 m0, s32, 53248
    s_add_u32 s61, s28, 0x1a0000
    buffer_load_dwordx4 v6, s[12:15], s61 offen nt lds
    s_add_u32 m0, s32, 57344
    s_add_u32 s61, s28, 0x1c0000
    buffer_load_dwordx4 v6, s[12:15], s61 offen nt lds
    s_add_u32 m0, s32, 61440
    s_add_u32 s61, s28, 0x1e0000
    buffer_load_dwordx4 v6, s[12:15], s61 offen nt lds
    s_add_u32 m0, s32, 65536
    s_add_u32 s61, s28, 0x200000
    buffer_load_dwordx4 v6, s[12:15], s61 offen nt lds
    s_add_u32 m0, s32, 69632
    s_add_u32 s61, s28, 0x220000
    buffer_load_dwordx4 v6, s[12:15], s61 offen nt lds
    s_add_u32 m0, s32, 73728
    s_add_u32 s61, s28, 0x240000
    buffer_load_dwordx4 v6, s[12:15], s61 offen nt lds
    s_add_u32 m0, s32, 77824
    s_add_u32 s61, s28, 0x260000
    buffer_load_dwordx4 v6, s[12:15], s61 offen nt lds
    s_add_u32 m0, s32, 81920
    s_add_u32 s61, s28, 0x280000
    buffer_load_dwordx4 v6, s[12:15], s61 offen nt lds
    s_add_u32 m0, s32, 86016
    s_add_u32 s61, s28, 0x2a0000
    buffer_load_dwordx4 v6, s[12:15], s61 offen nt lds
    s_add_u32 m0, s32, 90112
    s_add_u32 s61, s28, 0x2c0000
    buffer_load_dwordx4 v6, s[12:15], s61 offen nt lds
    s_add_u32 m0, s32, 94208
    s_add_u32 s61, s28, 0x2e0000
    buffer_load_dwordx4 v6, s[12:15], s61 offen nt lds
    s_add_u32 m0, s32, 98304
    s_add_u32 s61, s28, 0x300000
    buffer_load_dwordx4 v6, s[12:15], s61 offen nt lds
    s_add_u32 m0, s32, 102400
    s_add_u32 s61, s28, 0x320000
    buffer_load_dwordx4 v6, s[12:15], s61 offen nt lds
    s_add_u32 m0, s32, 106496
    s_add_u32 s61, s28, 0x340000
    buffer_load_dwordx4 v6, s[12:15], s61 offen nt lds
    s_add_u32 m0, s32, 110592
    s_add_u32 s61, s28, 0x360000
    buffer_load_dwordx4 v6, s[12:15], s61 offen nt lds
    s_add_u32 m0, s32, 114688
    s_add_u32 s61, s28, 0x380000
    buffer_load_dwordx4 v6, s[12:15], s61 offen nt lds
    s_add_u32 m0, s32, 118784
    s_add_u32 s61, s28, 0x3a0000
    buffer_load_dwordx4 v6, s[12:15], s61 offen nt lds
    s_add_u32 m0, s32, 122880
    s_add_u32 s61, s28, 0x3c0000
    buffer_load_dwordx4 v6, s[12:15], s61 offen nt lds
    s_add_u32 m0, s32, 126976
    s_add_u32 s61, s28, 0x3e0000
    buffer_load_dwordx4 v6, s[12:15], s61 offen nt lds
    s_add_u32 m0, s32, 131072
    s_add_u32 s61, s28, 0x400000
    buffer_load_dwordx4 v6, s[12:15], s61 offen nt lds
    s_add_u32 m0, s32, 135168
    s_add_u32 s61, s28, 0x420000
    buffer_load_dwordx4 v6, s[12:15], s61 offen nt lds
    s_add_u32 m0, s32, 139264
    s_add_u32 s61, s28, 0x440000
    buffer_load_dwordx4 v6, s[12:15], s61 offen nt lds
    s_add_u32 m0, s32, 143360
    s_add_u32 s61, s28, 0x460000
    buffer_load_dwordx4 v6, s[12:15], s61 offen nt lds
    s_add_u32 m0, s32, 147456
    s_add_u32 s61, s28, 0x480000
    buffer_load_dwordx4 v6, s[12:15], s61 offen nt lds
    s_add_u32 m0, s32, 151552
    s_add_u32 s61, s28, 0x4a0000
    buffer_load_dwordx4 v6, s[12:15], s61 offen nt lds
    s_add_u32 m0, s32, 155648
    s_add_u32 s61, s28, 0x4c0000
    buffer_load_dwordx4 v6, s[12:15], s61 offen nt lds
    s_add_u32 m0, s32, 159744
    s_add_u32 s61, s28, 0x4e0000
    buffer_load_dwordx4 v6, s[12:15], s61 offen nt lds
    v_bfe_u32 v24, v0, 4, 3
    v_and_b32 v25, 7, v0
    v_xor_b32 v24, v24, v25
    v_lshlrev_b32 v2, 4, v24
    v_lshrrev_b32 v24, 3, v0
    v_lshl_add_u32 v2, v24, 11, v2
    v_bfe_u32 v24, v0, 1, 3
    v_bfe_u32 v25, v0, 4, 2
    v_xor_b32 v24, v24, v25
    v_lshlrev_b32 v4, 4, v24
    v_and_b32 v25, 15, v0
    v_lshl_add_u32 v4, v25, 7, v4
    v_add_u32 v4, 98304, v4
    v_xor_b32 v5, 64, v4
    v_bfe_u32 v24, v0, 2, 3
    v_lshrrev_b32 v25, 6, v0
    v_lshlrev_b32 v25, 1, v25
    v_xor_b32 v24, v24, v25
    v_lshlrev_b32 v8, 5, v24
    v_bfe_u32 v24, v0, 0, 2
    v_lshl_add_u32 v8, v24, 3, v8
    v_bfe_u32 v24, v0, 2, 2
    v_lshl_add_u32 v8, v24, 8, v8
    v_bfe_u32 v24, v0, 4, 2
    v_lshl_add_u32 v8, v24, 11, v8
    v_xor_b32 v9, 32, v8
    v_mov_b32 v28, -1
    v_mov_b32 v29, -1
    v_mov_b32 v30, -1
    v_mov_b32 v31, -1
    s_lshl_b32 s20, s58, 10
    s_add_u32 s20, s20, 98304
    s_mov_b32 s21, 98304
    s_mov_b32 s23, 0
    s_mov_b32 s29, 32768
    s_lshl_b32 s30, s57, 15
    s_cmp_eq_u32 s56, 3
    s_cselect_b32 s60, 11, 10
    s_cselect_b32 s61, 0x4000, 0
    s_lshl_b32 s60, s58, s60
    s_add_u32 s30, s30, s60
    s_add_u32 s30, s30, s61
    s_lshl_b32 s31, s57, 14
    s_lshr_b32 s61, s61, 2
    s_add_u32 s31, s31, s61
    s_lshl_b32 s60, s58, 10
    s_add_u32 s31, s31, s60
    s_add_u32 s31, s31, 0x8000000
    s_waitcnt vmcnt(33)
    s_barrier
    ds_read_b64_tr_b16 a[0:1], v8 offset:0
    ds_read_b64_tr_b16 a[2:3], v8 offset:1024
    ds_read_b64_tr_b16 a[4:5], v9 offset:0
    ds_read_b64_tr_b16 a[6:7], v9 offset:1024
    ds_read_b64_tr_b16 a[8:9], v8 offset:8192
    ds_read_b64_tr_b16 a[10:11], v8 offset:9216
    ds_read_b64_tr_b16 a[12:13], v9 offset:8192
    ds_read_b64_tr_b16 a[14:15], v9 offset:9216
    s_waitcnt lgkmcnt(0)
    ds_read_b64_tr_b16 a[16:17], v8 offset:16384
    ds_read_b64_tr_b16 a[18:19], v8 offset:17408
    ds_read_b64_tr_b16 a[20:21], v9 offset:16384
    ds_read_b64_tr_b16 a[22:23], v9 offset:17408
    ds_read_b64_tr_b16 a[24:25], v8 offset:24576
    ds_read_b64_tr_b16 a[26:27], v8 offset:25600
    ds_read_b64_tr_b16 a[28:29], v9 offset:24576
    ds_read_b64_tr_b16 a[30:31], v9 offset:25600
    s_waitcnt lgkmcnt(0)
    s_waitcnt vmcnt(24)
    s_barrier
    s_add_u32 m0, s32, 0
    s_add_u32 s61, s28, 0x500000
    buffer_load_dwordx4 v6, s[12:15], s61 offen nt lds
    s_add_u32 m0, s32, 4096
    s_add_u32 s61, s28, 0x520000
    buffer_load_dwordx4 v6, s[12:15], s61 offen nt lds
    s_add_u32 m0, s32, 8192
    s_add_u32 s61, s28, 0x540000
    buffer_load_dwordx4 v6, s[12:15], s61 offen nt lds
    s_add_u32 m0, s32, 12288
    s_add_u32 s61, s28, 0x560000
    buffer_load_dwordx4 v6, s[12:15], s61 offen nt lds
    s_add_u32 m0, s32, 16384
    s_add_u32 s61, s28, 0x580000
    buffer_load_dwordx4 v6, s[12:15], s61 offen nt lds
    s_add_u32 m0, s32, 20480
    s_add_u32 s61, s28, 0x5a0000
    buffer_load_dwordx4 v6, s[12:15], s61 offen nt lds
    s_add_u32 m0, s32, 24576
    s_add_u32 s61, s28, 0x5c0000
    buffer_load_dwordx4 v6, s[12:15], s61 offen nt lds
    s_add_u32 m0, s32, 28672
    s_add_u32 s61, s28, 0x5e0000
    buffer_load_dwordx4 v6, s[12:15], s61 offen nt lds
    ds_read_b64_tr_b16 a[32:33], v8 offset:32768
    ds_read_b64_tr_b16 a[34:35], v8 offset:33792
    ds_read_b64_tr_b16 a[36:37], v9 offset:32768
    ds_read_b64_tr_b16 a[38:39], v9 offset:33792
    ds_read_b64_tr_b16 a[40:41], v8 offset:40960
    ds_read_b64_tr_b16 a[42:43], v8 offset:41984
    ds_read_b64_tr_b16 a[44:45], v9 offset:40960
    ds_read_b64_tr_b16 a[46:47], v9 offset:41984
    s_waitcnt lgkmcnt(0)
    ds_read_b64_tr_b16 a[48:49], v8 offset:49152
    ds_read_b64_tr_b16 a[50:51], v8 offset:50176
    ds_read_b64_tr_b16 a[52:53], v9 offset:49152
    ds_read_b64_tr_b16 a[54:55], v9 offset:50176
    ds_read_b64_tr_b16 a[56:57], v8 offset:57344
    ds_read_b64_tr_b16 a[58:59], v8 offset:58368
    ds_read_b64_tr_b16 a[60:61], v9 offset:57344
    ds_read_b64_tr_b16 a[62:63], v9 offset:58368
    s_waitcnt lgkmcnt(0)
    s_waitcnt vmcnt(24)
    s_barrier
    s_add_u32 m0, s32, 32768
    s_add_u32 s61, s28, 0x600000
    buffer_load_dwordx4 v6, s[12:15], s61 offen nt lds
    s_add_u32 m0, s32, 36864
    s_add_u32 s61, s28, 0x620000
    buffer_load_dwordx4 v6, s[12:15], s61 offen nt lds
    s_add_u32 m0, s32, 40960
    s_add_u32 s61, s28, 0x640000
    buffer_load_dwordx4 v6, s[12:15], s61 offen nt lds
    s_add_u32 m0, s32, 45056
    s_add_u32 s61, s28, 0x660000
    buffer_load_dwordx4 v6, s[12:15], s61 offen nt lds
    s_add_u32 m0, s32, 49152
    s_add_u32 s61, s28, 0x680000
    buffer_load_dwordx4 v6, s[12:15], s61 offen nt lds
    s_add_u32 m0, s32, 53248
    s_add_u32 s61, s28, 0x6a0000
    buffer_load_dwordx4 v6, s[12:15], s61 offen nt lds
    s_add_u32 m0, s32, 57344
    s_add_u32 s61, s28, 0x6c0000
    buffer_load_dwordx4 v6, s[12:15], s61 offen nt lds
    s_add_u32 m0, s32, 61440
    s_add_u32 s61, s28, 0x6e0000
    buffer_load_dwordx4 v6, s[12:15], s61 offen nt lds
    v_add_u32 v8, 0x10000, v8
    v_add_u32 v9, 0x10000, v9
    ds_read_b64_tr_b16 a[64:65], v8 offset:0
    ds_read_b64_tr_b16 a[66:67], v8 offset:1024
    ds_read_b64_tr_b16 a[68:69], v9 offset:0
    ds_read_b64_tr_b16 a[70:71], v9 offset:1024
    ds_read_b64_tr_b16 a[72:73], v8 offset:8192
    ds_read_b64_tr_b16 a[74:75], v8 offset:9216
    ds_read_b64_tr_b16 a[76:77], v9 offset:8192
    ds_read_b64_tr_b16 a[78:79], v9 offset:9216
    s_waitcnt lgkmcnt(0)
    ds_read_b64_tr_b16 a[80:81], v8 offset:16384
    ds_read_b64_tr_b16 a[82:83], v8 offset:17408
    ds_read_b64_tr_b16 a[84:85], v9 offset:16384
    ds_read_b64_tr_b16 a[86:87], v9 offset:17408
    ds_read_b64_tr_b16 a[88:89], v8 offset:24576
    ds_read_b64_tr_b16 a[90:91], v8 offset:25600
    ds_read_b64_tr_b16 a[92:93], v9 offset:24576
    ds_read_b64_tr_b16 a[94:95], v9 offset:25600
    s_waitcnt lgkmcnt(0)
    s_waitcnt vmcnt(24)
    s_barrier
    s_add_u32 m0, s32, 65536
    s_add_u32 s61, s28, 0x700000
    buffer_load_dwordx4 v6, s[12:15], s61 offen nt lds
    s_add_u32 m0, s32, 69632
    s_add_u32 s61, s28, 0x720000
    buffer_load_dwordx4 v6, s[12:15], s61 offen nt lds
    s_add_u32 m0, s32, 73728
    s_add_u32 s61, s28, 0x740000
    buffer_load_dwordx4 v6, s[12:15], s61 offen nt lds
    s_add_u32 m0, s32, 77824
    s_add_u32 s61, s28, 0x760000
    buffer_load_dwordx4 v6, s[12:15], s61 offen nt lds
    s_add_u32 m0, s32, 81920
    s_add_u32 s61, s28, 0x780000
    buffer_load_dwordx4 v6, s[12:15], s61 offen nt lds
    s_add_u32 m0, s32, 86016
    s_add_u32 s61, s28, 0x7a0000
    buffer_load_dwordx4 v6, s[12:15], s61 offen nt lds
    s_add_u32 m0, s32, 90112
    s_add_u32 s61, s28, 0x7c0000
    buffer_load_dwordx4 v6, s[12:15], s61 offen nt lds
    s_add_u32 m0, s32, 94208
    s_add_u32 s61, s28, 0x7e0000
    buffer_load_dwordx4 v6, s[12:15], s61 offen nt lds
    v_mov_b32 v24, 4
    global_load_dword v11, v24, s[98:99] sc1
    ds_read_b64_tr_b16 a[96:97], v8 offset:32768
    ds_read_b64_tr_b16 a[98:99], v8 offset:33792
    ds_read_b64_tr_b16 a[100:101], v9 offset:32768
    ds_read_b64_tr_b16 a[102:103], v9 offset:33792
    ds_read_b64_tr_b16 a[104:105], v8 offset:40960
    ds_read_b64_tr_b16 a[106:107], v8 offset:41984
    ds_read_b64_tr_b16 a[108:109], v9 offset:40960
    ds_read_b64_tr_b16 a[110:111], v9 offset:41984
    s_waitcnt lgkmcnt(0)
    ds_read_b64_tr_b16 a[112:113], v8 offset:49152
    ds_read_b64_tr_b16 a[114:115], v8 offset:50176
    ds_read_b64_tr_b16 a[116:117], v9 offset:49152
    ds_read_b64_tr_b16 a[118:119], v9 offset:50176
    ds_read_b64_tr_b16 a[120:121], v8 offset:57344
    ds_read_b64_tr_b16 a[122:123], v8 offset:58368
    ds_read_b64_tr_b16 a[124:125], v9 offset:57344
    ds_read_b64_tr_b16 a[126:127], v9 offset:58368
    s_waitcnt lgkmcnt(0)
    s_waitcnt vmcnt(24)
    s_barrier
    s_add_u32 m0, s20, 0
    s_nop 0
    buffer_load_dwordx4 v2, s[8:11], s23 offen offset:0 lds
    s_add_u32 m0, s20, 3968
    s_nop 0
    buffer_load_dwordx4 v2, s[8:11], s23 offen offset:128 lds
    s_add_u32 m0, s20, 7936
    s_nop 0
    buffer_load_dwordx4 v2, s[8:11], s23 offen offset:256 lds
    s_add_u32 m0, s20, 11904
    s_nop 0
    buffer_load_dwordx4 v2, s[8:11], s23 offen offset:384 lds
    s_add_u32 m0, s20, 15872
    s_nop 0
    buffer_load_dwordx4 v2, s[8:11], s23 offen offset:512 lds
    s_add_u32 m0, s20, 19840
    s_nop 0
    buffer_load_dwordx4 v2, s[8:11], s23 offen offset:640 lds
    s_add_u32 m0, s20, 23808
    s_nop 0
    buffer_load_dwordx4 v2, s[8:11], s23 offen offset:768 lds
    s_add_u32 m0, s20, 27776
    s_nop 0
    buffer_load_dwordx4 v2, s[8:11], s23 offen offset:896 lds
    s_add_u32 s23, s23, 1024
    s_bitcmp1_b32 s23, 11
    s_cselect_b32 s60, 0xf800, 0
    s_add_u32 s23, s23, s60
    s_add_u32 s20, s20, 32768
    s_cmp_ge_u32 s20, 163840
    s_cselect_b32 s60, 163840, 0
    s_sub_u32 s20, s20, s60
    v_add_u32 v8, 0x10000, v8
    v_add_u32 v9, 0x10000, v9
    ds_read_b64_tr_b16 a[128:129], v8 offset:0
    ds_read_b64_tr_b16 a[130:131], v8 offset:1024
    ds_read_b64_tr_b16 a[132:133], v9 offset:0
    ds_read_b64_tr_b16 a[134:135], v9 offset:1024
    ds_read_b64_tr_b16 a[136:137], v8 offset:8192
    ds_read_b64_tr_b16 a[138:139], v8 offset:9216
    ds_read_b64_tr_b16 a[140:141], v9 offset:8192
    ds_read_b64_tr_b16 a[142:143], v9 offset:9216
    s_waitcnt lgkmcnt(0)
    ds_read_b64_tr_b16 a[144:145], v8 offset:16384
    ds_read_b64_tr_b16 a[146:147], v8 offset:17408
    ds_read_b64_tr_b16 a[148:149], v9 offset:16384
    ds_read_b64_tr_b16 a[150:151], v9 offset:17408
    ds_read_b64_tr_b16 a[152:153], v8 offset:24576
    ds_read_b64_tr_b16 a[154:155], v8 offset:25600
    ds_read_b64_tr_b16 a[156:157], v9 offset:24576
    ds_read_b64_tr_b16 a[158:159], v9 offset:25600
    s_waitcnt lgkmcnt(0)
    s_waitcnt vmcnt(24)
    s_barrier
    s_add_u32 m0, s20, 0
    s_nop 0
    buffer_load_dwordx4 v2, s[8:11], s23 offen offset:0 lds
    s_add_u32 m0, s20, 3968
    s_nop 0
    buffer_load_dwordx4 v2, s[8:11], s23 offen offset:128 lds
    s_add_u32 m0, s20, 7936
    s_nop 0
    buffer_load_dwordx4 v2, s[8:11], s23 offen offset:256 lds
    s_add_u32 m0, s20, 11904
    s_nop 0
    buffer_load_dwordx4 v2, s[8:11], s23 offen offset:384 lds
    s_add_u32 m0, s20, 15872
    s_nop 0
    buffer_load_dwordx4 v2, s[8:11], s23 offen offset:512 lds
    s_add_u32 m0, s20, 19840
    s_nop 0
    buffer_load_dwordx4 v2, s[8:11], s23 offen offset:640 lds
    s_add_u32 m0, s20, 23808
    s_nop 0
    buffer_load_dwordx4 v2, s[8:11], s23 offen offset:768 lds
    s_add_u32 m0, s20, 27776
    s_nop 0
    buffer_load_dwordx4 v2, s[8:11], s23 offen offset:896 lds
    s_add_u32 s23, s23, 1024
    s_bitcmp1_b32 s23, 11
    s_cselect_b32 s60, 0xf800, 0
    s_add_u32 s23, s23, s60
    s_add_u32 s20, s20, 32768
    s_cmp_ge_u32 s20, 163840
    s_cselect_b32 s60, 163840, 0
    s_sub_u32 s20, s20, s60
    v_add_u32 v8, 0xfffe0000, v8
    v_add_u32 v9, 0xfffe0000, v9
    ds_read_b64_tr_b16 a[160:161], v8 offset:0
    ds_read_b64_tr_b16 a[162:163], v8 offset:1024
    ds_read_b64_tr_b16 a[164:165], v9 offset:0
    ds_read_b64_tr_b16 a[166:167], v9 offset:1024
    ds_read_b64_tr_b16 a[168:169], v8 offset:8192
    ds_read_b64_tr_b16 a[170:171], v8 offset:9216
    ds_read_b64_tr_b16 a[172:173], v9 offset:8192
    ds_read_b64_tr_b16 a[174:175], v9 offset:9216
    s_waitcnt lgkmcnt(0)
    ds_read_b64_tr_b16 a[176:177], v8 offset:16384
    ds_read_b64_tr_b16 a[178:179], v8 offset:17408
    ds_read_b64_tr_b16 a[180:181], v9 offset:16384
    ds_read_b64_tr_b16 a[182:183], v9 offset:17408
    ds_read_b64_tr_b16 a[184:185], v8 offset:24576
    ds_read_b64_tr_b16 a[186:187], v8 offset:25600
    ds_read_b64_tr_b16 a[188:189], v9 offset:24576
    ds_read_b64_tr_b16 a[190:191], v9 offset:25600
    s_waitcnt lgkmcnt(0)
    s_waitcnt vmcnt(24)
    s_barrier
    s_add_u32 m0, s20, 0
    s_nop 0
    buffer_load_dwordx4 v2, s[8:11], s23 offen offset:0 lds
    s_add_u32 m0, s20, 3968
    s_nop 0
    buffer_load_dwordx4 v2, s[8:11], s23 offen offset:128 lds
    s_add_u32 m0, s20, 7936
    s_nop 0
    buffer_load_dwordx4 v2, s[8:11], s23 offen offset:256 lds
    s_add_u32 m0, s20, 11904
    s_nop 0
    buffer_load_dwordx4 v2, s[8:11], s23 offen offset:384 lds
    s_add_u32 m0, s20, 15872
    s_nop 0
    buffer_load_dwordx4 v2, s[8:11], s23 offen offset:512 lds
    s_add_u32 m0, s20, 19840
    s_nop 0
    buffer_load_dwordx4 v2, s[8:11], s23 offen offset:640 lds
    s_add_u32 m0, s20, 23808
    s_nop 0
    buffer_load_dwordx4 v2, s[8:11], s23 offen offset:768 lds
    s_add_u32 m0, s20, 27776
    s_nop 0
    buffer_load_dwordx4 v2, s[8:11], s23 offen offset:896 lds
    s_add_u32 s23, s23, 1024
    s_bitcmp1_b32 s23, 11
    s_cselect_b32 s60, 0xf800, 0
    s_add_u32 s23, s23, s60
    s_add_u32 s20, s20, 32768
    s_cmp_ge_u32 s20, 163840
    s_cselect_b32 s60, 163840, 0
    s_sub_u32 s20, s20, s60
    ds_read_b64_tr_b16 a[192:193], v8 offset:32768
    ds_read_b64_tr_b16 a[194:195], v8 offset:33792
    ds_read_b64_tr_b16 a[196:197], v9 offset:32768
    ds_read_b64_tr_b16 a[198:199], v9 offset:33792
    ds_read_b64_tr_b16 a[200:201], v8 offset:40960
    ds_read_b64_tr_b16 a[202:203], v8 offset:41984
    ds_read_b64_tr_b16 a[204:205], v9 offset:40960
    ds_read_b64_tr_b16 a[206:207], v9 offset:41984
    s_waitcnt lgkmcnt(0)
    ds_read_b64_tr_b16 a[208:209], v8 offset:49152
    ds_read_b64_tr_b16 a[210:211], v8 offset:50176
    ds_read_b64_tr_b16 a[212:213], v9 offset:49152
    ds_read_b64_tr_b16 a[214:215], v9 offset:50176
    ds_read_b64_tr_b16 a[216:217], v8 offset:57344
    ds_read_b64_tr_b16 a[218:219], v8 offset:58368
    ds_read_b64_tr_b16 a[220:221], v9 offset:57344
    ds_read_b64_tr_b16 a[222:223], v9 offset:58368
    s_waitcnt lgkmcnt(0)
    s_waitcnt vmcnt(24)
    s_barrier
    v_add_u32 v8, 0x10000, v8
    v_add_u32 v9, 0x10000, v9
    ds_read_b64_tr_b16 a[224:225], v8 offset:0
    ds_read_b64_tr_b16 a[226:227], v8 offset:1024
    ds_read_b64_tr_b16 a[228:229], v9 offset:0
    ds_read_b64_tr_b16 a[230:231], v9 offset:1024
    ds_read_b64_tr_b16 a[232:233], v8 offset:8192
    ds_read_b64_tr_b16 a[234:235], v8 offset:9216
    ds_read_b64_tr_b16 a[236:237], v9 offset:8192
    ds_read_b64_tr_b16 a[238:239], v9 offset:9216
    s_waitcnt lgkmcnt(0)
    ds_read_b64_tr_b16 a[240:241], v8 offset:16384
    ds_read_b64_tr_b16 a[242:243], v8 offset:17408
    ds_read_b64_tr_b16 a[244:245], v9 offset:16384
    ds_read_b64_tr_b16 a[246:247], v9 offset:17408
    ds_read_b64_tr_b16 a[248:249], v8 offset:24576
    ds_read_b64_tr_b16 a[250:251], v8 offset:25600
    ds_read_b64_tr_b16 a[252:253], v9 offset:24576
    ds_read_b64_tr_b16 a[254:255], v9 offset:25600
    s_waitcnt lgkmcnt(0)
    s_waitcnt vmcnt(16)
    s_barrier
    s_mov_b32 s62, 0
L_pp_38:
    v_readfirstlane_b32 s59, v11
    s_and_b32 s60, s59, 0xff
    s_cmp_ge_u32 s60, 15
    s_cbranch_scc1 L_pok_39
    v_mov_b32 v24, 4
    global_load_dword v11, v24, s[98:99] sc1
    s_add_u32 s62, s62, 1
    s_cmp_gt_u32 s62, 0x200000
    s_cbranch_scc1 chain_kernel_wabort
    s_waitcnt vmcnt(0)
    s_branch L_pp_38
L_pok_39:
    s_cmp_ge_u32 s59, 0x800
    s_cselect_b32 s59, 0x2000, 0
    s_xor_b32 s31, s31, s59
    s_xor_b32 s30, s30, s59
    s_lshr_b32 s60, s57, 1
    s_lshl_b32 s60, s60, 14
    s_and_b32 s61, s57, 1
    s_lshl2_add_u32 s61, s61, s58
    s_lshl_b32 s61, s61, 10
    s_add_u32 s60, s60, s61
    s_xor_b32 s61, s59, 0x2000
    s_add_u32 s60, s60, s61
    s_add_u32 s60, s60, 0x57c0000
    buffer_store_dwordx4 v[28:31], v1, s[16:19], s60 offen sc1
    s_mov_b32 s24, 0
    s_mov_b32 s18, 0
    s_cmp_eq_u32 s56, 3
    s_cbranch_scc1 L_kvv_40
    ds_read_b128 v[72:75], v4 offset:0
    ds_read_b128 v[76:79], v4 offset:2048
    ds_read_b128 v[80:83], v5 offset:0
    ds_read_b128 v[84:87], v5 offset:2048
    ds_read_b128 v[88:91], v4 offset:4096
    ds_read_b128 v[92:95], v4 offset:6144
    s_mov_b32 s34, 0x808088a8
    s_mov_b32 s35, 0x40808080
    s_cmp_eq_u32 s58, 0
    s_cselect_b32 s33, s27, 0x400000
    s_mov_b32 s25, 0
    s_mov_b32 s26, 0
kvsk:
    s_waitcnt lgkmcnt(4)
    v_mfma_f32_16x16x32_bf16 v[32:35], a[0:3], v[72:75], 0
    ds_read_b128 v[96:99], v5 offset:4096
    v_mfma_f32_16x16x32_bf16 v[36:39], a[4:7], v[72:75], 0
    ds_read_b128 v[100:103], v5 offset:6144
    v_mfma_f32_16x16x32_bf16 v[44:47], a[4:7], v[76:79], 0
    v_mfma_f32_16x16x32_bf16 v[40:43], a[0:3], v[76:79], 0
    v_cvt_pk_bf16_f32 v64, v48, v49
    s_waitcnt lgkmcnt(4)
    v_mfma_f32_16x16x32_bf16 v[32:35], a[8:11], v[80:83], v[32:35]
    ds_read_b128 v[72:75], v4 offset:8192
    v_cvt_pk_bf16_f32 v65, v50, v51
    v_mfma_f32_16x16x32_bf16 v[36:39], a[12:15], v[80:83], v[36:39]
    ds_read_b128 v[76:79], v4 offset:10240
    v_cvt_pk_bf16_f32 v66, v52, v53
    v_mfma_f32_16x16x32_bf16 v[44:47], a[12:15], v[84:87], v[44:47]
    v_cvt_pk_bf16_f32 v67, v54, v55
    v_cvt_pk_bf16_f32 v68, v56, v57
    v_mfma_f32_16x16x32_bf16 v[40:43], a[8:11], v[84:87], v[40:43]
    v_cvt_pk_bf16_f32 v69, v58, v59
    s_waitcnt lgkmcnt(4)
    v_mfma_f32_16x16x32_bf16 v[32:35], a[16:19], v[88:91], v[32:35]
    ds_read_b128 v[80:83], v5 offset:8192
    v_cvt_pk_bf16_f32 v70, v60, v61
    v_mfma_f32_16x16x32_bf16 v[36:39], a[20:23], v[88:91], v[36:39]
    ds_read_b128 v[84:87], v5 offset:10240
    v_cvt_pk_bf16_f32 v71, v62, v63
    v_mfma_f32_16x16x32_bf16 v[44:47], a[20:23], v[92:95], v[44:47]
    buffer_store_dwordx4 v[64:67], v1, s[16:19], s25 offen sc1
    v_mfma_f32_16x16x32_bf16 v[40:43], a[16:19], v[92:95], v[40:43]
    s_waitcnt lgkmcnt(4)
    v_mfma_f32_16x16x32_bf16 v[32:35], a[24:27], v[96:99], v[32:35]
    ds_read_b128 v[88:91], v4 offset:12288
    buffer_store_dwordx4 v[68:71], v12, s[16:19], s25 offen sc1
    v_mfma_f32_16x16x32_bf16 v[36:39], a[28:31], v[96:99], v[36:39]
    ds_read_b128 v[92:95], v4 offset:14336
    v_mfma_f32_16x16x32_bf16 v[44:47], a[28:31], v[100:103], v[44:47]
    v_mfma_f32_16x16x32_bf16 v[40:43], a[24:27], v[100:103], v[40:43]
    s_waitcnt lgkmcnt(4)
    v_mfma_f32_16x16x32_bf16 v[32:35], a[32:35], v[72:75], v[32:35]
    ds_read_b128 v[96:99], v5 offset:12288
    buffer_store_dwordx4 v[28:31], v1, s[16:19], s26 offen sc1
    v_mfma_f32_16x16x32_bf16 v[36:39], a[36:39], v[72:75], v[36:39]
    ds_read_b128 v[100:103], v5 offset:14336
    buffer_load_dword v13, v10, s[8:11], s33 offen
    v_mfma_f32_16x16x32_bf16 v[44:47], a[36:39], v[76:79], v[44:47]
    v_mfma_f32_16x16x32_bf16 v[40:43], a[32:35], v[76:79], v[40:43]
    s_waitcnt lgkmcnt(4)
    v_mfma_f32_16x16x32_bf16 v[32:35], a[40:43], v[80:83], v[32:35]
    ds_read_b128 v[72:75], v4 offset:16384
    v_mfma_f32_16x16x32_bf16 v[36:39], a[44:47], v[80:83], v[36:39]
    ds_read_b128 v[76:79], v4 offset:18432
    v_mfma_f32_16x16x32_bf16 v[44:47], a[44:47], v[84:87], v[44:47]
    s_add_u32 m0, s20, 0
    v_mfma_f32_16x16x32_bf16 v[40:43], a[40:43], v[84:87], v[40:43]
    buffer_load_dwordx4 v2, s[8:11], s23 offen offset:0 lds
    s_waitcnt lgkmcnt(4)
    v_mfma_f32_16x16x32_bf16 v[32:35], a[48:51], v[88:91], v[32:35]
    ds_read_b128 v[80:83], v5 offset:16384
    v_mfma_f32_16x16x32_bf16 v[36:39], a[52:55], v[88:91], v[36:39]
    ds_read_b128 v[84:87], v5 offset:18432
    s_add_u32 m0, s20, 3968
    v_mfma_f32_16x16x32_bf16 v[44:47], a[52:55], v[92:95], v[44:47]
    buffer_load_dwordx4 v2, s[8:11], s23 offen offset:128 lds
    v_mfma_f32_16x16x32_bf16 v[40:43], a[48:51], v[92:95], v[40:43]
    s_waitcnt lgkmcnt(4)
    v_mfma_f32_16x16x32_bf16 v[32:35], a[56:59], v[96:99], v[32:35]
    ds_read_b128 v[88:91], v4 offset:20480
    s_add_u32 m0, s20, 7936
    v_mfma_f32_16x16x32_bf16 v[36:39], a[60:63], v[96:99], v[36:39]
    ds_read_b128 v[92:95], v4 offset:22528
    buffer_load_dwordx4 v2, s[8:11], s23 offen offset:256 lds
    v_mfma_f32_16x16x32_bf16 v[44:47], a[60:63], v[100:103], v[44:47]
    v_mfma_f32_16x16x32_bf16 v[40:43], a[56:59], v[100:103], v[40:43]
    s_add_u32 m0, s20, 11904
    s_waitcnt lgkmcnt(4)
    v_mfma_f32_16x16x32_bf16 v[32:35], a[64:67], v[72:75], v[32:35]
    ds_read_b128 v[96:99], v5 offset:20480
    buffer_load_dwordx4 v2, s[8:11], s23 offen offset:384 lds
    v_mfma_f32_16x16x32_bf16 v[36:39], a[68:71], v[72:75], v[36:39]
    ds_read_b128 v[100:103], v5 offset:22528
    v_mfma_f32_16x16x32_bf16 v[44:47], a[68:71], v[76:79], v[44:47]
    s_add_u32 m0, s20, 15872
    v_mfma_f32_16x16x32_bf16 v[40:43], a[64:67], v[76:79], v[40:43]
    buffer_load_dwordx4 v2, s[8:11], s23 offen offset:512 lds
    s_waitcnt lgkmcnt(4)
    v_mfma_f32_16x16x32_bf16 v[32:35], a[72:75], v[80:83], v[32:35]
    ds_read_b128 v[72:75], v4 offset:24576
    v_mfma_f32_16x16x32_bf16 v[36:39], a[76:79], v[80:83], v[36:39]
    ds_read_b128 v[76:79], v4 offset:26624
    s_add_u32 m0, s20, 19840
    v_mfma_f32_16x16x32_bf16 v[44:47], a[76:79], v[84:87], v[44:47]
    buffer_load_dwordx4 v2, s[8:11], s23 offen offset:640 lds
    v_mfma_f32_16x16x32_bf16 v[40:43], a[72:75], v[84:87], v[40:43]
    s_waitcnt lgkmcnt(4)
    v_mfma_f32_16x16x32_bf16 v[32:35], a[80:83], v[88:91], v[32:35]
    ds_read_b128 v[80:83], v5 offset:24576
    s_add_u32 m0, s20, 23808
    v_mfma_f32_16x16x32_bf16 v[36:39], a[84:87], v[88:91], v[36:39]
    ds_read_b128 v[84:87], v5 offset:26624
    buffer_load_dwordx4 v2, s[8:11], s23 offen offset:768 lds
    v_mfma_f32_16x16x32_bf16 v[44:47], a[84:87], v[92:95], v[44:47]
    s_cmp_ge_u32 s21, 131072
    s_cselect_b32 s22, 0xfffe0000, s29
    v_mfma_f32_16x16x32_bf16 v[40:43], a[80:83], v[92:95], v[40:43]
    s_add_u32 s21, s21, s22
    s_waitcnt lgkmcnt(4)
    v_mfma_f32_16x16x32_bf16 v[32:35], a[88:91], v[96:99], v[32:35]
    ds_read_b128 v[88:91], v4 offset:28672
    s_add_u32 m0, s20, 27776
    v_mfma_f32_16x16x32_bf16 v[36:39], a[92:95], v[96:99], v[36:39]
    ds_read_b128 v[92:95], v4 offset:30720
    buffer_load_dwordx4 v2, s[8:11], s23 offen offset:896 lds
    v_mfma_f32_16x16x32_bf16 v[44:47], a[92:95], v[100:103], v[44:47]
    v_add_u32 v4, s22, v4
    v_mfma_f32_16x16x32_bf16 v[40:43], a[88:91], v[100:103], v[40:43]
    s_waitcnt lgkmcnt(4)
    v_mfma_f32_16x16x32_bf16 v[32:35], a[96:99], v[72:75], v[32:35]
    ds_read_b128 v[96:99], v5 offset:28672
    v_mfma_f32_16x16x32_bf16 v[36:39], a[100:103], v[72:75], v[36:39]
    ds_read_b128 v[100:103], v5 offset:30720
    v_mfma_f32_16x16x32_bf16 v[44:47], a[100:103], v[76:79], v[44:47]
    v_add_u32 v5, s22, v5
    s_cmp_lt_u32 s24, 4
    v_mfma_f32_16x16x32_bf16 v[40:43], a[96:99], v[76:79], v[40:43]
    s_waitcnt vmcnt(20)
    s_cbranch_scc1 kvsk_early
    s_barrier
kvsk_mid:
    s_waitcnt lgkmcnt(4)
    v_mfma_f32_16x16x32_bf16 v[32:35], a[104:107], v[80:83], v[32:35]
    ds_read_b128 v[72:75], v4 offset:0
    s_add_u32 s23, s23, 1024
    v_mfma_f32_16x16x32_bf16 v[36:39], a[108:111], v[80:83], v[36:39]
    ds_read_b128 v[76:79], v4 offset:2048
    s_bitcmp1_b32 s23, 11
    v_mfma_f32_16x16x32_bf16 v[44:47], a[108:111], v[84:87], v[44:47]
    s_cselect_b32 s60, 0xf800, 0
    s_add_u32 s23, s23, s60
    v_mfma_f32_16x16x32_bf16 v[40:43], a[104:107], v[84:87], v[40:43]
    s_add_u32 s20, s20, 32768
    s_waitcnt lgkmcnt(4)
    v_mfma_f32_16x16x32_bf16 v[32:35], a[112:115], v[88:91], v[32:35]
    ds_read_b128 v[80:83], v5 offset:0
    s_cmp_ge_u32 s20, 163840
    v_mfma_f32_16x16x32_bf16 v[36:39], a[116:119], v[88:91], v[36:39]
    ds_read_b128 v[84:87], v5 offset:2048
    s_cselect_b32 s60, 163840, 0
    v_mfma_f32_16x16x32_bf16 v[44:47], a[116:119], v[92:95], v[44:47]
    s_sub_u32 s20, s20, s60
    v_mfma_f32_16x16x32_bf16 v[40:43], a[112:115], v[92:95], v[40:43]
    s_waitcnt lgkmcnt(4)
    v_mfma_f32_16x16x32_bf16 v[32:35], a[120:123], v[96:99], v[32:35]
    ds_read_b128 v[88:91], v4 offset:4096
    v_mfma_f32_16x16x32_bf16 v[36:39], a[124:127], v[96:99], v[36:39]
    ds_read_b128 v[92:95], v4 offset:6144
    v_mfma_f32_16x16x32_bf16 v[44:47], a[124:127], v[100:103], v[44:47]
    v_mfma_f32_16x16x32_bf16 v[40:43], a[120:123], v[100:103], v[40:43]
    s_waitcnt lgkmcnt(4)
    v_mfma_f32_16x16x32_bf16 v[32:35], a[128:131], v[72:75], v[32:35]
    ds_read_b128 v[96:99], v5 offset:4096
    s_mov_b32 s18, 0xa000000
    v_mfma_f32_16x16x32_bf16 v[36:39], a[132:135], v[72:75], v[36:39]
    ds_read_b128 v[100:103], v5 offset:6144
    v_mfma_f32_16x16x32_bf16 v[44:47], a[132:135], v[76:79], v[44:47]
    s_add_u32 m0, s20, 0
    v_mfma_f32_16x16x32_bf16 v[40:43], a[128:131], v[76:79], v[40:43]
    buffer_load_dwordx4 v2, s[8:11], s23 offen offset:0 lds
    s_waitcnt lgkmcnt(4)
    v_mfma_f32_16x16x32_bf16 v[32:35], a[136:139], v[80:83], v[32:35]
    ds_read_b128 v[72:75], v4 offset:8192
    s_lshl_b32 s25, s24, 20
    v_mfma_f32_16x16x32_bf16 v[36:39], a[140:143], v[80:83], v[36:39]
    ds_read_b128 v[76:79], v4 offset:10240
    s_lshl_b32 s62, s24, 12
    v_mfma_f32_16x16x32_bf16 v[44:47], a[140:143], v[84:87], v[44:47]
    s_and_b32 s62, s62, 0x2000
    v_mfma_f32_16x16x32_bf16 v[40:43], a[136:139], v[84:87], v[40:43]
    s_add_u32 m0, s20, 3968
    s_waitcnt lgkmcnt(4)
    v_mfma_f32_16x16x32_bf16 v[32:35], a[144:147], v[88:91], v[32:35]
    ds_read_b128 v[80:83], v5 offset:8192
    buffer_load_dwordx4 v2, s[8:11], s23 offen offset:128 lds
    v_mfma_f32_16x16x32_bf16 v[36:39], a[148:151], v[88:91], v[36:39]
    ds_read_b128 v[84:87], v5 offset:10240
    s_xor_b32 s62, s62, s30
    v_mfma_f32_16x16x32_bf16 v[44:47], a[148:151], v[92:95], v[44:47]
    s_add_u32 s25, s25, s62
    s_lshl_b32 s26, s24, 19
    v_mfma_f32_16x16x32_bf16 v[40:43], a[144:147], v[92:95], v[40:43]
    s_waitcnt lgkmcnt(4)
    v_mfma_f32_16x16x32_bf16 v[32:35], a[152:155], v[96:99], v[32:35]
    ds_read_b128 v[88:91], v4 offset:12288
    s_add_u32 m0, s20, 7936
    v_mfma_f32_16x16x32_bf16 v[36:39], a[156:159], v[96:99], v[36:39]
    ds_read_b128 v[92:95], v4 offset:14336
    buffer_load_dwordx4 v2, s[8:11], s23 offen offset:256 lds
    v_mfma_f32_16x16x32_bf16 v[44:47], a[156:159], v[100:103], v[44:47]
    s_lshl_b32 s62, s24, 11
    s_and_b32 s62, s62, 0x2000
    v_mfma_f32_16x16x32_bf16 v[40:43], a[152:155], v[100:103], v[40:43]
    s_waitcnt lgkmcnt(4)
    v_mfma_f32_16x16x32_bf16 v[32:35], a[160:163], v[72:75], v[32:35]
    ds_read_b128 v[96:99], v5 offset:12288
    v_mfma_f32_16x16x32_bf16 v[36:39], a[164:167], v[72:75], v[36:39]
    ds_read_b128 v[100:103], v5 offset:14336
    s_add_u32 m0, s20, 11904
    v_mfma_f32_16x16x32_bf16 v[44:47], a[164:167], v[76:79], v[44:47]
    buffer_load_dwordx4 v2, s[8:11], s23 offen offset:384 lds
    v_mfma_f32_16x16x32_bf16 v[40:43], a[160:163], v[76:79], v[40:43]
    s_xor_b32 s62, s62, s31
    s_waitcnt lgkmcnt(4)
    v_mfma_f32_16x16x32_bf16 v[32:35], a[168:171], v[80:83], v[32:35]
    ds_read_b128 v[72:75], v4 offset:16384
    s_add_u32 s26, s26, s62
    v_mfma_f32_16x16x32_bf16 v[36:39], a[172:175], v[80:83], v[36:39]
    ds_read_b128 v[76:79], v4 offset:18432
    v_mfma_f32_16x16x32_bf16 v[44:47], a[172:175], v[84:87], v[44:47]
    s_add_u32 m0, s20, 15872
    v_mfma_f32_16x16x32_bf16 v[40:43], a[168:171], v[84:87], v[40:43]
    buffer_load_dwordx4 v2, s[8:11], s23 offen offset:512 lds
    s_waitcnt lgkmcnt(4)
    v_mfma_f32_16x16x32_bf16 v[32:35], a[176:179], v[88:91], v[32:35]
    ds_read_b128 v[80:83], v5 offset:16384
    s_add_u32 s27, s27, 0x10000
    v_mfma_f32_16x16x32_bf16 v[36:39], a[180:183], v[88:91], v[36:39]
    ds_read_b128 v[84:87], v5 offset:18432
    s_andn2_b32 s61, 3, s24
    v_mfma_f32_16x16x32_bf16 v[44:47], a[180:183], v[92:95], v[44:47]
    s_or_b32 s61, s61, s58
    s_cselect_b32 s33, 0x400000, s27
    v_mfma_f32_16x16x32_bf16 v[40:43], a[176:179], v[92:95], v[40:43]
    s_add_u32 m0, s20, 19840
    s_waitcnt lgkmcnt(4)
    v_mfma_f32_16x16x32_bf16 v[32:35], a[184:187], v[96:99], v[32:35]
    ds_read_b128 v[88:91], v4 offset:20480
    buffer_load_dwordx4 v2, s[8:11], s23 offen offset:640 lds
    v_mfma_f32_16x16x32_bf16 v[36:39], a[188:191], v[96:99], v[36:39]
    ds_read_b128 v[92:95], v4 offset:22528
    v_mfma_f32_16x16x32_bf16 v[44:47], a[188:191], v[100:103], v[44:47]
    v_mfma_f32_16x16x32_bf16 v[40:43], a[184:187], v[100:103], v[40:43]
    s_waitcnt lgkmcnt(4)
    v_mfma_f32_16x16x32_bf16 v[32:35], a[192:195], v[72:75], v[32:35]
    ds_read_b128 v[96:99], v5 offset:20480
    s_add_u32 m0, s20, 23808
    v_mfma_f32_16x16x32_bf16 v[36:39], a[196:199], v[72:75], v[36:39]
    ds_read_b128 v[100:103], v5 offset:22528
    buffer_load_dwordx4 v2, s[8:11], s23 offen offset:768 lds
    v_mfma_f32_16x16x32_bf16 v[44:47], a[196:199], v[76:79], v[44:47]
    s_cmp_ge_u32 s21, 131072
    s_cselect_b32 s22, 0xfffe0000, s29
    v_mfma_f32_16x16x32_bf16 v[40:43], a[192:195], v[76:79], v[40:43]
    s_add_u32 s21, s21, s22
    s_waitcnt lgkmcnt(4)
    v_mfma_f32_16x16x32_bf16 v[32:35], a[200:203], v[80:83], v[32:35]
    ds_read_b128 v[72:75], v4 offset:24576
    v_mfma_f32_16x16x32_bf16 v[36:39], a[204:207], v[80:83], v[36:39]
    ds_read_b128 v[76:79], v4 offset:26624
    s_add_u32 m0, s20, 27776
    v_mfma_f32_16x16x32_bf16 v[44:47], a[204:207], v[84:87], v[44:47]
    buffer_load_dwordx4 v2, s[8:11], s23 offen offset:896 lds
    v_mfma_f32_16x16x32_bf16 v[40:43], a[200:203], v[84:87], v[40:43]
    s_waitcnt lgkmcnt(4)
    v_mfma_f32_16x16x32_bf16 v[32:35], a[208:211], v[88:91], v[32:35]
    ds_read_b128 v[80:83], v5 offset:24576
    v_mfma_f32_16x16x32_bf16 v[36:39], a[212:215], v[88:91], v[36:39]
    ds_read_b128 v[84:87], v5 offset:26624
    v_mfma_f32_16x16x32_bf16 v[44:47], a[212:215], v[92:95], v[44:47]
    v_mfma_f32_16x16x32_bf16 v[40:43], a[208:211], v[92:95], v[40:43]
    s_waitcnt lgkmcnt(4)
    v_mfma_f32_16x16x32_bf16 v[32:35], a[216:219], v[96:99], v[32:35]
    ds_read_b128 v[88:91], v4 offset:28672
    v_mfma_f32_16x16x32_bf16 v[36:39], a[220:223], v[96:99], v[36:39]
    ds_read_b128 v[92:95], v4 offset:30720
    v_mfma_f32_16x16x32_bf16 v[44:47], a[220:223], v[100:103], v[44:47]
    v_add_u32 v4, s22, v4
    v_mfma_f32_16x16x32_bf16 v[40:43], a[216:219], v[100:103], v[40:43]
    s_waitcnt lgkmcnt(4)
    v_mfma_f32_16x16x32_bf16 v[32:35], a[224:227], v[72:75], v[32:35]
    ds_read_b128 v[96:99], v5 offset:28672
    v_mfma_f32_16x16x32_bf16 v[36:39], a[228:231], v[72:75], v[36:39]
    ds_read_b128 v[100:103], v5 offset:30720
    v_mfma_f32_16x16x32_bf16 v[44:47], a[228:231], v[76:79], v[44:47]
    v_add_u32 v5, s22, v5
    v_mfma_f32_16x16x32_bf16 v[40:43], a[224:227], v[76:79], v[40:43]
    s_waitcnt vmcnt(16)
    s_barrier
    s_waitcnt lgkmcnt(4)
    v_mfma_f32_16x16x32_bf16 v[32:35], a[232:235], v[80:83], v[32:35]
    ds_read_b128 v[72:75], v4 offset:0
    s_add_u32 s23, s23, 1024
    v_mfma_f32_16x16x32_bf16 v[36:39], a[236:239], v[80:83], v[36:39]
    ds_read_b128 v[76:79], v4 offset:2048
    s_bitcmp1_b32 s23, 11
    v_mfma_f32_16x16x32_bf16 v[44:47], a[236:239], v[84:87], v[44:47]
    s_cselect_b32 s60, 0xf800, 0
    s_add_u32 s23, s23, s60
    v_mfma_f32_16x16x32_bf16 v[40:43], a[232:235], v[84:87], v[40:43]
    s_add_u32 s20, s20, 32768
    s_waitcnt lgkmcnt(4)
    v_mfma_f32_16x16x32_bf16 v[32:35], a[240:243], v[88:91], v[32:35]
    ds_read_b128 v[80:83], v5 offset:0
    s_cmp_ge_u32 s20, 163840
    v_mfma_f32_16x16x32_bf16 v[36:39], a[244:247], v[88:91], v[36:39]
    ds_read_b128 v[84:87], v5 offset:2048
    s_cselect_b32 s60, 163840, 0
    v_mfma_f32_16x16x32_bf16 v[44:47], a[244:247], v[92:95], v[44:47]
    s_sub_u32 s20, s20, s60
    s_add_u32 s24, s24, 1
    v_mfma_f32_16x16x32_bf16 v[40:43], a[240:243], v[92:95], v[40:43]
    s_sub_u32 s61, s24, 2
    s_waitcnt lgkmcnt(4)
    v_mfma_f32_16x16x32_bf16 v[48:51], a[248:251], v[96:99], v[32:35]
    ds_read_b128 v[88:91], v4 offset:4096
    s_bitcmp1_b64 s[34:35], s61
    v_mfma_f32_16x16x32_bf16 v[52:55], a[252:255], v[96:99], v[36:39]
    ds_read_b128 v[92:95], v4 offset:6144
    v_mfma_f32_16x16x32_bf16 v[60:63], a[252:255], v[100:103], v[44:47]
    v_mfma_f32_16x16x32_bf16 v[56:59], a[248:251], v[100:103], v[40:43]
    s_cbranch_scc0 kvsk
    s_cmp_eq_u32 s24, 64
    s_cbranch_scc1 kvsk_fin
    s_cmp_lg_u32 s58, 0
    s_cbranch_scc1 kvsk
    s_bfm_b64 s[62:63], s61, 0
    s_and_b32 s62, s62, 0x808088af
    s_and_b32 s63, s63, 0x80808080
    s_bcnt1_i32_b64 s60, s[62:63]
    s_lshl_b32 s60, s60, 2
    s_add_u32 s60, s60, 64
    v_mov_b32 v24, s60
    v_mov_b32 v25, 1
    s_mov_b64 exec, 1
    global_atomic_add v24, v25, s[98:99] sc1
    s_mov_b64 exec, -1
    s_branch kvsk
kvsk_early:
    s_waitcnt vmcnt(8)
    s_barrier
    s_cmp_eq_u32 s24, 0
    s_cbranch_scc1 kvsk_mid
    s_cmp_lg_u32 s58, 0
    s_cbranch_scc1 kvsk_mid
    s_lshl_b32 s60, s24, 2
    s_add_u32 s60, s60, 60
    v_mov_b32 v24, s60
    v_mov_b32 v25, 1
    s_mov_b64 exec, 1
    global_atomic_add v24, v25, s[98:99] sc1
    s_mov_b64 exec, -1
    s_branch kvsk_mid
kvsk_fin:
    s_nop 7
    v_cvt_pk_bf16_f32 v64, v48, v49
    v_cvt_pk_bf16_f32 v65, v50, v51
    v_cvt_pk_bf16_f32 v66, v52, v53
    v_cvt_pk_bf16_f32 v67, v54, v55
    v_cvt_pk_bf16_f32 v68, v56, v57
    v_cvt_pk_bf16_f32 v69, v58, v59
    v_cvt_pk_bf16_f32 v70, v60, v61
    v_cvt_pk_bf16_f32 v71, v62, v63
    buffer_store_dwordx4 v[64:67], v1, s[16:19], s25 offen sc1
    buffer_store_dwordx4 v[68:71], v12, s[16:19], s25 offen sc1
    buffer_store_dwordx4 v[28:31], v1, s[16:19], s26 offen sc1
    s_waitcnt vmcnt(0) lgkmcnt(0)
    s_barrier
    s_cmp_lg_u32 s58, 0
    s_cbranch_scc1 L_kve_41
    s_mov_b32 s60, 116
    v_mov_b32 v24, s60
    v_mov_b32 v25, 1
    s_mov_b64 exec, 1
    global_atomic_add v24, v25, s[98:99] sc1
    s_mov_b64 exec, -1
    s_branch L_kve_41
L_kvv_40:
    ds_read_b128 v[72:75], v4 offset:0
    ds_read_b128 v[76:79], v4 offset:2048
    ds_read_b128 v[80:83], v5 offset:0
    ds_read_b128 v[84:87], v5 offset:2048
    ds_read_b128 v[88:91], v4 offset:4096
    ds_read_b128 v[92:95], v4 offset:6144
    s_mov_b32 s34, 0x808088a8
    s_mov_b32 s35, 0x40808080
    s_cmp_eq_u32 s58, 0
    s_cselect_b32 s33, s27, 0x400000
    s_mov_b32 s25, 0
    s_mov_b32 s26, 0
kvsv:
    s_waitcnt lgkmcnt(4)
    v_mfma_f32_16x16x32_bf16 v[32:35], v[72:75], a[0:3], 0
    ds_read_b128 v[96:99], v5 offset:4096
    v_mfma_f32_16x16x32_bf16 v[40:43], v[72:75], a[4:7], 0
    ds_read_b128 v[100:103], v5 offset:6144
    v_mfma_f32_16x16x32_bf16 v[44:47], v[76:79], a[4:7], 0
    v_mfma_f32_16x16x32_bf16 v[36:39], v[76:79], a[0:3], 0
    v_cvt_pk_bf16_f32 v64, v48, v49
    s_waitcnt lgkmcnt(4)
    v_mfma_f32_16x16x32_bf16 v[32:35], v[80:83], a[8:11], v[32:35]
    ds_read_b128 v[72:75], v4 offset:8192
    v_cvt_pk_bf16_f32 v65, v50, v51
    v_mfma_f32_16x16x32_bf16 v[40:43], v[80:83], a[12:15], v[40:43]
    ds_read_b128 v[76:79], v4 offset:10240
    v_cvt_pk_bf16_f32 v66, v52, v53
    v_mfma_f32_16x16x32_bf16 v[44:47], v[84:87], a[12:15], v[44:47]
    v_cvt_pk_bf16_f32 v67, v54, v55
    v_cvt_pk_bf16_f32 v68, v56, v57
    v_mfma_f32_16x16x32_bf16 v[36:39], v[84:87], a[8:11], v[36:39]
    v_cvt_pk_bf16_f32 v69, v58, v59
    s_waitcnt lgkmcnt(4)
    v_mfma_f32_16x16x32_bf16 v[32:35], v[88:91], a[16:19], v[32:35]
    ds_read_b128 v[80:83], v5 offset:8192
    v_cvt_pk_bf16_f32 v70, v60, v61
    v_mfma_f32_16x16x32_bf16 v[40:43], v[88:91], a[20:23], v[40:43]
    ds_read_b128 v[84:87], v5 offset:10240
    v_cvt_pk_bf16_f32 v71, v62, v63
    v_mfma_f32_16x16x32_bf16 v[44:47], v[92:95], a[20:23], v[44:47]
    buffer_store_dwordx4 v[64:67], v1, s[16:19], s25 offen sc1
    v_mfma_f32_16x16x32_bf16 v[36:39], v[92:95], a[16:19], v[36:39]
    s_waitcnt lgkmcnt(4)
    v_mfma_f32_16x16x32_bf16 v[32:35], v[96:99], a[24:27], v[32:35]
    ds_read_b128 v[88:91], v4 offset:12288
    buffer_store_dwordx4 v[68:71], v1, s[16:19], s25 offen offset:1024 sc1
    v_mfma_f32_16x16x32_bf16 v[40:43], v[96:99], a[28:31], v[40:43]
    ds_read_b128 v[92:95], v4 offset:14336
    v_mfma_f32_16x16x32_bf16 v[44:47], v[100:103], a[28:31], v[44:47]
    v_mfma_f32_16x16x32_bf16 v[36:39], v[100:103], a[24:27], v[36:39]
    s_waitcnt lgkmcnt(4)
    v_mfma_f32_16x16x32_bf16 v[32:35], v[72:75], a[32:35], v[32:35]
    ds_read_b128 v[96:99], v5 offset:12288
    buffer_store_dwordx4 v[28:31], v1, s[16:19], s26 offen sc1
    v_mfma_f32_16x16x32_bf16 v[40:43], v[72:75], a[36:39], v[40:43]
    ds_read_b128 v[100:103], v5 offset:14336
    buffer_load_dword v13, v10, s[8:11], s33 offen
    v_mfma_f32_16x16x32_bf16 v[44:47], v[76:79], a[36:39], v[44:47]
    v_mfma_f32_16x16x32_bf16 v[36:39], v[76:79], a[32:35], v[36:39]
    s_waitcnt lgkmcnt(4)
    v_mfma_f32_16x16x32_bf16 v[32:35], v[80:83], a[40:43], v[32:35]
    ds_read_b128 v[72:75], v4 offset:16384
    v_mfma_f32_16x16x32_bf16 v[40:43], v[80:83], a[44:47], v[40:43]
    ds_read_b128 v[76:79], v4 offset:18432
    v_mfma_f32_16x16x32_bf16 v[44:47], v[84:87], a[44:47], v[44:47]
    s_add_u32 m0, s20, 0
    v_mfma_f32_16x16x32_bf16 v[36:39], v[84:87], a[40:43], v[36:39]
    buffer_load_dwordx4 v2, s[8:11], s23 offen offset:0 lds
    s_waitcnt lgkmcnt(4)
    v_mfma_f32_16x16x32_bf16 v[32:35], v[88:91], a[48:51], v[32:35]
    ds_read_b128 v[80:83], v5 offset:16384
    v_mfma_f32_16x16x32_bf16 v[40:43], v[88:91], a[52:55], v[40:43]
    ds_read_b128 v[84:87], v5 offset:18432
    s_add_u32 m0, s20, 3968
    v_mfma_f32_16x16x32_bf16 v[44:47], v[92:95], a[52:55], v[44:47]
    buffer_load_dwordx4 v2, s[8:11], s23 offen offset:128 lds
    v_mfma_f32_16x16x32_bf16 v[36:39], v[92:95], a[48:51], v[36:39]
    s_waitcnt lgkmcnt(4)
    v_mfma_f32_16x16x32_bf16 v[32:35], v[96:99], a[56:59], v[32:35]
    ds_read_b128 v[88:91], v4 offset:20480
    s_add_u32 m0, s20, 7936
    v_mfma_f32_16x16x32_bf16 v[40:43], v[96:99], a[60:63], v[40:43]
    ds_read_b128 v[92:95], v4 offset:22528
    buffer_load_dwordx4 v2, s[8:11], s23 offen offset:256 lds
    v_mfma_f32_16x16x32_bf16 v[44:47], v[100:103], a[60:63], v[44:47]
    v_mfma_f32_16x16x32_bf16 v[36:39], v[100:103], a[56:59], v[36:39]
    s_add_u32 m0, s20, 11904
    s_waitcnt lgkmcnt(4)
    v_mfma_f32_16x16x32_bf16 v[32:35], v[72:75], a[64:67], v[32:35]
    ds_read_b128 v[96:99], v5 offset:20480
    buffer_load_dwordx4 v2, s[8:11], s23 offen offset:384 lds
    v_mfma_f32_16x16x32_bf16 v[40:43], v[72:75], a[68:71], v[40:43]
    ds_read_b128 v[100:103], v5 offset:22528
    v_mfma_f32_16x16x32_bf16 v[44:47], v[76:79], a[68:71], v[44:47]
    s_add_u32 m0, s20, 15872
    v_mfma_f32_16x16x32_bf16 v[36:39], v[76:79], a[64:67], v[36:39]
    buffer_load_dwordx4 v2, s[8:11], s23 offen offset:512 lds
    s_waitcnt lgkmcnt(4)
    v_mfma_f32_16x16x32_bf16 v[32:35], v[80:83], a[72:75], v[32:35]
    ds_read_b128 v[72:75], v4 offset:24576
    v_mfma_f32_16x16x32_bf16 v[40:43], v[80:83], a[76:79], v[40:43]
    ds_read_b128 v[76:79], v4 offset:26624
    s_add_u32 m0, s20, 19840
    v_mfma_f32_16x16x32_bf16 v[44:47], v[84:87], a[76:79], v[44:47]
    buffer_load_dwordx4 v2, s[8:11], s23 offen offset:640 lds
    v_mfma_f32_16x16x32_bf16 v[36:39], v[84:87], a[72:75], v[36:39]
    s_waitcnt lgkmcnt(4)
    v_mfma_f32_16x16x32_bf16 v[32:35], v[88:91], a[80:83], v[32:35]
    ds_read_b128 v[80:83], v5 offset:24576
    s_add_u32 m0, s20, 23808
    v_mfma_f32_16x16x32_bf16 v[40:43], v[88:91], a[84:87], v[40:43]
    ds_read_b128 v[84:87], v5 offset:26624
    buffer_load_dwordx4 v2, s[8:11], s23 offen offset:768 lds
    v_mfma_f32_16x16x32_bf16 v[44:47], v[92:95], a[84:87], v[44:47]
    s_cmp_ge_u32 s21, 131072
    s_cselect_b32 s22, 0xfffe0000, s29
    v_mfma_f32_16x16x32_bf16 v[36:39], v[92:95], a[80:83], v[36:39]
    s_add_u32 s21, s21, s22
    s_waitcnt lgkmcnt(4)
    v_mfma_f32_16x16x32_bf16 v[32:35], v[96:99], a[88:91], v[32:35]
    ds_read_b128 v[88:91], v4 offset:28672
    s_add_u32 m0, s20, 27776
    v_mfma_f32_16x16x32_bf16 v[40:43], v[96:99], a[92:95], v[40:43]
    ds_read_b128 v[92:95], v4 offset:30720
    buffer_load_dwordx4 v2, s[8:11], s23 offen offset:896 lds
    v_mfma_f32_16x16x32_bf16 v[44:47], v[100:103], a[92:95], v[44:47]
    v_add_u32 v4, s22, v4
    v_mfma_f32_16x16x32_bf16 v[36:39], v[100:103], a[88:91], v[36:39]
    s_waitcnt lgkmcnt(4)
    v_mfma_f32_16x16x32_bf16 v[32:35], v[72:75], a[96:99], v[32:35]
    ds_read_b128 v[96:99], v5 offset:28672
    v_mfma_f32_16x16x32_bf16 v[40:43], v[72:75], a[100:103], v[40:43]
    ds_read_b128 v[100:103], v5 offset:30720
    v_mfma_f32_16x16x32_bf16 v[44:47], v[76:79], a[100:103], v[44:47]
    v_add_u32 v5, s22, v5
    s_cmp_lt_u32 s24, 4
    v_mfma_f32_16x16x32_bf16 v[36:39], v[76:79], a[96:99], v[36:39]
    s_waitcnt vmcnt(20)
    s_cbranch_scc1 kvsv_early
    s_barrier
kvsv_mid:
    s_waitcnt lgkmcnt(4)
    v_mfma_f32_16x16x32_bf16 v[32:35], v[80:83], a[104:107], v[32:35]
    ds_read_b128 v[72:75], v4 offset:0
    s_add_u32 s23, s23, 1024
    v_mfma_f32_16x16x32_bf16 v[40:43], v[80:83], a[108:111], v[40:43]
    ds_read_b128 v[76:79], v4 offset:2048
    s_bitcmp1_b32 s23, 11
    v_mfma_f32_16x16x32_bf16 v[44:47], v[84:87], a[108:111], v[44:47]
    s_cselect_b32 s60, 0xf800, 0
    s_add_u32 s23, s23, s60
    v_mfma_f32_16x16x32_bf16 v[36:39], v[84:87], a[104:107], v[36:39]
    s_add_u32 s20, s20, 32768
    s_waitcnt lgkmcnt(4)
    v_mfma_f32_16x16x32_bf16 v[32:35], v[88:91], a[112:115], v[32:35]
    ds_read_b128 v[80:83], v5 offset:0
    s_cmp_ge_u32 s20, 163840
    v_mfma_f32_16x16x32_bf16 v[40:43], v[88:91], a[116:119], v[40:43]
    ds_read_b128 v[84:87], v5 offset:2048
    s_cselect_b32 s60, 163840, 0
    v_mfma_f32_16x16x32_bf16 v[44:47], v[92:95], a[116:119], v[44:47]
    s_sub_u32 s20, s20, s60
    v_mfma_f32_16x16x32_bf16 v[36:39], v[92:95], a[112:115], v[36:39]
    s_waitcnt lgkmcnt(4)
    v_mfma_f32_16x16x32_bf16 v[32:35], v[96:99], a[120:123], v[32:35]
    ds_read_b128 v[88:91], v4 offset:4096
    v_mfma_f32_16x16x32_bf16 v[40:43], v[96:99], a[124:127], v[40:43]
    ds_read_b128 v[92:95], v4 offset:6144
    v_mfma_f32_16x16x32_bf16 v[44:47], v[100:103], a[124:127], v[44:47]
    v_mfma_f32_16x16x32_bf16 v[36:39], v[100:103], a[120:123], v[36:39]
    s_waitcnt lgkmcnt(4)
    v_mfma_f32_16x16x32_bf16 v[32:35], v[72:75], a[128:131], v[32:35]
    ds_read_b128 v[96:99], v5 offset:4096
    s_mov_b32 s18, 0xa000000
    v_mfma_f32_16x16x32_bf16 v[40:43], v[72:75], a[132:135], v[40:43]
    ds_read_b128 v[100:103], v5 offset:6144
    v_mfma_f32_16x16x32_bf16 v[44:47], v[76:79], a[132:135], v[44:47]
    s_add_u32 m0, s20, 0
    v_mfma_f32_16x16x32_bf16 v[36:39], v[76:79], a[128:131], v[36:39]
    buffer_load_dwordx4 v2, s[8:11], s23 offen offset:0 lds
    s_waitcnt lgkmcnt(4)
    v_mfma_f32_16x16x32_bf16 v[32:35], v[80:83], a[136:139], v[32:35]
    ds_read_b128 v[72:75], v4 offset:8192
    s_lshl_b32 s25, s24, 20
    v_mfma_f32_16x16x32_bf16 v[40:43], v[80:83], a[140:143], v[40:43]
    ds_read_b128 v[76:79], v4 offset:10240
    s_lshl_b32 s62, s24, 12
    v_mfma_f32_16x16x32_bf16 v[44:47], v[84:87], a[140:143], v[44:47]
    s_and_b32 s62, s62, 0x2000
    v_mfma_f32_16x16x32_bf16 v[36:39], v[84:87], a[136:139], v[36:39]
    s_add_u32 m0, s20, 3968
    s_waitcnt lgkmcnt(4)
    v_mfma_f32_16x16x32_bf16 v[32:35], v[88:91], a[144:147], v[32:35]
    ds_read_b128 v[80:83], v5 offset:8192
    buffer_load_dwordx4 v2, s[8:11], s23 offen offset:128 lds
    v_mfma_f32_16x16x32_bf16 v[40:43], v[88:91], a[148:151], v[40:43]
    ds_read_b128 v[84:87], v5 offset:10240
    s_xor_b32 s62, s62, s30
    v_mfma_f32_16x16x32_bf16 v[44:47], v[92:95], a[148:151], v[44:47]
    s_add_u32 s25, s25, s62
    s_lshl_b32 s26, s24, 19
    v_mfma_f32_16x16x32_bf16 v[36:39], v[92:95], a[144:147], v[36:39]
    s_waitcnt lgkmcnt(4)
    v_mfma_f32_16x16x32_bf16 v[32:35], v[96:99], a[152:155], v[32:35]
    ds_read_b128 v[88:91], v4 offset:12288
    s_add_u32 m0, s20, 7936
    v_mfma_f32_16x16x32_bf16 v[40:43], v[96:99], a[156:159], v[40:43]
    ds_read_b128 v[92:95], v4 offset:14336
    buffer_load_dwordx4 v2, s[8:11], s23 offen offset:256 lds
    v_mfma_f32_16x16x32_bf16 v[44:47], v[100:103], a[156:159], v[44:47]
    s_lshl_b32 s62, s24, 11
    s_and_b32 s62, s62, 0x2000
    v_mfma_f32_16x16x32_bf16 v[36:39], v[100:103], a[152:155], v[36:39]
    s_waitcnt lgkmcnt(4)
    v_mfma_f32_16x16x32_bf16 v[32:35], v[72:75], a[160:163], v[32:35]
    ds_read_b128 v[96:99], v5 offset:12288
    v_mfma_f32_16x16x32_bf16 v[40:43], v[72:75], a[164:167], v[40:43]
    ds_read_b128 v[100:103], v5 offset:14336
    s_add_u32 m0, s20, 11904
    v_mfma_f32_16x16x32_bf16 v[44:47], v[76:79], a[164:167], v[44:47]
    buffer_load_dwordx4 v2, s[8:11], s23 offen offset:384 lds
    v_mfma_f32_16x16x32_bf16 v[36:39], v[76:79], a[160:163], v[36:39]
    s_xor_b32 s62, s62, s31
    s_waitcnt lgkmcnt(4)
    v_mfma_f32_16x16x32_bf16 v[32:35], v[80:83], a[168:171], v[32:35]
    ds_read_b128 v[72:75], v4 offset:16384
    s_add_u32 s26, s26, s62
    v_mfma_f32_16x16x32_bf16 v[40:43], v[80:83], a[172:175], v[40:43]
    ds_read_b128 v[76:79], v4 offset:18432
    v_mfma_f32_16x16x32_bf16 v[44:47], v[84:87], a[172:175], v[44:47]
    s_add_u32 m0, s20, 15872
    v_mfma_f32_16x16x32_bf16 v[36:39], v[84:87], a[168:171], v[36:39]
    buffer_load_dwordx4 v2, s[8:11], s23 offen offset:512 lds
    s_waitcnt lgkmcnt(4)
    v_mfma_f32_16x16x32_bf16 v[32:35], v[88:91], a[176:179], v[32:35]
    ds_read_b128 v[80:83], v5 offset:16384
    s_add_u32 s27, s27, 0x10000
    v_mfma_f32_16x16x32_bf16 v[40:43], v[88:91], a[180:183], v[40:43]
    ds_read_b128 v[84:87], v5 offset:18432
    s_andn2_b32 s61, 3, s24
    v_mfma_f32_16x16x32_bf16 v[44:47], v[92:95], a[180:183], v[44:47]
    s_or_b32 s61, s61, s58
    s_cselect_b32 s33, 0x400000, s27
    v_mfma_f32_16x16x32_bf16 v[36:39], v[92:95], a[176:179], v[36:39]
    s_add_u32 m0, s20, 19840
    s_waitcnt lgkmcnt(4)
    v_mfma_f32_16x16x32_bf16 v[32:35], v[96:99], a[184:187], v[32:35]
    ds_read_b128 v[88:91], v4 offset:20480
    buffer_load_dwordx4 v2, s[8:11], s23 offen offset:640 lds
    v_mfma_f32_16x16x32_bf16 v[40:43], v[96:99], a[188:191], v[40:43]
    ds_read_b128 v[92:95], v4 offset:22528
    v_mfma_f32_16x16x32_bf16 v[44:47], v[100:103], a[188:191], v[44:47]
    v_mfma_f32_16x16x32_bf16 v[36:39], v[100:103], a[184:187], v[36:39]
    s_waitcnt lgkmcnt(4)
    v_mfma_f32_16x16x32_bf16 v[32:35], v[72:75], a[192:195], v[32:35]
    ds_read_b128 v[96:99], v5 offset:20480
    s_add_u32 m0, s20, 23808
    v_mfma_f32_16x16x32_bf16 v[40:43], v[72:75], a[196:199], v[40:43]
    ds_read_b128 v[100:103], v5 offset:22528
    buffer_load_dwordx4 v2, s[8:11], s23 offen offset:768 lds
    v_mfma_f32_16x16x32_bf16 v[44:47], v[76:79], a[196:199], v[44:47]
    s_cmp_ge_u32 s21, 131072
    s_cselect_b32 s22, 0xfffe0000, s29
    v_mfma_f32_16x16x32_bf16 v[36:39], v[76:79], a[192:195], v[36:39]
    s_add_u32 s21, s21, s22
    s_waitcnt lgkmcnt(4)
    v_mfma_f32_16x16x32_bf16 v[32:35], v[80:83], a[200:203], v[32:35]
    ds_read_b128 v[72:75], v4 offset:24576
    v_mfma_f32_16x16x32_bf16 v[40:43], v[80:83], a[204:207], v[40:43]
    ds_read_b128 v[76:79], v4 offset:26624
    s_add_u32 m0, s20, 27776
    v_mfma_f32_16x16x32_bf16 v[44:47], v[84:87], a[204:207], v[44:47]
    buffer_load_dwordx4 v2, s[8:11], s23 offen offset:896 lds
    v_mfma_f32_16x16x32_bf16 v[36:39], v[84:87], a[200:203], v[36:39]
    s_waitcnt lgkmcnt(4)
    v_mfma_f32_16x16x32_bf16 v[32:35], v[88:91], a[208:211], v[32:35]
    ds_read_b128 v[80:83], v5 offset:24576
    v_mfma_f32_16x16x32_bf16 v[40:43], v[88:91], a[212:215], v[40:43]
    ds_read_b128 v[84:87], v5 offset:26624
    v_mfma_f32_16x16x32_bf16 v[44:47], v[92:95], a[212:215], v[44:47]
    v_mfma_f32_16x16x32_bf16 v[36:39], v[92:95], a[208:211], v[36:39]
    s_waitcnt lgkmcnt(4)
    v_mfma_f32_16x16x32_bf16 v[32:35], v[96:99], a[216:219], v[32:35]
    ds_read_b128 v[88:91], v4 offset:28672
    v_mfma_f32_16x16x32_bf16 v[40:43], v[96:99], a[220:223], v[40:43]
    ds_read_b128 v[92:95], v4 offset:30720
    v_mfma_f32_16x16x32_bf16 v[44:47], v[100:103], a[220:223], v[44:47]
    v_add_u32 v4, s22, v4
    v_mfma_f32_16x16x32_bf16 v[36:39], v[100:103], a[216:219], v[36:39]
    s_waitcnt lgkmcnt(4)
    v_mfma_f32_16x16x32_bf16 v[32:35], v[72:75], a[224:227], v[32:35]
    ds_read_b128 v[96:99], v5 offset:28672
    v_mfma_f32_16x16x32_bf16 v[40:43], v[72:75], a[228:231], v[40:43]
    ds_read_b128 v[100:103], v5 offset:30720
    v_mfma_f32_16x16x32_bf16 v[44:47], v[76:79], a[228:231], v[44:47]
    v_add_u32 v5, s22, v5
    v_mfma_f32_16x16x32_bf16 v[36:39], v[76:79], a[224:227], v[36:39]
    s_waitcnt vmcnt(16)
    s_barrier
    s_waitcnt lgkmcnt(4)
    v_mfma_f32_16x16x32_bf16 v[32:35], v[80:83], a[232:235], v[32:35]
    ds_read_b128 v[72:75], v4 offset:0
    s_add_u32 s23, s23, 1024
    v_mfma_f32_16x16x32_bf16 v[40:43], v[80:83], a[236:239], v[40:43]
    ds_read_b128 v[76:79], v4 offset:2048
    s_bitcmp1_b32 s23, 11
    v_mfma_f32_16x16x32_bf16 v[44:47], v[84:87], a[236:239], v[44:47]
    s_cselect_b32 s60, 0xf800, 0
    s_add_u32 s23, s23, s60
    v_mfma_f32_16x16x32_bf16 v[36:39], v[84:87], a[232:235], v[36:39]
    s_add_u32 s20, s20, 32768
    s_waitcnt lgkmcnt(4)
    v_mfma_f32_16x16x32_bf16 v[32:35], v[88:91], a[240:243], v[32:35]
    ds_read_b128 v[80:83], v5 offset:0
    s_cmp_ge_u32 s20, 163840
    v_mfma_f32_16x16x32_bf16 v[40:43], v[88:91], a[244:247], v[40:43]
    ds_read_b128 v[84:87], v5 offset:2048
    s_cselect_b32 s60, 163840, 0
    v_mfma_f32_16x16x32_bf16 v[44:47], v[92:95], a[244:247], v[44:47]
    s_sub_u32 s20, s20, s60
    s_add_u32 s24, s24, 1
    v_mfma_f32_16x16x32_bf16 v[36:39], v[92:95], a[240:243], v[36:39]
    s_sub_u32 s61, s24, 2
    s_waitcnt lgkmcnt(4)
    v_mfma_f32_16x16x32_bf16 v[48:51], v[96:99], a[248:251], v[32:35]
    ds_read_b128 v[88:91], v4 offset:4096
    s_bitcmp1_b64 s[34:35], s61
    v_mfma_f32_16x16x32_bf16 v[56:59], v[96:99], a[252:255], v[40:43]
    ds_read_b128 v[92:95], v4 offset:6144
    v_mfma_f32_16x16x32_bf16 v[60:63], v[100:103], a[252:255], v[44:47]
    v_mfma_f32_16x16x32_bf16 v[52:55], v[100:103], a[248:251], v[36:39]
    s_cbranch_scc0 kvsv
    s_cmp_eq_u32 s24, 64
    s_cbranch_scc1 kvsv_fin
    s_cmp_lg_u32 s58, 0
    s_cbranch_scc1 kvsv
    s_bfm_b64 s[62:63], s61, 0
    s_and_b32 s62, s62, 0x808088af
    s_and_b32 s63, s63, 0x80808080
    s_bcnt1_i32_b64 s60, s[62:63]
    s_lshl_b32 s60, s60, 2
    s_add_u32 s60, s60, 64
    v_mov_b32 v24, s60
    v_mov_b32 v25, 1
    s_mov_b64 exec, 1
    global_atomic_add v24, v25, s[98:99] sc1
    s_mov_b64 exec, -1
    s_branch kvsv
kvsv_early:
    s_waitcnt vmcnt(8)
    s_barrier
    s_cmp_eq_u32 s24, 0
    s_cbranch_scc1 kvsv_mid
    s_cmp_lg_u32 s58, 0
    s_cbranch_scc1 kvsv_mid
    s_lshl_b32 s60, s24, 2
    s_add_u32 s60, s60, 60
    v_mov_b32 v24, s60
    v_mov_b32 v25, 1
    s_mov_b64 exec, 1
    global_atomic_add v24, v25, s[98:99] sc1
    s_mov_b64 exec, -1
    s_branch kvsv_mid
kvsv_fin:
    s_nop 7
    v_cvt_pk_bf16_f32 v64, v48, v49
    v_cvt_pk_bf16_f32 v65, v50, v51
    v_cvt_pk_bf16_f32 v66, v52, v53
    v_cvt_pk_bf16_f32 v67, v54, v55
    v_cvt_pk_bf16_f32 v68, v56, v57
    v_cvt_pk_bf16_f32 v69, v58, v59
    v_cvt_pk_bf16_f32 v70, v60, v61
    v_cvt_pk_bf16_f32 v71, v62, v63
    buffer_store_dwordx4 v[64:67], v1, s[16:19], s25 offen sc1
    buffer_store_dwordx4 v[68:71], v1, s[16:19], s25 offen offset:1024 sc1
    buffer_store_dwordx4 v[28:31], v1, s[16:19], s26 offen sc1
    s_waitcnt vmcnt(0) lgkmcnt(0)
    s_barrier
    s_cmp_lg_u32 s58, 0
    s_cbranch_scc1 L_kve_41
    s_mov_b32 s60, 116
    v_mov_b32 v24, s60
    v_mov_b32 v25, 1
    s_mov_b64 exec, 1
    global_atomic_add v24, v25, s[98:99] sc1
    s_mov_b64 exec, -1
    s_branch L_kve_41
L_kve_41:
    s_branch chain_kernel_seg
L_big_37:
    v_and_b32 v24, 63, v0
    v_lshlrev_b32 v1, 4, v24
    v_mov_b32 v2, v1
    v_add_u32 v3, 1024, v1
    v_bfe_u32 v24, v0, 1, 3
    v_bfe_u32 v25, v0, 4, 2
    v_xor_b32 v24, v24, v25
    v_lshlrev_b32 v24, 4, v24
    v_and_b32 v25, 15, v0
    v_lshl_add_u32 v24, v25, 7, v24
    s_lshr_b32 s60, s58, 1
    s_lshl_b32 s60, s60, 14
    v_add_u32 v23, s60, v24
    s_and_b32 s60, s58, 1
    s_lshl_b32 s60, s60, 14
    s_add_u32 s60, s60, 32768
    v_add_u32 v12, s60, v24
    v_xor_b32 v13, 64, v12
    v_bfe_u32 v24, v0, 2, 3
    v_lshlrev_b32 v22, 5, v24
    v_and_b32 v24, 3, v0
    v_lshl_add_u32 v22, v24, 3, v22
    v_bfe_u32 v24, v0, 2, 2
    v_lshl_add_u32 v22, v24, 9, v22
    v_bfe_u32 v24, v0, 4, 2
    v_lshl_add_u32 v22, v24, 12, v22
    v_bfe_u32 v24, v0, 7, 1
    v_lshl_add_u32 v22, v24, 8, v22
    s_mov_b32 s49, 0
    s_mov_b32 s48, 32768
    s_lshl_b32 s45, s58, 12
    s_add_u32 s44, s45, 32768
    s_mov_b32 s11, 0x00020000
    s_mov_b32 s15, 0x00020000
    s_mov_b32 s19, 0x00020000
    s_and_b32 s85, s57, 3
    s_lshl2_add_u32 s0, s56, s85
    s_lshr_b32 s85, s57, 2
    s_mov_b32 s84, s0
    s_lshl_b32 s94, s85, 0
    s_lshl_b32 s60, s85, 19
    s_mov_b32 s30, s64
    s_and_b32 s31, s65, 0xffff
    s_mov_b32 s32, 0x400000
    s_mov_b32 s33, s60
    s_mov_b32 s34, 0x2000
    s_mov_b32 s35, 0x40000
    s_lshl_b32 s60, s0, 18
    s_mov_b32 s36, s70
    s_and_b32 s37, s71, 0xffff
    s_mov_b32 s38, 0x200000
    s_mov_b32 s39, s60
    s_mov_b32 s40, 0x8000
    s_mov_b32 s41, 0x20000
    s_mov_b32 s42, 0x80
    s_cmp_ge_u32 s58, 2
    s_cselect_b32 s36, s72, s70
    s_cselect_b32 s37, s73, s71
    s_and_b32 s37, s37, 0xffff
    v_bfe_u32 v24, v0, 4, 2
    v_and_b32 v25, 7, v0
    v_xor_b32 v24, v24, v25
    v_lshlrev_b32 v8, 4, v24
    v_bfe_u32 v24, v0, 3, 2
    v_lshl_add_u32 v8, v24, 11, v8
    v_bfe_u32 v24, v0, 5, 1
    v_lshl_add_u32 v8, v24, 16, v8
    v_lshrrev_b32 v24, 6, v0
    v_lshl_add_u32 v8, v24, 14, v8
    v_xor_b32 v9, 64, v8
    v_add_u32 v9, 0x20000, v9
    v_bfe_u32 v24, v0, 4, 2
    v_and_b32 v25, 7, v0
    v_xor_b32 v24, v24, v25
    v_lshlrev_b32 v10, 4, v24
    v_bfe_u32 v24, v0, 3, 3
    v_lshl_add_u32 v10, v24, 11, v10
    v_bfe_u32 v24, v0, 6, 1
    v_lshl_add_u32 v10, v24, 16, v10
    v_xor_b32 v11, 64, v10
    v_add_u32 v11, 0x4000, v11
    v_and_b32 v24, 15, v0
    v_bfe_u32 v25, v0, 7, 1
    v_lshl_add_u32 v24, v25, 6, v24
    v_lshlrev_b32 v24, 1, v24
    s_lshl_b32 s53, s0, 8
    s_mov_b32 s60, s66
    s_and_b32 s61, s67, 0xffff
    s_mov_b32 s62, 0x800
    s_mov_b32 s63, 0x00020000
    buffer_load_ushort v192, v24, s[60:63], s53 offen offset:0
    buffer_load_ushort v200, v24, s[60:63], s53 offen offset:32
    buffer_load_ushort v208, v24, s[60:63], s53 offen offset:64
    buffer_load_ushort v216, v24, s[60:63], s53 offen offset:96
    s_mov_b32 s60, s68
    s_and_b32 s61, s69, 0xffff
    s_mov_b32 s62, 0x800
    s_mov_b32 s63, 0x00020000
    buffer_load_ushort v193, v24, s[60:63], s53 offen offset:0
    buffer_load_ushort v201, v24, s[60:63], s53 offen offset:32
    buffer_load_ushort v209, v24, s[60:63], s53 offen offset:64
    buffer_load_ushort v217, v24, s[60:63], s53 offen offset:96
    s_mov_b32 s60, s78
    s_and_b32 s61, s79, 0xffff
    s_mov_b32 s62, 0x800
    s_mov_b32 s63, 0x00020000
    buffer_load_ushort v194, v24, s[60:63], s53 offen offset:0
    buffer_load_ushort v202, v24, s[60:63], s53 offen offset:32
    buffer_load_ushort v210, v24, s[60:63], s53 offen offset:64
    buffer_load_ushort v218, v24, s[60:63], s53 offen offset:96
    s_mov_b32 s6, 0xfffe8000
    s_mov_b32 s7, 65536
    s_mov_b32 s12, s36
    s_mov_b32 s13, s37
    s_mov_b32 s14, s38
    s_and_b32 s45, s45, 0xffffb7ff
    s_bitcmp1_b32 s94, 1
    s_cselect_b32 s24, s41, 0
    s_cselect_b32 s26, 0, s41
    s_cselect_b32 s60, 0x4000, 0
    s_or_b32 s45, s45, s60
    s_add_u32 s24, s24, s39
    s_add_u32 s26, s26, s39
    s_bitcmp1_b32 s94, 0
    s_cselect_b32 s61, s40, 0
    s_cselect_b32 s62, 0, s40
    s_cselect_b32 s60, 0x800, 0
    s_or_b32 s45, s45, s60
    s_add_u32 s25, s24, s62
    s_add_u32 s24, s24, s61
    s_add_u32 s27, s26, s62
    s_add_u32 s26, s26, s61
    s_mov_b32 s28, s42
    v_mov_b32 v6, v10
    v_mov_b32 v7, v11
    s_mov_b32 s8, s30
    s_mov_b32 s9, s31
    s_mov_b32 s10, s32
    s_and_b32 s44, s44, 0xffffb7ff
    s_bitcmp1_b32 s84, 1
    s_cselect_b32 s20, s35, 0
    s_cselect_b32 s22, 0, s35
    s_cselect_b32 s60, 0x4000, 0
    s_or_b32 s44, s44, s60
    s_add_u32 s20, s20, s33
    s_add_u32 s22, s22, s33
    s_bitcmp1_b32 s84, 0
    s_cselect_b32 s61, s34, 0
    s_cselect_b32 s62, 0, s34
    s_cselect_b32 s60, 0x800, 0
    s_or_b32 s44, s44, s60
    s_add_u32 s21, s20, s62
    s_add_u32 s20, s20, s61
    s_add_u32 s23, s22, s62
    s_add_u32 s22, s22, s61
    v_mov_b32 v4, v8
    v_mov_b32 v5, v9
    s_xor_b32 m0, s45, 0
    s_nop 0
    buffer_load_dwordx4 v6, s[12:15], s24 offen lds
    s_xor_b32 m0, s45, 1024
    s_nop 0
    buffer_load_dwordx4 v7, s[12:15], s24 offen lds
    s_xor_b32 m0, s45, 2048
    s_nop 0
    buffer_load_dwordx4 v6, s[12:15], s25 offen lds
    s_xor_b32 m0, s45, 3072
    s_nop 0
    buffer_load_dwordx4 v7, s[12:15], s25 offen lds
    s_xor_b32 m0, s45, 16384
    s_nop 0
    buffer_load_dwordx4 v6, s[12:15], s26 offen lds
    s_xor_b32 m0, s45, 17408
    s_nop 0
    buffer_load_dwordx4 v7, s[12:15], s26 offen lds
    s_xor_b32 m0, s45, 18432
    s_nop 0
    buffer_load_dwordx4 v6, s[12:15], s27 offen lds
    s_xor_b32 m0, s45, 19456
    s_nop 0
    buffer_load_dwordx4 v7, s[12:15], s27 offen lds
    s_add_u32 s24, s24, s28
    s_add_u32 s25, s25, s28
    s_add_u32 s26, s26, s28
    s_add_u32 s27, s27, s28
    s_cmp_ge_u32 s45, 98304
    s_cselect_b32 s60, s6, s7
    s_add_u32 s45, s45, s60
    s_xor_b32 m0, s44, 0
    s_nop 0
    buffer_load_dwordx4 v4, s[8:11], s20 offen lds
    s_xor_b32 m0, s44, 1024
    s_nop 0
    buffer_load_dwordx4 v5, s[8:11], s20 offen lds
    s_xor_b32 m0, s44, 2048
    s_nop 0
    buffer_load_dwordx4 v4, s[8:11], s21 offen lds
    s_xor_b32 m0, s44, 3072
    s_nop 0
    buffer_load_dwordx4 v5, s[8:11], s21 offen lds
    s_xor_b32 m0, s44, 16384
    s_nop 0
    buffer_load_dwordx4 v4, s[8:11], s22 offen lds
    s_xor_b32 m0, s44, 17408
    s_nop 0
    buffer_load_dwordx4 v5, s[8:11], s22 offen lds
    s_xor_b32 m0, s44, 18432
    s_nop 0
    buffer_load_dwordx4 v4, s[8:11], s23 offen lds
    s_xor_b32 m0, s44, 19456
    s_nop 0
    buffer_load_dwordx4 v5, s[8:11], s23 offen lds
    s_add_u32 s20, s20, 128
    s_add_u32 s21, s21, 128
    s_add_u32 s22, s22, 128
    s_add_u32 s23, s23, 128
    s_cmp_ge_u32 s44, 98304
    s_cselect_b32 s60, s6, s7
    s_add_u32 s44, s44, s60
    s_xor_b32 m0, s45, 0
    s_nop 0
    buffer_load_dwordx4 v6, s[12:15], s24 offen lds
    s_xor_b32 m0, s45, 1024
    s_nop 0
    buffer_load_dwordx4 v7, s[12:15], s24 offen lds
    s_xor_b32 m0, s45, 2048
    s_nop 0
    buffer_load_dwordx4 v6, s[12:15], s25 offen lds
    s_xor_b32 m0, s45, 3072
    s_nop 0
    buffer_load_dwordx4 v7, s[12:15], s25 offen lds
    s_xor_b32 m0, s45, 16384
    s_nop 0
    buffer_load_dwordx4 v6, s[12:15], s26 offen lds
    s_xor_b32 m0, s45, 17408
    s_nop 0
    buffer_load_dwordx4 v7, s[12:15], s26 offen lds
    s_xor_b32 m0, s45, 18432
    s_nop 0
    buffer_load_dwordx4 v6, s[12:15], s27 offen lds
    s_xor_b32 m0, s45, 19456
    s_nop 0
    buffer_load_dwordx4 v7, s[12:15], s27 offen lds
    s_add_u32 s24, s24, s28
    s_add_u32 s25, s25, s28
    s_add_u32 s26, s26, s28
    s_add_u32 s27, s27, s28
    s_cmp_ge_u32 s45, 98304
    s_cselect_b32 s60, s6, s7
    s_add_u32 s45, s45, s60
    s_mov_b32 s16, s100
    s_and_b32 s17, s101, 0xffff
    s_mov_b32 s18, 0x8000000
    s_mov_b32 s19, 0x00020000
    v_mov_b32 v32, -1
    v_mov_b32 v33, -1
    v_lshlrev_b32 v26, 3, v0
    s_lshl_b32 s60, s56, 5
    s_add_u32 s60, s60, s57
    s_lshl_b32 s60, s60, 11
    s_add_u32 s60, s60, 0x5900000
    buffer_store_dwordx2 v[32:33], v26, s[16:19], s60 offen sc1
    s_mov_b32 s18, 0
    s_and_b32 s62, s57, 7
    s_lshr_b32 s63, s57, 3
    s_lshl3_add_u32 s62, s56, s62
    s_lshl_b32 s60, s63, 19
    s_mov_b32 s30, s82
    s_and_b32 s31, s83, 0xffff
    s_mov_b32 s32, 0x400000
    s_mov_b32 s33, s60
    s_mov_b32 s34, 0x8000
    s_mov_b32 s35, 0x40000
    s_lshl_b32 s60, s62, 9
    s_mov_b32 s36, s86
    s_and_b32 s37, s87, 0xffff
    s_mov_b32 s38, 0x800000
    s_mov_b32 s39, s60
    s_mov_b32 s40, 0x8000
    s_mov_b32 s41, 0x40000
    s_mov_b32 s42, 0x80000
    v_bfe_u32 v24, v0, 4, 2
    v_and_b32 v25, 7, v0
    v_xor_b32 v24, v24, v25
    v_lshlrev_b32 v8, 4, v24
    v_bfe_u32 v24, v0, 3, 3
    v_lshl_add_u32 v8, v24, 11, v8
    v_bfe_u32 v24, v0, 6, 2
    v_lshl_add_u32 v8, v24, 16, v8
    v_xor_b32 v9, 64, v8
    v_add_u32 v9, 0x4000, v9
    v_bfe_u32 v24, v0, 5, 1
    v_bfe_u32 v25, v0, 6, 1
    v_lshl_add_u32 v25, v25, 2, v24
    v_lshlrev_b32 v25, 1, v25
    v_and_b32 v10, 31, v0
    v_xor_b32 v10, v10, v25
    v_lshlrev_b32 v10, 4, v10
    v_lshl_add_u32 v10, v24, 13, v10
    v_lshrrev_b32 v24, 6, v0
    v_lshl_add_u32 v10, v24, 16, v10
    v_xor_b32 v11, 64, v10
    v_add_u32 v11, 0x4000, v11
    s_mov_b32 s84, s62
    s_lshl_b32 s94, s63, 0
    s_waitcnt vmcnt(25)
    v_lshlrev_b32 v192, 16, v192
    v_lshlrev_b32 v200, 16, v200
    v_lshlrev_b32 v208, 16, v208
    v_lshlrev_b32 v216, 16, v216
    v_lshlrev_b32 v193, 16, v193
    v_lshlrev_b32 v201, 16, v201
    v_lshlrev_b32 v209, 16, v209
    v_lshlrev_b32 v217, 16, v217
    v_lshlrev_b32 v194, 16, v194
    v_lshlrev_b32 v202, 16, v202
    v_lshlrev_b32 v210, 16, v210
    v_lshlrev_b32 v218, 16, v218
    v_mul_f32 v194, 0x3fb8aa3b, v194
    v_mul_f32 v202, 0x3fb8aa3b, v202
    v_mul_f32 v210, 0x3fb8aa3b, v210
    v_mul_f32 v218, 0x3fb8aa3b, v218
    v_exp_f32 v194, v194
    v_exp_f32 v202, v202
    v_exp_f32 v210, v210
    v_exp_f32 v218, v218
    v_cvt_pk_bf16_f32 v194, 0, v194
    v_cvt_pk_bf16_f32 v202, 0, v202
    v_cvt_pk_bf16_f32 v210, 0, v210
    v_cvt_pk_bf16_f32 v218, 0, v218
    v_mul_f32 v195, v194, v192
    v_mul_f32 v203, v202, v200
    v_mul_f32 v211, v210, v208
    v_mul_f32 v219, v218, v216
    v_mul_f32 v196, v194, v193
    v_mul_f32 v204, v202, v201
    v_mul_f32 v212, v210, v209
    v_mul_f32 v220, v218, v217
    v_mul_f32 v195, 0x3fb8aa3b, v195
    v_mul_f32 v203, 0x3fb8aa3b, v203
    v_mul_f32 v211, 0x3fb8aa3b, v211
    v_mul_f32 v219, 0x3fb8aa3b, v219
    v_exp_f32 v195, v195
    v_exp_f32 v203, v203
    v_exp_f32 v211, v211
    v_exp_f32 v219, v219
    v_mul_f32 v196, 0x3e22f983, v196
    v_mul_f32 v204, 0x3e22f983, v204
    v_mul_f32 v212, 0x3e22f983, v212
    v_mul_f32 v220, 0x3e22f983, v220
    v_fract_f32 v196, v196
    v_fract_f32 v204, v204
    v_fract_f32 v212, v212
    v_fract_f32 v220, v220
    v_cos_f32 v197, v196
    v_cos_f32 v205, v204
    v_cos_f32 v213, v212
    v_cos_f32 v221, v220
    v_sin_f32 v198, v196
    v_sin_f32 v206, v204
    v_sin_f32 v214, v212
    v_sin_f32 v222, v220
    v_mul_f32 v88, v195, v197
    v_mul_f32 v90, v203, v205
    v_mul_f32 v92, v211, v213
    v_mul_f32 v94, v219, v221
    v_mul_f32 v89, v195, v198
    v_mul_f32 v91, v203, v206
    v_mul_f32 v93, v211, v214
    v_mul_f32 v95, v219, v222
    v_add_f32 v197, -1.0, v88
    v_add_f32 v205, -1.0, v90
    v_add_f32 v213, -1.0, v92
    v_add_f32 v221, -1.0, v94
    v_mul_f32 v198, v197, v192
    v_mul_f32 v206, v205, v200
    v_mul_f32 v214, v213, v208
    v_mul_f32 v222, v221, v216
    v_fma_f32 v198, v89, v193, v198
    v_fma_f32 v206, v91, v201, v206
    v_fma_f32 v214, v93, v209, v214
    v_fma_f32 v222, v95, v217, v222
    v_mul_f32 v199, v89, v192
    v_mul_f32 v207, v91, v200
    v_mul_f32 v215, v93, v208
    v_mul_f32 v223, v95, v216
    v_fma_f32 v199, -v197, v193, v199
    v_fma_f32 v207, -v205, v201, v207
    v_fma_f32 v215, -v213, v209, v215
    v_fma_f32 v223, -v221, v217, v223
    v_mul_f32 v195, v192, v192
    v_mul_f32 v203, v200, v200
    v_mul_f32 v211, v208, v208
    v_mul_f32 v219, v216, v216
    v_fma_f32 v195, v193, v193, v195
    v_fma_f32 v203, v201, v201, v203
    v_fma_f32 v211, v209, v209, v211
    v_fma_f32 v219, v217, v217, v219
    v_rcp_f32 v195, v195
    v_rcp_f32 v203, v203
    v_rcp_f32 v211, v211
    v_rcp_f32 v219, v219
    v_add_f32 v195, v195, v195
    v_add_f32 v203, v203, v203
    v_add_f32 v211, v211, v211
    v_add_f32 v219, v219, v219
    v_mul_f32 v96, v198, v195
    v_mul_f32 v98, v206, v203
    v_mul_f32 v100, v214, v211
    v_mul_f32 v102, v222, v219
    v_mul_f32 v97, v199, v195
    v_mul_f32 v99, v207, v203
    v_mul_f32 v101, v215, v211
    v_mul_f32 v103, v223, v219
    v_pk_mul_f32 v[192:193], v[88:89], v[88:89] op_sel:[0,0] op_sel_hi:[0,1]
    v_pk_mul_f32 v[200:201], v[90:91], v[90:91] op_sel:[0,0] op_sel_hi:[0,1]
    v_pk_mul_f32 v[208:209], v[92:93], v[92:93] op_sel:[0,0] op_sel_hi:[0,1]
    v_pk_mul_f32 v[216:217], v[94:95], v[94:95] op_sel:[0,0] op_sel_hi:[0,1]
    v_pk_fma_f32 v[104:105], v[88:89], v[88:89], v[192:193] op_sel:[1,1,0] op_sel_hi:[1,0,1] neg_lo:[1,0,0]
    v_pk_fma_f32 v[106:107], v[90:91], v[90:91], v[200:201] op_sel:[1,1,0] op_sel_hi:[1,0,1] neg_lo:[1,0,0]
    v_pk_fma_f32 v[108:109], v[92:93], v[92:93], v[208:209] op_sel:[1,1,0] op_sel_hi:[1,0,1] neg_lo:[1,0,0]
    v_pk_fma_f32 v[110:111], v[94:95], v[94:95], v[216:217] op_sel:[1,1,0] op_sel_hi:[1,0,1] neg_lo:[1,0,0]
    v_pk_mul_f32 v[192:193], v[104:105], v[104:105] op_sel:[0,0] op_sel_hi:[0,1]
    v_pk_mul_f32 v[200:201], v[106:107], v[106:107] op_sel:[0,0] op_sel_hi:[0,1]
    v_pk_mul_f32 v[208:209], v[108:109], v[108:109] op_sel:[0,0] op_sel_hi:[0,1]
    v_pk_mul_f32 v[216:217], v[110:111], v[110:111] op_sel:[0,0] op_sel_hi:[0,1]
    v_pk_fma_f32 v[104:105], v[104:105], v[104:105], v[192:193] op_sel:[1,1,0] op_sel_hi:[1,0,1] neg_lo:[1,0,0]
    v_pk_fma_f32 v[106:107], v[106:107], v[106:107], v[200:201] op_sel:[1,1,0] op_sel_hi:[1,0,1] neg_lo:[1,0,0]
    v_pk_fma_f32 v[108:109], v[108:109], v[108:109], v[208:209] op_sel:[1,1,0] op_sel_hi:[1,0,1] neg_lo:[1,0,0]
    v_pk_fma_f32 v[110:111], v[110:111], v[110:111], v[216:217] op_sel:[1,1,0] op_sel_hi:[1,0,1] neg_lo:[1,0,0]
    v_pk_mul_f32 v[192:193], v[104:105], v[104:105] op_sel:[0,0] op_sel_hi:[0,1]
    v_pk_mul_f32 v[200:201], v[106:107], v[106:107] op_sel:[0,0] op_sel_hi:[0,1]
    v_pk_mul_f32 v[208:209], v[108:109], v[108:109] op_sel:[0,0] op_sel_hi:[0,1]
    v_pk_mul_f32 v[216:217], v[110:111], v[110:111] op_sel:[0,0] op_sel_hi:[0,1]
    v_pk_fma_f32 v[104:105], v[104:105], v[104:105], v[192:193] op_sel:[1,1,0] op_sel_hi:[1,0,1] neg_lo:[1,0,0]
    v_pk_fma_f32 v[106:107], v[106:107], v[106:107], v[200:201] op_sel:[1,1,0] op_sel_hi:[1,0,1] neg_lo:[1,0,0]
    v_pk_fma_f32 v[108:109], v[108:109], v[108:109], v[208:209] op_sel:[1,1,0] op_sel_hi:[1,0,1] neg_lo:[1,0,0]
    v_pk_fma_f32 v[110:111], v[110:111], v[110:111], v[216:217] op_sel:[1,1,0] op_sel_hi:[1,0,1] neg_lo:[1,0,0]
    v_pk_mul_f32 v[192:193], v[104:105], v[104:105] op_sel:[0,0] op_sel_hi:[0,1]
    v_pk_mul_f32 v[200:201], v[106:107], v[106:107] op_sel:[0,0] op_sel_hi:[0,1]
    v_pk_mul_f32 v[208:209], v[108:109], v[108:109] op_sel:[0,0] op_sel_hi:[0,1]
    v_pk_mul_f32 v[216:217], v[110:111], v[110:111] op_sel:[0,0] op_sel_hi:[0,1]
    v_pk_fma_f32 v[104:105], v[104:105], v[104:105], v[192:193] op_sel:[1,1,0] op_sel_hi:[1,0,1] neg_lo:[1,0,0]
    v_pk_fma_f32 v[106:107], v[106:107], v[106:107], v[200:201] op_sel:[1,1,0] op_sel_hi:[1,0,1] neg_lo:[1,0,0]
    v_pk_fma_f32 v[108:109], v[108:109], v[108:109], v[208:209] op_sel:[1,1,0] op_sel_hi:[1,0,1] neg_lo:[1,0,0]
    v_pk_fma_f32 v[110:111], v[110:111], v[110:111], v[216:217] op_sel:[1,1,0] op_sel_hi:[1,0,1] neg_lo:[1,0,0]
    v_pk_mul_f32 v[192:193], v[104:105], v[104:105] op_sel:[0,0] op_sel_hi:[0,1]
    v_pk_mul_f32 v[200:201], v[106:107], v[106:107] op_sel:[0,0] op_sel_hi:[0,1]
    v_pk_mul_f32 v[208:209], v[108:109], v[108:109] op_sel:[0,0] op_sel_hi:[0,1]
    v_pk_mul_f32 v[216:217], v[110:111], v[110:111] op_sel:[0,0] op_sel_hi:[0,1]
    v_pk_fma_f32 v[104:105], v[104:105], v[104:105], v[192:193] op_sel:[1,1,0] op_sel_hi:[1,0,1] neg_lo:[1,0,0]
    v_pk_fma_f32 v[106:107], v[106:107], v[106:107], v[200:201] op_sel:[1,1,0] op_sel_hi:[1,0,1] neg_lo:[1,0,0]
    v_pk_fma_f32 v[108:109], v[108:109], v[108:109], v[208:209] op_sel:[1,1,0] op_sel_hi:[1,0,1] neg_lo:[1,0,0]
    v_pk_fma_f32 v[110:111], v[110:111], v[110:111], v[216:217] op_sel:[1,1,0] op_sel_hi:[1,0,1] neg_lo:[1,0,0]
    v_pk_mul_f32 v[192:193], v[104:105], v[104:105] op_sel:[0,0] op_sel_hi:[0,1]
    v_pk_mul_f32 v[200:201], v[106:107], v[106:107] op_sel:[0,0] op_sel_hi:[0,1]
    v_pk_mul_f32 v[208:209], v[108:109], v[108:109] op_sel:[0,0] op_sel_hi:[0,1]
    v_pk_mul_f32 v[216:217], v[110:111], v[110:111] op_sel:[0,0] op_sel_hi:[0,1]
    v_pk_fma_f32 v[112:113], v[104:105], v[104:105], v[192:193] op_sel:[1,1,0] op_sel_hi:[1,0,1] neg_lo:[1,0,0]
    v_pk_fma_f32 v[114:115], v[106:107], v[106:107], v[200:201] op_sel:[1,1,0] op_sel_hi:[1,0,1] neg_lo:[1,0,0]
    v_pk_fma_f32 v[116:117], v[108:109], v[108:109], v[208:209] op_sel:[1,1,0] op_sel_hi:[1,0,1] neg_lo:[1,0,0]
    v_pk_fma_f32 v[118:119], v[110:111], v[110:111], v[216:217] op_sel:[1,1,0] op_sel_hi:[1,0,1] neg_lo:[1,0,0]
    v_pk_mul_f32 v[192:193], v[112:113], v[112:113] op_sel:[0,0] op_sel_hi:[0,1]
    v_pk_mul_f32 v[200:201], v[114:115], v[114:115] op_sel:[0,0] op_sel_hi:[0,1]
    v_pk_mul_f32 v[208:209], v[116:117], v[116:117] op_sel:[0,0] op_sel_hi:[0,1]
    v_pk_mul_f32 v[216:217], v[118:119], v[118:119] op_sel:[0,0] op_sel_hi:[0,1]
    v_pk_fma_f32 v[196:197], v[112:113], v[112:113], v[192:193] op_sel:[1,1,0] op_sel_hi:[1,0,1] neg_lo:[1,0,0]
    v_pk_fma_f32 v[204:205], v[114:115], v[114:115], v[200:201] op_sel:[1,1,0] op_sel_hi:[1,0,1] neg_lo:[1,0,0]
    v_pk_fma_f32 v[212:213], v[116:117], v[116:117], v[208:209] op_sel:[1,1,0] op_sel_hi:[1,0,1] neg_lo:[1,0,0]
    v_pk_fma_f32 v[220:221], v[118:119], v[118:119], v[216:217] op_sel:[1,1,0] op_sel_hi:[1,0,1] neg_lo:[1,0,0]
    s_mov_b32 exec_lo, 0xffffffff
    s_mov_b32 exec_hi, 0xffffffff
    v_mov_b32 v120, v196
    v_mov_b32 v121, v197
    s_mov_b32 exec_lo, 0xffff0000
    s_mov_b32 exec_hi, 0xffffffff
    v_mov_b32 v120, v204
    v_mov_b32 v121, v205
    s_mov_b32 exec_lo, 0x0
    s_mov_b32 exec_hi, 0xffffffff
    v_mov_b32 v120, v212
    v_mov_b32 v121, v213
    s_mov_b32 exec_lo, 0x0
    s_mov_b32 exec_hi, 0xffff0000
    v_mov_b32 v120, v220
    v_mov_b32 v121, v221
    s_mov_b64 exec, -1
    s_cmp_eq_u32 s58, 0
    s_cselect_b32 s1, 20, 0
    s_mov_b32 s4, 0
    s_mov_b32 s3, 20
    s_mov_b32 s2, 64
    s_mov_b32 s50, 0
    s_mov_b32 s5, 0
    s_mov_b32 s51, 0
    s_mov_b32 s52, 0
    s_waitcnt vmcnt(9)
    s_barrier
    s_call_b64 s[54:55], t_g1
    v_mov_b32 v24, 4
    global_load_dword v125, v24, s[98:99] sc1
    s_nop 7
    v_accvgpr_read_b32 v40, a0
    v_accvgpr_read_b32 v42, a4
    v_accvgpr_read_b32 v44, a8
    v_accvgpr_read_b32 v46, a12
    v_accvgpr_read_b32 v41, a16
    v_accvgpr_read_b32 v43, a20
    v_accvgpr_read_b32 v45, a24
    v_accvgpr_read_b32 v47, a28
    v_accvgpr_read_b32 v48, a1
    v_accvgpr_read_b32 v50, a5
    v_accvgpr_read_b32 v52, a9
    v_accvgpr_read_b32 v54, a13
    v_accvgpr_read_b32 v49, a17
    v_accvgpr_read_b32 v51, a21
    v_accvgpr_read_b32 v53, a25
    v_accvgpr_read_b32 v55, a29
    v_pk_fma_f32 v[56:57], v[88:89], v[40:41], v[48:49] op_sel:[0,0,0] op_sel_hi:[0,1,1]
    v_pk_fma_f32 v[58:59], v[90:91], v[42:43], v[50:51] op_sel:[0,0,0] op_sel_hi:[0,1,1]
    v_pk_fma_f32 v[60:61], v[92:93], v[44:45], v[52:53] op_sel:[0,0,0] op_sel_hi:[0,1,1]
    v_pk_fma_f32 v[62:63], v[94:95], v[46:47], v[54:55] op_sel:[0,0,0] op_sel_hi:[0,1,1]
    v_pk_fma_f32 v[40:41], v[88:89], v[40:41], v[56:57] op_sel:[1,1,0] op_sel_hi:[1,0,1] neg_lo:[1,0,0]
    v_pk_fma_f32 v[42:43], v[90:91], v[42:43], v[58:59] op_sel:[1,1,0] op_sel_hi:[1,0,1] neg_lo:[1,0,0]
    v_pk_fma_f32 v[44:45], v[92:93], v[44:45], v[60:61] op_sel:[1,1,0] op_sel_hi:[1,0,1] neg_lo:[1,0,0]
    v_pk_fma_f32 v[46:47], v[94:95], v[46:47], v[62:63] op_sel:[1,1,0] op_sel_hi:[1,0,1] neg_lo:[1,0,0]
    v_accvgpr_read_b32 v64, a2
    v_accvgpr_read_b32 v66, a6
    v_accvgpr_read_b32 v68, a10
    v_accvgpr_read_b32 v70, a14
    v_accvgpr_read_b32 v65, a18
    v_accvgpr_read_b32 v67, a22
    v_accvgpr_read_b32 v69, a26
    v_accvgpr_read_b32 v71, a30
    v_pk_fma_f32 v[56:57], v[88:89], v[40:41], v[64:65] op_sel:[0,0,0] op_sel_hi:[0,1,1]
    v_pk_fma_f32 v[58:59], v[90:91], v[42:43], v[66:67] op_sel:[0,0,0] op_sel_hi:[0,1,1]
    v_pk_fma_f32 v[60:61], v[92:93], v[44:45], v[68:69] op_sel:[0,0,0] op_sel_hi:[0,1,1]
    v_pk_fma_f32 v[62:63], v[94:95], v[46:47], v[70:71] op_sel:[0,0,0] op_sel_hi:[0,1,1]
    v_pk_fma_f32 v[40:41], v[88:89], v[40:41], v[56:57] op_sel:[1,1,0] op_sel_hi:[1,0,1] neg_lo:[1,0,0]
    v_pk_fma_f32 v[42:43], v[90:91], v[42:43], v[58:59] op_sel:[1,1,0] op_sel_hi:[1,0,1] neg_lo:[1,0,0]
    v_pk_fma_f32 v[44:45], v[92:93], v[44:45], v[60:61] op_sel:[1,1,0] op_sel_hi:[1,0,1] neg_lo:[1,0,0]
    v_pk_fma_f32 v[46:47], v[94:95], v[46:47], v[62:63] op_sel:[1,1,0] op_sel_hi:[1,0,1] neg_lo:[1,0,0]
    v_accvgpr_read_b32 v48, a3
    v_accvgpr_read_b32 v50, a7
    v_accvgpr_read_b32 v52, a11
    v_accvgpr_read_b32 v54, a15
    v_accvgpr_read_b32 v49, a19
    v_accvgpr_read_b32 v51, a23
    v_accvgpr_read_b32 v53, a27
    v_accvgpr_read_b32 v55, a31
    v_pk_fma_f32 v[56:57], v[88:89], v[40:41], v[48:49] op_sel:[0,0,0] op_sel_hi:[0,1,1]
    v_pk_fma_f32 v[58:59], v[90:91], v[42:43], v[50:51] op_sel:[0,0,0] op_sel_hi:[0,1,1]
    v_pk_fma_f32 v[60:61], v[92:93], v[44:45], v[52:53] op_sel:[0,0,0] op_sel_hi:[0,1,1]
    v_pk_fma_f32 v[62:63], v[94:95], v[46:47], v[54:55] op_sel:[0,0,0] op_sel_hi:[0,1,1]
    v_pk_fma_f32 v[40:41], v[88:89], v[40:41], v[56:57] op_sel:[1,1,0] op_sel_hi:[1,0,1] neg_lo:[1,0,0]
    v_pk_fma_f32 v[42:43], v[90:91], v[42:43], v[58:59] op_sel:[1,1,0] op_sel_hi:[1,0,1] neg_lo:[1,0,0]
    v_pk_fma_f32 v[44:45], v[92:93], v[44:45], v[60:61] op_sel:[1,1,0] op_sel_hi:[1,0,1] neg_lo:[1,0,0]
    v_pk_fma_f32 v[46:47], v[94:95], v[46:47], v[62:63] op_sel:[1,1,0] op_sel_hi:[1,0,1] neg_lo:[1,0,0]
    v_accvgpr_read_b32 v64, a32
    v_accvgpr_read_b32 v66, a36
    v_accvgpr_read_b32 v68, a40
    v_accvgpr_read_b32 v70, a44
    v_accvgpr_read_b32 v65, a48
    v_accvgpr_read_b32 v67, a52
    v_accvgpr_read_b32 v69, a56
    v_accvgpr_read_b32 v71, a60
    v_pk_fma_f32 v[56:57], v[88:89], v[40:41], v[64:65] op_sel:[0,0,0] op_sel_hi:[0,1,1]
    v_pk_fma_f32 v[58:59], v[90:91], v[42:43], v[66:67] op_sel:[0,0,0] op_sel_hi:[0,1,1]
    v_pk_fma_f32 v[60:61], v[92:93], v[44:45], v[68:69] op_sel:[0,0,0] op_sel_hi:[0,1,1]
    v_pk_fma_f32 v[62:63], v[94:95], v[46:47], v[70:71] op_sel:[0,0,0] op_sel_hi:[0,1,1]
    v_pk_fma_f32 v[40:41], v[88:89], v[40:41], v[56:57] op_sel:[1,1,0] op_sel_hi:[1,0,1] neg_lo:[1,0,0]
    v_pk_fma_f32 v[42:43], v[90:91], v[42:43], v[58:59] op_sel:[1,1,0] op_sel_hi:[1,0,1] neg_lo:[1,0,0]
    v_pk_fma_f32 v[44:45], v[92:93], v[44:45], v[60:61] op_sel:[1,1,0] op_sel_hi:[1,0,1] neg_lo:[1,0,0]
    v_pk_fma_f32 v[46:47], v[94:95], v[46:47], v[62:63] op_sel:[1,1,0] op_sel_hi:[1,0,1] neg_lo:[1,0,0]
    v_accvgpr_read_b32 v48, a33
    v_accvgpr_read_b32 v50, a37
    v_accvgpr_read_b32 v52, a41
    v_accvgpr_read_b32 v54, a45
    v_accvgpr_read_b32 v49, a49
    v_accvgpr_read_b32 v51, a53
    v_accvgpr_read_b32 v53, a57
    v_accvgpr_read_b32 v55, a61
    v_pk_fma_f32 v[56:57], v[88:89], v[40:41], v[48:49] op_sel:[0,0,0] op_sel_hi:[0,1,1]
    v_pk_fma_f32 v[58:59], v[90:91], v[42:43], v[50:51] op_sel:[0,0,0] op_sel_hi:[0,1,1]
    v_pk_fma_f32 v[60:61], v[92:93], v[44:45], v[52:53] op_sel:[0,0,0] op_sel_hi:[0,1,1]
    v_pk_fma_f32 v[62:63], v[94:95], v[46:47], v[54:55] op_sel:[0,0,0] op_sel_hi:[0,1,1]
    v_pk_fma_f32 v[40:41], v[88:89], v[40:41], v[56:57] op_sel:[1,1,0] op_sel_hi:[1,0,1] neg_lo:[1,0,0]
    v_pk_fma_f32 v[42:43], v[90:91], v[42:43], v[58:59] op_sel:[1,1,0] op_sel_hi:[1,0,1] neg_lo:[1,0,0]
    v_pk_fma_f32 v[44:45], v[92:93], v[44:45], v[60:61] op_sel:[1,1,0] op_sel_hi:[1,0,1] neg_lo:[1,0,0]
    v_pk_fma_f32 v[46:47], v[94:95], v[46:47], v[62:63] op_sel:[1,1,0] op_sel_hi:[1,0,1] neg_lo:[1,0,0]
    v_accvgpr_read_b32 v64, a34
    v_accvgpr_read_b32 v66, a38
    v_accvgpr_read_b32 v68, a42
    v_accvgpr_read_b32 v70, a46
    v_accvgpr_read_b32 v65, a50
    v_accvgpr_read_b32 v67, a54
    v_accvgpr_read_b32 v69, a58
    v_accvgpr_read_b32 v71, a62
    v_pk_fma_f32 v[56:57], v[88:89], v[40:41], v[64:65] op_sel:[0,0,0] op_sel_hi:[0,1,1]
    v_pk_fma_f32 v[58:59], v[90:91], v[42:43], v[66:67] op_sel:[0,0,0] op_sel_hi:[0,1,1]
    v_pk_fma_f32 v[60:61], v[92:93], v[44:45], v[68:69] op_sel:[0,0,0] op_sel_hi:[0,1,1]
    v_pk_fma_f32 v[62:63], v[94:95], v[46:47], v[70:71] op_sel:[0,0,0] op_sel_hi:[0,1,1]
    v_pk_fma_f32 v[40:41], v[88:89], v[40:41], v[56:57] op_sel:[1,1,0] op_sel_hi:[1,0,1] neg_lo:[1,0,0]
    v_pk_fma_f32 v[42:43], v[90:91], v[42:43], v[58:59] op_sel:[1,1,0] op_sel_hi:[1,0,1] neg_lo:[1,0,0]
    v_pk_fma_f32 v[44:45], v[92:93], v[44:45], v[60:61] op_sel:[1,1,0] op_sel_hi:[1,0,1] neg_lo:[1,0,0]
    v_pk_fma_f32 v[46:47], v[94:95], v[46:47], v[62:63] op_sel:[1,1,0] op_sel_hi:[1,0,1] neg_lo:[1,0,0]
    v_accvgpr_read_b32 v48, a35
    v_accvgpr_read_b32 v50, a39
    v_accvgpr_read_b32 v52, a43
    v_accvgpr_read_b32 v54, a47
    v_accvgpr_read_b32 v49, a51
    v_accvgpr_read_b32 v51, a55
    v_accvgpr_read_b32 v53, a59
    v_accvgpr_read_b32 v55, a63
    v_pk_fma_f32 v[56:57], v[88:89], v[40:41], v[48:49] op_sel:[0,0,0] op_sel_hi:[0,1,1]
    v_pk_fma_f32 v[58:59], v[90:91], v[42:43], v[50:51] op_sel:[0,0,0] op_sel_hi:[0,1,1]
    v_pk_fma_f32 v[60:61], v[92:93], v[44:45], v[52:53] op_sel:[0,0,0] op_sel_hi:[0,1,1]
    v_pk_fma_f32 v[62:63], v[94:95], v[46:47], v[54:55] op_sel:[0,0,0] op_sel_hi:[0,1,1]
    v_pk_fma_f32 v[40:41], v[88:89], v[40:41], v[56:57] op_sel:[1,1,0] op_sel_hi:[1,0,1] neg_lo:[1,0,0]
    v_pk_fma_f32 v[42:43], v[90:91], v[42:43], v[58:59] op_sel:[1,1,0] op_sel_hi:[1,0,1] neg_lo:[1,0,0]
    v_pk_fma_f32 v[44:45], v[92:93], v[44:45], v[60:61] op_sel:[1,1,0] op_sel_hi:[1,0,1] neg_lo:[1,0,0]
    v_pk_fma_f32 v[46:47], v[94:95], v[46:47], v[62:63] op_sel:[1,1,0] op_sel_hi:[1,0,1] neg_lo:[1,0,0]
    v_accvgpr_read_b32 v64, a64
    v_accvgpr_read_b32 v66, a68
    v_accvgpr_read_b32 v68, a72
    v_accvgpr_read_b32 v70, a76
    v_accvgpr_read_b32 v65, a80
    v_accvgpr_read_b32 v67, a84
    v_accvgpr_read_b32 v69, a88
    v_accvgpr_read_b32 v71, a92
    v_pk_fma_f32 v[56:57], v[88:89], v[40:41], v[64:65] op_sel:[0,0,0] op_sel_hi:[0,1,1]
    v_pk_fma_f32 v[58:59], v[90:91], v[42:43], v[66:67] op_sel:[0,0,0] op_sel_hi:[0,1,1]
    v_pk_fma_f32 v[60:61], v[92:93], v[44:45], v[68:69] op_sel:[0,0,0] op_sel_hi:[0,1,1]
    v_pk_fma_f32 v[62:63], v[94:95], v[46:47], v[70:71] op_sel:[0,0,0] op_sel_hi:[0,1,1]
    v_pk_fma_f32 v[40:41], v[88:89], v[40:41], v[56:57] op_sel:[1,1,0] op_sel_hi:[1,0,1] neg_lo:[1,0,0]
    v_pk_fma_f32 v[42:43], v[90:91], v[42:43], v[58:59] op_sel:[1,1,0] op_sel_hi:[1,0,1] neg_lo:[1,0,0]
    v_pk_fma_f32 v[44:45], v[92:93], v[44:45], v[60:61] op_sel:[1,1,0] op_sel_hi:[1,0,1] neg_lo:[1,0,0]
    v_pk_fma_f32 v[46:47], v[94:95], v[46:47], v[62:63] op_sel:[1,1,0] op_sel_hi:[1,0,1] neg_lo:[1,0,0]
    v_accvgpr_read_b32 v48, a65
    v_accvgpr_read_b32 v50, a69
    v_accvgpr_read_b32 v52, a73
    v_accvgpr_read_b32 v54, a77
    v_accvgpr_read_b32 v49, a81
    v_accvgpr_read_b32 v51, a85
    v_accvgpr_read_b32 v53, a89
    v_accvgpr_read_b32 v55, a93
    v_pk_fma_f32 v[56:57], v[88:89], v[40:41], v[48:49] op_sel:[0,0,0] op_sel_hi:[0,1,1]
    v_pk_fma_f32 v[58:59], v[90:91], v[42:43], v[50:51] op_sel:[0,0,0] op_sel_hi:[0,1,1]
    v_pk_fma_f32 v[60:61], v[92:93], v[44:45], v[52:53] op_sel:[0,0,0] op_sel_hi:[0,1,1]
    v_pk_fma_f32 v[62:63], v[94:95], v[46:47], v[54:55] op_sel:[0,0,0] op_sel_hi:[0,1,1]
    v_pk_fma_f32 v[40:41], v[88:89], v[40:41], v[56:57] op_sel:[1,1,0] op_sel_hi:[1,0,1] neg_lo:[1,0,0]
    v_pk_fma_f32 v[42:43], v[90:91], v[42:43], v[58:59] op_sel:[1,1,0] op_sel_hi:[1,0,1] neg_lo:[1,0,0]
    v_pk_fma_f32 v[44:45], v[92:93], v[44:45], v[60:61] op_sel:[1,1,0] op_sel_hi:[1,0,1] neg_lo:[1,0,0]
    v_pk_fma_f32 v[46:47], v[94:95], v[46:47], v[62:63] op_sel:[1,1,0] op_sel_hi:[1,0,1] neg_lo:[1,0,0]
    v_accvgpr_read_b32 v64, a66
    v_accvgpr_read_b32 v66, a70
    v_accvgpr_read_b32 v68, a74
    v_accvgpr_read_b32 v70, a78
    v_accvgpr_read_b32 v65, a82
    v_accvgpr_read_b32 v67, a86
    v_accvgpr_read_b32 v69, a90
    v_accvgpr_read_b32 v71, a94
    v_pk_fma_f32 v[56:57], v[88:89], v[40:41], v[64:65] op_sel:[0,0,0] op_sel_hi:[0,1,1]
    v_pk_fma_f32 v[58:59], v[90:91], v[42:43], v[66:67] op_sel:[0,0,0] op_sel_hi:[0,1,1]
    v_pk_fma_f32 v[60:61], v[92:93], v[44:45], v[68:69] op_sel:[0,0,0] op_sel_hi:[0,1,1]
    v_pk_fma_f32 v[62:63], v[94:95], v[46:47], v[70:71] op_sel:[0,0,0] op_sel_hi:[0,1,1]
    v_pk_fma_f32 v[40:41], v[88:89], v[40:41], v[56:57] op_sel:[1,1,0] op_sel_hi:[1,0,1] neg_lo:[1,0,0]
    v_pk_fma_f32 v[42:43], v[90:91], v[42:43], v[58:59] op_sel:[1,1,0] op_sel_hi:[1,0,1] neg_lo:[1,0,0]
    v_pk_fma_f32 v[44:45], v[92:93], v[44:45], v[60:61] op_sel:[1,1,0] op_sel_hi:[1,0,1] neg_lo:[1,0,0]
    v_pk_fma_f32 v[46:47], v[94:95], v[46:47], v[62:63] op_sel:[1,1,0] op_sel_hi:[1,0,1] neg_lo:[1,0,0]
    v_accvgpr_read_b32 v48, a67
    v_accvgpr_read_b32 v50, a71
    v_accvgpr_read_b32 v52, a75
    v_accvgpr_read_b32 v54, a79
    v_accvgpr_read_b32 v49, a83
    v_accvgpr_read_b32 v51, a87
    v_accvgpr_read_b32 v53, a91
    v_accvgpr_read_b32 v55, a95
    v_pk_fma_f32 v[56:57], v[88:89], v[40:41], v[48:49] op_sel:[0,0,0] op_sel_hi:[0,1,1]
    v_pk_fma_f32 v[58:59], v[90:91], v[42:43], v[50:51] op_sel:[0,0,0] op_sel_hi:[0,1,1]
    v_pk_fma_f32 v[60:61], v[92:93], v[44:45], v[52:53] op_sel:[0,0,0] op_sel_hi:[0,1,1]
    v_pk_fma_f32 v[62:63], v[94:95], v[46:47], v[54:55] op_sel:[0,0,0] op_sel_hi:[0,1,1]
    v_pk_fma_f32 v[40:41], v[88:89], v[40:41], v[56:57] op_sel:[1,1,0] op_sel_hi:[1,0,1] neg_lo:[1,0,0]
    v_pk_fma_f32 v[42:43], v[90:91], v[42:43], v[58:59] op_sel:[1,1,0] op_sel_hi:[1,0,1] neg_lo:[1,0,0]
    v_pk_fma_f32 v[44:45], v[92:93], v[44:45], v[60:61] op_sel:[1,1,0] op_sel_hi:[1,0,1] neg_lo:[1,0,0]
    v_pk_fma_f32 v[46:47], v[94:95], v[46:47], v[62:63] op_sel:[1,1,0] op_sel_hi:[1,0,1] neg_lo:[1,0,0]
    v_accvgpr_read_b32 v64, a96
    v_accvgpr_read_b32 v66, a100
    v_accvgpr_read_b32 v68, a104
    v_accvgpr_read_b32 v70, a108
    v_accvgpr_read_b32 v65, a112
    v_accvgpr_read_b32 v67, a116
    v_accvgpr_read_b32 v69, a120
    v_accvgpr_read_b32 v71, a124
    v_pk_fma_f32 v[56:57], v[88:89], v[40:41], v[64:65] op_sel:[0,0,0] op_sel_hi:[0,1,1]
    v_pk_fma_f32 v[58:59], v[90:91], v[42:43], v[66:67] op_sel:[0,0,0] op_sel_hi:[0,1,1]
    v_pk_fma_f32 v[60:61], v[92:93], v[44:45], v[68:69] op_sel:[0,0,0] op_sel_hi:[0,1,1]
    v_pk_fma_f32 v[62:63], v[94:95], v[46:47], v[70:71] op_sel:[0,0,0] op_sel_hi:[0,1,1]
    v_pk_fma_f32 v[40:41], v[88:89], v[40:41], v[56:57] op_sel:[1,1,0] op_sel_hi:[1,0,1] neg_lo:[1,0,0]
    v_pk_fma_f32 v[42:43], v[90:91], v[42:43], v[58:59] op_sel:[1,1,0] op_sel_hi:[1,0,1] neg_lo:[1,0,0]
    v_pk_fma_f32 v[44:45], v[92:93], v[44:45], v[60:61] op_sel:[1,1,0] op_sel_hi:[1,0,1] neg_lo:[1,0,0]
    v_pk_fma_f32 v[46:47], v[94:95], v[46:47], v[62:63] op_sel:[1,1,0] op_sel_hi:[1,0,1] neg_lo:[1,0,0]
    v_accvgpr_read_b32 v48, a97
    v_accvgpr_read_b32 v50, a101
    v_accvgpr_read_b32 v52, a105
    v_accvgpr_read_b32 v54, a109
    v_accvgpr_read_b32 v49, a113
    v_accvgpr_read_b32 v51, a117
    v_accvgpr_read_b32 v53, a121
    v_accvgpr_read_b32 v55, a125
    v_pk_fma_f32 v[56:57], v[88:89], v[40:41], v[48:49] op_sel:[0,0,0] op_sel_hi:[0,1,1]
    v_pk_fma_f32 v[58:59], v[90:91], v[42:43], v[50:51] op_sel:[0,0,0] op_sel_hi:[0,1,1]
    v_pk_fma_f32 v[60:61], v[92:93], v[44:45], v[52:53] op_sel:[0,0,0] op_sel_hi:[0,1,1]
    v_pk_fma_f32 v[62:63], v[94:95], v[46:47], v[54:55] op_sel:[0,0,0] op_sel_hi:[0,1,1]
    v_pk_fma_f32 v[40:41], v[88:89], v[40:41], v[56:57] op_sel:[1,1,0] op_sel_hi:[1,0,1] neg_lo:[1,0,0]
    v_pk_fma_f32 v[42:43], v[90:91], v[42:43], v[58:59] op_sel:[1,1,0] op_sel_hi:[1,0,1] neg_lo:[1,0,0]
    v_pk_fma_f32 v[44:45], v[92:93], v[44:45], v[60:61] op_sel:[1,1,0] op_sel_hi:[1,0,1] neg_lo:[1,0,0]
    v_pk_fma_f32 v[46:47], v[94:95], v[46:47], v[62:63] op_sel:[1,1,0] op_sel_hi:[1,0,1] neg_lo:[1,0,0]
    v_accvgpr_read_b32 v64, a98
    v_accvgpr_read_b32 v66, a102
    v_accvgpr_read_b32 v68, a106
    v_accvgpr_read_b32 v70, a110
    v_accvgpr_read_b32 v65, a114
    v_accvgpr_read_b32 v67, a118
    v_accvgpr_read_b32 v69, a122
    v_accvgpr_read_b32 v71, a126
    v_pk_fma_f32 v[56:57], v[88:89], v[40:41], v[64:65] op_sel:[0,0,0] op_sel_hi:[0,1,1]
    v_pk_fma_f32 v[58:59], v[90:91], v[42:43], v[66:67] op_sel:[0,0,0] op_sel_hi:[0,1,1]
    v_pk_fma_f32 v[60:61], v[92:93], v[44:45], v[68:69] op_sel:[0,0,0] op_sel_hi:[0,1,1]
    v_pk_fma_f32 v[62:63], v[94:95], v[46:47], v[70:71] op_sel:[0,0,0] op_sel_hi:[0,1,1]
    v_pk_fma_f32 v[40:41], v[88:89], v[40:41], v[56:57] op_sel:[1,1,0] op_sel_hi:[1,0,1] neg_lo:[1,0,0]
    v_pk_fma_f32 v[42:43], v[90:91], v[42:43], v[58:59] op_sel:[1,1,0] op_sel_hi:[1,0,1] neg_lo:[1,0,0]
    v_pk_fma_f32 v[44:45], v[92:93], v[44:45], v[60:61] op_sel:[1,1,0] op_sel_hi:[1,0,1] neg_lo:[1,0,0]
    v_pk_fma_f32 v[46:47], v[94:95], v[46:47], v[62:63] op_sel:[1,1,0] op_sel_hi:[1,0,1] neg_lo:[1,0,0]
    v_accvgpr_read_b32 v48, a99
    v_accvgpr_read_b32 v50, a103
    v_accvgpr_read_b32 v52, a107
    v_accvgpr_read_b32 v54, a111
    v_accvgpr_read_b32 v49, a115
    v_accvgpr_read_b32 v51, a119
    v_accvgpr_read_b32 v53, a123
    v_accvgpr_read_b32 v55, a127
    v_pk_fma_f32 v[56:57], v[88:89], v[40:41], v[48:49] op_sel:[0,0,0] op_sel_hi:[0,1,1]
    v_pk_fma_f32 v[58:59], v[90:91], v[42:43], v[50:51] op_sel:[0,0,0] op_sel_hi:[0,1,1]
    v_pk_fma_f32 v[60:61], v[92:93], v[44:45], v[52:53] op_sel:[0,0,0] op_sel_hi:[0,1,1]
    v_pk_fma_f32 v[62:63], v[94:95], v[46:47], v[54:55] op_sel:[0,0,0] op_sel_hi:[0,1,1]
    v_pk_fma_f32 v[40:41], v[88:89], v[40:41], v[56:57] op_sel:[1,1,0] op_sel_hi:[1,0,1] neg_lo:[1,0,0]
    v_pk_fma_f32 v[42:43], v[90:91], v[42:43], v[58:59] op_sel:[1,1,0] op_sel_hi:[1,0,1] neg_lo:[1,0,0]
    v_pk_fma_f32 v[44:45], v[92:93], v[44:45], v[60:61] op_sel:[1,1,0] op_sel_hi:[1,0,1] neg_lo:[1,0,0]
    v_pk_fma_f32 v[46:47], v[94:95], v[46:47], v[62:63] op_sel:[1,1,0] op_sel_hi:[1,0,1] neg_lo:[1,0,0]
    v_accvgpr_read_b32 v64, a128
    v_accvgpr_read_b32 v66, a132
    v_accvgpr_read_b32 v68, a136
    v_accvgpr_read_b32 v70, a140
    v_accvgpr_read_b32 v65, a144
    v_accvgpr_read_b32 v67, a148
    v_accvgpr_read_b32 v69, a152
    v_accvgpr_read_b32 v71, a156
    v_pk_fma_f32 v[56:57], v[88:89], v[40:41], v[64:65] op_sel:[0,0,0] op_sel_hi:[0,1,1]
    v_pk_fma_f32 v[58:59], v[90:91], v[42:43], v[66:67] op_sel:[0,0,0] op_sel_hi:[0,1,1]
    v_pk_fma_f32 v[60:61], v[92:93], v[44:45], v[68:69] op_sel:[0,0,0] op_sel_hi:[0,1,1]
    v_pk_fma_f32 v[62:63], v[94:95], v[46:47], v[70:71] op_sel:[0,0,0] op_sel_hi:[0,1,1]
    v_pk_fma_f32 v[40:41], v[88:89], v[40:41], v[56:57] op_sel:[1,1,0] op_sel_hi:[1,0,1] neg_lo:[1,0,0]
    v_pk_fma_f32 v[42:43], v[90:91], v[42:43], v[58:59] op_sel:[1,1,0] op_sel_hi:[1,0,1] neg_lo:[1,0,0]
    v_pk_fma_f32 v[44:45], v[92:93], v[44:45], v[60:61] op_sel:[1,1,0] op_sel_hi:[1,0,1] neg_lo:[1,0,0]
    v_pk_fma_f32 v[46:47], v[94:95], v[46:47], v[62:63] op_sel:[1,1,0] op_sel_hi:[1,0,1] neg_lo:[1,0,0]
    v_accvgpr_read_b32 v48, a129
    v_accvgpr_read_b32 v50, a133
    v_accvgpr_read_b32 v52, a137
    v_accvgpr_read_b32 v54, a141
    v_accvgpr_read_b32 v49, a145
    v_accvgpr_read_b32 v51, a149
    v_accvgpr_read_b32 v53, a153
    v_accvgpr_read_b32 v55, a157
    v_pk_fma_f32 v[56:57], v[88:89], v[40:41], v[48:49] op_sel:[0,0,0] op_sel_hi:[0,1,1]
    v_pk_fma_f32 v[58:59], v[90:91], v[42:43], v[50:51] op_sel:[0,0,0] op_sel_hi:[0,1,1]
    v_pk_fma_f32 v[60:61], v[92:93], v[44:45], v[52:53] op_sel:[0,0,0] op_sel_hi:[0,1,1]
    v_pk_fma_f32 v[62:63], v[94:95], v[46:47], v[54:55] op_sel:[0,0,0] op_sel_hi:[0,1,1]
    v_pk_fma_f32 v[40:41], v[88:89], v[40:41], v[56:57] op_sel:[1,1,0] op_sel_hi:[1,0,1] neg_lo:[1,0,0]
    v_pk_fma_f32 v[42:43], v[90:91], v[42:43], v[58:59] op_sel:[1,1,0] op_sel_hi:[1,0,1] neg_lo:[1,0,0]
    v_pk_fma_f32 v[44:45], v[92:93], v[44:45], v[60:61] op_sel:[1,1,0] op_sel_hi:[1,0,1] neg_lo:[1,0,0]
    v_pk_fma_f32 v[46:47], v[94:95], v[46:47], v[62:63] op_sel:[1,1,0] op_sel_hi:[1,0,1] neg_lo:[1,0,0]
    v_accvgpr_read_b32 v64, a130
    v_accvgpr_read_b32 v66, a134
    v_accvgpr_read_b32 v68, a138
    v_accvgpr_read_b32 v70, a142
    v_accvgpr_read_b32 v65, a146
    v_accvgpr_read_b32 v67, a150
    v_accvgpr_read_b32 v69, a154
    v_accvgpr_read_b32 v71, a158
    v_pk_fma_f32 v[56:57], v[88:89], v[40:41], v[64:65] op_sel:[0,0,0] op_sel_hi:[0,1,1]
    v_pk_fma_f32 v[58:59], v[90:91], v[42:43], v[66:67] op_sel:[0,0,0] op_sel_hi:[0,1,1]
    v_pk_fma_f32 v[60:61], v[92:93], v[44:45], v[68:69] op_sel:[0,0,0] op_sel_hi:[0,1,1]
    v_pk_fma_f32 v[62:63], v[94:95], v[46:47], v[70:71] op_sel:[0,0,0] op_sel_hi:[0,1,1]
    v_pk_fma_f32 v[40:41], v[88:89], v[40:41], v[56:57] op_sel:[1,1,0] op_sel_hi:[1,0,1] neg_lo:[1,0,0]
    v_pk_fma_f32 v[42:43], v[90:91], v[42:43], v[58:59] op_sel:[1,1,0] op_sel_hi:[1,0,1] neg_lo:[1,0,0]
    v_pk_fma_f32 v[44:45], v[92:93], v[44:45], v[60:61] op_sel:[1,1,0] op_sel_hi:[1,0,1] neg_lo:[1,0,0]
    v_pk_fma_f32 v[46:47], v[94:95], v[46:47], v[62:63] op_sel:[1,1,0] op_sel_hi:[1,0,1] neg_lo:[1,0,0]
    v_accvgpr_read_b32 v48, a131
    v_accvgpr_read_b32 v50, a135
    v_accvgpr_read_b32 v52, a139
    v_accvgpr_read_b32 v54, a143
    v_accvgpr_read_b32 v49, a147
    v_accvgpr_read_b32 v51, a151
    v_accvgpr_read_b32 v53, a155
    v_accvgpr_read_b32 v55, a159
    v_pk_fma_f32 v[56:57], v[88:89], v[40:41], v[48:49] op_sel:[0,0,0] op_sel_hi:[0,1,1]
    v_pk_fma_f32 v[58:59], v[90:91], v[42:43], v[50:51] op_sel:[0,0,0] op_sel_hi:[0,1,1]
    v_pk_fma_f32 v[60:61], v[92:93], v[44:45], v[52:53] op_sel:[0,0,0] op_sel_hi:[0,1,1]
    v_pk_fma_f32 v[62:63], v[94:95], v[46:47], v[54:55] op_sel:[0,0,0] op_sel_hi:[0,1,1]
    v_pk_fma_f32 v[40:41], v[88:89], v[40:41], v[56:57] op_sel:[1,1,0] op_sel_hi:[1,0,1] neg_lo:[1,0,0]
    v_pk_fma_f32 v[42:43], v[90:91], v[42:43], v[58:59] op_sel:[1,1,0] op_sel_hi:[1,0,1] neg_lo:[1,0,0]
    v_pk_fma_f32 v[44:45], v[92:93], v[44:45], v[60:61] op_sel:[1,1,0] op_sel_hi:[1,0,1] neg_lo:[1,0,0]
    v_pk_fma_f32 v[46:47], v[94:95], v[46:47], v[62:63] op_sel:[1,1,0] op_sel_hi:[1,0,1] neg_lo:[1,0,0]
    v_accvgpr_read_b32 v64, a160
    v_accvgpr_read_b32 v66, a164
    v_accvgpr_read_b32 v68, a168
    v_accvgpr_read_b32 v70, a172
    v_accvgpr_read_b32 v65, a176
    v_accvgpr_read_b32 v67, a180
    v_accvgpr_read_b32 v69, a184
    v_accvgpr_read_b32 v71, a188
    v_pk_fma_f32 v[56:57], v[88:89], v[40:41], v[64:65] op_sel:[0,0,0] op_sel_hi:[0,1,1]
    v_pk_fma_f32 v[58:59], v[90:91], v[42:43], v[66:67] op_sel:[0,0,0] op_sel_hi:[0,1,1]
    v_pk_fma_f32 v[60:61], v[92:93], v[44:45], v[68:69] op_sel:[0,0,0] op_sel_hi:[0,1,1]
    v_pk_fma_f32 v[62:63], v[94:95], v[46:47], v[70:71] op_sel:[0,0,0] op_sel_hi:[0,1,1]
    v_pk_fma_f32 v[40:41], v[88:89], v[40:41], v[56:57] op_sel:[1,1,0] op_sel_hi:[1,0,1] neg_lo:[1,0,0]
    v_pk_fma_f32 v[42:43], v[90:91], v[42:43], v[58:59] op_sel:[1,1,0] op_sel_hi:[1,0,1] neg_lo:[1,0,0]
    v_pk_fma_f32 v[44:45], v[92:93], v[44:45], v[60:61] op_sel:[1,1,0] op_sel_hi:[1,0,1] neg_lo:[1,0,0]
    v_pk_fma_f32 v[46:47], v[94:95], v[46:47], v[62:63] op_sel:[1,1,0] op_sel_hi:[1,0,1] neg_lo:[1,0,0]
    v_accvgpr_read_b32 v48, a161
    v_accvgpr_read_b32 v50, a165
    v_accvgpr_read_b32 v52, a169
    v_accvgpr_read_b32 v54, a173
    v_accvgpr_read_b32 v49, a177
    v_accvgpr_read_b32 v51, a181
    v_accvgpr_read_b32 v53, a185
    v_accvgpr_read_b32 v55, a189
    v_pk_fma_f32 v[56:57], v[88:89], v[40:41], v[48:49] op_sel:[0,0,0] op_sel_hi:[0,1,1]
    v_pk_fma_f32 v[58:59], v[90:91], v[42:43], v[50:51] op_sel:[0,0,0] op_sel_hi:[0,1,1]
    v_pk_fma_f32 v[60:61], v[92:93], v[44:45], v[52:53] op_sel:[0,0,0] op_sel_hi:[0,1,1]
    v_pk_fma_f32 v[62:63], v[94:95], v[46:47], v[54:55] op_sel:[0,0,0] op_sel_hi:[0,1,1]
    v_pk_fma_f32 v[40:41], v[88:89], v[40:41], v[56:57] op_sel:[1,1,0] op_sel_hi:[1,0,1] neg_lo:[1,0,0]
    v_pk_fma_f32 v[42:43], v[90:91], v[42:43], v[58:59] op_sel:[1,1,0] op_sel_hi:[1,0,1] neg_lo:[1,0,0]
    v_pk_fma_f32 v[44:45], v[92:93], v[44:45], v[60:61] op_sel:[1,1,0] op_sel_hi:[1,0,1] neg_lo:[1,0,0]
    v_pk_fma_f32 v[46:47], v[94:95], v[46:47], v[62:63] op_sel:[1,1,0] op_sel_hi:[1,0,1] neg_lo:[1,0,0]
    v_accvgpr_read_b32 v64, a162
    v_accvgpr_read_b32 v66, a166
    v_accvgpr_read_b32 v68, a170
    v_accvgpr_read_b32 v70, a174
    v_accvgpr_read_b32 v65, a178
    v_accvgpr_read_b32 v67, a182
    v_accvgpr_read_b32 v69, a186
    v_accvgpr_read_b32 v71, a190
    v_pk_fma_f32 v[56:57], v[88:89], v[40:41], v[64:65] op_sel:[0,0,0] op_sel_hi:[0,1,1]
    v_pk_fma_f32 v[58:59], v[90:91], v[42:43], v[66:67] op_sel:[0,0,0] op_sel_hi:[0,1,1]
    v_pk_fma_f32 v[60:61], v[92:93], v[44:45], v[68:69] op_sel:[0,0,0] op_sel_hi:[0,1,1]
    v_pk_fma_f32 v[62:63], v[94:95], v[46:47], v[70:71] op_sel:[0,0,0] op_sel_hi:[0,1,1]
    v_pk_fma_f32 v[40:41], v[88:89], v[40:41], v[56:57] op_sel:[1,1,0] op_sel_hi:[1,0,1] neg_lo:[1,0,0]
    v_pk_fma_f32 v[42:43], v[90:91], v[42:43], v[58:59] op_sel:[1,1,0] op_sel_hi:[1,0,1] neg_lo:[1,0,0]
    v_pk_fma_f32 v[44:45], v[92:93], v[44:45], v[60:61] op_sel:[1,1,0] op_sel_hi:[1,0,1] neg_lo:[1,0,0]
    v_pk_fma_f32 v[46:47], v[94:95], v[46:47], v[62:63] op_sel:[1,1,0] op_sel_hi:[1,0,1] neg_lo:[1,0,0]
    v_accvgpr_read_b32 v48, a163
    v_accvgpr_read_b32 v50, a167
    v_accvgpr_read_b32 v52, a171
    v_accvgpr_read_b32 v54, a175
    v_accvgpr_read_b32 v49, a179
    v_accvgpr_read_b32 v51, a183
    v_accvgpr_read_b32 v53, a187
    v_accvgpr_read_b32 v55, a191
    v_pk_fma_f32 v[56:57], v[88:89], v[40:41], v[48:49] op_sel:[0,0,0] op_sel_hi:[0,1,1]
    v_pk_fma_f32 v[58:59], v[90:91], v[42:43], v[50:51] op_sel:[0,0,0] op_sel_hi:[0,1,1]
    v_pk_fma_f32 v[60:61], v[92:93], v[44:45], v[52:53] op_sel:[0,0,0] op_sel_hi:[0,1,1]
    v_pk_fma_f32 v[62:63], v[94:95], v[46:47], v[54:55] op_sel:[0,0,0] op_sel_hi:[0,1,1]
    v_pk_fma_f32 v[40:41], v[88:89], v[40:41], v[56:57] op_sel:[1,1,0] op_sel_hi:[1,0,1] neg_lo:[1,0,0]
    v_pk_fma_f32 v[42:43], v[90:91], v[42:43], v[58:59] op_sel:[1,1,0] op_sel_hi:[1,0,1] neg_lo:[1,0,0]
    v_pk_fma_f32 v[44:45], v[92:93], v[44:45], v[60:61] op_sel:[1,1,0] op_sel_hi:[1,0,1] neg_lo:[1,0,0]
    v_pk_fma_f32 v[46:47], v[94:95], v[46:47], v[62:63] op_sel:[1,1,0] op_sel_hi:[1,0,1] neg_lo:[1,0,0]
    v_accvgpr_read_b32 v64, a192
    v_accvgpr_read_b32 v66, a196
    v_accvgpr_read_b32 v68, a200
    v_accvgpr_read_b32 v70, a204
    v_accvgpr_read_b32 v65, a208
    v_accvgpr_read_b32 v67, a212
    v_accvgpr_read_b32 v69, a216
    v_accvgpr_read_b32 v71, a220
    v_pk_fma_f32 v[56:57], v[88:89], v[40:41], v[64:65] op_sel:[0,0,0] op_sel_hi:[0,1,1]
    v_pk_fma_f32 v[58:59], v[90:91], v[42:43], v[66:67] op_sel:[0,0,0] op_sel_hi:[0,1,1]
    v_pk_fma_f32 v[60:61], v[92:93], v[44:45], v[68:69] op_sel:[0,0,0] op_sel_hi:[0,1,1]
    v_pk_fma_f32 v[62:63], v[94:95], v[46:47], v[70:71] op_sel:[0,0,0] op_sel_hi:[0,1,1]
    v_pk_fma_f32 v[40:41], v[88:89], v[40:41], v[56:57] op_sel:[1,1,0] op_sel_hi:[1,0,1] neg_lo:[1,0,0]
    v_pk_fma_f32 v[42:43], v[90:91], v[42:43], v[58:59] op_sel:[1,1,0] op_sel_hi:[1,0,1] neg_lo:[1,0,0]
    v_pk_fma_f32 v[44:45], v[92:93], v[44:45], v[60:61] op_sel:[1,1,0] op_sel_hi:[1,0,1] neg_lo:[1,0,0]
    v_pk_fma_f32 v[46:47], v[94:95], v[46:47], v[62:63] op_sel:[1,1,0] op_sel_hi:[1,0,1] neg_lo:[1,0,0]
    v_accvgpr_read_b32 v48, a193
    v_accvgpr_read_b32 v50, a197
    v_accvgpr_read_b32 v52, a201
    v_accvgpr_read_b32 v54, a205
    v_accvgpr_read_b32 v49, a209
    v_accvgpr_read_b32 v51, a213
    v_accvgpr_read_b32 v53, a217
    v_accvgpr_read_b32 v55, a221
    v_pk_fma_f32 v[56:57], v[88:89], v[40:41], v[48:49] op_sel:[0,0,0] op_sel_hi:[0,1,1]
    v_pk_fma_f32 v[58:59], v[90:91], v[42:43], v[50:51] op_sel:[0,0,0] op_sel_hi:[0,1,1]
    v_pk_fma_f32 v[60:61], v[92:93], v[44:45], v[52:53] op_sel:[0,0,0] op_sel_hi:[0,1,1]
    v_pk_fma_f32 v[62:63], v[94:95], v[46:47], v[54:55] op_sel:[0,0,0] op_sel_hi:[0,1,1]
    v_pk_fma_f32 v[40:41], v[88:89], v[40:41], v[56:57] op_sel:[1,1,0] op_sel_hi:[1,0,1] neg_lo:[1,0,0]
    v_pk_fma_f32 v[42:43], v[90:91], v[42:43], v[58:59] op_sel:[1,1,0] op_sel_hi:[1,0,1] neg_lo:[1,0,0]
    v_pk_fma_f32 v[44:45], v[92:93], v[44:45], v[60:61] op_sel:[1,1,0] op_sel_hi:[1,0,1] neg_lo:[1,0,0]
    v_pk_fma_f32 v[46:47], v[94:95], v[46:47], v[62:63] op_sel:[1,1,0] op_sel_hi:[1,0,1] neg_lo:[1,0,0]
    v_accvgpr_read_b32 v64, a194
    v_accvgpr_read_b32 v66, a198
    v_accvgpr_read_b32 v68, a202
    v_accvgpr_read_b32 v70, a206
    v_accvgpr_read_b32 v65, a210
    v_accvgpr_read_b32 v67, a214
    v_accvgpr_read_b32 v69, a218
    v_accvgpr_read_b32 v71, a222
    v_pk_fma_f32 v[56:57], v[88:89], v[40:41], v[64:65] op_sel:[0,0,0] op_sel_hi:[0,1,1]
    v_pk_fma_f32 v[58:59], v[90:91], v[42:43], v[66:67] op_sel:[0,0,0] op_sel_hi:[0,1,1]
    v_pk_fma_f32 v[60:61], v[92:93], v[44:45], v[68:69] op_sel:[0,0,0] op_sel_hi:[0,1,1]
    v_pk_fma_f32 v[62:63], v[94:95], v[46:47], v[70:71] op_sel:[0,0,0] op_sel_hi:[0,1,1]
    v_pk_fma_f32 v[40:41], v[88:89], v[40:41], v[56:57] op_sel:[1,1,0] op_sel_hi:[1,0,1] neg_lo:[1,0,0]
    v_pk_fma_f32 v[42:43], v[90:91], v[42:43], v[58:59] op_sel:[1,1,0] op_sel_hi:[1,0,1] neg_lo:[1,0,0]
    v_pk_fma_f32 v[44:45], v[92:93], v[44:45], v[60:61] op_sel:[1,1,0] op_sel_hi:[1,0,1] neg_lo:[1,0,0]
    v_pk_fma_f32 v[46:47], v[94:95], v[46:47], v[62:63] op_sel:[1,1,0] op_sel_hi:[1,0,1] neg_lo:[1,0,0]
    v_accvgpr_read_b32 v48, a195
    v_accvgpr_read_b32 v50, a199
    v_accvgpr_read_b32 v52, a203
    v_accvgpr_read_b32 v54, a207
    v_accvgpr_read_b32 v49, a211
    v_accvgpr_read_b32 v51, a215
    v_accvgpr_read_b32 v53, a219
    v_accvgpr_read_b32 v55, a223
    v_pk_fma_f32 v[56:57], v[88:89], v[40:41], v[48:49] op_sel:[0,0,0] op_sel_hi:[0,1,1]
    v_pk_fma_f32 v[58:59], v[90:91], v[42:43], v[50:51] op_sel:[0,0,0] op_sel_hi:[0,1,1]
    v_pk_fma_f32 v[60:61], v[92:93], v[44:45], v[52:53] op_sel:[0,0,0] op_sel_hi:[0,1,1]
    v_pk_fma_f32 v[62:63], v[94:95], v[46:47], v[54:55] op_sel:[0,0,0] op_sel_hi:[0,1,1]
    v_pk_fma_f32 v[40:41], v[88:89], v[40:41], v[56:57] op_sel:[1,1,0] op_sel_hi:[1,0,1] neg_lo:[1,0,0]
    v_pk_fma_f32 v[42:43], v[90:91], v[42:43], v[58:59] op_sel:[1,1,0] op_sel_hi:[1,0,1] neg_lo:[1,0,0]
    v_pk_fma_f32 v[44:45], v[92:93], v[44:45], v[60:61] op_sel:[1,1,0] op_sel_hi:[1,0,1] neg_lo:[1,0,0]
    v_pk_fma_f32 v[46:47], v[94:95], v[46:47], v[62:63] op_sel:[1,1,0] op_sel_hi:[1,0,1] neg_lo:[1,0,0]
    v_accvgpr_read_b32 v64, a224
    v_accvgpr_read_b32 v66, a228
    v_accvgpr_read_b32 v68, a232
    v_accvgpr_read_b32 v70, a236
    v_accvgpr_read_b32 v65, a240
    v_accvgpr_read_b32 v67, a244
    v_accvgpr_read_b32 v69, a248
    v_accvgpr_read_b32 v71, a252
    v_pk_fma_f32 v[56:57], v[88:89], v[40:41], v[64:65] op_sel:[0,0,0] op_sel_hi:[0,1,1]
    v_pk_fma_f32 v[58:59], v[90:91], v[42:43], v[66:67] op_sel:[0,0,0] op_sel_hi:[0,1,1]
    v_pk_fma_f32 v[60:61], v[92:93], v[44:45], v[68:69] op_sel:[0,0,0] op_sel_hi:[0,1,1]
    v_pk_fma_f32 v[62:63], v[94:95], v[46:47], v[70:71] op_sel:[0,0,0] op_sel_hi:[0,1,1]
    v_pk_fma_f32 v[40:41], v[88:89], v[40:41], v[56:57] op_sel:[1,1,0] op_sel_hi:[1,0,1] neg_lo:[1,0,0]
    v_pk_fma_f32 v[42:43], v[90:91], v[42:43], v[58:59] op_sel:[1,1,0] op_sel_hi:[1,0,1] neg_lo:[1,0,0]
    v_pk_fma_f32 v[44:45], v[92:93], v[44:45], v[60:61] op_sel:[1,1,0] op_sel_hi:[1,0,1] neg_lo:[1,0,0]
    v_pk_fma_f32 v[46:47], v[94:95], v[46:47], v[62:63] op_sel:[1,1,0] op_sel_hi:[1,0,1] neg_lo:[1,0,0]
    v_accvgpr_read_b32 v48, a225
    v_accvgpr_read_b32 v50, a229
    v_accvgpr_read_b32 v52, a233
    v_accvgpr_read_b32 v54, a237
    v_accvgpr_read_b32 v49, a241
    v_accvgpr_read_b32 v51, a245
    v_accvgpr_read_b32 v53, a249
    v_accvgpr_read_b32 v55, a253
    v_pk_fma_f32 v[56:57], v[88:89], v[40:41], v[48:49] op_sel:[0,0,0] op_sel_hi:[0,1,1]
    v_pk_fma_f32 v[58:59], v[90:91], v[42:43], v[50:51] op_sel:[0,0,0] op_sel_hi:[0,1,1]
    v_pk_fma_f32 v[60:61], v[92:93], v[44:45], v[52:53] op_sel:[0,0,0] op_sel_hi:[0,1,1]
    v_pk_fma_f32 v[62:63], v[94:95], v[46:47], v[54:55] op_sel:[0,0,0] op_sel_hi:[0,1,1]
    v_pk_fma_f32 v[40:41], v[88:89], v[40:41], v[56:57] op_sel:[1,1,0] op_sel_hi:[1,0,1] neg_lo:[1,0,0]
    v_pk_fma_f32 v[42:43], v[90:91], v[42:43], v[58:59] op_sel:[1,1,0] op_sel_hi:[1,0,1] neg_lo:[1,0,0]
    v_pk_fma_f32 v[44:45], v[92:93], v[44:45], v[60:61] op_sel:[1,1,0] op_sel_hi:[1,0,1] neg_lo:[1,0,0]
    v_pk_fma_f32 v[46:47], v[94:95], v[46:47], v[62:63] op_sel:[1,1,0] op_sel_hi:[1,0,1] neg_lo:[1,0,0]
    v_accvgpr_read_b32 v64, a226
    v_accvgpr_read_b32 v66, a230
    v_accvgpr_read_b32 v68, a234
    v_accvgpr_read_b32 v70, a238
    v_accvgpr_read_b32 v65, a242
    v_accvgpr_read_b32 v67, a246
    v_accvgpr_read_b32 v69, a250
    v_accvgpr_read_b32 v71, a254
    v_pk_fma_f32 v[56:57], v[88:89], v[40:41], v[64:65] op_sel:[0,0,0] op_sel_hi:[0,1,1]
    v_pk_fma_f32 v[58:59], v[90:91], v[42:43], v[66:67] op_sel:[0,0,0] op_sel_hi:[0,1,1]
    v_pk_fma_f32 v[60:61], v[92:93], v[44:45], v[68:69] op_sel:[0,0,0] op_sel_hi:[0,1,1]
    v_pk_fma_f32 v[62:63], v[94:95], v[46:47], v[70:71] op_sel:[0,0,0] op_sel_hi:[0,1,1]
    v_pk_fma_f32 v[40:41], v[88:89], v[40:41], v[56:57] op_sel:[1,1,0] op_sel_hi:[1,0,1] neg_lo:[1,0,0]
    v_pk_fma_f32 v[42:43], v[90:91], v[42:43], v[58:59] op_sel:[1,1,0] op_sel_hi:[1,0,1] neg_lo:[1,0,0]
    v_pk_fma_f32 v[44:45], v[92:93], v[44:45], v[60:61] op_sel:[1,1,0] op_sel_hi:[1,0,1] neg_lo:[1,0,0]
    v_pk_fma_f32 v[46:47], v[94:95], v[46:47], v[62:63] op_sel:[1,1,0] op_sel_hi:[1,0,1] neg_lo:[1,0,0]
    v_accvgpr_read_b32 v48, a227
    v_accvgpr_read_b32 v50, a231
    v_accvgpr_read_b32 v52, a235
    v_accvgpr_read_b32 v54, a239
    v_accvgpr_read_b32 v49, a243
    v_accvgpr_read_b32 v51, a247
    v_accvgpr_read_b32 v53, a251
    v_accvgpr_read_b32 v55, a255
    v_pk_fma_f32 v[56:57], v[88:89], v[40:41], v[48:49] op_sel:[0,0,0] op_sel_hi:[0,1,1]
    v_pk_fma_f32 v[58:59], v[90:91], v[42:43], v[50:51] op_sel:[0,0,0] op_sel_hi:[0,1,1]
    v_pk_fma_f32 v[60:61], v[92:93], v[44:45], v[52:53] op_sel:[0,0,0] op_sel_hi:[0,1,1]
    v_pk_fma_f32 v[62:63], v[94:95], v[46:47], v[54:55] op_sel:[0,0,0] op_sel_hi:[0,1,1]
    v_pk_fma_f32 v[40:41], v[88:89], v[40:41], v[56:57] op_sel:[1,1,0] op_sel_hi:[1,0,1] neg_lo:[1,0,0]
    v_pk_fma_f32 v[42:43], v[90:91], v[42:43], v[58:59] op_sel:[1,1,0] op_sel_hi:[1,0,1] neg_lo:[1,0,0]
    v_pk_fma_f32 v[44:45], v[92:93], v[44:45], v[60:61] op_sel:[1,1,0] op_sel_hi:[1,0,1] neg_lo:[1,0,0]
    v_pk_fma_f32 v[46:47], v[94:95], v[46:47], v[62:63] op_sel:[1,1,0] op_sel_hi:[1,0,1] neg_lo:[1,0,0]
    v_mov_b32 v64, v40
    v_mov_b32 v72, v40
    v_mov_b32 v65, v41
    v_mov_b32 v73, v41
    v_mov_b32 v66, v42
    v_mov_b32 v74, v42
    v_mov_b32 v67, v43
    v_mov_b32 v75, v43
    v_mov_b32 v68, v44
    v_mov_b32 v76, v44
    v_mov_b32 v69, v45
    v_mov_b32 v77, v45
    v_mov_b32 v70, v46
    v_mov_b32 v78, v46
    v_mov_b32 v71, v47
    v_mov_b32 v79, v47
    s_nop 1
    v_permlane16_swap_b32 v64, v72
    v_permlane16_swap_b32 v65, v73
    v_permlane16_swap_b32 v66, v74
    v_permlane16_swap_b32 v67, v75
    v_permlane16_swap_b32 v68, v76
    v_permlane16_swap_b32 v69, v77
    v_permlane16_swap_b32 v70, v78
    v_permlane16_swap_b32 v71, v79
    v_pk_fma_f32 v[56:57], v[104:105], v[64:65], v[72:73] op_sel:[0,0,0] op_sel_hi:[0,1,1]
    v_pk_fma_f32 v[58:59], v[106:107], v[66:67], v[74:75] op_sel:[0,0,0] op_sel_hi:[0,1,1]
    v_pk_fma_f32 v[60:61], v[108:109], v[68:69], v[76:77] op_sel:[0,0,0] op_sel_hi:[0,1,1]
    v_pk_fma_f32 v[62:63], v[110:111], v[70:71], v[78:79] op_sel:[0,0,0] op_sel_hi:[0,1,1]
    v_pk_fma_f32 v[80:81], v[104:105], v[64:65], v[56:57] op_sel:[1,1,0] op_sel_hi:[1,0,1] neg_lo:[1,0,0]
    v_pk_fma_f32 v[82:83], v[106:107], v[66:67], v[58:59] op_sel:[1,1,0] op_sel_hi:[1,0,1] neg_lo:[1,0,0]
    v_pk_fma_f32 v[84:85], v[108:109], v[68:69], v[60:61] op_sel:[1,1,0] op_sel_hi:[1,0,1] neg_lo:[1,0,0]
    v_pk_fma_f32 v[86:87], v[110:111], v[70:71], v[62:63] op_sel:[1,1,0] op_sel_hi:[1,0,1] neg_lo:[1,0,0]
    v_mov_b32 v24, v80
    v_mov_b32 v25, v81
    v_mov_b32 v26, v82
    v_mov_b32 v27, v83
    v_mov_b32 v28, v84
    v_mov_b32 v29, v85
    v_mov_b32 v30, v86
    v_mov_b32 v31, v87
    s_nop 1
    v_permlane32_swap_b32 v80, v24
    v_permlane32_swap_b32 v81, v25
    v_permlane32_swap_b32 v82, v26
    v_permlane32_swap_b32 v83, v27
    v_permlane32_swap_b32 v84, v28
    v_permlane32_swap_b32 v85, v29
    v_permlane32_swap_b32 v86, v30
    v_permlane32_swap_b32 v87, v31
    v_pk_fma_f32 v[56:57], v[112:113], v[80:81], v[24:25] op_sel:[0,0,0] op_sel_hi:[0,1,1]
    v_pk_fma_f32 v[58:59], v[114:115], v[82:83], v[26:27] op_sel:[0,0,0] op_sel_hi:[0,1,1]
    v_pk_fma_f32 v[60:61], v[116:117], v[84:85], v[28:29] op_sel:[0,0,0] op_sel_hi:[0,1,1]
    v_pk_fma_f32 v[62:63], v[118:119], v[86:87], v[30:31] op_sel:[0,0,0] op_sel_hi:[0,1,1]
    v_pk_fma_f32 v[40:41], v[112:113], v[80:81], v[56:57] op_sel:[1,1,0] op_sel_hi:[1,0,1] neg_lo:[1,0,0]
    v_pk_fma_f32 v[42:43], v[114:115], v[82:83], v[58:59] op_sel:[1,1,0] op_sel_hi:[1,0,1] neg_lo:[1,0,0]
    v_pk_fma_f32 v[44:45], v[116:117], v[84:85], v[60:61] op_sel:[1,1,0] op_sel_hi:[1,0,1] neg_lo:[1,0,0]
    v_pk_fma_f32 v[46:47], v[118:119], v[86:87], v[62:63] op_sel:[1,1,0] op_sel_hi:[1,0,1] neg_lo:[1,0,0]
    s_mov_b32 exec_lo, 0xffffffff
    s_mov_b32 exec_hi, 0xffffffff
    v_mov_b32 v122, v40
    v_mov_b32 v123, v41
    s_mov_b32 exec_lo, 0xffff0000
    s_mov_b32 exec_hi, 0xffffffff
    v_mov_b32 v122, v42
    v_mov_b32 v123, v43
    s_mov_b32 exec_lo, 0x0
    s_mov_b32 exec_hi, 0xffffffff
    v_mov_b32 v122, v44
    v_mov_b32 v123, v45
    s_mov_b32 exec_lo, 0x0
    s_mov_b32 exec_hi, 0xffff0000
    v_mov_b32 v122, v46
    v_mov_b32 v123, v47
    s_mov_b64 exec, -1
    v_min_u32 v122, 0xfffffffe, v122
    v_min_u32 v123, 0xfffffffe, v123
    s_and_b32 s53, s58, 1
    s_lshl1_add_u32 s53, s85, s53
    s_lshl_b32 s53, s53, 13
    s_lshr_b32 s29, s58, 1
    s_lshl1_add_u32 s29, s0, s29
    s_lshl_b32 s29, s29, 9
    s_add_u32 s53, s53, s29
    v_lshrrev_b32 v124, 1, v1
    v_add_u32 v124, s53, v124
    s_add_u32 s60, s100, 0x5900000
    s_addc_u32 s61, s101, 0
    s_and_b32 s61, s61, 0xffff
    s_mov_b32 s62, 0x20000
    s_mov_b32 s63, 0x00020000
    buffer_store_dwordx2 v[122:123], v124, s[60:63], 0 offen sc1
    v_subrev_u32 v160, 8192, v124
    v_subrev_u32 v161, 16384, v124
    v_subrev_u32 v162, 24576, v124
    v_subrev_u32 v163, 32768, v124
    v_subrev_u32 v164, 40960, v124
    v_subrev_u32 v165, 49152, v124
    v_subrev_u32 v166, 57344, v124
    v_subrev_u32 v167, 65536, v124
    v_subrev_u32 v168, 73728, v124
    v_subrev_u32 v169, 81920, v124
    v_subrev_u32 v170, 90112, v124
    v_subrev_u32 v171, 98304, v124
    v_subrev_u32 v172, 106496, v124
    v_subrev_u32 v173, 114688, v124
    v_subrev_u32 v174, 122880, v124
    s_mov_b32 s53, 0
L_lb_42:
    buffer_load_dwordx2 v[128:129], v160, s[60:63], 0 offen sc1
    buffer_load_dwordx2 v[130:131], v161, s[60:63], 0 offen sc1
    buffer_load_dwordx2 v[132:133], v162, s[60:63], 0 offen sc1
    buffer_load_dwordx2 v[134:135], v163, s[60:63], 0 offen sc1
    buffer_load_dwordx2 v[136:137], v164, s[60:63], 0 offen sc1
    buffer_load_dwordx2 v[138:139], v165, s[60:63], 0 offen sc1
    buffer_load_dwordx2 v[140:141], v166, s[60:63], 0 offen sc1
    buffer_load_dwordx2 v[142:143], v167, s[60:63], 0 offen sc1
    buffer_load_dwordx2 v[144:145], v168, s[60:63], 0 offen sc1
    buffer_load_dwordx2 v[146:147], v169, s[60:63], 0 offen sc1
    buffer_load_dwordx2 v[148:149], v170, s[60:63], 0 offen sc1
    buffer_load_dwordx2 v[150:151], v171, s[60:63], 0 offen sc1
    buffer_load_dwordx2 v[152:153], v172, s[60:63], 0 offen sc1
    buffer_load_dwordx2 v[154:155], v173, s[60:63], 0 offen sc1
    buffer_load_dwordx2 v[156:157], v174, s[60:63], 0 offen sc1
    s_add_u32 s53, s53, 1
    s_cmp_gt_u32 s53, 0x200000
    s_cbranch_scc1 chain_kernel_wabort
    s_waitcnt vmcnt(0)
    v_max_u32 v56, v128, v129
    v_max3_u32 v56, v56, v130, v131
    v_max3_u32 v56, v56, v132, v133
    v_max3_u32 v56, v56, v134, v135
    v_max3_u32 v56, v56, v136, v137
    v_max3_u32 v56, v56, v138, v139
    v_max3_u32 v56, v56, v140, v141
    v_max3_u32 v56, v56, v142, v143
    v_max3_u32 v56, v56, v144, v145
    v_max3_u32 v56, v56, v146, v147
    v_max3_u32 v56, v56, v148, v149
    v_max3_u32 v56, v56, v150, v151
    v_max3_u32 v56, v56, v152, v153
    v_max3_u32 v56, v56, v154, v155
    v_max3_u32 v56, v56, v156, v157
    v_cmp_eq_u32 vcc, -1, v56
    s_cbranch_vccnz L_lb_42
    v_pk_fma_f32 v[56:57], v[120:121], v[156:157], v[154:155] op_sel:[0,0,0] op_sel_hi:[0,1,1]
    v_pk_fma_f32 v[154:155], v[120:121], v[156:157], v[56:57] op_sel:[1,1,0] op_sel_hi:[1,0,1] neg_lo:[1,0,0]
    v_pk_fma_f32 v[56:57], v[120:121], v[154:155], v[152:153] op_sel:[0,0,0] op_sel_hi:[0,1,1]
    v_pk_fma_f32 v[152:153], v[120:121], v[154:155], v[56:57] op_sel:[1,1,0] op_sel_hi:[1,0,1] neg_lo:[1,0,0]
    v_pk_fma_f32 v[56:57], v[120:121], v[152:153], v[150:151] op_sel:[0,0,0] op_sel_hi:[0,1,1]
    v_pk_fma_f32 v[150:151], v[120:121], v[152:153], v[56:57] op_sel:[1,1,0] op_sel_hi:[1,0,1] neg_lo:[1,0,0]
    v_pk_fma_f32 v[56:57], v[120:121], v[150:151], v[148:149] op_sel:[0,0,0] op_sel_hi:[0,1,1]
    v_pk_fma_f32 v[148:149], v[120:121], v[150:151], v[56:57] op_sel:[1,1,0] op_sel_hi:[1,0,1] neg_lo:[1,0,0]
    v_pk_fma_f32 v[56:57], v[120:121], v[148:149], v[146:147] op_sel:[0,0,0] op_sel_hi:[0,1,1]
    v_pk_fma_f32 v[146:147], v[120:121], v[148:149], v[56:57] op_sel:[1,1,0] op_sel_hi:[1,0,1] neg_lo:[1,0,0]
    v_pk_fma_f32 v[56:57], v[120:121], v[146:147], v[144:145] op_sel:[0,0,0] op_sel_hi:[0,1,1]
    v_pk_fma_f32 v[144:145], v[120:121], v[146:147], v[56:57] op_sel:[1,1,0] op_sel_hi:[1,0,1] neg_lo:[1,0,0]
    v_pk_fma_f32 v[56:57], v[120:121], v[144:145], v[142:143] op_sel:[0,0,0] op_sel_hi:[0,1,1]
    v_pk_fma_f32 v[142:143], v[120:121], v[144:145], v[56:57] op_sel:[1,1,0] op_sel_hi:[1,0,1] neg_lo:[1,0,0]
    v_pk_fma_f32 v[56:57], v[120:121], v[142:143], v[140:141] op_sel:[0,0,0] op_sel_hi:[0,1,1]
    v_pk_fma_f32 v[140:141], v[120:121], v[142:143], v[56:57] op_sel:[1,1,0] op_sel_hi:[1,0,1] neg_lo:[1,0,0]
    v_pk_fma_f32 v[56:57], v[120:121], v[140:141], v[138:139] op_sel:[0,0,0] op_sel_hi:[0,1,1]
    v_pk_fma_f32 v[138:139], v[120:121], v[140:141], v[56:57] op_sel:[1,1,0] op_sel_hi:[1,0,1] neg_lo:[1,0,0]
    v_pk_fma_f32 v[56:57], v[120:121], v[138:139], v[136:137] op_sel:[0,0,0] op_sel_hi:[0,1,1]
    v_pk_fma_f32 v[136:137], v[120:121], v[138:139], v[56:57] op_sel:[1,1,0] op_sel_hi:[1,0,1] neg_lo:[1,0,0]
    v_pk_fma_f32 v[56:57], v[120:121], v[136:137], v[134:135] op_sel:[0,0,0] op_sel_hi:[0,1,1]
    v_pk_fma_f32 v[134:135], v[120:121], v[136:137], v[56:57] op_sel:[1,1,0] op_sel_hi:[1,0,1] neg_lo:[1,0,0]
    v_pk_fma_f32 v[56:57], v[120:121], v[134:135], v[132:133] op_sel:[0,0,0] op_sel_hi:[0,1,1]
    v_pk_fma_f32 v[132:133], v[120:121], v[134:135], v[56:57] op_sel:[1,1,0] op_sel_hi:[1,0,1] neg_lo:[1,0,0]
    v_pk_fma_f32 v[56:57], v[120:121], v[132:133], v[130:131] op_sel:[0,0,0] op_sel_hi:[0,1,1]
    v_pk_fma_f32 v[130:131], v[120:121], v[132:133], v[56:57] op_sel:[1,1,0] op_sel_hi:[1,0,1] neg_lo:[1,0,0]
    v_pk_fma_f32 v[56:57], v[120:121], v[130:131], v[128:129] op_sel:[0,0,0] op_sel_hi:[0,1,1]
    v_pk_fma_f32 v[128:129], v[120:121], v[130:131], v[56:57] op_sel:[1,1,0] op_sel_hi:[1,0,1] neg_lo:[1,0,0]
    v_mov_b32 v32, v128
    v_mov_b32 v34, v128
    v_mov_b32 v33, v129
    v_mov_b32 v35, v129
    s_nop 1
    v_permlane16_swap_b32 v32, v34
    v_permlane16_swap_b32 v33, v35
    v_mov_b32 v36, v32
    v_mov_b32 v37, v33
    v_mov_b32 v38, v34
    v_mov_b32 v39, v35
    s_nop 1
    v_permlane32_swap_b32 v32, v36
    v_permlane32_swap_b32 v33, v37
    v_permlane32_swap_b32 v34, v38
    v_permlane32_swap_b32 v35, v39
    s_mov_b32 exec_lo, 0
    v_pk_fma_f32 v[56:57], v[112:113], v[32:33], v[80:81] op_sel:[0,0,0] op_sel_hi:[0,1,1]
    v_pk_fma_f32 v[58:59], v[114:115], v[34:35], v[82:83] op_sel:[0,0,0] op_sel_hi:[0,1,1]
    v_pk_fma_f32 v[60:61], v[116:117], v[36:37], v[84:85] op_sel:[0,0,0] op_sel_hi:[0,1,1]
    v_pk_fma_f32 v[62:63], v[118:119], v[38:39], v[86:87] op_sel:[0,0,0] op_sel_hi:[0,1,1]
    v_pk_fma_f32 v[32:33], v[112:113], v[32:33], v[56:57] op_sel:[1,1,0] op_sel_hi:[1,0,1] neg_lo:[1,0,0]
    v_pk_fma_f32 v[34:35], v[114:115], v[34:35], v[58:59] op_sel:[1,1,0] op_sel_hi:[1,0,1] neg_lo:[1,0,0]
    v_pk_fma_f32 v[36:37], v[116:117], v[36:37], v[60:61] op_sel:[1,1,0] op_sel_hi:[1,0,1] neg_lo:[1,0,0]
    v_pk_fma_f32 v[38:39], v[118:119], v[38:39], v[62:63] op_sel:[1,1,0] op_sel_hi:[1,0,1] neg_lo:[1,0,0]
    s_mov_b32 exec_lo, 0xffff0000
    s_mov_b32 exec_hi, 0xffff0000
    v_pk_fma_f32 v[56:57], v[104:105], v[32:33], v[64:65] op_sel:[0,0,0] op_sel_hi:[0,1,1]
    v_pk_fma_f32 v[58:59], v[106:107], v[34:35], v[66:67] op_sel:[0,0,0] op_sel_hi:[0,1,1]
    v_pk_fma_f32 v[60:61], v[108:109], v[36:37], v[68:69] op_sel:[0,0,0] op_sel_hi:[0,1,1]
    v_pk_fma_f32 v[62:63], v[110:111], v[38:39], v[70:71] op_sel:[0,0,0] op_sel_hi:[0,1,1]
    v_pk_fma_f32 v[32:33], v[104:105], v[32:33], v[56:57] op_sel:[1,1,0] op_sel_hi:[1,0,1] neg_lo:[1,0,0]
    v_pk_fma_f32 v[34:35], v[106:107], v[34:35], v[58:59] op_sel:[1,1,0] op_sel_hi:[1,0,1] neg_lo:[1,0,0]
    v_pk_fma_f32 v[36:37], v[108:109], v[36:37], v[60:61] op_sel:[1,1,0] op_sel_hi:[1,0,1] neg_lo:[1,0,0]
    v_pk_fma_f32 v[38:39], v[110:111], v[38:39], v[62:63] op_sel:[1,1,0] op_sel_hi:[1,0,1] neg_lo:[1,0,0]
    s_mov_b64 exec, -1
    v_accvgpr_read_b32 v64, a0
    v_accvgpr_read_b32 v66, a4
    v_accvgpr_read_b32 v68, a8
    v_accvgpr_read_b32 v70, a12
    v_accvgpr_read_b32 v65, a16
    v_accvgpr_read_b32 v67, a20
    v_accvgpr_read_b32 v69, a24
    v_accvgpr_read_b32 v71, a28
    v_pk_fma_f32 v[56:57], v[88:89], v[32:33], v[64:65] op_sel:[0,0,0] op_sel_hi:[0,1,1]
    v_pk_fma_f32 v[58:59], v[90:91], v[34:35], v[66:67] op_sel:[0,0,0] op_sel_hi:[0,1,1]
    v_pk_fma_f32 v[60:61], v[92:93], v[36:37], v[68:69] op_sel:[0,0,0] op_sel_hi:[0,1,1]
    v_pk_fma_f32 v[62:63], v[94:95], v[38:39], v[70:71] op_sel:[0,0,0] op_sel_hi:[0,1,1]
    v_pk_fma_f32 v[32:33], v[88:89], v[32:33], v[56:57] op_sel:[1,1,0] op_sel_hi:[1,0,1] neg_lo:[1,0,0]
    v_pk_fma_f32 v[34:35], v[90:91], v[34:35], v[58:59] op_sel:[1,1,0] op_sel_hi:[1,0,1] neg_lo:[1,0,0]
    v_pk_fma_f32 v[36:37], v[92:93], v[36:37], v[60:61] op_sel:[1,1,0] op_sel_hi:[1,0,1] neg_lo:[1,0,0]
    v_pk_fma_f32 v[38:39], v[94:95], v[38:39], v[62:63] op_sel:[1,1,0] op_sel_hi:[1,0,1] neg_lo:[1,0,0]
    v_pk_mul_f32 v[40:41], v[96:97], v[32:33] op_sel:[0,0] op_sel_hi:[0,1]
    v_pk_mul_f32 v[42:43], v[98:99], v[34:35] op_sel:[0,0] op_sel_hi:[0,1]
    v_pk_mul_f32 v[44:45], v[100:101], v[36:37] op_sel:[0,0] op_sel_hi:[0,1]
    v_pk_mul_f32 v[46:47], v[102:103], v[38:39] op_sel:[0,0] op_sel_hi:[0,1]
    v_pk_fma_f32 v[72:73], v[96:97], v[32:33], v[40:41] op_sel:[1,1,0] op_sel_hi:[1,0,1] neg_lo:[1,0,0] neg_hi:[1,0,1]
    v_pk_fma_f32 v[74:75], v[98:99], v[34:35], v[42:43] op_sel:[1,1,0] op_sel_hi:[1,0,1] neg_lo:[1,0,0] neg_hi:[1,0,1]
    v_pk_fma_f32 v[76:77], v[100:101], v[36:37], v[44:45] op_sel:[1,1,0] op_sel_hi:[1,0,1] neg_lo:[1,0,0] neg_hi:[1,0,1]
    v_pk_fma_f32 v[78:79], v[102:103], v[38:39], v[46:47] op_sel:[1,1,0] op_sel_hi:[1,0,1] neg_lo:[1,0,0] neg_hi:[1,0,1]
    v_accvgpr_read_b32 v48, a1
    v_accvgpr_read_b32 v50, a5
    v_accvgpr_read_b32 v52, a9
    v_accvgpr_read_b32 v54, a13
    v_accvgpr_read_b32 v49, a17
    v_accvgpr_read_b32 v51, a21
    v_accvgpr_read_b32 v53, a25
    v_accvgpr_read_b32 v55, a29
    v_pk_fma_f32 v[56:57], v[88:89], v[32:33], v[48:49] op_sel:[0,0,0] op_sel_hi:[0,1,1]
    v_pk_fma_f32 v[58:59], v[90:91], v[34:35], v[50:51] op_sel:[0,0,0] op_sel_hi:[0,1,1]
    v_pk_fma_f32 v[60:61], v[92:93], v[36:37], v[52:53] op_sel:[0,0,0] op_sel_hi:[0,1,1]
    v_pk_fma_f32 v[62:63], v[94:95], v[38:39], v[54:55] op_sel:[0,0,0] op_sel_hi:[0,1,1]
    v_pk_fma_f32 v[32:33], v[88:89], v[32:33], v[56:57] op_sel:[1,1,0] op_sel_hi:[1,0,1] neg_lo:[1,0,0]
    v_pk_fma_f32 v[34:35], v[90:91], v[34:35], v[58:59] op_sel:[1,1,0] op_sel_hi:[1,0,1] neg_lo:[1,0,0]
    v_pk_fma_f32 v[36:37], v[92:93], v[36:37], v[60:61] op_sel:[1,1,0] op_sel_hi:[1,0,1] neg_lo:[1,0,0]
    v_pk_fma_f32 v[38:39], v[94:95], v[38:39], v[62:63] op_sel:[1,1,0] op_sel_hi:[1,0,1] neg_lo:[1,0,0]
    v_pk_mul_f32 v[40:41], v[96:97], v[32:33] op_sel:[0,0] op_sel_hi:[0,1]
    v_pk_mul_f32 v[42:43], v[98:99], v[34:35] op_sel:[0,0] op_sel_hi:[0,1]
    v_pk_mul_f32 v[44:45], v[100:101], v[36:37] op_sel:[0,0] op_sel_hi:[0,1]
    v_pk_mul_f32 v[46:47], v[102:103], v[38:39] op_sel:[0,0] op_sel_hi:[0,1]
    v_pk_fma_f32 v[80:81], v[96:97], v[32:33], v[40:41] op_sel:[1,1,0] op_sel_hi:[1,0,1] neg_lo:[1,0,0] neg_hi:[1,0,1]
    v_pk_fma_f32 v[82:83], v[98:99], v[34:35], v[42:43] op_sel:[1,1,0] op_sel_hi:[1,0,1] neg_lo:[1,0,0] neg_hi:[1,0,1]
    v_pk_fma_f32 v[84:85], v[100:101], v[36:37], v[44:45] op_sel:[1,1,0] op_sel_hi:[1,0,1] neg_lo:[1,0,0] neg_hi:[1,0,1]
    v_pk_fma_f32 v[86:87], v[102:103], v[38:39], v[46:47] op_sel:[1,1,0] op_sel_hi:[1,0,1] neg_lo:[1,0,0] neg_hi:[1,0,1]
    v_cvt_pk_bf16_f32 v128, v72, v80
    v_cvt_pk_bf16_f32 v136, v74, v82
    v_cvt_pk_bf16_f32 v144, v76, v84
    v_cvt_pk_bf16_f32 v152, v78, v86
    v_cvt_pk_bf16_f32 v192, v73, v81
    v_cvt_pk_bf16_f32 v200, v75, v83
    v_cvt_pk_bf16_f32 v208, v77, v85
    v_cvt_pk_bf16_f32 v216, v79, v87
    v_accvgpr_read_b32 v64, a2
    v_accvgpr_read_b32 v66, a6
    v_accvgpr_read_b32 v68, a10
    v_accvgpr_read_b32 v70, a14
    v_accvgpr_read_b32 v65, a18
    v_accvgpr_read_b32 v67, a22
    v_accvgpr_read_b32 v69, a26
    v_accvgpr_read_b32 v71, a30
    v_pk_fma_f32 v[56:57], v[88:89], v[32:33], v[64:65] op_sel:[0,0,0] op_sel_hi:[0,1,1]
    v_pk_fma_f32 v[58:59], v[90:91], v[34:35], v[66:67] op_sel:[0,0,0] op_sel_hi:[0,1,1]
    v_pk_fma_f32 v[60:61], v[92:93], v[36:37], v[68:69] op_sel:[0,0,0] op_sel_hi:[0,1,1]
    v_pk_fma_f32 v[62:63], v[94:95], v[38:39], v[70:71] op_sel:[0,0,0] op_sel_hi:[0,1,1]
    v_pk_fma_f32 v[32:33], v[88:89], v[32:33], v[56:57] op_sel:[1,1,0] op_sel_hi:[1,0,1] neg_lo:[1,0,0]
    v_pk_fma_f32 v[34:35], v[90:91], v[34:35], v[58:59] op_sel:[1,1,0] op_sel_hi:[1,0,1] neg_lo:[1,0,0]
    v_pk_fma_f32 v[36:37], v[92:93], v[36:37], v[60:61] op_sel:[1,1,0] op_sel_hi:[1,0,1] neg_lo:[1,0,0]
    v_pk_fma_f32 v[38:39], v[94:95], v[38:39], v[62:63] op_sel:[1,1,0] op_sel_hi:[1,0,1] neg_lo:[1,0,0]
    v_pk_mul_f32 v[40:41], v[96:97], v[32:33] op_sel:[0,0] op_sel_hi:[0,1]
    v_pk_mul_f32 v[42:43], v[98:99], v[34:35] op_sel:[0,0] op_sel_hi:[0,1]
    v_pk_mul_f32 v[44:45], v[100:101], v[36:37] op_sel:[0,0] op_sel_hi:[0,1]
    v_pk_mul_f32 v[46:47], v[102:103], v[38:39] op_sel:[0,0] op_sel_hi:[0,1]
    v_pk_fma_f32 v[72:73], v[96:97], v[32:33], v[40:41] op_sel:[1,1,0] op_sel_hi:[1,0,1] neg_lo:[1,0,0] neg_hi:[1,0,1]
    v_pk_fma_f32 v[74:75], v[98:99], v[34:35], v[42:43] op_sel:[1,1,0] op_sel_hi:[1,0,1] neg_lo:[1,0,0] neg_hi:[1,0,1]
    v_pk_fma_f32 v[76:77], v[100:101], v[36:37], v[44:45] op_sel:[1,1,0] op_sel_hi:[1,0,1] neg_lo:[1,0,0] neg_hi:[1,0,1]
    v_pk_fma_f32 v[78:79], v[102:103], v[38:39], v[46:47] op_sel:[1,1,0] op_sel_hi:[1,0,1] neg_lo:[1,0,0] neg_hi:[1,0,1]
    v_accvgpr_read_b32 v48, a3
    v_accvgpr_read_b32 v50, a7
    v_accvgpr_read_b32 v52, a11
    v_accvgpr_read_b32 v54, a15
    v_accvgpr_read_b32 v49, a19
    v_accvgpr_read_b32 v51, a23
    v_accvgpr_read_b32 v53, a27
    v_accvgpr_read_b32 v55, a31
    v_pk_fma_f32 v[56:57], v[88:89], v[32:33], v[48:49] op_sel:[0,0,0] op_sel_hi:[0,1,1]
    v_pk_fma_f32 v[58:59], v[90:91], v[34:35], v[50:51] op_sel:[0,0,0] op_sel_hi:[0,1,1]
    v_pk_fma_f32 v[60:61], v[92:93], v[36:37], v[52:53] op_sel:[0,0,0] op_sel_hi:[0,1,1]
    v_pk_fma_f32 v[62:63], v[94:95], v[38:39], v[54:55] op_sel:[0,0,0] op_sel_hi:[0,1,1]
    v_pk_fma_f32 v[32:33], v[88:89], v[32:33], v[56:57] op_sel:[1,1,0] op_sel_hi:[1,0,1] neg_lo:[1,0,0]
    v_pk_fma_f32 v[34:35], v[90:91], v[34:35], v[58:59] op_sel:[1,1,0] op_sel_hi:[1,0,1] neg_lo:[1,0,0]
    v_pk_fma_f32 v[36:37], v[92:93], v[36:37], v[60:61] op_sel:[1,1,0] op_sel_hi:[1,0,1] neg_lo:[1,0,0]
    v_pk_fma_f32 v[38:39], v[94:95], v[38:39], v[62:63] op_sel:[1,1,0] op_sel_hi:[1,0,1] neg_lo:[1,0,0]
    v_pk_mul_f32 v[40:41], v[96:97], v[32:33] op_sel:[0,0] op_sel_hi:[0,1]
    v_pk_mul_f32 v[42:43], v[98:99], v[34:35] op_sel:[0,0] op_sel_hi:[0,1]
    v_pk_mul_f32 v[44:45], v[100:101], v[36:37] op_sel:[0,0] op_sel_hi:[0,1]
    v_pk_mul_f32 v[46:47], v[102:103], v[38:39] op_sel:[0,0] op_sel_hi:[0,1]
    v_pk_fma_f32 v[80:81], v[96:97], v[32:33], v[40:41] op_sel:[1,1,0] op_sel_hi:[1,0,1] neg_lo:[1,0,0] neg_hi:[1,0,1]
    v_pk_fma_f32 v[82:83], v[98:99], v[34:35], v[42:43] op_sel:[1,1,0] op_sel_hi:[1,0,1] neg_lo:[1,0,0] neg_hi:[1,0,1]
    v_pk_fma_f32 v[84:85], v[100:101], v[36:37], v[44:45] op_sel:[1,1,0] op_sel_hi:[1,0,1] neg_lo:[1,0,0] neg_hi:[1,0,1]
    v_pk_fma_f32 v[86:87], v[102:103], v[38:39], v[46:47] op_sel:[1,1,0] op_sel_hi:[1,0,1] neg_lo:[1,0,0] neg_hi:[1,0,1]
    v_cvt_pk_bf16_f32 v129, v72, v80
    v_cvt_pk_bf16_f32 v137, v74, v82
    v_cvt_pk_bf16_f32 v145, v76, v84
    v_cvt_pk_bf16_f32 v153, v78, v86
    v_cvt_pk_bf16_f32 v193, v73, v81
    v_cvt_pk_bf16_f32 v201, v75, v83
    v_cvt_pk_bf16_f32 v209, v77, v85
    v_cvt_pk_bf16_f32 v217, v79, v87
    v_accvgpr_read_b32 v64, a32
    v_accvgpr_read_b32 v66, a36
    v_accvgpr_read_b32 v68, a40
    v_accvgpr_read_b32 v70, a44
    v_accvgpr_read_b32 v65, a48
    v_accvgpr_read_b32 v67, a52
    v_accvgpr_read_b32 v69, a56
    v_accvgpr_read_b32 v71, a60
    v_pk_fma_f32 v[56:57], v[88:89], v[32:33], v[64:65] op_sel:[0,0,0] op_sel_hi:[0,1,1]
    v_pk_fma_f32 v[58:59], v[90:91], v[34:35], v[66:67] op_sel:[0,0,0] op_sel_hi:[0,1,1]
    v_pk_fma_f32 v[60:61], v[92:93], v[36:37], v[68:69] op_sel:[0,0,0] op_sel_hi:[0,1,1]
    v_pk_fma_f32 v[62:63], v[94:95], v[38:39], v[70:71] op_sel:[0,0,0] op_sel_hi:[0,1,1]
    v_pk_fma_f32 v[32:33], v[88:89], v[32:33], v[56:57] op_sel:[1,1,0] op_sel_hi:[1,0,1] neg_lo:[1,0,0]
    v_pk_fma_f32 v[34:35], v[90:91], v[34:35], v[58:59] op_sel:[1,1,0] op_sel_hi:[1,0,1] neg_lo:[1,0,0]
    v_pk_fma_f32 v[36:37], v[92:93], v[36:37], v[60:61] op_sel:[1,1,0] op_sel_hi:[1,0,1] neg_lo:[1,0,0]
    v_pk_fma_f32 v[38:39], v[94:95], v[38:39], v[62:63] op_sel:[1,1,0] op_sel_hi:[1,0,1] neg_lo:[1,0,0]
    v_pk_mul_f32 v[40:41], v[96:97], v[32:33] op_sel:[0,0] op_sel_hi:[0,1]
    v_pk_mul_f32 v[42:43], v[98:99], v[34:35] op_sel:[0,0] op_sel_hi:[0,1]
    v_pk_mul_f32 v[44:45], v[100:101], v[36:37] op_sel:[0,0] op_sel_hi:[0,1]
    v_pk_mul_f32 v[46:47], v[102:103], v[38:39] op_sel:[0,0] op_sel_hi:[0,1]
    v_pk_fma_f32 v[72:73], v[96:97], v[32:33], v[40:41] op_sel:[1,1,0] op_sel_hi:[1,0,1] neg_lo:[1,0,0] neg_hi:[1,0,1]
    v_pk_fma_f32 v[74:75], v[98:99], v[34:35], v[42:43] op_sel:[1,1,0] op_sel_hi:[1,0,1] neg_lo:[1,0,0] neg_hi:[1,0,1]
    v_pk_fma_f32 v[76:77], v[100:101], v[36:37], v[44:45] op_sel:[1,1,0] op_sel_hi:[1,0,1] neg_lo:[1,0,0] neg_hi:[1,0,1]
    v_pk_fma_f32 v[78:79], v[102:103], v[38:39], v[46:47] op_sel:[1,1,0] op_sel_hi:[1,0,1] neg_lo:[1,0,0] neg_hi:[1,0,1]
    v_accvgpr_read_b32 v48, a33
    v_accvgpr_read_b32 v50, a37
    v_accvgpr_read_b32 v52, a41
    v_accvgpr_read_b32 v54, a45
    v_accvgpr_read_b32 v49, a49
    v_accvgpr_read_b32 v51, a53
    v_accvgpr_read_b32 v53, a57
    v_accvgpr_read_b32 v55, a61
    v_pk_fma_f32 v[56:57], v[88:89], v[32:33], v[48:49] op_sel:[0,0,0] op_sel_hi:[0,1,1]
    v_pk_fma_f32 v[58:59], v[90:91], v[34:35], v[50:51] op_sel:[0,0,0] op_sel_hi:[0,1,1]
    v_pk_fma_f32 v[60:61], v[92:93], v[36:37], v[52:53] op_sel:[0,0,0] op_sel_hi:[0,1,1]
    v_pk_fma_f32 v[62:63], v[94:95], v[38:39], v[54:55] op_sel:[0,0,0] op_sel_hi:[0,1,1]
    v_pk_fma_f32 v[32:33], v[88:89], v[32:33], v[56:57] op_sel:[1,1,0] op_sel_hi:[1,0,1] neg_lo:[1,0,0]
    v_pk_fma_f32 v[34:35], v[90:91], v[34:35], v[58:59] op_sel:[1,1,0] op_sel_hi:[1,0,1] neg_lo:[1,0,0]
    v_pk_fma_f32 v[36:37], v[92:93], v[36:37], v[60:61] op_sel:[1,1,0] op_sel_hi:[1,0,1] neg_lo:[1,0,0]
    v_pk_fma_f32 v[38:39], v[94:95], v[38:39], v[62:63] op_sel:[1,1,0] op_sel_hi:[1,0,1] neg_lo:[1,0,0]
    v_pk_mul_f32 v[40:41], v[96:97], v[32:33] op_sel:[0,0] op_sel_hi:[0,1]
    v_pk_mul_f32 v[42:43], v[98:99], v[34:35] op_sel:[0,0] op_sel_hi:[0,1]
    v_pk_mul_f32 v[44:45], v[100:101], v[36:37] op_sel:[0,0] op_sel_hi:[0,1]
    v_pk_mul_f32 v[46:47], v[102:103], v[38:39] op_sel:[0,0] op_sel_hi:[0,1]
    v_pk_fma_f32 v[80:81], v[96:97], v[32:33], v[40:41] op_sel:[1,1,0] op_sel_hi:[1,0,1] neg_lo:[1,0,0] neg_hi:[1,0,1]
    v_pk_fma_f32 v[82:83], v[98:99], v[34:35], v[42:43] op_sel:[1,1,0] op_sel_hi:[1,0,1] neg_lo:[1,0,0] neg_hi:[1,0,1]
    v_pk_fma_f32 v[84:85], v[100:101], v[36:37], v[44:45] op_sel:[1,1,0] op_sel_hi:[1,0,1] neg_lo:[1,0,0] neg_hi:[1,0,1]
    v_pk_fma_f32 v[86:87], v[102:103], v[38:39], v[46:47] op_sel:[1,1,0] op_sel_hi:[1,0,1] neg_lo:[1,0,0] neg_hi:[1,0,1]
    v_cvt_pk_bf16_f32 v130, v72, v80
    v_cvt_pk_bf16_f32 v138, v74, v82
    v_cvt_pk_bf16_f32 v146, v76, v84
    v_cvt_pk_bf16_f32 v154, v78, v86
    v_cvt_pk_bf16_f32 v194, v73, v81
    v_cvt_pk_bf16_f32 v202, v75, v83
    v_cvt_pk_bf16_f32 v210, v77, v85
    v_cvt_pk_bf16_f32 v218, v79, v87
    v_accvgpr_read_b32 v64, a34
    v_accvgpr_read_b32 v66, a38
    v_accvgpr_read_b32 v68, a42
    v_accvgpr_read_b32 v70, a46
    v_accvgpr_read_b32 v65, a50
    v_accvgpr_read_b32 v67, a54
    v_accvgpr_read_b32 v69, a58
    v_accvgpr_read_b32 v71, a62
    v_pk_fma_f32 v[56:57], v[88:89], v[32:33], v[64:65] op_sel:[0,0,0] op_sel_hi:[0,1,1]
    v_pk_fma_f32 v[58:59], v[90:91], v[34:35], v[66:67] op_sel:[0,0,0] op_sel_hi:[0,1,1]
    v_pk_fma_f32 v[60:61], v[92:93], v[36:37], v[68:69] op_sel:[0,0,0] op_sel_hi:[0,1,1]
    v_pk_fma_f32 v[62:63], v[94:95], v[38:39], v[70:71] op_sel:[0,0,0] op_sel_hi:[0,1,1]
    v_pk_fma_f32 v[32:33], v[88:89], v[32:33], v[56:57] op_sel:[1,1,0] op_sel_hi:[1,0,1] neg_lo:[1,0,0]
    v_pk_fma_f32 v[34:35], v[90:91], v[34:35], v[58:59] op_sel:[1,1,0] op_sel_hi:[1,0,1] neg_lo:[1,0,0]
    v_pk_fma_f32 v[36:37], v[92:93], v[36:37], v[60:61] op_sel:[1,1,0] op_sel_hi:[1,0,1] neg_lo:[1,0,0]
    v_pk_fma_f32 v[38:39], v[94:95], v[38:39], v[62:63] op_sel:[1,1,0] op_sel_hi:[1,0,1] neg_lo:[1,0,0]
    v_pk_mul_f32 v[40:41], v[96:97], v[32:33] op_sel:[0,0] op_sel_hi:[0,1]
    v_pk_mul_f32 v[42:43], v[98:99], v[34:35] op_sel:[0,0] op_sel_hi:[0,1]
    v_pk_mul_f32 v[44:45], v[100:101], v[36:37] op_sel:[0,0] op_sel_hi:[0,1]
    v_pk_mul_f32 v[46:47], v[102:103], v[38:39] op_sel:[0,0] op_sel_hi:[0,1]
    v_pk_fma_f32 v[72:73], v[96:97], v[32:33], v[40:41] op_sel:[1,1,0] op_sel_hi:[1,0,1] neg_lo:[1,0,0] neg_hi:[1,0,1]
    v_pk_fma_f32 v[74:75], v[98:99], v[34:35], v[42:43] op_sel:[1,1,0] op_sel_hi:[1,0,1] neg_lo:[1,0,0] neg_hi:[1,0,1]
    v_pk_fma_f32 v[76:77], v[100:101], v[36:37], v[44:45] op_sel:[1,1,0] op_sel_hi:[1,0,1] neg_lo:[1,0,0] neg_hi:[1,0,1]
    v_pk_fma_f32 v[78:79], v[102:103], v[38:39], v[46:47] op_sel:[1,1,0] op_sel_hi:[1,0,1] neg_lo:[1,0,0] neg_hi:[1,0,1]
    v_accvgpr_read_b32 v48, a35
    v_accvgpr_read_b32 v50, a39
    v_accvgpr_read_b32 v52, a43
    v_accvgpr_read_b32 v54, a47
    v_accvgpr_read_b32 v49, a51
    v_accvgpr_read_b32 v51, a55
    v_accvgpr_read_b32 v53, a59
    v_accvgpr_read_b32 v55, a63
    v_pk_fma_f32 v[56:57], v[88:89], v[32:33], v[48:49] op_sel:[0,0,0] op_sel_hi:[0,1,1]
    v_pk_fma_f32 v[58:59], v[90:91], v[34:35], v[50:51] op_sel:[0,0,0] op_sel_hi:[0,1,1]
    v_pk_fma_f32 v[60:61], v[92:93], v[36:37], v[52:53] op_sel:[0,0,0] op_sel_hi:[0,1,1]
    v_pk_fma_f32 v[62:63], v[94:95], v[38:39], v[54:55] op_sel:[0,0,0] op_sel_hi:[0,1,1]
    v_pk_fma_f32 v[32:33], v[88:89], v[32:33], v[56:57] op_sel:[1,1,0] op_sel_hi:[1,0,1] neg_lo:[1,0,0]
    v_pk_fma_f32 v[34:35], v[90:91], v[34:35], v[58:59] op_sel:[1,1,0] op_sel_hi:[1,0,1] neg_lo:[1,0,0]
    v_pk_fma_f32 v[36:37], v[92:93], v[36:37], v[60:61] op_sel:[1,1,0] op_sel_hi:[1,0,1] neg_lo:[1,0,0]
    v_pk_fma_f32 v[38:39], v[94:95], v[38:39], v[62:63] op_sel:[1,1,0] op_sel_hi:[1,0,1] neg_lo:[1,0,0]
    v_pk_mul_f32 v[40:41], v[96:97], v[32:33] op_sel:[0,0] op_sel_hi:[0,1]
    v_pk_mul_f32 v[42:43], v[98:99], v[34:35] op_sel:[0,0] op_sel_hi:[0,1]
    v_pk_mul_f32 v[44:45], v[100:101], v[36:37] op_sel:[0,0] op_sel_hi:[0,1]
    v_pk_mul_f32 v[46:47], v[102:103], v[38:39] op_sel:[0,0] op_sel_hi:[0,1]
    v_pk_fma_f32 v[80:81], v[96:97], v[32:33], v[40:41] op_sel:[1,1,0] op_sel_hi:[1,0,1] neg_lo:[1,0,0] neg_hi:[1,0,1]
    v_pk_fma_f32 v[82:83], v[98:99], v[34:35], v[42:43] op_sel:[1,1,0] op_sel_hi:[1,0,1] neg_lo:[1,0,0] neg_hi:[1,0,1]
    v_pk_fma_f32 v[84:85], v[100:101], v[36:37], v[44:45] op_sel:[1,1,0] op_sel_hi:[1,0,1] neg_lo:[1,0,0] neg_hi:[1,0,1]
    v_pk_fma_f32 v[86:87], v[102:103], v[38:39], v[46:47] op_sel:[1,1,0] op_sel_hi:[1,0,1] neg_lo:[1,0,0] neg_hi:[1,0,1]
    v_cvt_pk_bf16_f32 v131, v72, v80
    v_cvt_pk_bf16_f32 v139, v74, v82
    v_cvt_pk_bf16_f32 v147, v76, v84
    v_cvt_pk_bf16_f32 v155, v78, v86
    v_cvt_pk_bf16_f32 v195, v73, v81
    v_cvt_pk_bf16_f32 v203, v75, v83
    v_cvt_pk_bf16_f32 v211, v77, v85
    v_cvt_pk_bf16_f32 v219, v79, v87
    v_accvgpr_read_b32 v64, a64
    v_accvgpr_read_b32 v66, a68
    v_accvgpr_read_b32 v68, a72
    v_accvgpr_read_b32 v70, a76
    v_accvgpr_read_b32 v65, a80
    v_accvgpr_read_b32 v67, a84
    v_accvgpr_read_b32 v69, a88
    v_accvgpr_read_b32 v71, a92
    v_pk_fma_f32 v[56:57], v[88:89], v[32:33], v[64:65] op_sel:[0,0,0] op_sel_hi:[0,1,1]
    v_pk_fma_f32 v[58:59], v[90:91], v[34:35], v[66:67] op_sel:[0,0,0] op_sel_hi:[0,1,1]
    v_pk_fma_f32 v[60:61], v[92:93], v[36:37], v[68:69] op_sel:[0,0,0] op_sel_hi:[0,1,1]
    v_pk_fma_f32 v[62:63], v[94:95], v[38:39], v[70:71] op_sel:[0,0,0] op_sel_hi:[0,1,1]
    v_pk_fma_f32 v[32:33], v[88:89], v[32:33], v[56:57] op_sel:[1,1,0] op_sel_hi:[1,0,1] neg_lo:[1,0,0]
    v_pk_fma_f32 v[34:35], v[90:91], v[34:35], v[58:59] op_sel:[1,1,0] op_sel_hi:[1,0,1] neg_lo:[1,0,0]
    v_pk_fma_f32 v[36:37], v[92:93], v[36:37], v[60:61] op_sel:[1,1,0] op_sel_hi:[1,0,1] neg_lo:[1,0,0]
    v_pk_fma_f32 v[38:39], v[94:95], v[38:39], v[62:63] op_sel:[1,1,0] op_sel_hi:[1,0,1] neg_lo:[1,0,0]
    v_pk_mul_f32 v[40:41], v[96:97], v[32:33] op_sel:[0,0] op_sel_hi:[0,1]
    v_pk_mul_f32 v[42:43], v[98:99], v[34:35] op_sel:[0,0] op_sel_hi:[0,1]
    v_pk_mul_f32 v[44:45], v[100:101], v[36:37] op_sel:[0,0] op_sel_hi:[0,1]
    v_pk_mul_f32 v[46:47], v[102:103], v[38:39] op_sel:[0,0] op_sel_hi:[0,1]
    v_pk_fma_f32 v[72:73], v[96:97], v[32:33], v[40:41] op_sel:[1,1,0] op_sel_hi:[1,0,1] neg_lo:[1,0,0] neg_hi:[1,0,1]
    v_pk_fma_f32 v[74:75], v[98:99], v[34:35], v[42:43] op_sel:[1,1,0] op_sel_hi:[1,0,1] neg_lo:[1,0,0] neg_hi:[1,0,1]
    v_pk_fma_f32 v[76:77], v[100:101], v[36:37], v[44:45] op_sel:[1,1,0] op_sel_hi:[1,0,1] neg_lo:[1,0,0] neg_hi:[1,0,1]
    v_pk_fma_f32 v[78:79], v[102:103], v[38:39], v[46:47] op_sel:[1,1,0] op_sel_hi:[1,0,1] neg_lo:[1,0,0] neg_hi:[1,0,1]
    v_accvgpr_read_b32 v48, a65
    v_accvgpr_read_b32 v50, a69
    v_accvgpr_read_b32 v52, a73
    v_accvgpr_read_b32 v54, a77
    v_accvgpr_read_b32 v49, a81
    v_accvgpr_read_b32 v51, a85
    v_accvgpr_read_b32 v53, a89
    v_accvgpr_read_b32 v55, a93
    v_pk_fma_f32 v[56:57], v[88:89], v[32:33], v[48:49] op_sel:[0,0,0] op_sel_hi:[0,1,1]
    v_pk_fma_f32 v[58:59], v[90:91], v[34:35], v[50:51] op_sel:[0,0,0] op_sel_hi:[0,1,1]
    v_pk_fma_f32 v[60:61], v[92:93], v[36:37], v[52:53] op_sel:[0,0,0] op_sel_hi:[0,1,1]
    v_pk_fma_f32 v[62:63], v[94:95], v[38:39], v[54:55] op_sel:[0,0,0] op_sel_hi:[0,1,1]
    v_pk_fma_f32 v[32:33], v[88:89], v[32:33], v[56:57] op_sel:[1,1,0] op_sel_hi:[1,0,1] neg_lo:[1,0,0]
    v_pk_fma_f32 v[34:35], v[90:91], v[34:35], v[58:59] op_sel:[1,1,0] op_sel_hi:[1,0,1] neg_lo:[1,0,0]
    v_pk_fma_f32 v[36:37], v[92:93], v[36:37], v[60:61] op_sel:[1,1,0] op_sel_hi:[1,0,1] neg_lo:[1,0,0]
    v_pk_fma_f32 v[38:39], v[94:95], v[38:39], v[62:63] op_sel:[1,1,0] op_sel_hi:[1,0,1] neg_lo:[1,0,0]
    v_pk_mul_f32 v[40:41], v[96:97], v[32:33] op_sel:[0,0] op_sel_hi:[0,1]
    v_pk_mul_f32 v[42:43], v[98:99], v[34:35] op_sel:[0,0] op_sel_hi:[0,1]
    v_pk_mul_f32 v[44:45], v[100:101], v[36:37] op_sel:[0,0] op_sel_hi:[0,1]
    v_pk_mul_f32 v[46:47], v[102:103], v[38:39] op_sel:[0,0] op_sel_hi:[0,1]
    v_pk_fma_f32 v[80:81], v[96:97], v[32:33], v[40:41] op_sel:[1,1,0] op_sel_hi:[1,0,1] neg_lo:[1,0,0] neg_hi:[1,0,1]
    v_pk_fma_f32 v[82:83], v[98:99], v[34:35], v[42:43] op_sel:[1,1,0] op_sel_hi:[1,0,1] neg_lo:[1,0,0] neg_hi:[1,0,1]
    v_pk_fma_f32 v[84:85], v[100:101], v[36:37], v[44:45] op_sel:[1,1,0] op_sel_hi:[1,0,1] neg_lo:[1,0,0] neg_hi:[1,0,1]
    v_pk_fma_f32 v[86:87], v[102:103], v[38:39], v[46:47] op_sel:[1,1,0] op_sel_hi:[1,0,1] neg_lo:[1,0,0] neg_hi:[1,0,1]
    v_cvt_pk_bf16_f32 v132, v72, v80
    v_cvt_pk_bf16_f32 v140, v74, v82
    v_cvt_pk_bf16_f32 v148, v76, v84
    v_cvt_pk_bf16_f32 v156, v78, v86
    v_cvt_pk_bf16_f32 v196, v73, v81
    v_cvt_pk_bf16_f32 v204, v75, v83
    v_cvt_pk_bf16_f32 v212, v77, v85
    v_cvt_pk_bf16_f32 v220, v79, v87
    v_accvgpr_read_b32 v64, a66
    v_accvgpr_read_b32 v66, a70
    v_accvgpr_read_b32 v68, a74
    v_accvgpr_read_b32 v70, a78
    v_accvgpr_read_b32 v65, a82
    v_accvgpr_read_b32 v67, a86
    v_accvgpr_read_b32 v69, a90
    v_accvgpr_read_b32 v71, a94
    v_pk_fma_f32 v[56:57], v[88:89], v[32:33], v[64:65] op_sel:[0,0,0] op_sel_hi:[0,1,1]
    v_pk_fma_f32 v[58:59], v[90:91], v[34:35], v[66:67] op_sel:[0,0,0] op_sel_hi:[0,1,1]
    v_pk_fma_f32 v[60:61], v[92:93], v[36:37], v[68:69] op_sel:[0,0,0] op_sel_hi:[0,1,1]
    v_pk_fma_f32 v[62:63], v[94:95], v[38:39], v[70:71] op_sel:[0,0,0] op_sel_hi:[0,1,1]
    v_pk_fma_f32 v[32:33], v[88:89], v[32:33], v[56:57] op_sel:[1,1,0] op_sel_hi:[1,0,1] neg_lo:[1,0,0]
    v_pk_fma_f32 v[34:35], v[90:91], v[34:35], v[58:59] op_sel:[1,1,0] op_sel_hi:[1,0,1] neg_lo:[1,0,0]
    v_pk_fma_f32 v[36:37], v[92:93], v[36:37], v[60:61] op_sel:[1,1,0] op_sel_hi:[1,0,1] neg_lo:[1,0,0]
    v_pk_fma_f32 v[38:39], v[94:95], v[38:39], v[62:63] op_sel:[1,1,0] op_sel_hi:[1,0,1] neg_lo:[1,0,0]
    v_pk_mul_f32 v[40:41], v[96:97], v[32:33] op_sel:[0,0] op_sel_hi:[0,1]
    v_pk_mul_f32 v[42:43], v[98:99], v[34:35] op_sel:[0,0] op_sel_hi:[0,1]
    v_pk_mul_f32 v[44:45], v[100:101], v[36:37] op_sel:[0,0] op_sel_hi:[0,1]
    v_pk_mul_f32 v[46:47], v[102:103], v[38:39] op_sel:[0,0] op_sel_hi:[0,1]
    v_pk_fma_f32 v[72:73], v[96:97], v[32:33], v[40:41] op_sel:[1,1,0] op_sel_hi:[1,0,1] neg_lo:[1,0,0] neg_hi:[1,0,1]
    v_pk_fma_f32 v[74:75], v[98:99], v[34:35], v[42:43] op_sel:[1,1,0] op_sel_hi:[1,0,1] neg_lo:[1,0,0] neg_hi:[1,0,1]
    v_pk_fma_f32 v[76:77], v[100:101], v[36:37], v[44:45] op_sel:[1,1,0] op_sel_hi:[1,0,1] neg_lo:[1,0,0] neg_hi:[1,0,1]
    v_pk_fma_f32 v[78:79], v[102:103], v[38:39], v[46:47] op_sel:[1,1,0] op_sel_hi:[1,0,1] neg_lo:[1,0,0] neg_hi:[1,0,1]
    v_accvgpr_read_b32 v48, a67
    v_accvgpr_read_b32 v50, a71
    v_accvgpr_read_b32 v52, a75
    v_accvgpr_read_b32 v54, a79
    v_accvgpr_read_b32 v49, a83
    v_accvgpr_read_b32 v51, a87
    v_accvgpr_read_b32 v53, a91
    v_accvgpr_read_b32 v55, a95
    v_pk_fma_f32 v[56:57], v[88:89], v[32:33], v[48:49] op_sel:[0,0,0] op_sel_hi:[0,1,1]
    v_pk_fma_f32 v[58:59], v[90:91], v[34:35], v[50:51] op_sel:[0,0,0] op_sel_hi:[0,1,1]
    v_pk_fma_f32 v[60:61], v[92:93], v[36:37], v[52:53] op_sel:[0,0,0] op_sel_hi:[0,1,1]
    v_pk_fma_f32 v[62:63], v[94:95], v[38:39], v[54:55] op_sel:[0,0,0] op_sel_hi:[0,1,1]
    v_pk_fma_f32 v[32:33], v[88:89], v[32:33], v[56:57] op_sel:[1,1,0] op_sel_hi:[1,0,1] neg_lo:[1,0,0]
    v_pk_fma_f32 v[34:35], v[90:91], v[34:35], v[58:59] op_sel:[1,1,0] op_sel_hi:[1,0,1] neg_lo:[1,0,0]
    v_pk_fma_f32 v[36:37], v[92:93], v[36:37], v[60:61] op_sel:[1,1,0] op_sel_hi:[1,0,1] neg_lo:[1,0,0]
    v_pk_fma_f32 v[38:39], v[94:95], v[38:39], v[62:63] op_sel:[1,1,0] op_sel_hi:[1,0,1] neg_lo:[1,0,0]
    v_pk_mul_f32 v[40:41], v[96:97], v[32:33] op_sel:[0,0] op_sel_hi:[0,1]
    v_pk_mul_f32 v[42:43], v[98:99], v[34:35] op_sel:[0,0] op_sel_hi:[0,1]
    v_pk_mul_f32 v[44:45], v[100:101], v[36:37] op_sel:[0,0] op_sel_hi:[0,1]
    v_pk_mul_f32 v[46:47], v[102:103], v[38:39] op_sel:[0,0] op_sel_hi:[0,1]
    v_pk_fma_f32 v[80:81], v[96:97], v[32:33], v[40:41] op_sel:[1,1,0] op_sel_hi:[1,0,1] neg_lo:[1,0,0] neg_hi:[1,0,1]
    v_pk_fma_f32 v[82:83], v[98:99], v[34:35], v[42:43] op_sel:[1,1,0] op_sel_hi:[1,0,1] neg_lo:[1,0,0] neg_hi:[1,0,1]
    v_pk_fma_f32 v[84:85], v[100:101], v[36:37], v[44:45] op_sel:[1,1,0] op_sel_hi:[1,0,1] neg_lo:[1,0,0] neg_hi:[1,0,1]
    v_pk_fma_f32 v[86:87], v[102:103], v[38:39], v[46:47] op_sel:[1,1,0] op_sel_hi:[1,0,1] neg_lo:[1,0,0] neg_hi:[1,0,1]
    v_cvt_pk_bf16_f32 v133, v72, v80
    v_cvt_pk_bf16_f32 v141, v74, v82
    v_cvt_pk_bf16_f32 v149, v76, v84
    v_cvt_pk_bf16_f32 v157, v78, v86
    v_cvt_pk_bf16_f32 v197, v73, v81
    v_cvt_pk_bf16_f32 v205, v75, v83
    v_cvt_pk_bf16_f32 v213, v77, v85
    v_cvt_pk_bf16_f32 v221, v79, v87
    v_accvgpr_read_b32 v64, a96
    v_accvgpr_read_b32 v66, a100
    v_accvgpr_read_b32 v68, a104
    v_accvgpr_read_b32 v70, a108
    v_accvgpr_read_b32 v65, a112
    v_accvgpr_read_b32 v67, a116
    v_accvgpr_read_b32 v69, a120
    v_accvgpr_read_b32 v71, a124
    v_pk_fma_f32 v[56:57], v[88:89], v[32:33], v[64:65] op_sel:[0,0,0] op_sel_hi:[0,1,1]
    v_pk_fma_f32 v[58:59], v[90:91], v[34:35], v[66:67] op_sel:[0,0,0] op_sel_hi:[0,1,1]
    v_pk_fma_f32 v[60:61], v[92:93], v[36:37], v[68:69] op_sel:[0,0,0] op_sel_hi:[0,1,1]
    v_pk_fma_f32 v[62:63], v[94:95], v[38:39], v[70:71] op_sel:[0,0,0] op_sel_hi:[0,1,1]
    v_pk_fma_f32 v[32:33], v[88:89], v[32:33], v[56:57] op_sel:[1,1,0] op_sel_hi:[1,0,1] neg_lo:[1,0,0]
    v_pk_fma_f32 v[34:35], v[90:91], v[34:35], v[58:59] op_sel:[1,1,0] op_sel_hi:[1,0,1] neg_lo:[1,0,0]
    v_pk_fma_f32 v[36:37], v[92:93], v[36:37], v[60:61] op_sel:[1,1,0] op_sel_hi:[1,0,1] neg_lo:[1,0,0]
    v_pk_fma_f32 v[38:39], v[94:95], v[38:39], v[62:63] op_sel:[1,1,0] op_sel_hi:[1,0,1] neg_lo:[1,0,0]
    v_pk_mul_f32 v[40:41], v[96:97], v[32:33] op_sel:[0,0] op_sel_hi:[0,1]
    v_pk_mul_f32 v[42:43], v[98:99], v[34:35] op_sel:[0,0] op_sel_hi:[0,1]
    v_pk_mul_f32 v[44:45], v[100:101], v[36:37] op_sel:[0,0] op_sel_hi:[0,1]
    v_pk_mul_f32 v[46:47], v[102:103], v[38:39] op_sel:[0,0] op_sel_hi:[0,1]
    v_pk_fma_f32 v[72:73], v[96:97], v[32:33], v[40:41] op_sel:[1,1,0] op_sel_hi:[1,0,1] neg_lo:[1,0,0] neg_hi:[1,0,1]
    v_pk_fma_f32 v[74:75], v[98:99], v[34:35], v[42:43] op_sel:[1,1,0] op_sel_hi:[1,0,1] neg_lo:[1,0,0] neg_hi:[1,0,1]
    v_pk_fma_f32 v[76:77], v[100:101], v[36:37], v[44:45] op_sel:[1,1,0] op_sel_hi:[1,0,1] neg_lo:[1,0,0] neg_hi:[1,0,1]
    v_pk_fma_f32 v[78:79], v[102:103], v[38:39], v[46:47] op_sel:[1,1,0] op_sel_hi:[1,0,1] neg_lo:[1,0,0] neg_hi:[1,0,1]
    v_accvgpr_read_b32 v48, a97
    v_accvgpr_read_b32 v50, a101
    v_accvgpr_read_b32 v52, a105
    v_accvgpr_read_b32 v54, a109
    v_accvgpr_read_b32 v49, a113
    v_accvgpr_read_b32 v51, a117
    v_accvgpr_read_b32 v53, a121
    v_accvgpr_read_b32 v55, a125
    v_pk_fma_f32 v[56:57], v[88:89], v[32:33], v[48:49] op_sel:[0,0,0] op_sel_hi:[0,1,1]
    v_pk_fma_f32 v[58:59], v[90:91], v[34:35], v[50:51] op_sel:[0,0,0] op_sel_hi:[0,1,1]
    v_pk_fma_f32 v[60:61], v[92:93], v[36:37], v[52:53] op_sel:[0,0,0] op_sel_hi:[0,1,1]
    v_pk_fma_f32 v[62:63], v[94:95], v[38:39], v[54:55] op_sel:[0,0,0] op_sel_hi:[0,1,1]
    v_pk_fma_f32 v[32:33], v[88:89], v[32:33], v[56:57] op_sel:[1,1,0] op_sel_hi:[1,0,1] neg_lo:[1,0,0]
    v_pk_fma_f32 v[34:35], v[90:91], v[34:35], v[58:59] op_sel:[1,1,0] op_sel_hi:[1,0,1] neg_lo:[1,0,0]
    v_pk_fma_f32 v[36:37], v[92:93], v[36:37], v[60:61] op_sel:[1,1,0] op_sel_hi:[1,0,1] neg_lo:[1,0,0]
    v_pk_fma_f32 v[38:39], v[94:95], v[38:39], v[62:63] op_sel:[1,1,0] op_sel_hi:[1,0,1] neg_lo:[1,0,0]
    v_pk_mul_f32 v[40:41], v[96:97], v[32:33] op_sel:[0,0] op_sel_hi:[0,1]
    v_pk_mul_f32 v[42:43], v[98:99], v[34:35] op_sel:[0,0] op_sel_hi:[0,1]
    v_pk_mul_f32 v[44:45], v[100:101], v[36:37] op_sel:[0,0] op_sel_hi:[0,1]
    v_pk_mul_f32 v[46:47], v[102:103], v[38:39] op_sel:[0,0] op_sel_hi:[0,1]
    v_pk_fma_f32 v[80:81], v[96:97], v[32:33], v[40:41] op_sel:[1,1,0] op_sel_hi:[1,0,1] neg_lo:[1,0,0] neg_hi:[1,0,1]
    v_pk_fma_f32 v[82:83], v[98:99], v[34:35], v[42:43] op_sel:[1,1,0] op_sel_hi:[1,0,1] neg_lo:[1,0,0] neg_hi:[1,0,1]
    v_pk_fma_f32 v[84:85], v[100:101], v[36:37], v[44:45] op_sel:[1,1,0] op_sel_hi:[1,0,1] neg_lo:[1,0,0] neg_hi:[1,0,1]
    v_pk_fma_f32 v[86:87], v[102:103], v[38:39], v[46:47] op_sel:[1,1,0] op_sel_hi:[1,0,1] neg_lo:[1,0,0] neg_hi:[1,0,1]
    v_cvt_pk_bf16_f32 v134, v72, v80
    v_cvt_pk_bf16_f32 v142, v74, v82
    v_cvt_pk_bf16_f32 v150, v76, v84
    v_cvt_pk_bf16_f32 v158, v78, v86
    v_cvt_pk_bf16_f32 v198, v73, v81
    v_cvt_pk_bf16_f32 v206, v75, v83
    v_cvt_pk_bf16_f32 v214, v77, v85
    v_cvt_pk_bf16_f32 v222, v79, v87
    v_accvgpr_read_b32 v64, a98
    v_accvgpr_read_b32 v66, a102
    v_accvgpr_read_b32 v68, a106
    v_accvgpr_read_b32 v70, a110
    v_accvgpr_read_b32 v65, a114
    v_accvgpr_read_b32 v67, a118
    v_accvgpr_read_b32 v69, a122
    v_accvgpr_read_b32 v71, a126
    v_pk_fma_f32 v[56:57], v[88:89], v[32:33], v[64:65] op_sel:[0,0,0] op_sel_hi:[0,1,1]
    v_pk_fma_f32 v[58:59], v[90:91], v[34:35], v[66:67] op_sel:[0,0,0] op_sel_hi:[0,1,1]
    v_pk_fma_f32 v[60:61], v[92:93], v[36:37], v[68:69] op_sel:[0,0,0] op_sel_hi:[0,1,1]
    v_pk_fma_f32 v[62:63], v[94:95], v[38:39], v[70:71] op_sel:[0,0,0] op_sel_hi:[0,1,1]
    v_pk_fma_f32 v[32:33], v[88:89], v[32:33], v[56:57] op_sel:[1,1,0] op_sel_hi:[1,0,1] neg_lo:[1,0,0]
    v_pk_fma_f32 v[34:35], v[90:91], v[34:35], v[58:59] op_sel:[1,1,0] op_sel_hi:[1,0,1] neg_lo:[1,0,0]
    v_pk_fma_f32 v[36:37], v[92:93], v[36:37], v[60:61] op_sel:[1,1,0] op_sel_hi:[1,0,1] neg_lo:[1,0,0]
    v_pk_fma_f32 v[38:39], v[94:95], v[38:39], v[62:63] op_sel:[1,1,0] op_sel_hi:[1,0,1] neg_lo:[1,0,0]
    v_pk_mul_f32 v[40:41], v[96:97], v[32:33] op_sel:[0,0] op_sel_hi:[0,1]
    v_pk_mul_f32 v[42:43], v[98:99], v[34:35] op_sel:[0,0] op_sel_hi:[0,1]
    v_pk_mul_f32 v[44:45], v[100:101], v[36:37] op_sel:[0,0] op_sel_hi:[0,1]
    v_pk_mul_f32 v[46:47], v[102:103], v[38:39] op_sel:[0,0] op_sel_hi:[0,1]
    v_pk_fma_f32 v[72:73], v[96:97], v[32:33], v[40:41] op_sel:[1,1,0] op_sel_hi:[1,0,1] neg_lo:[1,0,0] neg_hi:[1,0,1]
    v_pk_fma_f32 v[74:75], v[98:99], v[34:35], v[42:43] op_sel:[1,1,0] op_sel_hi:[1,0,1] neg_lo:[1,0,0] neg_hi:[1,0,1]
    v_pk_fma_f32 v[76:77], v[100:101], v[36:37], v[44:45] op_sel:[1,1,0] op_sel_hi:[1,0,1] neg_lo:[1,0,0] neg_hi:[1,0,1]
    v_pk_fma_f32 v[78:79], v[102:103], v[38:39], v[46:47] op_sel:[1,1,0] op_sel_hi:[1,0,1] neg_lo:[1,0,0] neg_hi:[1,0,1]
    v_accvgpr_read_b32 v48, a99
    v_accvgpr_read_b32 v50, a103
    v_accvgpr_read_b32 v52, a107
    v_accvgpr_read_b32 v54, a111
    v_accvgpr_read_b32 v49, a115
    v_accvgpr_read_b32 v51, a119
    v_accvgpr_read_b32 v53, a123
    v_accvgpr_read_b32 v55, a127
    v_pk_fma_f32 v[56:57], v[88:89], v[32:33], v[48:49] op_sel:[0,0,0] op_sel_hi:[0,1,1]
    v_pk_fma_f32 v[58:59], v[90:91], v[34:35], v[50:51] op_sel:[0,0,0] op_sel_hi:[0,1,1]
    v_pk_fma_f32 v[60:61], v[92:93], v[36:37], v[52:53] op_sel:[0,0,0] op_sel_hi:[0,1,1]
    v_pk_fma_f32 v[62:63], v[94:95], v[38:39], v[54:55] op_sel:[0,0,0] op_sel_hi:[0,1,1]
    v_pk_fma_f32 v[32:33], v[88:89], v[32:33], v[56:57] op_sel:[1,1,0] op_sel_hi:[1,0,1] neg_lo:[1,0,0]
    v_pk_fma_f32 v[34:35], v[90:91], v[34:35], v[58:59] op_sel:[1,1,0] op_sel_hi:[1,0,1] neg_lo:[1,0,0]
    v_pk_fma_f32 v[36:37], v[92:93], v[36:37], v[60:61] op_sel:[1,1,0] op_sel_hi:[1,0,1] neg_lo:[1,0,0]
    v_pk_fma_f32 v[38:39], v[94:95], v[38:39], v[62:63] op_sel:[1,1,0] op_sel_hi:[1,0,1] neg_lo:[1,0,0]
    v_pk_mul_f32 v[40:41], v[96:97], v[32:33] op_sel:[0,0] op_sel_hi:[0,1]
    v_pk_mul_f32 v[42:43], v[98:99], v[34:35] op_sel:[0,0] op_sel_hi:[0,1]
    v_pk_mul_f32 v[44:45], v[100:101], v[36:37] op_sel:[0,0] op_sel_hi:[0,1]
    v_pk_mul_f32 v[46:47], v[102:103], v[38:39] op_sel:[0,0] op_sel_hi:[0,1]
    v_pk_fma_f32 v[80:81], v[96:97], v[32:33], v[40:41] op_sel:[1,1,0] op_sel_hi:[1,0,1] neg_lo:[1,0,0] neg_hi:[1,0,1]
    v_pk_fma_f32 v[82:83], v[98:99], v[34:35], v[42:43] op_sel:[1,1,0] op_sel_hi:[1,0,1] neg_lo:[1,0,0] neg_hi:[1,0,1]
    v_pk_fma_f32 v[84:85], v[100:101], v[36:37], v[44:45] op_sel:[1,1,0] op_sel_hi:[1,0,1] neg_lo:[1,0,0] neg_hi:[1,0,1]
    v_pk_fma_f32 v[86:87], v[102:103], v[38:39], v[46:47] op_sel:[1,1,0] op_sel_hi:[1,0,1] neg_lo:[1,0,0] neg_hi:[1,0,1]
    v_cvt_pk_bf16_f32 v135, v72, v80
    v_cvt_pk_bf16_f32 v143, v74, v82
    v_cvt_pk_bf16_f32 v151, v76, v84
    v_cvt_pk_bf16_f32 v159, v78, v86
    v_cvt_pk_bf16_f32 v199, v73, v81
    v_cvt_pk_bf16_f32 v207, v75, v83
    v_cvt_pk_bf16_f32 v215, v77, v85
    v_cvt_pk_bf16_f32 v223, v79, v87
    v_accvgpr_read_b32 v64, a128
    v_accvgpr_read_b32 v66, a132
    v_accvgpr_read_b32 v68, a136
    v_accvgpr_read_b32 v70, a140
    v_accvgpr_read_b32 v65, a144
    v_accvgpr_read_b32 v67, a148
    v_accvgpr_read_b32 v69, a152
    v_accvgpr_read_b32 v71, a156
    v_pk_fma_f32 v[56:57], v[88:89], v[32:33], v[64:65] op_sel:[0,0,0] op_sel_hi:[0,1,1]
    v_pk_fma_f32 v[58:59], v[90:91], v[34:35], v[66:67] op_sel:[0,0,0] op_sel_hi:[0,1,1]
    v_pk_fma_f32 v[60:61], v[92:93], v[36:37], v[68:69] op_sel:[0,0,0] op_sel_hi:[0,1,1]
    v_pk_fma_f32 v[62:63], v[94:95], v[38:39], v[70:71] op_sel:[0,0,0] op_sel_hi:[0,1,1]
    v_pk_fma_f32 v[32:33], v[88:89], v[32:33], v[56:57] op_sel:[1,1,0] op_sel_hi:[1,0,1] neg_lo:[1,0,0]
    v_pk_fma_f32 v[34:35], v[90:91], v[34:35], v[58:59] op_sel:[1,1,0] op_sel_hi:[1,0,1] neg_lo:[1,0,0]
    v_pk_fma_f32 v[36:37], v[92:93], v[36:37], v[60:61] op_sel:[1,1,0] op_sel_hi:[1,0,1] neg_lo:[1,0,0]
    v_pk_fma_f32 v[38:39], v[94:95], v[38:39], v[62:63] op_sel:[1,1,0] op_sel_hi:[1,0,1] neg_lo:[1,0,0]
    v_pk_mul_f32 v[40:41], v[96:97], v[32:33] op_sel:[0,0] op_sel_hi:[0,1]
    v_pk_mul_f32 v[42:43], v[98:99], v[34:35] op_sel:[0,0] op_sel_hi:[0,1]
    v_pk_mul_f32 v[44:45], v[100:101], v[36:37] op_sel:[0,0] op_sel_hi:[0,1]
    v_pk_mul_f32 v[46:47], v[102:103], v[38:39] op_sel:[0,0] op_sel_hi:[0,1]
    v_pk_fma_f32 v[72:73], v[96:97], v[32:33], v[40:41] op_sel:[1,1,0] op_sel_hi:[1,0,1] neg_lo:[1,0,0] neg_hi:[1,0,1]
    v_pk_fma_f32 v[74:75], v[98:99], v[34:35], v[42:43] op_sel:[1,1,0] op_sel_hi:[1,0,1] neg_lo:[1,0,0] neg_hi:[1,0,1]
    v_pk_fma_f32 v[76:77], v[100:101], v[36:37], v[44:45] op_sel:[1,1,0] op_sel_hi:[1,0,1] neg_lo:[1,0,0] neg_hi:[1,0,1]
    v_pk_fma_f32 v[78:79], v[102:103], v[38:39], v[46:47] op_sel:[1,1,0] op_sel_hi:[1,0,1] neg_lo:[1,0,0] neg_hi:[1,0,1]
    v_accvgpr_read_b32 v48, a129
    v_accvgpr_read_b32 v50, a133
    v_accvgpr_read_b32 v52, a137
    v_accvgpr_read_b32 v54, a141
    v_accvgpr_read_b32 v49, a145
    v_accvgpr_read_b32 v51, a149
    v_accvgpr_read_b32 v53, a153
    v_accvgpr_read_b32 v55, a157
    v_pk_fma_f32 v[56:57], v[88:89], v[32:33], v[48:49] op_sel:[0,0,0] op_sel_hi:[0,1,1]
    v_pk_fma_f32 v[58:59], v[90:91], v[34:35], v[50:51] op_sel:[0,0,0] op_sel_hi:[0,1,1]
    v_pk_fma_f32 v[60:61], v[92:93], v[36:37], v[52:53] op_sel:[0,0,0] op_sel_hi:[0,1,1]
    v_pk_fma_f32 v[62:63], v[94:95], v[38:39], v[54:55] op_sel:[0,0,0] op_sel_hi:[0,1,1]
    v_pk_fma_f32 v[32:33], v[88:89], v[32:33], v[56:57] op_sel:[1,1,0] op_sel_hi:[1,0,1] neg_lo:[1,0,0]
    v_pk_fma_f32 v[34:35], v[90:91], v[34:35], v[58:59] op_sel:[1,1,0] op_sel_hi:[1,0,1] neg_lo:[1,0,0]
    v_pk_fma_f32 v[36:37], v[92:93], v[36:37], v[60:61] op_sel:[1,1,0] op_sel_hi:[1,0,1] neg_lo:[1,0,0]
    v_pk_fma_f32 v[38:39], v[94:95], v[38:39], v[62:63] op_sel:[1,1,0] op_sel_hi:[1,0,1] neg_lo:[1,0,0]
    v_pk_mul_f32 v[40:41], v[96:97], v[32:33] op_sel:[0,0] op_sel_hi:[0,1]
    v_pk_mul_f32 v[42:43], v[98:99], v[34:35] op_sel:[0,0] op_sel_hi:[0,1]
    v_pk_mul_f32 v[44:45], v[100:101], v[36:37] op_sel:[0,0] op_sel_hi:[0,1]
    v_pk_mul_f32 v[46:47], v[102:103], v[38:39] op_sel:[0,0] op_sel_hi:[0,1]
    v_pk_fma_f32 v[80:81], v[96:97], v[32:33], v[40:41] op_sel:[1,1,0] op_sel_hi:[1,0,1] neg_lo:[1,0,0] neg_hi:[1,0,1]
    v_pk_fma_f32 v[82:83], v[98:99], v[34:35], v[42:43] op_sel:[1,1,0] op_sel_hi:[1,0,1] neg_lo:[1,0,0] neg_hi:[1,0,1]
    v_pk_fma_f32 v[84:85], v[100:101], v[36:37], v[44:45] op_sel:[1,1,0] op_sel_hi:[1,0,1] neg_lo:[1,0,0] neg_hi:[1,0,1]
    v_pk_fma_f32 v[86:87], v[102:103], v[38:39], v[46:47] op_sel:[1,1,0] op_sel_hi:[1,0,1] neg_lo:[1,0,0] neg_hi:[1,0,1]
    v_cvt_pk_bf16_f32 v160, v72, v80
    v_cvt_pk_bf16_f32 v168, v74, v82
    v_cvt_pk_bf16_f32 v176, v76, v84
    v_cvt_pk_bf16_f32 v184, v78, v86
    v_cvt_pk_bf16_f32 v224, v73, v81
    v_cvt_pk_bf16_f32 v232, v75, v83
    v_cvt_pk_bf16_f32 v240, v77, v85
    v_cvt_pk_bf16_f32 v248, v79, v87
    v_accvgpr_read_b32 v64, a130
    v_accvgpr_read_b32 v66, a134
    v_accvgpr_read_b32 v68, a138
    v_accvgpr_read_b32 v70, a142
    v_accvgpr_read_b32 v65, a146
    v_accvgpr_read_b32 v67, a150
    v_accvgpr_read_b32 v69, a154
    v_accvgpr_read_b32 v71, a158
    v_pk_fma_f32 v[56:57], v[88:89], v[32:33], v[64:65] op_sel:[0,0,0] op_sel_hi:[0,1,1]
    v_pk_fma_f32 v[58:59], v[90:91], v[34:35], v[66:67] op_sel:[0,0,0] op_sel_hi:[0,1,1]
    v_pk_fma_f32 v[60:61], v[92:93], v[36:37], v[68:69] op_sel:[0,0,0] op_sel_hi:[0,1,1]
    v_pk_fma_f32 v[62:63], v[94:95], v[38:39], v[70:71] op_sel:[0,0,0] op_sel_hi:[0,1,1]
    v_pk_fma_f32 v[32:33], v[88:89], v[32:33], v[56:57] op_sel:[1,1,0] op_sel_hi:[1,0,1] neg_lo:[1,0,0]
    v_pk_fma_f32 v[34:35], v[90:91], v[34:35], v[58:59] op_sel:[1,1,0] op_sel_hi:[1,0,1] neg_lo:[1,0,0]
    v_pk_fma_f32 v[36:37], v[92:93], v[36:37], v[60:61] op_sel:[1,1,0] op_sel_hi:[1,0,1] neg_lo:[1,0,0]
    v_pk_fma_f32 v[38:39], v[94:95], v[38:39], v[62:63] op_sel:[1,1,0] op_sel_hi:[1,0,1] neg_lo:[1,0,0]
    v_pk_mul_f32 v[40:41], v[96:97], v[32:33] op_sel:[0,0] op_sel_hi:[0,1]
    v_pk_mul_f32 v[42:43], v[98:99], v[34:35] op_sel:[0,0] op_sel_hi:[0,1]
    v_pk_mul_f32 v[44:45], v[100:101], v[36:37] op_sel:[0,0] op_sel_hi:[0,1]
    v_pk_mul_f32 v[46:47], v[102:103], v[38:39] op_sel:[0,0] op_sel_hi:[0,1]
    v_pk_fma_f32 v[72:73], v[96:97], v[32:33], v[40:41] op_sel:[1,1,0] op_sel_hi:[1,0,1] neg_lo:[1,0,0] neg_hi:[1,0,1]
    v_pk_fma_f32 v[74:75], v[98:99], v[34:35], v[42:43] op_sel:[1,1,0] op_sel_hi:[1,0,1] neg_lo:[1,0,0] neg_hi:[1,0,1]
    v_pk_fma_f32 v[76:77], v[100:101], v[36:37], v[44:45] op_sel:[1,1,0] op_sel_hi:[1,0,1] neg_lo:[1,0,0] neg_hi:[1,0,1]
    v_pk_fma_f32 v[78:79], v[102:103], v[38:39], v[46:47] op_sel:[1,1,0] op_sel_hi:[1,0,1] neg_lo:[1,0,0] neg_hi:[1,0,1]
    v_accvgpr_read_b32 v48, a131
    v_accvgpr_read_b32 v50, a135
    v_accvgpr_read_b32 v52, a139
    v_accvgpr_read_b32 v54, a143
    v_accvgpr_read_b32 v49, a147
    v_accvgpr_read_b32 v51, a151
    v_accvgpr_read_b32 v53, a155
    v_accvgpr_read_b32 v55, a159
    v_pk_fma_f32 v[56:57], v[88:89], v[32:33], v[48:49] op_sel:[0,0,0] op_sel_hi:[0,1,1]
    v_pk_fma_f32 v[58:59], v[90:91], v[34:35], v[50:51] op_sel:[0,0,0] op_sel_hi:[0,1,1]
    v_pk_fma_f32 v[60:61], v[92:93], v[36:37], v[52:53] op_sel:[0,0,0] op_sel_hi:[0,1,1]
    v_pk_fma_f32 v[62:63], v[94:95], v[38:39], v[54:55] op_sel:[0,0,0] op_sel_hi:[0,1,1]
    v_pk_fma_f32 v[32:33], v[88:89], v[32:33], v[56:57] op_sel:[1,1,0] op_sel_hi:[1,0,1] neg_lo:[1,0,0]
    v_pk_fma_f32 v[34:35], v[90:91], v[34:35], v[58:59] op_sel:[1,1,0] op_sel_hi:[1,0,1] neg_lo:[1,0,0]
    v_pk_fma_f32 v[36:37], v[92:93], v[36:37], v[60:61] op_sel:[1,1,0] op_sel_hi:[1,0,1] neg_lo:[1,0,0]
    v_pk_fma_f32 v[38:39], v[94:95], v[38:39], v[62:63] op_sel:[1,1,0] op_sel_hi:[1,0,1] neg_lo:[1,0,0]
    v_pk_mul_f32 v[40:41], v[96:97], v[32:33] op_sel:[0,0] op_sel_hi:[0,1]
    v_pk_mul_f32 v[42:43], v[98:99], v[34:35] op_sel:[0,0] op_sel_hi:[0,1]
    v_pk_mul_f32 v[44:45], v[100:101], v[36:37] op_sel:[0,0] op_sel_hi:[0,1]
    v_pk_mul_f32 v[46:47], v[102:103], v[38:39] op_sel:[0,0] op_sel_hi:[0,1]
    v_pk_fma_f32 v[80:81], v[96:97], v[32:33], v[40:41] op_sel:[1,1,0] op_sel_hi:[1,0,1] neg_lo:[1,0,0] neg_hi:[1,0,1]
    v_pk_fma_f32 v[82:83], v[98:99], v[34:35], v[42:43] op_sel:[1,1,0] op_sel_hi:[1,0,1] neg_lo:[1,0,0] neg_hi:[1,0,1]
    v_pk_fma_f32 v[84:85], v[100:101], v[36:37], v[44:45] op_sel:[1,1,0] op_sel_hi:[1,0,1] neg_lo:[1,0,0] neg_hi:[1,0,1]
    v_pk_fma_f32 v[86:87], v[102:103], v[38:39], v[46:47] op_sel:[1,1,0] op_sel_hi:[1,0,1] neg_lo:[1,0,0] neg_hi:[1,0,1]
    v_cvt_pk_bf16_f32 v161, v72, v80
    v_cvt_pk_bf16_f32 v169, v74, v82
    v_cvt_pk_bf16_f32 v177, v76, v84
    v_cvt_pk_bf16_f32 v185, v78, v86
    v_cvt_pk_bf16_f32 v225, v73, v81
    v_cvt_pk_bf16_f32 v233, v75, v83
    v_cvt_pk_bf16_f32 v241, v77, v85
    v_cvt_pk_bf16_f32 v249, v79, v87
    v_accvgpr_read_b32 v64, a160
    v_accvgpr_read_b32 v66, a164
    v_accvgpr_read_b32 v68, a168
    v_accvgpr_read_b32 v70, a172
    v_accvgpr_read_b32 v65, a176
    v_accvgpr_read_b32 v67, a180
    v_accvgpr_read_b32 v69, a184
    v_accvgpr_read_b32 v71, a188
    v_pk_fma_f32 v[56:57], v[88:89], v[32:33], v[64:65] op_sel:[0,0,0] op_sel_hi:[0,1,1]
    v_pk_fma_f32 v[58:59], v[90:91], v[34:35], v[66:67] op_sel:[0,0,0] op_sel_hi:[0,1,1]
    v_pk_fma_f32 v[60:61], v[92:93], v[36:37], v[68:69] op_sel:[0,0,0] op_sel_hi:[0,1,1]
    v_pk_fma_f32 v[62:63], v[94:95], v[38:39], v[70:71] op_sel:[0,0,0] op_sel_hi:[0,1,1]
    v_pk_fma_f32 v[32:33], v[88:89], v[32:33], v[56:57] op_sel:[1,1,0] op_sel_hi:[1,0,1] neg_lo:[1,0,0]
    v_pk_fma_f32 v[34:35], v[90:91], v[34:35], v[58:59] op_sel:[1,1,0] op_sel_hi:[1,0,1] neg_lo:[1,0,0]
    v_pk_fma_f32 v[36:37], v[92:93], v[36:37], v[60:61] op_sel:[1,1,0] op_sel_hi:[1,0,1] neg_lo:[1,0,0]
    v_pk_fma_f32 v[38:39], v[94:95], v[38:39], v[62:63] op_sel:[1,1,0] op_sel_hi:[1,0,1] neg_lo:[1,0,0]
    v_pk_mul_f32 v[40:41], v[96:97], v[32:33] op_sel:[0,0] op_sel_hi:[0,1]
    v_pk_mul_f32 v[42:43], v[98:99], v[34:35] op_sel:[0,0] op_sel_hi:[0,1]
    v_pk_mul_f32 v[44:45], v[100:101], v[36:37] op_sel:[0,0] op_sel_hi:[0,1]
    v_pk_mul_f32 v[46:47], v[102:103], v[38:39] op_sel:[0,0] op_sel_hi:[0,1]
    v_pk_fma_f32 v[72:73], v[96:97], v[32:33], v[40:41] op_sel:[1,1,0] op_sel_hi:[1,0,1] neg_lo:[1,0,0] neg_hi:[1,0,1]
    v_pk_fma_f32 v[74:75], v[98:99], v[34:35], v[42:43] op_sel:[1,1,0] op_sel_hi:[1,0,1] neg_lo:[1,0,0] neg_hi:[1,0,1]
    v_pk_fma_f32 v[76:77], v[100:101], v[36:37], v[44:45] op_sel:[1,1,0] op_sel_hi:[1,0,1] neg_lo:[1,0,0] neg_hi:[1,0,1]
    v_pk_fma_f32 v[78:79], v[102:103], v[38:39], v[46:47] op_sel:[1,1,0] op_sel_hi:[1,0,1] neg_lo:[1,0,0] neg_hi:[1,0,1]
    v_accvgpr_read_b32 v48, a161
    v_accvgpr_read_b32 v50, a165
    v_accvgpr_read_b32 v52, a169
    v_accvgpr_read_b32 v54, a173
    v_accvgpr_read_b32 v49, a177
    v_accvgpr_read_b32 v51, a181
    v_accvgpr_read_b32 v53, a185
    v_accvgpr_read_b32 v55, a189
    v_pk_fma_f32 v[56:57], v[88:89], v[32:33], v[48:49] op_sel:[0,0,0] op_sel_hi:[0,1,1]
    v_pk_fma_f32 v[58:59], v[90:91], v[34:35], v[50:51] op_sel:[0,0,0] op_sel_hi:[0,1,1]
    v_pk_fma_f32 v[60:61], v[92:93], v[36:37], v[52:53] op_sel:[0,0,0] op_sel_hi:[0,1,1]
    v_pk_fma_f32 v[62:63], v[94:95], v[38:39], v[54:55] op_sel:[0,0,0] op_sel_hi:[0,1,1]
    v_pk_fma_f32 v[32:33], v[88:89], v[32:33], v[56:57] op_sel:[1,1,0] op_sel_hi:[1,0,1] neg_lo:[1,0,0]
    v_pk_fma_f32 v[34:35], v[90:91], v[34:35], v[58:59] op_sel:[1,1,0] op_sel_hi:[1,0,1] neg_lo:[1,0,0]
    v_pk_fma_f32 v[36:37], v[92:93], v[36:37], v[60:61] op_sel:[1,1,0] op_sel_hi:[1,0,1] neg_lo:[1,0,0]
    v_pk_fma_f32 v[38:39], v[94:95], v[38:39], v[62:63] op_sel:[1,1,0] op_sel_hi:[1,0,1] neg_lo:[1,0,0]
    v_pk_mul_f32 v[40:41], v[96:97], v[32:33] op_sel:[0,0] op_sel_hi:[0,1]
    v_pk_mul_f32 v[42:43], v[98:99], v[34:35] op_sel:[0,0] op_sel_hi:[0,1]
    v_pk_mul_f32 v[44:45], v[100:101], v[36:37] op_sel:[0,0] op_sel_hi:[0,1]
    v_pk_mul_f32 v[46:47], v[102:103], v[38:39] op_sel:[0,0] op_sel_hi:[0,1]
    v_pk_fma_f32 v[80:81], v[96:97], v[32:33], v[40:41] op_sel:[1,1,0] op_sel_hi:[1,0,1] neg_lo:[1,0,0] neg_hi:[1,0,1]
    v_pk_fma_f32 v[82:83], v[98:99], v[34:35], v[42:43] op_sel:[1,1,0] op_sel_hi:[1,0,1] neg_lo:[1,0,0] neg_hi:[1,0,1]
    v_pk_fma_f32 v[84:85], v[100:101], v[36:37], v[44:45] op_sel:[1,1,0] op_sel_hi:[1,0,1] neg_lo:[1,0,0] neg_hi:[1,0,1]
    v_pk_fma_f32 v[86:87], v[102:103], v[38:39], v[46:47] op_sel:[1,1,0] op_sel_hi:[1,0,1] neg_lo:[1,0,0] neg_hi:[1,0,1]
    v_cvt_pk_bf16_f32 v162, v72, v80
    v_cvt_pk_bf16_f32 v170, v74, v82
    v_cvt_pk_bf16_f32 v178, v76, v84
    v_cvt_pk_bf16_f32 v186, v78, v86
    v_cvt_pk_bf16_f32 v226, v73, v81
    v_cvt_pk_bf16_f32 v234, v75, v83
    v_cvt_pk_bf16_f32 v242, v77, v85
    v_cvt_pk_bf16_f32 v250, v79, v87
    v_accvgpr_read_b32 v64, a162
    v_accvgpr_read_b32 v66, a166
    v_accvgpr_read_b32 v68, a170
    v_accvgpr_read_b32 v70, a174
    v_accvgpr_read_b32 v65, a178
    v_accvgpr_read_b32 v67, a182
    v_accvgpr_read_b32 v69, a186
    v_accvgpr_read_b32 v71, a190
    v_pk_fma_f32 v[56:57], v[88:89], v[32:33], v[64:65] op_sel:[0,0,0] op_sel_hi:[0,1,1]
    v_pk_fma_f32 v[58:59], v[90:91], v[34:35], v[66:67] op_sel:[0,0,0] op_sel_hi:[0,1,1]
    v_pk_fma_f32 v[60:61], v[92:93], v[36:37], v[68:69] op_sel:[0,0,0] op_sel_hi:[0,1,1]
    v_pk_fma_f32 v[62:63], v[94:95], v[38:39], v[70:71] op_sel:[0,0,0] op_sel_hi:[0,1,1]
    v_pk_fma_f32 v[32:33], v[88:89], v[32:33], v[56:57] op_sel:[1,1,0] op_sel_hi:[1,0,1] neg_lo:[1,0,0]
    v_pk_fma_f32 v[34:35], v[90:91], v[34:35], v[58:59] op_sel:[1,1,0] op_sel_hi:[1,0,1] neg_lo:[1,0,0]
    v_pk_fma_f32 v[36:37], v[92:93], v[36:37], v[60:61] op_sel:[1,1,0] op_sel_hi:[1,0,1] neg_lo:[1,0,0]
    v_pk_fma_f32 v[38:39], v[94:95], v[38:39], v[62:63] op_sel:[1,1,0] op_sel_hi:[1,0,1] neg_lo:[1,0,0]
    v_pk_mul_f32 v[40:41], v[96:97], v[32:33] op_sel:[0,0] op_sel_hi:[0,1]
    v_pk_mul_f32 v[42:43], v[98:99], v[34:35] op_sel:[0,0] op_sel_hi:[0,1]
    v_pk_mul_f32 v[44:45], v[100:101], v[36:37] op_sel:[0,0] op_sel_hi:[0,1]
    v_pk_mul_f32 v[46:47], v[102:103], v[38:39] op_sel:[0,0] op_sel_hi:[0,1]
    v_pk_fma_f32 v[72:73], v[96:97], v[32:33], v[40:41] op_sel:[1,1,0] op_sel_hi:[1,0,1] neg_lo:[1,0,0] neg_hi:[1,0,1]
    v_pk_fma_f32 v[74:75], v[98:99], v[34:35], v[42:43] op_sel:[1,1,0] op_sel_hi:[1,0,1] neg_lo:[1,0,0] neg_hi:[1,0,1]
    v_pk_fma_f32 v[76:77], v[100:101], v[36:37], v[44:45] op_sel:[1,1,0] op_sel_hi:[1,0,1] neg_lo:[1,0,0] neg_hi:[1,0,1]
    v_pk_fma_f32 v[78:79], v[102:103], v[38:39], v[46:47] op_sel:[1,1,0] op_sel_hi:[1,0,1] neg_lo:[1,0,0] neg_hi:[1,0,1]
    v_accvgpr_read_b32 v48, a163
    v_accvgpr_read_b32 v50, a167
    v_accvgpr_read_b32 v52, a171
    v_accvgpr_read_b32 v54, a175
    v_accvgpr_read_b32 v49, a179
    v_accvgpr_read_b32 v51, a183
    v_accvgpr_read_b32 v53, a187
    v_accvgpr_read_b32 v55, a191
    v_pk_fma_f32 v[56:57], v[88:89], v[32:33], v[48:49] op_sel:[0,0,0] op_sel_hi:[0,1,1]
    v_pk_fma_f32 v[58:59], v[90:91], v[34:35], v[50:51] op_sel:[0,0,0] op_sel_hi:[0,1,1]
    v_pk_fma_f32 v[60:61], v[92:93], v[36:37], v[52:53] op_sel:[0,0,0] op_sel_hi:[0,1,1]
    v_pk_fma_f32 v[62:63], v[94:95], v[38:39], v[54:55] op_sel:[0,0,0] op_sel_hi:[0,1,1]
    v_pk_fma_f32 v[32:33], v[88:89], v[32:33], v[56:57] op_sel:[1,1,0] op_sel_hi:[1,0,1] neg_lo:[1,0,0]
    v_pk_fma_f32 v[34:35], v[90:91], v[34:35], v[58:59] op_sel:[1,1,0] op_sel_hi:[1,0,1] neg_lo:[1,0,0]
    v_pk_fma_f32 v[36:37], v[92:93], v[36:37], v[60:61] op_sel:[1,1,0] op_sel_hi:[1,0,1] neg_lo:[1,0,0]
    v_pk_fma_f32 v[38:39], v[94:95], v[38:39], v[62:63] op_sel:[1,1,0] op_sel_hi:[1,0,1] neg_lo:[1,0,0]
    v_pk_mul_f32 v[40:41], v[96:97], v[32:33] op_sel:[0,0] op_sel_hi:[0,1]
    v_pk_mul_f32 v[42:43], v[98:99], v[34:35] op_sel:[0,0] op_sel_hi:[0,1]
    v_pk_mul_f32 v[44:45], v[100:101], v[36:37] op_sel:[0,0] op_sel_hi:[0,1]
    v_pk_mul_f32 v[46:47], v[102:103], v[38:39] op_sel:[0,0] op_sel_hi:[0,1]
    v_pk_fma_f32 v[80:81], v[96:97], v[32:33], v[40:41] op_sel:[1,1,0] op_sel_hi:[1,0,1] neg_lo:[1,0,0] neg_hi:[1,0,1]
    v_pk_fma_f32 v[82:83], v[98:99], v[34:35], v[42:43] op_sel:[1,1,0] op_sel_hi:[1,0,1] neg_lo:[1,0,0] neg_hi:[1,0,1]
    v_pk_fma_f32 v[84:85], v[100:101], v[36:37], v[44:45] op_sel:[1,1,0] op_sel_hi:[1,0,1] neg_lo:[1,0,0] neg_hi:[1,0,1]
    v_pk_fma_f32 v[86:87], v[102:103], v[38:39], v[46:47] op_sel:[1,1,0] op_sel_hi:[1,0,1] neg_lo:[1,0,0] neg_hi:[1,0,1]
    v_cvt_pk_bf16_f32 v163, v72, v80
    v_cvt_pk_bf16_f32 v171, v74, v82
    v_cvt_pk_bf16_f32 v179, v76, v84
    v_cvt_pk_bf16_f32 v187, v78, v86
    v_cvt_pk_bf16_f32 v227, v73, v81
    v_cvt_pk_bf16_f32 v235, v75, v83
    v_cvt_pk_bf16_f32 v243, v77, v85
    v_cvt_pk_bf16_f32 v251, v79, v87
    v_accvgpr_read_b32 v64, a192
    v_accvgpr_read_b32 v66, a196
    v_accvgpr_read_b32 v68, a200
    v_accvgpr_read_b32 v70, a204
    v_accvgpr_read_b32 v65, a208
    v_accvgpr_read_b32 v67, a212
    v_accvgpr_read_b32 v69, a216
    v_accvgpr_read_b32 v71, a220
    v_pk_fma_f32 v[56:57], v[88:89], v[32:33], v[64:65] op_sel:[0,0,0] op_sel_hi:[0,1,1]
    v_pk_fma_f32 v[58:59], v[90:91], v[34:35], v[66:67] op_sel:[0,0,0] op_sel_hi:[0,1,1]
    v_pk_fma_f32 v[60:61], v[92:93], v[36:37], v[68:69] op_sel:[0,0,0] op_sel_hi:[0,1,1]
    v_pk_fma_f32 v[62:63], v[94:95], v[38:39], v[70:71] op_sel:[0,0,0] op_sel_hi:[0,1,1]
    v_pk_fma_f32 v[32:33], v[88:89], v[32:33], v[56:57] op_sel:[1,1,0] op_sel_hi:[1,0,1] neg_lo:[1,0,0]
    v_pk_fma_f32 v[34:35], v[90:91], v[34:35], v[58:59] op_sel:[1,1,0] op_sel_hi:[1,0,1] neg_lo:[1,0,0]
    v_pk_fma_f32 v[36:37], v[92:93], v[36:37], v[60:61] op_sel:[1,1,0] op_sel_hi:[1,0,1] neg_lo:[1,0,0]
    v_pk_fma_f32 v[38:39], v[94:95], v[38:39], v[62:63] op_sel:[1,1,0] op_sel_hi:[1,0,1] neg_lo:[1,0,0]
    v_pk_mul_f32 v[40:41], v[96:97], v[32:33] op_sel:[0,0] op_sel_hi:[0,1]
    v_pk_mul_f32 v[42:43], v[98:99], v[34:35] op_sel:[0,0] op_sel_hi:[0,1]
    v_pk_mul_f32 v[44:45], v[100:101], v[36:37] op_sel:[0,0] op_sel_hi:[0,1]
    v_pk_mul_f32 v[46:47], v[102:103], v[38:39] op_sel:[0,0] op_sel_hi:[0,1]
    v_pk_fma_f32 v[72:73], v[96:97], v[32:33], v[40:41] op_sel:[1,1,0] op_sel_hi:[1,0,1] neg_lo:[1,0,0] neg_hi:[1,0,1]
    v_pk_fma_f32 v[74:75], v[98:99], v[34:35], v[42:43] op_sel:[1,1,0] op_sel_hi:[1,0,1] neg_lo:[1,0,0] neg_hi:[1,0,1]
    v_pk_fma_f32 v[76:77], v[100:101], v[36:37], v[44:45] op_sel:[1,1,0] op_sel_hi:[1,0,1] neg_lo:[1,0,0] neg_hi:[1,0,1]
    v_pk_fma_f32 v[78:79], v[102:103], v[38:39], v[46:47] op_sel:[1,1,0] op_sel_hi:[1,0,1] neg_lo:[1,0,0] neg_hi:[1,0,1]
    v_accvgpr_read_b32 v48, a193
    v_accvgpr_read_b32 v50, a197
    v_accvgpr_read_b32 v52, a201
    v_accvgpr_read_b32 v54, a205
    v_accvgpr_read_b32 v49, a209
    v_accvgpr_read_b32 v51, a213
    v_accvgpr_read_b32 v53, a217
    v_accvgpr_read_b32 v55, a221
    v_pk_fma_f32 v[56:57], v[88:89], v[32:33], v[48:49] op_sel:[0,0,0] op_sel_hi:[0,1,1]
    v_pk_fma_f32 v[58:59], v[90:91], v[34:35], v[50:51] op_sel:[0,0,0] op_sel_hi:[0,1,1]
    v_pk_fma_f32 v[60:61], v[92:93], v[36:37], v[52:53] op_sel:[0,0,0] op_sel_hi:[0,1,1]
    v_pk_fma_f32 v[62:63], v[94:95], v[38:39], v[54:55] op_sel:[0,0,0] op_sel_hi:[0,1,1]
    v_pk_fma_f32 v[32:33], v[88:89], v[32:33], v[56:57] op_sel:[1,1,0] op_sel_hi:[1,0,1] neg_lo:[1,0,0]
    v_pk_fma_f32 v[34:35], v[90:91], v[34:35], v[58:59] op_sel:[1,1,0] op_sel_hi:[1,0,1] neg_lo:[1,0,0]
    v_pk_fma_f32 v[36:37], v[92:93], v[36:37], v[60:61] op_sel:[1,1,0] op_sel_hi:[1,0,1] neg_lo:[1,0,0]
    v_pk_fma_f32 v[38:39], v[94:95], v[38:39], v[62:63] op_sel:[1,1,0] op_sel_hi:[1,0,1] neg_lo:[1,0,0]
    v_pk_mul_f32 v[40:41], v[96:97], v[32:33] op_sel:[0,0] op_sel_hi:[0,1]
    v_pk_mul_f32 v[42:43], v[98:99], v[34:35] op_sel:[0,0] op_sel_hi:[0,1]
    v_pk_mul_f32 v[44:45], v[100:101], v[36:37] op_sel:[0,0] op_sel_hi:[0,1]
    v_pk_mul_f32 v[46:47], v[102:103], v[38:39] op_sel:[0,0] op_sel_hi:[0,1]
    v_pk_fma_f32 v[80:81], v[96:97], v[32:33], v[40:41] op_sel:[1,1,0] op_sel_hi:[1,0,1] neg_lo:[1,0,0] neg_hi:[1,0,1]
    v_pk_fma_f32 v[82:83], v[98:99], v[34:35], v[42:43] op_sel:[1,1,0] op_sel_hi:[1,0,1] neg_lo:[1,0,0] neg_hi:[1,0,1]
    v_pk_fma_f32 v[84:85], v[100:101], v[36:37], v[44:45] op_sel:[1,1,0] op_sel_hi:[1,0,1] neg_lo:[1,0,0] neg_hi:[1,0,1]
    v_pk_fma_f32 v[86:87], v[102:103], v[38:39], v[46:47] op_sel:[1,1,0] op_sel_hi:[1,0,1] neg_lo:[1,0,0] neg_hi:[1,0,1]
    v_cvt_pk_bf16_f32 v164, v72, v80
    v_cvt_pk_bf16_f32 v172, v74, v82
    v_cvt_pk_bf16_f32 v180, v76, v84
    v_cvt_pk_bf16_f32 v188, v78, v86
    v_cvt_pk_bf16_f32 v228, v73, v81
    v_cvt_pk_bf16_f32 v236, v75, v83
    v_cvt_pk_bf16_f32 v244, v77, v85
    v_cvt_pk_bf16_f32 v252, v79, v87
    v_accvgpr_read_b32 v64, a194
    v_accvgpr_read_b32 v66, a198
    v_accvgpr_read_b32 v68, a202
    v_accvgpr_read_b32 v70, a206
    v_accvgpr_read_b32 v65, a210
    v_accvgpr_read_b32 v67, a214
    v_accvgpr_read_b32 v69, a218
    v_accvgpr_read_b32 v71, a222
    v_pk_fma_f32 v[56:57], v[88:89], v[32:33], v[64:65] op_sel:[0,0,0] op_sel_hi:[0,1,1]
    v_pk_fma_f32 v[58:59], v[90:91], v[34:35], v[66:67] op_sel:[0,0,0] op_sel_hi:[0,1,1]
    v_pk_fma_f32 v[60:61], v[92:93], v[36:37], v[68:69] op_sel:[0,0,0] op_sel_hi:[0,1,1]
    v_pk_fma_f32 v[62:63], v[94:95], v[38:39], v[70:71] op_sel:[0,0,0] op_sel_hi:[0,1,1]
    v_pk_fma_f32 v[32:33], v[88:89], v[32:33], v[56:57] op_sel:[1,1,0] op_sel_hi:[1,0,1] neg_lo:[1,0,0]
    v_pk_fma_f32 v[34:35], v[90:91], v[34:35], v[58:59] op_sel:[1,1,0] op_sel_hi:[1,0,1] neg_lo:[1,0,0]
    v_pk_fma_f32 v[36:37], v[92:93], v[36:37], v[60:61] op_sel:[1,1,0] op_sel_hi:[1,0,1] neg_lo:[1,0,0]
    v_pk_fma_f32 v[38:39], v[94:95], v[38:39], v[62:63] op_sel:[1,1,0] op_sel_hi:[1,0,1] neg_lo:[1,0,0]
    v_pk_mul_f32 v[40:41], v[96:97], v[32:33] op_sel:[0,0] op_sel_hi:[0,1]
    v_pk_mul_f32 v[42:43], v[98:99], v[34:35] op_sel:[0,0] op_sel_hi:[0,1]
    v_pk_mul_f32 v[44:45], v[100:101], v[36:37] op_sel:[0,0] op_sel_hi:[0,1]
    v_pk_mul_f32 v[46:47], v[102:103], v[38:39] op_sel:[0,0] op_sel_hi:[0,1]
    v_pk_fma_f32 v[72:73], v[96:97], v[32:33], v[40:41] op_sel:[1,1,0] op_sel_hi:[1,0,1] neg_lo:[1,0,0] neg_hi:[1,0,1]
    v_pk_fma_f32 v[74:75], v[98:99], v[34:35], v[42:43] op_sel:[1,1,0] op_sel_hi:[1,0,1] neg_lo:[1,0,0] neg_hi:[1,0,1]
    v_pk_fma_f32 v[76:77], v[100:101], v[36:37], v[44:45] op_sel:[1,1,0] op_sel_hi:[1,0,1] neg_lo:[1,0,0] neg_hi:[1,0,1]
    v_pk_fma_f32 v[78:79], v[102:103], v[38:39], v[46:47] op_sel:[1,1,0] op_sel_hi:[1,0,1] neg_lo:[1,0,0] neg_hi:[1,0,1]
    v_accvgpr_read_b32 v48, a195
    v_accvgpr_read_b32 v50, a199
    v_accvgpr_read_b32 v52, a203
    v_accvgpr_read_b32 v54, a207
    v_accvgpr_read_b32 v49, a211
    v_accvgpr_read_b32 v51, a215
    v_accvgpr_read_b32 v53, a219
    v_accvgpr_read_b32 v55, a223
    v_pk_fma_f32 v[56:57], v[88:89], v[32:33], v[48:49] op_sel:[0,0,0] op_sel_hi:[0,1,1]
    v_pk_fma_f32 v[58:59], v[90:91], v[34:35], v[50:51] op_sel:[0,0,0] op_sel_hi:[0,1,1]
    v_pk_fma_f32 v[60:61], v[92:93], v[36:37], v[52:53] op_sel:[0,0,0] op_sel_hi:[0,1,1]
    v_pk_fma_f32 v[62:63], v[94:95], v[38:39], v[54:55] op_sel:[0,0,0] op_sel_hi:[0,1,1]
    v_pk_fma_f32 v[32:33], v[88:89], v[32:33], v[56:57] op_sel:[1,1,0] op_sel_hi:[1,0,1] neg_lo:[1,0,0]
    v_pk_fma_f32 v[34:35], v[90:91], v[34:35], v[58:59] op_sel:[1,1,0] op_sel_hi:[1,0,1] neg_lo:[1,0,0]
    v_pk_fma_f32 v[36:37], v[92:93], v[36:37], v[60:61] op_sel:[1,1,0] op_sel_hi:[1,0,1] neg_lo:[1,0,0]
    v_pk_fma_f32 v[38:39], v[94:95], v[38:39], v[62:63] op_sel:[1,1,0] op_sel_hi:[1,0,1] neg_lo:[1,0,0]
    v_pk_mul_f32 v[40:41], v[96:97], v[32:33] op_sel:[0,0] op_sel_hi:[0,1]
    v_pk_mul_f32 v[42:43], v[98:99], v[34:35] op_sel:[0,0] op_sel_hi:[0,1]
    v_pk_mul_f32 v[44:45], v[100:101], v[36:37] op_sel:[0,0] op_sel_hi:[0,1]
    v_pk_mul_f32 v[46:47], v[102:103], v[38:39] op_sel:[0,0] op_sel_hi:[0,1]
    v_pk_fma_f32 v[80:81], v[96:97], v[32:33], v[40:41] op_sel:[1,1,0] op_sel_hi:[1,0,1] neg_lo:[1,0,0] neg_hi:[1,0,1]
    v_pk_fma_f32 v[82:83], v[98:99], v[34:35], v[42:43] op_sel:[1,1,0] op_sel_hi:[1,0,1] neg_lo:[1,0,0] neg_hi:[1,0,1]
    v_pk_fma_f32 v[84:85], v[100:101], v[36:37], v[44:45] op_sel:[1,1,0] op_sel_hi:[1,0,1] neg_lo:[1,0,0] neg_hi:[1,0,1]
    v_pk_fma_f32 v[86:87], v[102:103], v[38:39], v[46:47] op_sel:[1,1,0] op_sel_hi:[1,0,1] neg_lo:[1,0,0] neg_hi:[1,0,1]
    v_cvt_pk_bf16_f32 v165, v72, v80
    v_cvt_pk_bf16_f32 v173, v74, v82
    v_cvt_pk_bf16_f32 v181, v76, v84
    v_cvt_pk_bf16_f32 v189, v78, v86
    v_cvt_pk_bf16_f32 v229, v73, v81
    v_cvt_pk_bf16_f32 v237, v75, v83
    v_cvt_pk_bf16_f32 v245, v77, v85
    v_cvt_pk_bf16_f32 v253, v79, v87
    v_accvgpr_read_b32 v64, a224
    v_accvgpr_read_b32 v66, a228
    v_accvgpr_read_b32 v68, a232
    v_accvgpr_read_b32 v70, a236
    v_accvgpr_read_b32 v65, a240
    v_accvgpr_read_b32 v67, a244
    v_accvgpr_read_b32 v69, a248
    v_accvgpr_read_b32 v71, a252
    v_pk_fma_f32 v[56:57], v[88:89], v[32:33], v[64:65] op_sel:[0,0,0] op_sel_hi:[0,1,1]
    v_pk_fma_f32 v[58:59], v[90:91], v[34:35], v[66:67] op_sel:[0,0,0] op_sel_hi:[0,1,1]
    v_pk_fma_f32 v[60:61], v[92:93], v[36:37], v[68:69] op_sel:[0,0,0] op_sel_hi:[0,1,1]
    v_pk_fma_f32 v[62:63], v[94:95], v[38:39], v[70:71] op_sel:[0,0,0] op_sel_hi:[0,1,1]
    v_pk_fma_f32 v[32:33], v[88:89], v[32:33], v[56:57] op_sel:[1,1,0] op_sel_hi:[1,0,1] neg_lo:[1,0,0]
    v_pk_fma_f32 v[34:35], v[90:91], v[34:35], v[58:59] op_sel:[1,1,0] op_sel_hi:[1,0,1] neg_lo:[1,0,0]
    v_pk_fma_f32 v[36:37], v[92:93], v[36:37], v[60:61] op_sel:[1,1,0] op_sel_hi:[1,0,1] neg_lo:[1,0,0]
    v_pk_fma_f32 v[38:39], v[94:95], v[38:39], v[62:63] op_sel:[1,1,0] op_sel_hi:[1,0,1] neg_lo:[1,0,0]
    v_pk_mul_f32 v[40:41], v[96:97], v[32:33] op_sel:[0,0] op_sel_hi:[0,1]
    v_pk_mul_f32 v[42:43], v[98:99], v[34:35] op_sel:[0,0] op_sel_hi:[0,1]
    v_pk_mul_f32 v[44:45], v[100:101], v[36:37] op_sel:[0,0] op_sel_hi:[0,1]
    v_pk_mul_f32 v[46:47], v[102:103], v[38:39] op_sel:[0,0] op_sel_hi:[0,1]
    v_pk_fma_f32 v[72:73], v[96:97], v[32:33], v[40:41] op_sel:[1,1,0] op_sel_hi:[1,0,1] neg_lo:[1,0,0] neg_hi:[1,0,1]
    v_pk_fma_f32 v[74:75], v[98:99], v[34:35], v[42:43] op_sel:[1,1,0] op_sel_hi:[1,0,1] neg_lo:[1,0,0] neg_hi:[1,0,1]
    v_pk_fma_f32 v[76:77], v[100:101], v[36:37], v[44:45] op_sel:[1,1,0] op_sel_hi:[1,0,1] neg_lo:[1,0,0] neg_hi:[1,0,1]
    v_pk_fma_f32 v[78:79], v[102:103], v[38:39], v[46:47] op_sel:[1,1,0] op_sel_hi:[1,0,1] neg_lo:[1,0,0] neg_hi:[1,0,1]
    v_accvgpr_read_b32 v48, a225
    v_accvgpr_read_b32 v50, a229
    v_accvgpr_read_b32 v52, a233
    v_accvgpr_read_b32 v54, a237
    v_accvgpr_read_b32 v49, a241
    v_accvgpr_read_b32 v51, a245
    v_accvgpr_read_b32 v53, a249
    v_accvgpr_read_b32 v55, a253
    v_pk_fma_f32 v[56:57], v[88:89], v[32:33], v[48:49] op_sel:[0,0,0] op_sel_hi:[0,1,1]
    v_pk_fma_f32 v[58:59], v[90:91], v[34:35], v[50:51] op_sel:[0,0,0] op_sel_hi:[0,1,1]
    v_pk_fma_f32 v[60:61], v[92:93], v[36:37], v[52:53] op_sel:[0,0,0] op_sel_hi:[0,1,1]
    v_pk_fma_f32 v[62:63], v[94:95], v[38:39], v[54:55] op_sel:[0,0,0] op_sel_hi:[0,1,1]
    v_pk_fma_f32 v[32:33], v[88:89], v[32:33], v[56:57] op_sel:[1,1,0] op_sel_hi:[1,0,1] neg_lo:[1,0,0]
    v_pk_fma_f32 v[34:35], v[90:91], v[34:35], v[58:59] op_sel:[1,1,0] op_sel_hi:[1,0,1] neg_lo:[1,0,0]
    v_pk_fma_f32 v[36:37], v[92:93], v[36:37], v[60:61] op_sel:[1,1,0] op_sel_hi:[1,0,1] neg_lo:[1,0,0]
    v_pk_fma_f32 v[38:39], v[94:95], v[38:39], v[62:63] op_sel:[1,1,0] op_sel_hi:[1,0,1] neg_lo:[1,0,0]
    v_pk_mul_f32 v[40:41], v[96:97], v[32:33] op_sel:[0,0] op_sel_hi:[0,1]
    v_pk_mul_f32 v[42:43], v[98:99], v[34:35] op_sel:[0,0] op_sel_hi:[0,1]
    v_pk_mul_f32 v[44:45], v[100:101], v[36:37] op_sel:[0,0] op_sel_hi:[0,1]
    v_pk_mul_f32 v[46:47], v[102:103], v[38:39] op_sel:[0,0] op_sel_hi:[0,1]
    v_pk_fma_f32 v[80:81], v[96:97], v[32:33], v[40:41] op_sel:[1,1,0] op_sel_hi:[1,0,1] neg_lo:[1,0,0] neg_hi:[1,0,1]
    v_pk_fma_f32 v[82:83], v[98:99], v[34:35], v[42:43] op_sel:[1,1,0] op_sel_hi:[1,0,1] neg_lo:[1,0,0] neg_hi:[1,0,1]
    v_pk_fma_f32 v[84:85], v[100:101], v[36:37], v[44:45] op_sel:[1,1,0] op_sel_hi:[1,0,1] neg_lo:[1,0,0] neg_hi:[1,0,1]
    v_pk_fma_f32 v[86:87], v[102:103], v[38:39], v[46:47] op_sel:[1,1,0] op_sel_hi:[1,0,1] neg_lo:[1,0,0] neg_hi:[1,0,1]
    v_cvt_pk_bf16_f32 v166, v72, v80
    v_cvt_pk_bf16_f32 v174, v74, v82
    v_cvt_pk_bf16_f32 v182, v76, v84
    v_cvt_pk_bf16_f32 v190, v78, v86
    v_cvt_pk_bf16_f32 v230, v73, v81
    v_cvt_pk_bf16_f32 v238, v75, v83
    v_cvt_pk_bf16_f32 v246, v77, v85
    v_cvt_pk_bf16_f32 v254, v79, v87
    v_accvgpr_read_b32 v64, a226
    v_accvgpr_read_b32 v66, a230
    v_accvgpr_read_b32 v68, a234
    v_accvgpr_read_b32 v70, a238
    v_accvgpr_read_b32 v65, a242
    v_accvgpr_read_b32 v67, a246
    v_accvgpr_read_b32 v69, a250
    v_accvgpr_read_b32 v71, a254
    v_pk_fma_f32 v[56:57], v[88:89], v[32:33], v[64:65] op_sel:[0,0,0] op_sel_hi:[0,1,1]
    v_pk_fma_f32 v[58:59], v[90:91], v[34:35], v[66:67] op_sel:[0,0,0] op_sel_hi:[0,1,1]
    v_pk_fma_f32 v[60:61], v[92:93], v[36:37], v[68:69] op_sel:[0,0,0] op_sel_hi:[0,1,1]
    v_pk_fma_f32 v[62:63], v[94:95], v[38:39], v[70:71] op_sel:[0,0,0] op_sel_hi:[0,1,1]
    v_pk_fma_f32 v[32:33], v[88:89], v[32:33], v[56:57] op_sel:[1,1,0] op_sel_hi:[1,0,1] neg_lo:[1,0,0]
    v_pk_fma_f32 v[34:35], v[90:91], v[34:35], v[58:59] op_sel:[1,1,0] op_sel_hi:[1,0,1] neg_lo:[1,0,0]
    v_pk_fma_f32 v[36:37], v[92:93], v[36:37], v[60:61] op_sel:[1,1,0] op_sel_hi:[1,0,1] neg_lo:[1,0,0]
    v_pk_fma_f32 v[38:39], v[94:95], v[38:39], v[62:63] op_sel:[1,1,0] op_sel_hi:[1,0,1] neg_lo:[1,0,0]
    v_pk_mul_f32 v[40:41], v[96:97], v[32:33] op_sel:[0,0] op_sel_hi:[0,1]
    v_pk_mul_f32 v[42:43], v[98:99], v[34:35] op_sel:[0,0] op_sel_hi:[0,1]
    v_pk_mul_f32 v[44:45], v[100:101], v[36:37] op_sel:[0,0] op_sel_hi:[0,1]
    v_pk_mul_f32 v[46:47], v[102:103], v[38:39] op_sel:[0,0] op_sel_hi:[0,1]
    v_pk_fma_f32 v[72:73], v[96:97], v[32:33], v[40:41] op_sel:[1,1,0] op_sel_hi:[1,0,1] neg_lo:[1,0,0] neg_hi:[1,0,1]
    v_pk_fma_f32 v[74:75], v[98:99], v[34:35], v[42:43] op_sel:[1,1,0] op_sel_hi:[1,0,1] neg_lo:[1,0,0] neg_hi:[1,0,1]
    v_pk_fma_f32 v[76:77], v[100:101], v[36:37], v[44:45] op_sel:[1,1,0] op_sel_hi:[1,0,1] neg_lo:[1,0,0] neg_hi:[1,0,1]
    v_pk_fma_f32 v[78:79], v[102:103], v[38:39], v[46:47] op_sel:[1,1,0] op_sel_hi:[1,0,1] neg_lo:[1,0,0] neg_hi:[1,0,1]
    v_accvgpr_read_b32 v48, a227
    v_accvgpr_read_b32 v50, a231
    v_accvgpr_read_b32 v52, a235
    v_accvgpr_read_b32 v54, a239
    v_accvgpr_read_b32 v49, a243
    v_accvgpr_read_b32 v51, a247
    v_accvgpr_read_b32 v53, a251
    v_accvgpr_read_b32 v55, a255
    v_pk_fma_f32 v[56:57], v[88:89], v[32:33], v[48:49] op_sel:[0,0,0] op_sel_hi:[0,1,1]
    v_pk_fma_f32 v[58:59], v[90:91], v[34:35], v[50:51] op_sel:[0,0,0] op_sel_hi:[0,1,1]
    v_pk_fma_f32 v[60:61], v[92:93], v[36:37], v[52:53] op_sel:[0,0,0] op_sel_hi:[0,1,1]
    v_pk_fma_f32 v[62:63], v[94:95], v[38:39], v[54:55] op_sel:[0,0,0] op_sel_hi:[0,1,1]
    v_pk_fma_f32 v[32:33], v[88:89], v[32:33], v[56:57] op_sel:[1,1,0] op_sel_hi:[1,0,1] neg_lo:[1,0,0]
    v_pk_fma_f32 v[34:35], v[90:91], v[34:35], v[58:59] op_sel:[1,1,0] op_sel_hi:[1,0,1] neg_lo:[1,0,0]
    v_pk_fma_f32 v[36:37], v[92:93], v[36:37], v[60:61] op_sel:[1,1,0] op_sel_hi:[1,0,1] neg_lo:[1,0,0]
    v_pk_fma_f32 v[38:39], v[94:95], v[38:39], v[62:63] op_sel:[1,1,0] op_sel_hi:[1,0,1] neg_lo:[1,0,0]
    v_pk_mul_f32 v[40:41], v[96:97], v[32:33] op_sel:[0,0] op_sel_hi:[0,1]
    v_pk_mul_f32 v[42:43], v[98:99], v[34:35] op_sel:[0,0] op_sel_hi:[0,1]
    v_pk_mul_f32 v[44:45], v[100:101], v[36:37] op_sel:[0,0] op_sel_hi:[0,1]
    v_pk_mul_f32 v[46:47], v[102:103], v[38:39] op_sel:[0,0] op_sel_hi:[0,1]
    v_pk_fma_f32 v[80:81], v[96:97], v[32:33], v[40:41] op_sel:[1,1,0] op_sel_hi:[1,0,1] neg_lo:[1,0,0] neg_hi:[1,0,1]
    v_pk_fma_f32 v[82:83], v[98:99], v[34:35], v[42:43] op_sel:[1,1,0] op_sel_hi:[1,0,1] neg_lo:[1,0,0] neg_hi:[1,0,1]
    v_pk_fma_f32 v[84:85], v[100:101], v[36:37], v[44:45] op_sel:[1,1,0] op_sel_hi:[1,0,1] neg_lo:[1,0,0] neg_hi:[1,0,1]
    v_pk_fma_f32 v[86:87], v[102:103], v[38:39], v[46:47] op_sel:[1,1,0] op_sel_hi:[1,0,1] neg_lo:[1,0,0] neg_hi:[1,0,1]
    v_cvt_pk_bf16_f32 v167, v72, v80
    v_cvt_pk_bf16_f32 v175, v74, v82
    v_cvt_pk_bf16_f32 v183, v76, v84
    v_cvt_pk_bf16_f32 v191, v78, v86
    v_cvt_pk_bf16_f32 v231, v73, v81
    v_cvt_pk_bf16_f32 v239, v75, v83
    v_cvt_pk_bf16_f32 v247, v77, v85
    v_cvt_pk_bf16_f32 v255, v79, v87
    s_lshl_b32 s50, s85, 20
    s_lshl_b32 s29, s29, 6
    s_add_u32 s50, s50, s29
    s_and_b32 s60, s58, 1
    s_lshl_b32 s60, s60, 12
    s_add_u32 s50, s50, s60
    s_add_u32 s50, s50, 0x4000000
    s_mov_b32 s5, 8192
    s_mov_b32 s51, 2048
    s_mov_b32 s52, 0x80000
    v_bfe_u32 v2, v0, 4, 1
    v_lshlrev_b32 v2, 6, v2
    v_xor_b32 v2, v2, v1
    v_add_u32 v3, 1024, v2
    s_mov_b32 s62, 0
L_pp_43:
    v_readfirstlane_b32 s59, v125
    s_and_b32 s60, s59, 0xff
    s_cmp_ge_u32 s60, 15
    s_cbranch_scc1 L_pok_44
    v_mov_b32 v24, 4
    global_load_dword v125, v24, s[98:99] sc1
    s_add_u32 s62, s62, 1
    s_cmp_gt_u32 s62, 0x200000
    s_cbranch_scc1 chain_kernel_wabort
    s_waitcnt vmcnt(0)
    s_branch L_pp_43
L_pok_44:
    s_cmp_ge_u32 s59, 0x800
    s_cselect_b32 s59, 0x2000, 0
    s_mov_b32 s18, 0x8000000
    s_mov_b32 s4, 12
    s_and_b32 s0, s57, 7
    s_lshr_b32 s85, s57, 3
    s_lshl3_add_u32 s0, s56, s0
    s_cmp_ge_u32 s57, 16
    s_cbranch_scc1 L_nq_45
    s_and_b32 s62, s57, 3
    s_lshl2_add_u32 s62, s56, s62
    s_lshr_b32 s63, s57, 2
    s_lshl_b32 s60, s63, 19
    s_mov_b32 s30, s74
    s_and_b32 s31, s75, 0xffff
    s_mov_b32 s32, 0x200000
    s_mov_b32 s33, s60
    s_mov_b32 s34, 0x8000
    s_mov_b32 s35, 0x40000
    s_lshl_b32 s60, s62, 20
    s_add_u32 s60, s60, 0x0
    s_add_u32 s36, s100, 0x4000000
    s_addc_u32 s37, s101, 0
    s_and_b32 s37, s37, 0xffff
    s_mov_b32 s38, 0x800000
    s_mov_b32 s39, s60
    s_mov_b32 s40, 0x800
    s_mov_b32 s41, 0x4000
    s_mov_b32 s42, 0x8000
    s_mov_b32 s84, s62
    s_lshl_b32 s94, s63, 0
    v_bfe_u32 v24, v0, 4, 2
    v_and_b32 v25, 7, v0
    v_xor_b32 v24, v24, v25
    v_lshlrev_b32 v8, 4, v24
    v_bfe_u32 v24, v0, 3, 3
    v_lshl_add_u32 v8, v24, 11, v8
    v_bfe_u32 v24, v0, 6, 2
    v_lshl_add_u32 v8, v24, 16, v8
    v_xor_b32 v9, 64, v8
    v_add_u32 v9, 0x4000, v9
    s_lshl_b32 s61, s58, 12
    v_add_u32 v10, s61, v1
    v_add_u32 v11, 1024, v10
    s_mov_b32 s3, 12
    s_branch L_c_46
L_nq_45:
    s_and_b32 s62, s57, 3
    s_add_u32 s62, s62, 0
    s_lshr_b32 s63, s57, 2
    s_lshl3_add_u32 s62, s56, s62
    s_lshl_b32 s60, s63, 19
    s_mov_b32 s30, s82
    s_and_b32 s31, s83, 0xffff
    s_mov_b32 s32, 0x400000
    s_mov_b32 s33, s60
    s_mov_b32 s34, 0x8000
    s_mov_b32 s35, 0x40000
    s_lshl_b32 s60, s62, 9
    s_mov_b32 s36, s86
    s_and_b32 s37, s87, 0xffff
    s_mov_b32 s38, 0x800000
    s_mov_b32 s39, s60
    s_mov_b32 s40, 0x8000
    s_mov_b32 s41, 0x40000
    s_mov_b32 s42, 0x80000
    v_bfe_u32 v24, v0, 4, 2
    v_and_b32 v25, 7, v0
    v_xor_b32 v24, v24, v25
    v_lshlrev_b32 v8, 4, v24
    v_bfe_u32 v24, v0, 3, 3
    v_lshl_add_u32 v8, v24, 11, v8
    v_bfe_u32 v24, v0, 6, 2
    v_lshl_add_u32 v8, v24, 16, v8
    v_xor_b32 v9, 64, v8
    v_add_u32 v9, 0x4000, v9
    v_bfe_u32 v24, v0, 5, 1
    v_bfe_u32 v25, v0, 6, 1
    v_lshl_add_u32 v25, v25, 2, v24
    v_lshlrev_b32 v25, 1, v25
    v_and_b32 v10, 31, v0
    v_xor_b32 v10, v10, v25
    v_lshlrev_b32 v10, 4, v10
    v_lshl_add_u32 v10, v24, 13, v10
    v_lshrrev_b32 v24, 6, v0
    v_lshl_add_u32 v10, v24, 16, v10
    v_xor_b32 v11, 64, v10
    v_add_u32 v11, 0x4000, v11
    s_mov_b32 s84, s62
    s_lshl_b32 s94, s63, 0
    s_mov_b32 s3, 0
L_c_46:
    s_call_b64 s[54:55], t_kq
    s_call_b64 s[54:55], t_conv
    s_and_b32 s60, s58, 1
    s_lshl1_add_u32 s60, s85, s60
    s_lshl_b32 s50, s60, 22
    s_lshr_b32 s60, s58, 1
    s_lshl1_add_u32 s60, s0, s60
    s_lshl_b32 s60, s60, 15
    s_add_u32 s50, s50, s60
    s_add_u32 s50, s50, s59
    s_xor_b32 s50, s50, 0x2000
    s_mov_b32 s5, 2048
    s_mov_b32 s51, 0x100000
    s_mov_b32 s60, 0x202000
    s_bitcmp1_b32 s50, 13
    s_cselect_b32 s52, 0x1fe000, s60
    v_mov_b32 v2, v1
    v_add_u32 v3, 1024, v1
    s_mov_b32 s18, 0x8000000
    s_mov_b32 s4, 32
    s_mov_b32 s3, 0
    s_cmp_ge_u32 s57, 16
    s_cbranch_scc1 L_cq_47
    s_and_b32 s62, s57, 3
    s_lshl2_add_u32 s62, s56, s62
    s_lshr_b32 s63, s57, 2
    s_lshl_b32 s60, s63, 19
    s_mov_b32 s30, s76
    s_and_b32 s31, s77, 0xffff
    s_mov_b32 s32, 0x200000
    s_mov_b32 s33, s60
    s_mov_b32 s34, 0x8000
    s_mov_b32 s35, 0x40000
    s_lshl_b32 s60, s62, 20
    s_add_u32 s60, s60, 0x80000
    s_add_u32 s36, s100, 0x4000000
    s_addc_u32 s37, s101, 0
    s_and_b32 s37, s37, 0xffff
    s_mov_b32 s38, 0x800000
    s_mov_b32 s39, s60
    s_mov_b32 s40, 0x800
    s_mov_b32 s41, 0x4000
    s_mov_b32 s42, 0x8000
    s_mov_b32 s84, s62
    s_lshl_b32 s94, s63, 0
    v_bfe_u32 v24, v0, 4, 2
    v_and_b32 v25, 7, v0
    v_xor_b32 v24, v24, v25
    v_lshlrev_b32 v8, 4, v24
    v_bfe_u32 v24, v0, 3, 3
    v_lshl_add_u32 v8, v24, 11, v8
    v_bfe_u32 v24, v0, 6, 2
    v_lshl_add_u32 v8, v24, 16, v8
    v_xor_b32 v9, 64, v8
    v_add_u32 v9, 0x4000, v9
    s_lshl_b32 s61, s58, 12
    v_add_u32 v10, s61, v1
    v_add_u32 v11, 1024, v10
    s_call_b64 s[54:55], t_g2
    s_mov_b32 s32, 0
    s_mov_b32 s38, 0
    s_mov_b32 s18, 0
    s_mov_b32 s4, 0
    s_call_b64 s[54:55], t_g2_c
    s_and_b32 s85, s57, 3
    s_lshl2_add_u32 s85, s56, s85
    s_lshr_b32 s0, s57, 2
    s_waitcnt vmcnt(0)
    s_barrier
    v_and_b32 v26, 31, v0
    v_bfe_u32 v25, v0, 6, 1
    v_lshl_add_u32 v27, v25, 5, v26
    v_bfe_u32 v28, v0, 5, 1
    v_bfe_u32 v24, v0, 7, 1
    v_lshl_add_u32 v24, v24, 7, v28
    v_lshlrev_b32 v25, 13, v24
    v_lshl_add_u32 v25, v27, 4, v25
    v_lshlrev_b32 v24, 11, v24
    v_lshl_add_u32 v24, v27, 3, v24
    v_lshlrev_b32 v27, 3, v27
    s_mov_b32 s60, s80
    s_and_b32 s61, s81, 0xffff
    s_mov_b32 s62, 0x800
    s_mov_b32 s63, 0x00020000
    s_lshl_b32 s53, s0, 9
    buffer_load_dwordx2 v[44:45], v27, s[60:63], s53 offen
    s_mov_b32 s8, s64
    s_and_b32 s9, s65, 0xffff
    s_mov_b32 s10, 0x400000
    s_mov_b32 s11, 0x00020000
    s_mov_b32 s12, s96
    s_and_b32 s13, s97, 0xffff
    s_mov_b32 s14, 0x1000000
    s_mov_b32 s15, 0x00020000
    s_lshl_b32 s50, s85, 19
    s_add_u32 s50, s50, s53
    s_add_u32 s53, s50, 0x0
    buffer_load_dwordx2 v[128:129], v24, s[8:11], s53 offen
    s_add_u32 s53, s50, 0x1000
    buffer_load_dwordx2 v[130:131], v24, s[8:11], s53 offen
    s_add_u32 s53, s50, 0x2000
    buffer_load_dwordx2 v[132:133], v24, s[8:11], s53 offen
    s_add_u32 s53, s50, 0x3000
    buffer_load_dwordx2 v[134:135], v24, s[8:11], s53 offen
    s_add_u32 s53, s50, 0x10000
    buffer_load_dwordx2 v[136:137], v24, s[8:11], s53 offen
    s_add_u32 s53, s50, 0x11000
    buffer_load_dwordx2 v[138:139], v24, s[8:11], s53 offen
    s_add_u32 s53, s50, 0x12000
    buffer_load_dwordx2 v[140:141], v24, s[8:11], s53 offen
    s_add_u32 s53, s50, 0x13000
    buffer_load_dwordx2 v[142:143], v24, s[8:11], s53 offen
    s_add_u32 s53, s50, 0x20000
    buffer_load_dwordx2 v[144:145], v24, s[8:11], s53 offen
    s_add_u32 s53, s50, 0x21000
    buffer_load_dwordx2 v[146:147], v24, s[8:11], s53 offen
    s_add_u32 s53, s50, 0x22000
    buffer_load_dwordx2 v[148:149], v24, s[8:11], s53 offen
    s_add_u32 s53, s50, 0x23000
    buffer_load_dwordx2 v[150:151], v24, s[8:11], s53 offen
    s_add_u32 s53, s50, 0x30000
    buffer_load_dwordx2 v[152:153], v24, s[8:11], s53 offen
    s_add_u32 s53, s50, 0x31000
    buffer_load_dwordx2 v[154:155], v24, s[8:11], s53 offen
    s_add_u32 s53, s50, 0x32000
    buffer_load_dwordx2 v[156:157], v24, s[8:11], s53 offen
    s_add_u32 s53, s50, 0x33000
    buffer_load_dwordx2 v[158:159], v24, s[8:11], s53 offen
    s_add_u32 s53, s50, 0x4000
    buffer_load_dwordx2 v[160:161], v24, s[8:11], s53 offen
    s_add_u32 s53, s50, 0x5000
    buffer_load_dwordx2 v[162:163], v24, s[8:11], s53 offen
    s_add_u32 s53, s50, 0x6000
    buffer_load_dwordx2 v[164:165], v24, s[8:11], s53 offen
    s_add_u32 s53, s50, 0x7000
    buffer_load_dwordx2 v[166:167], v24, s[8:11], s53 offen
    s_add_u32 s53, s50, 0x14000
    buffer_load_dwordx2 v[168:169], v24, s[8:11], s53 offen
    s_add_u32 s53, s50, 0x15000
    buffer_load_dwordx2 v[170:171], v24, s[8:11], s53 offen
    s_add_u32 s53, s50, 0x16000
    buffer_load_dwordx2 v[172:173], v24, s[8:11], s53 offen
    s_add_u32 s53, s50, 0x17000
    buffer_load_dwordx2 v[174:175], v24, s[8:11], s53 offen
    s_add_u32 s53, s50, 0x24000
    buffer_load_dwordx2 v[176:177], v24, s[8:11], s53 offen
    s_add_u32 s53, s50, 0x25000
    buffer_load_dwordx2 v[178:179], v24, s[8:11], s53 offen
    s_add_u32 s53, s50, 0x26000
    buffer_load_dwordx2 v[180:181], v24, s[8:11], s53 offen
    s_add_u32 s53, s50, 0x27000
    buffer_load_dwordx2 v[182:183], v24, s[8:11], s53 offen
    s_add_u32 s53, s50, 0x34000
    buffer_load_dwordx2 v[184:185], v24, s[8:11], s53 offen
    s_add_u32 s53, s50, 0x35000
    buffer_load_dwordx2 v[186:187], v24, s[8:11], s53 offen
    s_add_u32 s53, s50, 0x36000
    buffer_load_dwordx2 v[188:189], v24, s[8:11], s53 offen
    s_add_u32 s53, s50, 0x37000
    buffer_load_dwordx2 v[190:191], v24, s[8:11], s53 offen
    s_mul_i32 s60, s58, 33792
    v_mul_u32_u24 v28, 528, v28
    v_lshl_add_u32 v28, v26, 4, v28
    v_add_u32 v28, s60, v28
    v_and_b32 v27, 15, v0
    v_mul_u32_u24 v27, 528, v27
    v_bfe_u32 v26, v0, 4, 2
    v_lshl_add_u32 v27, v26, 4, v27
    v_add_u32 v27, s60, v27
    s_lshl_b32 s51, s85, 21
    s_lshl_b32 s52, s0, 10
    s_add_u32 s51, s51, s52
    ds_write_b128 v27, a[0:3] offset:0
    ds_write_b128 v27, a[32:35] offset:64
    ds_write_b128 v27, a[64:67] offset:128
    ds_write_b128 v27, a[96:99] offset:192
    ds_write_b128 v27, a[128:131] offset:256
    ds_write_b128 v27, a[160:163] offset:320
    ds_write_b128 v27, a[192:195] offset:384
    ds_write_b128 v27, a[224:227] offset:448
    ds_read_b128 v[48:51], v28 offset:0
    ds_read_b128 v[52:55], v28 offset:1056
    ds_read_b128 v[56:59], v28 offset:2112
    ds_read_b128 v[60:63], v28 offset:3168
    ds_read_b128 v[64:67], v28 offset:4224
    ds_read_b128 v[68:71], v28 offset:5280
    ds_read_b128 v[72:75], v28 offset:6336
    ds_read_b128 v[76:79], v28 offset:7392
    ds_write_b128 v27, a[4:7] offset:8448
    ds_write_b128 v27, a[36:39] offset:8512
    ds_write_b128 v27, a[68:71] offset:8576
    ds_write_b128 v27, a[100:103] offset:8640
    ds_write_b128 v27, a[132:135] offset:8704
    ds_write_b128 v27, a[164:167] offset:8768
    ds_write_b128 v27, a[196:199] offset:8832
    ds_write_b128 v27, a[228:231] offset:8896
    s_waitcnt vmcnt(32)
    v_lshlrev_b32 v40, 16, v44
    v_and_b32 v41, 0xffff0000, v44
    v_lshlrev_b32 v42, 16, v45
    v_and_b32 v43, 0xffff0000, v45
    s_waitcnt vmcnt(24) lgkmcnt(8)
    ds_read_b128 v[80:83], v28 offset:8448
    ds_read_b128 v[84:87], v28 offset:9504
    ds_read_b128 v[88:91], v28 offset:10560
    ds_read_b128 v[92:95], v28 offset:11616
    ds_read_b128 v[96:99], v28 offset:12672
    ds_read_b128 v[100:103], v28 offset:13728
    ds_read_b128 v[104:107], v28 offset:14784
    ds_read_b128 v[108:111], v28 offset:15840
    ds_write_b128 v27, a[8:11] offset:16896
    ds_write_b128 v27, a[40:43] offset:16960
    ds_write_b128 v27, a[72:75] offset:17024
    ds_write_b128 v27, a[104:107] offset:17088
    ds_write_b128 v27, a[136:139] offset:17152
    ds_write_b128 v27, a[168:171] offset:17216
    ds_write_b128 v27, a[200:203] offset:17280
    ds_write_b128 v27, a[232:235] offset:17344
    v_lshlrev_b32 v112, 16, v128
    v_and_b32 v113, 0xffff0000, v128
    v_lshlrev_b32 v114, 16, v129
    v_and_b32 v115, 0xffff0000, v129
    v_pk_mul_f32 v[112:113], v[112:113], v[40:41]
    v_pk_mul_f32 v[114:115], v[114:115], v[42:43]
    s_add_u32 s52, s51, 0x0
    v_cvt_pk_bf16_f32 v112, 0, v112
    v_cvt_pk_bf16_f32 v113, 0, v113
    v_cvt_pk_bf16_f32 v114, 0, v114
    v_cvt_pk_bf16_f32 v115, 0, v115
    v_pk_add_f32 v[48:49], v[48:49], v[112:113]
    v_pk_add_f32 v[50:51], v[50:51], v[114:115]
    buffer_store_dwordx4 v[48:51], v25, s[12:15], s52 offen
    v_lshlrev_b32 v116, 16, v130
    v_and_b32 v117, 0xffff0000, v130
    v_lshlrev_b32 v118, 16, v131
    v_and_b32 v119, 0xffff0000, v131
    v_pk_mul_f32 v[116:117], v[116:117], v[40:41]
    v_pk_mul_f32 v[118:119], v[118:119], v[42:43]
    s_add_u32 s52, s51, 0x4000
    v_cvt_pk_bf16_f32 v116, 0, v116
    v_cvt_pk_bf16_f32 v117, 0, v117
    v_cvt_pk_bf16_f32 v118, 0, v118
    v_cvt_pk_bf16_f32 v119, 0, v119
    v_pk_add_f32 v[52:53], v[52:53], v[116:117]
    v_pk_add_f32 v[54:55], v[54:55], v[118:119]
    buffer_store_dwordx4 v[52:55], v25, s[12:15], s52 offen
    v_lshlrev_b32 v112, 16, v132
    v_and_b32 v113, 0xffff0000, v132
    v_lshlrev_b32 v114, 16, v133
    v_and_b32 v115, 0xffff0000, v133
    v_pk_mul_f32 v[112:113], v[112:113], v[40:41]
    v_pk_mul_f32 v[114:115], v[114:115], v[42:43]
    s_add_u32 s52, s51, 0x8000
    v_cvt_pk_bf16_f32 v112, 0, v112
    v_cvt_pk_bf16_f32 v113, 0, v113
    v_cvt_pk_bf16_f32 v114, 0, v114
    v_cvt_pk_bf16_f32 v115, 0, v115
    v_pk_add_f32 v[56:57], v[56:57], v[112:113]
    v_pk_add_f32 v[58:59], v[58:59], v[114:115]
    buffer_store_dwordx4 v[56:59], v25, s[12:15], s52 offen
    v_lshlrev_b32 v116, 16, v134
    v_and_b32 v117, 0xffff0000, v134
    v_lshlrev_b32 v118, 16, v135
    v_and_b32 v119, 0xffff0000, v135
    v_pk_mul_f32 v[116:117], v[116:117], v[40:41]
    v_pk_mul_f32 v[118:119], v[118:119], v[42:43]
    s_add_u32 s52, s51, 0xc000
    v_cvt_pk_bf16_f32 v116, 0, v116
    v_cvt_pk_bf16_f32 v117, 0, v117
    v_cvt_pk_bf16_f32 v118, 0, v118
    v_cvt_pk_bf16_f32 v119, 0, v119
    v_pk_add_f32 v[60:61], v[60:61], v[116:117]
    v_pk_add_f32 v[62:63], v[62:63], v[118:119]
    buffer_store_dwordx4 v[60:63], v25, s[12:15], s52 offen
    v_lshlrev_b32 v112, 16, v136
    v_and_b32 v113, 0xffff0000, v136
    v_lshlrev_b32 v114, 16, v137
    v_and_b32 v115, 0xffff0000, v137
    v_pk_mul_f32 v[112:113], v[112:113], v[40:41]
    v_pk_mul_f32 v[114:115], v[114:115], v[42:43]
    s_add_u32 s52, s51, 0x40000
    v_cvt_pk_bf16_f32 v112, 0, v112
    v_cvt_pk_bf16_f32 v113, 0, v113
    v_cvt_pk_bf16_f32 v114, 0, v114
    v_cvt_pk_bf16_f32 v115, 0, v115
    v_pk_add_f32 v[64:65], v[64:65], v[112:113]
    v_pk_add_f32 v[66:67], v[66:67], v[114:115]
    buffer_store_dwordx4 v[64:67], v25, s[12:15], s52 offen
    v_lshlrev_b32 v116, 16, v138
    v_and_b32 v117, 0xffff0000, v138
    v_lshlrev_b32 v118, 16, v139
    v_and_b32 v119, 0xffff0000, v139
    v_pk_mul_f32 v[116:117], v[116:117], v[40:41]
    v_pk_mul_f32 v[118:119], v[118:119], v[42:43]
    s_add_u32 s52, s51, 0x44000
    v_cvt_pk_bf16_f32 v116, 0, v116
    v_cvt_pk_bf16_f32 v117, 0, v117
    v_cvt_pk_bf16_f32 v118, 0, v118
    v_cvt_pk_bf16_f32 v119, 0, v119
    v_pk_add_f32 v[68:69], v[68:69], v[116:117]
    v_pk_add_f32 v[70:71], v[70:71], v[118:119]
    buffer_store_dwordx4 v[68:71], v25, s[12:15], s52 offen
    v_lshlrev_b32 v112, 16, v140
    v_and_b32 v113, 0xffff0000, v140
    v_lshlrev_b32 v114, 16, v141
    v_and_b32 v115, 0xffff0000, v141
    v_pk_mul_f32 v[112:113], v[112:113], v[40:41]
    v_pk_mul_f32 v[114:115], v[114:115], v[42:43]
    s_add_u32 s52, s51, 0x48000
    v_cvt_pk_bf16_f32 v112, 0, v112
    v_cvt_pk_bf16_f32 v113, 0, v113
    v_cvt_pk_bf16_f32 v114, 0, v114
    v_cvt_pk_bf16_f32 v115, 0, v115
    v_pk_add_f32 v[72:73], v[72:73], v[112:113]
    v_pk_add_f32 v[74:75], v[74:75], v[114:115]
    buffer_store_dwordx4 v[72:75], v25, s[12:15], s52 offen
    v_lshlrev_b32 v116, 16, v142
    v_and_b32 v117, 0xffff0000, v142
    v_lshlrev_b32 v118, 16, v143
    v_and_b32 v119, 0xffff0000, v143
    v_pk_mul_f32 v[116:117], v[116:117], v[40:41]
    v_pk_mul_f32 v[118:119], v[118:119], v[42:43]
    s_add_u32 s52, s51, 0x4c000
    v_cvt_pk_bf16_f32 v116, 0, v116
    v_cvt_pk_bf16_f32 v117, 0, v117
    v_cvt_pk_bf16_f32 v118, 0, v118
    v_cvt_pk_bf16_f32 v119, 0, v119
    v_pk_add_f32 v[76:77], v[76:77], v[116:117]
    v_pk_add_f32 v[78:79], v[78:79], v[118:119]
    buffer_store_dwordx4 v[76:79], v25, s[12:15], s52 offen
    s_add_u32 s53, s50, 0x8000
    buffer_load_dwordx2 v[192:193], v24, s[8:11], s53 offen
    s_add_u32 s53, s50, 0x9000
    buffer_load_dwordx2 v[194:195], v24, s[8:11], s53 offen
    s_add_u32 s53, s50, 0xa000
    buffer_load_dwordx2 v[196:197], v24, s[8:11], s53 offen
    s_add_u32 s53, s50, 0xb000
    buffer_load_dwordx2 v[198:199], v24, s[8:11], s53 offen
    s_add_u32 s53, s50, 0x18000
    buffer_load_dwordx2 v[200:201], v24, s[8:11], s53 offen
    s_add_u32 s53, s50, 0x19000
    buffer_load_dwordx2 v[202:203], v24, s[8:11], s53 offen
    s_add_u32 s53, s50, 0x1a000
    buffer_load_dwordx2 v[204:205], v24, s[8:11], s53 offen
    s_add_u32 s53, s50, 0x1b000
    buffer_load_dwordx2 v[206:207], v24, s[8:11], s53 offen
    s_waitcnt vmcnt(32) lgkmcnt(8)
    ds_read_b128 v[48:51], v28 offset:16896
    ds_read_b128 v[52:55], v28 offset:17952
    ds_read_b128 v[56:59], v28 offset:19008
    ds_read_b128 v[60:63], v28 offset:20064
    ds_read_b128 v[64:67], v28 offset:21120
    ds_read_b128 v[68:71], v28 offset:22176
    ds_read_b128 v[72:75], v28 offset:23232
    ds_read_b128 v[76:79], v28 offset:24288
    ds_write_b128 v27, a[12:15] offset:25344
    ds_write_b128 v27, a[44:47] offset:25408
    ds_write_b128 v27, a[76:79] offset:25472
    ds_write_b128 v27, a[108:111] offset:25536
    ds_write_b128 v27, a[140:143] offset:25600
    ds_write_b128 v27, a[172:175] offset:25664
    ds_write_b128 v27, a[204:207] offset:25728
    ds_write_b128 v27, a[236:239] offset:25792
    v_lshlrev_b32 v112, 16, v144
    v_and_b32 v113, 0xffff0000, v144
    v_lshlrev_b32 v114, 16, v145
    v_and_b32 v115, 0xffff0000, v145
    v_pk_mul_f32 v[112:113], v[112:113], v[40:41]
    v_pk_mul_f32 v[114:115], v[114:115], v[42:43]
    s_add_u32 s52, s51, 0x80000
    v_cvt_pk_bf16_f32 v112, 0, v112
    v_cvt_pk_bf16_f32 v113, 0, v113
    v_cvt_pk_bf16_f32 v114, 0, v114
    v_cvt_pk_bf16_f32 v115, 0, v115
    v_pk_add_f32 v[80:81], v[80:81], v[112:113]
    v_pk_add_f32 v[82:83], v[82:83], v[114:115]
    buffer_store_dwordx4 v[80:83], v25, s[12:15], s52 offen
    v_lshlrev_b32 v116, 16, v146
    v_and_b32 v117, 0xffff0000, v146
    v_lshlrev_b32 v118, 16, v147
    v_and_b32 v119, 0xffff0000, v147
    v_pk_mul_f32 v[116:117], v[116:117], v[40:41]
    v_pk_mul_f32 v[118:119], v[118:119], v[42:43]
    s_add_u32 s52, s51, 0x84000
    v_cvt_pk_bf16_f32 v116, 0, v116
    v_cvt_pk_bf16_f32 v117, 0, v117
    v_cvt_pk_bf16_f32 v118, 0, v118
    v_cvt_pk_bf16_f32 v119, 0, v119
    v_pk_add_f32 v[84:85], v[84:85], v[116:117]
    v_pk_add_f32 v[86:87], v[86:87], v[118:119]
    buffer_store_dwordx4 v[84:87], v25, s[12:15], s52 offen
    v_lshlrev_b32 v112, 16, v148
    v_and_b32 v113, 0xffff0000, v148
    v_lshlrev_b32 v114, 16, v149
    v_and_b32 v115, 0xffff0000, v149
    v_pk_mul_f32 v[112:113], v[112:113], v[40:41]
    v_pk_mul_f32 v[114:115], v[114:115], v[42:43]
    s_add_u32 s52, s51, 0x88000
    v_cvt_pk_bf16_f32 v112, 0, v112
    v_cvt_pk_bf16_f32 v113, 0, v113
    v_cvt_pk_bf16_f32 v114, 0, v114
    v_cvt_pk_bf16_f32 v115, 0, v115
    v_pk_add_f32 v[88:89], v[88:89], v[112:113]
    v_pk_add_f32 v[90:91], v[90:91], v[114:115]
    buffer_store_dwordx4 v[88:91], v25, s[12:15], s52 offen
    v_lshlrev_b32 v116, 16, v150
    v_and_b32 v117, 0xffff0000, v150
    v_lshlrev_b32 v118, 16, v151
    v_and_b32 v119, 0xffff0000, v151
    v_pk_mul_f32 v[116:117], v[116:117], v[40:41]
    v_pk_mul_f32 v[118:119], v[118:119], v[42:43]
    s_add_u32 s52, s51, 0x8c000
    v_cvt_pk_bf16_f32 v116, 0, v116
    v_cvt_pk_bf16_f32 v117, 0, v117
    v_cvt_pk_bf16_f32 v118, 0, v118
    v_cvt_pk_bf16_f32 v119, 0, v119
    v_pk_add_f32 v[92:93], v[92:93], v[116:117]
    v_pk_add_f32 v[94:95], v[94:95], v[118:119]
    buffer_store_dwordx4 v[92:95], v25, s[12:15], s52 offen
    v_lshlrev_b32 v112, 16, v152
    v_and_b32 v113, 0xffff0000, v152
    v_lshlrev_b32 v114, 16, v153
    v_and_b32 v115, 0xffff0000, v153
    v_pk_mul_f32 v[112:113], v[112:113], v[40:41]
    v_pk_mul_f32 v[114:115], v[114:115], v[42:43]
    s_add_u32 s52, s51, 0xc0000
    v_cvt_pk_bf16_f32 v112, 0, v112
    v_cvt_pk_bf16_f32 v113, 0, v113
    v_cvt_pk_bf16_f32 v114, 0, v114
    v_cvt_pk_bf16_f32 v115, 0, v115
    v_pk_add_f32 v[96:97], v[96:97], v[112:113]
    v_pk_add_f32 v[98:99], v[98:99], v[114:115]
    buffer_store_dwordx4 v[96:99], v25, s[12:15], s52 offen
    v_lshlrev_b32 v116, 16, v154
    v_and_b32 v117, 0xffff0000, v154
    v_lshlrev_b32 v118, 16, v155
    v_and_b32 v119, 0xffff0000, v155
    v_pk_mul_f32 v[116:117], v[116:117], v[40:41]
    v_pk_mul_f32 v[118:119], v[118:119], v[42:43]
    s_add_u32 s52, s51, 0xc4000
    v_cvt_pk_bf16_f32 v116, 0, v116
    v_cvt_pk_bf16_f32 v117, 0, v117
    v_cvt_pk_bf16_f32 v118, 0, v118
    v_cvt_pk_bf16_f32 v119, 0, v119
    v_pk_add_f32 v[100:101], v[100:101], v[116:117]
    v_pk_add_f32 v[102:103], v[102:103], v[118:119]
    buffer_store_dwordx4 v[100:103], v25, s[12:15], s52 offen
    v_lshlrev_b32 v112, 16, v156
    v_and_b32 v113, 0xffff0000, v156
    v_lshlrev_b32 v114, 16, v157
    v_and_b32 v115, 0xffff0000, v157
    v_pk_mul_f32 v[112:113], v[112:113], v[40:41]
    v_pk_mul_f32 v[114:115], v[114:115], v[42:43]
    s_add_u32 s52, s51, 0xc8000
    v_cvt_pk_bf16_f32 v112, 0, v112
    v_cvt_pk_bf16_f32 v113, 0, v113
    v_cvt_pk_bf16_f32 v114, 0, v114
    v_cvt_pk_bf16_f32 v115, 0, v115
    v_pk_add_f32 v[104:105], v[104:105], v[112:113]
    v_pk_add_f32 v[106:107], v[106:107], v[114:115]
    buffer_store_dwordx4 v[104:107], v25, s[12:15], s52 offen
    v_lshlrev_b32 v116, 16, v158
    v_and_b32 v117, 0xffff0000, v158
    v_lshlrev_b32 v118, 16, v159
    v_and_b32 v119, 0xffff0000, v159
    v_pk_mul_f32 v[116:117], v[116:117], v[40:41]
    v_pk_mul_f32 v[118:119], v[118:119], v[42:43]
    s_add_u32 s52, s51, 0xcc000
    v_cvt_pk_bf16_f32 v116, 0, v116
    v_cvt_pk_bf16_f32 v117, 0, v117
    v_cvt_pk_bf16_f32 v118, 0, v118
    v_cvt_pk_bf16_f32 v119, 0, v119
    v_pk_add_f32 v[108:109], v[108:109], v[116:117]
    v_pk_add_f32 v[110:111], v[110:111], v[118:119]
    buffer_store_dwordx4 v[108:111], v25, s[12:15], s52 offen
    s_add_u32 s53, s50, 0x28000
    buffer_load_dwordx2 v[208:209], v24, s[8:11], s53 offen
    s_add_u32 s53, s50, 0x29000
    buffer_load_dwordx2 v[210:211], v24, s[8:11], s53 offen
    s_add_u32 s53, s50, 0x2a000
    buffer_load_dwordx2 v[212:213], v24, s[8:11], s53 offen
    s_add_u32 s53, s50, 0x2b000
    buffer_load_dwordx2 v[214:215], v24, s[8:11], s53 offen
    s_add_u32 s53, s50, 0x38000
    buffer_load_dwordx2 v[216:217], v24, s[8:11], s53 offen
    s_add_u32 s53, s50, 0x39000
    buffer_load_dwordx2 v[218:219], v24, s[8:11], s53 offen
    s_add_u32 s53, s50, 0x3a000
    buffer_load_dwordx2 v[220:221], v24, s[8:11], s53 offen
    s_add_u32 s53, s50, 0x3b000
    buffer_load_dwordx2 v[222:223], v24, s[8:11], s53 offen
    s_waitcnt vmcnt(40) lgkmcnt(8)
    ds_read_b128 v[80:83], v28 offset:25344
    ds_read_b128 v[84:87], v28 offset:26400
    ds_read_b128 v[88:91], v28 offset:27456
    ds_read_b128 v[92:95], v28 offset:28512
    ds_read_b128 v[96:99], v28 offset:29568
    ds_read_b128 v[100:103], v28 offset:30624
    ds_read_b128 v[104:107], v28 offset:31680
    ds_read_b128 v[108:111], v28 offset:32736
    ds_write_b128 v27, a[16:19] offset:0
    ds_write_b128 v27, a[48:51] offset:64
    ds_write_b128 v27, a[80:83] offset:128
    ds_write_b128 v27, a[112:115] offset:192
    ds_write_b128 v27, a[144:147] offset:256
    ds_write_b128 v27, a[176:179] offset:320
    ds_write_b128 v27, a[208:211] offset:384
    ds_write_b128 v27, a[240:243] offset:448
    v_lshlrev_b32 v112, 16, v160
    v_and_b32 v113, 0xffff0000, v160
    v_lshlrev_b32 v114, 16, v161
    v_and_b32 v115, 0xffff0000, v161
    v_pk_mul_f32 v[112:113], v[112:113], v[40:41]
    v_pk_mul_f32 v[114:115], v[114:115], v[42:43]
    s_add_u32 s52, s51, 0x10000
    v_cvt_pk_bf16_f32 v112, 0, v112
    v_cvt_pk_bf16_f32 v113, 0, v113
    v_cvt_pk_bf16_f32 v114, 0, v114
    v_cvt_pk_bf16_f32 v115, 0, v115
    v_pk_add_f32 v[48:49], v[48:49], v[112:113]
    v_pk_add_f32 v[50:51], v[50:51], v[114:115]
    buffer_store_dwordx4 v[48:51], v25, s[12:15], s52 offen
    v_lshlrev_b32 v116, 16, v162
    v_and_b32 v117, 0xffff0000, v162
    v_lshlrev_b32 v118, 16, v163
    v_and_b32 v119, 0xffff0000, v163
    v_pk_mul_f32 v[116:117], v[116:117], v[40:41]
    v_pk_mul_f32 v[118:119], v[118:119], v[42:43]
    s_add_u32 s52, s51, 0x14000
    v_cvt_pk_bf16_f32 v116, 0, v116
    v_cvt_pk_bf16_f32 v117, 0, v117
    v_cvt_pk_bf16_f32 v118, 0, v118
    v_cvt_pk_bf16_f32 v119, 0, v119
    v_pk_add_f32 v[52:53], v[52:53], v[116:117]
    v_pk_add_f32 v[54:55], v[54:55], v[118:119]
    buffer_store_dwordx4 v[52:55], v25, s[12:15], s52 offen
    v_lshlrev_b32 v112, 16, v164
    v_and_b32 v113, 0xffff0000, v164
    v_lshlrev_b32 v114, 16, v165
    v_and_b32 v115, 0xffff0000, v165
    v_pk_mul_f32 v[112:113], v[112:113], v[40:41]
    v_pk_mul_f32 v[114:115], v[114:115], v[42:43]
    s_add_u32 s52, s51, 0x18000
    v_cvt_pk_bf16_f32 v112, 0, v112
    v_cvt_pk_bf16_f32 v113, 0, v113
    v_cvt_pk_bf16_f32 v114, 0, v114
    v_cvt_pk_bf16_f32 v115, 0, v115
    v_pk_add_f32 v[56:57], v[56:57], v[112:113]
    v_pk_add_f32 v[58:59], v[58:59], v[114:115]
    buffer_store_dwordx4 v[56:59], v25, s[12:15], s52 offen
    v_lshlrev_b32 v116, 16, v166
    v_and_b32 v117, 0xffff0000, v166
    v_lshlrev_b32 v118, 16, v167
    v_and_b32 v119, 0xffff0000, v167
    v_pk_mul_f32 v[116:117], v[116:117], v[40:41]
    v_pk_mul_f32 v[118:119], v[118:119], v[42:43]
    s_add_u32 s52, s51, 0x1c000
    v_cvt_pk_bf16_f32 v116, 0, v116
    v_cvt_pk_bf16_f32 v117, 0, v117
    v_cvt_pk_bf16_f32 v118, 0, v118
    v_cvt_pk_bf16_f32 v119, 0, v119
    v_pk_add_f32 v[60:61], v[60:61], v[116:117]
    v_pk_add_f32 v[62:63], v[62:63], v[118:119]
    buffer_store_dwordx4 v[60:63], v25, s[12:15], s52 offen
    v_lshlrev_b32 v112, 16, v168
    v_and_b32 v113, 0xffff0000, v168
    v_lshlrev_b32 v114, 16, v169
    v_and_b32 v115, 0xffff0000, v169
    v_pk_mul_f32 v[112:113], v[112:113], v[40:41]
    v_pk_mul_f32 v[114:115], v[114:115], v[42:43]
    s_add_u32 s52, s51, 0x50000
    v_cvt_pk_bf16_f32 v112, 0, v112
    v_cvt_pk_bf16_f32 v113, 0, v113
    v_cvt_pk_bf16_f32 v114, 0, v114
    v_cvt_pk_bf16_f32 v115, 0, v115
    v_pk_add_f32 v[64:65], v[64:65], v[112:113]
    v_pk_add_f32 v[66:67], v[66:67], v[114:115]
    buffer_store_dwordx4 v[64:67], v25, s[12:15], s52 offen
    v_lshlrev_b32 v116, 16, v170
    v_and_b32 v117, 0xffff0000, v170
    v_lshlrev_b32 v118, 16, v171
    v_and_b32 v119, 0xffff0000, v171
    v_pk_mul_f32 v[116:117], v[116:117], v[40:41]
    v_pk_mul_f32 v[118:119], v[118:119], v[42:43]
    s_add_u32 s52, s51, 0x54000
    v_cvt_pk_bf16_f32 v116, 0, v116
    v_cvt_pk_bf16_f32 v117, 0, v117
    v_cvt_pk_bf16_f32 v118, 0, v118
    v_cvt_pk_bf16_f32 v119, 0, v119
    v_pk_add_f32 v[68:69], v[68:69], v[116:117]
    v_pk_add_f32 v[70:71], v[70:71], v[118:119]
    buffer_store_dwordx4 v[68:71], v25, s[12:15], s52 offen
    v_lshlrev_b32 v112, 16, v172
    v_and_b32 v113, 0xffff0000, v172
    v_lshlrev_b32 v114, 16, v173
    v_and_b32 v115, 0xffff0000, v173
    v_pk_mul_f32 v[112:113], v[112:113], v[40:41]
    v_pk_mul_f32 v[114:115], v[114:115], v[42:43]
    s_add_u32 s52, s51, 0x58000
    v_cvt_pk_bf16_f32 v112, 0, v112
    v_cvt_pk_bf16_f32 v113, 0, v113
    v_cvt_pk_bf16_f32 v114, 0, v114
    v_cvt_pk_bf16_f32 v115, 0, v115
    v_pk_add_f32 v[72:73], v[72:73], v[112:113]
    v_pk_add_f32 v[74:75], v[74:75], v[114:115]
    buffer_store_dwordx4 v[72:75], v25, s[12:15], s52 offen
    v_lshlrev_b32 v116, 16, v174
    v_and_b32 v117, 0xffff0000, v174
    v_lshlrev_b32 v118, 16, v175
    v_and_b32 v119, 0xffff0000, v175
    v_pk_mul_f32 v[116:117], v[116:117], v[40:41]
    v_pk_mul_f32 v[118:119], v[118:119], v[42:43]
    s_add_u32 s52, s51, 0x5c000
    v_cvt_pk_bf16_f32 v116, 0, v116
    v_cvt_pk_bf16_f32 v117, 0, v117
    v_cvt_pk_bf16_f32 v118, 0, v118
    v_cvt_pk_bf16_f32 v119, 0, v119
    v_pk_add_f32 v[76:77], v[76:77], v[116:117]
    v_pk_add_f32 v[78:79], v[78:79], v[118:119]
    buffer_store_dwordx4 v[76:79], v25, s[12:15], s52 offen
    s_add_u32 s53, s50, 0xc000
    buffer_load_dwordx2 v[224:225], v24, s[8:11], s53 offen
    s_add_u32 s53, s50, 0xd000
    buffer_load_dwordx2 v[226:227], v24, s[8:11], s53 offen
    s_add_u32 s53, s50, 0xe000
    buffer_load_dwordx2 v[228:229], v24, s[8:11], s53 offen
    s_add_u32 s53, s50, 0xf000
    buffer_load_dwordx2 v[230:231], v24, s[8:11], s53 offen
    s_add_u32 s53, s50, 0x1c000
    buffer_load_dwordx2 v[232:233], v24, s[8:11], s53 offen
    s_add_u32 s53, s50, 0x1d000
    buffer_load_dwordx2 v[234:235], v24, s[8:11], s53 offen
    s_add_u32 s53, s50, 0x1e000
    buffer_load_dwordx2 v[236:237], v24, s[8:11], s53 offen
    s_add_u32 s53, s50, 0x1f000
    buffer_load_dwordx2 v[238:239], v24, s[8:11], s53 offen
    s_waitcnt vmcnt(48) lgkmcnt(8)
    ds_read_b128 v[48:51], v28 offset:0
    ds_read_b128 v[52:55], v28 offset:1056
    ds_read_b128 v[56:59], v28 offset:2112
    ds_read_b128 v[60:63], v28 offset:3168
    ds_read_b128 v[64:67], v28 offset:4224
    ds_read_b128 v[68:71], v28 offset:5280
    ds_read_b128 v[72:75], v28 offset:6336
    ds_read_b128 v[76:79], v28 offset:7392
    ds_write_b128 v27, a[20:23] offset:8448
    ds_write_b128 v27, a[52:55] offset:8512
    ds_write_b128 v27, a[84:87] offset:8576
    ds_write_b128 v27, a[116:119] offset:8640
    ds_write_b128 v27, a[148:151] offset:8704
    ds_write_b128 v27, a[180:183] offset:8768
    ds_write_b128 v27, a[212:215] offset:8832
    ds_write_b128 v27, a[244:247] offset:8896
    v_lshlrev_b32 v112, 16, v176
    v_and_b32 v113, 0xffff0000, v176
    v_lshlrev_b32 v114, 16, v177
    v_and_b32 v115, 0xffff0000, v177
    v_pk_mul_f32 v[112:113], v[112:113], v[40:41]
    v_pk_mul_f32 v[114:115], v[114:115], v[42:43]
    s_add_u32 s52, s51, 0x90000
    v_cvt_pk_bf16_f32 v112, 0, v112
    v_cvt_pk_bf16_f32 v113, 0, v113
    v_cvt_pk_bf16_f32 v114, 0, v114
    v_cvt_pk_bf16_f32 v115, 0, v115
    v_pk_add_f32 v[80:81], v[80:81], v[112:113]
    v_pk_add_f32 v[82:83], v[82:83], v[114:115]
    buffer_store_dwordx4 v[80:83], v25, s[12:15], s52 offen
    v_lshlrev_b32 v116, 16, v178
    v_and_b32 v117, 0xffff0000, v178
    v_lshlrev_b32 v118, 16, v179
    v_and_b32 v119, 0xffff0000, v179
    v_pk_mul_f32 v[116:117], v[116:117], v[40:41]
    v_pk_mul_f32 v[118:119], v[118:119], v[42:43]
    s_add_u32 s52, s51, 0x94000
    v_cvt_pk_bf16_f32 v116, 0, v116
    v_cvt_pk_bf16_f32 v117, 0, v117
    v_cvt_pk_bf16_f32 v118, 0, v118
    v_cvt_pk_bf16_f32 v119, 0, v119
    v_pk_add_f32 v[84:85], v[84:85], v[116:117]
    v_pk_add_f32 v[86:87], v[86:87], v[118:119]
    buffer_store_dwordx4 v[84:87], v25, s[12:15], s52 offen
    v_lshlrev_b32 v112, 16, v180
    v_and_b32 v113, 0xffff0000, v180
    v_lshlrev_b32 v114, 16, v181
    v_and_b32 v115, 0xffff0000, v181
    v_pk_mul_f32 v[112:113], v[112:113], v[40:41]
    v_pk_mul_f32 v[114:115], v[114:115], v[42:43]
    s_add_u32 s52, s51, 0x98000
    v_cvt_pk_bf16_f32 v112, 0, v112
    v_cvt_pk_bf16_f32 v113, 0, v113
    v_cvt_pk_bf16_f32 v114, 0, v114
    v_cvt_pk_bf16_f32 v115, 0, v115
    v_pk_add_f32 v[88:89], v[88:89], v[112:113]
    v_pk_add_f32 v[90:91], v[90:91], v[114:115]
    buffer_store_dwordx4 v[88:91], v25, s[12:15], s52 offen
    v_lshlrev_b32 v116, 16, v182
    v_and_b32 v117, 0xffff0000, v182
    v_lshlrev_b32 v118, 16, v183
    v_and_b32 v119, 0xffff0000, v183
    v_pk_mul_f32 v[116:117], v[116:117], v[40:41]
    v_pk_mul_f32 v[118:119], v[118:119], v[42:43]
    s_add_u32 s52, s51, 0x9c000
    v_cvt_pk_bf16_f32 v116, 0, v116
    v_cvt_pk_bf16_f32 v117, 0, v117
    v_cvt_pk_bf16_f32 v118, 0, v118
    v_cvt_pk_bf16_f32 v119, 0, v119
    v_pk_add_f32 v[92:93], v[92:93], v[116:117]
    v_pk_add_f32 v[94:95], v[94:95], v[118:119]
    buffer_store_dwordx4 v[92:95], v25, s[12:15], s52 offen
    v_lshlrev_b32 v112, 16, v184
    v_and_b32 v113, 0xffff0000, v184
    v_lshlrev_b32 v114, 16, v185
    v_and_b32 v115, 0xffff0000, v185
    v_pk_mul_f32 v[112:113], v[112:113], v[40:41]
    v_pk_mul_f32 v[114:115], v[114:115], v[42:43]
    s_add_u32 s52, s51, 0xd0000
    v_cvt_pk_bf16_f32 v112, 0, v112
    v_cvt_pk_bf16_f32 v113, 0, v113
    v_cvt_pk_bf16_f32 v114, 0, v114
    v_cvt_pk_bf16_f32 v115, 0, v115
    v_pk_add_f32 v[96:97], v[96:97], v[112:113]
    v_pk_add_f32 v[98:99], v[98:99], v[114:115]
    buffer_store_dwordx4 v[96:99], v25, s[12:15], s52 offen
    v_lshlrev_b32 v116, 16, v186
    v_and_b32 v117, 0xffff0000, v186
    v_lshlrev_b32 v118, 16, v187
    v_and_b32 v119, 0xffff0000, v187
    v_pk_mul_f32 v[116:117], v[116:117], v[40:41]
    v_pk_mul_f32 v[118:119], v[118:119], v[42:43]
    s_add_u32 s52, s51, 0xd4000
    v_cvt_pk_bf16_f32 v116, 0, v116
    v_cvt_pk_bf16_f32 v117, 0, v117
    v_cvt_pk_bf16_f32 v118, 0, v118
    v_cvt_pk_bf16_f32 v119, 0, v119
    v_pk_add_f32 v[100:101], v[100:101], v[116:117]
    v_pk_add_f32 v[102:103], v[102:103], v[118:119]
    buffer_store_dwordx4 v[100:103], v25, s[12:15], s52 offen
    v_lshlrev_b32 v112, 16, v188
    v_and_b32 v113, 0xffff0000, v188
    v_lshlrev_b32 v114, 16, v189
    v_and_b32 v115, 0xffff0000, v189
    v_pk_mul_f32 v[112:113], v[112:113], v[40:41]
    v_pk_mul_f32 v[114:115], v[114:115], v[42:43]
    s_add_u32 s52, s51, 0xd8000
    v_cvt_pk_bf16_f32 v112, 0, v112
    v_cvt_pk_bf16_f32 v113, 0, v113
    v_cvt_pk_bf16_f32 v114, 0, v114
    v_cvt_pk_bf16_f32 v115, 0, v115
    v_pk_add_f32 v[104:105], v[104:105], v[112:113]
    v_pk_add_f32 v[106:107], v[106:107], v[114:115]
    buffer_store_dwordx4 v[104:107], v25, s[12:15], s52 offen
    v_lshlrev_b32 v116, 16, v190
    v_and_b32 v117, 0xffff0000, v190
    v_lshlrev_b32 v118, 16, v191
    v_and_b32 v119, 0xffff0000, v191
    v_pk_mul_f32 v[116:117], v[116:117], v[40:41]
    v_pk_mul_f32 v[118:119], v[118:119], v[42:43]
    s_add_u32 s52, s51, 0xdc000
    v_cvt_pk_bf16_f32 v116, 0, v116
    v_cvt_pk_bf16_f32 v117, 0, v117
    v_cvt_pk_bf16_f32 v118, 0, v118
    v_cvt_pk_bf16_f32 v119, 0, v119
    v_pk_add_f32 v[108:109], v[108:109], v[116:117]
    v_pk_add_f32 v[110:111], v[110:111], v[118:119]
    buffer_store_dwordx4 v[108:111], v25, s[12:15], s52 offen
    s_add_u32 s53, s50, 0x2c000
    buffer_load_dwordx2 v[240:241], v24, s[8:11], s53 offen
    s_add_u32 s53, s50, 0x2d000
    buffer_load_dwordx2 v[242:243], v24, s[8:11], s53 offen
    s_add_u32 s53, s50, 0x2e000
    buffer_load_dwordx2 v[244:245], v24, s[8:11], s53 offen
    s_add_u32 s53, s50, 0x2f000
    buffer_load_dwordx2 v[246:247], v24, s[8:11], s53 offen
    s_add_u32 s53, s50, 0x3c000
    buffer_load_dwordx2 v[248:249], v24, s[8:11], s53 offen
    s_add_u32 s53, s50, 0x3d000
    buffer_load_dwordx2 v[250:251], v24, s[8:11], s53 offen
    s_add_u32 s53, s50, 0x3e000
    buffer_load_dwordx2 v[252:253], v24, s[8:11], s53 offen
    s_add_u32 s53, s50, 0x3f000
    buffer_load_dwordx2 v[254:255], v24, s[8:11], s53 offen
    s_waitcnt vmcnt(48) lgkmcnt(8)
    ds_read_b128 v[80:83], v28 offset:8448
    ds_read_b128 v[84:87], v28 offset:9504
    ds_read_b128 v[88:91], v28 offset:10560
    ds_read_b128 v[92:95], v28 offset:11616
    ds_read_b128 v[96:99], v28 offset:12672
    ds_read_b128 v[100:103], v28 offset:13728
    ds_read_b128 v[104:107], v28 offset:14784
    ds_read_b128 v[108:111], v28 offset:15840
    ds_write_b128 v27, a[24:27] offset:16896
    ds_write_b128 v27, a[56:59] offset:16960
    ds_write_b128 v27, a[88:91] offset:17024
    ds_write_b128 v27, a[120:123] offset:17088
    ds_write_b128 v27, a[152:155] offset:17152
    ds_write_b128 v27, a[184:187] offset:17216
    ds_write_b128 v27, a[216:219] offset:17280
    ds_write_b128 v27, a[248:251] offset:17344
    v_lshlrev_b32 v112, 16, v192
    v_and_b32 v113, 0xffff0000, v192
    v_lshlrev_b32 v114, 16, v193
    v_and_b32 v115, 0xffff0000, v193
    v_pk_mul_f32 v[112:113], v[112:113], v[40:41]
    v_pk_mul_f32 v[114:115], v[114:115], v[42:43]
    s_add_u32 s52, s51, 0x20000
    v_cvt_pk_bf16_f32 v112, 0, v112
    v_cvt_pk_bf16_f32 v113, 0, v113
    v_cvt_pk_bf16_f32 v114, 0, v114
    v_cvt_pk_bf16_f32 v115, 0, v115
    v_pk_add_f32 v[48:49], v[48:49], v[112:113]
    v_pk_add_f32 v[50:51], v[50:51], v[114:115]
    buffer_store_dwordx4 v[48:51], v25, s[12:15], s52 offen
    v_lshlrev_b32 v116, 16, v194
    v_and_b32 v117, 0xffff0000, v194
    v_lshlrev_b32 v118, 16, v195
    v_and_b32 v119, 0xffff0000, v195
    v_pk_mul_f32 v[116:117], v[116:117], v[40:41]
    v_pk_mul_f32 v[118:119], v[118:119], v[42:43]
    s_add_u32 s52, s51, 0x24000
    v_cvt_pk_bf16_f32 v116, 0, v116
    v_cvt_pk_bf16_f32 v117, 0, v117
    v_cvt_pk_bf16_f32 v118, 0, v118
    v_cvt_pk_bf16_f32 v119, 0, v119
    v_pk_add_f32 v[52:53], v[52:53], v[116:117]
    v_pk_add_f32 v[54:55], v[54:55], v[118:119]
    buffer_store_dwordx4 v[52:55], v25, s[12:15], s52 offen
    v_lshlrev_b32 v112, 16, v196
    v_and_b32 v113, 0xffff0000, v196
    v_lshlrev_b32 v114, 16, v197
    v_and_b32 v115, 0xffff0000, v197
    v_pk_mul_f32 v[112:113], v[112:113], v[40:41]
    v_pk_mul_f32 v[114:115], v[114:115], v[42:43]
    s_add_u32 s52, s51, 0x28000
    v_cvt_pk_bf16_f32 v112, 0, v112
    v_cvt_pk_bf16_f32 v113, 0, v113
    v_cvt_pk_bf16_f32 v114, 0, v114
    v_cvt_pk_bf16_f32 v115, 0, v115
    v_pk_add_f32 v[56:57], v[56:57], v[112:113]
    v_pk_add_f32 v[58:59], v[58:59], v[114:115]
    buffer_store_dwordx4 v[56:59], v25, s[12:15], s52 offen
    v_lshlrev_b32 v116, 16, v198
    v_and_b32 v117, 0xffff0000, v198
    v_lshlrev_b32 v118, 16, v199
    v_and_b32 v119, 0xffff0000, v199
    v_pk_mul_f32 v[116:117], v[116:117], v[40:41]
    v_pk_mul_f32 v[118:119], v[118:119], v[42:43]
    s_add_u32 s52, s51, 0x2c000
    v_cvt_pk_bf16_f32 v116, 0, v116
    v_cvt_pk_bf16_f32 v117, 0, v117
    v_cvt_pk_bf16_f32 v118, 0, v118
    v_cvt_pk_bf16_f32 v119, 0, v119
    v_pk_add_f32 v[60:61], v[60:61], v[116:117]
    v_pk_add_f32 v[62:63], v[62:63], v[118:119]
    buffer_store_dwordx4 v[60:63], v25, s[12:15], s52 offen
    v_lshlrev_b32 v112, 16, v200
    v_and_b32 v113, 0xffff0000, v200
    v_lshlrev_b32 v114, 16, v201
    v_and_b32 v115, 0xffff0000, v201
    v_pk_mul_f32 v[112:113], v[112:113], v[40:41]
    v_pk_mul_f32 v[114:115], v[114:115], v[42:43]
    s_add_u32 s52, s51, 0x60000
    v_cvt_pk_bf16_f32 v112, 0, v112
    v_cvt_pk_bf16_f32 v113, 0, v113
    v_cvt_pk_bf16_f32 v114, 0, v114
    v_cvt_pk_bf16_f32 v115, 0, v115
    v_pk_add_f32 v[64:65], v[64:65], v[112:113]
    v_pk_add_f32 v[66:67], v[66:67], v[114:115]
    buffer_store_dwordx4 v[64:67], v25, s[12:15], s52 offen
    v_lshlrev_b32 v116, 16, v202
    v_and_b32 v117, 0xffff0000, v202
    v_lshlrev_b32 v118, 16, v203
    v_and_b32 v119, 0xffff0000, v203
    v_pk_mul_f32 v[116:117], v[116:117], v[40:41]
    v_pk_mul_f32 v[118:119], v[118:119], v[42:43]
    s_add_u32 s52, s51, 0x64000
    v_cvt_pk_bf16_f32 v116, 0, v116
    v_cvt_pk_bf16_f32 v117, 0, v117
    v_cvt_pk_bf16_f32 v118, 0, v118
    v_cvt_pk_bf16_f32 v119, 0, v119
    v_pk_add_f32 v[68:69], v[68:69], v[116:117]
    v_pk_add_f32 v[70:71], v[70:71], v[118:119]
    buffer_store_dwordx4 v[68:71], v25, s[12:15], s52 offen
    v_lshlrev_b32 v112, 16, v204
    v_and_b32 v113, 0xffff0000, v204
    v_lshlrev_b32 v114, 16, v205
    v_and_b32 v115, 0xffff0000, v205
    v_pk_mul_f32 v[112:113], v[112:113], v[40:41]
    v_pk_mul_f32 v[114:115], v[114:115], v[42:43]
    s_add_u32 s52, s51, 0x68000
    v_cvt_pk_bf16_f32 v112, 0, v112
    v_cvt_pk_bf16_f32 v113, 0, v113
    v_cvt_pk_bf16_f32 v114, 0, v114
    v_cvt_pk_bf16_f32 v115, 0, v115
    v_pk_add_f32 v[72:73], v[72:73], v[112:113]
    v_pk_add_f32 v[74:75], v[74:75], v[114:115]
    buffer_store_dwordx4 v[72:75], v25, s[12:15], s52 offen
    v_lshlrev_b32 v116, 16, v206
    v_and_b32 v117, 0xffff0000, v206
    v_lshlrev_b32 v118, 16, v207
    v_and_b32 v119, 0xffff0000, v207
    v_pk_mul_f32 v[116:117], v[116:117], v[40:41]
    v_pk_mul_f32 v[118:119], v[118:119], v[42:43]
    s_add_u32 s52, s51, 0x6c000
    v_cvt_pk_bf16_f32 v116, 0, v116
    v_cvt_pk_bf16_f32 v117, 0, v117
    v_cvt_pk_bf16_f32 v118, 0, v118
    v_cvt_pk_bf16_f32 v119, 0, v119
    v_pk_add_f32 v[76:77], v[76:77], v[116:117]
    v_pk_add_f32 v[78:79], v[78:79], v[118:119]
    buffer_store_dwordx4 v[76:79], v25, s[12:15], s52 offen
    s_waitcnt vmcnt(40) lgkmcnt(8)
    ds_read_b128 v[48:51], v28 offset:16896
    ds_read_b128 v[52:55], v28 offset:17952
    ds_read_b128 v[56:59], v28 offset:19008
    ds_read_b128 v[60:63], v28 offset:20064
    ds_read_b128 v[64:67], v28 offset:21120
    ds_read_b128 v[68:71], v28 offset:22176
    ds_read_b128 v[72:75], v28 offset:23232
    ds_read_b128 v[76:79], v28 offset:24288
    ds_write_b128 v27, a[28:31] offset:25344
    ds_write_b128 v27, a[60:63] offset:25408
    ds_write_b128 v27, a[92:95] offset:25472
    ds_write_b128 v27, a[124:127] offset:25536
    ds_write_b128 v27, a[156:159] offset:25600
    ds_write_b128 v27, a[188:191] offset:25664
    ds_write_b128 v27, a[220:223] offset:25728
    ds_write_b128 v27, a[252:255] offset:25792
    v_lshlrev_b32 v112, 16, v208
    v_and_b32 v113, 0xffff0000, v208
    v_lshlrev_b32 v114, 16, v209
    v_and_b32 v115, 0xffff0000, v209
    v_pk_mul_f32 v[112:113], v[112:113], v[40:41]
    v_pk_mul_f32 v[114:115], v[114:115], v[42:43]
    s_add_u32 s52, s51, 0xa0000
    v_cvt_pk_bf16_f32 v112, 0, v112
    v_cvt_pk_bf16_f32 v113, 0, v113
    v_cvt_pk_bf16_f32 v114, 0, v114
    v_cvt_pk_bf16_f32 v115, 0, v115
    v_pk_add_f32 v[80:81], v[80:81], v[112:113]
    v_pk_add_f32 v[82:83], v[82:83], v[114:115]
    buffer_store_dwordx4 v[80:83], v25, s[12:15], s52 offen
    v_lshlrev_b32 v116, 16, v210
    v_and_b32 v117, 0xffff0000, v210
    v_lshlrev_b32 v118, 16, v211
    v_and_b32 v119, 0xffff0000, v211
    v_pk_mul_f32 v[116:117], v[116:117], v[40:41]
    v_pk_mul_f32 v[118:119], v[118:119], v[42:43]
    s_add_u32 s52, s51, 0xa4000
    v_cvt_pk_bf16_f32 v116, 0, v116
    v_cvt_pk_bf16_f32 v117, 0, v117
    v_cvt_pk_bf16_f32 v118, 0, v118
    v_cvt_pk_bf16_f32 v119, 0, v119
    v_pk_add_f32 v[84:85], v[84:85], v[116:117]
    v_pk_add_f32 v[86:87], v[86:87], v[118:119]
    buffer_store_dwordx4 v[84:87], v25, s[12:15], s52 offen
    v_lshlrev_b32 v112, 16, v212
    v_and_b32 v113, 0xffff0000, v212
    v_lshlrev_b32 v114, 16, v213
    v_and_b32 v115, 0xffff0000, v213
    v_pk_mul_f32 v[112:113], v[112:113], v[40:41]
    v_pk_mul_f32 v[114:115], v[114:115], v[42:43]
    s_add_u32 s52, s51, 0xa8000
    v_cvt_pk_bf16_f32 v112, 0, v112
    v_cvt_pk_bf16_f32 v113, 0, v113
    v_cvt_pk_bf16_f32 v114, 0, v114
    v_cvt_pk_bf16_f32 v115, 0, v115
    v_pk_add_f32 v[88:89], v[88:89], v[112:113]
    v_pk_add_f32 v[90:91], v[90:91], v[114:115]
    buffer_store_dwordx4 v[88:91], v25, s[12:15], s52 offen
    v_lshlrev_b32 v116, 16, v214
    v_and_b32 v117, 0xffff0000, v214
    v_lshlrev_b32 v118, 16, v215
    v_and_b32 v119, 0xffff0000, v215
    v_pk_mul_f32 v[116:117], v[116:117], v[40:41]
    v_pk_mul_f32 v[118:119], v[118:119], v[42:43]
    s_add_u32 s52, s51, 0xac000
    v_cvt_pk_bf16_f32 v116, 0, v116
    v_cvt_pk_bf16_f32 v117, 0, v117
    v_cvt_pk_bf16_f32 v118, 0, v118
    v_cvt_pk_bf16_f32 v119, 0, v119
    v_pk_add_f32 v[92:93], v[92:93], v[116:117]
    v_pk_add_f32 v[94:95], v[94:95], v[118:119]
    buffer_store_dwordx4 v[92:95], v25, s[12:15], s52 offen
    v_lshlrev_b32 v112, 16, v216
    v_and_b32 v113, 0xffff0000, v216
    v_lshlrev_b32 v114, 16, v217
    v_and_b32 v115, 0xffff0000, v217
    v_pk_mul_f32 v[112:113], v[112:113], v[40:41]
    v_pk_mul_f32 v[114:115], v[114:115], v[42:43]
    s_add_u32 s52, s51, 0xe0000
    v_cvt_pk_bf16_f32 v112, 0, v112
    v_cvt_pk_bf16_f32 v113, 0, v113
    v_cvt_pk_bf16_f32 v114, 0, v114
    v_cvt_pk_bf16_f32 v115, 0, v115
    v_pk_add_f32 v[96:97], v[96:97], v[112:113]
    v_pk_add_f32 v[98:99], v[98:99], v[114:115]
    buffer_store_dwordx4 v[96:99], v25, s[12:15], s52 offen
    v_lshlrev_b32 v116, 16, v218
    v_and_b32 v117, 0xffff0000, v218
    v_lshlrev_b32 v118, 16, v219
    v_and_b32 v119, 0xffff0000, v219
    v_pk_mul_f32 v[116:117], v[116:117], v[40:41]
    v_pk_mul_f32 v[118:119], v[118:119], v[42:43]
    s_add_u32 s52, s51, 0xe4000
    v_cvt_pk_bf16_f32 v116, 0, v116
    v_cvt_pk_bf16_f32 v117, 0, v117
    v_cvt_pk_bf16_f32 v118, 0, v118
    v_cvt_pk_bf16_f32 v119, 0, v119
    v_pk_add_f32 v[100:101], v[100:101], v[116:117]
    v_pk_add_f32 v[102:103], v[102:103], v[118:119]
    buffer_store_dwordx4 v[100:103], v25, s[12:15], s52 offen
    v_lshlrev_b32 v112, 16, v220
    v_and_b32 v113, 0xffff0000, v220
    v_lshlrev_b32 v114, 16, v221
    v_and_b32 v115, 0xffff0000, v221
    v_pk_mul_f32 v[112:113], v[112:113], v[40:41]
    v_pk_mul_f32 v[114:115], v[114:115], v[42:43]
    s_add_u32 s52, s51, 0xe8000
    v_cvt_pk_bf16_f32 v112, 0, v112
    v_cvt_pk_bf16_f32 v113, 0, v113
    v_cvt_pk_bf16_f32 v114, 0, v114
    v_cvt_pk_bf16_f32 v115, 0, v115
    v_pk_add_f32 v[104:105], v[104:105], v[112:113]
    v_pk_add_f32 v[106:107], v[106:107], v[114:115]
    buffer_store_dwordx4 v[104:107], v25, s[12:15], s52 offen
    v_lshlrev_b32 v116, 16, v222
    v_and_b32 v117, 0xffff0000, v222
    v_lshlrev_b32 v118, 16, v223
    v_and_b32 v119, 0xffff0000, v223
    v_pk_mul_f32 v[116:117], v[116:117], v[40:41]
    v_pk_mul_f32 v[118:119], v[118:119], v[42:43]
    s_add_u32 s52, s51, 0xec000
    v_cvt_pk_bf16_f32 v116, 0, v116
    v_cvt_pk_bf16_f32 v117, 0, v117
    v_cvt_pk_bf16_f32 v118, 0, v118
    v_cvt_pk_bf16_f32 v119, 0, v119
    v_pk_add_f32 v[108:109], v[108:109], v[116:117]
    v_pk_add_f32 v[110:111], v[110:111], v[118:119]
    buffer_store_dwordx4 v[108:111], v25, s[12:15], s52 offen
    s_waitcnt vmcnt(32) lgkmcnt(8)
    ds_read_b128 v[80:83], v28 offset:25344
    ds_read_b128 v[84:87], v28 offset:26400
    ds_read_b128 v[88:91], v28 offset:27456
    ds_read_b128 v[92:95], v28 offset:28512
    ds_read_b128 v[96:99], v28 offset:29568
    ds_read_b128 v[100:103], v28 offset:30624
    ds_read_b128 v[104:107], v28 offset:31680
    ds_read_b128 v[108:111], v28 offset:32736
    v_lshlrev_b32 v112, 16, v224
    v_and_b32 v113, 0xffff0000, v224
    v_lshlrev_b32 v114, 16, v225
    v_and_b32 v115, 0xffff0000, v225
    v_pk_mul_f32 v[112:113], v[112:113], v[40:41]
    v_pk_mul_f32 v[114:115], v[114:115], v[42:43]
    s_add_u32 s52, s51, 0x30000
    v_cvt_pk_bf16_f32 v112, 0, v112
    v_cvt_pk_bf16_f32 v113, 0, v113
    v_cvt_pk_bf16_f32 v114, 0, v114
    v_cvt_pk_bf16_f32 v115, 0, v115
    v_pk_add_f32 v[48:49], v[48:49], v[112:113]
    v_pk_add_f32 v[50:51], v[50:51], v[114:115]
    buffer_store_dwordx4 v[48:51], v25, s[12:15], s52 offen
    v_lshlrev_b32 v116, 16, v226
    v_and_b32 v117, 0xffff0000, v226
    v_lshlrev_b32 v118, 16, v227
    v_and_b32 v119, 0xffff0000, v227
    v_pk_mul_f32 v[116:117], v[116:117], v[40:41]
    v_pk_mul_f32 v[118:119], v[118:119], v[42:43]
    s_add_u32 s52, s51, 0x34000
    v_cvt_pk_bf16_f32 v116, 0, v116
    v_cvt_pk_bf16_f32 v117, 0, v117
    v_cvt_pk_bf16_f32 v118, 0, v118
    v_cvt_pk_bf16_f32 v119, 0, v119
    v_pk_add_f32 v[52:53], v[52:53], v[116:117]
    v_pk_add_f32 v[54:55], v[54:55], v[118:119]
    buffer_store_dwordx4 v[52:55], v25, s[12:15], s52 offen
    v_lshlrev_b32 v112, 16, v228
    v_and_b32 v113, 0xffff0000, v228
    v_lshlrev_b32 v114, 16, v229
    v_and_b32 v115, 0xffff0000, v229
    v_pk_mul_f32 v[112:113], v[112:113], v[40:41]
    v_pk_mul_f32 v[114:115], v[114:115], v[42:43]
    s_add_u32 s52, s51, 0x38000
    v_cvt_pk_bf16_f32 v112, 0, v112
    v_cvt_pk_bf16_f32 v113, 0, v113
    v_cvt_pk_bf16_f32 v114, 0, v114
    v_cvt_pk_bf16_f32 v115, 0, v115
    v_pk_add_f32 v[56:57], v[56:57], v[112:113]
    v_pk_add_f32 v[58:59], v[58:59], v[114:115]
    buffer_store_dwordx4 v[56:59], v25, s[12:15], s52 offen
    v_lshlrev_b32 v116, 16, v230
    v_and_b32 v117, 0xffff0000, v230
    v_lshlrev_b32 v118, 16, v231
    v_and_b32 v119, 0xffff0000, v231
    v_pk_mul_f32 v[116:117], v[116:117], v[40:41]
    v_pk_mul_f32 v[118:119], v[118:119], v[42:43]
    s_add_u32 s52, s51, 0x3c000
    v_cvt_pk_bf16_f32 v116, 0, v116
    v_cvt_pk_bf16_f32 v117, 0, v117
    v_cvt_pk_bf16_f32 v118, 0, v118
    v_cvt_pk_bf16_f32 v119, 0, v119
    v_pk_add_f32 v[60:61], v[60:61], v[116:117]
    v_pk_add_f32 v[62:63], v[62:63], v[118:119]
    buffer_store_dwordx4 v[60:63], v25, s[12:15], s52 offen
    v_lshlrev_b32 v112, 16, v232
    v_and_b32 v113, 0xffff0000, v232
    v_lshlrev_b32 v114, 16, v233
    v_and_b32 v115, 0xffff0000, v233
    v_pk_mul_f32 v[112:113], v[112:113], v[40:41]
    v_pk_mul_f32 v[114:115], v[114:115], v[42:43]
    s_add_u32 s52, s51, 0x70000
    v_cvt_pk_bf16_f32 v112, 0, v112
    v_cvt_pk_bf16_f32 v113, 0, v113
    v_cvt_pk_bf16_f32 v114, 0, v114
    v_cvt_pk_bf16_f32 v115, 0, v115
    v_pk_add_f32 v[64:65], v[64:65], v[112:113]
    v_pk_add_f32 v[66:67], v[66:67], v[114:115]
    buffer_store_dwordx4 v[64:67], v25, s[12:15], s52 offen
    v_lshlrev_b32 v116, 16, v234
    v_and_b32 v117, 0xffff0000, v234
    v_lshlrev_b32 v118, 16, v235
    v_and_b32 v119, 0xffff0000, v235
    v_pk_mul_f32 v[116:117], v[116:117], v[40:41]
    v_pk_mul_f32 v[118:119], v[118:119], v[42:43]
    s_add_u32 s52, s51, 0x74000
    v_cvt_pk_bf16_f32 v116, 0, v116
    v_cvt_pk_bf16_f32 v117, 0, v117
    v_cvt_pk_bf16_f32 v118, 0, v118
    v_cvt_pk_bf16_f32 v119, 0, v119
    v_pk_add_f32 v[68:69], v[68:69], v[116:117]
    v_pk_add_f32 v[70:71], v[70:71], v[118:119]
    buffer_store_dwordx4 v[68:71], v25, s[12:15], s52 offen
    v_lshlrev_b32 v112, 16, v236
    v_and_b32 v113, 0xffff0000, v236
    v_lshlrev_b32 v114, 16, v237
    v_and_b32 v115, 0xffff0000, v237
    v_pk_mul_f32 v[112:113], v[112:113], v[40:41]
    v_pk_mul_f32 v[114:115], v[114:115], v[42:43]
    s_add_u32 s52, s51, 0x78000
    v_cvt_pk_bf16_f32 v112, 0, v112
    v_cvt_pk_bf16_f32 v113, 0, v113
    v_cvt_pk_bf16_f32 v114, 0, v114
    v_cvt_pk_bf16_f32 v115, 0, v115
    v_pk_add_f32 v[72:73], v[72:73], v[112:113]
    v_pk_add_f32 v[74:75], v[74:75], v[114:115]
    buffer_store_dwordx4 v[72:75], v25, s[12:15], s52 offen
    v_lshlrev_b32 v116, 16, v238
    v_and_b32 v117, 0xffff0000, v238
    v_lshlrev_b32 v118, 16, v239
    v_and_b32 v119, 0xffff0000, v239
    v_pk_mul_f32 v[116:117], v[116:117], v[40:41]
    v_pk_mul_f32 v[118:119], v[118:119], v[42:43]
    s_add_u32 s52, s51, 0x7c000
    v_cvt_pk_bf16_f32 v116, 0, v116
    v_cvt_pk_bf16_f32 v117, 0, v117
    v_cvt_pk_bf16_f32 v118, 0, v118
    v_cvt_pk_bf16_f32 v119, 0, v119
    v_pk_add_f32 v[76:77], v[76:77], v[116:117]
    v_pk_add_f32 v[78:79], v[78:79], v[118:119]
    buffer_store_dwordx4 v[76:79], v25, s[12:15], s52 offen
    s_waitcnt vmcnt(24) lgkmcnt(0)
    v_lshlrev_b32 v112, 16, v240
    v_and_b32 v113, 0xffff0000, v240
    v_lshlrev_b32 v114, 16, v241
    v_and_b32 v115, 0xffff0000, v241
    v_pk_mul_f32 v[112:113], v[112:113], v[40:41]
    v_pk_mul_f32 v[114:115], v[114:115], v[42:43]
    s_add_u32 s52, s51, 0xb0000
    v_cvt_pk_bf16_f32 v112, 0, v112
    v_cvt_pk_bf16_f32 v113, 0, v113
    v_cvt_pk_bf16_f32 v114, 0, v114
    v_cvt_pk_bf16_f32 v115, 0, v115
    v_pk_add_f32 v[80:81], v[80:81], v[112:113]
    v_pk_add_f32 v[82:83], v[82:83], v[114:115]
    buffer_store_dwordx4 v[80:83], v25, s[12:15], s52 offen
    v_lshlrev_b32 v116, 16, v242
    v_and_b32 v117, 0xffff0000, v242
    v_lshlrev_b32 v118, 16, v243
    v_and_b32 v119, 0xffff0000, v243
    v_pk_mul_f32 v[116:117], v[116:117], v[40:41]
    v_pk_mul_f32 v[118:119], v[118:119], v[42:43]
    s_add_u32 s52, s51, 0xb4000
    v_cvt_pk_bf16_f32 v116, 0, v116
    v_cvt_pk_bf16_f32 v117, 0, v117
    v_cvt_pk_bf16_f32 v118, 0, v118
    v_cvt_pk_bf16_f32 v119, 0, v119
    v_pk_add_f32 v[84:85], v[84:85], v[116:117]
    v_pk_add_f32 v[86:87], v[86:87], v[118:119]
    buffer_store_dwordx4 v[84:87], v25, s[12:15], s52 offen
    v_lshlrev_b32 v112, 16, v244
    v_and_b32 v113, 0xffff0000, v244
    v_lshlrev_b32 v114, 16, v245
    v_and_b32 v115, 0xffff0000, v245
    v_pk_mul_f32 v[112:113], v[112:113], v[40:41]
    v_pk_mul_f32 v[114:115], v[114:115], v[42:43]
    s_add_u32 s52, s51, 0xb8000
    v_cvt_pk_bf16_f32 v112, 0, v112
    v_cvt_pk_bf16_f32 v113, 0, v113
    v_cvt_pk_bf16_f32 v114, 0, v114
    v_cvt_pk_bf16_f32 v115, 0, v115
    v_pk_add_f32 v[88:89], v[88:89], v[112:113]
    v_pk_add_f32 v[90:91], v[90:91], v[114:115]
    buffer_store_dwordx4 v[88:91], v25, s[12:15], s52 offen
    v_lshlrev_b32 v116, 16, v246
    v_and_b32 v117, 0xffff0000, v246
    v_lshlrev_b32 v118, 16, v247
    v_and_b32 v119, 0xffff0000, v247
    v_pk_mul_f32 v[116:117], v[116:117], v[40:41]
    v_pk_mul_f32 v[118:119], v[118:119], v[42:43]
    s_add_u32 s52, s51, 0xbc000
    v_cvt_pk_bf16_f32 v116, 0, v116
    v_cvt_pk_bf16_f32 v117, 0, v117
    v_cvt_pk_bf16_f32 v118, 0, v118
    v_cvt_pk_bf16_f32 v119, 0, v119
    v_pk_add_f32 v[92:93], v[92:93], v[116:117]
    v_pk_add_f32 v[94:95], v[94:95], v[118:119]
    buffer_store_dwordx4 v[92:95], v25, s[12:15], s52 offen
    v_lshlrev_b32 v112, 16, v248
    v_and_b32 v113, 0xffff0000, v248
    v_lshlrev_b32 v114, 16, v249
    v_and_b32 v115, 0xffff0000, v249
    v_pk_mul_f32 v[112:113], v[112:113], v[40:41]
    v_pk_mul_f32 v[114:115], v[114:115], v[42:43]
    s_add_u32 s52, s51, 0xf0000
    v_cvt_pk_bf16_f32 v112, 0, v112
    v_cvt_pk_bf16_f32 v113, 0, v113
    v_cvt_pk_bf16_f32 v114, 0, v114
    v_cvt_pk_bf16_f32 v115, 0, v115
    v_pk_add_f32 v[96:97], v[96:97], v[112:113]
    v_pk_add_f32 v[98:99], v[98:99], v[114:115]
    buffer_store_dwordx4 v[96:99], v25, s[12:15], s52 offen
    v_lshlrev_b32 v116, 16, v250
    v_and_b32 v117, 0xffff0000, v250
    v_lshlrev_b32 v118, 16, v251
    v_and_b32 v119, 0xffff0000, v251
    v_pk_mul_f32 v[116:117], v[116:117], v[40:41]
    v_pk_mul_f32 v[118:119], v[118:119], v[42:43]
    s_add_u32 s52, s51, 0xf4000
    v_cvt_pk_bf16_f32 v116, 0, v116
    v_cvt_pk_bf16_f32 v117, 0, v117
    v_cvt_pk_bf16_f32 v118, 0, v118
    v_cvt_pk_bf16_f32 v119, 0, v119
    v_pk_add_f32 v[100:101], v[100:101], v[116:117]
    v_pk_add_f32 v[102:103], v[102:103], v[118:119]
    buffer_store_dwordx4 v[100:103], v25, s[12:15], s52 offen
    v_lshlrev_b32 v112, 16, v252
    v_and_b32 v113, 0xffff0000, v252
    v_lshlrev_b32 v114, 16, v253
    v_and_b32 v115, 0xffff0000, v253
    v_pk_mul_f32 v[112:113], v[112:113], v[40:41]
    v_pk_mul_f32 v[114:115], v[114:115], v[42:43]
    s_add_u32 s52, s51, 0xf8000
    v_cvt_pk_bf16_f32 v112, 0, v112
    v_cvt_pk_bf16_f32 v113, 0, v113
    v_cvt_pk_bf16_f32 v114, 0, v114
    v_cvt_pk_bf16_f32 v115, 0, v115
    v_pk_add_f32 v[104:105], v[104:105], v[112:113]
    v_pk_add_f32 v[106:107], v[106:107], v[114:115]
    buffer_store_dwordx4 v[104:107], v25, s[12:15], s52 offen
    v_lshlrev_b32 v116, 16, v254
    v_and_b32 v117, 0xffff0000, v254
    v_lshlrev_b32 v118, 16, v255
    v_and_b32 v119, 0xffff0000, v255
    v_pk_mul_f32 v[116:117], v[116:117], v[40:41]
    v_pk_mul_f32 v[118:119], v[118:119], v[42:43]
    s_add_u32 s52, s51, 0xfc000
    v_cvt_pk_bf16_f32 v116, 0, v116
    v_cvt_pk_bf16_f32 v117, 0, v117
    v_cvt_pk_bf16_f32 v118, 0, v118
    v_cvt_pk_bf16_f32 v119, 0, v119
    v_pk_add_f32 v[108:109], v[108:109], v[116:117]
    v_pk_add_f32 v[110:111], v[110:111], v[118:119]
    buffer_store_dwordx4 v[108:111], v25, s[12:15], s52 offen
    s_branch chain_kernel_seg
L_cq_47:
    s_and_b32 s0, s57, 3
    s_add_u32 s0, s0, 0
    s_lshr_b32 s85, s57, 2
    s_lshl3_add_u32 s0, s56, s0
    s_and_b32 s62, s57, 3
    s_add_u32 s62, s62, 4
    s_lshr_b32 s63, s57, 2
    s_lshl3_add_u32 s62, s56, s62
    s_lshl_b32 s60, s63, 19
    s_mov_b32 s30, s82
    s_and_b32 s31, s83, 0xffff
    s_mov_b32 s32, 0x400000
    s_mov_b32 s33, s60
    s_mov_b32 s34, 0x8000
    s_mov_b32 s35, 0x40000
    s_lshl_b32 s60, s62, 9
    s_mov_b32 s36, s86
    s_and_b32 s37, s87, 0xffff
    s_mov_b32 s38, 0x800000
    s_mov_b32 s39, s60
    s_mov_b32 s40, 0x8000
    s_mov_b32 s41, 0x40000
    s_mov_b32 s42, 0x80000
    v_bfe_u32 v24, v0, 4, 2
    v_and_b32 v25, 7, v0
    v_xor_b32 v24, v24, v25
    v_lshlrev_b32 v8, 4, v24
    v_bfe_u32 v24, v0, 3, 3
    v_lshl_add_u32 v8, v24, 11, v8
    v_bfe_u32 v24, v0, 6, 2
    v_lshl_add_u32 v8, v24, 16, v8
    v_xor_b32 v9, 64, v8
    v_add_u32 v9, 0x4000, v9
    v_bfe_u32 v24, v0, 5, 1
    v_bfe_u32 v25, v0, 6, 1
    v_lshl_add_u32 v25, v25, 2, v24
    v_lshlrev_b32 v25, 1, v25
    v_and_b32 v10, 31, v0
    v_xor_b32 v10, v10, v25
    v_lshlrev_b32 v10, 4, v10
    v_lshl_add_u32 v10, v24, 13, v10
    v_lshrrev_b32 v24, 6, v0
    v_lshl_add_u32 v10, v24, 16, v10
    v_xor_b32 v11, 64, v10
    v_add_u32 v11, 0x4000, v11
    s_mov_b32 s84, s62
    s_lshl_b32 s94, s63, 0
    s_call_b64 s[54:55], t_kq
    s_call_b64 s[54:55], t_conv
    s_and_b32 s60, s58, 1
    s_lshl1_add_u32 s60, s85, s60
    s_lshl_b32 s50, s60, 22
    s_lshr_b32 s60, s58, 1
    s_lshl1_add_u32 s60, s0, s60
    s_lshl_b32 s60, s60, 15
    s_add_u32 s50, s50, s60
    s_add_u32 s50, s50, s59
    s_xor_b32 s50, s50, 0x2000
    s_mov_b32 s5, 2048
    s_mov_b32 s51, 0x100000
    s_mov_b32 s60, 0x202000
    s_bitcmp1_b32 s50, 13
    s_cselect_b32 s52, 0x1fe000, s60
    v_mov_b32 v2, v1
    v_add_u32 v3, 1024, v1
    s_mov_b32 s18, 0x8000000
    s_mov_b32 s4, 36
    s_and_b32 s0, s57, 3
    s_add_u32 s0, s0, 4
    s_lshr_b32 s85, s57, 2
    s_lshl3_add_u32 s0, s56, s0
    s_mov_b32 s32, 0
    s_mov_b32 s38, 0
    s_call_b64 s[54:55], t_kq
    s_call_b64 s[54:55], t_conv
    s_and_b32 s60, s58, 1
    s_lshl1_add_u32 s60, s85, s60
    s_lshl_b32 s50, s60, 22
    s_lshr_b32 s60, s58, 1
    s_lshl1_add_u32 s60, s0, s60
    s_lshl_b32 s60, s60, 15
    s_add_u32 s50, s50, s60
    s_add_u32 s50, s50, s59
    s_xor_b32 s50, s50, 0x2000
    s_mov_b32 s5, 2048
    s_mov_b32 s51, 0x100000
    s_mov_b32 s60, 0x202000
    s_bitcmp1_b32 s50, 13
    s_cselect_b32 s52, 0x1fe000, s60
    v_mov_b32 v2, v1
    v_add_u32 v3, 1024, v1
    s_mov_b32 s18, 0x8000000
    s_call_b64 s[54:55], t_flush
    s_waitcnt vmcnt(0)
    s_barrier
    s_cmp_lg_u32 s58, 0
    s_cbranch_scc1 L_ns_48
    s_mov_b32 s60, 36
    v_mov_b32 v24, s60
    v_mov_b32 v25, 1
    s_mov_b64 exec, 1
    global_atomic_add v24, v25, s[98:99] sc1
    s_mov_b64 exec, -1
L_ns_48:
chain_kernel_seg:
    s_waitcnt vmcnt(0) lgkmcnt(0)
    s_barrier
    s_mov_b32 s12, s92
    s_and_b32 s13, s93, 0xffff
    s_mov_b32 s14, 0x800000
    s_mov_b32 s15, 0x00020000
    s_lshr_b32 s60, s57, 3
    s_lshl_b32 s28, s60, 21
    s_and_b32 s60, s57, 7
    s_lshl_b32 s60, s60, 8
    s_add_u32 s28, s28, s60
    v_bfe_u32 v24, v0, 4, 3
    v_lshlrev_b32 v24, 1, v24
    v_and_b32 v25, 15, v0
    v_xor_b32 v24, v24, v25
    v_lshlrev_b32 v6, 4, v24
    v_bfe_u32 v24, v0, 4, 2
    v_lshl_add_u32 v6, v24, 11, v6
    v_bfe_u32 v24, v0, 6, 1
    v_lshl_add_u32 v6, v24, 13, v6
    v_bfe_u32 v24, v0, 7, 1
    v_lshl_add_u32 v6, v24, 15, v6
    s_and_b32 s60, s58, 1
    s_lshl_b32 s61, s60, 11
    s_lshr_b32 s60, s58, 1
    s_lshl_b32 s60, s60, 10
    s_add_u32 s32, s60, s61
    s_add_u32 m0, s32, 0
    s_add_u32 s61, s28, 0x0
    buffer_load_dwordx4 v6, s[12:15], s61 offen lds
    s_add_u32 m0, s32, 4096
    s_add_u32 s61, s28, 0x4000
    buffer_load_dwordx4 v6, s[12:15], s61 offen lds
    s_add_u32 m0, s32, 8192
    s_add_u32 s61, s28, 0x10000
    buffer_load_dwordx4 v6, s[12:15], s61 offen lds
    s_add_u32 m0, s32, 12288
    s_add_u32 s61, s28, 0x14000
    buffer_load_dwordx4 v6, s[12:15], s61 offen lds
    s_add_u32 m0, s32, 16384
    s_add_u32 s61, s28, 0x20000
    buffer_load_dwordx4 v6, s[12:15], s61 offen lds
    s_add_u32 m0, s32, 20480
    s_add_u32 s61, s28, 0x24000
    buffer_load_dwordx4 v6, s[12:15], s61 offen lds
    s_add_u32 m0, s32, 24576
    s_add_u32 s61, s28, 0x30000
    buffer_load_dwordx4 v6, s[12:15], s61 offen lds
    s_add_u32 m0, s32, 28672
    s_add_u32 s61, s28, 0x34000
    buffer_load_dwordx4 v6, s[12:15], s61 offen lds
    s_mov_b32 s8, s100
    s_and_b32 s9, s101, 0xffff
    s_mov_b32 s10, 0x8000000
    s_mov_b32 s11, 0x00020000
    s_mov_b32 s16, s96
    s_and_b32 s17, s97, 0xffff
    s_mov_b32 s18, 0x1000000
    s_mov_b32 s19, 0x00020000
    v_and_b32 v24, 63, v0
    v_lshlrev_b32 v1, 4, v24
    v_add_u32 v2, 4096, v1
    v_lshlrev_b32 v14, 3, v24
    v_mov_b32 v240, 0
    v_mov_b32 v93, 0
    v_mov_b32 v94, 0
    s_lshl_b32 s60, s56, 8
    s_add_u32 s60, s60, 0x5b00000
    s_lshl2_add_u32 s31, s57, s60
    s_cmp_eq_u32 s58, 0
    s_cselect_b32 s31, s31, 0x8000000
    s_add_u32 s60, s60, s100
    s_addc_u32 s61, s101, 0
    v_and_b32 v25, 31, v0
    v_lshlrev_b32 v25, 2, v25
    v_add_u32 v16, s60, v25
    v_mov_b32 v17, s61
    s_add_u32 s60, s98, 176
    s_addc_u32 s61, s99, 0
    v_writelane_b32 v16, s60, 32
    v_writelane_b32 v17, s61, 32
    s_add_u32 s60, s98, 32
    s_addc_u32 s61, s99, 0
    v_writelane_b32 v16, s60, 33
    v_writelane_b32 v17, s61, 33
    s_add_u32 s60, s98, 36
    s_addc_u32 s61, s99, 0
    v_writelane_b32 v16, s60, 34
    v_writelane_b32 v17, s61, 34
    s_add_u32 s60, s98, 100
    s_addc_u32 s61, s99, 0
    v_writelane_b32 v16, s60, 35
    v_writelane_b32 v17, s61, 35
    s_add_u32 s60, s98, 116
    s_addc_u32 s61, s99, 0
    v_writelane_b32 v16, s60, 36
    v_writelane_b32 v17, s61, 36
    buffer_store_dword v240, v240, s[8:11], s31 offen
    s_mov_b32 s30, 0
    s_mov_b32 s38, 0
    s_mov_b32 s40, 0x3db504f3
    s_mov_b32 s41, 0x3db504f3
    s_mov_b32 s42, 0x3fb8aa3b
    s_mov_b32 s43, 0x3fb8aa3b
    s_lshr_b32 s60, s57, 4
    s_lshl_b32 s60, s60, 12
    v_add_u32 v5, s60, v1
    v_xor_b32 v4, 4096, v5
    v_add_u32 v10, 0x10000, v4
    v_add_u32 v11, 0x10000, v5
    s_lshr_b32 s60, s58, 1
    s_lshl_b32 s60, s60, 14
    s_add_u32 s60, s60, 131072
    v_add_u32 v12, s60, v1
    s_lshl_b32 s36, s58, 13
    s_add_u32 s37, s36, 131072
    v_bfe_u32 v24, v0, 4, 2
    v_lshlrev_b32 v13, 7, v24
    v_bfe_u32 v24, v0, 2, 1
    v_lshl_add_u32 v13, v24, 6, v13
    v_bfe_u32 v24, v0, 3, 1
    v_lshl_add_u32 v13, v24, 5, v13
    v_bfe_u32 v24, v0, 0, 1
    v_lshl_add_u32 v13, v24, 4, v13
    v_and_b32 v24, 15, v0
    v_bfe_u32 v25, v0, 6, 1
    v_lshl_add_u32 v24, v25, 4, v24
    v_bfe_u32 v25, v0, 4, 2
    v_lshlrev_b32 v25, 2, v25
    v_sub_u32 v24, v24, v25
    v_mov_b32 v25, 0xff800000
    v_cmp_gt_i32 vcc, 0, v24
    s_nop 1
    v_cndmask_b32 v28, 0, v25, vcc
    v_cmp_gt_i32 vcc, 1, v24
    s_nop 1
    v_cndmask_b32 v29, 0, v25, vcc
    v_cmp_gt_i32 vcc, 2, v24
    s_nop 1
    v_cndmask_b32 v30, 0, v25, vcc
    v_cmp_gt_i32 vcc, 3, v24
    s_nop 1
    v_cndmask_b32 v31, 0, v25, vcc
    v_cmp_gt_i32 vcc, 16, v24
    s_nop 1
    v_cndmask_b32 v32, 0, v25, vcc
    v_cmp_gt_i32 vcc, 17, v24
    s_nop 1
    v_cndmask_b32 v33, 0, v25, vcc
    v_cmp_gt_i32 vcc, 18, v24
    s_nop 1
    v_cndmask_b32 v34, 0, v25, vcc
    v_cmp_gt_i32 vcc, 19, v24
    s_nop 1
    v_cndmask_b32 v35, 0, v25, vcc
    v_and_b32 v24, 15, v0
    v_lshlrev_b32 v15, 13, v24
    v_bfe_u32 v24, v0, 4, 2
    v_lshl_add_u32 v15, v24, 4, v15
    s_lshr_b32 s60, s57, 4
    s_lshl_b32 s60, s60, 17
    s_and_b32 s61, s57, 7
    s_lshl_b32 s61, s61, 9
    s_add_u32 s60, s60, s61
    s_lshl_b32 s61, s58, 7
    s_add_u32 s60, s60, s61
    s_and_b32 s61, s57, 8
    s_lshl_b32 s61, s61, 3
    s_add_u32 s60, s60, s61
    s_add_u32 s60, s60, 4096
    v_add_u32 v15, s60, v15
    s_lshl_b32 s61, s58, 12
    s_xor_b32 s60, s57, 24
    s_lshl_b32 s60, s60, 14
    s_add_u32 s60, s60, s61
    s_add_u32 s60, s60, 0
    v_add_u32 v20, s60, v1
    s_xor_b32 s60, s57, 16
    s_lshl_b32 s60, s60, 14
    s_add_u32 s60, s60, s61
    s_add_u32 s60, s60, 1024
    v_add_u32 v21, s60, v1
    s_xor_b32 s60, s57, 8
    s_lshl_b32 s60, s60, 14
    s_add_u32 s60, s60, s61
    s_add_u32 s60, s60, 2048
    v_add_u32 v22, s60, v1
    s_xor_b32 s60, s57, 0
    s_lshl_b32 s60, s60, 14
    s_add_u32 s60, s60, s61
    s_add_u32 s60, s60, 0
    v_add_u32 v23, s60, v1
    s_lshl_b32 s22, s56, 21
    s_add_u32 s22, s22, 0x6c00000
    s_lshl_b32 s21, s56, 20
    s_add_u32 s21, s21, 0x6800000
    s_lshr_b32 s60, s58, 1
    s_lshl_b32 s60, s60, 18
    s_lshl_b32 s61, s57, 13
    s_add_u32 s60, s60, s61
    s_and_b32 s61, s58, 1
    s_lshl_b32 s61, s61, 12
    s_add_u32 s60, s60, s61
    s_add_u32 s24, s60, s21
    s_lshr_b32 s60, s57, 3
    s_lshl_b32 s60, s60, 16
    s_add_u32 s60, s60, s36
    s_add_u32 s23, s60, s21
    s_lshl_b32 s44, s57, 15
    s_add_u32 s44, s44, s59
    s_lshr_b32 s60, s57, 1
    s_lshl_b32 s45, s60, 14
    s_and_b32 s60, s57, 1
    s_lshl_b32 s60, s60, 12
    s_add_u32 s45, s45, s60
    s_add_u32 s45, s45, s59
    s_add_u32 s45, s45, 0x4800000
    s_add_u32 m0, s32, 32768
    s_add_u32 s61, s28, 0x40000
    buffer_load_dwordx4 v6, s[12:15], s61 offen lds
    s_add_u32 m0, s32, 36864
    s_add_u32 s61, s28, 0x44000
    buffer_load_dwordx4 v6, s[12:15], s61 offen lds
    s_add_u32 m0, s32, 40960
    s_add_u32 s61, s28, 0x50000
    buffer_load_dwordx4 v6, s[12:15], s61 offen lds
    s_add_u32 m0, s32, 45056
    s_add_u32 s61, s28, 0x54000
    buffer_load_dwordx4 v6, s[12:15], s61 offen lds
    s_add_u32 m0, s32, 49152
    s_add_u32 s61, s28, 0x60000
    buffer_load_dwordx4 v6, s[12:15], s61 offen lds
    s_add_u32 m0, s32, 53248
    s_add_u32 s61, s28, 0x64000
    buffer_load_dwordx4 v6, s[12:15], s61 offen lds
    s_add_u32 m0, s32, 57344
    s_add_u32 s61, s28, 0x70000
    buffer_load_dwordx4 v6, s[12:15], s61 offen lds
    s_add_u32 m0, s32, 61440
    s_add_u32 s61, s28, 0x74000
    buffer_load_dwordx4 v6, s[12:15], s61 offen lds
    s_add_u32 m0, s32, 65536
    s_add_u32 s61, s28, 0x80000
    buffer_load_dwordx4 v6, s[12:15], s61 offen lds
    s_add_u32 m0, s32, 69632
    s_add_u32 s61, s28, 0x84000
    buffer_load_dwordx4 v6, s[12:15], s61 offen lds
    s_add_u32 m0, s32, 73728
    s_add_u32 s61, s28, 0x90000
    buffer_load_dwordx4 v6, s[12:15], s61 offen lds
    s_add_u32 m0, s32, 77824
    s_add_u32 s61, s28, 0x94000
    buffer_load_dwordx4 v6, s[12:15], s61 offen lds
    s_add_u32 m0, s32, 81920
    s_add_u32 s61, s28, 0xa0000
    buffer_load_dwordx4 v6, s[12:15], s61 offen lds
    s_add_u32 m0, s32, 86016
    s_add_u32 s61, s28, 0xa4000
    buffer_load_dwordx4 v6, s[12:15], s61 offen lds
    s_add_u32 m0, s32, 90112
    s_add_u32 s61, s28, 0xb0000
    buffer_load_dwordx4 v6, s[12:15], s61 offen lds
    s_add_u32 m0, s32, 94208
    s_add_u32 s61, s28, 0xb4000
    buffer_load_dwordx4 v6, s[12:15], s61 offen lds
    s_add_u32 m0, s32, 98304
    s_add_u32 s61, s28, 0xc0000
    buffer_load_dwordx4 v6, s[12:15], s61 offen lds
    s_add_u32 m0, s32, 102400
    s_add_u32 s61, s28, 0xc4000
    buffer_load_dwordx4 v6, s[12:15], s61 offen lds
    s_add_u32 m0, s32, 106496
    s_add_u32 s61, s28, 0xd0000
    buffer_load_dwordx4 v6, s[12:15], s61 offen lds
    s_add_u32 m0, s32, 110592
    s_add_u32 s61, s28, 0xd4000
    buffer_load_dwordx4 v6, s[12:15], s61 offen lds
    s_add_u32 m0, s32, 114688
    s_add_u32 s61, s28, 0xe0000
    buffer_load_dwordx4 v6, s[12:15], s61 offen lds
    s_add_u32 m0, s32, 118784
    s_add_u32 s61, s28, 0xe4000
    buffer_load_dwordx4 v6, s[12:15], s61 offen lds
    s_add_u32 m0, s32, 122880
    s_add_u32 s61, s28, 0xf0000
    buffer_load_dwordx4 v6, s[12:15], s61 offen lds
    s_add_u32 m0, s32, 126976
    s_add_u32 s61, s28, 0xf4000
    buffer_load_dwordx4 v6, s[12:15], s61 offen lds
    s_add_u32 m0, s32, 131072
    s_add_u32 s61, s28, 0x100000
    buffer_load_dwordx4 v6, s[12:15], s61 offen lds
    s_add_u32 m0, s32, 135168
    s_add_u32 s61, s28, 0x104000
    buffer_load_dwordx4 v6, s[12:15], s61 offen lds
    s_add_u32 m0, s32, 139264
    s_add_u32 s61, s28, 0x110000
    buffer_load_dwordx4 v6, s[12:15], s61 offen lds
    s_add_u32 m0, s32, 143360
    s_add_u32 s61, s28, 0x114000
    buffer_load_dwordx4 v6, s[12:15], s61 offen lds
    s_add_u32 m0, s32, 147456
    s_add_u32 s61, s28, 0x120000
    buffer_load_dwordx4 v6, s[12:15], s61 offen lds
    s_add_u32 m0, s32, 151552
    s_add_u32 s61, s28, 0x124000
    buffer_load_dwordx4 v6, s[12:15], s61 offen lds
    s_add_u32 m0, s32, 155648
    s_add_u32 s61, s28, 0x130000
    buffer_load_dwordx4 v6, s[12:15], s61 offen lds
    s_add_u32 m0, s32, 159744
    s_add_u32 s61, s28, 0x134000
    buffer_load_dwordx4 v6, s[12:15], s61 offen lds
    s_andn2_b32 s60, 8, s57
    s_lshl_b32 s60, s60, 2
    v_bfe_u32 v24, v0, 2, 3
    v_lshrrev_b32 v25, 6, v0
    v_lshlrev_b32 v25, 1, v25
    v_xor_b32 v24, v24, v25
    v_lshlrev_b32 v8, 5, v24
    v_bfe_u32 v24, v0, 0, 2
    v_lshl_add_u32 v8, v24, 3, v8
    v_bfe_u32 v24, v0, 2, 2
    v_lshl_add_u32 v8, v24, 8, v8
    v_bfe_u32 v24, v0, 4, 2
    v_lshl_add_u32 v8, v24, 11, v8
    v_xor_b32 v8, s60, v8
    v_xor_b32 v9, 32, v8
    s_waitcnt vmcnt(32)
    s_barrier
    s_cmp_lg_u32 s58, 0
    s_cbranch_scc1 L_si_49
    s_lshl_b32 s60, s56, 2
    s_add_u32 s60, s60, 192
    s_mov_b32 s61, 1
    s_atomic_add s61, s[98:99], s60
L_si_49:
    ds_read_b64_tr_b16 a[0:1], v8 offset:0
    ds_read_b64_tr_b16 a[2:3], v8 offset:1024
    ds_read_b64_tr_b16 a[4:5], v9 offset:0
    ds_read_b64_tr_b16 a[6:7], v9 offset:1024
    ds_read_b64_tr_b16 a[8:9], v8 offset:8192
    ds_read_b64_tr_b16 a[10:11], v8 offset:9216
    ds_read_b64_tr_b16 a[12:13], v9 offset:8192
    ds_read_b64_tr_b16 a[14:15], v9 offset:9216
    s_waitcnt lgkmcnt(0)
    ds_read_b64_tr_b16 a[16:17], v8 offset:16384
    ds_read_b64_tr_b16 a[18:19], v8 offset:17408
    ds_read_b64_tr_b16 a[20:21], v9 offset:16384
    ds_read_b64_tr_b16 a[22:23], v9 offset:17408
    ds_read_b64_tr_b16 a[24:25], v8 offset:24576
    ds_read_b64_tr_b16 a[26:27], v8 offset:25600
    ds_read_b64_tr_b16 a[28:29], v9 offset:24576
    ds_read_b64_tr_b16 a[30:31], v9 offset:25600
    s_waitcnt lgkmcnt(0)
    s_waitcnt vmcnt(24)
    s_barrier
    s_add_u32 m0, s32, 0
    s_add_u32 s61, s28, 0x140000
    buffer_load_dwordx4 v6, s[12:15], s61 offen lds
    s_add_u32 m0, s32, 4096
    s_add_u32 s61, s28, 0x144000
    buffer_load_dwordx4 v6, s[12:15], s61 offen lds
    s_add_u32 m0, s32, 8192
    s_add_u32 s61, s28, 0x150000
    buffer_load_dwordx4 v6, s[12:15], s61 offen lds
    s_add_u32 m0, s32, 12288
    s_add_u32 s61, s28, 0x154000
    buffer_load_dwordx4 v6, s[12:15], s61 offen lds
    s_add_u32 m0, s32, 16384
    s_add_u32 s61, s28, 0x160000
    buffer_load_dwordx4 v6, s[12:15], s61 offen lds
    s_add_u32 m0, s32, 20480
    s_add_u32 s61, s28, 0x164000
    buffer_load_dwordx4 v6, s[12:15], s61 offen lds
    s_add_u32 m0, s32, 24576
    s_add_u32 s61, s28, 0x170000
    buffer_load_dwordx4 v6, s[12:15], s61 offen lds
    s_add_u32 m0, s32, 28672
    s_add_u32 s61, s28, 0x174000
    buffer_load_dwordx4 v6, s[12:15], s61 offen lds
    ds_read_b64_tr_b16 a[32:33], v8 offset:32768
    ds_read_b64_tr_b16 a[34:35], v8 offset:33792
    ds_read_b64_tr_b16 a[36:37], v9 offset:32768
    ds_read_b64_tr_b16 a[38:39], v9 offset:33792
    ds_read_b64_tr_b16 a[40:41], v8 offset:40960
    ds_read_b64_tr_b16 a[42:43], v8 offset:41984
    ds_read_b64_tr_b16 a[44:45], v9 offset:40960
    ds_read_b64_tr_b16 a[46:47], v9 offset:41984
    s_waitcnt lgkmcnt(0)
    ds_read_b64_tr_b16 a[48:49], v8 offset:49152
    ds_read_b64_tr_b16 a[50:51], v8 offset:50176
    ds_read_b64_tr_b16 a[52:53], v9 offset:49152
    ds_read_b64_tr_b16 a[54:55], v9 offset:50176
    ds_read_b64_tr_b16 a[56:57], v8 offset:57344
    ds_read_b64_tr_b16 a[58:59], v8 offset:58368
    ds_read_b64_tr_b16 a[60:61], v9 offset:57344
    ds_read_b64_tr_b16 a[62:63], v9 offset:58368
    s_waitcnt lgkmcnt(0)
    s_waitcnt vmcnt(24)
    s_barrier
    s_add_u32 m0, s32, 32768
    s_add_u32 s61, s28, 0x180000
    buffer_load_dwordx4 v6, s[12:15], s61 offen lds
    s_add_u32 m0, s32, 36864
    s_add_u32 s61, s28, 0x184000
    buffer_load_dwordx4 v6, s[12:15], s61 offen lds
    s_add_u32 m0, s32, 40960
    s_add_u32 s61, s28, 0x190000
    buffer_load_dwordx4 v6, s[12:15], s61 offen lds
    s_add_u32 m0, s32, 45056
    s_add_u32 s61, s28, 0x194000
    buffer_load_dwordx4 v6, s[12:15], s61 offen lds
    s_add_u32 m0, s32, 49152
    s_add_u32 s61, s28, 0x1a0000
    buffer_load_dwordx4 v6, s[12:15], s61 offen lds
    s_add_u32 m0, s32, 53248
    s_add_u32 s61, s28, 0x1a4000
    buffer_load_dwordx4 v6, s[12:15], s61 offen lds
    s_add_u32 m0, s32, 57344
    s_add_u32 s61, s28, 0x1b0000
    buffer_load_dwordx4 v6, s[12:15], s61 offen lds
    s_add_u32 m0, s32, 61440
    s_add_u32 s61, s28, 0x1b4000
    buffer_load_dwordx4 v6, s[12:15], s61 offen lds
    v_add_u32 v8, 0x10000, v8
    v_add_u32 v9, 0x10000, v9
    ds_read_b64_tr_b16 a[64:65], v8 offset:0
    ds_read_b64_tr_b16 a[66:67], v8 offset:1024
    ds_read_b64_tr_b16 a[68:69], v9 offset:0
    ds_read_b64_tr_b16 a[70:71], v9 offset:1024
    ds_read_b64_tr_b16 a[72:73], v8 offset:8192
    ds_read_b64_tr_b16 a[74:75], v8 offset:9216
    ds_read_b64_tr_b16 a[76:77], v9 offset:8192
    ds_read_b64_tr_b16 a[78:79], v9 offset:9216
    s_waitcnt lgkmcnt(0)
    ds_read_b64_tr_b16 a[80:81], v8 offset:16384
    ds_read_b64_tr_b16 a[82:83], v8 offset:17408
    ds_read_b64_tr_b16 a[84:85], v9 offset:16384
    ds_read_b64_tr_b16 a[86:87], v9 offset:17408
    ds_read_b64_tr_b16 a[88:89], v8 offset:24576
    ds_read_b64_tr_b16 a[90:91], v8 offset:25600
    ds_read_b64_tr_b16 a[92:93], v9 offset:24576
    ds_read_b64_tr_b16 a[94:95], v9 offset:25600
    s_waitcnt lgkmcnt(0)
    s_waitcnt vmcnt(24)
    s_barrier
    s_add_u32 m0, s32, 65536
    s_add_u32 s61, s28, 0x1c0000
    buffer_load_dwordx4 v6, s[12:15], s61 offen lds
    s_add_u32 m0, s32, 69632
    s_add_u32 s61, s28, 0x1c4000
    buffer_load_dwordx4 v6, s[12:15], s61 offen lds
    s_add_u32 m0, s32, 73728
    s_add_u32 s61, s28, 0x1d0000
    buffer_load_dwordx4 v6, s[12:15], s61 offen lds
    s_add_u32 m0, s32, 77824
    s_add_u32 s61, s28, 0x1d4000
    buffer_load_dwordx4 v6, s[12:15], s61 offen lds
    s_add_u32 m0, s32, 81920
    s_add_u32 s61, s28, 0x1e0000
    buffer_load_dwordx4 v6, s[12:15], s61 offen lds
    s_add_u32 m0, s32, 86016
    s_add_u32 s61, s28, 0x1e4000
    buffer_load_dwordx4 v6, s[12:15], s61 offen lds
    s_add_u32 m0, s32, 90112
    s_add_u32 s61, s28, 0x1f0000
    buffer_load_dwordx4 v6, s[12:15], s61 offen lds
    s_add_u32 m0, s32, 94208
    s_add_u32 s61, s28, 0x1f4000
    buffer_load_dwordx4 v6, s[12:15], s61 offen lds
    ds_read_b64_tr_b16 a[96:97], v8 offset:32768
    ds_read_b64_tr_b16 a[98:99], v8 offset:33792
    ds_read_b64_tr_b16 a[100:101], v9 offset:32768
    ds_read_b64_tr_b16 a[102:103], v9 offset:33792
    ds_read_b64_tr_b16 a[104:105], v8 offset:40960
    ds_read_b64_tr_b16 a[106:107], v8 offset:41984
    ds_read_b64_tr_b16 a[108:109], v9 offset:40960
    ds_read_b64_tr_b16 a[110:111], v9 offset:41984
    s_waitcnt lgkmcnt(0)
    ds_read_b64_tr_b16 a[112:113], v8 offset:49152
    ds_read_b64_tr_b16 a[114:115], v8 offset:50176
    ds_read_b64_tr_b16 a[116:117], v9 offset:49152
    ds_read_b64_tr_b16 a[118:119], v9 offset:50176
    ds_read_b64_tr_b16 a[120:121], v8 offset:57344
    ds_read_b64_tr_b16 a[122:123], v8 offset:58368
    ds_read_b64_tr_b16 a[124:125], v9 offset:57344
    ds_read_b64_tr_b16 a[126:127], v9 offset:58368
    s_waitcnt lgkmcnt(0)
    s_waitcnt vmcnt(24)
    s_barrier
    v_add_u32 v8, 0x10000, v8
    v_add_u32 v9, 0x10000, v9
    ds_read_b64_tr_b16 a[128:129], v8 offset:0
    ds_read_b64_tr_b16 a[130:131], v8 offset:1024
    ds_read_b64_tr_b16 a[132:133], v9 offset:0
    ds_read_b64_tr_b16 a[134:135], v9 offset:1024
    ds_read_b64_tr_b16 a[136:137], v8 offset:8192
    ds_read_b64_tr_b16 a[138:139], v8 offset:9216
    ds_read_b64_tr_b16 a[140:141], v9 offset:8192
    ds_read_b64_tr_b16 a[142:143], v9 offset:9216
    s_waitcnt lgkmcnt(0)
    ds_read_b64_tr_b16 a[144:145], v8 offset:16384
    ds_read_b64_tr_b16 a[146:147], v8 offset:17408
    ds_read_b64_tr_b16 a[148:149], v9 offset:16384
    ds_read_b64_tr_b16 a[150:151], v9 offset:17408
    ds_read_b64_tr_b16 a[152:153], v8 offset:24576
    ds_read_b64_tr_b16 a[154:155], v8 offset:25600
    ds_read_b64_tr_b16 a[156:157], v9 offset:24576
    ds_read_b64_tr_b16 a[158:159], v9 offset:25600
    s_waitcnt lgkmcnt(0)
    s_waitcnt vmcnt(16)
    s_barrier
    v_add_u32 v8, 0xfffe0000, v8
    v_add_u32 v9, 0xfffe0000, v9
    ds_read_b64_tr_b16 a[160:161], v8 offset:0
    ds_read_b64_tr_b16 a[162:163], v8 offset:1024
    ds_read_b64_tr_b16 a[164:165], v9 offset:0
    ds_read_b64_tr_b16 a[166:167], v9 offset:1024
    ds_read_b64_tr_b16 a[168:169], v8 offset:8192
    ds_read_b64_tr_b16 a[170:171], v8 offset:9216
    ds_read_b64_tr_b16 a[172:173], v9 offset:8192
    ds_read_b64_tr_b16 a[174:175], v9 offset:9216
    s_waitcnt lgkmcnt(0)
    ds_read_b64_tr_b16 a[176:177], v8 offset:16384
    ds_read_b64_tr_b16 a[178:179], v8 offset:17408
    ds_read_b64_tr_b16 a[180:181], v9 offset:16384
    ds_read_b64_tr_b16 a[182:183], v9 offset:17408
    ds_read_b64_tr_b16 a[184:185], v8 offset:24576
    ds_read_b64_tr_b16 a[186:187], v8 offset:25600
    ds_read_b64_tr_b16 a[188:189], v9 offset:24576
    ds_read_b64_tr_b16 a[190:191], v9 offset:25600
    s_waitcnt lgkmcnt(0)
    s_waitcnt vmcnt(8)
    s_barrier
    ds_read_b64_tr_b16 a[192:193], v8 offset:32768
    ds_read_b64_tr_b16 a[194:195], v8 offset:33792
    ds_read_b64_tr_b16 a[196:197], v9 offset:32768
    ds_read_b64_tr_b16 a[198:199], v9 offset:33792
    ds_read_b64_tr_b16 a[200:201], v8 offset:40960
    ds_read_b64_tr_b16 a[202:203], v8 offset:41984
    ds_read_b64_tr_b16 a[204:205], v9 offset:40960
    ds_read_b64_tr_b16 a[206:207], v9 offset:41984
    s_waitcnt lgkmcnt(0)
    ds_read_b64_tr_b16 a[208:209], v8 offset:49152
    ds_read_b64_tr_b16 a[210:211], v8 offset:50176
    ds_read_b64_tr_b16 a[212:213], v9 offset:49152
    ds_read_b64_tr_b16 a[214:215], v9 offset:50176
    ds_read_b64_tr_b16 a[216:217], v8 offset:57344
    ds_read_b64_tr_b16 a[218:219], v8 offset:58368
    ds_read_b64_tr_b16 a[220:221], v9 offset:57344
    ds_read_b64_tr_b16 a[222:223], v9 offset:58368
    s_waitcnt lgkmcnt(0)
    s_waitcnt vmcnt(0)
    s_barrier
    v_add_u32 v8, 0x10000, v8
    v_add_u32 v9, 0x10000, v9
    ds_read_b64_tr_b16 a[224:225], v8 offset:0
    ds_read_b64_tr_b16 a[226:227], v8 offset:1024
    ds_read_b64_tr_b16 a[228:229], v9 offset:0
    ds_read_b64_tr_b16 a[230:231], v9 offset:1024
    ds_read_b64_tr_b16 a[232:233], v8 offset:8192
    ds_read_b64_tr_b16 a[234:235], v8 offset:9216
    ds_read_b64_tr_b16 a[236:237], v9 offset:8192
    ds_read_b64_tr_b16 a[238:239], v9 offset:9216
    s_waitcnt lgkmcnt(0)
    ds_read_b64_tr_b16 a[240:241], v8 offset:16384
    ds_read_b64_tr_b16 a[242:243], v8 offset:17408
    ds_read_b64_tr_b16 a[244:245], v9 offset:16384
    ds_read_b64_tr_b16 a[246:247], v9 offset:17408
    ds_read_b64_tr_b16 a[248:249], v8 offset:24576
    ds_read_b64_tr_b16 a[250:251], v8 offset:25600
    ds_read_b64_tr_b16 a[252:253], v9 offset:24576
    ds_read_b64_tr_b16 a[254:255], v9 offset:25600
    s_waitcnt lgkmcnt(0)
    s_cmp_lg_u32 s58, 0
    s_cbranch_scc1 L_si_50
    s_lshl_b32 s60, s56, 2
    s_add_u32 s60, s60, 192
    s_mov_b32 s62, 0
L_sw_51:
    s_load_dword s63, s[98:99], s60 glc
    s_add_u32 s62, s62, 1
    s_cmp_gt_u32 s62, 0x200000
    s_cbranch_scc1 chain_kernel_wabort
    s_waitcnt lgkmcnt(0)
    s_cmp_ge_u32 s63, 32
    s_cbranch_scc1 L_swok_52
    s_sleep 16
    s_branch L_sw_51
L_swok_52:
L_si_50:
    s_barrier
    s_lshr_b32 s60, s58, 1
    s_lshl1_add_u32 s46, s56, s60
    s_lshl1_add_u32 s20, s56, 3
    v_mov_b32 v18, s30
    v_writelane_b32 v18, s20, 32
    s_cmp_gt_u32 s20, 25
    s_cselect_b32 s63, 64, 0
    v_writelane_b32 v18, 64, 33
    v_writelane_b32 v18, s63, 34
    v_writelane_b32 v18, 64, 35
    v_writelane_b32 v18, s63, 36
L_sp_53:
    global_load_dword v19, v[16:17], off sc1
    s_add_u32 s38, s38, 1
    s_cmp_gt_u32 s38, 0x200000
    s_cbranch_scc1 chain_kernel_wabort
    s_waitcnt vmcnt(0)
    v_cmp_lt_u32 vcc, v19, v18
    s_cbranch_vccz L_spok_54
    s_sleep 4
    s_branch L_sp_53
L_spok_54:
    s_lshl_b32 s61, s46, 12
    s_and_b32 s61, s61, 0x2000
    s_xor_b32 s61, s61, s44
    s_lshl_b32 s62, s46, 20
    s_add_u32 s61, s61, s62
    s_and_b32 s62, s58, 1
    s_lshl_b32 s62, s62, 14
    s_add_u32 s33, s61, s62
    s_lshr_b32 s62, s62, 2
    s_xor_b32 s61, s61, 0x2000
    s_add_u32 s34, s61, s62
    s_lshl_b32 s61, s46, 10
    s_and_b32 s61, s61, 0x2000
    s_xor_b32 s61, s61, s45
    s_lshl_b32 s62, s46, 18
    s_add_u32 s35, s61, s62
    s_add_u32 m0, s37, 0
    s_nop 0
    buffer_load_dwordx4 v1, s[8:11], s33 offen offset:0 lds
    buffer_load_dwordx4 v1, s[8:11], s33 offen offset:1024 lds
    buffer_load_dwordx4 v1, s[8:11], s33 offen offset:2048 lds
    buffer_load_dwordx4 v1, s[8:11], s33 offen offset:3072 lds
    s_add_u32 m0, s37, 4096
    s_nop 0
    buffer_load_dwordx4 v2, s[8:11], s33 offen offset:0 lds
    buffer_load_dwordx4 v2, s[8:11], s33 offen offset:1024 lds
    buffer_load_dwordx4 v2, s[8:11], s33 offen offset:2048 lds
    buffer_load_dwordx4 v2, s[8:11], s33 offen offset:3072 lds
    buffer_load_dwordx4 v[36:39], v1, s[8:11], s34 offen offset:0
    buffer_load_dwordx4 v[40:43], v1, s[8:11], s34 offen offset:1024
    buffer_load_dwordx4 v[44:47], v1, s[8:11], s34 offen offset:2048
    buffer_load_dwordx4 v[48:51], v1, s[8:11], s34 offen offset:3072
    buffer_load_dwordx4 v[52:55], v13, s[8:11], s35 offen offset:0 sc1
    buffer_load_dwordx4 v[56:59], v13, s[8:11], s35 offen offset:512 sc1
    buffer_load_dwordx4 v[60:63], v13, s[8:11], s35 offen offset:1024 sc1
    buffer_load_dwordx4 v[64:67], v13, s[8:11], s35 offen offset:1536 sc1
    buffer_load_dwordx2 v[68:69], v14, s[8:11], s35 offen offset:2048 sc1
    buffer_load_dwordx2 v[70:71], v14, s[8:11], s35 offen offset:2560 sc1
    buffer_load_dwordx2 v[72:73], v14, s[8:11], s35 offen offset:3072 sc1
    buffer_load_dwordx2 v[74:75], v14, s[8:11], s35 offen offset:3584 sc1
    s_waitcnt vmcnt(0)
    s_barrier
    s_call_b64 s[54:55], seg_att
    s_add_u32 s20, s20, 8
    s_waitcnt vmcnt(0)
    s_barrier
    s_add_u32 s30, s30, 1
    v_mov_b32 v102, s30
    buffer_store_dword v102, v240, s[8:11], s31 offen
    v_mov_b32 v18, s30
    v_writelane_b32 v18, s20, 32
    s_cmp_gt_u32 s20, 25
    s_cselect_b32 s63, 64, 0
    v_writelane_b32 v18, 64, 33
    v_writelane_b32 v18, s63, 34
    v_writelane_b32 v18, 64, 35
    v_writelane_b32 v18, s63, 36
L_sp_55:
    global_load_dword v19, v[16:17], off sc1
    s_add_u32 s38, s38, 1
    s_cmp_gt_u32 s38, 0x200000
    s_cbranch_scc1 chain_kernel_wabort
    s_waitcnt vmcnt(0)
    v_cmp_lt_u32 vcc, v19, v18
    s_cbranch_vccz L_spok_56
    s_branch L_sp_55
L_spok_56:
    s_add_u32 s46, s46, 8
    s_lshl_b32 s61, s46, 12
    s_and_b32 s61, s61, 0x2000
    s_xor_b32 s61, s61, s44
    s_lshl_b32 s62, s46, 20
    s_add_u32 s61, s61, s62
    s_and_b32 s62, s58, 1
    s_lshl_b32 s62, s62, 14
    s_add_u32 s33, s61, s62
    s_lshr_b32 s62, s62, 2
    s_xor_b32 s61, s61, 0x2000
    s_add_u32 s34, s61, s62
    s_lshl_b32 s61, s46, 10
    s_and_b32 s61, s61, 0x2000
    s_xor_b32 s61, s61, s45
    s_lshl_b32 s62, s46, 18
    s_add_u32 s35, s61, s62
    s_add_u32 m0, s37, 0
    s_nop 0
    buffer_load_dwordx4 v1, s[8:11], s33 offen offset:0 lds
    buffer_load_dwordx4 v1, s[8:11], s33 offen offset:1024 lds
    buffer_load_dwordx4 v1, s[8:11], s33 offen offset:2048 lds
    buffer_load_dwordx4 v1, s[8:11], s33 offen offset:3072 lds
    s_add_u32 m0, s37, 4096
    s_nop 0
    buffer_load_dwordx4 v2, s[8:11], s33 offen offset:0 lds
    buffer_load_dwordx4 v2, s[8:11], s33 offen offset:1024 lds
    buffer_load_dwordx4 v2, s[8:11], s33 offen offset:2048 lds
    buffer_load_dwordx4 v2, s[8:11], s33 offen offset:3072 lds
    buffer_load_dwordx4 v[36:39], v1, s[8:11], s34 offen offset:0
    buffer_load_dwordx4 v[40:43], v1, s[8:11], s34 offen offset:1024
    buffer_load_dwordx4 v[44:47], v1, s[8:11], s34 offen offset:2048
    buffer_load_dwordx4 v[48:51], v1, s[8:11], s34 offen offset:3072
    buffer_load_dwordx4 v[52:55], v13, s[8:11], s35 offen offset:0 sc1
    buffer_load_dwordx4 v[56:59], v13, s[8:11], s35 offen offset:512 sc1
    buffer_load_dwordx4 v[60:63], v13, s[8:11], s35 offen offset:1024 sc1
    buffer_load_dwordx4 v[64:67], v13, s[8:11], s35 offen offset:1536 sc1
    buffer_load_dwordx2 v[68:69], v14, s[8:11], s35 offen offset:2048 sc1
    buffer_load_dwordx2 v[70:71], v14, s[8:11], s35 offen offset:2560 sc1
    buffer_load_dwordx2 v[72:73], v14, s[8:11], s35 offen offset:3072 sc1
    buffer_load_dwordx2 v[74:75], v14, s[8:11], s35 offen offset:3584 sc1
    s_xor_b32 s24, s24, 0x80000
    s_mov_b32 s25, s22
    s_mov_b32 s26, 0x8000000
    s_xor_b32 s27, s22, 0x100000
    s_lshl_b32 s29, s56, 19
    s_sub_u32 s29, s29, 0x400000
    s_mov_b32 s18, 0
    s_waitcnt vmcnt(0)
seg_p:
    s_add_u32 m0, s36, 0
    s_add_u32 s63, s23, 0x0
    buffer_load_dwordx4 v1, s[8:11], s63 offen offset:0 sc1 lds
    buffer_load_dwordx4 v1, s[8:11], s63 offen offset:1024 sc1 lds
    buffer_load_dwordx4 v1, s[8:11], s63 offen offset:2048 sc1 lds
    buffer_load_dwordx4 v1, s[8:11], s63 offen offset:3072 sc1 lds
    s_nop 0
    s_nop 0
    buffer_store_dwordx4 v[136:139], v20, s[8:11], s26 offen
    buffer_store_dwordx4 v[140:143], v21, s[8:11], s26 offen
    buffer_store_dwordx4 v[144:147], v22, s[8:11], s26 offen
    s_waitcnt vmcnt(10)
    s_add_u32 m0, s36, 4096
    s_nop 0
    buffer_load_dwordx4 v2, s[8:11], s63 offen offset:0 sc1 lds
    buffer_load_dwordx4 v2, s[8:11], s63 offen offset:1024 sc1 lds
    buffer_load_dwordx4 v2, s[8:11], s63 offen offset:2048 sc1 lds
    buffer_load_dwordx4 v2, s[8:11], s63 offen offset:3072 sc1 lds
    v_pk_add_f32 v[104:105], v[104:105], v[232:233]
    v_pk_add_f32 v[106:107], v[106:107], v[234:235]
    v_pk_add_f32 v[108:109], v[108:109], v[112:113]
    v_pk_add_f32 v[110:111], v[110:111], v[114:115]
    v_pk_add_f32 v[104:105], v[104:105], v[108:109]
    v_pk_add_f32 v[106:107], v[106:107], v[110:111]
    v_cvt_pk_bf16_f32 v104, 0, v104
    v_cvt_pk_bf16_f32 v105, 0, v105
    v_cvt_pk_bf16_f32 v106, 0, v106
    v_cvt_pk_bf16_f32 v107, 0, v107
    s_add_u32 s62, s29, 0x0
    buffer_store_dwordx4 v[104:107], v15, s[16:19], s62 offen
    s_add_u32 m0, s36, 32768
    s_add_u32 s63, s23, 0x8000
    buffer_load_dwordx4 v1, s[8:11], s63 offen offset:0 sc1 lds
    buffer_load_dwordx4 v1, s[8:11], s63 offen offset:1024 sc1 lds
    buffer_load_dwordx4 v1, s[8:11], s63 offen offset:2048 sc1 lds
    buffer_load_dwordx4 v1, s[8:11], s63 offen offset:3072 sc1 lds
    v_pk_add_f32 v[116:117], v[116:117], v[236:237]
    v_pk_add_f32 v[118:119], v[118:119], v[238:239]
    v_pk_add_f32 v[120:121], v[120:121], v[124:125]
    v_pk_add_f32 v[122:123], v[122:123], v[126:127]
    v_pk_add_f32 v[116:117], v[116:117], v[120:121]
    v_pk_add_f32 v[118:119], v[118:119], v[122:123]
    v_cvt_pk_bf16_f32 v116, 0, v116
    v_cvt_pk_bf16_f32 v117, 0, v117
    v_cvt_pk_bf16_f32 v118, 0, v118
    v_cvt_pk_bf16_f32 v119, 0, v119
    s_add_u32 s62, s29, 0x40000
    buffer_store_dwordx4 v[116:119], v15, s[16:19], s62 offen
    s_add_u32 m0, s36, 36864
    s_nop 0
    buffer_load_dwordx4 v2, s[8:11], s63 offen offset:0 sc1 lds
    buffer_load_dwordx4 v2, s[8:11], s63 offen offset:1024 sc1 lds
    buffer_load_dwordx4 v2, s[8:11], s63 offen offset:2048 sc1 lds
    buffer_load_dwordx4 v2, s[8:11], s63 offen offset:3072 sc1 lds
    v_mov_b32 v232, v196
    v_mov_b32 v233, v197
    v_mov_b32 v234, v198
    v_mov_b32 v235, v199
    v_mov_b32 v236, v148
    v_mov_b32 v237, v149
    v_mov_b32 v238, v150
    v_mov_b32 v239, v151
    s_add_u32 s29, s29, 0x200000
    s_cmp_lt_i32 s29, 0
    s_cselect_b32 s18, 0, 0x1000000
    s_waitcnt vmcnt(30)
    s_barrier
    ds_read_b128 v[104:107], v12 offset:0
    ds_read_b128 v[108:111], v12 offset:4096
    ds_read_b128 v[112:115], v12 offset:1024
    ds_read_b128 v[116:119], v12 offset:5120
    ds_read_b128 v[120:123], v12 offset:2048
    ds_read_b128 v[124:127], v12 offset:6144
    ds_read_b128 v[128:131], v12 offset:3072
    ds_read_b128 v[132:135], v12 offset:7168
    v_mfma_f32_16x16x32_bf16 v[84:87], v[52:55], v[36:39], 0
    v_mfma_f32_16x16x32_bf16 v[84:87], v[56:59], v[40:43], v[84:87]
    v_mfma_f32_16x16x32_bf16 v[84:87], v[60:63], v[44:47], v[84:87]
    v_mfma_f32_16x16x32_bf16 v[84:87], v[64:67], v[48:51], v[84:87]
    s_waitcnt lgkmcnt(6)
    v_mfma_f32_16x16x32_bf16 v[76:79], v[104:107], v[36:39], 0
    v_mfma_f32_16x16x32_bf16 v[80:83], v[108:111], v[36:39], 0
    s_waitcnt lgkmcnt(4)
    v_mfma_f32_16x16x32_bf16 v[76:79], v[112:115], v[40:43], v[76:79]
    v_mfma_f32_16x16x32_bf16 v[80:83], v[116:119], v[40:43], v[80:83]
    s_waitcnt lgkmcnt(2)
    v_mfma_f32_16x16x32_bf16 v[76:79], v[120:123], v[44:47], v[76:79]
    v_mfma_f32_16x16x32_bf16 v[80:83], v[124:127], v[44:47], v[80:83]
    s_waitcnt lgkmcnt(0)
    v_mfma_f32_16x16x32_bf16 v[76:79], v[128:131], v[48:51], v[76:79]
    v_mfma_f32_16x16x32_bf16 v[80:83], v[132:135], v[48:51], v[80:83]
    ds_read_b128 v[104:107], v12 offset:8192
    ds_read_b128 v[108:111], v12 offset:9216
    ds_read_b128 v[112:115], v12 offset:10240
    ds_read_b128 v[116:119], v12 offset:11264
    ds_read_b128 v[120:123], v12 offset:12288
    ds_read_b128 v[124:127], v12 offset:13312
    ds_read_b128 v[128:131], v12 offset:14336
    ds_read_b128 v[132:135], v12 offset:15360
    v_cvt_pk_bf16_f32 v84, 0, v84
    v_cvt_pk_bf16_f32 v85, 0, v85
    v_cvt_pk_bf16_f32 v76, 0, v76
    v_cvt_pk_bf16_f32 v77, 0, v77
    v_cvt_pk_bf16_f32 v78, 0, v78
    v_cvt_pk_bf16_f32 v79, 0, v79
    v_cvt_pk_bf16_f32 v80, 0, v80
    v_cvt_pk_bf16_f32 v81, 0, v81
    v_cvt_pk_bf16_f32 v82, 0, v82
    v_cvt_pk_bf16_f32 v83, 0, v83
    v_pk_mul_f32 v[84:85], v[84:85], s[40:41]
    v_pk_mul_f32 v[76:77], v[76:77], s[40:41]
    v_pk_mul_f32 v[78:79], v[78:79], s[40:41]
    v_pk_mul_f32 v[80:81], v[80:81], s[40:41]
    v_pk_mul_f32 v[82:83], v[82:83], s[40:41]
    v_cvt_pk_bf16_f32 v84, 0, v84
    v_cvt_pk_bf16_f32 v85, 0, v85
    v_cvt_pk_bf16_f32 v76, 0, v76
    v_cvt_pk_bf16_f32 v77, 0, v77
    v_cvt_pk_bf16_f32 v78, 0, v78
    v_cvt_pk_bf16_f32 v79, 0, v79
    v_cvt_pk_bf16_f32 v80, 0, v80
    v_cvt_pk_bf16_f32 v81, 0, v81
    v_cvt_pk_bf16_f32 v82, 0, v82
    v_cvt_pk_bf16_f32 v83, 0, v83
    v_pk_add_f32 v[76:77], v[76:77], v[28:29]
    v_pk_add_f32 v[78:79], v[78:79], v[30:31]
    v_pk_add_f32 v[80:81], v[80:81], v[32:33]
    v_pk_add_f32 v[82:83], v[82:83], v[34:35]
    v_max3_f32 v96, v84, v85, v76
    v_max3_f32 v97, v77, v78, v79
    v_max3_f32 v96, v96, v80, v81
    v_max3_f32 v97, v97, v82, v83
    v_max_f32 v96, v96, v97
    v_mov_b32 v97, v96
    s_nop 1
    v_permlane16_swap_b32 v96, v97
    v_max_f32 v96, v96, v97
    v_mov_b32 v97, v96
    s_nop 1
    v_permlane32_swap_b32 v96, v97
    v_max_f32 v96, v96, v97
    v_mul_f32 v96, s42, v96
    v_pk_fma_f32 v[84:85], v[84:85], s[42:43], v[96:97] op_sel_hi:[1,1,0] neg_lo:[0,0,1] neg_hi:[0,0,1]
    v_pk_fma_f32 v[76:77], v[76:77], s[42:43], v[96:97] op_sel_hi:[1,1,0] neg_lo:[0,0,1] neg_hi:[0,0,1]
    v_pk_fma_f32 v[78:79], v[78:79], s[42:43], v[96:97] op_sel_hi:[1,1,0] neg_lo:[0,0,1] neg_hi:[0,0,1]
    v_pk_fma_f32 v[80:81], v[80:81], s[42:43], v[96:97] op_sel_hi:[1,1,0] neg_lo:[0,0,1] neg_hi:[0,0,1]
    v_pk_fma_f32 v[82:83], v[82:83], s[42:43], v[96:97] op_sel_hi:[1,1,0] neg_lo:[0,0,1] neg_hi:[0,0,1]
    v_exp_f32 v84, v84
    v_exp_f32 v85, v85
    v_exp_f32 v76, v76
    v_exp_f32 v77, v77
    v_exp_f32 v78, v78
    v_exp_f32 v79, v79
    v_exp_f32 v80, v80
    v_exp_f32 v81, v81
    v_exp_f32 v82, v82
    v_exp_f32 v83, v83
    v_pk_add_f32 v[98:99], v[84:85], v[76:77]
    v_pk_add_f32 v[100:101], v[78:79], v[80:81]
    v_pk_add_f32 v[98:99], v[98:99], v[82:83]
    v_pk_add_f32 v[98:99], v[98:99], v[100:101]
    v_add_f32 v98, v98, v99
    v_mov_b32 v97, v98
    s_nop 1
    v_permlane16_swap_b32 v98, v97
    v_add_f32 v98, v98, v97
    v_mov_b32 v97, v98
    s_nop 1
    v_permlane32_swap_b32 v98, v97
    v_add_f32 v98, v98, v97
    v_rcp_f32 v98, v98
    s_nop 0
    v_pk_mul_f32 v[76:77], v[76:77], v[98:99] op_sel_hi:[1,0]
    v_pk_mul_f32 v[78:79], v[78:79], v[98:99] op_sel_hi:[1,0]
    v_pk_mul_f32 v[80:81], v[80:81], v[98:99] op_sel_hi:[1,0]
    v_pk_mul_f32 v[82:83], v[82:83], v[98:99] op_sel_hi:[1,0]
    v_pk_mul_f32 v[84:85], v[84:85], v[98:99] op_sel_hi:[1,0]
    v_cvt_pk_bf16_f32 v88, v76, v77
    v_cvt_pk_bf16_f32 v89, v78, v79
    v_cvt_pk_bf16_f32 v90, v80, v81
    v_cvt_pk_bf16_f32 v91, v82, v83
    v_cvt_pk_bf16_f32 v92, v84, v85
    v_cvt_pk_bf16_f32 v95, v84, v85
    s_waitcnt lgkmcnt(0)
    v_mfma_f32_16x16x32_bf16 v[136:139], v[104:107], v[88:91], 0
    v_mfma_f32_16x16x32_bf16 v[140:143], v[108:111], v[88:91], 0
    v_mfma_f32_16x16x16_bf16 v[136:139], v[68:69], v[92:93], v[136:139]
    v_mfma_f32_16x16x16_bf16 v[140:143], v[68:69], v[94:95], v[140:143]
    v_mfma_f32_16x16x32_bf16 v[144:147], v[112:115], v[88:91], 0
    v_mfma_f32_16x16x32_bf16 v[148:151], v[116:119], v[88:91], 0
    v_mfma_f32_16x16x16_bf16 v[144:147], v[70:71], v[92:93], v[144:147]
    v_mfma_f32_16x16x16_bf16 v[148:151], v[70:71], v[94:95], v[148:151]
    v_cvt_pk_bf16_f32 v136, v136, v137
    v_cvt_pk_bf16_f32 v137, v138, v139
    v_cvt_pk_bf16_f32 v138, v140, v141
    v_cvt_pk_bf16_f32 v139, v142, v143
    buffer_store_dwordx4 v[136:139], v1, s[8:11], s24 offen offset:0
    v_mfma_f32_16x16x32_bf16 v[152:155], v[120:123], v[88:91], 0
    v_mfma_f32_16x16x32_bf16 v[156:159], v[124:127], v[88:91], 0
    v_mfma_f32_16x16x16_bf16 v[152:155], v[72:73], v[92:93], v[152:155]
    v_mfma_f32_16x16x16_bf16 v[156:159], v[72:73], v[94:95], v[156:159]
    v_cvt_pk_bf16_f32 v144, v144, v145
    v_cvt_pk_bf16_f32 v145, v146, v147
    v_cvt_pk_bf16_f32 v146, v148, v149
    v_cvt_pk_bf16_f32 v147, v150, v151
    buffer_store_dwordx4 v[144:147], v1, s[8:11], s24 offen offset:1024
    v_mfma_f32_16x16x32_bf16 v[160:163], v[128:131], v[88:91], 0
    v_mfma_f32_16x16x32_bf16 v[164:167], v[132:135], v[88:91], 0
    v_mfma_f32_16x16x16_bf16 v[160:163], v[74:75], v[92:93], v[160:163]
    v_mfma_f32_16x16x16_bf16 v[164:167], v[74:75], v[94:95], v[164:167]
    v_cvt_pk_bf16_f32 v152, v152, v153
    v_cvt_pk_bf16_f32 v153, v154, v155
    v_cvt_pk_bf16_f32 v154, v156, v157
    v_cvt_pk_bf16_f32 v155, v158, v159
    buffer_store_dwordx4 v[152:155], v1, s[8:11], s24 offen offset:2048
    s_nop 3
    v_cvt_pk_bf16_f32 v160, v160, v161
    v_cvt_pk_bf16_f32 v161, v162, v163
    v_cvt_pk_bf16_f32 v162, v164, v165
    v_cvt_pk_bf16_f32 v163, v166, v167
    buffer_store_dwordx4 v[160:163], v1, s[8:11], s24 offen offset:3072
    s_waitcnt vmcnt(4)
    s_barrier
    ds_read_b128 v[200:203], v4 offset:0
    ds_read_b128 v[204:207], v5 offset:0
    ds_read_b128 v[208:211], v4 offset:1024
    ds_read_b128 v[212:215], v5 offset:1024
    ds_read_b128 v[216:219], v4 offset:2048
    ds_read_b128 v[220:223], v5 offset:2048
    s_waitcnt lgkmcnt(4)
    v_mfma_f32_16x16x32_bf16 v[168:171], a[0:3], v[200:203], 0
    ds_read_b128 v[224:227], v4 offset:3072
    s_add_u32 m0, s36, 65536
    v_mfma_f32_16x16x32_bf16 v[172:175], a[4:7], v[200:203], 0
    ds_read_b128 v[228:231], v5 offset:3072
    v_mfma_f32_16x16x32_bf16 v[180:183], a[4:7], v[204:207], 0
    s_add_u32 s63, s23, 0x40000
    v_mfma_f32_16x16x32_bf16 v[176:179], a[0:3], v[204:207], 0
    s_waitcnt lgkmcnt(4)
    v_mfma_f32_16x16x32_bf16 v[168:171], a[8:11], v[208:211], v[168:171]
    ds_read_b128 v[200:203], v4 offset:8192
    buffer_load_dwordx4 v1, s[8:11], s63 offen offset:0 sc1 lds
    v_mfma_f32_16x16x32_bf16 v[172:175], a[12:15], v[208:211], v[172:175]
    ds_read_b128 v[204:207], v5 offset:8192
    v_mfma_f32_16x16x32_bf16 v[180:183], a[12:15], v[212:215], v[180:183]
    buffer_load_dwordx4 v1, s[8:11], s63 offen offset:1024 sc1 lds
    v_mfma_f32_16x16x32_bf16 v[176:179], a[8:11], v[212:215], v[176:179]
    s_waitcnt lgkmcnt(4)
    v_mfma_f32_16x16x32_bf16 v[168:171], a[16:19], v[216:219], v[168:171]
    ds_read_b128 v[208:211], v4 offset:9216
    buffer_load_dwordx4 v1, s[8:11], s63 offen offset:2048 sc1 lds
    v_mfma_f32_16x16x32_bf16 v[172:175], a[20:23], v[216:219], v[172:175]
    ds_read_b128 v[212:215], v5 offset:9216
    v_mfma_f32_16x16x32_bf16 v[180:183], a[20:23], v[220:223], v[180:183]
    buffer_load_dwordx4 v1, s[8:11], s63 offen offset:3072 sc1 lds
    v_mfma_f32_16x16x32_bf16 v[176:179], a[16:19], v[220:223], v[176:179]
    s_waitcnt lgkmcnt(4)
    v_mfma_f32_16x16x32_bf16 v[168:171], a[24:27], v[224:227], v[168:171]
    ds_read_b128 v[216:219], v4 offset:10240
    s_add_u32 m0, s36, 69632
    v_mfma_f32_16x16x32_bf16 v[172:175], a[28:31], v[224:227], v[172:175]
    ds_read_b128 v[220:223], v5 offset:10240
    v_mfma_f32_16x16x32_bf16 v[180:183], a[28:31], v[228:231], v[180:183]
    s_nop 0
    v_mfma_f32_16x16x32_bf16 v[176:179], a[24:27], v[228:231], v[176:179]
    s_waitcnt lgkmcnt(4)
    v_mfma_f32_16x16x32_bf16 v[168:171], a[32:35], v[200:203], v[168:171]
    ds_read_b128 v[224:227], v4 offset:11264
    buffer_load_dwordx4 v2, s[8:11], s63 offen offset:0 sc1 lds
    v_mfma_f32_16x16x32_bf16 v[172:175], a[36:39], v[200:203], v[172:175]
    ds_read_b128 v[228:231], v5 offset:11264
    v_mfma_f32_16x16x32_bf16 v[180:183], a[36:39], v[204:207], v[180:183]
    buffer_load_dwordx4 v2, s[8:11], s63 offen offset:1024 sc1 lds
    v_mfma_f32_16x16x32_bf16 v[176:179], a[32:35], v[204:207], v[176:179]
    s_waitcnt lgkmcnt(4)
    v_mfma_f32_16x16x32_bf16 v[168:171], a[40:43], v[208:211], v[168:171]
    ds_read_b128 v[200:203], v4 offset:16384
    buffer_load_dwordx4 v2, s[8:11], s63 offen offset:2048 sc1 lds
    v_mfma_f32_16x16x32_bf16 v[172:175], a[44:47], v[208:211], v[172:175]
    ds_read_b128 v[204:207], v5 offset:16384
    v_mfma_f32_16x16x32_bf16 v[180:183], a[44:47], v[212:215], v[180:183]
    buffer_load_dwordx4 v2, s[8:11], s63 offen offset:3072 sc1 lds
    v_mfma_f32_16x16x32_bf16 v[176:179], a[40:43], v[212:215], v[176:179]
    s_waitcnt lgkmcnt(4)
    v_mfma_f32_16x16x32_bf16 v[168:171], a[48:51], v[216:219], v[168:171]
    ds_read_b128 v[208:211], v4 offset:17408
    s_add_u32 m0, s36, 98304
    v_mfma_f32_16x16x32_bf16 v[172:175], a[52:55], v[216:219], v[172:175]
    ds_read_b128 v[212:215], v5 offset:17408
    v_mfma_f32_16x16x32_bf16 v[180:183], a[52:55], v[220:223], v[180:183]
    s_add_u32 s63, s23, 0x48000
    v_mfma_f32_16x16x32_bf16 v[176:179], a[48:51], v[220:223], v[176:179]
    s_waitcnt lgkmcnt(4)
    v_mfma_f32_16x16x32_bf16 v[168:171], a[56:59], v[224:227], v[168:171]
    ds_read_b128 v[216:219], v4 offset:18432
    buffer_load_dwordx4 v1, s[8:11], s63 offen offset:0 sc1 lds
    v_mfma_f32_16x16x32_bf16 v[172:175], a[60:63], v[224:227], v[172:175]
    ds_read_b128 v[220:223], v5 offset:18432
    v_mfma_f32_16x16x32_bf16 v[180:183], a[60:63], v[228:231], v[180:183]
    buffer_load_dwordx4 v1, s[8:11], s63 offen offset:1024 sc1 lds
    v_mfma_f32_16x16x32_bf16 v[176:179], a[56:59], v[228:231], v[176:179]
    s_waitcnt lgkmcnt(4)
    v_mfma_f32_16x16x32_bf16 v[168:171], a[64:67], v[200:203], v[168:171]
    ds_read_b128 v[224:227], v4 offset:19456
    buffer_load_dwordx4 v1, s[8:11], s63 offen offset:2048 sc1 lds
    v_mfma_f32_16x16x32_bf16 v[172:175], a[68:71], v[200:203], v[172:175]
    ds_read_b128 v[228:231], v5 offset:19456
    v_mfma_f32_16x16x32_bf16 v[180:183], a[68:71], v[204:207], v[180:183]
    buffer_load_dwordx4 v1, s[8:11], s63 offen offset:3072 sc1 lds
    v_mfma_f32_16x16x32_bf16 v[176:179], a[64:67], v[204:207], v[176:179]
    s_waitcnt lgkmcnt(4)
    v_mfma_f32_16x16x32_bf16 v[168:171], a[72:75], v[208:211], v[168:171]
    ds_read_b128 v[200:203], v4 offset:24576
    s_add_u32 m0, s36, 102400
    v_mfma_f32_16x16x32_bf16 v[172:175], a[76:79], v[208:211], v[172:175]
    ds_read_b128 v[204:207], v5 offset:24576
    v_mfma_f32_16x16x32_bf16 v[180:183], a[76:79], v[212:215], v[180:183]
    s_nop 0
    v_mfma_f32_16x16x32_bf16 v[176:179], a[72:75], v[212:215], v[176:179]
    s_waitcnt lgkmcnt(4)
    v_mfma_f32_16x16x32_bf16 v[168:171], a[80:83], v[216:219], v[168:171]
    ds_read_b128 v[208:211], v4 offset:25600
    buffer_load_dwordx4 v2, s[8:11], s63 offen offset:0 sc1 lds
    v_mfma_f32_16x16x32_bf16 v[172:175], a[84:87], v[216:219], v[172:175]
    ds_read_b128 v[212:215], v5 offset:25600
    v_mfma_f32_16x16x32_bf16 v[180:183], a[84:87], v[220:223], v[180:183]
    buffer_load_dwordx4 v2, s[8:11], s63 offen offset:1024 sc1 lds
    v_mfma_f32_16x16x32_bf16 v[176:179], a[80:83], v[220:223], v[176:179]
    s_waitcnt lgkmcnt(4)
    v_mfma_f32_16x16x32_bf16 v[168:171], a[88:91], v[224:227], v[168:171]
    ds_read_b128 v[216:219], v4 offset:26624
    buffer_load_dwordx4 v2, s[8:11], s63 offen offset:2048 sc1 lds
    v_mfma_f32_16x16x32_bf16 v[172:175], a[92:95], v[224:227], v[172:175]
    ds_read_b128 v[220:223], v5 offset:26624
    v_mfma_f32_16x16x32_bf16 v[180:183], a[92:95], v[228:231], v[180:183]
    buffer_load_dwordx4 v2, s[8:11], s63 offen offset:3072 sc1 lds
    v_mfma_f32_16x16x32_bf16 v[176:179], a[88:91], v[228:231], v[176:179]
    s_waitcnt lgkmcnt(4)
    v_mfma_f32_16x16x32_bf16 v[168:171], a[96:99], v[200:203], v[168:171]
    ds_read_b128 v[224:227], v4 offset:27648
    v_mfma_f32_16x16x32_bf16 v[172:175], a[100:103], v[200:203], v[172:175]
    ds_read_b128 v[228:231], v5 offset:27648
    v_mfma_f32_16x16x32_bf16 v[180:183], a[100:103], v[204:207], v[180:183]
    v_mfma_f32_16x16x32_bf16 v[176:179], a[96:99], v[204:207], v[176:179]
    s_waitcnt vmcnt(0)
    s_barrier
    s_waitcnt lgkmcnt(4)
    v_mfma_f32_16x16x32_bf16 v[168:171], a[104:107], v[208:211], v[168:171]
    ds_read_b128 v[200:203], v4 offset:32768
    s_add_u32 s30, s30, 1
    v_mfma_f32_16x16x32_bf16 v[172:175], a[108:111], v[208:211], v[172:175]
    ds_read_b128 v[204:207], v5 offset:32768
    v_mov_b32 v102, s30
    v_mfma_f32_16x16x32_bf16 v[180:183], a[108:111], v[212:215], v[180:183]
    buffer_store_dword v102, v240, s[8:11], s31 offen
    v_mfma_f32_16x16x32_bf16 v[176:179], a[104:107], v[212:215], v[176:179]
    s_add_u32 s46, s46, 8
    s_waitcnt lgkmcnt(4)
    v_mfma_f32_16x16x32_bf16 v[168:171], a[112:115], v[216:219], v[168:171]
    ds_read_b128 v[208:211], v4 offset:33792
    s_cmp_ge_u32 s46, 56
    v_mfma_f32_16x16x32_bf16 v[172:175], a[116:119], v[216:219], v[172:175]
    ds_read_b128 v[212:215], v5 offset:33792
    s_cselect_b32 s46, 128, s46
    v_mfma_f32_16x16x32_bf16 v[180:183], a[116:119], v[220:223], v[180:183]
    s_lshl_b32 s61, s46, 12
    s_and_b32 s61, s61, 0x2000
    v_mfma_f32_16x16x32_bf16 v[176:179], a[112:115], v[220:223], v[176:179]
    s_xor_b32 s61, s61, s44
    s_waitcnt lgkmcnt(4)
    v_mfma_f32_16x16x32_bf16 v[168:171], a[120:123], v[224:227], v[168:171]
    ds_read_b128 v[216:219], v4 offset:34816
    s_lshl_b32 s62, s46, 20
    v_mfma_f32_16x16x32_bf16 v[172:175], a[124:127], v[224:227], v[172:175]
    ds_read_b128 v[220:223], v5 offset:34816
    s_add_u32 s61, s61, s62
    v_mfma_f32_16x16x32_bf16 v[180:183], a[124:127], v[228:231], v[180:183]
    s_and_b32 s62, s58, 1
    s_lshl_b32 s62, s62, 14
    v_mfma_f32_16x16x32_bf16 v[176:179], a[120:123], v[228:231], v[176:179]
    s_add_u32 s33, s61, s62
    s_waitcnt lgkmcnt(4)
    v_mfma_f32_16x16x32_bf16 v[168:171], a[128:131], v[200:203], v[168:171]
    ds_read_b128 v[224:227], v4 offset:35840
    s_lshr_b32 s62, s62, 2
    v_mfma_f32_16x16x32_bf16 v[172:175], a[132:135], v[200:203], v[172:175]
    ds_read_b128 v[228:231], v5 offset:35840
    s_xor_b32 s61, s61, 0x2000
    v_mfma_f32_16x16x32_bf16 v[180:183], a[132:135], v[204:207], v[180:183]
    s_add_u32 s34, s61, s62
    s_lshl_b32 s61, s46, 10
    v_mfma_f32_16x16x32_bf16 v[176:179], a[128:131], v[204:207], v[176:179]
    s_and_b32 s61, s61, 0x2000
    s_waitcnt lgkmcnt(4)
    v_mfma_f32_16x16x32_bf16 v[168:171], a[136:139], v[208:211], v[168:171]
    ds_read_b128 v[200:203], v4 offset:40960
    s_xor_b32 s61, s61, s45
    v_mfma_f32_16x16x32_bf16 v[172:175], a[140:143], v[208:211], v[172:175]
    ds_read_b128 v[204:207], v5 offset:40960
    s_lshl_b32 s62, s46, 18
    v_mfma_f32_16x16x32_bf16 v[180:183], a[140:143], v[212:215], v[180:183]
    s_add_u32 s35, s61, s62
    v_mfma_f32_16x16x32_bf16 v[176:179], a[136:139], v[212:215], v[176:179]
    s_waitcnt lgkmcnt(4)
    v_mfma_f32_16x16x32_bf16 v[168:171], a[144:147], v[216:219], v[168:171]
    ds_read_b128 v[208:211], v4 offset:41984
    s_add_u32 m0, s37, 0
    v_mfma_f32_16x16x32_bf16 v[172:175], a[148:151], v[216:219], v[172:175]
    ds_read_b128 v[212:215], v5 offset:41984
    v_mfma_f32_16x16x32_bf16 v[180:183], a[148:151], v[220:223], v[180:183]
    v_mfma_f32_16x16x32_bf16 v[176:179], a[144:147], v[220:223], v[176:179]
    s_waitcnt lgkmcnt(4)
    v_mfma_f32_16x16x32_bf16 v[168:171], a[152:155], v[224:227], v[168:171]
    ds_read_b128 v[216:219], v4 offset:43008
    v_mfma_f32_16x16x32_bf16 v[172:175], a[156:159], v[224:227], v[172:175]
    ds_read_b128 v[220:223], v5 offset:43008
    s_nop 0
    v_mfma_f32_16x16x32_bf16 v[180:183], a[156:159], v[228:231], v[180:183]
    v_mfma_f32_16x16x32_bf16 v[176:179], a[152:155], v[228:231], v[176:179]
    s_waitcnt lgkmcnt(4)
    v_mfma_f32_16x16x32_bf16 v[168:171], a[160:163], v[200:203], v[168:171]
    ds_read_b128 v[224:227], v4 offset:44032
    v_mfma_f32_16x16x32_bf16 v[172:175], a[164:167], v[200:203], v[172:175]
    ds_read_b128 v[228:231], v5 offset:44032
    v_mfma_f32_16x16x32_bf16 v[180:183], a[164:167], v[204:207], v[180:183]
    buffer_load_dwordx4 v1, s[8:11], s33 offen offset:0 lds
    v_mfma_f32_16x16x32_bf16 v[176:179], a[160:163], v[204:207], v[176:179]
    s_waitcnt lgkmcnt(4)
    v_mfma_f32_16x16x32_bf16 v[168:171], a[168:171], v[208:211], v[168:171]
    ds_read_b128 v[200:203], v4 offset:49152
    v_mfma_f32_16x16x32_bf16 v[172:175], a[172:175], v[208:211], v[172:175]
    ds_read_b128 v[204:207], v5 offset:49152
    v_mfma_f32_16x16x32_bf16 v[180:183], a[172:175], v[212:215], v[180:183]
    v_mfma_f32_16x16x32_bf16 v[176:179], a[168:171], v[212:215], v[176:179]
    buffer_load_dwordx4 v1, s[8:11], s33 offen offset:1024 lds
    s_waitcnt lgkmcnt(4)
    v_mfma_f32_16x16x32_bf16 v[168:171], a[176:179], v[216:219], v[168:171]
    ds_read_b128 v[208:211], v4 offset:50176
    v_mfma_f32_16x16x32_bf16 v[172:175], a[180:183], v[216:219], v[172:175]
    ds_read_b128 v[212:215], v5 offset:50176
    v_mfma_f32_16x16x32_bf16 v[180:183], a[180:183], v[220:223], v[180:183]
    v_mfma_f32_16x16x32_bf16 v[176:179], a[176:179], v[220:223], v[176:179]
    s_waitcnt lgkmcnt(4)
    v_mfma_f32_16x16x32_bf16 v[168:171], a[184:187], v[224:227], v[168:171]
    ds_read_b128 v[216:219], v4 offset:51200
    buffer_load_dwordx4 v1, s[8:11], s33 offen offset:2048 lds
    v_mfma_f32_16x16x32_bf16 v[172:175], a[188:191], v[224:227], v[172:175]
    ds_read_b128 v[220:223], v5 offset:51200
    v_mfma_f32_16x16x32_bf16 v[180:183], a[188:191], v[228:231], v[180:183]
    v_mfma_f32_16x16x32_bf16 v[176:179], a[184:187], v[228:231], v[176:179]
    s_waitcnt lgkmcnt(4)
    v_mfma_f32_16x16x32_bf16 v[168:171], a[192:195], v[200:203], v[168:171]
    ds_read_b128 v[224:227], v4 offset:52224
    v_mfma_f32_16x16x32_bf16 v[172:175], a[196:199], v[200:203], v[172:175]
    ds_read_b128 v[228:231], v5 offset:52224
    buffer_load_dwordx4 v1, s[8:11], s33 offen offset:3072 lds
    v_mfma_f32_16x16x32_bf16 v[180:183], a[196:199], v[204:207], v[180:183]
    v_mfma_f32_16x16x32_bf16 v[176:179], a[192:195], v[204:207], v[176:179]
    s_waitcnt lgkmcnt(4)
    v_mfma_f32_16x16x32_bf16 v[168:171], a[200:203], v[208:211], v[168:171]
    ds_read_b128 v[200:203], v4 offset:57344
    v_mfma_f32_16x16x32_bf16 v[172:175], a[204:207], v[208:211], v[172:175]
    ds_read_b128 v[204:207], v5 offset:57344
    v_mfma_f32_16x16x32_bf16 v[180:183], a[204:207], v[212:215], v[180:183]
    s_add_u32 m0, s37, 4096
    v_mfma_f32_16x16x32_bf16 v[176:179], a[200:203], v[212:215], v[176:179]
    s_waitcnt lgkmcnt(4)
    v_mfma_f32_16x16x32_bf16 v[168:171], a[208:211], v[216:219], v[168:171]
    ds_read_b128 v[208:211], v4 offset:58368
    v_mfma_f32_16x16x32_bf16 v[172:175], a[212:215], v[216:219], v[172:175]
    ds_read_b128 v[212:215], v5 offset:58368
    v_mfma_f32_16x16x32_bf16 v[180:183], a[212:215], v[220:223], v[180:183]
    v_mfma_f32_16x16x32_bf16 v[176:179], a[208:211], v[220:223], v[176:179]
    s_nop 0
    s_waitcnt lgkmcnt(4)
    v_mfma_f32_16x16x32_bf16 v[168:171], a[216:219], v[224:227], v[168:171]
    ds_read_b128 v[216:219], v4 offset:59392
    v_mfma_f32_16x16x32_bf16 v[172:175], a[220:223], v[224:227], v[172:175]
    ds_read_b128 v[220:223], v5 offset:59392
    v_mfma_f32_16x16x32_bf16 v[180:183], a[220:223], v[228:231], v[180:183]
    v_mfma_f32_16x16x32_bf16 v[176:179], a[216:219], v[228:231], v[176:179]
    s_waitcnt lgkmcnt(4)
    v_mfma_f32_16x16x32_bf16 v[168:171], a[224:227], v[200:203], v[168:171]
    ds_read_b128 v[224:227], v4 offset:60416
    buffer_load_dwordx4 v2, s[8:11], s33 offen offset:0 lds
    v_mfma_f32_16x16x32_bf16 v[172:175], a[228:231], v[200:203], v[172:175]
    ds_read_b128 v[228:231], v5 offset:60416
    v_mfma_f32_16x16x32_bf16 v[180:183], a[228:231], v[204:207], v[180:183]
    v_mfma_f32_16x16x32_bf16 v[176:179], a[224:227], v[204:207], v[176:179]
    s_waitcnt lgkmcnt(4)
    v_mfma_f32_16x16x32_bf16 v[168:171], a[232:235], v[208:211], v[168:171]
    ds_read_b128 v[200:203], v10 offset:0
    v_mfma_f32_16x16x32_bf16 v[172:175], a[236:239], v[208:211], v[172:175]
    ds_read_b128 v[204:207], v11 offset:0
    buffer_load_dwordx4 v2, s[8:11], s33 offen offset:1024 lds
    v_mfma_f32_16x16x32_bf16 v[180:183], a[236:239], v[212:215], v[180:183]
    v_mfma_f32_16x16x32_bf16 v[176:179], a[232:235], v[212:215], v[176:179]
    s_waitcnt lgkmcnt(4)
    v_mfma_f32_16x16x32_bf16 v[168:171], a[240:243], v[216:219], v[168:171]
    ds_read_b128 v[208:211], v10 offset:1024
    v_mfma_f32_16x16x32_bf16 v[172:175], a[244:247], v[216:219], v[172:175]
    ds_read_b128 v[212:215], v11 offset:1024
    v_mfma_f32_16x16x32_bf16 v[180:183], a[244:247], v[220:223], v[180:183]
    buffer_load_dwordx4 v2, s[8:11], s33 offen offset:2048 lds
    v_mfma_f32_16x16x32_bf16 v[176:179], a[240:243], v[220:223], v[176:179]
    s_waitcnt lgkmcnt(4)
    v_mfma_f32_16x16x32_bf16 v[184:187], a[248:251], v[224:227], v[168:171]
    ds_read_b128 v[216:219], v10 offset:2048
    v_mfma_f32_16x16x32_bf16 v[188:191], a[252:255], v[224:227], v[172:175]
    ds_read_b128 v[220:223], v11 offset:2048
    v_mfma_f32_16x16x32_bf16 v[196:199], a[252:255], v[228:231], v[180:183]
    v_mfma_f32_16x16x32_bf16 v[192:195], a[248:251], v[228:231], v[176:179]
    buffer_load_dwordx4 v2, s[8:11], s33 offen offset:3072 lds
    s_waitcnt lgkmcnt(4)
    v_mfma_f32_16x16x32_bf16 v[168:171], a[0:3], v[200:203], 0
    ds_read_b128 v[224:227], v10 offset:3072
    v_mfma_f32_16x16x32_bf16 v[172:175], a[4:7], v[200:203], 0
    ds_read_b128 v[228:231], v11 offset:3072
    v_mfma_f32_16x16x32_bf16 v[180:183], a[4:7], v[204:207], 0
    v_mfma_f32_16x16x32_bf16 v[176:179], a[0:3], v[204:207], 0
    s_waitcnt lgkmcnt(4)
    v_mfma_f32_16x16x32_bf16 v[168:171], a[8:11], v[208:211], v[168:171]
    ds_read_b128 v[200:203], v10 offset:8192
    buffer_load_dwordx4 v[36:39], v1, s[8:11], s34 offen offset:0
    v_mfma_f32_16x16x32_bf16 v[172:175], a[12:15], v[208:211], v[172:175]
    ds_read_b128 v[204:207], v11 offset:8192
    v_mfma_f32_16x16x32_bf16 v[180:183], a[12:15], v[212:215], v[180:183]
    v_mfma_f32_16x16x32_bf16 v[176:179], a[8:11], v[212:215], v[176:179]
    s_waitcnt lgkmcnt(4)
    v_mfma_f32_16x16x32_bf16 v[168:171], a[16:19], v[216:219], v[168:171]
    ds_read_b128 v[208:211], v10 offset:9216
    v_mfma_f32_16x16x32_bf16 v[172:175], a[20:23], v[216:219], v[172:175]
    ds_read_b128 v[212:215], v11 offset:9216
    buffer_load_dwordx4 v[40:43], v1, s[8:11], s34 offen offset:1024
    v_mfma_f32_16x16x32_bf16 v[180:183], a[20:23], v[220:223], v[180:183]
    v_mfma_f32_16x16x32_bf16 v[176:179], a[16:19], v[220:223], v[176:179]
    s_waitcnt lgkmcnt(4)
    v_mfma_f32_16x16x32_bf16 v[168:171], a[24:27], v[224:227], v[168:171]
    ds_read_b128 v[216:219], v10 offset:10240
    v_mfma_f32_16x16x32_bf16 v[172:175], a[28:31], v[224:227], v[172:175]
    ds_read_b128 v[220:223], v11 offset:10240
    v_mfma_f32_16x16x32_bf16 v[180:183], a[28:31], v[228:231], v[180:183]
    buffer_load_dwordx4 v[44:47], v1, s[8:11], s34 offen offset:2048
    v_mfma_f32_16x16x32_bf16 v[176:179], a[24:27], v[228:231], v[176:179]
    s_waitcnt lgkmcnt(4)
    v_mfma_f32_16x16x32_bf16 v[168:171], a[32:35], v[200:203], v[168:171]
    ds_read_b128 v[224:227], v10 offset:11264
    v_mfma_f32_16x16x32_bf16 v[172:175], a[36:39], v[200:203], v[172:175]
    ds_read_b128 v[228:231], v11 offset:11264
    v_mfma_f32_16x16x32_bf16 v[180:183], a[36:39], v[204:207], v[180:183]
    v_mfma_f32_16x16x32_bf16 v[176:179], a[32:35], v[204:207], v[176:179]
    buffer_load_dwordx4 v[48:51], v1, s[8:11], s34 offen offset:3072
    s_waitcnt lgkmcnt(4)
    v_mfma_f32_16x16x32_bf16 v[168:171], a[40:43], v[208:211], v[168:171]
    ds_read_b128 v[200:203], v10 offset:16384
    s_add_u32 s20, s20, 8
    v_mfma_f32_16x16x32_bf16 v[172:175], a[44:47], v[208:211], v[172:175]
    ds_read_b128 v[204:207], v11 offset:16384
    s_lshl1_add_u32 s63, s56, 51
    v_mfma_f32_16x16x32_bf16 v[180:183], a[44:47], v[212:215], v[180:183]
    s_min_u32 s20, s20, s63
    v_mov_b32 v18, s30
    v_mfma_f32_16x16x32_bf16 v[176:179], a[40:43], v[212:215], v[176:179]
    v_writelane_b32 v18, s20, 32
    s_waitcnt lgkmcnt(4)
    v_mfma_f32_16x16x32_bf16 v[168:171], a[48:51], v[216:219], v[168:171]
    ds_read_b128 v[208:211], v10 offset:17408
    s_cmp_gt_u32 s20, 25
    v_mfma_f32_16x16x32_bf16 v[172:175], a[52:55], v[216:219], v[172:175]
    ds_read_b128 v[212:215], v11 offset:17408
    s_cselect_b32 s63, 64, 0
    v_mfma_f32_16x16x32_bf16 v[180:183], a[52:55], v[220:223], v[180:183]
    v_writelane_b32 v18, 64, 33
    v_writelane_b32 v18, s63, 34
    v_mfma_f32_16x16x32_bf16 v[176:179], a[48:51], v[220:223], v[176:179]
    v_writelane_b32 v18, 64, 35
    s_waitcnt lgkmcnt(4)
    v_mfma_f32_16x16x32_bf16 v[168:171], a[56:59], v[224:227], v[168:171]
    ds_read_b128 v[216:219], v10 offset:18432
    v_writelane_b32 v18, s63, 36
    v_mfma_f32_16x16x32_bf16 v[172:175], a[60:63], v[224:227], v[172:175]
    ds_read_b128 v[220:223], v11 offset:18432
    v_mfma_f32_16x16x32_bf16 v[180:183], a[60:63], v[228:231], v[180:183]
    v_mfma_f32_16x16x32_bf16 v[176:179], a[56:59], v[228:231], v[176:179]
    s_waitcnt lgkmcnt(4)
    v_mfma_f32_16x16x32_bf16 v[168:171], a[64:67], v[200:203], v[168:171]
    ds_read_b128 v[224:227], v10 offset:19456
    v_mfma_f32_16x16x32_bf16 v[172:175], a[68:71], v[200:203], v[172:175]
    ds_read_b128 v[228:231], v11 offset:19456
    v_mfma_f32_16x16x32_bf16 v[180:183], a[68:71], v[204:207], v[180:183]
    v_mfma_f32_16x16x32_bf16 v[176:179], a[64:67], v[204:207], v[176:179]
    s_waitcnt lgkmcnt(4)
    v_mfma_f32_16x16x32_bf16 v[168:171], a[72:75], v[208:211], v[168:171]
    ds_read_b128 v[200:203], v10 offset:24576
    global_load_dword v19, v[16:17], off sc1
    v_mfma_f32_16x16x32_bf16 v[172:175], a[76:79], v[208:211], v[172:175]
    ds_read_b128 v[204:207], v11 offset:24576
    v_mfma_f32_16x16x32_bf16 v[180:183], a[76:79], v[212:215], v[180:183]
    v_mfma_f32_16x16x32_bf16 v[176:179], a[72:75], v[212:215], v[176:179]
    s_waitcnt lgkmcnt(4)
    v_mfma_f32_16x16x32_bf16 v[168:171], a[80:83], v[216:219], v[168:171]
    ds_read_b128 v[208:211], v10 offset:25600
    v_mfma_f32_16x16x32_bf16 v[172:175], a[84:87], v[216:219], v[172:175]
    ds_read_b128 v[212:215], v11 offset:25600
    v_mfma_f32_16x16x32_bf16 v[180:183], a[84:87], v[220:223], v[180:183]
    v_mfma_f32_16x16x32_bf16 v[176:179], a[80:83], v[220:223], v[176:179]
    s_waitcnt lgkmcnt(4)
    v_mfma_f32_16x16x32_bf16 v[168:171], a[88:91], v[224:227], v[168:171]
    ds_read_b128 v[216:219], v10 offset:26624
    v_mfma_f32_16x16x32_bf16 v[172:175], a[92:95], v[224:227], v[172:175]
    ds_read_b128 v[220:223], v11 offset:26624
    v_mfma_f32_16x16x32_bf16 v[180:183], a[92:95], v[228:231], v[180:183]
    v_mfma_f32_16x16x32_bf16 v[176:179], a[88:91], v[228:231], v[176:179]
    s_waitcnt lgkmcnt(4)
    v_mfma_f32_16x16x32_bf16 v[168:171], a[96:99], v[200:203], v[168:171]
    ds_read_b128 v[224:227], v10 offset:27648
    v_mfma_f32_16x16x32_bf16 v[172:175], a[100:103], v[200:203], v[172:175]
    ds_read_b128 v[228:231], v11 offset:27648
    v_mfma_f32_16x16x32_bf16 v[180:183], a[100:103], v[204:207], v[180:183]
    v_mfma_f32_16x16x32_bf16 v[176:179], a[96:99], v[204:207], v[176:179]
    s_barrier
    s_waitcnt lgkmcnt(4)
    v_mfma_f32_16x16x32_bf16 v[168:171], a[104:107], v[208:211], v[168:171]
    ds_read_b128 v[200:203], v10 offset:32768
    v_mfma_f32_16x16x32_bf16 v[172:175], a[108:111], v[208:211], v[172:175]
    ds_read_b128 v[204:207], v11 offset:32768
    v_mfma_f32_16x16x32_bf16 v[180:183], a[108:111], v[212:215], v[180:183]
    v_mfma_f32_16x16x32_bf16 v[176:179], a[104:107], v[212:215], v[176:179]
    s_waitcnt lgkmcnt(4)
    v_mfma_f32_16x16x32_bf16 v[168:171], a[112:115], v[216:219], v[168:171]
    ds_read_b128 v[208:211], v10 offset:33792
    v_mfma_f32_16x16x32_bf16 v[172:175], a[116:119], v[216:219], v[172:175]
    ds_read_b128 v[212:215], v11 offset:33792
    v_mfma_f32_16x16x32_bf16 v[180:183], a[116:119], v[220:223], v[180:183]
    v_mfma_f32_16x16x32_bf16 v[176:179], a[112:115], v[220:223], v[176:179]
    s_waitcnt lgkmcnt(4)
    v_mfma_f32_16x16x32_bf16 v[168:171], a[120:123], v[224:227], v[168:171]
    ds_read_b128 v[216:219], v10 offset:34816
    v_mfma_f32_16x16x32_bf16 v[172:175], a[124:127], v[224:227], v[172:175]
    ds_read_b128 v[220:223], v11 offset:34816
    v_mfma_f32_16x16x32_bf16 v[180:183], a[124:127], v[228:231], v[180:183]
    v_mfma_f32_16x16x32_bf16 v[176:179], a[120:123], v[228:231], v[176:179]
    s_waitcnt lgkmcnt(4)
    v_mfma_f32_16x16x32_bf16 v[168:171], a[128:131], v[200:203], v[168:171]
    ds_read_b128 v[224:227], v10 offset:35840
    v_mfma_f32_16x16x32_bf16 v[172:175], a[132:135], v[200:203], v[172:175]
    ds_read_b128 v[228:231], v11 offset:35840
    v_mfma_f32_16x16x32_bf16 v[180:183], a[132:135], v[204:207], v[180:183]
    v_mfma_f32_16x16x32_bf16 v[176:179], a[128:131], v[204:207], v[176:179]
    s_waitcnt lgkmcnt(4)
    v_mfma_f32_16x16x32_bf16 v[168:171], a[136:139], v[208:211], v[168:171]
    ds_read_b128 v[200:203], v10 offset:40960
    s_waitcnt vmcnt(0)
    v_cmp_lt_u32 vcc, v19, v18
    v_mfma_f32_16x16x32_bf16 v[172:175], a[140:143], v[208:211], v[172:175]
    ds_read_b128 v[204:207], v11 offset:40960
    v_mfma_f32_16x16x32_bf16 v[180:183], a[140:143], v[212:215], v[180:183]
    v_mfma_f32_16x16x32_bf16 v[176:179], a[136:139], v[212:215], v[176:179]
    s_cbranch_vccnz seg_pslow
seg_pok:
    s_waitcnt lgkmcnt(4)
    v_mfma_f32_16x16x32_bf16 v[168:171], a[144:147], v[216:219], v[168:171]
    ds_read_b128 v[208:211], v10 offset:41984
    buffer_load_dwordx4 v[52:55], v13, s[8:11], s35 offen offset:0 sc1
    v_mfma_f32_16x16x32_bf16 v[172:175], a[148:151], v[216:219], v[172:175]
    ds_read_b128 v[212:215], v11 offset:41984
    v_mfma_f32_16x16x32_bf16 v[180:183], a[148:151], v[220:223], v[180:183]
    buffer_load_dwordx4 v[56:59], v13, s[8:11], s35 offen offset:512 sc1
    v_mfma_f32_16x16x32_bf16 v[176:179], a[144:147], v[220:223], v[176:179]
    s_waitcnt lgkmcnt(4)
    v_mfma_f32_16x16x32_bf16 v[168:171], a[152:155], v[224:227], v[168:171]
    ds_read_b128 v[216:219], v10 offset:43008
    buffer_load_dwordx4 v[60:63], v13, s[8:11], s35 offen offset:1024 sc1
    v_mfma_f32_16x16x32_bf16 v[172:175], a[156:159], v[224:227], v[172:175]
    ds_read_b128 v[220:223], v11 offset:43008
    v_mfma_f32_16x16x32_bf16 v[180:183], a[156:159], v[228:231], v[180:183]
    buffer_load_dwordx4 v[64:67], v13, s[8:11], s35 offen offset:1536 sc1
    v_mfma_f32_16x16x32_bf16 v[176:179], a[152:155], v[228:231], v[176:179]
    s_waitcnt lgkmcnt(4)
    v_mfma_f32_16x16x32_bf16 v[168:171], a[160:163], v[200:203], v[168:171]
    ds_read_b128 v[224:227], v10 offset:44032
    buffer_load_dwordx2 v[68:69], v14, s[8:11], s35 offen offset:2048 sc1
    v_mfma_f32_16x16x32_bf16 v[172:175], a[164:167], v[200:203], v[172:175]
    ds_read_b128 v[228:231], v11 offset:44032
    v_mfma_f32_16x16x32_bf16 v[180:183], a[164:167], v[204:207], v[180:183]
    buffer_load_dwordx2 v[70:71], v14, s[8:11], s35 offen offset:2560 sc1
    v_mfma_f32_16x16x32_bf16 v[176:179], a[160:163], v[204:207], v[176:179]
    s_waitcnt lgkmcnt(4)
    v_mfma_f32_16x16x32_bf16 v[168:171], a[168:171], v[208:211], v[168:171]
    ds_read_b128 v[200:203], v10 offset:49152
    buffer_load_dwordx2 v[72:73], v14, s[8:11], s35 offen offset:3072 sc1
    v_mfma_f32_16x16x32_bf16 v[172:175], a[172:175], v[208:211], v[172:175]
    ds_read_b128 v[204:207], v11 offset:49152
    v_mfma_f32_16x16x32_bf16 v[180:183], a[172:175], v[212:215], v[180:183]
    buffer_load_dwordx2 v[74:75], v14, s[8:11], s35 offen offset:3584 sc1
    v_mfma_f32_16x16x32_bf16 v[176:179], a[168:171], v[212:215], v[176:179]
    s_waitcnt lgkmcnt(4)
    v_mfma_f32_16x16x32_bf16 v[168:171], a[176:179], v[216:219], v[168:171]
    ds_read_b128 v[208:211], v10 offset:50176
    s_add_u32 s63, s27, 0x0
    v_mfma_f32_16x16x32_bf16 v[172:175], a[180:183], v[216:219], v[172:175]
    ds_read_b128 v[212:215], v11 offset:50176
    v_mfma_f32_16x16x32_bf16 v[180:183], a[180:183], v[220:223], v[180:183]
    buffer_load_dwordx4 v[104:107], v23, s[8:11], s63 offen offset:0 sc1
    v_mfma_f32_16x16x32_bf16 v[176:179], a[176:179], v[220:223], v[176:179]
    s_waitcnt lgkmcnt(4)
    v_mfma_f32_16x16x32_bf16 v[168:171], a[184:187], v[224:227], v[168:171]
    ds_read_b128 v[216:219], v10 offset:51200
    buffer_load_dwordx4 v[108:111], v23, s[8:11], s63 offen offset:1024 sc1
    v_mfma_f32_16x16x32_bf16 v[172:175], a[188:191], v[224:227], v[172:175]
    ds_read_b128 v[220:223], v11 offset:51200
    v_mfma_f32_16x16x32_bf16 v[180:183], a[188:191], v[228:231], v[180:183]
    buffer_load_dwordx4 v[112:115], v23, s[8:11], s63 offen offset:2048 sc1
    v_mfma_f32_16x16x32_bf16 v[176:179], a[184:187], v[228:231], v[176:179]
    s_waitcnt lgkmcnt(4)
    v_mfma_f32_16x16x32_bf16 v[168:171], a[192:195], v[200:203], v[168:171]
    ds_read_b128 v[224:227], v10 offset:52224
    s_add_u32 s63, s27, 0x80000
    v_mfma_f32_16x16x32_bf16 v[172:175], a[196:199], v[200:203], v[172:175]
    ds_read_b128 v[228:231], v11 offset:52224
    v_mfma_f32_16x16x32_bf16 v[180:183], a[196:199], v[204:207], v[180:183]
    buffer_load_dwordx4 v[116:119], v23, s[8:11], s63 offen offset:0 sc1
    v_mfma_f32_16x16x32_bf16 v[176:179], a[192:195], v[204:207], v[176:179]
    s_waitcnt lgkmcnt(4)
    v_mfma_f32_16x16x32_bf16 v[168:171], a[200:203], v[208:211], v[168:171]
    ds_read_b128 v[200:203], v10 offset:57344
    buffer_load_dwordx4 v[120:123], v23, s[8:11], s63 offen offset:1024 sc1
    v_mfma_f32_16x16x32_bf16 v[172:175], a[204:207], v[208:211], v[172:175]
    ds_read_b128 v[204:207], v11 offset:57344
    v_mfma_f32_16x16x32_bf16 v[180:183], a[204:207], v[212:215], v[180:183]
    buffer_load_dwordx4 v[124:127], v23, s[8:11], s63 offen offset:2048 sc1
    v_mfma_f32_16x16x32_bf16 v[176:179], a[200:203], v[212:215], v[176:179]
    s_waitcnt lgkmcnt(4)
    v_mfma_f32_16x16x32_bf16 v[168:171], a[208:211], v[216:219], v[168:171]
    ds_read_b128 v[208:211], v10 offset:58368
    buffer_store_dwordx4 v[184:187], v20, s[8:11], s25 offen
    v_mfma_f32_16x16x32_bf16 v[172:175], a[212:215], v[216:219], v[172:175]
    ds_read_b128 v[212:215], v11 offset:58368
    v_mfma_f32_16x16x32_bf16 v[180:183], a[212:215], v[220:223], v[180:183]
    buffer_store_dwordx4 v[188:191], v21, s[8:11], s25 offen
    v_mfma_f32_16x16x32_bf16 v[176:179], a[208:211], v[220:223], v[176:179]
    s_waitcnt lgkmcnt(4)
    v_mfma_f32_16x16x32_bf16 v[168:171], a[216:219], v[224:227], v[168:171]
    ds_read_b128 v[216:219], v10 offset:59392
    buffer_store_dwordx4 v[192:195], v22, s[8:11], s25 offen
    v_mfma_f32_16x16x32_bf16 v[172:175], a[220:223], v[224:227], v[172:175]
    ds_read_b128 v[220:223], v11 offset:59392
    s_add_u32 s26, s25, 0x80000
    v_mfma_f32_16x16x32_bf16 v[180:183], a[220:223], v[228:231], v[180:183]
    s_xor_b32 s25, s25, 0x100000
    s_xor_b32 s27, s27, 0x100000
    v_mfma_f32_16x16x32_bf16 v[176:179], a[216:219], v[228:231], v[176:179]
    s_xor_b32 s24, s24, 0x80000
    s_waitcnt lgkmcnt(4)
    v_mfma_f32_16x16x32_bf16 v[168:171], a[224:227], v[200:203], v[168:171]
    ds_read_b128 v[224:227], v10 offset:60416
    s_xor_b32 s23, s23, 0x80000
    v_mfma_f32_16x16x32_bf16 v[172:175], a[228:231], v[200:203], v[172:175]
    ds_read_b128 v[228:231], v11 offset:60416
    s_cmp_lt_u32 s30, 8
    v_mfma_f32_16x16x32_bf16 v[180:183], a[228:231], v[204:207], v[180:183]
    v_mfma_f32_16x16x32_bf16 v[176:179], a[224:227], v[204:207], v[176:179]
    s_waitcnt lgkmcnt(4)
    v_mfma_f32_16x16x32_bf16 v[168:171], a[232:235], v[208:211], v[168:171]
    v_mfma_f32_16x16x32_bf16 v[172:175], a[236:239], v[208:211], v[172:175]
    v_mfma_f32_16x16x32_bf16 v[180:183], a[236:239], v[212:215], v[180:183]
    v_mfma_f32_16x16x32_bf16 v[176:179], a[232:235], v[212:215], v[176:179]
    s_waitcnt lgkmcnt(2)
    v_mfma_f32_16x16x32_bf16 v[168:171], a[240:243], v[216:219], v[168:171]
    v_mfma_f32_16x16x32_bf16 v[172:175], a[244:247], v[216:219], v[172:175]
    v_mfma_f32_16x16x32_bf16 v[180:183], a[244:247], v[220:223], v[180:183]
    v_mfma_f32_16x16x32_bf16 v[176:179], a[240:243], v[220:223], v[176:179]
    s_waitcnt lgkmcnt(0)
    v_mfma_f32_16x16x32_bf16 v[136:139], a[248:251], v[224:227], v[168:171]
    v_mfma_f32_16x16x32_bf16 v[140:143], a[252:255], v[224:227], v[172:175]
    v_mfma_f32_16x16x32_bf16 v[148:151], a[252:255], v[228:231], v[180:183]
    v_mfma_f32_16x16x32_bf16 v[144:147], a[248:251], v[228:231], v[176:179]
    s_cbranch_scc1 seg_p
    s_nop 7
    buffer_store_dwordx4 v[136:139], v20, s[8:11], s26 offen
    buffer_store_dwordx4 v[140:143], v21, s[8:11], s26 offen
    buffer_store_dwordx4 v[144:147], v22, s[8:11], s26 offen
    s_waitcnt vmcnt(3)
    v_pk_add_f32 v[104:105], v[104:105], v[232:233]
    v_pk_add_f32 v[106:107], v[106:107], v[234:235]
    v_pk_add_f32 v[108:109], v[108:109], v[112:113]
    v_pk_add_f32 v[110:111], v[110:111], v[114:115]
    v_pk_add_f32 v[104:105], v[104:105], v[108:109]
    v_pk_add_f32 v[106:107], v[106:107], v[110:111]
    v_cvt_pk_bf16_f32 v104, 0, v104
    v_cvt_pk_bf16_f32 v105, 0, v105
    v_cvt_pk_bf16_f32 v106, 0, v106
    v_cvt_pk_bf16_f32 v107, 0, v107
    s_add_u32 s62, s29, 0x0
    buffer_store_dwordx4 v[104:107], v15, s[16:19], s62 offen
    v_pk_add_f32 v[116:117], v[116:117], v[236:237]
    v_pk_add_f32 v[118:119], v[118:119], v[238:239]
    v_pk_add_f32 v[120:121], v[120:121], v[124:125]
    v_pk_add_f32 v[122:123], v[122:123], v[126:127]
    v_pk_add_f32 v[116:117], v[116:117], v[120:121]
    v_pk_add_f32 v[118:119], v[118:119], v[122:123]
    v_cvt_pk_bf16_f32 v116, 0, v116
    v_cvt_pk_bf16_f32 v117, 0, v117
    v_cvt_pk_bf16_f32 v118, 0, v118
    v_cvt_pk_bf16_f32 v119, 0, v119
    s_add_u32 s62, s29, 0x40000
    buffer_store_dwordx4 v[116:119], v15, s[16:19], s62 offen
    s_add_u32 s29, s29, 0x200000
    s_waitcnt vmcnt(0)
    s_barrier
    s_add_u32 s30, s30, 1
    v_mov_b32 v102, s30
    buffer_store_dword v102, v240, s[8:11], s31 offen
    v_mov_b32 v18, s30
    v_writelane_b32 v18, s20, 32
    s_cmp_gt_u32 s20, 25
    s_cselect_b32 s63, 64, 0
    v_writelane_b32 v18, 64, 33
    v_writelane_b32 v18, s63, 34
    v_writelane_b32 v18, 64, 35
    v_writelane_b32 v18, s63, 36
L_sp_57:
    global_load_dword v19, v[16:17], off sc1
    s_add_u32 s38, s38, 1
    s_cmp_gt_u32 s38, 0x200000
    s_cbranch_scc1 chain_kernel_wabort
    s_waitcnt vmcnt(0)
    v_cmp_lt_u32 vcc, v19, v18
    s_cbranch_vccz L_spok_58
    s_branch L_sp_57
L_spok_58:
    s_add_u32 s63, s27, 0x0
    buffer_load_dwordx4 v[104:107], v23, s[8:11], s63 offen offset:0 sc1
    buffer_load_dwordx4 v[108:111], v23, s[8:11], s63 offen offset:1024 sc1
    buffer_load_dwordx4 v[112:115], v23, s[8:11], s63 offen offset:2048 sc1
    s_add_u32 s63, s27, 0x80000
    buffer_load_dwordx4 v[116:119], v23, s[8:11], s63 offen offset:0 sc1
    buffer_load_dwordx4 v[120:123], v23, s[8:11], s63 offen offset:1024 sc1
    buffer_load_dwordx4 v[124:127], v23, s[8:11], s63 offen offset:2048 sc1
    s_waitcnt vmcnt(0)
    v_pk_add_f32 v[104:105], v[104:105], v[196:197]
    v_pk_add_f32 v[106:107], v[106:107], v[198:199]
    v_pk_add_f32 v[108:109], v[108:109], v[112:113]
    v_pk_add_f32 v[110:111], v[110:111], v[114:115]
    v_pk_add_f32 v[104:105], v[104:105], v[108:109]
    v_pk_add_f32 v[106:107], v[106:107], v[110:111]
    v_cvt_pk_bf16_f32 v104, 0, v104
    v_cvt_pk_bf16_f32 v105, 0, v105
    v_cvt_pk_bf16_f32 v106, 0, v106
    v_cvt_pk_bf16_f32 v107, 0, v107
    s_add_u32 s62, s29, 0x0
    buffer_store_dwordx4 v[104:107], v15, s[16:19], s62 offen
    v_pk_add_f32 v[116:117], v[116:117], v[148:149]
    v_pk_add_f32 v[118:119], v[118:119], v[150:151]
    v_pk_add_f32 v[120:121], v[120:121], v[124:125]
    v_pk_add_f32 v[122:123], v[122:123], v[126:127]
    v_pk_add_f32 v[116:117], v[116:117], v[120:121]
    v_pk_add_f32 v[118:119], v[118:119], v[122:123]
    v_cvt_pk_bf16_f32 v116, 0, v116
    v_cvt_pk_bf16_f32 v117, 0, v117
    v_cvt_pk_bf16_f32 v118, 0, v118
    v_cvt_pk_bf16_f32 v119, 0, v119
    s_add_u32 s62, s29, 0x40000
    buffer_store_dwordx4 v[116:119], v15, s[16:19], s62 offen
    s_cmp_ge_u32 s58, 2
    s_cselect_b32 s60, 0x8000000, 0
    s_and_b32 s24, s24, 0xfff7ffff
    s_add_u32 s24, s24, s60
    s_and_b32 s23, s23, 0xfff7ffff
    s_mov_b32 s27, s25
    s_add_u32 s46, s56, 56
seg_t:
    s_min_u32 s20, s46, 62
    s_lshl_b32 s61, s46, 12
    s_and_b32 s61, s61, 0x2000
    s_xor_b32 s61, s61, s44
    s_lshl_b32 s62, s46, 20
    s_add_u32 s61, s61, s62
    s_and_b32 s62, s58, 1
    s_lshl_b32 s62, s62, 14
    s_add_u32 s33, s61, s62
    s_lshr_b32 s62, s62, 2
    s_xor_b32 s61, s61, 0x2000
    s_add_u32 s34, s61, s62
    s_lshl_b32 s61, s46, 10
    s_and_b32 s61, s61, 0x2000
    s_xor_b32 s61, s61, s45
    s_lshl_b32 s62, s46, 18
    s_add_u32 s35, s61, s62
    s_add_u32 m0, s37, 0
    s_nop 0
    buffer_load_dwordx4 v1, s[8:11], s33 offen offset:0 lds
    buffer_load_dwordx4 v1, s[8:11], s33 offen offset:1024 lds
    buffer_load_dwordx4 v1, s[8:11], s33 offen offset:2048 lds
    buffer_load_dwordx4 v1, s[8:11], s33 offen offset:3072 lds
    s_add_u32 m0, s37, 4096
    s_nop 0
    buffer_load_dwordx4 v2, s[8:11], s33 offen offset:0 lds
    buffer_load_dwordx4 v2, s[8:11], s33 offen offset:1024 lds
    buffer_load_dwordx4 v2, s[8:11], s33 offen offset:2048 lds
    buffer_load_dwordx4 v2, s[8:11], s33 offen offset:3072 lds
    buffer_load_dwordx4 v[36:39], v1, s[8:11], s34 offen offset:0
    buffer_load_dwordx4 v[40:43], v1, s[8:11], s34 offen offset:1024
    buffer_load_dwordx4 v[44:47], v1, s[8:11], s34 offen offset:2048
    buffer_load_dwordx4 v[48:51], v1, s[8:11], s34 offen offset:3072
    s_add_u32 s20, s20, 2
    v_mov_b32 v18, s30
    v_writelane_b32 v18, s20, 32
    s_cmp_gt_u32 s20, 25
    s_cselect_b32 s63, 64, 0
    v_writelane_b32 v18, 64, 33
    v_writelane_b32 v18, s63, 34
    v_writelane_b32 v18, 64, 35
    v_writelane_b32 v18, s63, 36
L_sp_59:
    global_load_dword v19, v[16:17], off sc1
    s_add_u32 s38, s38, 1
    s_cmp_gt_u32 s38, 0x200000
    s_cbranch_scc1 chain_kernel_wabort
    s_waitcnt vmcnt(0)
    v_cmp_lt_u32 vcc, v19, v18
    s_cbranch_vccz L_spok_60
    s_sleep 1
    s_branch L_sp_59
L_spok_60:
L_tm_61:
    buffer_load_dwordx4 v[52:55], v13, s[8:11], s35 offen offset:0 sc1
    buffer_load_dwordx4 v[56:59], v13, s[8:11], s35 offen offset:512 sc1
    buffer_load_dwordx4 v[60:63], v13, s[8:11], s35 offen offset:1024 sc1
    buffer_load_dwordx4 v[64:67], v13, s[8:11], s35 offen offset:1536 sc1
    buffer_load_dwordx2 v[68:69], v14, s[8:11], s35 offen offset:2048 sc1
    buffer_load_dwordx2 v[70:71], v14, s[8:11], s35 offen offset:2560 sc1
    buffer_load_dwordx2 v[72:73], v14, s[8:11], s35 offen offset:3072 sc1
    buffer_load_dwordx2 v[74:75], v14, s[8:11], s35 offen offset:3584 sc1
    s_add_u32 s38, s38, 1
    s_cmp_gt_u32 s38, 0x200000
    s_cbranch_scc1 chain_kernel_wabort
    s_waitcnt vmcnt(0)
    v_max_u32 v96, v52, v53
    v_max3_u32 v96, v96, v54, v55
    v_max3_u32 v96, v96, v56, v57
    v_max3_u32 v96, v96, v58, v59
    v_max3_u32 v96, v96, v60, v61
    v_max3_u32 v96, v96, v62, v63
    v_max3_u32 v96, v96, v64, v65
    v_max3_u32 v96, v96, v66, v67
    v_max3_u32 v96, v96, v68, v69
    v_max3_u32 v96, v96, v70, v71
    v_max3_u32 v96, v96, v72, v73
    v_max3_u32 v96, v96, v74, v75
    v_cmp_eq_u32 vcc, -1, v96
    s_cbranch_vccnz L_tm_61
    s_barrier
    s_call_b64 s[54:55], seg_att
    s_waitcnt vmcnt(0)
    s_barrier
    s_add_u32 s30, s30, 1
    v_mov_b32 v102, s30
    buffer_store_dword v102, v240, s[8:11], s31 offen
    v_mov_b32 v18, s30
    v_writelane_b32 v18, s20, 32
    s_cmp_gt_u32 s20, 25
    s_cselect_b32 s63, 64, 0
    v_writelane_b32 v18, 64, 33
    v_writelane_b32 v18, s63, 34
    v_writelane_b32 v18, 64, 35
    v_writelane_b32 v18, s63, 36
L_sp_62:
    global_load_dword v19, v[16:17], off sc1
    s_add_u32 s38, s38, 1
    s_cmp_gt_u32 s38, 0x200000
    s_cbranch_scc1 chain_kernel_wabort
    s_waitcnt vmcnt(0)
    v_cmp_lt_u32 vcc, v19, v18
    s_cbranch_vccz L_spok_63
    s_branch L_sp_62
L_spok_63:
    s_add_u32 m0, s36, 0
    s_add_u32 s63, s23, 0x0
    buffer_load_dwordx4 v1, s[8:11], s63 offen offset:0 sc1 lds
    buffer_load_dwordx4 v1, s[8:11], s63 offen offset:1024 sc1 lds
    buffer_load_dwordx4 v1, s[8:11], s63 offen offset:2048 sc1 lds
    buffer_load_dwordx4 v1, s[8:11], s63 offen offset:3072 sc1 lds
    s_add_u32 m0, s36, 4096
    s_nop 0
    buffer_load_dwordx4 v2, s[8:11], s63 offen offset:0 sc1 lds
    buffer_load_dwordx4 v2, s[8:11], s63 offen offset:1024 sc1 lds
    buffer_load_dwordx4 v2, s[8:11], s63 offen offset:2048 sc1 lds
    buffer_load_dwordx4 v2, s[8:11], s63 offen offset:3072 sc1 lds
    s_add_u32 m0, s36, 32768
    s_add_u32 s63, s23, 0x8000
    buffer_load_dwordx4 v1, s[8:11], s63 offen offset:0 sc1 lds
    buffer_load_dwordx4 v1, s[8:11], s63 offen offset:1024 sc1 lds
    buffer_load_dwordx4 v1, s[8:11], s63 offen offset:2048 sc1 lds
    buffer_load_dwordx4 v1, s[8:11], s63 offen offset:3072 sc1 lds
    s_add_u32 m0, s36, 36864
    s_nop 0
    buffer_load_dwordx4 v2, s[8:11], s63 offen offset:0 sc1 lds
    buffer_load_dwordx4 v2, s[8:11], s63 offen offset:1024 sc1 lds
    buffer_load_dwordx4 v2, s[8:11], s63 offen offset:2048 sc1 lds
    buffer_load_dwordx4 v2, s[8:11], s63 offen offset:3072 sc1 lds
    s_waitcnt vmcnt(8)
    s_barrier
    ds_read_b128 v[200:203], v4 offset:0
    ds_read_b128 v[204:207], v5 offset:0
    ds_read_b128 v[208:211], v4 offset:1024
    ds_read_b128 v[212:215], v5 offset:1024
    ds_read_b128 v[216:219], v4 offset:2048
    ds_read_b128 v[220:223], v5 offset:2048
    s_waitcnt lgkmcnt(4)
    v_mfma_f32_16x16x32_bf16 v[168:171], a[0:3], v[200:203], 0
    ds_read_b128 v[224:227], v4 offset:3072
    v_mfma_f32_16x16x32_bf16 v[172:175], a[4:7], v[200:203], 0
    ds_read_b128 v[228:231], v5 offset:3072
    v_mfma_f32_16x16x32_bf16 v[180:183], a[4:7], v[204:207], 0
    v_mfma_f32_16x16x32_bf16 v[176:179], a[0:3], v[204:207], 0
    s_waitcnt lgkmcnt(4)
    v_mfma_f32_16x16x32_bf16 v[168:171], a[8:11], v[208:211], v[168:171]
    ds_read_b128 v[200:203], v4 offset:8192
    v_mfma_f32_16x16x32_bf16 v[172:175], a[12:15], v[208:211], v[172:175]
    ds_read_b128 v[204:207], v5 offset:8192
    v_mfma_f32_16x16x32_bf16 v[180:183], a[12:15], v[212:215], v[180:183]
    v_mfma_f32_16x16x32_bf16 v[176:179], a[8:11], v[212:215], v[176:179]
    s_waitcnt lgkmcnt(4)
    v_mfma_f32_16x16x32_bf16 v[168:171], a[16:19], v[216:219], v[168:171]
    ds_read_b128 v[208:211], v4 offset:9216
    v_mfma_f32_16x16x32_bf16 v[172:175], a[20:23], v[216:219], v[172:175]
    ds_read_b128 v[212:215], v5 offset:9216
    v_mfma_f32_16x16x32_bf16 v[180:183], a[20:23], v[220:223], v[180:183]
    v_mfma_f32_16x16x32_bf16 v[176:179], a[16:19], v[220:223], v[176:179]
    s_waitcnt lgkmcnt(4)
    v_mfma_f32_16x16x32_bf16 v[168:171], a[24:27], v[224:227], v[168:171]
    ds_read_b128 v[216:219], v4 offset:10240
    v_mfma_f32_16x16x32_bf16 v[172:175], a[28:31], v[224:227], v[172:175]
    ds_read_b128 v[220:223], v5 offset:10240
    v_mfma_f32_16x16x32_bf16 v[180:183], a[28:31], v[228:231], v[180:183]
    v_mfma_f32_16x16x32_bf16 v[176:179], a[24:27], v[228:231], v[176:179]
    s_waitcnt lgkmcnt(4)
    v_mfma_f32_16x16x32_bf16 v[168:171], a[32:35], v[200:203], v[168:171]
    ds_read_b128 v[224:227], v4 offset:11264
    v_mfma_f32_16x16x32_bf16 v[172:175], a[36:39], v[200:203], v[172:175]
    ds_read_b128 v[228:231], v5 offset:11264
    v_mfma_f32_16x16x32_bf16 v[180:183], a[36:39], v[204:207], v[180:183]
    v_mfma_f32_16x16x32_bf16 v[176:179], a[32:35], v[204:207], v[176:179]
    s_waitcnt lgkmcnt(4)
    v_mfma_f32_16x16x32_bf16 v[168:171], a[40:43], v[208:211], v[168:171]
    ds_read_b128 v[200:203], v4 offset:16384
    v_mfma_f32_16x16x32_bf16 v[172:175], a[44:47], v[208:211], v[172:175]
    ds_read_b128 v[204:207], v5 offset:16384
    v_mfma_f32_16x16x32_bf16 v[180:183], a[44:47], v[212:215], v[180:183]
    v_mfma_f32_16x16x32_bf16 v[176:179], a[40:43], v[212:215], v[176:179]
    s_waitcnt lgkmcnt(4)
    v_mfma_f32_16x16x32_bf16 v[168:171], a[48:51], v[216:219], v[168:171]
    ds_read_b128 v[208:211], v4 offset:17408
    v_mfma_f32_16x16x32_bf16 v[172:175], a[52:55], v[216:219], v[172:175]
    ds_read_b128 v[212:215], v5 offset:17408
    v_mfma_f32_16x16x32_bf16 v[180:183], a[52:55], v[220:223], v[180:183]
    v_mfma_f32_16x16x32_bf16 v[176:179], a[48:51], v[220:223], v[176:179]
    s_waitcnt lgkmcnt(4)
    v_mfma_f32_16x16x32_bf16 v[168:171], a[56:59], v[224:227], v[168:171]
    ds_read_b128 v[216:219], v4 offset:18432
    v_mfma_f32_16x16x32_bf16 v[172:175], a[60:63], v[224:227], v[172:175]
    ds_read_b128 v[220:223], v5 offset:18432
    v_mfma_f32_16x16x32_bf16 v[180:183], a[60:63], v[228:231], v[180:183]
    v_mfma_f32_16x16x32_bf16 v[176:179], a[56:59], v[228:231], v[176:179]
    s_waitcnt lgkmcnt(4)
    v_mfma_f32_16x16x32_bf16 v[168:171], a[64:67], v[200:203], v[168:171]
    ds_read_b128 v[224:227], v4 offset:19456
    v_mfma_f32_16x16x32_bf16 v[172:175], a[68:71], v[200:203], v[172:175]
    ds_read_b128 v[228:231], v5 offset:19456
    v_mfma_f32_16x16x32_bf16 v[180:183], a[68:71], v[204:207], v[180:183]
    v_mfma_f32_16x16x32_bf16 v[176:179], a[64:67], v[204:207], v[176:179]
    s_waitcnt lgkmcnt(4)
    v_mfma_f32_16x16x32_bf16 v[168:171], a[72:75], v[208:211], v[168:171]
    ds_read_b128 v[200:203], v4 offset:24576
    v_mfma_f32_16x16x32_bf16 v[172:175], a[76:79], v[208:211], v[172:175]
    ds_read_b128 v[204:207], v5 offset:24576
    v_mfma_f32_16x16x32_bf16 v[180:183], a[76:79], v[212:215], v[180:183]
    v_mfma_f32_16x16x32_bf16 v[176:179], a[72:75], v[212:215], v[176:179]
    s_waitcnt lgkmcnt(4)
    v_mfma_f32_16x16x32_bf16 v[168:171], a[80:83], v[216:219], v[168:171]
    ds_read_b128 v[208:211], v4 offset:25600
    v_mfma_f32_16x16x32_bf16 v[172:175], a[84:87], v[216:219], v[172:175]
    ds_read_b128 v[212:215], v5 offset:25600
    v_mfma_f32_16x16x32_bf16 v[180:183], a[84:87], v[220:223], v[180:183]
    v_mfma_f32_16x16x32_bf16 v[176:179], a[80:83], v[220:223], v[176:179]
    s_waitcnt lgkmcnt(4)
    v_mfma_f32_16x16x32_bf16 v[168:171], a[88:91], v[224:227], v[168:171]
    ds_read_b128 v[216:219], v4 offset:26624
    v_mfma_f32_16x16x32_bf16 v[172:175], a[92:95], v[224:227], v[172:175]
    ds_read_b128 v[220:223], v5 offset:26624
    v_mfma_f32_16x16x32_bf16 v[180:183], a[92:95], v[228:231], v[180:183]
    v_mfma_f32_16x16x32_bf16 v[176:179], a[88:91], v[228:231], v[176:179]
    s_waitcnt lgkmcnt(4)
    v_mfma_f32_16x16x32_bf16 v[168:171], a[96:99], v[200:203], v[168:171]
    ds_read_b128 v[224:227], v4 offset:27648
    v_mfma_f32_16x16x32_bf16 v[172:175], a[100:103], v[200:203], v[172:175]
    ds_read_b128 v[228:231], v5 offset:27648
    v_mfma_f32_16x16x32_bf16 v[180:183], a[100:103], v[204:207], v[180:183]
    v_mfma_f32_16x16x32_bf16 v[176:179], a[96:99], v[204:207], v[176:179]
    s_waitcnt vmcnt(0)
    s_barrier
    s_waitcnt lgkmcnt(4)
    v_mfma_f32_16x16x32_bf16 v[168:171], a[104:107], v[208:211], v[168:171]
    ds_read_b128 v[200:203], v4 offset:32768
    v_mfma_f32_16x16x32_bf16 v[172:175], a[108:111], v[208:211], v[172:175]
    ds_read_b128 v[204:207], v5 offset:32768
    v_mfma_f32_16x16x32_bf16 v[180:183], a[108:111], v[212:215], v[180:183]
    v_mfma_f32_16x16x32_bf16 v[176:179], a[104:107], v[212:215], v[176:179]
    s_waitcnt lgkmcnt(4)
    v_mfma_f32_16x16x32_bf16 v[168:171], a[112:115], v[216:219], v[168:171]
    ds_read_b128 v[208:211], v4 offset:33792
    v_mfma_f32_16x16x32_bf16 v[172:175], a[116:119], v[216:219], v[172:175]
    ds_read_b128 v[212:215], v5 offset:33792
    v_mfma_f32_16x16x32_bf16 v[180:183], a[116:119], v[220:223], v[180:183]
    v_mfma_f32_16x16x32_bf16 v[176:179], a[112:115], v[220:223], v[176:179]
    s_waitcnt lgkmcnt(4)
    v_mfma_f32_16x16x32_bf16 v[168:171], a[120:123], v[224:227], v[168:171]
    ds_read_b128 v[216:219], v4 offset:34816
    v_mfma_f32_16x16x32_bf16 v[172:175], a[124:127], v[224:227], v[172:175]
    ds_read_b128 v[220:223], v5 offset:34816
    v_mfma_f32_16x16x32_bf16 v[180:183], a[124:127], v[228:231], v[180:183]
    v_mfma_f32_16x16x32_bf16 v[176:179], a[120:123], v[228:231], v[176:179]
    s_waitcnt lgkmcnt(4)
    v_mfma_f32_16x16x32_bf16 v[168:171], a[128:131], v[200:203], v[168:171]
    ds_read_b128 v[224:227], v4 offset:35840
    v_mfma_f32_16x16x32_bf16 v[172:175], a[132:135], v[200:203], v[172:175]
    ds_read_b128 v[228:231], v5 offset:35840
    v_mfma_f32_16x16x32_bf16 v[180:183], a[132:135], v[204:207], v[180:183]
    v_mfma_f32_16x16x32_bf16 v[176:179], a[128:131], v[204:207], v[176:179]
    s_waitcnt lgkmcnt(4)
    v_mfma_f32_16x16x32_bf16 v[168:171], a[136:139], v[208:211], v[168:171]
    ds_read_b128 v[200:203], v4 offset:40960
    v_mfma_f32_16x16x32_bf16 v[172:175], a[140:143], v[208:211], v[172:175]
    ds_read_b128 v[204:207], v5 offset:40960
    v_mfma_f32_16x16x32_bf16 v[180:183], a[140:143], v[212:215], v[180:183]
    v_mfma_f32_16x16x32_bf16 v[176:179], a[136:139], v[212:215], v[176:179]
    s_waitcnt lgkmcnt(4)
    v_mfma_f32_16x16x32_bf16 v[168:171], a[144:147], v[216:219], v[168:171]
    ds_read_b128 v[208:211], v4 offset:41984
    v_mfma_f32_16x16x32_bf16 v[172:175], a[148:151], v[216:219], v[172:175]
    ds_read_b128 v[212:215], v5 offset:41984
    v_mfma_f32_16x16x32_bf16 v[180:183], a[148:151], v[220:223], v[180:183]
    v_mfma_f32_16x16x32_bf16 v[176:179], a[144:147], v[220:223], v[176:179]
    s_waitcnt lgkmcnt(4)
    v_mfma_f32_16x16x32_bf16 v[168:171], a[152:155], v[224:227], v[168:171]
    ds_read_b128 v[216:219], v4 offset:43008
    v_mfma_f32_16x16x32_bf16 v[172:175], a[156:159], v[224:227], v[172:175]
    ds_read_b128 v[220:223], v5 offset:43008
    v_mfma_f32_16x16x32_bf16 v[180:183], a[156:159], v[228:231], v[180:183]
    v_mfma_f32_16x16x32_bf16 v[176:179], a[152:155], v[228:231], v[176:179]
    s_waitcnt lgkmcnt(4)
    v_mfma_f32_16x16x32_bf16 v[168:171], a[160:163], v[200:203], v[168:171]
    ds_read_b128 v[224:227], v4 offset:44032
    v_mfma_f32_16x16x32_bf16 v[172:175], a[164:167], v[200:203], v[172:175]
    ds_read_b128 v[228:231], v5 offset:44032
    v_mfma_f32_16x16x32_bf16 v[180:183], a[164:167], v[204:207], v[180:183]
    v_mfma_f32_16x16x32_bf16 v[176:179], a[160:163], v[204:207], v[176:179]
    s_waitcnt lgkmcnt(4)
    v_mfma_f32_16x16x32_bf16 v[168:171], a[168:171], v[208:211], v[168:171]
    ds_read_b128 v[200:203], v4 offset:49152
    v_mfma_f32_16x16x32_bf16 v[172:175], a[172:175], v[208:211], v[172:175]
    ds_read_b128 v[204:207], v5 offset:49152
    v_mfma_f32_16x16x32_bf16 v[180:183], a[172:175], v[212:215], v[180:183]
    v_mfma_f32_16x16x32_bf16 v[176:179], a[168:171], v[212:215], v[176:179]
    s_waitcnt lgkmcnt(4)
    v_mfma_f32_16x16x32_bf16 v[168:171], a[176:179], v[216:219], v[168:171]
    ds_read_b128 v[208:211], v4 offset:50176
    v_mfma_f32_16x16x32_bf16 v[172:175], a[180:183], v[216:219], v[172:175]
    ds_read_b128 v[212:215], v5 offset:50176
    v_mfma_f32_16x16x32_bf16 v[180:183], a[180:183], v[220:223], v[180:183]
    v_mfma_f32_16x16x32_bf16 v[176:179], a[176:179], v[220:223], v[176:179]
    s_waitcnt lgkmcnt(4)
    v_mfma_f32_16x16x32_bf16 v[168:171], a[184:187], v[224:227], v[168:171]
    ds_read_b128 v[216:219], v4 offset:51200
    v_mfma_f32_16x16x32_bf16 v[172:175], a[188:191], v[224:227], v[172:175]
    ds_read_b128 v[220:223], v5 offset:51200
    v_mfma_f32_16x16x32_bf16 v[180:183], a[188:191], v[228:231], v[180:183]
    v_mfma_f32_16x16x32_bf16 v[176:179], a[184:187], v[228:231], v[176:179]
    s_waitcnt lgkmcnt(4)
    v_mfma_f32_16x16x32_bf16 v[168:171], a[192:195], v[200:203], v[168:171]
    ds_read_b128 v[224:227], v4 offset:52224
    v_mfma_f32_16x16x32_bf16 v[172:175], a[196:199], v[200:203], v[172:175]
    ds_read_b128 v[228:231], v5 offset:52224
    v_mfma_f32_16x16x32_bf16 v[180:183], a[196:199], v[204:207], v[180:183]
    v_mfma_f32_16x16x32_bf16 v[176:179], a[192:195], v[204:207], v[176:179]
    s_waitcnt lgkmcnt(4)
    v_mfma_f32_16x16x32_bf16 v[168:171], a[200:203], v[208:211], v[168:171]
    ds_read_b128 v[200:203], v4 offset:57344
    v_mfma_f32_16x16x32_bf16 v[172:175], a[204:207], v[208:211], v[172:175]
    ds_read_b128 v[204:207], v5 offset:57344
    v_mfma_f32_16x16x32_bf16 v[180:183], a[204:207], v[212:215], v[180:183]
    v_mfma_f32_16x16x32_bf16 v[176:179], a[200:203], v[212:215], v[176:179]
    s_waitcnt lgkmcnt(4)
    v_mfma_f32_16x16x32_bf16 v[168:171], a[208:211], v[216:219], v[168:171]
    ds_read_b128 v[208:211], v4 offset:58368
    v_mfma_f32_16x16x32_bf16 v[172:175], a[212:215], v[216:219], v[172:175]
    ds_read_b128 v[212:215], v5 offset:58368
    v_mfma_f32_16x16x32_bf16 v[180:183], a[212:215], v[220:223], v[180:183]
    v_mfma_f32_16x16x32_bf16 v[176:179], a[208:211], v[220:223], v[176:179]
    s_waitcnt lgkmcnt(4)
    v_mfma_f32_16x16x32_bf16 v[168:171], a[216:219], v[224:227], v[168:171]
    ds_read_b128 v[216:219], v4 offset:59392
    v_mfma_f32_16x16x32_bf16 v[172:175], a[220:223], v[224:227], v[172:175]
    ds_read_b128 v[220:223], v5 offset:59392
    v_mfma_f32_16x16x32_bf16 v[180:183], a[220:223], v[228:231], v[180:183]
    v_mfma_f32_16x16x32_bf16 v[176:179], a[216:219], v[228:231], v[176:179]
    s_waitcnt lgkmcnt(4)
    v_mfma_f32_16x16x32_bf16 v[168:171], a[224:227], v[200:203], v[168:171]
    ds_read_b128 v[224:227], v4 offset:60416
    v_mfma_f32_16x16x32_bf16 v[172:175], a[228:231], v[200:203], v[172:175]
    ds_read_b128 v[228:231], v5 offset:60416
    v_mfma_f32_16x16x32_bf16 v[180:183], a[228:231], v[204:207], v[180:183]
    v_mfma_f32_16x16x32_bf16 v[176:179], a[224:227], v[204:207], v[176:179]
    s_waitcnt lgkmcnt(4)
    v_mfma_f32_16x16x32_bf16 v[168:171], a[232:235], v[208:211], v[168:171]
    v_mfma_f32_16x16x32_bf16 v[172:175], a[236:239], v[208:211], v[172:175]
    v_mfma_f32_16x16x32_bf16 v[180:183], a[236:239], v[212:215], v[180:183]
    v_mfma_f32_16x16x32_bf16 v[176:179], a[232:235], v[212:215], v[176:179]
    s_waitcnt lgkmcnt(2)
    v_mfma_f32_16x16x32_bf16 v[168:171], a[240:243], v[216:219], v[168:171]
    v_mfma_f32_16x16x32_bf16 v[172:175], a[244:247], v[216:219], v[172:175]
    v_mfma_f32_16x16x32_bf16 v[180:183], a[244:247], v[220:223], v[180:183]
    v_mfma_f32_16x16x32_bf16 v[176:179], a[240:243], v[220:223], v[176:179]
    s_waitcnt lgkmcnt(0)
    v_mfma_f32_16x16x32_bf16 v[184:187], a[248:251], v[224:227], v[168:171]
    v_mfma_f32_16x16x32_bf16 v[188:191], a[252:255], v[224:227], v[172:175]
    v_mfma_f32_16x16x32_bf16 v[196:199], a[252:255], v[228:231], v[180:183]
    v_mfma_f32_16x16x32_bf16 v[192:195], a[248:251], v[228:231], v[176:179]
    s_lshl_b32 s29, s46, 18
    s_nop 6
    buffer_store_dwordx4 v[184:187], v20, s[8:11], s25 offen
    buffer_store_dwordx4 v[188:191], v21, s[8:11], s25 offen
    buffer_store_dwordx4 v[192:195], v22, s[8:11], s25 offen
    s_waitcnt vmcnt(0)
    s_barrier
    s_add_u32 s30, s30, 1
    v_mov_b32 v102, s30
    buffer_store_dword v102, v240, s[8:11], s31 offen
    v_mov_b32 v18, s30
    v_writelane_b32 v18, s20, 32
    s_cmp_gt_u32 s20, 25
    s_cselect_b32 s63, 64, 0
    v_writelane_b32 v18, 64, 33
    v_writelane_b32 v18, s63, 34
    v_writelane_b32 v18, 64, 35
    v_writelane_b32 v18, s63, 36
L_sp_64:
    global_load_dword v19, v[16:17], off sc1
    s_add_u32 s38, s38, 1
    s_cmp_gt_u32 s38, 0x200000
    s_cbranch_scc1 chain_kernel_wabort
    s_waitcnt vmcnt(0)
    v_cmp_lt_u32 vcc, v19, v18
    s_cbranch_vccz L_spok_65
    s_branch L_sp_64
L_spok_65:
    s_add_u32 s63, s27, 0x0
    buffer_load_dwordx4 v[104:107], v23, s[8:11], s63 offen offset:0 sc1
    buffer_load_dwordx4 v[108:111], v23, s[8:11], s63 offen offset:1024 sc1
    buffer_load_dwordx4 v[112:115], v23, s[8:11], s63 offen offset:2048 sc1
    s_waitcnt vmcnt(0)
    v_pk_add_f32 v[104:105], v[104:105], v[196:197]
    v_pk_add_f32 v[106:107], v[106:107], v[198:199]
    v_pk_add_f32 v[108:109], v[108:109], v[112:113]
    v_pk_add_f32 v[110:111], v[110:111], v[114:115]
    v_pk_add_f32 v[104:105], v[104:105], v[108:109]
    v_pk_add_f32 v[106:107], v[106:107], v[110:111]
    v_cvt_pk_bf16_f32 v104, 0, v104
    v_cvt_pk_bf16_f32 v105, 0, v105
    v_cvt_pk_bf16_f32 v106, 0, v106
    v_cvt_pk_bf16_f32 v107, 0, v107
    s_add_u32 s62, s29, 0x0
    buffer_store_dwordx4 v[104:107], v15, s[16:19], s62 offen
    s_add_u32 s46, s46, 4
    s_cmp_lt_u32 s46, 64
    s_cbranch_scc1 seg_t
    s_endpgm
seg_pslow:
L_sp_66:
    global_load_dword v19, v[16:17], off sc1
    s_add_u32 s38, s38, 1
    s_cmp_gt_u32 s38, 0x200000
    s_cbranch_scc1 chain_kernel_wabort
    s_waitcnt vmcnt(0)
    v_cmp_lt_u32 vcc, v19, v18
    s_cbranch_vccz L_spok_67
    s_sleep 2
    s_branch L_sp_66
L_spok_67:
    s_branch seg_pok
seg_att:
    ds_read_b128 v[104:107], v12 offset:0
    ds_read_b128 v[108:111], v12 offset:4096
    ds_read_b128 v[112:115], v12 offset:1024
    ds_read_b128 v[116:119], v12 offset:5120
    ds_read_b128 v[120:123], v12 offset:2048
    ds_read_b128 v[124:127], v12 offset:6144
    ds_read_b128 v[128:131], v12 offset:3072
    ds_read_b128 v[132:135], v12 offset:7168
    v_mfma_f32_16x16x32_bf16 v[84:87], v[52:55], v[36:39], 0
    v_mfma_f32_16x16x32_bf16 v[84:87], v[56:59], v[40:43], v[84:87]
    v_mfma_f32_16x16x32_bf16 v[84:87], v[60:63], v[44:47], v[84:87]
    v_mfma_f32_16x16x32_bf16 v[84:87], v[64:67], v[48:51], v[84:87]
    s_waitcnt lgkmcnt(6)
    v_mfma_f32_16x16x32_bf16 v[76:79], v[104:107], v[36:39], 0
    v_mfma_f32_16x16x32_bf16 v[80:83], v[108:111], v[36:39], 0
    s_waitcnt lgkmcnt(4)
    v_mfma_f32_16x16x32_bf16 v[76:79], v[112:115], v[40:43], v[76:79]
    v_mfma_f32_16x16x32_bf16 v[80:83], v[116:119], v[40:43], v[80:83]
    s_waitcnt lgkmcnt(2)
    v_mfma_f32_16x16x32_bf16 v[76:79], v[120:123], v[44:47], v[76:79]
    v_mfma_f32_16x16x32_bf16 v[80:83], v[124:127], v[44:47], v[80:83]
    s_waitcnt lgkmcnt(0)
    v_mfma_f32_16x16x32_bf16 v[76:79], v[128:131], v[48:51], v[76:79]
    v_mfma_f32_16x16x32_bf16 v[80:83], v[132:135], v[48:51], v[80:83]
    ds_read_b128 v[104:107], v12 offset:8192
    ds_read_b128 v[108:111], v12 offset:9216
    ds_read_b128 v[112:115], v12 offset:10240
    ds_read_b128 v[116:119], v12 offset:11264
    ds_read_b128 v[120:123], v12 offset:12288
    ds_read_b128 v[124:127], v12 offset:13312
    ds_read_b128 v[128:131], v12 offset:14336
    ds_read_b128 v[132:135], v12 offset:15360
    v_cvt_pk_bf16_f32 v84, 0, v84
    v_cvt_pk_bf16_f32 v85, 0, v85
    v_cvt_pk_bf16_f32 v76, 0, v76
    v_cvt_pk_bf16_f32 v77, 0, v77
    v_cvt_pk_bf16_f32 v78, 0, v78
    v_cvt_pk_bf16_f32 v79, 0, v79
    v_cvt_pk_bf16_f32 v80, 0, v80
    v_cvt_pk_bf16_f32 v81, 0, v81
    v_cvt_pk_bf16_f32 v82, 0, v82
    v_cvt_pk_bf16_f32 v83, 0, v83
    v_pk_mul_f32 v[84:85], v[84:85], s[40:41]
    v_pk_mul_f32 v[76:77], v[76:77], s[40:41]
    v_pk_mul_f32 v[78:79], v[78:79], s[40:41]
    v_pk_mul_f32 v[80:81], v[80:81], s[40:41]
    v_pk_mul_f32 v[82:83], v[82:83], s[40:41]
    v_cvt_pk_bf16_f32 v84, 0, v84
    v_cvt_pk_bf16_f32 v85, 0, v85
    v_cvt_pk_bf16_f32 v76, 0, v76
    v_cvt_pk_bf16_f32 v77, 0, v77
    v_cvt_pk_bf16_f32 v78, 0, v78
    v_cvt_pk_bf16_f32 v79, 0, v79
    v_cvt_pk_bf16_f32 v80, 0, v80
    v_cvt_pk_bf16_f32 v81, 0, v81
    v_cvt_pk_bf16_f32 v82, 0, v82
    v_cvt_pk_bf16_f32 v83, 0, v83
    v_pk_add_f32 v[76:77], v[76:77], v[28:29]
    v_pk_add_f32 v[78:79], v[78:79], v[30:31]
    v_pk_add_f32 v[80:81], v[80:81], v[32:33]
    v_pk_add_f32 v[82:83], v[82:83], v[34:35]
    v_max3_f32 v96, v84, v85, v76
    v_max3_f32 v97, v77, v78, v79
    v_max3_f32 v96, v96, v80, v81
    v_max3_f32 v97, v97, v82, v83
    v_max_f32 v96, v96, v97
    v_mov_b32 v97, v96
    s_nop 1
    v_permlane16_swap_b32 v96, v97
    v_max_f32 v96, v96, v97
    v_mov_b32 v97, v96
    s_nop 1
    v_permlane32_swap_b32 v96, v97
    v_max_f32 v96, v96, v97
    v_mul_f32 v96, s42, v96
    v_pk_fma_f32 v[84:85], v[84:85], s[42:43], v[96:97] op_sel_hi:[1,1,0] neg_lo:[0,0,1] neg_hi:[0,0,1]
    v_pk_fma_f32 v[76:77], v[76:77], s[42:43], v[96:97] op_sel_hi:[1,1,0] neg_lo:[0,0,1] neg_hi:[0,0,1]
    v_pk_fma_f32 v[78:79], v[78:79], s[42:43], v[96:97] op_sel_hi:[1,1,0] neg_lo:[0,0,1] neg_hi:[0,0,1]
    v_pk_fma_f32 v[80:81], v[80:81], s[42:43], v[96:97] op_sel_hi:[1,1,0] neg_lo:[0,0,1] neg_hi:[0,0,1]
    v_pk_fma_f32 v[82:83], v[82:83], s[42:43], v[96:97] op_sel_hi:[1,1,0] neg_lo:[0,0,1] neg_hi:[0,0,1]
    v_exp_f32 v84, v84
    v_exp_f32 v85, v85
    v_exp_f32 v76, v76
    v_exp_f32 v77, v77
    v_exp_f32 v78, v78
    v_exp_f32 v79, v79
    v_exp_f32 v80, v80
    v_exp_f32 v81, v81
    v_exp_f32 v82, v82
    v_exp_f32 v83, v83
    v_pk_add_f32 v[98:99], v[84:85], v[76:77]
    v_pk_add_f32 v[100:101], v[78:79], v[80:81]
    v_pk_add_f32 v[98:99], v[98:99], v[82:83]
    v_pk_add_f32 v[98:99], v[98:99], v[100:101]
    v_add_f32 v98, v98, v99
    v_mov_b32 v97, v98
    s_nop 1
    v_permlane16_swap_b32 v98, v97
    v_add_f32 v98, v98, v97
    v_mov_b32 v97, v98
    s_nop 1
    v_permlane32_swap_b32 v98, v97
    v_add_f32 v98, v98, v97
    v_rcp_f32 v98, v98
    s_nop 0
    v_pk_mul_f32 v[76:77], v[76:77], v[98:99] op_sel_hi:[1,0]
    v_pk_mul_f32 v[78:79], v[78:79], v[98:99] op_sel_hi:[1,0]
    v_pk_mul_f32 v[80:81], v[80:81], v[98:99] op_sel_hi:[1,0]
    v_pk_mul_f32 v[82:83], v[82:83], v[98:99] op_sel_hi:[1,0]
    v_pk_mul_f32 v[84:85], v[84:85], v[98:99] op_sel_hi:[1,0]
    v_cvt_pk_bf16_f32 v88, v76, v77
    v_cvt_pk_bf16_f32 v89, v78, v79
    v_cvt_pk_bf16_f32 v90, v80, v81
    v_cvt_pk_bf16_f32 v91, v82, v83
    v_cvt_pk_bf16_f32 v92, v84, v85
    v_cvt_pk_bf16_f32 v95, v84, v85
    s_waitcnt lgkmcnt(0)
    v_mfma_f32_16x16x32_bf16 v[136:139], v[104:107], v[88:91], 0
    v_mfma_f32_16x16x32_bf16 v[140:143], v[108:111], v[88:91], 0
    v_mfma_f32_16x16x16_bf16 v[136:139], v[68:69], v[92:93], v[136:139]
    v_mfma_f32_16x16x16_bf16 v[140:143], v[68:69], v[94:95], v[140:143]
    v_mfma_f32_16x16x32_bf16 v[144:147], v[112:115], v[88:91], 0
    v_mfma_f32_16x16x32_bf16 v[148:151], v[116:119], v[88:91], 0
    v_mfma_f32_16x16x16_bf16 v[144:147], v[70:71], v[92:93], v[144:147]
    v_mfma_f32_16x16x16_bf16 v[148:151], v[70:71], v[94:95], v[148:151]
    v_cvt_pk_bf16_f32 v136, v136, v137
    v_cvt_pk_bf16_f32 v137, v138, v139
    v_cvt_pk_bf16_f32 v138, v140, v141
    v_cvt_pk_bf16_f32 v139, v142, v143
    buffer_store_dwordx4 v[136:139], v1, s[8:11], s24 offen offset:0
    v_mfma_f32_16x16x32_bf16 v[152:155], v[120:123], v[88:91], 0
    v_mfma_f32_16x16x32_bf16 v[156:159], v[124:127], v[88:91], 0
    v_mfma_f32_16x16x16_bf16 v[152:155], v[72:73], v[92:93], v[152:155]
    v_mfma_f32_16x16x16_bf16 v[156:159], v[72:73], v[94:95], v[156:159]
    v_cvt_pk_bf16_f32 v144, v144, v145
    v_cvt_pk_bf16_f32 v145, v146, v147
    v_cvt_pk_bf16_f32 v146, v148, v149
    v_cvt_pk_bf16_f32 v147, v150, v151
    buffer_store_dwordx4 v[144:147], v1, s[8:11], s24 offen offset:1024
    v_mfma_f32_16x16x32_bf16 v[160:163], v[128:131], v[88:91], 0
    v_mfma_f32_16x16x32_bf16 v[164:167], v[132:135], v[88:91], 0
    v_mfma_f32_16x16x16_bf16 v[160:163], v[74:75], v[92:93], v[160:163]
    v_mfma_f32_16x16x16_bf16 v[164:167], v[74:75], v[94:95], v[164:167]
    v_cvt_pk_bf16_f32 v152, v152, v153
    v_cvt_pk_bf16_f32 v153, v154, v155
    v_cvt_pk_bf16_f32 v154, v156, v157
    v_cvt_pk_bf16_f32 v155, v158, v159
    buffer_store_dwordx4 v[152:155], v1, s[8:11], s24 offen offset:2048
    s_nop 3
    v_cvt_pk_bf16_f32 v160, v160, v161
    v_cvt_pk_bf16_f32 v161, v162, v163
    v_cvt_pk_bf16_f32 v162, v164, v165
    v_cvt_pk_bf16_f32 v163, v166, v167
    buffer_store_dwordx4 v[160:163], v1, s[8:11], s24 offen offset:3072
    s_setpc_b64 s[54:55]
    s_endpgm
chain_kernel_wabort:
    s_mov_b64 exec, 1
    v_mov_b32 v1, 0xdeadbeef
    v_mov_b32 v2, 120
    global_store_dword v2, v1, s[98:99]
    s_endpgm
t_kq:
    s_mov_b32 s43, 0
    v_xor_b32 v14, 0, v22
    v_xor_b32 v15, 32, v22
    v_xor_b32 v16, 64, v22
    v_xor_b32 v17, 96, v22
    v_xor_b32 v18, 128, v22
    v_xor_b32 v19, 160, v22
    v_xor_b32 v20, 192, v22
    v_xor_b32 v21, 224, v22
    v_add_u32 v14, s49, v14
    v_add_u32 v15, s49, v15
    v_add_u32 v16, s49, v16
    v_add_u32 v17, s49, v17
    v_add_u32 v18, s49, v18
    v_add_u32 v19, s49, v19
    v_add_u32 v20, s49, v20
    v_add_u32 v21, s49, v21
    ds_read_b64_tr_b16 v[72:73], v14 offset:0
    ds_read_b64_tr_b16 v[74:75], v14 offset:2048
    ds_read_b128 v[44:47], v12 offset:2048
    ds_read_b128 v[40:43], v12 offset:0
    ds_read_b64_tr_b16 v[76:77], v15 offset:0
    ds_read_b64_tr_b16 v[78:79], v15 offset:2048
    ds_read_b128 v[52:55], v12 offset:6144
    ds_read_b128 v[48:51], v12 offset:4096
    ds_read_b128 v[60:63], v12 offset:10240
    ds_read_b128 v[56:59], v12 offset:8192
    ds_read_b128 v[68:71], v12 offset:14336
    ds_read_b128 v[64:67], v12 offset:12288
    s_waitcnt lgkmcnt(8)
    v_mfma_f32_16x16x32_bf16 a[0:3], v[72:75], v[40:43], 0
    s_xor_b32 m0, s44, 0
    v_mfma_f32_16x16x32_bf16 a[32:35], v[72:75], v[44:47], 0
    buffer_load_dwordx4 v4, s[8:11], s20 offen lds
    s_waitcnt lgkmcnt(6)
    v_mfma_f32_16x16x32_bf16 a[36:39], v[76:79], v[44:47], 0
    ds_read_b64_tr_b16 v[80:81], v16 offset:0
    s_xor_b32 m0, s44, 1024
    v_mfma_f32_16x16x32_bf16 a[4:7], v[76:79], v[40:43], 0
    buffer_load_dwordx4 v5, s[8:11], s20 offen lds
    s_waitcnt lgkmcnt(5)
    v_mfma_f32_16x16x32_bf16 a[64:67], v[72:75], v[48:51], 0
    ds_read_b64_tr_b16 v[82:83], v16 offset:2048
    s_add_u32 s20, s20, 128
    v_mfma_f32_16x16x32_bf16 a[96:99], v[72:75], v[52:55], 0
    s_xor_b32 m0, s45, 0
    v_mfma_f32_16x16x32_bf16 a[100:103], v[76:79], v[52:55], 0
    ds_read_b64_tr_b16 v[84:85], v17 offset:0
    buffer_load_dwordx4 v6, s[12:15], s24 offen lds
    v_mfma_f32_16x16x32_bf16 a[68:71], v[76:79], v[48:51], 0
    s_xor_b32 m0, s45, 1024
    s_waitcnt lgkmcnt(5)
    v_mfma_f32_16x16x32_bf16 a[128:131], v[72:75], v[56:59], 0
    ds_read_b64_tr_b16 v[86:87], v17 offset:2048
    buffer_load_dwordx4 v7, s[12:15], s24 offen lds
    v_mfma_f32_16x16x32_bf16 a[160:163], v[72:75], v[60:63], 0
    s_add_u32 s24, s24, s28
    s_bitcmp1_b32 s43, 0
    v_mfma_f32_16x16x32_bf16 a[164:167], v[76:79], v[60:63], 0
    s_cselect_b32 s61, s5, 0
    s_lshl1_add_u32 s53, s61, s50
    v_mfma_f32_16x16x32_bf16 a[132:135], v[76:79], v[56:59], 0
    s_bitcmp1_b32 s43, 1
    s_waitcnt lgkmcnt(4)
    v_mfma_f32_16x16x32_bf16 a[192:195], v[72:75], v[64:67], 0
    s_cselect_b32 s61, s51, 0
    s_add_u32 s53, s53, s61
    v_mfma_f32_16x16x32_bf16 a[224:227], v[72:75], v[68:71], 0
    s_bitcmp1_b32 s43, 2
    s_cselect_b32 s61, s52, 0
    v_mfma_f32_16x16x32_bf16 a[228:231], v[76:79], v[68:71], 0
    s_add_u32 s53, s53, s61
    s_lshl_b32 s29, s43, 4
    v_mfma_f32_16x16x32_bf16 a[196:199], v[76:79], v[64:67], 0
    s_waitcnt lgkmcnt(2)
    v_mfma_f32_16x16x32_bf16 a[8:11], v[80:83], v[40:43], 0
    s_set_gpr_idx_on s29, gpr_idx(SRC0)
    v_mov_b32 v24, v128
    v_mov_b32 v25, v129
    v_mov_b32 v26, v130
    v_mov_b32 v27, v131
    s_set_gpr_idx_off
    v_mfma_f32_16x16x32_bf16 a[40:43], v[80:83], v[44:47], 0
    s_waitcnt lgkmcnt(0)
    v_mfma_f32_16x16x32_bf16 a[44:47], v[84:87], v[44:47], 0
    ds_read_b64_tr_b16 v[72:73], v18 offset:0
    s_set_gpr_idx_on s29, gpr_idx(SRC0)
    v_mov_b32 v28, v132
    v_mov_b32 v29, v133
    v_mov_b32 v30, v134
    v_mov_b32 v31, v135
    s_set_gpr_idx_off
    v_mfma_f32_16x16x32_bf16 a[12:15], v[84:87], v[40:43], 0
    v_mfma_f32_16x16x32_bf16 a[72:75], v[80:83], v[48:51], 0
    ds_read_b64_tr_b16 v[74:75], v18 offset:2048
    s_set_gpr_idx_on s29, gpr_idx(SRC0)
    v_mov_b32 v32, v136
    v_mov_b32 v33, v137
    v_mov_b32 v34, v138
    v_mov_b32 v35, v139
    s_set_gpr_idx_off
    v_mfma_f32_16x16x32_bf16 a[104:107], v[80:83], v[52:55], 0
    v_mfma_f32_16x16x32_bf16 a[108:111], v[84:87], v[52:55], 0
    ds_read_b64_tr_b16 v[76:77], v19 offset:0
    s_set_gpr_idx_on s29, gpr_idx(SRC0)
    v_mov_b32 v36, v140
    v_mov_b32 v37, v141
    v_mov_b32 v38, v142
    v_mov_b32 v39, v143
    s_set_gpr_idx_off
    v_mfma_f32_16x16x32_bf16 a[76:79], v[84:87], v[48:51], 0
    v_mfma_f32_16x16x32_bf16 a[136:139], v[80:83], v[56:59], 0
    ds_read_b64_tr_b16 v[78:79], v19 offset:2048
    buffer_store_dwordx4 v[24:27], v2, s[16:19], s53 offen sc1
    v_mfma_f32_16x16x32_bf16 a[168:171], v[80:83], v[60:63], 0
    v_mfma_f32_16x16x32_bf16 a[172:175], v[84:87], v[60:63], 0
    buffer_store_dwordx4 v[28:31], v3, s[16:19], s53 offen sc1
    v_mfma_f32_16x16x32_bf16 a[140:143], v[84:87], v[56:59], 0
    s_add_u32 s53, s53, s5
    v_mfma_f32_16x16x32_bf16 a[200:203], v[80:83], v[64:67], 0
    buffer_store_dwordx4 v[32:35], v2, s[16:19], s53 offen sc1
    v_mfma_f32_16x16x32_bf16 a[232:235], v[80:83], v[68:71], 0
    v_mfma_f32_16x16x32_bf16 a[236:239], v[84:87], v[68:71], 0
    buffer_store_dwordx4 v[36:39], v3, s[16:19], s53 offen sc1
    v_mfma_f32_16x16x32_bf16 a[204:207], v[84:87], v[64:67], 0
    s_waitcnt lgkmcnt(2)
    v_mfma_f32_16x16x32_bf16 a[16:19], v[72:75], v[40:43], 0
    v_mfma_f32_16x16x32_bf16 a[48:51], v[72:75], v[44:47], 0
    s_waitcnt lgkmcnt(0)
    v_mfma_f32_16x16x32_bf16 a[52:55], v[76:79], v[44:47], 0
    ds_read_b64_tr_b16 v[80:81], v20 offset:0
    v_mfma_f32_16x16x32_bf16 a[20:23], v[76:79], v[40:43], 0
    v_mfma_f32_16x16x32_bf16 a[80:83], v[72:75], v[48:51], 0
    ds_read_b64_tr_b16 v[82:83], v20 offset:2048
    v_mfma_f32_16x16x32_bf16 a[112:115], v[72:75], v[52:55], 0
    v_mfma_f32_16x16x32_bf16 a[116:119], v[76:79], v[52:55], 0
    ds_read_b64_tr_b16 v[84:85], v21 offset:0
    v_mfma_f32_16x16x32_bf16 a[84:87], v[76:79], v[48:51], 0
    v_mfma_f32_16x16x32_bf16 a[144:147], v[72:75], v[56:59], 0
    ds_read_b64_tr_b16 v[86:87], v21 offset:2048
    v_mfma_f32_16x16x32_bf16 a[176:179], v[72:75], v[60:63], 0
    v_mfma_f32_16x16x32_bf16 a[180:183], v[76:79], v[60:63], 0
    v_mfma_f32_16x16x32_bf16 a[148:151], v[76:79], v[56:59], 0
    v_mfma_f32_16x16x32_bf16 a[208:211], v[72:75], v[64:67], 0
    v_mfma_f32_16x16x32_bf16 a[240:243], v[72:75], v[68:71], 0
    v_mfma_f32_16x16x32_bf16 a[244:247], v[76:79], v[68:71], 0
    v_mfma_f32_16x16x32_bf16 a[212:215], v[76:79], v[64:67], 0
    s_waitcnt lgkmcnt(2)
    v_mfma_f32_16x16x32_bf16 a[24:27], v[80:83], v[40:43], 0
    ds_read_b64_tr_b16 v[72:73], v14 offset:16384
    v_mfma_f32_16x16x32_bf16 a[56:59], v[80:83], v[44:47], 0
    ds_read_b64_tr_b16 v[74:75], v14 offset:18432
    s_waitcnt lgkmcnt(2)
    v_mfma_f32_16x16x32_bf16 a[60:63], v[84:87], v[44:47], 0
    ds_read_b128 v[44:47], v13 offset:2048
    v_mfma_f32_16x16x32_bf16 a[28:31], v[84:87], v[40:43], 0
    ds_read_b128 v[40:43], v13 offset:0
    v_mfma_f32_16x16x32_bf16 a[88:91], v[80:83], v[48:51], 0
    ds_read_b64_tr_b16 v[76:77], v15 offset:16384
    v_mfma_f32_16x16x32_bf16 a[120:123], v[80:83], v[52:55], 0
    ds_read_b64_tr_b16 v[78:79], v15 offset:18432
    v_mfma_f32_16x16x32_bf16 a[124:127], v[84:87], v[52:55], 0
    ds_read_b128 v[52:55], v13 offset:6144
    v_mfma_f32_16x16x32_bf16 a[92:95], v[84:87], v[48:51], 0
    ds_read_b128 v[48:51], v13 offset:4096
    v_mfma_f32_16x16x32_bf16 a[152:155], v[80:83], v[56:59], 0
    s_xor_b32 m0, s44, 2048
    v_mfma_f32_16x16x32_bf16 a[184:187], v[80:83], v[60:63], 0
    buffer_load_dwordx4 v4, s[8:11], s21 offen lds
    v_mfma_f32_16x16x32_bf16 a[188:191], v[84:87], v[60:63], 0
    ds_read_b128 v[60:63], v13 offset:10240
    v_mfma_f32_16x16x32_bf16 a[156:159], v[84:87], v[56:59], 0
    ds_read_b128 v[56:59], v13 offset:8192
    v_mfma_f32_16x16x32_bf16 a[216:219], v[80:83], v[64:67], 0
    s_xor_b32 m0, s44, 3072
    v_mfma_f32_16x16x32_bf16 a[248:251], v[80:83], v[68:71], 0
    buffer_load_dwordx4 v5, s[8:11], s21 offen lds
    v_mfma_f32_16x16x32_bf16 a[252:255], v[84:87], v[68:71], 0
    ds_read_b128 v[68:71], v13 offset:14336
    s_add_u32 s21, s21, 128
    v_mfma_f32_16x16x32_bf16 a[220:223], v[84:87], v[64:67], 0
    ds_read_b128 v[64:67], v13 offset:12288
    s_branch t_kq_b
t_kq_as:
    s_waitcnt lgkmcnt(8)
    v_mfma_f32_16x16x32_bf16 a[0:3], v[72:75], v[40:43], a[0:3]
    s_xor_b32 m0, s44, 0
    v_mfma_f32_16x16x32_bf16 a[32:35], v[72:75], v[44:47], a[32:35]
    buffer_load_dwordx4 v4, s[8:11], s20 offen lds
    s_waitcnt lgkmcnt(6)
    v_mfma_f32_16x16x32_bf16 a[36:39], v[76:79], v[44:47], a[36:39]
    ds_read_b64_tr_b16 v[80:81], v16 offset:0
    s_xor_b32 m0, s44, 1024
    v_mfma_f32_16x16x32_bf16 a[4:7], v[76:79], v[40:43], a[4:7]
    buffer_load_dwordx4 v5, s[8:11], s20 offen lds
    s_waitcnt lgkmcnt(5)
    v_mfma_f32_16x16x32_bf16 a[64:67], v[72:75], v[48:51], a[64:67]
    ds_read_b64_tr_b16 v[82:83], v16 offset:2048
    s_add_u32 s20, s20, 128
    v_mfma_f32_16x16x32_bf16 a[96:99], v[72:75], v[52:55], a[96:99]
    s_xor_b32 m0, s45, 0
    v_mfma_f32_16x16x32_bf16 a[100:103], v[76:79], v[52:55], a[100:103]
    ds_read_b64_tr_b16 v[84:85], v17 offset:0
    buffer_load_dwordx4 v6, s[12:15], s24 offen lds
    v_mfma_f32_16x16x32_bf16 a[68:71], v[76:79], v[48:51], a[68:71]
    s_xor_b32 m0, s45, 1024
    s_waitcnt lgkmcnt(5)
    v_mfma_f32_16x16x32_bf16 a[128:131], v[72:75], v[56:59], a[128:131]
    ds_read_b64_tr_b16 v[86:87], v17 offset:2048
    buffer_load_dwordx4 v7, s[12:15], s24 offen lds
    v_mfma_f32_16x16x32_bf16 a[160:163], v[72:75], v[60:63], a[160:163]
    s_add_u32 s24, s24, s28
    s_bitcmp1_b32 s43, 0
    v_mfma_f32_16x16x32_bf16 a[164:167], v[76:79], v[60:63], a[164:167]
    s_cselect_b32 s61, s5, 0
    s_lshl1_add_u32 s53, s61, s50
    v_mfma_f32_16x16x32_bf16 a[132:135], v[76:79], v[56:59], a[132:135]
    s_bitcmp1_b32 s43, 1
    s_waitcnt lgkmcnt(4)
    v_mfma_f32_16x16x32_bf16 a[192:195], v[72:75], v[64:67], a[192:195]
    s_cselect_b32 s61, s51, 0
    s_add_u32 s53, s53, s61
    v_mfma_f32_16x16x32_bf16 a[224:227], v[72:75], v[68:71], a[224:227]
    s_bitcmp1_b32 s43, 2
    s_cselect_b32 s61, s52, 0
    v_mfma_f32_16x16x32_bf16 a[228:231], v[76:79], v[68:71], a[228:231]
    s_add_u32 s53, s53, s61
    s_lshl_b32 s29, s43, 4
    v_mfma_f32_16x16x32_bf16 a[196:199], v[76:79], v[64:67], a[196:199]
    s_waitcnt lgkmcnt(2)
    v_mfma_f32_16x16x32_bf16 a[8:11], v[80:83], v[40:43], a[8:11]
    s_set_gpr_idx_on s29, gpr_idx(SRC0)
    v_mov_b32 v24, v128
    v_mov_b32 v25, v129
    v_mov_b32 v26, v130
    v_mov_b32 v27, v131
    s_set_gpr_idx_off
    v_mfma_f32_16x16x32_bf16 a[40:43], v[80:83], v[44:47], a[40:43]
    s_waitcnt lgkmcnt(0)
    v_mfma_f32_16x16x32_bf16 a[44:47], v[84:87], v[44:47], a[44:47]
    ds_read_b64_tr_b16 v[72:73], v18 offset:0
    s_set_gpr_idx_on s29, gpr_idx(SRC0)
    v_mov_b32 v28, v132
    v_mov_b32 v29, v133
    v_mov_b32 v30, v134
    v_mov_b32 v31, v135
    s_set_gpr_idx_off
    v_mfma_f32_16x16x32_bf16 a[12:15], v[84:87], v[40:43], a[12:15]
    v_mfma_f32_16x16x32_bf16 a[72:75], v[80:83], v[48:51], a[72:75]
    ds_read_b64_tr_b16 v[74:75], v18 offset:2048
    s_set_gpr_idx_on s29, gpr_idx(SRC0)
    v_mov_b32 v32, v136
    v_mov_b32 v33, v137
    v_mov_b32 v34, v138
    v_mov_b32 v35, v139
    s_set_gpr_idx_off
    v_mfma_f32_16x16x32_bf16 a[104:107], v[80:83], v[52:55], a[104:107]
    v_mfma_f32_16x16x32_bf16 a[108:111], v[84:87], v[52:55], a[108:111]
    ds_read_b64_tr_b16 v[76:77], v19 offset:0
    s_set_gpr_idx_on s29, gpr_idx(SRC0)
    v_mov_b32 v36, v140
    v_mov_b32 v37, v141
    v_mov_b32 v38, v142
    v_mov_b32 v39, v143
    s_set_gpr_idx_off
    v_mfma_f32_16x16x32_bf16 a[76:79], v[84:87], v[48:51], a[76:79]
    v_mfma_f32_16x16x32_bf16 a[136:139], v[80:83], v[56:59], a[136:139]
    ds_read_b64_tr_b16 v[78:79], v19 offset:2048
    buffer_store_dwordx4 v[24:27], v2, s[16:19], s53 offen sc1
    v_mfma_f32_16x16x32_bf16 a[168:171], v[80:83], v[60:63], a[168:171]
    v_mfma_f32_16x16x32_bf16 a[172:175], v[84:87], v[60:63], a[172:175]
    buffer_store_dwordx4 v[28:31], v3, s[16:19], s53 offen sc1
    v_mfma_f32_16x16x32_bf16 a[140:143], v[84:87], v[56:59], a[140:143]
    s_add_u32 s53, s53, s5
    v_mfma_f32_16x16x32_bf16 a[200:203], v[80:83], v[64:67], a[200:203]
    buffer_store_dwordx4 v[32:35], v2, s[16:19], s53 offen sc1
    v_mfma_f32_16x16x32_bf16 a[232:235], v[80:83], v[68:71], a[232:235]
    v_mfma_f32_16x16x32_bf16 a[236:239], v[84:87], v[68:71], a[236:239]
    buffer_store_dwordx4 v[36:39], v3, s[16:19], s53 offen sc1
    v_mfma_f32_16x16x32_bf16 a[204:207], v[84:87], v[64:67], a[204:207]
    s_waitcnt lgkmcnt(2)
    v_mfma_f32_16x16x32_bf16 a[16:19], v[72:75], v[40:43], a[16:19]
    v_mfma_f32_16x16x32_bf16 a[48:51], v[72:75], v[44:47], a[48:51]
    s_waitcnt lgkmcnt(0)
    v_mfma_f32_16x16x32_bf16 a[52:55], v[76:79], v[44:47], a[52:55]
    ds_read_b64_tr_b16 v[80:81], v20 offset:0
    v_mfma_f32_16x16x32_bf16 a[20:23], v[76:79], v[40:43], a[20:23]
    v_mfma_f32_16x16x32_bf16 a[80:83], v[72:75], v[48:51], a[80:83]
    ds_read_b64_tr_b16 v[82:83], v20 offset:2048
    v_mfma_f32_16x16x32_bf16 a[112:115], v[72:75], v[52:55], a[112:115]
    v_mfma_f32_16x16x32_bf16 a[116:119], v[76:79], v[52:55], a[116:119]
    ds_read_b64_tr_b16 v[84:85], v21 offset:0
    v_mfma_f32_16x16x32_bf16 a[84:87], v[76:79], v[48:51], a[84:87]
    v_mfma_f32_16x16x32_bf16 a[144:147], v[72:75], v[56:59], a[144:147]
    ds_read_b64_tr_b16 v[86:87], v21 offset:2048
    v_mfma_f32_16x16x32_bf16 a[176:179], v[72:75], v[60:63], a[176:179]
    v_mfma_f32_16x16x32_bf16 a[180:183], v[76:79], v[60:63], a[180:183]
    v_mfma_f32_16x16x32_bf16 a[148:151], v[76:79], v[56:59], a[148:151]
    v_mfma_f32_16x16x32_bf16 a[208:211], v[72:75], v[64:67], a[208:211]
    v_mfma_f32_16x16x32_bf16 a[240:243], v[72:75], v[68:71], a[240:243]
    v_mfma_f32_16x16x32_bf16 a[244:247], v[76:79], v[68:71], a[244:247]
    v_mfma_f32_16x16x32_bf16 a[212:215], v[76:79], v[64:67], a[212:215]
    s_waitcnt lgkmcnt(2)
    v_mfma_f32_16x16x32_bf16 a[24:27], v[80:83], v[40:43], a[24:27]
    ds_read_b64_tr_b16 v[72:73], v14 offset:16384
    v_mfma_f32_16x16x32_bf16 a[56:59], v[80:83], v[44:47], a[56:59]
    ds_read_b64_tr_b16 v[74:75], v14 offset:18432
    s_waitcnt lgkmcnt(2)
    v_mfma_f32_16x16x32_bf16 a[60:63], v[84:87], v[44:47], a[60:63]
    ds_read_b128 v[44:47], v13 offset:2048
    v_mfma_f32_16x16x32_bf16 a[28:31], v[84:87], v[40:43], a[28:31]
    ds_read_b128 v[40:43], v13 offset:0
    v_mfma_f32_16x16x32_bf16 a[88:91], v[80:83], v[48:51], a[88:91]
    ds_read_b64_tr_b16 v[76:77], v15 offset:16384
    v_mfma_f32_16x16x32_bf16 a[120:123], v[80:83], v[52:55], a[120:123]
    ds_read_b64_tr_b16 v[78:79], v15 offset:18432
    v_mfma_f32_16x16x32_bf16 a[124:127], v[84:87], v[52:55], a[124:127]
    ds_read_b128 v[52:55], v13 offset:6144
    v_mfma_f32_16x16x32_bf16 a[92:95], v[84:87], v[48:51], a[92:95]
    ds_read_b128 v[48:51], v13 offset:4096
    v_mfma_f32_16x16x32_bf16 a[152:155], v[80:83], v[56:59], a[152:155]
    s_xor_b32 m0, s44, 2048
    v_mfma_f32_16x16x32_bf16 a[184:187], v[80:83], v[60:63], a[184:187]
    buffer_load_dwordx4 v4, s[8:11], s21 offen lds
    v_mfma_f32_16x16x32_bf16 a[188:191], v[84:87], v[60:63], a[188:191]
    ds_read_b128 v[60:63], v13 offset:10240
    v_mfma_f32_16x16x32_bf16 a[156:159], v[84:87], v[56:59], a[156:159]
    ds_read_b128 v[56:59], v13 offset:8192
    v_mfma_f32_16x16x32_bf16 a[216:219], v[80:83], v[64:67], a[216:219]
    s_xor_b32 m0, s44, 3072
    v_mfma_f32_16x16x32_bf16 a[248:251], v[80:83], v[68:71], a[248:251]
    buffer_load_dwordx4 v5, s[8:11], s21 offen lds
    v_mfma_f32_16x16x32_bf16 a[252:255], v[84:87], v[68:71], a[252:255]
    ds_read_b128 v[68:71], v13 offset:14336
    s_add_u32 s21, s21, 128
    v_mfma_f32_16x16x32_bf16 a[220:223], v[84:87], v[64:67], a[220:223]
    ds_read_b128 v[64:67], v13 offset:12288
    s_branch t_kq_b
t_kq_hook:
    s_cmp_eq_u32 s43, 1
    s_cbranch_scc1 t_kq_sig0
    s_cmp_lt_u32 s43, 8
    s_cbranch_scc1 t_kq_as
    s_cmp_eq_u32 s43, 14
    s_cbranch_scc1 t_kq_sws
    s_cmp_eq_u32 s43, 15
    s_cbranch_scc1 t_kq_swp
    s_cmp_lg_u32 s58, 0
    s_cbranch_scc1 t_kq_a
    s_cmp_eq_u32 s43, 13
    s_cbranch_scc1 t_kq_wait
    s_cmp_lg_u32 s43, 9
    s_cbranch_scc1 t_kq_a
    s_cmp_eq_u32 s4, 0
    s_cbranch_scc1 t_kq_a
    v_mov_b32 v24, s4
    v_mov_b32 v25, 1
    s_mov_b64 exec, 1
    global_atomic_add v24, v25, s[98:99] sc1
    s_mov_b64 exec, -1
    s_branch t_kq_a
t_kq_sig0:
    s_cmp_eq_u32 s1, 0
    s_cbranch_scc1 t_kq_as
    v_mov_b32 v24, s1
    v_mov_b32 v25, 1
    s_mov_b64 exec, 1
    global_atomic_add v24, v25, s[98:99] sc1
    s_mov_b64 exec, -1
    s_mov_b32 s1, 0
    s_branch t_kq_as
t_kq_wait:
    s_cmp_eq_u32 s3, 0
    s_cbranch_scc1 t_kq_a
    s_mov_b32 s62, 0
L_sw_68:
    s_load_dword s63, s[98:99], s3 glc
    s_add_u32 s62, s62, 1
    s_cmp_gt_u32 s62, 0x200000
    s_cbranch_scc1 chain_kernel_wabort
    s_waitcnt lgkmcnt(0)
    s_cmp_ge_u32 s63, s2
    s_cbranch_scc1 L_swok_69
    s_sleep 16
    s_branch L_sw_68
L_swok_69:
    s_branch t_kq_a
t_kq_sws:
    s_mov_b32 s12, s36
    s_mov_b32 s13, s37
    s_mov_b32 s14, s38
    s_and_b32 s45, s45, 0xffffb7ff
    s_bitcmp1_b32 s94, 1
    s_cselect_b32 s24, s41, 0
    s_cselect_b32 s26, 0, s41
    s_cselect_b32 s60, 0x4000, 0
    s_or_b32 s45, s45, s60
    s_add_u32 s24, s24, s39
    s_add_u32 s26, s26, s39
    s_bitcmp1_b32 s94, 0
    s_cselect_b32 s61, s40, 0
    s_cselect_b32 s62, 0, s40
    s_cselect_b32 s60, 0x800, 0
    s_or_b32 s45, s45, s60
    s_add_u32 s25, s24, s62
    s_add_u32 s24, s24, s61
    s_add_u32 s27, s26, s62
    s_add_u32 s26, s26, s61
    s_mov_b32 s28, s42
    v_mov_b32 v6, v10
    v_mov_b32 v7, v11
    s_branch t_kq_a
t_kq_swp:
    s_mov_b32 s8, s30
    s_mov_b32 s9, s31
    s_mov_b32 s10, s32
    s_and_b32 s44, s44, 0xffffb7ff
    s_bitcmp1_b32 s84, 1
    s_cselect_b32 s20, s35, 0
    s_cselect_b32 s22, 0, s35
    s_cselect_b32 s60, 0x4000, 0
    s_or_b32 s44, s44, s60
    s_add_u32 s20, s20, s33
    s_add_u32 s22, s22, s33
    s_bitcmp1_b32 s84, 0
    s_cselect_b32 s61, s34, 0
    s_cselect_b32 s62, 0, s34
    s_cselect_b32 s60, 0x800, 0
    s_or_b32 s44, s44, s60
    s_add_u32 s21, s20, s62
    s_add_u32 s20, s20, s61
    s_add_u32 s23, s22, s62
    s_add_u32 s22, s22, s61
    v_mov_b32 v4, v8
    v_mov_b32 v5, v9
t_kq_a:
    s_waitcnt lgkmcnt(8)
    v_mfma_f32_16x16x32_bf16 a[0:3], v[72:75], v[40:43], a[0:3]
    s_xor_b32 m0, s44, 0
    v_mfma_f32_16x16x32_bf16 a[32:35], v[72:75], v[44:47], a[32:35]
    buffer_load_dwordx4 v4, s[8:11], s20 offen lds
    s_waitcnt lgkmcnt(6)
    v_mfma_f32_16x16x32_bf16 a[36:39], v[76:79], v[44:47], a[36:39]
    ds_read_b64_tr_b16 v[80:81], v16 offset:0
    s_xor_b32 m0, s44, 1024
    v_mfma_f32_16x16x32_bf16 a[4:7], v[76:79], v[40:43], a[4:7]
    buffer_load_dwordx4 v5, s[8:11], s20 offen lds
    s_waitcnt lgkmcnt(5)
    v_mfma_f32_16x16x32_bf16 a[64:67], v[72:75], v[48:51], a[64:67]
    ds_read_b64_tr_b16 v[82:83], v16 offset:2048
    s_add_u32 s20, s20, 128
    v_mfma_f32_16x16x32_bf16 a[96:99], v[72:75], v[52:55], a[96:99]
    s_xor_b32 m0, s45, 0
    v_mfma_f32_16x16x32_bf16 a[100:103], v[76:79], v[52:55], a[100:103]
    ds_read_b64_tr_b16 v[84:85], v17 offset:0
    buffer_load_dwordx4 v6, s[12:15], s24 offen lds
    v_mfma_f32_16x16x32_bf16 a[68:71], v[76:79], v[48:51], a[68:71]
    s_xor_b32 m0, s45, 1024
    s_waitcnt lgkmcnt(5)
    v_mfma_f32_16x16x32_bf16 a[128:131], v[72:75], v[56:59], a[128:131]
    ds_read_b64_tr_b16 v[86:87], v17 offset:2048
    buffer_load_dwordx4 v7, s[12:15], s24 offen lds
    v_mfma_f32_16x16x32_bf16 a[160:163], v[72:75], v[60:63], a[160:163]
    s_add_u32 s24, s24, s28
    v_mfma_f32_16x16x32_bf16 a[164:167], v[76:79], v[60:63], a[164:167]
    v_mfma_f32_16x16x32_bf16 a[132:135], v[76:79], v[56:59], a[132:135]
    s_waitcnt lgkmcnt(4)
    v_mfma_f32_16x16x32_bf16 a[192:195], v[72:75], v[64:67], a[192:195]
    v_mfma_f32_16x16x32_bf16 a[224:227], v[72:75], v[68:71], a[224:227]
    v_mfma_f32_16x16x32_bf16 a[228:231], v[76:79], v[68:71], a[228:231]
    v_mfma_f32_16x16x32_bf16 a[196:199], v[76:79], v[64:67], a[196:199]
    s_waitcnt lgkmcnt(2)
    v_mfma_f32_16x16x32_bf16 a[8:11], v[80:83], v[40:43], a[8:11]
    v_mfma_f32_16x16x32_bf16 a[40:43], v[80:83], v[44:47], a[40:43]
    s_waitcnt lgkmcnt(0)
    v_mfma_f32_16x16x32_bf16 a[44:47], v[84:87], v[44:47], a[44:47]
    ds_read_b64_tr_b16 v[72:73], v18 offset:0
    v_mfma_f32_16x16x32_bf16 a[12:15], v[84:87], v[40:43], a[12:15]
    v_mfma_f32_16x16x32_bf16 a[72:75], v[80:83], v[48:51], a[72:75]
    ds_read_b64_tr_b16 v[74:75], v18 offset:2048
    v_mfma_f32_16x16x32_bf16 a[104:107], v[80:83], v[52:55], a[104:107]
    v_mfma_f32_16x16x32_bf16 a[108:111], v[84:87], v[52:55], a[108:111]
    ds_read_b64_tr_b16 v[76:77], v19 offset:0
    v_mfma_f32_16x16x32_bf16 a[76:79], v[84:87], v[48:51], a[76:79]
    v_mfma_f32_16x16x32_bf16 a[136:139], v[80:83], v[56:59], a[136:139]
    ds_read_b64_tr_b16 v[78:79], v19 offset:2048
    v_mfma_f32_16x16x32_bf16 a[168:171], v[80:83], v[60:63], a[168:171]
    v_mfma_f32_16x16x32_bf16 a[172:175], v[84:87], v[60:63], a[172:175]
    v_mfma_f32_16x16x32_bf16 a[140:143], v[84:87], v[56:59], a[140:143]
    v_mfma_f32_16x16x32_bf16 a[200:203], v[80:83], v[64:67], a[200:203]
    v_mfma_f32_16x16x32_bf16 a[232:235], v[80:83], v[68:71], a[232:235]
    v_mfma_f32_16x16x32_bf16 a[236:239], v[84:87], v[68:71], a[236:239]
    v_mfma_f32_16x16x32_bf16 a[204:207], v[84:87], v[64:67], a[204:207]
    s_waitcnt lgkmcnt(2)
    v_mfma_f32_16x16x32_bf16 a[16:19], v[72:75], v[40:43], a[16:19]
    v_mfma_f32_16x16x32_bf16 a[48:51], v[72:75], v[44:47], a[48:51]
    s_waitcnt lgkmcnt(0)
    v_mfma_f32_16x16x32_bf16 a[52:55], v[76:79], v[44:47], a[52:55]
    ds_read_b64_tr_b16 v[80:81], v20 offset:0
    v_mfma_f32_16x16x32_bf16 a[20:23], v[76:79], v[40:43], a[20:23]
    v_mfma_f32_16x16x32_bf16 a[80:83], v[72:75], v[48:51], a[80:83]
    ds_read_b64_tr_b16 v[82:83], v20 offset:2048
    v_mfma_f32_16x16x32_bf16 a[112:115], v[72:75], v[52:55], a[112:115]
    v_mfma_f32_16x16x32_bf16 a[116:119], v[76:79], v[52:55], a[116:119]
    ds_read_b64_tr_b16 v[84:85], v21 offset:0
    v_mfma_f32_16x16x32_bf16 a[84:87], v[76:79], v[48:51], a[84:87]
    v_mfma_f32_16x16x32_bf16 a[144:147], v[72:75], v[56:59], a[144:147]
    ds_read_b64_tr_b16 v[86:87], v21 offset:2048
    v_mfma_f32_16x16x32_bf16 a[176:179], v[72:75], v[60:63], a[176:179]
    v_mfma_f32_16x16x32_bf16 a[180:183], v[76:79], v[60:63], a[180:183]
    v_mfma_f32_16x16x32_bf16 a[148:151], v[76:79], v[56:59], a[148:151]
    v_mfma_f32_16x16x32_bf16 a[208:211], v[72:75], v[64:67], a[208:211]
    v_mfma_f32_16x16x32_bf16 a[240:243], v[72:75], v[68:71], a[240:243]
    v_mfma_f32_16x16x32_bf16 a[244:247], v[76:79], v[68:71], a[244:247]
    v_mfma_f32_16x16x32_bf16 a[212:215], v[76:79], v[64:67], a[212:215]
    s_waitcnt lgkmcnt(2)
    v_mfma_f32_16x16x32_bf16 a[24:27], v[80:83], v[40:43], a[24:27]
    ds_read_b64_tr_b16 v[72:73], v14 offset:16384
    v_mfma_f32_16x16x32_bf16 a[56:59], v[80:83], v[44:47], a[56:59]
    ds_read_b64_tr_b16 v[74:75], v14 offset:18432
    s_waitcnt lgkmcnt(2)
    v_mfma_f32_16x16x32_bf16 a[60:63], v[84:87], v[44:47], a[60:63]
    ds_read_b128 v[44:47], v13 offset:2048
    v_mfma_f32_16x16x32_bf16 a[28:31], v[84:87], v[40:43], a[28:31]
    ds_read_b128 v[40:43], v13 offset:0
    v_mfma_f32_16x16x32_bf16 a[88:91], v[80:83], v[48:51], a[88:91]
    ds_read_b64_tr_b16 v[76:77], v15 offset:16384
    v_mfma_f32_16x16x32_bf16 a[120:123], v[80:83], v[52:55], a[120:123]
    ds_read_b64_tr_b16 v[78:79], v15 offset:18432
    v_mfma_f32_16x16x32_bf16 a[124:127], v[84:87], v[52:55], a[124:127]
    ds_read_b128 v[52:55], v13 offset:6144
    v_mfma_f32_16x16x32_bf16 a[92:95], v[84:87], v[48:51], a[92:95]
    ds_read_b128 v[48:51], v13 offset:4096
    v_mfma_f32_16x16x32_bf16 a[152:155], v[80:83], v[56:59], a[152:155]
    s_xor_b32 m0, s44, 2048
    v_mfma_f32_16x16x32_bf16 a[184:187], v[80:83], v[60:63], a[184:187]
    buffer_load_dwordx4 v4, s[8:11], s21 offen lds
    v_mfma_f32_16x16x32_bf16 a[188:191], v[84:87], v[60:63], a[188:191]
    ds_read_b128 v[60:63], v13 offset:10240
    v_mfma_f32_16x16x32_bf16 a[156:159], v[84:87], v[56:59], a[156:159]
    ds_read_b128 v[56:59], v13 offset:8192
    v_mfma_f32_16x16x32_bf16 a[216:219], v[80:83], v[64:67], a[216:219]
    s_xor_b32 m0, s44, 3072
    v_mfma_f32_16x16x32_bf16 a[248:251], v[80:83], v[68:71], a[248:251]
    buffer_load_dwordx4 v5, s[8:11], s21 offen lds
    v_mfma_f32_16x16x32_bf16 a[252:255], v[84:87], v[68:71], a[252:255]
    ds_read_b128 v[68:71], v13 offset:14336
    s_add_u32 s21, s21, 128
    v_mfma_f32_16x16x32_bf16 a[220:223], v[84:87], v[64:67], a[220:223]
    ds_read_b128 v[64:67], v13 offset:12288
t_kq_b:
    s_waitcnt lgkmcnt(8)
    v_mfma_f32_16x16x32_bf16 a[0:3], v[72:75], v[40:43], a[0:3]
    v_mfma_f32_16x16x32_bf16 a[32:35], v[72:75], v[44:47], a[32:35]
    s_xor_b32 m0, s44, 16384
    s_waitcnt lgkmcnt(6)
    v_mfma_f32_16x16x32_bf16 a[36:39], v[76:79], v[44:47], a[36:39]
    ds_read_b64_tr_b16 v[80:81], v16 offset:16384
    buffer_load_dwordx4 v4, s[8:11], s22 offen lds
    v_mfma_f32_16x16x32_bf16 a[4:7], v[76:79], v[40:43], a[4:7]
    s_cmp_ge_u32 s48, 98304
    s_waitcnt lgkmcnt(5)
    v_mfma_f32_16x16x32_bf16 a[64:67], v[72:75], v[48:51], a[64:67]
    ds_read_b64_tr_b16 v[82:83], v16 offset:18432
    s_cselect_b32 s46, s6, s7
    v_mfma_f32_16x16x32_bf16 a[96:99], v[72:75], v[52:55], a[96:99]
    s_add_u32 s48, s48, s46
    s_xor_b32 m0, s44, 17408
    v_mfma_f32_16x16x32_bf16 a[100:103], v[76:79], v[52:55], a[100:103]
    ds_read_b64_tr_b16 v[84:85], v17 offset:16384
    buffer_load_dwordx4 v5, s[8:11], s22 offen lds
    v_mfma_f32_16x16x32_bf16 a[68:71], v[76:79], v[48:51], a[68:71]
    s_add_u32 s22, s22, 128
    s_waitcnt lgkmcnt(5)
    v_mfma_f32_16x16x32_bf16 a[128:131], v[72:75], v[56:59], a[128:131]
    ds_read_b64_tr_b16 v[86:87], v17 offset:18432
    s_cmp_ge_u32 s49, 98304
    v_mfma_f32_16x16x32_bf16 a[160:163], v[72:75], v[60:63], a[160:163]
    s_cselect_b32 s47, s6, s7
    s_add_u32 s49, s49, s47
    v_mfma_f32_16x16x32_bf16 a[164:167], v[76:79], v[60:63], a[164:167]
    s_xor_b32 m0, s44, 18432
    v_mfma_f32_16x16x32_bf16 a[132:135], v[76:79], v[56:59], a[132:135]
    buffer_load_dwordx4 v4, s[8:11], s23 offen lds
    s_waitcnt lgkmcnt(4)
    v_mfma_f32_16x16x32_bf16 a[192:195], v[72:75], v[64:67], a[192:195]
    v_mfma_f32_16x16x32_bf16 a[224:227], v[72:75], v[68:71], a[224:227]
    s_xor_b32 m0, s44, 19456
    v_mfma_f32_16x16x32_bf16 a[228:231], v[76:79], v[68:71], a[228:231]
    buffer_load_dwordx4 v5, s[8:11], s23 offen lds
    v_mfma_f32_16x16x32_bf16 a[196:199], v[76:79], v[64:67], a[196:199]
    s_add_u32 s23, s23, 128
    s_waitcnt lgkmcnt(2)
    v_mfma_f32_16x16x32_bf16 a[8:11], v[80:83], v[40:43], a[8:11]
    s_cmp_ge_u32 s44, 98304
    s_cselect_b32 s60, s6, s7
    v_mfma_f32_16x16x32_bf16 a[40:43], v[80:83], v[44:47], a[40:43]
    s_add_u32 s44, s44, s60
    s_waitcnt lgkmcnt(0)
    v_mfma_f32_16x16x32_bf16 a[44:47], v[84:87], v[44:47], a[44:47]
    ds_read_b64_tr_b16 v[72:73], v18 offset:16384
    v_add_u32 v12, s46, v12
    v_mfma_f32_16x16x32_bf16 a[12:15], v[84:87], v[40:43], a[12:15]
    v_add_u32 v13, s46, v13
    v_add_u32 v14, s47, v14
    v_mfma_f32_16x16x32_bf16 a[72:75], v[80:83], v[48:51], a[72:75]
    ds_read_b64_tr_b16 v[74:75], v18 offset:18432
    s_xor_b32 m0, s45, 2048
    v_mfma_f32_16x16x32_bf16 a[104:107], v[80:83], v[52:55], a[104:107]
    buffer_load_dwordx4 v6, s[12:15], s25 offen lds
    v_mfma_f32_16x16x32_bf16 a[108:111], v[84:87], v[52:55], a[108:111]
    ds_read_b64_tr_b16 v[76:77], v19 offset:16384
    v_add_u32 v15, s47, v15
    v_mfma_f32_16x16x32_bf16 a[76:79], v[84:87], v[48:51], a[76:79]
    v_add_u32 v16, s47, v16
    v_mfma_f32_16x16x32_bf16 a[136:139], v[80:83], v[56:59], a[136:139]
    ds_read_b64_tr_b16 v[78:79], v19 offset:18432
    s_xor_b32 m0, s45, 3072
    v_mfma_f32_16x16x32_bf16 a[168:171], v[80:83], v[60:63], a[168:171]
    buffer_load_dwordx4 v7, s[12:15], s25 offen lds
    v_mfma_f32_16x16x32_bf16 a[172:175], v[84:87], v[60:63], a[172:175]
    s_add_u32 s25, s25, s28
    v_add_u32 v17, s47, v17
    v_mfma_f32_16x16x32_bf16 a[140:143], v[84:87], v[56:59], a[140:143]
    v_mfma_f32_16x16x32_bf16 a[200:203], v[80:83], v[64:67], a[200:203]
    s_xor_b32 m0, s45, 16384
    v_mfma_f32_16x16x32_bf16 a[232:235], v[80:83], v[68:71], a[232:235]
    buffer_load_dwordx4 v6, s[12:15], s26 offen lds
    v_mfma_f32_16x16x32_bf16 a[236:239], v[84:87], v[68:71], a[236:239]
    v_add_u32 v18, s47, v18
    v_mfma_f32_16x16x32_bf16 a[204:207], v[84:87], v[64:67], a[204:207]
    v_add_u32 v19, s47, v19
    s_waitcnt lgkmcnt(2)
    v_mfma_f32_16x16x32_bf16 a[16:19], v[72:75], v[40:43], a[16:19]
    s_xor_b32 m0, s45, 17408
    v_mfma_f32_16x16x32_bf16 a[48:51], v[72:75], v[44:47], a[48:51]
    buffer_load_dwordx4 v7, s[12:15], s26 offen lds
    s_waitcnt lgkmcnt(0)
    v_mfma_f32_16x16x32_bf16 a[52:55], v[76:79], v[44:47], a[52:55]
    ds_read_b64_tr_b16 v[80:81], v20 offset:16384
    s_add_u32 s26, s26, s28
    v_mfma_f32_16x16x32_bf16 a[20:23], v[76:79], v[40:43], a[20:23]
    v_mfma_f32_16x16x32_bf16 a[80:83], v[72:75], v[48:51], a[80:83]
    ds_read_b64_tr_b16 v[82:83], v20 offset:18432
    s_xor_b32 m0, s45, 18432
    v_mfma_f32_16x16x32_bf16 a[112:115], v[72:75], v[52:55], a[112:115]
    buffer_load_dwordx4 v6, s[12:15], s27 offen lds
    v_mfma_f32_16x16x32_bf16 a[116:119], v[76:79], v[52:55], a[116:119]
    ds_read_b64_tr_b16 v[84:85], v21 offset:16384
    v_mfma_f32_16x16x32_bf16 a[84:87], v[76:79], v[48:51], a[84:87]
    s_xor_b32 m0, s45, 19456
    v_mfma_f32_16x16x32_bf16 a[144:147], v[72:75], v[56:59], a[144:147]
    ds_read_b64_tr_b16 v[86:87], v21 offset:18432
    buffer_load_dwordx4 v7, s[12:15], s27 offen lds
    v_mfma_f32_16x16x32_bf16 a[176:179], v[72:75], v[60:63], a[176:179]
    s_add_u32 s27, s27, s28
    s_cmp_ge_u32 s45, 98304
    v_mfma_f32_16x16x32_bf16 a[180:183], v[76:79], v[60:63], a[180:183]
    s_cselect_b32 s60, s6, s7
    s_add_u32 s45, s45, s60
    v_mfma_f32_16x16x32_bf16 a[148:151], v[76:79], v[56:59], a[148:151]
    v_add_u32 v20, s47, v20
    v_add_u32 v21, s47, v21
    v_mfma_f32_16x16x32_bf16 a[208:211], v[72:75], v[64:67], a[208:211]
    s_add_u32 s43, s43, 1
    s_cmp_eq_u32 s43, 16
    v_mfma_f32_16x16x32_bf16 a[240:243], v[72:75], v[68:71], a[240:243]
    v_mfma_f32_16x16x32_bf16 a[244:247], v[76:79], v[68:71], a[244:247]
    v_mfma_f32_16x16x32_bf16 a[212:215], v[76:79], v[64:67], a[212:215]
    s_waitcnt vmcnt(6) lgkmcnt(0)
    s_barrier
    s_cbranch_scc1 t_kq_last
    v_mfma_f32_16x16x32_bf16 a[24:27], v[80:83], v[40:43], a[24:27]
    ds_read_b64_tr_b16 v[72:73], v14 offset:0
    v_mfma_f32_16x16x32_bf16 a[56:59], v[80:83], v[44:47], a[56:59]
    ds_read_b64_tr_b16 v[74:75], v14 offset:2048
    v_mfma_f32_16x16x32_bf16 a[60:63], v[84:87], v[44:47], a[60:63]
    ds_read_b128 v[44:47], v12 offset:2048
    v_mfma_f32_16x16x32_bf16 a[28:31], v[84:87], v[40:43], a[28:31]
    ds_read_b128 v[40:43], v12 offset:0
    v_mfma_f32_16x16x32_bf16 a[88:91], v[80:83], v[48:51], a[88:91]
    ds_read_b64_tr_b16 v[76:77], v15 offset:0
    v_mfma_f32_16x16x32_bf16 a[120:123], v[80:83], v[52:55], a[120:123]
    ds_read_b64_tr_b16 v[78:79], v15 offset:2048
    v_mfma_f32_16x16x32_bf16 a[124:127], v[84:87], v[52:55], a[124:127]
    ds_read_b128 v[52:55], v12 offset:6144
    v_mfma_f32_16x16x32_bf16 a[92:95], v[84:87], v[48:51], a[92:95]
    ds_read_b128 v[48:51], v12 offset:4096
    v_mfma_f32_16x16x32_bf16 a[152:155], v[80:83], v[56:59], a[152:155]
    v_mfma_f32_16x16x32_bf16 a[184:187], v[80:83], v[60:63], a[184:187]
    v_mfma_f32_16x16x32_bf16 a[188:191], v[84:87], v[60:63], a[188:191]
    ds_read_b128 v[60:63], v12 offset:10240
    v_mfma_f32_16x16x32_bf16 a[156:159], v[84:87], v[56:59], a[156:159]
    ds_read_b128 v[56:59], v12 offset:8192
    v_mfma_f32_16x16x32_bf16 a[216:219], v[80:83], v[64:67], a[216:219]
    s_sub_u32 s61, s43, 10
    s_cmp_lt_u32 s61, 3
    v_mfma_f32_16x16x32_bf16 a[248:251], v[80:83], v[68:71], a[248:251]
    v_mfma_f32_16x16x32_bf16 a[252:255], v[84:87], v[68:71], a[252:255]
    ds_read_b128 v[68:71], v12 offset:14336
    v_mfma_f32_16x16x32_bf16 a[220:223], v[84:87], v[64:67], a[220:223]
    ds_read_b128 v[64:67], v12 offset:12288
    s_cbranch_scc1 t_kq_a
    s_branch t_kq_hook
t_kq_last:
    v_mfma_f32_16x16x32_bf16 a[24:27], v[80:83], v[40:43], a[24:27]
    v_mfma_f32_16x16x32_bf16 a[56:59], v[80:83], v[44:47], a[56:59]
    v_mfma_f32_16x16x32_bf16 a[60:63], v[84:87], v[44:47], a[60:63]
    v_mfma_f32_16x16x32_bf16 a[28:31], v[84:87], v[40:43], a[28:31]
    v_mfma_f32_16x16x32_bf16 a[88:91], v[80:83], v[48:51], a[88:91]
    v_mfma_f32_16x16x32_bf16 a[120:123], v[80:83], v[52:55], a[120:123]
    v_mfma_f32_16x16x32_bf16 a[124:127], v[84:87], v[52:55], a[124:127]
    v_mfma_f32_16x16x32_bf16 a[92:95], v[84:87], v[48:51], a[92:95]
    v_mfma_f32_16x16x32_bf16 a[152:155], v[80:83], v[56:59], a[152:155]
    v_mfma_f32_16x16x32_bf16 a[184:187], v[80:83], v[60:63], a[184:187]
    v_mfma_f32_16x16x32_bf16 a[188:191], v[84:87], v[60:63], a[188:191]
    v_mfma_f32_16x16x32_bf16 a[156:159], v[84:87], v[56:59], a[156:159]
    v_mfma_f32_16x16x32_bf16 a[216:219], v[80:83], v[64:67], a[216:219]
    v_mfma_f32_16x16x32_bf16 a[248:251], v[80:83], v[68:71], a[248:251]
    v_mfma_f32_16x16x32_bf16 a[252:255], v[84:87], v[68:71], a[252:255]
    v_mfma_f32_16x16x32_bf16 a[220:223], v[84:87], v[64:67], a[220:223]
    s_setpc_b64 s[54:55]
t_g2_c:
    s_mov_b32 s43, 0
    v_bfe_u32 v16, v0, 5, 1
    v_lshlrev_b32 v23, 13, v16
    v_bfe_u32 v16, v0, 7, 1
    v_lshl_add_u32 v23, v16, 12, v23
    v_bfe_u32 v16, v0, 1, 1
    v_lshl_add_u32 v23, v16, 8, v23
    v_bfe_u32 v16, v0, 1, 1
    v_lshl_add_u32 v23, v16, 6, v23
    v_bfe_u32 v16, v0, 4, 1
    v_lshl_add_u32 v23, v16, 7, v23
    v_bfe_u32 v16, v0, 2, 2
    v_lshl_add_u32 v23, v16, 4, v23
    v_bfe_u32 v16, v0, 0, 1
    v_lshl_add_u32 v23, v16, 3, v23
    v_add_u32 v14, s49, v23
    v_xor_b32 v15, 64, v14
    ds_read_b64_tr_b16 v[72:73], v14 offset:0
    ds_read_b64_tr_b16 v[74:75], v15 offset:0
    ds_read_b128 v[44:47], v12 offset:2048
    ds_read_b128 v[40:43], v12 offset:0
    ds_read_b64_tr_b16 v[76:77], v14 offset:512
    ds_read_b64_tr_b16 v[78:79], v15 offset:512
    ds_read_b128 v[52:55], v12 offset:6144
    ds_read_b128 v[48:51], v12 offset:4096
    ds_read_b128 v[60:63], v12 offset:10240
    ds_read_b128 v[56:59], v12 offset:8192
    ds_read_b128 v[68:71], v12 offset:14336
    ds_read_b128 v[64:67], v12 offset:12288
    s_branch t_g2_as
t_g2:
    s_mov_b32 s43, 0
    v_bfe_u32 v16, v0, 5, 1
    v_lshlrev_b32 v23, 13, v16
    v_bfe_u32 v16, v0, 7, 1
    v_lshl_add_u32 v23, v16, 12, v23
    v_bfe_u32 v16, v0, 1, 1
    v_lshl_add_u32 v23, v16, 8, v23
    v_bfe_u32 v16, v0, 1, 1
    v_lshl_add_u32 v23, v16, 6, v23
    v_bfe_u32 v16, v0, 4, 1
    v_lshl_add_u32 v23, v16, 7, v23
    v_bfe_u32 v16, v0, 2, 2
    v_lshl_add_u32 v23, v16, 4, v23
    v_bfe_u32 v16, v0, 0, 1
    v_lshl_add_u32 v23, v16, 3, v23
    v_add_u32 v14, s49, v23
    v_xor_b32 v15, 64, v14
    ds_read_b64_tr_b16 v[72:73], v14 offset:0
    ds_read_b64_tr_b16 v[74:75], v15 offset:0
    ds_read_b128 v[44:47], v12 offset:2048
    ds_read_b128 v[40:43], v12 offset:0
    ds_read_b64_tr_b16 v[76:77], v14 offset:512
    ds_read_b64_tr_b16 v[78:79], v15 offset:512
    ds_read_b128 v[52:55], v12 offset:6144
    ds_read_b128 v[48:51], v12 offset:4096
    ds_read_b128 v[60:63], v12 offset:10240
    ds_read_b128 v[56:59], v12 offset:8192
    ds_read_b128 v[68:71], v12 offset:14336
    ds_read_b128 v[64:67], v12 offset:12288
    s_waitcnt lgkmcnt(8)
    v_mfma_f32_16x16x32_bf16 a[0:3], v[40:43], v[72:75], 0
    s_xor_b32 m0, s44, 0
    v_mfma_f32_16x16x32_bf16 a[32:35], v[44:47], v[72:75], 0
    buffer_load_dwordx4 v4, s[8:11], s20 offen lds
    s_waitcnt lgkmcnt(6)
    v_mfma_f32_16x16x32_bf16 a[36:39], v[44:47], v[76:79], 0
    ds_read_b64_tr_b16 v[80:81], v14 offset:1024
    s_xor_b32 m0, s44, 1024
    v_mfma_f32_16x16x32_bf16 a[4:7], v[40:43], v[76:79], 0
    buffer_load_dwordx4 v5, s[8:11], s20 offen lds
    s_waitcnt lgkmcnt(5)
    v_mfma_f32_16x16x32_bf16 a[64:67], v[48:51], v[72:75], 0
    ds_read_b64_tr_b16 v[82:83], v15 offset:1024
    s_add_u32 s20, s20, 128
    v_mfma_f32_16x16x32_bf16 a[96:99], v[52:55], v[72:75], 0
    s_xor_b32 m0, s45, 0
    v_mfma_f32_16x16x32_bf16 a[100:103], v[52:55], v[76:79], 0
    ds_read_b64_tr_b16 v[84:85], v14 offset:1536
    buffer_load_dwordx4 v6, s[12:15], s24 offen lds
    v_mfma_f32_16x16x32_bf16 a[68:71], v[48:51], v[76:79], 0
    s_xor_b32 m0, s45, 1024
    s_waitcnt lgkmcnt(5)
    v_mfma_f32_16x16x32_bf16 a[128:131], v[56:59], v[72:75], 0
    ds_read_b64_tr_b16 v[86:87], v15 offset:1536
    buffer_load_dwordx4 v7, s[12:15], s24 offen lds
    v_mfma_f32_16x16x32_bf16 a[160:163], v[60:63], v[72:75], 0
    s_add_u32 s24, s24, s28
    s_bitcmp1_b32 s43, 0
    v_mfma_f32_16x16x32_bf16 a[164:167], v[60:63], v[76:79], 0
    s_cselect_b32 s61, s5, 0
    s_lshl1_add_u32 s53, s61, s50
    v_mfma_f32_16x16x32_bf16 a[132:135], v[56:59], v[76:79], 0
    s_bitcmp1_b32 s43, 1
    s_waitcnt lgkmcnt(4)
    v_mfma_f32_16x16x32_bf16 a[192:195], v[64:67], v[72:75], 0
    s_cselect_b32 s61, s51, 0
    s_add_u32 s53, s53, s61
    v_mfma_f32_16x16x32_bf16 a[224:227], v[68:71], v[72:75], 0
    s_bitcmp1_b32 s43, 2
    s_cselect_b32 s61, s52, 0
    v_mfma_f32_16x16x32_bf16 a[228:231], v[68:71], v[76:79], 0
    s_add_u32 s53, s53, s61
    s_lshl_b32 s29, s43, 4
    v_mfma_f32_16x16x32_bf16 a[196:199], v[64:67], v[76:79], 0
    s_waitcnt lgkmcnt(2)
    v_mfma_f32_16x16x32_bf16 a[8:11], v[40:43], v[80:83], 0
    s_set_gpr_idx_on s29, gpr_idx(SRC0)
    v_mov_b32 v24, v128
    v_mov_b32 v25, v129
    v_mov_b32 v26, v130
    v_mov_b32 v27, v131
    s_set_gpr_idx_off
    v_mfma_f32_16x16x32_bf16 a[40:43], v[44:47], v[80:83], 0
    s_waitcnt lgkmcnt(0)
    v_mfma_f32_16x16x32_bf16 a[44:47], v[44:47], v[84:87], 0
    ds_read_b64_tr_b16 v[72:73], v14 offset:2048
    s_set_gpr_idx_on s29, gpr_idx(SRC0)
    v_mov_b32 v28, v132
    v_mov_b32 v29, v133
    v_mov_b32 v30, v134
    v_mov_b32 v31, v135
    s_set_gpr_idx_off
    v_mfma_f32_16x16x32_bf16 a[12:15], v[40:43], v[84:87], 0
    v_mfma_f32_16x16x32_bf16 a[72:75], v[48:51], v[80:83], 0
    ds_read_b64_tr_b16 v[74:75], v15 offset:2048
    s_set_gpr_idx_on s29, gpr_idx(SRC0)
    v_mov_b32 v32, v136
    v_mov_b32 v33, v137
    v_mov_b32 v34, v138
    v_mov_b32 v35, v139
    s_set_gpr_idx_off
    v_mfma_f32_16x16x32_bf16 a[104:107], v[52:55], v[80:83], 0
    v_mfma_f32_16x16x32_bf16 a[108:111], v[52:55], v[84:87], 0
    ds_read_b64_tr_b16 v[76:77], v14 offset:2560
    s_set_gpr_idx_on s29, gpr_idx(SRC0)
    v_mov_b32 v36, v140
    v_mov_b32 v37, v141
    v_mov_b32 v38, v142
    v_mov_b32 v39, v143
    s_set_gpr_idx_off
    v_mfma_f32_16x16x32_bf16 a[76:79], v[48:51], v[84:87], 0
    v_mfma_f32_16x16x32_bf16 a[136:139], v[56:59], v[80:83], 0
    ds_read_b64_tr_b16 v[78:79], v15 offset:2560
    buffer_store_dwordx4 v[24:27], v2, s[16:19], s53 offen sc1
    v_mfma_f32_16x16x32_bf16 a[168:171], v[60:63], v[80:83], 0
    v_mfma_f32_16x16x32_bf16 a[172:175], v[60:63], v[84:87], 0
    buffer_store_dwordx4 v[28:31], v3, s[16:19], s53 offen sc1
    v_mfma_f32_16x16x32_bf16 a[140:143], v[56:59], v[84:87], 0
    s_add_u32 s53, s53, s5
    v_mfma_f32_16x16x32_bf16 a[200:203], v[64:67], v[80:83], 0
    buffer_store_dwordx4 v[32:35], v2, s[16:19], s53 offen sc1
    v_mfma_f32_16x16x32_bf16 a[232:235], v[68:71], v[80:83], 0
    v_mfma_f32_16x16x32_bf16 a[236:239], v[68:71], v[84:87], 0
    buffer_store_dwordx4 v[36:39], v3, s[16:19], s53 offen sc1
    v_mfma_f32_16x16x32_bf16 a[204:207], v[64:67], v[84:87], 0
    s_waitcnt lgkmcnt(2)
    v_mfma_f32_16x16x32_bf16 a[16:19], v[40:43], v[72:75], 0
    v_mfma_f32_16x16x32_bf16 a[48:51], v[44:47], v[72:75], 0
    s_waitcnt lgkmcnt(0)
    v_mfma_f32_16x16x32_bf16 a[52:55], v[44:47], v[76:79], 0
    ds_read_b64_tr_b16 v[80:81], v14 offset:3072
    v_mfma_f32_16x16x32_bf16 a[20:23], v[40:43], v[76:79], 0
    v_mfma_f32_16x16x32_bf16 a[80:83], v[48:51], v[72:75], 0
    ds_read_b64_tr_b16 v[82:83], v15 offset:3072
    v_mfma_f32_16x16x32_bf16 a[112:115], v[52:55], v[72:75], 0
    v_mfma_f32_16x16x32_bf16 a[116:119], v[52:55], v[76:79], 0
    ds_read_b64_tr_b16 v[84:85], v14 offset:3584
    v_mfma_f32_16x16x32_bf16 a[84:87], v[48:51], v[76:79], 0
    v_mfma_f32_16x16x32_bf16 a[144:147], v[56:59], v[72:75], 0
    ds_read_b64_tr_b16 v[86:87], v15 offset:3584
    v_mfma_f32_16x16x32_bf16 a[176:179], v[60:63], v[72:75], 0
    v_mfma_f32_16x16x32_bf16 a[180:183], v[60:63], v[76:79], 0
    v_mfma_f32_16x16x32_bf16 a[148:151], v[56:59], v[76:79], 0
    v_mfma_f32_16x16x32_bf16 a[208:211], v[64:67], v[72:75], 0
    v_mfma_f32_16x16x32_bf16 a[240:243], v[68:71], v[72:75], 0
    v_mfma_f32_16x16x32_bf16 a[244:247], v[68:71], v[76:79], 0
    v_mfma_f32_16x16x32_bf16 a[212:215], v[64:67], v[76:79], 0
    s_waitcnt lgkmcnt(2)
    v_mfma_f32_16x16x32_bf16 a[24:27], v[40:43], v[80:83], 0
    ds_read_b64_tr_b16 v[72:73], v14 offset:16384
    v_mfma_f32_16x16x32_bf16 a[56:59], v[44:47], v[80:83], 0
    ds_read_b64_tr_b16 v[74:75], v15 offset:16384
    s_waitcnt lgkmcnt(2)
    v_mfma_f32_16x16x32_bf16 a[60:63], v[44:47], v[84:87], 0
    ds_read_b128 v[44:47], v13 offset:2048
    v_mfma_f32_16x16x32_bf16 a[28:31], v[40:43], v[84:87], 0
    ds_read_b128 v[40:43], v13 offset:0
    v_mfma_f32_16x16x32_bf16 a[88:91], v[48:51], v[80:83], 0
    ds_read_b64_tr_b16 v[76:77], v14 offset:16896
    v_mfma_f32_16x16x32_bf16 a[120:123], v[52:55], v[80:83], 0
    ds_read_b64_tr_b16 v[78:79], v15 offset:16896
    v_mfma_f32_16x16x32_bf16 a[124:127], v[52:55], v[84:87], 0
    ds_read_b128 v[52:55], v13 offset:6144
    v_mfma_f32_16x16x32_bf16 a[92:95], v[48:51], v[84:87], 0
    ds_read_b128 v[48:51], v13 offset:4096
    v_mfma_f32_16x16x32_bf16 a[152:155], v[56:59], v[80:83], 0
    s_xor_b32 m0, s44, 2048
    v_mfma_f32_16x16x32_bf16 a[184:187], v[60:63], v[80:83], 0
    buffer_load_dwordx4 v4, s[8:11], s21 offen lds
    v_mfma_f32_16x16x32_bf16 a[188:191], v[60:63], v[84:87], 0
    ds_read_b128 v[60:63], v13 offset:10240
    v_mfma_f32_16x16x32_bf16 a[156:159], v[56:59], v[84:87], 0
    ds_read_b128 v[56:59], v13 offset:8192
    v_mfma_f32_16x16x32_bf16 a[216:219], v[64:67], v[80:83], 0
    s_xor_b32 m0, s44, 3072
    v_mfma_f32_16x16x32_bf16 a[248:251], v[68:71], v[80:83], 0
    buffer_load_dwordx4 v5, s[8:11], s21 offen lds
    v_mfma_f32_16x16x32_bf16 a[252:255], v[68:71], v[84:87], 0
    ds_read_b128 v[68:71], v13 offset:14336
    s_add_u32 s21, s21, 128
    v_mfma_f32_16x16x32_bf16 a[220:223], v[64:67], v[84:87], 0
    ds_read_b128 v[64:67], v13 offset:12288
    s_branch t_g2_b
t_g2_as:
    s_waitcnt lgkmcnt(8)
    v_mfma_f32_16x16x32_bf16 a[0:3], v[40:43], v[72:75], a[0:3]
    s_xor_b32 m0, s44, 0
    v_mfma_f32_16x16x32_bf16 a[32:35], v[44:47], v[72:75], a[32:35]
    buffer_load_dwordx4 v4, s[8:11], s20 offen lds
    s_waitcnt lgkmcnt(6)
    v_mfma_f32_16x16x32_bf16 a[36:39], v[44:47], v[76:79], a[36:39]
    ds_read_b64_tr_b16 v[80:81], v14 offset:1024
    s_xor_b32 m0, s44, 1024
    v_mfma_f32_16x16x32_bf16 a[4:7], v[40:43], v[76:79], a[4:7]
    buffer_load_dwordx4 v5, s[8:11], s20 offen lds
    s_waitcnt lgkmcnt(5)
    v_mfma_f32_16x16x32_bf16 a[64:67], v[48:51], v[72:75], a[64:67]
    ds_read_b64_tr_b16 v[82:83], v15 offset:1024
    s_add_u32 s20, s20, 128
    v_mfma_f32_16x16x32_bf16 a[96:99], v[52:55], v[72:75], a[96:99]
    s_xor_b32 m0, s45, 0
    v_mfma_f32_16x16x32_bf16 a[100:103], v[52:55], v[76:79], a[100:103]
    ds_read_b64_tr_b16 v[84:85], v14 offset:1536
    buffer_load_dwordx4 v6, s[12:15], s24 offen lds
    v_mfma_f32_16x16x32_bf16 a[68:71], v[48:51], v[76:79], a[68:71]
    s_xor_b32 m0, s45, 1024
    s_waitcnt lgkmcnt(5)
    v_mfma_f32_16x16x32_bf16 a[128:131], v[56:59], v[72:75], a[128:131]
    ds_read_b64_tr_b16 v[86:87], v15 offset:1536
    buffer_load_dwordx4 v7, s[12:15], s24 offen lds
    v_mfma_f32_16x16x32_bf16 a[160:163], v[60:63], v[72:75], a[160:163]
    s_add_u32 s24, s24, s28
    s_bitcmp1_b32 s43, 0
    v_mfma_f32_16x16x32_bf16 a[164:167], v[60:63], v[76:79], a[164:167]
    s_cselect_b32 s61, s5, 0
    s_lshl1_add_u32 s53, s61, s50
    v_mfma_f32_16x16x32_bf16 a[132:135], v[56:59], v[76:79], a[132:135]
    s_bitcmp1_b32 s43, 1
    s_waitcnt lgkmcnt(4)
    v_mfma_f32_16x16x32_bf16 a[192:195], v[64:67], v[72:75], a[192:195]
    s_cselect_b32 s61, s51, 0
    s_add_u32 s53, s53, s61
    v_mfma_f32_16x16x32_bf16 a[224:227], v[68:71], v[72:75], a[224:227]
    s_bitcmp1_b32 s43, 2
    s_cselect_b32 s61, s52, 0
    v_mfma_f32_16x16x32_bf16 a[228:231], v[68:71], v[76:79], a[228:231]
    s_add_u32 s53, s53, s61
    s_lshl_b32 s29, s43, 4
    v_mfma_f32_16x16x32_bf16 a[196:199], v[64:67], v[76:79], a[196:199]
    s_waitcnt lgkmcnt(2)
    v_mfma_f32_16x16x32_bf16 a[8:11], v[40:43], v[80:83], a[8:11]
    s_set_gpr_idx_on s29, gpr_idx(SRC0)
    v_mov_b32 v24, v128
    v_mov_b32 v25, v129
    v_mov_b32 v26, v130
    v_mov_b32 v27, v131
    s_set_gpr_idx_off
    v_mfma_f32_16x16x32_bf16 a[40:43], v[44:47], v[80:83], a[40:43]
    s_waitcnt lgkmcnt(0)
    v_mfma_f32_16x16x32_bf16 a[44:47], v[44:47], v[84:87], a[44:47]
    ds_read_b64_tr_b16 v[72:73], v14 offset:2048
    s_set_gpr_idx_on s29, gpr_idx(SRC0)
    v_mov_b32 v28, v132
    v_mov_b32 v29, v133
    v_mov_b32 v30, v134
    v_mov_b32 v31, v135
    s_set_gpr_idx_off
    v_mfma_f32_16x16x32_bf16 a[12:15], v[40:43], v[84:87], a[12:15]
    v_mfma_f32_16x16x32_bf16 a[72:75], v[48:51], v[80:83], a[72:75]
    ds_read_b64_tr_b16 v[74:75], v15 offset:2048
    s_set_gpr_idx_on s29, gpr_idx(SRC0)
    v_mov_b32 v32, v136
    v_mov_b32 v33, v137
    v_mov_b32 v34, v138
    v_mov_b32 v35, v139
    s_set_gpr_idx_off
    v_mfma_f32_16x16x32_bf16 a[104:107], v[52:55], v[80:83], a[104:107]
    v_mfma_f32_16x16x32_bf16 a[108:111], v[52:55], v[84:87], a[108:111]
    ds_read_b64_tr_b16 v[76:77], v14 offset:2560
    s_set_gpr_idx_on s29, gpr_idx(SRC0)
    v_mov_b32 v36, v140
    v_mov_b32 v37, v141
    v_mov_b32 v38, v142
    v_mov_b32 v39, v143
    s_set_gpr_idx_off
    v_mfma_f32_16x16x32_bf16 a[76:79], v[48:51], v[84:87], a[76:79]
    v_mfma_f32_16x16x32_bf16 a[136:139], v[56:59], v[80:83], a[136:139]
    ds_read_b64_tr_b16 v[78:79], v15 offset:2560
    buffer_store_dwordx4 v[24:27], v2, s[16:19], s53 offen sc1
    v_mfma_f32_16x16x32_bf16 a[168:171], v[60:63], v[80:83], a[168:171]
    v_mfma_f32_16x16x32_bf16 a[172:175], v[60:63], v[84:87], a[172:175]
    buffer_store_dwordx4 v[28:31], v3, s[16:19], s53 offen sc1
    v_mfma_f32_16x16x32_bf16 a[140:143], v[56:59], v[84:87], a[140:143]
    s_add_u32 s53, s53, s5
    v_mfma_f32_16x16x32_bf16 a[200:203], v[64:67], v[80:83], a[200:203]
    buffer_store_dwordx4 v[32:35], v2, s[16:19], s53 offen sc1
    v_mfma_f32_16x16x32_bf16 a[232:235], v[68:71], v[80:83], a[232:235]
    v_mfma_f32_16x16x32_bf16 a[236:239], v[68:71], v[84:87], a[236:239]
    buffer_store_dwordx4 v[36:39], v3, s[16:19], s53 offen sc1
    v_mfma_f32_16x16x32_bf16 a[204:207], v[64:67], v[84:87], a[204:207]
    s_waitcnt lgkmcnt(2)
    v_mfma_f32_16x16x32_bf16 a[16:19], v[40:43], v[72:75], a[16:19]
    v_mfma_f32_16x16x32_bf16 a[48:51], v[44:47], v[72:75], a[48:51]
    s_waitcnt lgkmcnt(0)
    v_mfma_f32_16x16x32_bf16 a[52:55], v[44:47], v[76:79], a[52:55]
    ds_read_b64_tr_b16 v[80:81], v14 offset:3072
    v_mfma_f32_16x16x32_bf16 a[20:23], v[40:43], v[76:79], a[20:23]
    v_mfma_f32_16x16x32_bf16 a[80:83], v[48:51], v[72:75], a[80:83]
    ds_read_b64_tr_b16 v[82:83], v15 offset:3072
    v_mfma_f32_16x16x32_bf16 a[112:115], v[52:55], v[72:75], a[112:115]
    v_mfma_f32_16x16x32_bf16 a[116:119], v[52:55], v[76:79], a[116:119]
    ds_read_b64_tr_b16 v[84:85], v14 offset:3584
    v_mfma_f32_16x16x32_bf16 a[84:87], v[48:51], v[76:79], a[84:87]
    v_mfma_f32_16x16x32_bf16 a[144:147], v[56:59], v[72:75], a[144:147]
    ds_read_b64_tr_b16 v[86:87], v15 offset:3584
    v_mfma_f32_16x16x32_bf16 a[176:179], v[60:63], v[72:75], a[176:179]
    v_mfma_f32_16x16x32_bf16 a[180:183], v[60:63], v[76:79], a[180:183]
    v_mfma_f32_16x16x32_bf16 a[148:151], v[56:59], v[76:79], a[148:151]
    v_mfma_f32_16x16x32_bf16 a[208:211], v[64:67], v[72:75], a[208:211]
    v_mfma_f32_16x16x32_bf16 a[240:243], v[68:71], v[72:75], a[240:243]
    v_mfma_f32_16x16x32_bf16 a[244:247], v[68:71], v[76:79], a[244:247]
    v_mfma_f32_16x16x32_bf16 a[212:215], v[64:67], v[76:79], a[212:215]
    s_waitcnt lgkmcnt(2)
    v_mfma_f32_16x16x32_bf16 a[24:27], v[40:43], v[80:83], a[24:27]
    ds_read_b64_tr_b16 v[72:73], v14 offset:16384
    v_mfma_f32_16x16x32_bf16 a[56:59], v[44:47], v[80:83], a[56:59]
    ds_read_b64_tr_b16 v[74:75], v15 offset:16384
    s_waitcnt lgkmcnt(2)
    v_mfma_f32_16x16x32_bf16 a[60:63], v[44:47], v[84:87], a[60:63]
    ds_read_b128 v[44:47], v13 offset:2048
    v_mfma_f32_16x16x32_bf16 a[28:31], v[40:43], v[84:87], a[28:31]
    ds_read_b128 v[40:43], v13 offset:0
    v_mfma_f32_16x16x32_bf16 a[88:91], v[48:51], v[80:83], a[88:91]
    ds_read_b64_tr_b16 v[76:77], v14 offset:16896
    v_mfma_f32_16x16x32_bf16 a[120:123], v[52:55], v[80:83], a[120:123]
    ds_read_b64_tr_b16 v[78:79], v15 offset:16896
    v_mfma_f32_16x16x32_bf16 a[124:127], v[52:55], v[84:87], a[124:127]
    ds_read_b128 v[52:55], v13 offset:6144
    v_mfma_f32_16x16x32_bf16 a[92:95], v[48:51], v[84:87], a[92:95]
    ds_read_b128 v[48:51], v13 offset:4096
    v_mfma_f32_16x16x32_bf16 a[152:155], v[56:59], v[80:83], a[152:155]
    s_xor_b32 m0, s44, 2048
    v_mfma_f32_16x16x32_bf16 a[184:187], v[60:63], v[80:83], a[184:187]
    buffer_load_dwordx4 v4, s[8:11], s21 offen lds
    v_mfma_f32_16x16x32_bf16 a[188:191], v[60:63], v[84:87], a[188:191]
    ds_read_b128 v[60:63], v13 offset:10240
    v_mfma_f32_16x16x32_bf16 a[156:159], v[56:59], v[84:87], a[156:159]
    ds_read_b128 v[56:59], v13 offset:8192
    v_mfma_f32_16x16x32_bf16 a[216:219], v[64:67], v[80:83], a[216:219]
    s_xor_b32 m0, s44, 3072
    v_mfma_f32_16x16x32_bf16 a[248:251], v[68:71], v[80:83], a[248:251]
    buffer_load_dwordx4 v5, s[8:11], s21 offen lds
    v_mfma_f32_16x16x32_bf16 a[252:255], v[68:71], v[84:87], a[252:255]
    ds_read_b128 v[68:71], v13 offset:14336
    s_add_u32 s21, s21, 128
    v_mfma_f32_16x16x32_bf16 a[220:223], v[64:67], v[84:87], a[220:223]
    ds_read_b128 v[64:67], v13 offset:12288
    s_branch t_g2_b
t_g2_hook:
    s_cmp_eq_u32 s43, 1
    s_cbranch_scc1 t_g2_sig0
    s_cmp_lt_u32 s43, 8
    s_cbranch_scc1 t_g2_as
    s_cmp_eq_u32 s43, 14
    s_cbranch_scc1 t_g2_sws
    s_cmp_eq_u32 s43, 15
    s_cbranch_scc1 t_g2_swp
    s_cmp_lg_u32 s58, 0
    s_cbranch_scc1 t_g2_a
    s_cmp_eq_u32 s43, 13
    s_cbranch_scc1 t_g2_wait
    s_cmp_lg_u32 s43, 9
    s_cbranch_scc1 t_g2_a
    s_cmp_eq_u32 s4, 0
    s_cbranch_scc1 t_g2_a
    v_mov_b32 v24, s4
    v_mov_b32 v25, 1
    s_mov_b64 exec, 1
    global_atomic_add v24, v25, s[98:99] sc1
    s_mov_b64 exec, -1
    s_branch t_g2_a
t_g2_sig0:
    s_cmp_eq_u32 s1, 0
    s_cbranch_scc1 t_g2_as
    v_mov_b32 v24, s1
    v_mov_b32 v25, 1
    s_mov_b64 exec, 1
    global_atomic_add v24, v25, s[98:99] sc1
    s_mov_b64 exec, -1
    s_mov_b32 s1, 0
    s_branch t_g2_as
t_g2_wait:
    s_cmp_eq_u32 s3, 0
    s_cbranch_scc1 t_g2_a
    s_mov_b32 s62, 0
L_sw_70:
    s_load_dword s63, s[98:99], s3 glc
    s_add_u32 s62, s62, 1
    s_cmp_gt_u32 s62, 0x200000
    s_cbranch_scc1 chain_kernel_wabort
    s_waitcnt lgkmcnt(0)
    s_cmp_ge_u32 s63, s2
    s_cbranch_scc1 L_swok_71
    s_sleep 16
    s_branch L_sw_70
L_swok_71:
    s_branch t_g2_a
t_g2_sws:
    s_mov_b32 s12, s36
    s_mov_b32 s13, s37
    s_mov_b32 s14, s38
    s_and_b32 s45, s45, 0xffffb7ff
    s_bitcmp1_b32 s94, 1
    s_cselect_b32 s24, s41, 0
    s_cselect_b32 s26, 0, s41
    s_cselect_b32 s60, 0x4000, 0
    s_or_b32 s45, s45, s60
    s_add_u32 s24, s24, s39
    s_add_u32 s26, s26, s39
    s_bitcmp1_b32 s94, 0
    s_cselect_b32 s61, s40, 0
    s_cselect_b32 s62, 0, s40
    s_cselect_b32 s60, 0x800, 0
    s_or_b32 s45, s45, s60
    s_add_u32 s25, s24, s62
    s_add_u32 s24, s24, s61
    s_add_u32 s27, s26, s62
    s_add_u32 s26, s26, s61
    s_mov_b32 s28, s42
    v_mov_b32 v6, v10
    v_mov_b32 v7, v11
    s_branch t_g2_a
t_g2_swp:
    s_mov_b32 s8, s30
    s_mov_b32 s9, s31
    s_mov_b32 s10, s32
    s_and_b32 s44, s44, 0xffffb7ff
    s_bitcmp1_b32 s84, 1
    s_cselect_b32 s20, s35, 0
    s_cselect_b32 s22, 0, s35
    s_cselect_b32 s60, 0x4000, 0
    s_or_b32 s44, s44, s60
    s_add_u32 s20, s20, s33
    s_add_u32 s22, s22, s33
    s_bitcmp1_b32 s84, 0
    s_cselect_b32 s61, s34, 0
    s_cselect_b32 s62, 0, s34
    s_cselect_b32 s60, 0x800, 0
    s_or_b32 s44, s44, s60
    s_add_u32 s21, s20, s62
    s_add_u32 s20, s20, s61
    s_add_u32 s23, s22, s62
    s_add_u32 s22, s22, s61
    v_mov_b32 v4, v8
    v_mov_b32 v5, v9
t_g2_a:
    s_waitcnt lgkmcnt(8)
    v_mfma_f32_16x16x32_bf16 a[0:3], v[40:43], v[72:75], a[0:3]
    s_xor_b32 m0, s44, 0
    v_mfma_f32_16x16x32_bf16 a[32:35], v[44:47], v[72:75], a[32:35]
    buffer_load_dwordx4 v4, s[8:11], s20 offen lds
    s_waitcnt lgkmcnt(6)
    v_mfma_f32_16x16x32_bf16 a[36:39], v[44:47], v[76:79], a[36:39]
    ds_read_b64_tr_b16 v[80:81], v14 offset:1024
    s_xor_b32 m0, s44, 1024
    v_mfma_f32_16x16x32_bf16 a[4:7], v[40:43], v[76:79], a[4:7]
    buffer_load_dwordx4 v5, s[8:11], s20 offen lds
    s_waitcnt lgkmcnt(5)
    v_mfma_f32_16x16x32_bf16 a[64:67], v[48:51], v[72:75], a[64:67]
    ds_read_b64_tr_b16 v[82:83], v15 offset:1024
    s_add_u32 s20, s20, 128
    v_mfma_f32_16x16x32_bf16 a[96:99], v[52:55], v[72:75], a[96:99]
    s_xor_b32 m0, s45, 0
    v_mfma_f32_16x16x32_bf16 a[100:103], v[52:55], v[76:79], a[100:103]
    ds_read_b64_tr_b16 v[84:85], v14 offset:1536
    buffer_load_dwordx4 v6, s[12:15], s24 offen lds
    v_mfma_f32_16x16x32_bf16 a[68:71], v[48:51], v[76:79], a[68:71]
    s_xor_b32 m0, s45, 1024
    s_waitcnt lgkmcnt(5)
    v_mfma_f32_16x16x32_bf16 a[128:131], v[56:59], v[72:75], a[128:131]
    ds_read_b64_tr_b16 v[86:87], v15 offset:1536
    buffer_load_dwordx4 v7, s[12:15], s24 offen lds
    v_mfma_f32_16x16x32_bf16 a[160:163], v[60:63], v[72:75], a[160:163]
    s_add_u32 s24, s24, s28
    v_mfma_f32_16x16x32_bf16 a[164:167], v[60:63], v[76:79], a[164:167]
    v_mfma_f32_16x16x32_bf16 a[132:135], v[56:59], v[76:79], a[132:135]
    s_waitcnt lgkmcnt(4)
    v_mfma_f32_16x16x32_bf16 a[192:195], v[64:67], v[72:75], a[192:195]
    v_mfma_f32_16x16x32_bf16 a[224:227], v[68:71], v[72:75], a[224:227]
    v_mfma_f32_16x16x32_bf16 a[228:231], v[68:71], v[76:79], a[228:231]
    v_mfma_f32_16x16x32_bf16 a[196:199], v[64:67], v[76:79], a[196:199]
    s_waitcnt lgkmcnt(2)
    v_mfma_f32_16x16x32_bf16 a[8:11], v[40:43], v[80:83], a[8:11]
    v_mfma_f32_16x16x32_bf16 a[40:43], v[44:47], v[80:83], a[40:43]
    s_waitcnt lgkmcnt(0)
    v_mfma_f32_16x16x32_bf16 a[44:47], v[44:47], v[84:87], a[44:47]
    ds_read_b64_tr_b16 v[72:73], v14 offset:2048
    v_mfma_f32_16x16x32_bf16 a[12:15], v[40:43], v[84:87], a[12:15]
    v_mfma_f32_16x16x32_bf16 a[72:75], v[48:51], v[80:83], a[72:75]
    ds_read_b64_tr_b16 v[74:75], v15 offset:2048
    v_mfma_f32_16x16x32_bf16 a[104:107], v[52:55], v[80:83], a[104:107]
    v_mfma_f32_16x16x32_bf16 a[108:111], v[52:55], v[84:87], a[108:111]
    ds_read_b64_tr_b16 v[76:77], v14 offset:2560
    v_mfma_f32_16x16x32_bf16 a[76:79], v[48:51], v[84:87], a[76:79]
    v_mfma_f32_16x16x32_bf16 a[136:139], v[56:59], v[80:83], a[136:139]
    ds_read_b64_tr_b16 v[78:79], v15 offset:2560
    v_mfma_f32_16x16x32_bf16 a[168:171], v[60:63], v[80:83], a[168:171]
    v_mfma_f32_16x16x32_bf16 a[172:175], v[60:63], v[84:87], a[172:175]
    v_mfma_f32_16x16x32_bf16 a[140:143], v[56:59], v[84:87], a[140:143]
    v_mfma_f32_16x16x32_bf16 a[200:203], v[64:67], v[80:83], a[200:203]
    v_mfma_f32_16x16x32_bf16 a[232:235], v[68:71], v[80:83], a[232:235]
    v_mfma_f32_16x16x32_bf16 a[236:239], v[68:71], v[84:87], a[236:239]
    v_mfma_f32_16x16x32_bf16 a[204:207], v[64:67], v[84:87], a[204:207]
    s_waitcnt lgkmcnt(2)
    v_mfma_f32_16x16x32_bf16 a[16:19], v[40:43], v[72:75], a[16:19]
    v_mfma_f32_16x16x32_bf16 a[48:51], v[44:47], v[72:75], a[48:51]
    s_waitcnt lgkmcnt(0)
    v_mfma_f32_16x16x32_bf16 a[52:55], v[44:47], v[76:79], a[52:55]
    ds_read_b64_tr_b16 v[80:81], v14 offset:3072
    v_mfma_f32_16x16x32_bf16 a[20:23], v[40:43], v[76:79], a[20:23]
    v_mfma_f32_16x16x32_bf16 a[80:83], v[48:51], v[72:75], a[80:83]
    ds_read_b64_tr_b16 v[82:83], v15 offset:3072
    v_mfma_f32_16x16x32_bf16 a[112:115], v[52:55], v[72:75], a[112:115]
    v_mfma_f32_16x16x32_bf16 a[116:119], v[52:55], v[76:79], a[116:119]
    ds_read_b64_tr_b16 v[84:85], v14 offset:3584
    v_mfma_f32_16x16x32_bf16 a[84:87], v[48:51], v[76:79], a[84:87]
    v_mfma_f32_16x16x32_bf16 a[144:147], v[56:59], v[72:75], a[144:147]
    ds_read_b64_tr_b16 v[86:87], v15 offset:3584
    v_mfma_f32_16x16x32_bf16 a[176:179], v[60:63], v[72:75], a[176:179]
    v_mfma_f32_16x16x32_bf16 a[180:183], v[60:63], v[76:79], a[180:183]
    v_mfma_f32_16x16x32_bf16 a[148:151], v[56:59], v[76:79], a[148:151]
    v_mfma_f32_16x16x32_bf16 a[208:211], v[64:67], v[72:75], a[208:211]
    v_mfma_f32_16x16x32_bf16 a[240:243], v[68:71], v[72:75], a[240:243]
    v_mfma_f32_16x16x32_bf16 a[244:247], v[68:71], v[76:79], a[244:247]
    v_mfma_f32_16x16x32_bf16 a[212:215], v[64:67], v[76:79], a[212:215]
    s_waitcnt lgkmcnt(2)
    v_mfma_f32_16x16x32_bf16 a[24:27], v[40:43], v[80:83], a[24:27]
    ds_read_b64_tr_b16 v[72:73], v14 offset:16384
    v_mfma_f32_16x16x32_bf16 a[56:59], v[44:47], v[80:83], a[56:59]
    ds_read_b64_tr_b16 v[74:75], v15 offset:16384
    s_waitcnt lgkmcnt(2)
    v_mfma_f32_16x16x32_bf16 a[60:63], v[44:47], v[84:87], a[60:63]
    ds_read_b128 v[44:47], v13 offset:2048
    v_mfma_f32_16x16x32_bf16 a[28:31], v[40:43], v[84:87], a[28:31]
    ds_read_b128 v[40:43], v13 offset:0
    v_mfma_f32_16x16x32_bf16 a[88:91], v[48:51], v[80:83], a[88:91]
    ds_read_b64_tr_b16 v[76:77], v14 offset:16896
    v_mfma_f32_16x16x32_bf16 a[120:123], v[52:55], v[80:83], a[120:123]
    ds_read_b64_tr_b16 v[78:79], v15 offset:16896
    v_mfma_f32_16x16x32_bf16 a[124:127], v[52:55], v[84:87], a[124:127]
    ds_read_b128 v[52:55], v13 offset:6144
    v_mfma_f32_16x16x32_bf16 a[92:95], v[48:51], v[84:87], a[92:95]
    ds_read_b128 v[48:51], v13 offset:4096
    v_mfma_f32_16x16x32_bf16 a[152:155], v[56:59], v[80:83], a[152:155]
    s_xor_b32 m0, s44, 2048
    v_mfma_f32_16x16x32_bf16 a[184:187], v[60:63], v[80:83], a[184:187]
    buffer_load_dwordx4 v4, s[8:11], s21 offen lds
    v_mfma_f32_16x16x32_bf16 a[188:191], v[60:63], v[84:87], a[188:191]
    ds_read_b128 v[60:63], v13 offset:10240
    v_mfma_f32_16x16x32_bf16 a[156:159], v[56:59], v[84:87], a[156:159]
    ds_read_b128 v[56:59], v13 offset:8192
    v_mfma_f32_16x16x32_bf16 a[216:219], v[64:67], v[80:83], a[216:219]
    s_xor_b32 m0, s44, 3072
    v_mfma_f32_16x16x32_bf16 a[248:251], v[68:71], v[80:83], a[248:251]
    buffer_load_dwordx4 v5, s[8:11], s21 offen lds
    v_mfma_f32_16x16x32_bf16 a[252:255], v[68:71], v[84:87], a[252:255]
    ds_read_b128 v[68:71], v13 offset:14336
    s_add_u32 s21, s21, 128
    v_mfma_f32_16x16x32_bf16 a[220:223], v[64:67], v[84:87], a[220:223]
    ds_read_b128 v[64:67], v13 offset:12288
t_g2_b:
    s_waitcnt lgkmcnt(8)
    v_mfma_f32_16x16x32_bf16 a[0:3], v[40:43], v[72:75], a[0:3]
    v_mfma_f32_16x16x32_bf16 a[32:35], v[44:47], v[72:75], a[32:35]
    s_xor_b32 m0, s44, 16384
    s_waitcnt lgkmcnt(6)
    v_mfma_f32_16x16x32_bf16 a[36:39], v[44:47], v[76:79], a[36:39]
    ds_read_b64_tr_b16 v[80:81], v14 offset:17408
    buffer_load_dwordx4 v4, s[8:11], s22 offen lds
    v_mfma_f32_16x16x32_bf16 a[4:7], v[40:43], v[76:79], a[4:7]
    s_cmp_ge_u32 s48, 98304
    s_waitcnt lgkmcnt(5)
    v_mfma_f32_16x16x32_bf16 a[64:67], v[48:51], v[72:75], a[64:67]
    ds_read_b64_tr_b16 v[82:83], v15 offset:17408
    s_cselect_b32 s46, s6, s7
    v_mfma_f32_16x16x32_bf16 a[96:99], v[52:55], v[72:75], a[96:99]
    s_add_u32 s48, s48, s46
    s_xor_b32 m0, s44, 17408
    v_mfma_f32_16x16x32_bf16 a[100:103], v[52:55], v[76:79], a[100:103]
    ds_read_b64_tr_b16 v[84:85], v14 offset:17920
    buffer_load_dwordx4 v5, s[8:11], s22 offen lds
    v_mfma_f32_16x16x32_bf16 a[68:71], v[48:51], v[76:79], a[68:71]
    s_add_u32 s22, s22, 128
    s_waitcnt lgkmcnt(5)
    v_mfma_f32_16x16x32_bf16 a[128:131], v[56:59], v[72:75], a[128:131]
    ds_read_b64_tr_b16 v[86:87], v15 offset:17920
    s_cmp_ge_u32 s49, 98304
    v_mfma_f32_16x16x32_bf16 a[160:163], v[60:63], v[72:75], a[160:163]
    s_cselect_b32 s47, s6, s7
    s_add_u32 s49, s49, s47
    v_mfma_f32_16x16x32_bf16 a[164:167], v[60:63], v[76:79], a[164:167]
    s_xor_b32 m0, s44, 18432
    v_mfma_f32_16x16x32_bf16 a[132:135], v[56:59], v[76:79], a[132:135]
    buffer_load_dwordx4 v4, s[8:11], s23 offen lds
    s_waitcnt lgkmcnt(4)
    v_mfma_f32_16x16x32_bf16 a[192:195], v[64:67], v[72:75], a[192:195]
    v_mfma_f32_16x16x32_bf16 a[224:227], v[68:71], v[72:75], a[224:227]
    s_xor_b32 m0, s44, 19456
    v_mfma_f32_16x16x32_bf16 a[228:231], v[68:71], v[76:79], a[228:231]
    buffer_load_dwordx4 v5, s[8:11], s23 offen lds
    v_mfma_f32_16x16x32_bf16 a[196:199], v[64:67], v[76:79], a[196:199]
    s_add_u32 s23, s23, 128
    s_waitcnt lgkmcnt(2)
    v_mfma_f32_16x16x32_bf16 a[8:11], v[40:43], v[80:83], a[8:11]
    s_cmp_ge_u32 s44, 98304
    s_cselect_b32 s60, s6, s7
    v_mfma_f32_16x16x32_bf16 a[40:43], v[44:47], v[80:83], a[40:43]
    s_add_u32 s44, s44, s60
    s_waitcnt lgkmcnt(0)
    v_mfma_f32_16x16x32_bf16 a[44:47], v[44:47], v[84:87], a[44:47]
    ds_read_b64_tr_b16 v[72:73], v14 offset:18432
    v_add_u32 v12, s46, v12
    v_mfma_f32_16x16x32_bf16 a[12:15], v[40:43], v[84:87], a[12:15]
    v_add_u32 v13, s46, v13
    v_mfma_f32_16x16x32_bf16 a[72:75], v[48:51], v[80:83], a[72:75]
    ds_read_b64_tr_b16 v[74:75], v15 offset:18432
    s_xor_b32 m0, s45, 2048
    v_mfma_f32_16x16x32_bf16 a[104:107], v[52:55], v[80:83], a[104:107]
    buffer_load_dwordx4 v6, s[12:15], s25 offen lds
    v_mfma_f32_16x16x32_bf16 a[108:111], v[52:55], v[84:87], a[108:111]
    ds_read_b64_tr_b16 v[76:77], v14 offset:18944
    v_mfma_f32_16x16x32_bf16 a[76:79], v[48:51], v[84:87], a[76:79]
    v_mfma_f32_16x16x32_bf16 a[136:139], v[56:59], v[80:83], a[136:139]
    ds_read_b64_tr_b16 v[78:79], v15 offset:18944
    s_xor_b32 m0, s45, 3072
    v_mfma_f32_16x16x32_bf16 a[168:171], v[60:63], v[80:83], a[168:171]
    buffer_load_dwordx4 v7, s[12:15], s25 offen lds
    v_mfma_f32_16x16x32_bf16 a[172:175], v[60:63], v[84:87], a[172:175]
    s_add_u32 s25, s25, s28
    v_mfma_f32_16x16x32_bf16 a[140:143], v[56:59], v[84:87], a[140:143]
    v_mfma_f32_16x16x32_bf16 a[200:203], v[64:67], v[80:83], a[200:203]
    s_xor_b32 m0, s45, 16384
    v_mfma_f32_16x16x32_bf16 a[232:235], v[68:71], v[80:83], a[232:235]
    buffer_load_dwordx4 v6, s[12:15], s26 offen lds
    v_mfma_f32_16x16x32_bf16 a[236:239], v[68:71], v[84:87], a[236:239]
    v_mfma_f32_16x16x32_bf16 a[204:207], v[64:67], v[84:87], a[204:207]
    s_waitcnt lgkmcnt(2)
    v_mfma_f32_16x16x32_bf16 a[16:19], v[40:43], v[72:75], a[16:19]
    s_xor_b32 m0, s45, 17408
    v_mfma_f32_16x16x32_bf16 a[48:51], v[44:47], v[72:75], a[48:51]
    buffer_load_dwordx4 v7, s[12:15], s26 offen lds
    s_waitcnt lgkmcnt(0)
    v_mfma_f32_16x16x32_bf16 a[52:55], v[44:47], v[76:79], a[52:55]
    ds_read_b64_tr_b16 v[80:81], v14 offset:19456
    s_add_u32 s26, s26, s28
    v_mfma_f32_16x16x32_bf16 a[20:23], v[40:43], v[76:79], a[20:23]
    v_mfma_f32_16x16x32_bf16 a[80:83], v[48:51], v[72:75], a[80:83]
    ds_read_b64_tr_b16 v[82:83], v15 offset:19456
    s_xor_b32 m0, s45, 18432
    v_mfma_f32_16x16x32_bf16 a[112:115], v[52:55], v[72:75], a[112:115]
    buffer_load_dwordx4 v6, s[12:15], s27 offen lds
    v_mfma_f32_16x16x32_bf16 a[116:119], v[52:55], v[76:79], a[116:119]
    ds_read_b64_tr_b16 v[84:85], v14 offset:19968
    v_mfma_f32_16x16x32_bf16 a[84:87], v[48:51], v[76:79], a[84:87]
    s_xor_b32 m0, s45, 19456
    v_mfma_f32_16x16x32_bf16 a[144:147], v[56:59], v[72:75], a[144:147]
    ds_read_b64_tr_b16 v[86:87], v15 offset:19968
    buffer_load_dwordx4 v7, s[12:15], s27 offen lds
    v_mfma_f32_16x16x32_bf16 a[176:179], v[60:63], v[72:75], a[176:179]
    s_add_u32 s27, s27, s28
    s_cmp_ge_u32 s45, 98304
    v_mfma_f32_16x16x32_bf16 a[180:183], v[60:63], v[76:79], a[180:183]
    s_cselect_b32 s60, s6, s7
    s_add_u32 s45, s45, s60
    v_mfma_f32_16x16x32_bf16 a[148:151], v[56:59], v[76:79], a[148:151]
    v_add_u32 v14, s47, v14
    v_add_u32 v15, s47, v15
    v_mfma_f32_16x16x32_bf16 a[208:211], v[64:67], v[72:75], a[208:211]
    s_add_u32 s43, s43, 1
    s_cmp_eq_u32 s43, 16
    v_mfma_f32_16x16x32_bf16 a[240:243], v[68:71], v[72:75], a[240:243]
    v_mfma_f32_16x16x32_bf16 a[244:247], v[68:71], v[76:79], a[244:247]
    v_mfma_f32_16x16x32_bf16 a[212:215], v[64:67], v[76:79], a[212:215]
    s_waitcnt vmcnt(6) lgkmcnt(0)
    s_barrier
    s_cbranch_scc1 t_g2_last
    v_mfma_f32_16x16x32_bf16 a[24:27], v[40:43], v[80:83], a[24:27]
    ds_read_b64_tr_b16 v[72:73], v14 offset:0
    v_mfma_f32_16x16x32_bf16 a[56:59], v[44:47], v[80:83], a[56:59]
    ds_read_b64_tr_b16 v[74:75], v15 offset:0
    v_mfma_f32_16x16x32_bf16 a[60:63], v[44:47], v[84:87], a[60:63]
    ds_read_b128 v[44:47], v12 offset:2048
    v_mfma_f32_16x16x32_bf16 a[28:31], v[40:43], v[84:87], a[28:31]
    ds_read_b128 v[40:43], v12 offset:0
    v_mfma_f32_16x16x32_bf16 a[88:91], v[48:51], v[80:83], a[88:91]
    ds_read_b64_tr_b16 v[76:77], v14 offset:512
    v_mfma_f32_16x16x32_bf16 a[120:123], v[52:55], v[80:83], a[120:123]
    ds_read_b64_tr_b16 v[78:79], v15 offset:512
    v_mfma_f32_16x16x32_bf16 a[124:127], v[52:55], v[84:87], a[124:127]
    ds_read_b128 v[52:55], v12 offset:6144
    v_mfma_f32_16x16x32_bf16 a[92:95], v[48:51], v[84:87], a[92:95]
    ds_read_b128 v[48:51], v12 offset:4096
    v_mfma_f32_16x16x32_bf16 a[152:155], v[56:59], v[80:83], a[152:155]
    v_mfma_f32_16x16x32_bf16 a[184:187], v[60:63], v[80:83], a[184:187]
    v_mfma_f32_16x16x32_bf16 a[188:191], v[60:63], v[84:87], a[188:191]
    ds_read_b128 v[60:63], v12 offset:10240
    v_mfma_f32_16x16x32_bf16 a[156:159], v[56:59], v[84:87], a[156:159]
    ds_read_b128 v[56:59], v12 offset:8192
    v_mfma_f32_16x16x32_bf16 a[216:219], v[64:67], v[80:83], a[216:219]
    s_sub_u32 s61, s43, 10
    s_cmp_lt_u32 s61, 3
    v_mfma_f32_16x16x32_bf16 a[248:251], v[68:71], v[80:83], a[248:251]
    v_mfma_f32_16x16x32_bf16 a[252:255], v[68:71], v[84:87], a[252:255]
    ds_read_b128 v[68:71], v12 offset:14336
    v_mfma_f32_16x16x32_bf16 a[220:223], v[64:67], v[84:87], a[220:223]
    ds_read_b128 v[64:67], v12 offset:12288
    s_cbranch_scc1 t_g2_a
    s_branch t_g2_hook
t_g2_last:
    v_mfma_f32_16x16x32_bf16 a[24:27], v[40:43], v[80:83], a[24:27]
    v_mfma_f32_16x16x32_bf16 a[56:59], v[44:47], v[80:83], a[56:59]
    v_mfma_f32_16x16x32_bf16 a[60:63], v[44:47], v[84:87], a[60:63]
    v_mfma_f32_16x16x32_bf16 a[28:31], v[40:43], v[84:87], a[28:31]
    v_mfma_f32_16x16x32_bf16 a[88:91], v[48:51], v[80:83], a[88:91]
    v_mfma_f32_16x16x32_bf16 a[120:123], v[52:55], v[80:83], a[120:123]
    v_mfma_f32_16x16x32_bf16 a[124:127], v[52:55], v[84:87], a[124:127]
    v_mfma_f32_16x16x32_bf16 a[92:95], v[48:51], v[84:87], a[92:95]
    v_mfma_f32_16x16x32_bf16 a[152:155], v[56:59], v[80:83], a[152:155]
    v_mfma_f32_16x16x32_bf16 a[184:187], v[60:63], v[80:83], a[184:187]
    v_mfma_f32_16x16x32_bf16 a[188:191], v[60:63], v[84:87], a[188:191]
    v_mfma_f32_16x16x32_bf16 a[156:159], v[56:59], v[84:87], a[156:159]
    v_mfma_f32_16x16x32_bf16 a[216:219], v[64:67], v[80:83], a[216:219]
    v_mfma_f32_16x16x32_bf16 a[248:251], v[68:71], v[80:83], a[248:251]
    v_mfma_f32_16x16x32_bf16 a[252:255], v[68:71], v[84:87], a[252:255]
    v_mfma_f32_16x16x32_bf16 a[220:223], v[64:67], v[84:87], a[220:223]
    s_setpc_b64 s[54:55]
t_g1:
    s_mov_b32 s43, 0
    v_add_u32 v14, s49, v23
    v_xor_b32 v15, 64, v14
    ds_read_b128 v[72:75], v14 offset:0
    ds_read_b128 v[76:79], v14 offset:2048
    ds_read_b128 v[44:47], v12 offset:2048
    ds_read_b128 v[40:43], v12 offset:0
    ds_read_b128 v[52:55], v12 offset:6144
    ds_read_b128 v[48:51], v12 offset:4096
    ds_read_b128 v[60:63], v12 offset:10240
    ds_read_b128 v[56:59], v12 offset:8192
    ds_read_b128 v[68:71], v12 offset:14336
    ds_read_b128 v[64:67], v12 offset:12288
    s_waitcnt lgkmcnt(6)
    v_mfma_f32_16x16x32_bf16 a[0:3], v[40:43], v[72:75], 0
    s_xor_b32 m0, s44, 0
    v_mfma_f32_16x16x32_bf16 a[32:35], v[44:47], v[72:75], 0
    buffer_load_dwordx4 v4, s[8:11], s20 offen lds
    v_mfma_f32_16x16x32_bf16 a[36:39], v[44:47], v[76:79], 0
    ds_read_b128 v[80:83], v14 offset:4096
    s_xor_b32 m0, s44, 1024
    v_mfma_f32_16x16x32_bf16 a[4:7], v[40:43], v[76:79], 0
    buffer_load_dwordx4 v5, s[8:11], s20 offen lds
    s_waitcnt lgkmcnt(5)
    v_mfma_f32_16x16x32_bf16 a[64:67], v[48:51], v[72:75], 0
    ds_read_b128 v[84:87], v14 offset:6144
    s_add_u32 s20, s20, 128
    v_mfma_f32_16x16x32_bf16 a[96:99], v[52:55], v[72:75], 0
    s_xor_b32 m0, s45, 0
    v_mfma_f32_16x16x32_bf16 a[100:103], v[52:55], v[76:79], 0
    buffer_load_dwordx4 v6, s[12:15], s24 offen lds
    v_mfma_f32_16x16x32_bf16 a[68:71], v[48:51], v[76:79], 0
    s_xor_b32 m0, s45, 1024
    s_waitcnt lgkmcnt(4)
    v_mfma_f32_16x16x32_bf16 a[128:131], v[56:59], v[72:75], 0
    buffer_load_dwordx4 v7, s[12:15], s24 offen lds
    v_mfma_f32_16x16x32_bf16 a[160:163], v[60:63], v[72:75], 0
    s_add_u32 s24, s24, s28
    s_bitcmp1_b32 s43, 0
    v_mfma_f32_16x16x32_bf16 a[164:167], v[60:63], v[76:79], 0
    s_cselect_b32 s61, s5, 0
    s_lshl1_add_u32 s53, s61, s50
    v_mfma_f32_16x16x32_bf16 a[132:135], v[56:59], v[76:79], 0
    s_bitcmp1_b32 s43, 1
    s_waitcnt lgkmcnt(2)
    v_mfma_f32_16x16x32_bf16 a[192:195], v[64:67], v[72:75], 0
    s_cselect_b32 s61, s51, 0
    s_add_u32 s53, s53, s61
    v_mfma_f32_16x16x32_bf16 a[224:227], v[68:71], v[72:75], 0
    s_bitcmp1_b32 s43, 2
    s_cselect_b32 s61, s52, 0
    v_mfma_f32_16x16x32_bf16 a[228:231], v[68:71], v[76:79], 0
    s_add_u32 s53, s53, s61
    s_lshl_b32 s29, s43, 4
    v_mfma_f32_16x16x32_bf16 a[196:199], v[64:67], v[76:79], 0
    s_waitcnt lgkmcnt(1)
    v_mfma_f32_16x16x32_bf16 a[8:11], v[40:43], v[80:83], 0
    s_set_gpr_idx_on s29, gpr_idx(SRC0)
    v_mov_b32 v24, v128
    v_mov_b32 v25, v129
    v_mov_b32 v26, v130
    v_mov_b32 v27, v131
    s_set_gpr_idx_off
    v_mfma_f32_16x16x32_bf16 a[40:43], v[44:47], v[80:83], 0
    s_waitcnt lgkmcnt(0)
    v_mfma_f32_16x16x32_bf16 a[44:47], v[44:47], v[84:87], 0
    ds_read_b128 v[72:75], v14 offset:8192
    s_set_gpr_idx_on s29, gpr_idx(SRC0)
    v_mov_b32 v28, v132
    v_mov_b32 v29, v133
    v_mov_b32 v30, v134
    v_mov_b32 v31, v135
    s_set_gpr_idx_off
    v_mfma_f32_16x16x32_bf16 a[12:15], v[40:43], v[84:87], 0
    v_mfma_f32_16x16x32_bf16 a[72:75], v[48:51], v[80:83], 0
    ds_read_b128 v[76:79], v14 offset:10240
    s_set_gpr_idx_on s29, gpr_idx(SRC0)
    v_mov_b32 v32, v136
    v_mov_b32 v33, v137
    v_mov_b32 v34, v138
    v_mov_b32 v35, v139
    s_set_gpr_idx_off
    v_mfma_f32_16x16x32_bf16 a[104:107], v[52:55], v[80:83], 0
    v_mfma_f32_16x16x32_bf16 a[108:111], v[52:55], v[84:87], 0
    s_set_gpr_idx_on s29, gpr_idx(SRC0)
    v_mov_b32 v36, v140
    v_mov_b32 v37, v141
    v_mov_b32 v38, v142
    v_mov_b32 v39, v143
    s_set_gpr_idx_off
    v_mfma_f32_16x16x32_bf16 a[76:79], v[48:51], v[84:87], 0
    v_mfma_f32_16x16x32_bf16 a[136:139], v[56:59], v[80:83], 0
    buffer_store_dwordx4 v[24:27], v2, s[16:19], s53 offen sc1
    v_mfma_f32_16x16x32_bf16 a[168:171], v[60:63], v[80:83], 0
    v_mfma_f32_16x16x32_bf16 a[172:175], v[60:63], v[84:87], 0
    buffer_store_dwordx4 v[28:31], v3, s[16:19], s53 offen sc1
    v_mfma_f32_16x16x32_bf16 a[140:143], v[56:59], v[84:87], 0
    s_add_u32 s53, s53, s5
    v_mfma_f32_16x16x32_bf16 a[200:203], v[64:67], v[80:83], 0
    buffer_store_dwordx4 v[32:35], v2, s[16:19], s53 offen sc1
    v_mfma_f32_16x16x32_bf16 a[232:235], v[68:71], v[80:83], 0
    v_mfma_f32_16x16x32_bf16 a[236:239], v[68:71], v[84:87], 0
    buffer_store_dwordx4 v[36:39], v3, s[16:19], s53 offen sc1
    v_mfma_f32_16x16x32_bf16 a[204:207], v[64:67], v[84:87], 0
    s_waitcnt lgkmcnt(1)
    v_mfma_f32_16x16x32_bf16 a[16:19], v[40:43], v[72:75], 0
    v_mfma_f32_16x16x32_bf16 a[48:51], v[44:47], v[72:75], 0
    s_waitcnt lgkmcnt(0)
    v_mfma_f32_16x16x32_bf16 a[52:55], v[44:47], v[76:79], 0
    ds_read_b128 v[80:83], v14 offset:12288
    v_mfma_f32_16x16x32_bf16 a[20:23], v[40:43], v[76:79], 0
    v_mfma_f32_16x16x32_bf16 a[80:83], v[48:51], v[72:75], 0
    ds_read_b128 v[84:87], v14 offset:14336
    v_mfma_f32_16x16x32_bf16 a[112:115], v[52:55], v[72:75], 0
    v_mfma_f32_16x16x32_bf16 a[116:119], v[52:55], v[76:79], 0
    v_mfma_f32_16x16x32_bf16 a[84:87], v[48:51], v[76:79], 0
    v_mfma_f32_16x16x32_bf16 a[144:147], v[56:59], v[72:75], 0
    v_mfma_f32_16x16x32_bf16 a[176:179], v[60:63], v[72:75], 0
    v_mfma_f32_16x16x32_bf16 a[180:183], v[60:63], v[76:79], 0
    v_mfma_f32_16x16x32_bf16 a[148:151], v[56:59], v[76:79], 0
    v_mfma_f32_16x16x32_bf16 a[208:211], v[64:67], v[72:75], 0
    v_mfma_f32_16x16x32_bf16 a[240:243], v[68:71], v[72:75], 0
    v_mfma_f32_16x16x32_bf16 a[244:247], v[68:71], v[76:79], 0
    v_mfma_f32_16x16x32_bf16 a[212:215], v[64:67], v[76:79], 0
    s_waitcnt lgkmcnt(1)
    v_mfma_f32_16x16x32_bf16 a[24:27], v[40:43], v[80:83], 0
    ds_read_b128 v[72:75], v15 offset:0
    v_mfma_f32_16x16x32_bf16 a[56:59], v[44:47], v[80:83], 0
    ds_read_b128 v[76:79], v15 offset:2048
    s_waitcnt lgkmcnt(2)
    v_mfma_f32_16x16x32_bf16 a[60:63], v[44:47], v[84:87], 0
    ds_read_b128 v[44:47], v13 offset:2048
    v_mfma_f32_16x16x32_bf16 a[28:31], v[40:43], v[84:87], 0
    ds_read_b128 v[40:43], v13 offset:0
    v_mfma_f32_16x16x32_bf16 a[88:91], v[48:51], v[80:83], 0
    v_mfma_f32_16x16x32_bf16 a[120:123], v[52:55], v[80:83], 0
    v_mfma_f32_16x16x32_bf16 a[124:127], v[52:55], v[84:87], 0
    ds_read_b128 v[52:55], v13 offset:6144
    v_mfma_f32_16x16x32_bf16 a[92:95], v[48:51], v[84:87], 0
    ds_read_b128 v[48:51], v13 offset:4096
    v_mfma_f32_16x16x32_bf16 a[152:155], v[56:59], v[80:83], 0
    s_xor_b32 m0, s44, 2048
    v_mfma_f32_16x16x32_bf16 a[184:187], v[60:63], v[80:83], 0
    buffer_load_dwordx4 v4, s[8:11], s21 offen lds
    v_mfma_f32_16x16x32_bf16 a[188:191], v[60:63], v[84:87], 0
    ds_read_b128 v[60:63], v13 offset:10240
    v_mfma_f32_16x16x32_bf16 a[156:159], v[56:59], v[84:87], 0
    ds_read_b128 v[56:59], v13 offset:8192
    v_mfma_f32_16x16x32_bf16 a[216:219], v[64:67], v[80:83], 0
    s_xor_b32 m0, s44, 3072
    v_mfma_f32_16x16x32_bf16 a[248:251], v[68:71], v[80:83], 0
    buffer_load_dwordx4 v5, s[8:11], s21 offen lds
    v_mfma_f32_16x16x32_bf16 a[252:255], v[68:71], v[84:87], 0
    ds_read_b128 v[68:71], v13 offset:14336
    s_add_u32 s21, s21, 128
    v_mfma_f32_16x16x32_bf16 a[220:223], v[64:67], v[84:87], 0
    ds_read_b128 v[64:67], v13 offset:12288
    s_branch t_g1_b
t_g1_as:
    s_waitcnt lgkmcnt(6)
    v_mfma_f32_16x16x32_bf16 a[0:3], v[40:43], v[72:75], a[0:3]
    s_xor_b32 m0, s44, 0
    v_mfma_f32_16x16x32_bf16 a[32:35], v[44:47], v[72:75], a[32:35]
    buffer_load_dwordx4 v4, s[8:11], s20 offen lds
    v_mfma_f32_16x16x32_bf16 a[36:39], v[44:47], v[76:79], a[36:39]
    ds_read_b128 v[80:83], v14 offset:4096
    s_xor_b32 m0, s44, 1024
    v_mfma_f32_16x16x32_bf16 a[4:7], v[40:43], v[76:79], a[4:7]
    buffer_load_dwordx4 v5, s[8:11], s20 offen lds
    s_waitcnt lgkmcnt(5)
    v_mfma_f32_16x16x32_bf16 a[64:67], v[48:51], v[72:75], a[64:67]
    ds_read_b128 v[84:87], v14 offset:6144
    s_add_u32 s20, s20, 128
    v_mfma_f32_16x16x32_bf16 a[96:99], v[52:55], v[72:75], a[96:99]
    s_xor_b32 m0, s45, 0
    v_mfma_f32_16x16x32_bf16 a[100:103], v[52:55], v[76:79], a[100:103]
    buffer_load_dwordx4 v6, s[12:15], s24 offen lds
    v_mfma_f32_16x16x32_bf16 a[68:71], v[48:51], v[76:79], a[68:71]
    s_xor_b32 m0, s45, 1024
    s_waitcnt lgkmcnt(4)
    v_mfma_f32_16x16x32_bf16 a[128:131], v[56:59], v[72:75], a[128:131]
    buffer_load_dwordx4 v7, s[12:15], s24 offen lds
    v_mfma_f32_16x16x32_bf16 a[160:163], v[60:63], v[72:75], a[160:163]
    s_add_u32 s24, s24, s28
    s_bitcmp1_b32 s43, 0
    v_mfma_f32_16x16x32_bf16 a[164:167], v[60:63], v[76:79], a[164:167]
    s_cselect_b32 s61, s5, 0
    s_lshl1_add_u32 s53, s61, s50
    v_mfma_f32_16x16x32_bf16 a[132:135], v[56:59], v[76:79], a[132:135]
    s_bitcmp1_b32 s43, 1
    s_waitcnt lgkmcnt(2)
    v_mfma_f32_16x16x32_bf16 a[192:195], v[64:67], v[72:75], a[192:195]
    s_cselect_b32 s61, s51, 0
    s_add_u32 s53, s53, s61
    v_mfma_f32_16x16x32_bf16 a[224:227], v[68:71], v[72:75], a[224:227]
    s_bitcmp1_b32 s43, 2
    s_cselect_b32 s61, s52, 0
    v_mfma_f32_16x16x32_bf16 a[228:231], v[68:71], v[76:79], a[228:231]
    s_add_u32 s53, s53, s61
    s_lshl_b32 s29, s43, 4
    v_mfma_f32_16x16x32_bf16 a[196:199], v[64:67], v[76:79], a[196:199]
    s_waitcnt lgkmcnt(1)
    v_mfma_f32_16x16x32_bf16 a[8:11], v[40:43], v[80:83], a[8:11]
    s_set_gpr_idx_on s29, gpr_idx(SRC0)
    v_mov_b32 v24, v128
    v_mov_b32 v25, v129
    v_mov_b32 v26, v130
    v_mov_b32 v27, v131
    s_set_gpr_idx_off
    v_mfma_f32_16x16x32_bf16 a[40:43], v[44:47], v[80:83], a[40:43]
    s_waitcnt lgkmcnt(0)
    v_mfma_f32_16x16x32_bf16 a[44:47], v[44:47], v[84:87], a[44:47]
    ds_read_b128 v[72:75], v14 offset:8192
    s_set_gpr_idx_on s29, gpr_idx(SRC0)
    v_mov_b32 v28, v132
    v_mov_b32 v29, v133
    v_mov_b32 v30, v134
    v_mov_b32 v31, v135
    s_set_gpr_idx_off
    v_mfma_f32_16x16x32_bf16 a[12:15], v[40:43], v[84:87], a[12:15]
    v_mfma_f32_16x16x32_bf16 a[72:75], v[48:51], v[80:83], a[72:75]
    ds_read_b128 v[76:79], v14 offset:10240
    s_set_gpr_idx_on s29, gpr_idx(SRC0)
    v_mov_b32 v32, v136
    v_mov_b32 v33, v137
    v_mov_b32 v34, v138
    v_mov_b32 v35, v139
    s_set_gpr_idx_off
    v_mfma_f32_16x16x32_bf16 a[104:107], v[52:55], v[80:83], a[104:107]
    v_mfma_f32_16x16x32_bf16 a[108:111], v[52:55], v[84:87], a[108:111]
    s_set_gpr_idx_on s29, gpr_idx(SRC0)
    v_mov_b32 v36, v140
    v_mov_b32 v37, v141
    v_mov_b32 v38, v142
    v_mov_b32 v39, v143
    s_set_gpr_idx_off
    v_mfma_f32_16x16x32_bf16 a[76:79], v[48:51], v[84:87], a[76:79]
    v_mfma_f32_16x16x32_bf16 a[136:139], v[56:59], v[80:83], a[136:139]
    buffer_store_dwordx4 v[24:27], v2, s[16:19], s53 offen sc1
    v_mfma_f32_16x16x32_bf16 a[168:171], v[60:63], v[80:83], a[168:171]
    v_mfma_f32_16x16x32_bf16 a[172:175], v[60:63], v[84:87], a[172:175]
    buffer_store_dwordx4 v[28:31], v3, s[16:19], s53 offen sc1
    v_mfma_f32_16x16x32_bf16 a[140:143], v[56:59], v[84:87], a[140:143]
    s_add_u32 s53, s53, s5
    v_mfma_f32_16x16x32_bf16 a[200:203], v[64:67], v[80:83], a[200:203]
    buffer_store_dwordx4 v[32:35], v2, s[16:19], s53 offen sc1
    v_mfma_f32_16x16x32_bf16 a[232:235], v[68:71], v[80:83], a[232:235]
    v_mfma_f32_16x16x32_bf16 a[236:239], v[68:71], v[84:87], a[236:239]
    buffer_store_dwordx4 v[36:39], v3, s[16:19], s53 offen sc1
    v_mfma_f32_16x16x32_bf16 a[204:207], v[64:67], v[84:87], a[204:207]
    s_waitcnt lgkmcnt(1)
    v_mfma_f32_16x16x32_bf16 a[16:19], v[40:43], v[72:75], a[16:19]
    v_mfma_f32_16x16x32_bf16 a[48:51], v[44:47], v[72:75], a[48:51]
    s_waitcnt lgkmcnt(0)
    v_mfma_f32_16x16x32_bf16 a[52:55], v[44:47], v[76:79], a[52:55]
    ds_read_b128 v[80:83], v14 offset:12288
    v_mfma_f32_16x16x32_bf16 a[20:23], v[40:43], v[76:79], a[20:23]
    v_mfma_f32_16x16x32_bf16 a[80:83], v[48:51], v[72:75], a[80:83]
    ds_read_b128 v[84:87], v14 offset:14336
    v_mfma_f32_16x16x32_bf16 a[112:115], v[52:55], v[72:75], a[112:115]
    v_mfma_f32_16x16x32_bf16 a[116:119], v[52:55], v[76:79], a[116:119]
    v_mfma_f32_16x16x32_bf16 a[84:87], v[48:51], v[76:79], a[84:87]
    v_mfma_f32_16x16x32_bf16 a[144:147], v[56:59], v[72:75], a[144:147]
    v_mfma_f32_16x16x32_bf16 a[176:179], v[60:63], v[72:75], a[176:179]
    v_mfma_f32_16x16x32_bf16 a[180:183], v[60:63], v[76:79], a[180:183]
    v_mfma_f32_16x16x32_bf16 a[148:151], v[56:59], v[76:79], a[148:151]
    v_mfma_f32_16x16x32_bf16 a[208:211], v[64:67], v[72:75], a[208:211]
    v_mfma_f32_16x16x32_bf16 a[240:243], v[68:71], v[72:75], a[240:243]
    v_mfma_f32_16x16x32_bf16 a[244:247], v[68:71], v[76:79], a[244:247]
    v_mfma_f32_16x16x32_bf16 a[212:215], v[64:67], v[76:79], a[212:215]
    s_waitcnt lgkmcnt(1)
    v_mfma_f32_16x16x32_bf16 a[24:27], v[40:43], v[80:83], a[24:27]
    ds_read_b128 v[72:75], v15 offset:0
    v_mfma_f32_16x16x32_bf16 a[56:59], v[44:47], v[80:83], a[56:59]
    ds_read_b128 v[76:79], v15 offset:2048
    s_waitcnt lgkmcnt(2)
    v_mfma_f32_16x16x32_bf16 a[60:63], v[44:47], v[84:87], a[60:63]
    ds_read_b128 v[44:47], v13 offset:2048
    v_mfma_f32_16x16x32_bf16 a[28:31], v[40:43], v[84:87], a[28:31]
    ds_read_b128 v[40:43], v13 offset:0
    v_mfma_f32_16x16x32_bf16 a[88:91], v[48:51], v[80:83], a[88:91]
    v_mfma_f32_16x16x32_bf16 a[120:123], v[52:55], v[80:83], a[120:123]
    v_mfma_f32_16x16x32_bf16 a[124:127], v[52:55], v[84:87], a[124:127]
    ds_read_b128 v[52:55], v13 offset:6144
    v_mfma_f32_16x16x32_bf16 a[92:95], v[48:51], v[84:87], a[92:95]
    ds_read_b128 v[48:51], v13 offset:4096
    v_mfma_f32_16x16x32_bf16 a[152:155], v[56:59], v[80:83], a[152:155]
    s_xor_b32 m0, s44, 2048
    v_mfma_f32_16x16x32_bf16 a[184:187], v[60:63], v[80:83], a[184:187]
    buffer_load_dwordx4 v4, s[8:11], s21 offen lds
    v_mfma_f32_16x16x32_bf16 a[188:191], v[60:63], v[84:87], a[188:191]
    ds_read_b128 v[60:63], v13 offset:10240
    v_mfma_f32_16x16x32_bf16 a[156:159], v[56:59], v[84:87], a[156:159]
    ds_read_b128 v[56:59], v13 offset:8192
    v_mfma_f32_16x16x32_bf16 a[216:219], v[64:67], v[80:83], a[216:219]
    s_xor_b32 m0, s44, 3072
    v_mfma_f32_16x16x32_bf16 a[248:251], v[68:71], v[80:83], a[248:251]
    buffer_load_dwordx4 v5, s[8:11], s21 offen lds
    v_mfma_f32_16x16x32_bf16 a[252:255], v[68:71], v[84:87], a[252:255]
    ds_read_b128 v[68:71], v13 offset:14336
    s_add_u32 s21, s21, 128
    v_mfma_f32_16x16x32_bf16 a[220:223], v[64:67], v[84:87], a[220:223]
    ds_read_b128 v[64:67], v13 offset:12288
    s_branch t_g1_b
t_g1_hook:
    s_cmp_eq_u32 s43, 1
    s_cbranch_scc1 t_g1_sig0
    s_cmp_lt_u32 s43, 8
    s_cbranch_scc1 t_g1_as
    s_cmp_eq_u32 s43, 14
    s_cbranch_scc1 t_g1_sws
    s_cmp_eq_u32 s43, 15
    s_cbranch_scc1 t_g1_swp
    s_cmp_lg_u32 s58, 0
    s_cbranch_scc1 t_g1_a
    s_cmp_eq_u32 s43, 13
    s_cbranch_scc1 t_g1_wait
    s_cmp_lg_u32 s43, 9
    s_cbranch_scc1 t_g1_a
    s_cmp_eq_u32 s4, 0
    s_cbranch_scc1 t_g1_a
    v_mov_b32 v24, s4
    v_mov_b32 v25, 1
    s_mov_b64 exec, 1
    global_atomic_add v24, v25, s[98:99] sc1
    s_mov_b64 exec, -1
    s_branch t_g1_a
t_g1_sig0:
    s_cmp_eq_u32 s1, 0
    s_cbranch_scc1 t_g1_as
    v_mov_b32 v24, s1
    v_mov_b32 v25, 1
    s_mov_b64 exec, 1
    global_atomic_add v24, v25, s[98:99] sc1
    s_mov_b64 exec, -1
    s_mov_b32 s1, 0
    s_branch t_g1_as
t_g1_wait:
    s_cmp_eq_u32 s3, 0
    s_cbranch_scc1 t_g1_a
    s_mov_b32 s62, 0
L_sw_72:
    s_load_dword s63, s[98:99], s3 glc
    s_add_u32 s62, s62, 1
    s_cmp_gt_u32 s62, 0x200000
    s_cbranch_scc1 chain_kernel_wabort
    s_waitcnt lgkmcnt(0)
    s_cmp_ge_u32 s63, s2
    s_cbranch_scc1 L_swok_73
    s_sleep 16
    s_branch L_sw_72
L_swok_73:
    s_branch t_g1_a
t_g1_sws:
    s_mov_b32 s12, s36
    s_mov_b32 s13, s37
    s_mov_b32 s14, s38
    s_and_b32 s45, s45, 0xffffb7ff
    s_bitcmp1_b32 s94, 1
    s_cselect_b32 s24, s41, 0
    s_cselect_b32 s26, 0, s41
    s_cselect_b32 s60, 0x4000, 0
    s_or_b32 s45, s45, s60
    s_add_u32 s24, s24, s39
    s_add_u32 s26, s26, s39
    s_bitcmp1_b32 s94, 0
    s_cselect_b32 s61, s40, 0
    s_cselect_b32 s62, 0, s40
    s_cselect_b32 s60, 0x800, 0
    s_or_b32 s45, s45, s60
    s_add_u32 s25, s24, s62
    s_add_u32 s24, s24, s61
    s_add_u32 s27, s26, s62
    s_add_u32 s26, s26, s61
    s_mov_b32 s28, s42
    v_mov_b32 v6, v10
    v_mov_b32 v7, v11
    s_branch t_g1_a
t_g1_swp:
    s_mov_b32 s8, s30
    s_mov_b32 s9, s31
    s_mov_b32 s10, s32
    s_and_b32 s44, s44, 0xffffb7ff
    s_bitcmp1_b32 s84, 1
    s_cselect_b32 s20, s35, 0
    s_cselect_b32 s22, 0, s35
    s_cselect_b32 s60, 0x4000, 0
    s_or_b32 s44, s44, s60
    s_add_u32 s20, s20, s33
    s_add_u32 s22, s22, s33
    s_bitcmp1_b32 s84, 0
    s_cselect_b32 s61, s34, 0
    s_cselect_b32 s62, 0, s34
    s_cselect_b32 s60, 0x800, 0
    s_or_b32 s44, s44, s60
    s_add_u32 s21, s20, s62
    s_add_u32 s20, s20, s61
    s_add_u32 s23, s22, s62
    s_add_u32 s22, s22, s61
    v_mov_b32 v4, v8
    v_mov_b32 v5, v9
t_g1_a:
    s_waitcnt lgkmcnt(6)
    v_mfma_f32_16x16x32_bf16 a[0:3], v[40:43], v[72:75], a[0:3]
    s_xor_b32 m0, s44, 0
    v_mfma_f32_16x16x32_bf16 a[32:35], v[44:47], v[72:75], a[32:35]
    buffer_load_dwordx4 v4, s[8:11], s20 offen lds
    v_mfma_f32_16x16x32_bf16 a[36:39], v[44:47], v[76:79], a[36:39]
    ds_read_b128 v[80:83], v14 offset:4096
    s_xor_b32 m0, s44, 1024
    v_mfma_f32_16x16x32_bf16 a[4:7], v[40:43], v[76:79], a[4:7]
    buffer_load_dwordx4 v5, s[8:11], s20 offen lds
    s_waitcnt lgkmcnt(5)
    v_mfma_f32_16x16x32_bf16 a[64:67], v[48:51], v[72:75], a[64:67]
    ds_read_b128 v[84:87], v14 offset:6144
    s_add_u32 s20, s20, 128
    v_mfma_f32_16x16x32_bf16 a[96:99], v[52:55], v[72:75], a[96:99]
    s_xor_b32 m0, s45, 0
    v_mfma_f32_16x16x32_bf16 a[100:103], v[52:55], v[76:79], a[100:103]
    buffer_load_dwordx4 v6, s[12:15], s24 offen lds
    v_mfma_f32_16x16x32_bf16 a[68:71], v[48:51], v[76:79], a[68:71]
    s_xor_b32 m0, s45, 1024
    s_waitcnt lgkmcnt(4)
    v_mfma_f32_16x16x32_bf16 a[128:131], v[56:59], v[72:75], a[128:131]
    buffer_load_dwordx4 v7, s[12:15], s24 offen lds
    v_mfma_f32_16x16x32_bf16 a[160:163], v[60:63], v[72:75], a[160:163]
    s_add_u32 s24, s24, s28
    v_mfma_f32_16x16x32_bf16 a[164:167], v[60:63], v[76:79], a[164:167]
    v_mfma_f32_16x16x32_bf16 a[132:135], v[56:59], v[76:79], a[132:135]
    s_waitcnt lgkmcnt(2)
    v_mfma_f32_16x16x32_bf16 a[192:195], v[64:67], v[72:75], a[192:195]
    v_mfma_f32_16x16x32_bf16 a[224:227], v[68:71], v[72:75], a[224:227]
    v_mfma_f32_16x16x32_bf16 a[228:231], v[68:71], v[76:79], a[228:231]
    v_mfma_f32_16x16x32_bf16 a[196:199], v[64:67], v[76:79], a[196:199]
    s_waitcnt lgkmcnt(1)
    v_mfma_f32_16x16x32_bf16 a[8:11], v[40:43], v[80:83], a[8:11]
    v_mfma_f32_16x16x32_bf16 a[40:43], v[44:47], v[80:83], a[40:43]
    s_waitcnt lgkmcnt(0)
    v_mfma_f32_16x16x32_bf16 a[44:47], v[44:47], v[84:87], a[44:47]
    ds_read_b128 v[72:75], v14 offset:8192
    v_mfma_f32_16x16x32_bf16 a[12:15], v[40:43], v[84:87], a[12:15]
    v_mfma_f32_16x16x32_bf16 a[72:75], v[48:51], v[80:83], a[72:75]
    ds_read_b128 v[76:79], v14 offset:10240
    v_mfma_f32_16x16x32_bf16 a[104:107], v[52:55], v[80:83], a[104:107]
    v_mfma_f32_16x16x32_bf16 a[108:111], v[52:55], v[84:87], a[108:111]
    v_mfma_f32_16x16x32_bf16 a[76:79], v[48:51], v[84:87], a[76:79]
    v_mfma_f32_16x16x32_bf16 a[136:139], v[56:59], v[80:83], a[136:139]
    v_mfma_f32_16x16x32_bf16 a[168:171], v[60:63], v[80:83], a[168:171]
    v_mfma_f32_16x16x32_bf16 a[172:175], v[60:63], v[84:87], a[172:175]
    v_mfma_f32_16x16x32_bf16 a[140:143], v[56:59], v[84:87], a[140:143]
    v_mfma_f32_16x16x32_bf16 a[200:203], v[64:67], v[80:83], a[200:203]
    v_mfma_f32_16x16x32_bf16 a[232:235], v[68:71], v[80:83], a[232:235]
    v_mfma_f32_16x16x32_bf16 a[236:239], v[68:71], v[84:87], a[236:239]
    v_mfma_f32_16x16x32_bf16 a[204:207], v[64:67], v[84:87], a[204:207]
    s_waitcnt lgkmcnt(1)
    v_mfma_f32_16x16x32_bf16 a[16:19], v[40:43], v[72:75], a[16:19]
    v_mfma_f32_16x16x32_bf16 a[48:51], v[44:47], v[72:75], a[48:51]
    s_waitcnt lgkmcnt(0)
    v_mfma_f32_16x16x32_bf16 a[52:55], v[44:47], v[76:79], a[52:55]
    ds_read_b128 v[80:83], v14 offset:12288
    v_mfma_f32_16x16x32_bf16 a[20:23], v[40:43], v[76:79], a[20:23]
    v_mfma_f32_16x16x32_bf16 a[80:83], v[48:51], v[72:75], a[80:83]
    ds_read_b128 v[84:87], v14 offset:14336
    v_mfma_f32_16x16x32_bf16 a[112:115], v[52:55], v[72:75], a[112:115]
    v_mfma_f32_16x16x32_bf16 a[116:119], v[52:55], v[76:79], a[116:119]
    v_mfma_f32_16x16x32_bf16 a[84:87], v[48:51], v[76:79], a[84:87]
    v_mfma_f32_16x16x32_bf16 a[144:147], v[56:59], v[72:75], a[144:147]
    v_mfma_f32_16x16x32_bf16 a[176:179], v[60:63], v[72:75], a[176:179]
    v_mfma_f32_16x16x32_bf16 a[180:183], v[60:63], v[76:79], a[180:183]
    v_mfma_f32_16x16x32_bf16 a[148:151], v[56:59], v[76:79], a[148:151]
    v_mfma_f32_16x16x32_bf16 a[208:211], v[64:67], v[72:75], a[208:211]
    v_mfma_f32_16x16x32_bf16 a[240:243], v[68:71], v[72:75], a[240:243]
    v_mfma_f32_16x16x32_bf16 a[244:247], v[68:71], v[76:79], a[244:247]
    v_mfma_f32_16x16x32_bf16 a[212:215], v[64:67], v[76:79], a[212:215]
    s_waitcnt lgkmcnt(1)
    v_mfma_f32_16x16x32_bf16 a[24:27], v[40:43], v[80:83], a[24:27]
    ds_read_b128 v[72:75], v15 offset:0
    v_mfma_f32_16x16x32_bf16 a[56:59], v[44:47], v[80:83], a[56:59]
    ds_read_b128 v[76:79], v15 offset:2048
    s_waitcnt lgkmcnt(2)
    v_mfma_f32_16x16x32_bf16 a[60:63], v[44:47], v[84:87], a[60:63]
    ds_read_b128 v[44:47], v13 offset:2048
    v_mfma_f32_16x16x32_bf16 a[28:31], v[40:43], v[84:87], a[28:31]
    ds_read_b128 v[40:43], v13 offset:0
    v_mfma_f32_16x16x32_bf16 a[88:91], v[48:51], v[80:83], a[88:91]
    v_mfma_f32_16x16x32_bf16 a[120:123], v[52:55], v[80:83], a[120:123]
    v_mfma_f32_16x16x32_bf16 a[124:127], v[52:55], v[84:87], a[124:127]
    ds_read_b128 v[52:55], v13 offset:6144
    v_mfma_f32_16x16x32_bf16 a[92:95], v[48:51], v[84:87], a[92:95]
    ds_read_b128 v[48:51], v13 offset:4096
    v_mfma_f32_16x16x32_bf16 a[152:155], v[56:59], v[80:83], a[152:155]
    s_xor_b32 m0, s44, 2048
    v_mfma_f32_16x16x32_bf16 a[184:187], v[60:63], v[80:83], a[184:187]
    buffer_load_dwordx4 v4, s[8:11], s21 offen lds
    v_mfma_f32_16x16x32_bf16 a[188:191], v[60:63], v[84:87], a[188:191]
    ds_read_b128 v[60:63], v13 offset:10240
    v_mfma_f32_16x16x32_bf16 a[156:159], v[56:59], v[84:87], a[156:159]
    ds_read_b128 v[56:59], v13 offset:8192
    v_mfma_f32_16x16x32_bf16 a[216:219], v[64:67], v[80:83], a[216:219]
    s_xor_b32 m0, s44, 3072
    v_mfma_f32_16x16x32_bf16 a[248:251], v[68:71], v[80:83], a[248:251]
    buffer_load_dwordx4 v5, s[8:11], s21 offen lds
    v_mfma_f32_16x16x32_bf16 a[252:255], v[68:71], v[84:87], a[252:255]
    ds_read_b128 v[68:71], v13 offset:14336
    s_add_u32 s21, s21, 128
    v_mfma_f32_16x16x32_bf16 a[220:223], v[64:67], v[84:87], a[220:223]
    ds_read_b128 v[64:67], v13 offset:12288
t_g1_b:
    s_waitcnt lgkmcnt(6)
    v_mfma_f32_16x16x32_bf16 a[0:3], v[40:43], v[72:75], a[0:3]
    v_mfma_f32_16x16x32_bf16 a[32:35], v[44:47], v[72:75], a[32:35]
    s_xor_b32 m0, s44, 16384
    v_mfma_f32_16x16x32_bf16 a[36:39], v[44:47], v[76:79], a[36:39]
    ds_read_b128 v[80:83], v15 offset:4096
    buffer_load_dwordx4 v4, s[8:11], s22 offen lds
    v_mfma_f32_16x16x32_bf16 a[4:7], v[40:43], v[76:79], a[4:7]
    s_cmp_ge_u32 s48, 98304
    s_waitcnt lgkmcnt(5)
    v_mfma_f32_16x16x32_bf16 a[64:67], v[48:51], v[72:75], a[64:67]
    ds_read_b128 v[84:87], v15 offset:6144
    s_cselect_b32 s46, s6, s7
    v_mfma_f32_16x16x32_bf16 a[96:99], v[52:55], v[72:75], a[96:99]
    s_add_u32 s48, s48, s46
    s_xor_b32 m0, s44, 17408
    v_mfma_f32_16x16x32_bf16 a[100:103], v[52:55], v[76:79], a[100:103]
    buffer_load_dwordx4 v5, s[8:11], s22 offen lds
    v_mfma_f32_16x16x32_bf16 a[68:71], v[48:51], v[76:79], a[68:71]
    s_add_u32 s22, s22, 128
    s_waitcnt lgkmcnt(4)
    v_mfma_f32_16x16x32_bf16 a[128:131], v[56:59], v[72:75], a[128:131]
    s_cmp_ge_u32 s49, 98304
    s_cselect_b32 s47, s6, s7
    v_mfma_f32_16x16x32_bf16 a[160:163], v[60:63], v[72:75], a[160:163]
    s_add_u32 s49, s49, s47
    s_xor_b32 m0, s44, 18432
    v_mfma_f32_16x16x32_bf16 a[164:167], v[60:63], v[76:79], a[164:167]
    buffer_load_dwordx4 v4, s[8:11], s23 offen lds
    v_mfma_f32_16x16x32_bf16 a[132:135], v[56:59], v[76:79], a[132:135]
    s_waitcnt lgkmcnt(2)
    v_mfma_f32_16x16x32_bf16 a[192:195], v[64:67], v[72:75], a[192:195]
    v_mfma_f32_16x16x32_bf16 a[224:227], v[68:71], v[72:75], a[224:227]
    s_xor_b32 m0, s44, 19456
    v_mfma_f32_16x16x32_bf16 a[228:231], v[68:71], v[76:79], a[228:231]
    buffer_load_dwordx4 v5, s[8:11], s23 offen lds
    v_mfma_f32_16x16x32_bf16 a[196:199], v[64:67], v[76:79], a[196:199]
    s_add_u32 s23, s23, 128
    s_waitcnt lgkmcnt(1)
    v_mfma_f32_16x16x32_bf16 a[8:11], v[40:43], v[80:83], a[8:11]
    s_cmp_ge_u32 s44, 98304
    s_cselect_b32 s60, s6, s7
    v_mfma_f32_16x16x32_bf16 a[40:43], v[44:47], v[80:83], a[40:43]
    s_add_u32 s44, s44, s60
    s_waitcnt lgkmcnt(0)
    v_mfma_f32_16x16x32_bf16 a[44:47], v[44:47], v[84:87], a[44:47]
    ds_read_b128 v[72:75], v15 offset:8192
    v_add_u32 v12, s46, v12
    v_mfma_f32_16x16x32_bf16 a[12:15], v[40:43], v[84:87], a[12:15]
    v_add_u32 v13, s46, v13
    v_add_u32 v14, s47, v14
    v_mfma_f32_16x16x32_bf16 a[72:75], v[48:51], v[80:83], a[72:75]
    ds_read_b128 v[76:79], v15 offset:10240
    s_xor_b32 m0, s45, 2048
    v_mfma_f32_16x16x32_bf16 a[104:107], v[52:55], v[80:83], a[104:107]
    buffer_load_dwordx4 v6, s[12:15], s25 offen lds
    v_mfma_f32_16x16x32_bf16 a[108:111], v[52:55], v[84:87], a[108:111]
    v_mfma_f32_16x16x32_bf16 a[76:79], v[48:51], v[84:87], a[76:79]
    v_mfma_f32_16x16x32_bf16 a[136:139], v[56:59], v[80:83], a[136:139]
    s_xor_b32 m0, s45, 3072
    v_mfma_f32_16x16x32_bf16 a[168:171], v[60:63], v[80:83], a[168:171]
    buffer_load_dwordx4 v7, s[12:15], s25 offen lds
    v_mfma_f32_16x16x32_bf16 a[172:175], v[60:63], v[84:87], a[172:175]
    s_add_u32 s25, s25, s28
    v_mfma_f32_16x16x32_bf16 a[140:143], v[56:59], v[84:87], a[140:143]
    v_mfma_f32_16x16x32_bf16 a[200:203], v[64:67], v[80:83], a[200:203]
    s_xor_b32 m0, s45, 16384
    v_mfma_f32_16x16x32_bf16 a[232:235], v[68:71], v[80:83], a[232:235]
    buffer_load_dwordx4 v6, s[12:15], s26 offen lds
    v_mfma_f32_16x16x32_bf16 a[236:239], v[68:71], v[84:87], a[236:239]
    v_mfma_f32_16x16x32_bf16 a[204:207], v[64:67], v[84:87], a[204:207]
    s_waitcnt lgkmcnt(1)
    v_mfma_f32_16x16x32_bf16 a[16:19], v[40:43], v[72:75], a[16:19]
    s_xor_b32 m0, s45, 17408
    v_mfma_f32_16x16x32_bf16 a[48:51], v[44:47], v[72:75], a[48:51]
    buffer_load_dwordx4 v7, s[12:15], s26 offen lds
    s_waitcnt lgkmcnt(0)
    v_mfma_f32_16x16x32_bf16 a[52:55], v[44:47], v[76:79], a[52:55]
    ds_read_b128 v[80:83], v15 offset:12288
    s_add_u32 s26, s26, s28
    v_mfma_f32_16x16x32_bf16 a[20:23], v[40:43], v[76:79], a[20:23]
    v_mfma_f32_16x16x32_bf16 a[80:83], v[48:51], v[72:75], a[80:83]
    ds_read_b128 v[84:87], v15 offset:14336
    s_xor_b32 m0, s45, 18432
    v_mfma_f32_16x16x32_bf16 a[112:115], v[52:55], v[72:75], a[112:115]
    buffer_load_dwordx4 v6, s[12:15], s27 offen lds
    v_mfma_f32_16x16x32_bf16 a[116:119], v[52:55], v[76:79], a[116:119]
    v_mfma_f32_16x16x32_bf16 a[84:87], v[48:51], v[76:79], a[84:87]
    s_xor_b32 m0, s45, 19456
    v_mfma_f32_16x16x32_bf16 a[144:147], v[56:59], v[72:75], a[144:147]
    buffer_load_dwordx4 v7, s[12:15], s27 offen lds
    v_mfma_f32_16x16x32_bf16 a[176:179], v[60:63], v[72:75], a[176:179]
    s_add_u32 s27, s27, s28
    s_cmp_ge_u32 s45, 98304
    v_mfma_f32_16x16x32_bf16 a[180:183], v[60:63], v[76:79], a[180:183]
    s_cselect_b32 s60, s6, s7
    s_add_u32 s45, s45, s60
    v_mfma_f32_16x16x32_bf16 a[148:151], v[56:59], v[76:79], a[148:151]
    v_add_u32 v15, s47, v15
    v_mfma_f32_16x16x32_bf16 a[208:211], v[64:67], v[72:75], a[208:211]
    s_add_u32 s43, s43, 1
    s_cmp_eq_u32 s43, 16
    v_mfma_f32_16x16x32_bf16 a[240:243], v[68:71], v[72:75], a[240:243]
    v_mfma_f32_16x16x32_bf16 a[244:247], v[68:71], v[76:79], a[244:247]
    v_mfma_f32_16x16x32_bf16 a[212:215], v[64:67], v[76:79], a[212:215]
    s_waitcnt vmcnt(6) lgkmcnt(0)
    s_barrier
    s_cbranch_scc1 t_g1_last
    v_mfma_f32_16x16x32_bf16 a[24:27], v[40:43], v[80:83], a[24:27]
    ds_read_b128 v[72:75], v14 offset:0
    v_mfma_f32_16x16x32_bf16 a[56:59], v[44:47], v[80:83], a[56:59]
    ds_read_b128 v[76:79], v14 offset:2048
    v_mfma_f32_16x16x32_bf16 a[60:63], v[44:47], v[84:87], a[60:63]
    ds_read_b128 v[44:47], v12 offset:2048
    v_mfma_f32_16x16x32_bf16 a[28:31], v[40:43], v[84:87], a[28:31]
    ds_read_b128 v[40:43], v12 offset:0
    v_mfma_f32_16x16x32_bf16 a[88:91], v[48:51], v[80:83], a[88:91]
    v_mfma_f32_16x16x32_bf16 a[120:123], v[52:55], v[80:83], a[120:123]
    v_mfma_f32_16x16x32_bf16 a[124:127], v[52:55], v[84:87], a[124:127]
    ds_read_b128 v[52:55], v12 offset:6144
    v_mfma_f32_16x16x32_bf16 a[92:95], v[48:51], v[84:87], a[92:95]
    ds_read_b128 v[48:51], v12 offset:4096
    v_mfma_f32_16x16x32_bf16 a[152:155], v[56:59], v[80:83], a[152:155]
    v_mfma_f32_16x16x32_bf16 a[184:187], v[60:63], v[80:83], a[184:187]
    v_mfma_f32_16x16x32_bf16 a[188:191], v[60:63], v[84:87], a[188:191]
    ds_read_b128 v[60:63], v12 offset:10240
    v_mfma_f32_16x16x32_bf16 a[156:159], v[56:59], v[84:87], a[156:159]
    ds_read_b128 v[56:59], v12 offset:8192
    v_mfma_f32_16x16x32_bf16 a[216:219], v[64:67], v[80:83], a[216:219]
    s_sub_u32 s61, s43, 10
    s_cmp_lt_u32 s61, 3
    v_mfma_f32_16x16x32_bf16 a[248:251], v[68:71], v[80:83], a[248:251]
    v_mfma_f32_16x16x32_bf16 a[252:255], v[68:71], v[84:87], a[252:255]
    ds_read_b128 v[68:71], v12 offset:14336
    v_mfma_f32_16x16x32_bf16 a[220:223], v[64:67], v[84:87], a[220:223]
    ds_read_b128 v[64:67], v12 offset:12288
    s_cbranch_scc1 t_g1_a
    s_branch t_g1_hook
t_g1_last:
    v_mfma_f32_16x16x32_bf16 a[24:27], v[40:43], v[80:83], a[24:27]
    v_mfma_f32_16x16x32_bf16 a[56:59], v[44:47], v[80:83], a[56:59]
    v_mfma_f32_16x16x32_bf16 a[60:63], v[44:47], v[84:87], a[60:63]
    v_mfma_f32_16x16x32_bf16 a[28:31], v[40:43], v[84:87], a[28:31]
    v_mfma_f32_16x16x32_bf16 a[88:91], v[48:51], v[80:83], a[88:91]
    v_mfma_f32_16x16x32_bf16 a[120:123], v[52:55], v[80:83], a[120:123]
    v_mfma_f32_16x16x32_bf16 a[124:127], v[52:55], v[84:87], a[124:127]
    v_mfma_f32_16x16x32_bf16 a[92:95], v[48:51], v[84:87], a[92:95]
    v_mfma_f32_16x16x32_bf16 a[152:155], v[56:59], v[80:83], a[152:155]
    v_mfma_f32_16x16x32_bf16 a[184:187], v[60:63], v[80:83], a[184:187]
    v_mfma_f32_16x16x32_bf16 a[188:191], v[60:63], v[84:87], a[188:191]
    v_mfma_f32_16x16x32_bf16 a[156:159], v[56:59], v[84:87], a[156:159]
    v_mfma_f32_16x16x32_bf16 a[216:219], v[64:67], v[80:83], a[216:219]
    v_mfma_f32_16x16x32_bf16 a[248:251], v[68:71], v[80:83], a[248:251]
    v_mfma_f32_16x16x32_bf16 a[252:255], v[68:71], v[84:87], a[252:255]
    v_mfma_f32_16x16x32_bf16 a[220:223], v[64:67], v[84:87], a[220:223]
    s_setpc_b64 s[54:55]
t_conv:
    s_nop 7
    v_accvgpr_read_b32 v88, a0
    v_accvgpr_read_b32 v89, a1
    v_accvgpr_read_b32 v90, a2
    v_accvgpr_read_b32 v91, a3
    v_accvgpr_read_b32 v92, a4
    v_accvgpr_read_b32 v93, a5
    v_accvgpr_read_b32 v94, a6
    v_accvgpr_read_b32 v95, a7
    v_cvt_pk_bf16_f32 v128, v88, v89
    v_cvt_pk_bf16_f32 v129, v90, v91
    v_cvt_pk_bf16_f32 v130, v92, v93
    v_cvt_pk_bf16_f32 v131, v94, v95
    v_accvgpr_read_b32 v96, a8
    v_accvgpr_read_b32 v97, a9
    v_accvgpr_read_b32 v98, a10
    v_accvgpr_read_b32 v99, a11
    v_accvgpr_read_b32 v100, a12
    v_accvgpr_read_b32 v101, a13
    v_accvgpr_read_b32 v102, a14
    v_accvgpr_read_b32 v103, a15
    v_cvt_pk_bf16_f32 v132, v96, v97
    v_cvt_pk_bf16_f32 v133, v98, v99
    v_cvt_pk_bf16_f32 v134, v100, v101
    v_cvt_pk_bf16_f32 v135, v102, v103
    v_accvgpr_read_b32 v88, a16
    v_accvgpr_read_b32 v89, a17
    v_accvgpr_read_b32 v90, a18
    v_accvgpr_read_b32 v91, a19
    v_accvgpr_read_b32 v92, a20
    v_accvgpr_read_b32 v93, a21
    v_accvgpr_read_b32 v94, a22
    v_accvgpr_read_b32 v95, a23
    v_cvt_pk_bf16_f32 v136, v88, v89
    v_cvt_pk_bf16_f32 v137, v90, v91
    v_cvt_pk_bf16_f32 v138, v92, v93
    v_cvt_pk_bf16_f32 v139, v94, v95
    v_accvgpr_read_b32 v96, a24
    v_accvgpr_read_b32 v97, a25
    v_accvgpr_read_b32 v98, a26
    v_accvgpr_read_b32 v99, a27
    v_accvgpr_read_b32 v100, a28
    v_accvgpr_read_b32 v101, a29
    v_accvgpr_read_b32 v102, a30
    v_accvgpr_read_b32 v103, a31
    v_cvt_pk_bf16_f32 v140, v96, v97
    v_cvt_pk_bf16_f32 v141, v98, v99
    v_cvt_pk_bf16_f32 v142, v100, v101
    v_cvt_pk_bf16_f32 v143, v102, v103
    v_accvgpr_read_b32 v88, a32
    v_accvgpr_read_b32 v89, a33
    v_accvgpr_read_b32 v90, a34
    v_accvgpr_read_b32 v91, a35
    v_accvgpr_read_b32 v92, a36
    v_accvgpr_read_b32 v93, a37
    v_accvgpr_read_b32 v94, a38
    v_accvgpr_read_b32 v95, a39
    v_cvt_pk_bf16_f32 v144, v88, v89
    v_cvt_pk_bf16_f32 v145, v90, v91
    v_cvt_pk_bf16_f32 v146, v92, v93
    v_cvt_pk_bf16_f32 v147, v94, v95
    v_accvgpr_read_b32 v96, a40
    v_accvgpr_read_b32 v97, a41
    v_accvgpr_read_b32 v98, a42
    v_accvgpr_read_b32 v99, a43
    v_accvgpr_read_b32 v100, a44
    v_accvgpr_read_b32 v101, a45
    v_accvgpr_read_b32 v102, a46
    v_accvgpr_read_b32 v103, a47
    v_cvt_pk_bf16_f32 v148, v96, v97
    v_cvt_pk_bf16_f32 v149, v98, v99
    v_cvt_pk_bf16_f32 v150, v100, v101
    v_cvt_pk_bf16_f32 v151, v102, v103
    v_accvgpr_read_b32 v88, a48
    v_accvgpr_read_b32 v89, a49
    v_accvgpr_read_b32 v90, a50
    v_accvgpr_read_b32 v91, a51
    v_accvgpr_read_b32 v92, a52
    v_accvgpr_read_b32 v93, a53
    v_accvgpr_read_b32 v94, a54
    v_accvgpr_read_b32 v95, a55
    v_cvt_pk_bf16_f32 v152, v88, v89
    v_cvt_pk_bf16_f32 v153, v90, v91
    v_cvt_pk_bf16_f32 v154, v92, v93
    v_cvt_pk_bf16_f32 v155, v94, v95
    v_accvgpr_read_b32 v96, a56
    v_accvgpr_read_b32 v97, a57
    v_accvgpr_read_b32 v98, a58
    v_accvgpr_read_b32 v99, a59
    v_accvgpr_read_b32 v100, a60
    v_accvgpr_read_b32 v101, a61
    v_accvgpr_read_b32 v102, a62
    v_accvgpr_read_b32 v103, a63
    v_cvt_pk_bf16_f32 v156, v96, v97
    v_cvt_pk_bf16_f32 v157, v98, v99
    v_cvt_pk_bf16_f32 v158, v100, v101
    v_cvt_pk_bf16_f32 v159, v102, v103
    v_accvgpr_read_b32 v88, a64
    v_accvgpr_read_b32 v89, a65
    v_accvgpr_read_b32 v90, a66
    v_accvgpr_read_b32 v91, a67
    v_accvgpr_read_b32 v92, a68
    v_accvgpr_read_b32 v93, a69
    v_accvgpr_read_b32 v94, a70
    v_accvgpr_read_b32 v95, a71
    v_cvt_pk_bf16_f32 v160, v88, v89
    v_cvt_pk_bf16_f32 v161, v90, v91
    v_cvt_pk_bf16_f32 v162, v92, v93
    v_cvt_pk_bf16_f32 v163, v94, v95
    v_accvgpr_read_b32 v96, a72
    v_accvgpr_read_b32 v97, a73
    v_accvgpr_read_b32 v98, a74
    v_accvgpr_read_b32 v99, a75
    v_accvgpr_read_b32 v100, a76
    v_accvgpr_read_b32 v101, a77
    v_accvgpr_read_b32 v102, a78
    v_accvgpr_read_b32 v103, a79
    v_cvt_pk_bf16_f32 v164, v96, v97
    v_cvt_pk_bf16_f32 v165, v98, v99
    v_cvt_pk_bf16_f32 v166, v100, v101
    v_cvt_pk_bf16_f32 v167, v102, v103
    v_accvgpr_read_b32 v88, a80
    v_accvgpr_read_b32 v89, a81
    v_accvgpr_read_b32 v90, a82
    v_accvgpr_read_b32 v91, a83
    v_accvgpr_read_b32 v92, a84
    v_accvgpr_read_b32 v93, a85
    v_accvgpr_read_b32 v94, a86
    v_accvgpr_read_b32 v95, a87
    v_cvt_pk_bf16_f32 v168, v88, v89
    v_cvt_pk_bf16_f32 v169, v90, v91
    v_cvt_pk_bf16_f32 v170, v92, v93
    v_cvt_pk_bf16_f32 v171, v94, v95
    v_accvgpr_read_b32 v96, a88
    v_accvgpr_read_b32 v97, a89
    v_accvgpr_read_b32 v98, a90
    v_accvgpr_read_b32 v99, a91
    v_accvgpr_read_b32 v100, a92
    v_accvgpr_read_b32 v101, a93
    v_accvgpr_read_b32 v102, a94
    v_accvgpr_read_b32 v103, a95
    v_cvt_pk_bf16_f32 v172, v96, v97
    v_cvt_pk_bf16_f32 v173, v98, v99
    v_cvt_pk_bf16_f32 v174, v100, v101
    v_cvt_pk_bf16_f32 v175, v102, v103
    v_accvgpr_read_b32 v88, a96
    v_accvgpr_read_b32 v89, a97
    v_accvgpr_read_b32 v90, a98
    v_accvgpr_read_b32 v91, a99
    v_accvgpr_read_b32 v92, a100
    v_accvgpr_read_b32 v93, a101
    v_accvgpr_read_b32 v94, a102
    v_accvgpr_read_b32 v95, a103
    v_cvt_pk_bf16_f32 v176, v88, v89
    v_cvt_pk_bf16_f32 v177, v90, v91
    v_cvt_pk_bf16_f32 v178, v92, v93
    v_cvt_pk_bf16_f32 v179, v94, v95
    v_accvgpr_read_b32 v96, a104
    v_accvgpr_read_b32 v97, a105
    v_accvgpr_read_b32 v98, a106
    v_accvgpr_read_b32 v99, a107
    v_accvgpr_read_b32 v100, a108
    v_accvgpr_read_b32 v101, a109
    v_accvgpr_read_b32 v102, a110
    v_accvgpr_read_b32 v103, a111
    v_cvt_pk_bf16_f32 v180, v96, v97
    v_cvt_pk_bf16_f32 v181, v98, v99
    v_cvt_pk_bf16_f32 v182, v100, v101
    v_cvt_pk_bf16_f32 v183, v102, v103
    v_accvgpr_read_b32 v88, a112
    v_accvgpr_read_b32 v89, a113
    v_accvgpr_read_b32 v90, a114
    v_accvgpr_read_b32 v91, a115
    v_accvgpr_read_b32 v92, a116
    v_accvgpr_read_b32 v93, a117
    v_accvgpr_read_b32 v94, a118
    v_accvgpr_read_b32 v95, a119
    v_cvt_pk_bf16_f32 v184, v88, v89
    v_cvt_pk_bf16_f32 v185, v90, v91
    v_cvt_pk_bf16_f32 v186, v92, v93
    v_cvt_pk_bf16_f32 v187, v94, v95
    v_accvgpr_read_b32 v96, a120
    v_accvgpr_read_b32 v97, a121
    v_accvgpr_read_b32 v98, a122
    v_accvgpr_read_b32 v99, a123
    v_accvgpr_read_b32 v100, a124
    v_accvgpr_read_b32 v101, a125
    v_accvgpr_read_b32 v102, a126
    v_accvgpr_read_b32 v103, a127
    v_cvt_pk_bf16_f32 v188, v96, v97
    v_cvt_pk_bf16_f32 v189, v98, v99
    v_cvt_pk_bf16_f32 v190, v100, v101
    v_cvt_pk_bf16_f32 v191, v102, v103
    v_accvgpr_read_b32 v88, a128
    v_accvgpr_read_b32 v89, a129
    v_accvgpr_read_b32 v90, a130
    v_accvgpr_read_b32 v91, a131
    v_accvgpr_read_b32 v92, a132
    v_accvgpr_read_b32 v93, a133
    v_accvgpr_read_b32 v94, a134
    v_accvgpr_read_b32 v95, a135
    v_cvt_pk_bf16_f32 v192, v88, v89
    v_cvt_pk_bf16_f32 v193, v90, v91
    v_cvt_pk_bf16_f32 v194, v92, v93
    v_cvt_pk_bf16_f32 v195, v94, v95
    v_accvgpr_read_b32 v96, a136
    v_accvgpr_read_b32 v97, a137
    v_accvgpr_read_b32 v98, a138
    v_accvgpr_read_b32 v99, a139
    v_accvgpr_read_b32 v100, a140
    v_accvgpr_read_b32 v101, a141
    v_accvgpr_read_b32 v102, a142
    v_accvgpr_read_b32 v103, a143
    v_cvt_pk_bf16_f32 v196, v96, v97
    v_cvt_pk_bf16_f32 v197, v98, v99
    v_cvt_pk_bf16_f32 v198, v100, v101
    v_cvt_pk_bf16_f32 v199, v102, v103
    v_accvgpr_read_b32 v88, a144
    v_accvgpr_read_b32 v89, a145
    v_accvgpr_read_b32 v90, a146
    v_accvgpr_read_b32 v91, a147
    v_accvgpr_read_b32 v92, a148
    v_accvgpr_read_b32 v93, a149
    v_accvgpr_read_b32 v94, a150
    v_accvgpr_read_b32 v95, a151
    v_cvt_pk_bf16_f32 v200, v88, v89
    v_cvt_pk_bf16_f32 v201, v90, v91
    v_cvt_pk_bf16_f32 v202, v92, v93
    v_cvt_pk_bf16_f32 v203, v94, v95
    v_accvgpr_read_b32 v96, a152
    v_accvgpr_read_b32 v97, a153
    v_accvgpr_read_b32 v98, a154
    v_accvgpr_read_b32 v99, a155
    v_accvgpr_read_b32 v100, a156
    v_accvgpr_read_b32 v101, a157
    v_accvgpr_read_b32 v102, a158
    v_accvgpr_read_b32 v103, a159
    v_cvt_pk_bf16_f32 v204, v96, v97
    v_cvt_pk_bf16_f32 v205, v98, v99
    v_cvt_pk_bf16_f32 v206, v100, v101
    v_cvt_pk_bf16_f32 v207, v102, v103
    v_accvgpr_read_b32 v88, a160
    v_accvgpr_read_b32 v89, a161
    v_accvgpr_read_b32 v90, a162
    v_accvgpr_read_b32 v91, a163
    v_accvgpr_read_b32 v92, a164
    v_accvgpr_read_b32 v93, a165
    v_accvgpr_read_b32 v94, a166
    v_accvgpr_read_b32 v95, a167
    v_cvt_pk_bf16_f32 v208, v88, v89
    v_cvt_pk_bf16_f32 v209, v90, v91
    v_cvt_pk_bf16_f32 v210, v92, v93
    v_cvt_pk_bf16_f32 v211, v94, v95
    v_accvgpr_read_b32 v96, a168
    v_accvgpr_read_b32 v97, a169
    v_accvgpr_read_b32 v98, a170
    v_accvgpr_read_b32 v99, a171
    v_accvgpr_read_b32 v100, a172
    v_accvgpr_read_b32 v101, a173
    v_accvgpr_read_b32 v102, a174
    v_accvgpr_read_b32 v103, a175
    v_cvt_pk_bf16_f32 v212, v96, v97
    v_cvt_pk_bf16_f32 v213, v98, v99
    v_cvt_pk_bf16_f32 v214, v100, v101
    v_cvt_pk_bf16_f32 v215, v102, v103
    v_accvgpr_read_b32 v88, a176
    v_accvgpr_read_b32 v89, a177
    v_accvgpr_read_b32 v90, a178
    v_accvgpr_read_b32 v91, a179
    v_accvgpr_read_b32 v92, a180
    v_accvgpr_read_b32 v93, a181
    v_accvgpr_read_b32 v94, a182
    v_accvgpr_read_b32 v95, a183
    v_cvt_pk_bf16_f32 v216, v88, v89
    v_cvt_pk_bf16_f32 v217, v90, v91
    v_cvt_pk_bf16_f32 v218, v92, v93
    v_cvt_pk_bf16_f32 v219, v94, v95
    v_accvgpr_read_b32 v96, a184
    v_accvgpr_read_b32 v97, a185
    v_accvgpr_read_b32 v98, a186
    v_accvgpr_read_b32 v99, a187
    v_accvgpr_read_b32 v100, a188
    v_accvgpr_read_b32 v101, a189
    v_accvgpr_read_b32 v102, a190
    v_accvgpr_read_b32 v103, a191
    v_cvt_pk_bf16_f32 v220, v96, v97
    v_cvt_pk_bf16_f32 v221, v98, v99
    v_cvt_pk_bf16_f32 v222, v100, v101
    v_cvt_pk_bf16_f32 v223, v102, v103
    v_accvgpr_read_b32 v88, a192
    v_accvgpr_read_b32 v89, a193
    v_accvgpr_read_b32 v90, a194
    v_accvgpr_read_b32 v91, a195
    v_accvgpr_read_b32 v92, a196
    v_accvgpr_read_b32 v93, a197
    v_accvgpr_read_b32 v94, a198
    v_accvgpr_read_b32 v95, a199
    v_cvt_pk_bf16_f32 v224, v88, v89
    v_cvt_pk_bf16_f32 v225, v90, v91
    v_cvt_pk_bf16_f32 v226, v92, v93
    v_cvt_pk_bf16_f32 v227, v94, v95
    v_accvgpr_read_b32 v96, a200
    v_accvgpr_read_b32 v97, a201
    v_accvgpr_read_b32 v98, a202
    v_accvgpr_read_b32 v99, a203
    v_accvgpr_read_b32 v100, a204
    v_accvgpr_read_b32 v101, a205
    v_accvgpr_read_b32 v102, a206
    v_accvgpr_read_b32 v103, a207
    v_cvt_pk_bf16_f32 v228, v96, v97
    v_cvt_pk_bf16_f32 v229, v98, v99
    v_cvt_pk_bf16_f32 v230, v100, v101
    v_cvt_pk_bf16_f32 v231, v102, v103
    v_accvgpr_read_b32 v88, a208
    v_accvgpr_read_b32 v89, a209
    v_accvgpr_read_b32 v90, a210
    v_accvgpr_read_b32 v91, a211
    v_accvgpr_read_b32 v92, a212
    v_accvgpr_read_b32 v93, a213
    v_accvgpr_read_b32 v94, a214
    v_accvgpr_read_b32 v95, a215
    v_cvt_pk_bf16_f32 v232, v88, v89
    v_cvt_pk_bf16_f32 v233, v90, v91
    v_cvt_pk_bf16_f32 v234, v92, v93
    v_cvt_pk_bf16_f32 v235, v94, v95
    v_accvgpr_read_b32 v96, a216
    v_accvgpr_read_b32 v97, a217
    v_accvgpr_read_b32 v98, a218
    v_accvgpr_read_b32 v99, a219
    v_accvgpr_read_b32 v100, a220
    v_accvgpr_read_b32 v101, a221
    v_accvgpr_read_b32 v102, a222
    v_accvgpr_read_b32 v103, a223
    v_cvt_pk_bf16_f32 v236, v96, v97
    v_cvt_pk_bf16_f32 v237, v98, v99
    v_cvt_pk_bf16_f32 v238, v100, v101
    v_cvt_pk_bf16_f32 v239, v102, v103
    v_accvgpr_read_b32 v88, a224
    v_accvgpr_read_b32 v89, a225
    v_accvgpr_read_b32 v90, a226
    v_accvgpr_read_b32 v91, a227
    v_accvgpr_read_b32 v92, a228
    v_accvgpr_read_b32 v93, a229
    v_accvgpr_read_b32 v94, a230
    v_accvgpr_read_b32 v95, a231
    v_cvt_pk_bf16_f32 v240, v88, v89
    v_cvt_pk_bf16_f32 v241, v90, v91
    v_cvt_pk_bf16_f32 v242, v92, v93
    v_cvt_pk_bf16_f32 v243, v94, v95
    v_accvgpr_read_b32 v96, a232
    v_accvgpr_read_b32 v97, a233
    v_accvgpr_read_b32 v98, a234
    v_accvgpr_read_b32 v99, a235
    v_accvgpr_read_b32 v100, a236
    v_accvgpr_read_b32 v101, a237
    v_accvgpr_read_b32 v102, a238
    v_accvgpr_read_b32 v103, a239
    v_cvt_pk_bf16_f32 v244, v96, v97
    v_cvt_pk_bf16_f32 v245, v98, v99
    v_cvt_pk_bf16_f32 v246, v100, v101
    v_cvt_pk_bf16_f32 v247, v102, v103
    v_accvgpr_read_b32 v88, a240
    v_accvgpr_read_b32 v89, a241
    v_accvgpr_read_b32 v90, a242
    v_accvgpr_read_b32 v91, a243
    v_accvgpr_read_b32 v92, a244
    v_accvgpr_read_b32 v93, a245
    v_accvgpr_read_b32 v94, a246
    v_accvgpr_read_b32 v95, a247
    v_cvt_pk_bf16_f32 v248, v88, v89
    v_cvt_pk_bf16_f32 v249, v90, v91
    v_cvt_pk_bf16_f32 v250, v92, v93
    v_cvt_pk_bf16_f32 v251, v94, v95
    v_accvgpr_read_b32 v96, a248
    v_accvgpr_read_b32 v97, a249
    v_accvgpr_read_b32 v98, a250
    v_accvgpr_read_b32 v99, a251
    v_accvgpr_read_b32 v100, a252
    v_accvgpr_read_b32 v101, a253
    v_accvgpr_read_b32 v102, a254
    v_accvgpr_read_b32 v103, a255
    v_cvt_pk_bf16_f32 v252, v96, v97
    v_cvt_pk_bf16_f32 v253, v98, v99
    v_cvt_pk_bf16_f32 v254, v100, v101
    v_cvt_pk_bf16_f32 v255, v102, v103
    s_setpc_b64 s[54:55]
t_flush:
    s_mov_b32 s53, s50
    buffer_store_dwordx4 v[128:131], v2, s[16:19], s53 offen offset:0 sc1
    buffer_store_dwordx4 v[132:135], v2, s[16:19], s53 offen offset:1024 sc1
    buffer_store_dwordx4 v[136:139], v2, s[16:19], s53 offen offset:2048 sc1
    buffer_store_dwordx4 v[140:143], v2, s[16:19], s53 offen offset:3072 sc1
    s_add_u32 s53, s53, 4096
    buffer_store_dwordx4 v[144:147], v2, s[16:19], s53 offen offset:0 sc1
    buffer_store_dwordx4 v[148:151], v2, s[16:19], s53 offen offset:1024 sc1
    buffer_store_dwordx4 v[152:155], v2, s[16:19], s53 offen offset:2048 sc1
    buffer_store_dwordx4 v[156:159], v2, s[16:19], s53 offen offset:3072 sc1
    s_mov_b32 s53, s50
    s_add_u32 s53, s53, s51
    buffer_store_dwordx4 v[160:163], v2, s[16:19], s53 offen offset:0 sc1
    buffer_store_dwordx4 v[164:167], v2, s[16:19], s53 offen offset:1024 sc1
    buffer_store_dwordx4 v[168:171], v2, s[16:19], s53 offen offset:2048 sc1
    buffer_store_dwordx4 v[172:175], v2, s[16:19], s53 offen offset:3072 sc1
    s_add_u32 s53, s53, 4096
    buffer_store_dwordx4 v[176:179], v2, s[16:19], s53 offen offset:0 sc1
    buffer_store_dwordx4 v[180:183], v2, s[16:19], s53 offen offset:1024 sc1
    buffer_store_dwordx4 v[184:187], v2, s[16:19], s53 offen offset:2048 sc1
    buffer_store_dwordx4 v[188:191], v2, s[16:19], s53 offen offset:3072 sc1
    s_mov_b32 s53, s50
    s_add_u32 s53, s53, s52
    buffer_store_dwordx4 v[192:195], v2, s[16:19], s53 offen offset:0 sc1
    buffer_store_dwordx4 v[196:199], v2, s[16:19], s53 offen offset:1024 sc1
    buffer_store_dwordx4 v[200:203], v2, s[16:19], s53 offen offset:2048 sc1
    buffer_store_dwordx4 v[204:207], v2, s[16:19], s53 offen offset:3072 sc1
    s_add_u32 s53, s53, 4096
    buffer_store_dwordx4 v[208:211], v2, s[16:19], s53 offen offset:0 sc1
    buffer_store_dwordx4 v[212:215], v2, s[16:19], s53 offen offset:1024 sc1
    buffer_store_dwordx4 v[216:219], v2, s[16:19], s53 offen offset:2048 sc1
    buffer_store_dwordx4 v[220:223], v2, s[16:19], s53 offen offset:3072 sc1
    s_mov_b32 s53, s50
    s_add_u32 s53, s53, s51
    s_add_u32 s53, s53, s52
    buffer_store_dwordx4 v[224:227], v2, s[16:19], s53 offen offset:0 sc1
    buffer_store_dwordx4 v[228:231], v2, s[16:19], s53 offen offset:1024 sc1
    buffer_store_dwordx4 v[232:235], v2, s[16:19], s53 offen offset:2048 sc1
    buffer_store_dwordx4 v[236:239], v2, s[16:19], s53 offen offset:3072 sc1
    s_add_u32 s53, s53, 4096
    buffer_store_dwordx4 v[240:243], v2, s[16:19], s53 offen offset:0 sc1
    buffer_store_dwordx4 v[244:247], v2, s[16:19], s53 offen offset:1024 sc1
    buffer_store_dwordx4 v[248:251], v2, s[16:19], s53 offen offset:2048 sc1
    buffer_store_dwordx4 v[252:255], v2, s[16:19], s53 offen offset:3072 sc1
    s_setpc_b64 s[54:55]
.section .rodata,"a"
.p2align 6
.amdhsa_kernel chain_kernel
  .amdhsa_next_free_vgpr 512
  .amdhsa_next_free_sgpr 102
  .amdhsa_accum_offset 256
  .amdhsa_group_segment_fixed_size 0
  .amdhsa_kernarg_size 152
  .amdhsa_user_sgpr_count 2
  .amdhsa_user_sgpr_kernarg_segment_ptr 1
  .amdhsa_system_sgpr_workgroup_id_x 1
  .amdhsa_float_denorm_mode_32 3
  .amdhsa_float_denorm_mode_16_64 3
.end_amdhsa_kernel
```

```asm
; @launch kernel=chain_kernel grid=(256,1,1) block=(256,1,1) lds=163840
.amdgcn_target "amdgcn-amd-amdhsa--gfx950"
.text
.globl chain_kernel
.p2align 8
.type chain_kernel,@function
chain_kernel:
    s_cmp_ge_u32 s2, 256
    s_cbranch_scc1 chain_kernel_end
    s_load_dwordx4 s[96:99], s[0:1], 128
    s_load_dwordx2 s[100:101], s[0:1], 144
    s_load_dwordx16 s[64:79], s[0:1], 0
    s_load_dwordx16 s[80:95], s[0:1], 64
    s_getreg_b32 s16, hwreg(HW_REG_XCC_ID)
    s_and_b32 s16, s16, 7
    v_lshrrev_b32 v1, 6, v0
    s_nop 0
    v_readfirstlane_b32 s18, v1
    s_waitcnt lgkmcnt(0)
    s_cmp_lg_u32 s18, 0
    s_cbranch_scc1 L_cal_2
    s_lshl_b32 s3, s16, 2
    s_add_u32 s3, s3, 128
    s_mov_b32 s17, 1
    s_atomic_add s17, s[98:99], s3 glc
    v_mov_b32 v2, 31744
    s_waitcnt lgkmcnt(0)
    v_mov_b32 v1, s17
    ds_write_b32 v2, v1
    s_waitcnt lgkmcnt(0)
    s_branch L_role_1
L_cal_2:
    s_cmp_lg_u32 s18, 1
    s_cbranch_scc1 L_role_1
    s_cmp_ge_u32 s2, 15
    s_cbranch_scc1 L_role_1
    s_lshl_b32 s3, s2, 14
    s_add_u32 s3, s3, 0xb400000
    s_add_u32 s4, s100, s3
    s_addc_u32 s5, s101, 0
    s_mov_b32 s6, 0
    s_atomic_or s6, s[4:5], 0
    s_atomic_or s6, s[4:5], 0x2000
    s_waitcnt lgkmcnt(0)
    s_memtime s[8:9]
    s_atomic_or s6, s[4:5], 0
    s_waitcnt lgkmcnt(0)
    s_memtime s[10:11]
    s_atomic_or s6, s[4:5], 0x2000
    s_waitcnt lgkmcnt(0)
    s_memtime s[12:13]
    s_waitcnt lgkmcnt(0)
    s_sub_u32 s12, s12, s10
    s_sub_u32 s10, s10, s8
    s_cmp_lt_u32 s12, s10
    s_cselect_b32 s6, 0x100, 0
    s_lshl_b32 s7, s16, 6
    s_and_b32 s7, s7, 0x100
    s_xor_b32 s6, s6, s7
    s_add_u32 s6, s6, 1
    s_atomic_add s6, s[98:99], 4
L_role_1:
    s_barrier
    v_mov_b32 v2, 31744
    ds_read_b32 v1, v2
    s_waitcnt lgkmcnt(0)
    v_readfirstlane_b32 s17, v1
    s_barrier
    s_cmp_ge_u32 s17, 32
    s_cbranch_scc1 chain_kernel_end
    s_cmp_ge_u32 s16, 4
    s_cbranch_scc1 chain_kernel_worker
    s_mov_b32 s8, s100
    s_and_b32 s9, s101, 0xffff
    s_mov_b32 s10, 0x10000000
    s_mov_b32 s11, 0x00020000
    s_mov_b32 s33, 0
    s_mov_b32 s24, 0x00ff00ff
    s_mov_b32 s25, 0x00ff00ff
    s_mov_b32 s26, 0x55555555
    s_mov_b32 s27, 0x55555555
    s_mov_b32 s56, 0x3fb8aa3b
    s_mov_b32 s57, 0x3fb8aa3b
    s_mov_b32 s58, 0x3db504f3
    s_mov_b32 s59, 0x3db504f3
    s_lshl_b32 s53, s16, 16
    s_add_u32 s53, s53, 0xb000000
    s_xor_b32 s29, s17, 8
    s_and_b32 s28, s17, 1
    s_bfe_u32 s20, s17, 0x10001
    s_xor_b32 s20, s20, 1
    s_lshl1_add_u32 s28, s28, s20
    s_lshl_b32 s47, s16, 5
    s_add_u32 s47, s47, s17
    s_mov_b64 s[60:61], s[98:99]
    v_mov_b32 v28, -1
    v_mov_b32 v29, -1
    v_mov_b32 v30, -1
    v_mov_b32 v31, -1
    v_and_b32 v210, 63, v0
    v_and_b32 v208, 15, v0
    v_bfe_u32 v209, v0, 4, 2
    v_lshlrev_b32 v1, 4, v210
    v_lshlrev_b32 v26, 3, v210
    s_lshl_b32 s21, s18, 12
    v_add_u32 v2, s21, v1
    s_xor_b32 s22, s18, 3
    s_lshl_b32 s22, s22, 4
    v_xor_b32 v3, s22, v2
    v_add_u32 v3, 16384, v3
    s_and_b32 s22, s22, 16
    s_lshl_b32 s22, s22, 1
    v_xor_b32 v2, s22, v2
    v_mov_b32 v19, 0xeeeeeeee
    v_mov_b32 v212, 0x44444444
    v_cndmask_b32 v19, v19, v212, s[24:25]
    v_mov_b32 v18, 0x03020706
    v_mov_b32 v212, 0x05040100
    v_cndmask_b32 v18, v18, v212, s[26:27]
    s_lshr_b32 s21, s17, 2
    s_lshl_b32 s21, s21, 12
    s_add_u32 s21, s21, 32768
    v_add_u32 v5, s21, v1
    s_and_b32 s22, s28, 1
    s_lshl_b32 s22, s22, 11
    s_add_u32 s21, s21, s22
    s_bfe_u32 s22, s28, 0x10001
    s_lshl_b32 s22, s22, 7
    s_add_u32 s23, s21, s22
    v_and_b32 v212, 1, v209
    v_lshlrev_b32 v234, 6, v212
    v_and_b32 v212, 1, v208
    v_lshl_add_u32 v234, v212, 4, v234
    v_bfe_u32 v212, v208, 1, 2
    v_lshl_add_u32 v234, v212, 2, v234
    s_and_b32 s22, s18, 1
    s_lshl_b32 s22, s22, 5
    v_add_u32 v234, s22, v234
    v_lshrrev_b32 v212, 3, v208
    v_and_b32 v213, 2, v209
    v_add_u32 v212, v212, v213
    s_and_b32 s22, s18, 2
    s_lshl_b32 s22, s22, 1
    v_add_u32 v212, s22, v212
    v_lshl_add_u32 v4, v212, 8, v234
    v_lshl_add_u32 v234, v212, 7, v234
    v_add_u32 v4, s23, v4
    v_lshrrev_b32 v212, 3, v210
    v_and_b32 v213, 7, v210
    v_lshlrev_b32 v22, 8, v212
    v_lshl_add_u32 v22, v213, 4, v22
    v_add_u32 v22, s23, v22
    s_lshr_b32 s20, s47, 2
    s_lshl_b32 s48, s20, 16
    s_and_b32 s21, s17, 3
    s_lshl_b32 s22, s21, 11
    s_add_u32 s22, s22, 0x4000
    v_add_u32 v237, s22, v1
    v_lshlrev_b32 v236, 7, v208
    v_and_b32 v212, 1, v209
    v_lshl_add_u32 v236, v212, 15, v236
    s_lshl_b32 s22, s21, 11
    v_add_u32 v236, s22, v236
    v_mov_b32 v25, v236
    s_cmp_lt_u32 s18, 2
    s_cselect_b32 s38, 0xf0000000, 0
    s_cmp_lg_u32 s18, 1
    s_cselect_b32 s39, 0xf0000000, 0
    s_lshr_b32 s22, s18, 1
    s_mul_i32 s54, s22, 10240
    s_lshl_b32 s22, s22, 15
    s_and_b32 s23, s18, 1
    s_lshl_b32 s23, s23, 12
    s_add_u32 s54, s54, s23
    s_add_u32 s54, s54, 32768
    s_add_u32 s22, s22, s23
    v_add_u32 v235, s22, v1
    v_lshrrev_b32 v212, 3, v210
    v_lshl_add_u32 v24, v212, 7, v5
    v_add_u32 v24, 128, v24
    s_and_b32 s22, s18, 1
    s_lshl_b32 s22, s22, 12
    v_add_u32 v242, s22, v1
    s_lshl_b32 s21, s21, 10
    s_add_u32 s21, s21, 0xc000
    v_add_u32 v23, s21, v242
    v_lshlrev_b32 v241, 7, v209
    v_bfe_u32 v212, v0, 2, 1
    v_lshl_add_u32 v241, v212, 6, v241
    v_bfe_u32 v212, v0, 3, 1
    v_lshl_add_u32 v241, v212, 5, v241
    v_bfe_u32 v212, v0, 0, 1
    v_lshl_add_u32 v241, v212, 4, v241
    v_and_b32 v212, 7, v208
    v_lshlrev_b32 v6, 4, v212
    v_lshl_add_u32 v6, v209, 7, v6
    s_lshl_b32 s21, s17, 9
    s_add_u32 s22, s21, 16384
    v_add_u32 v6, s22, v6
    v_lshrrev_b32 v212, 3, v208
    v_and_b32 v213, 2, v209
    v_add_u32 v212, v212, v213
    v_lshlrev_b32 v7, 7, v212
    v_and_b32 v212, 1, v209
    v_lshl_add_u32 v7, v212, 6, v7
    v_bfe_u32 v212, v208, 1, 2
    v_lshl_add_u32 v7, v212, 2, v7
    s_lshl_b32 s21, s29, 9
    s_lshl_b32 s22, s18, 4
    s_add_u32 s21, s21, s22
    v_add_u32 v7, s21, v7
    v_bfe_u32 v212, v210, 1, 3
    v_and_b32 v213, 1, v210
    v_lshlrev_b32 v27, 11, v212
    v_lshl_add_u32 v27, v213, 3, v27
    v_lshl_add_u32 v27, v209, 4, v27
    s_lshl_b32 s21, s29, 6
    v_add_u32 v27, s21, v27
    v_lshlrev_b32 v212, 2, v210
    s_xor_b32 s21, s18, 3
    s_mul_i32 s21, s21, 768
    s_add_u32 s21, s21, 0
    v_add_u32 v238, s21, v212
    v_lshlrev_b32 v12, 1, v238
    s_xor_b32 s21, s18, 2
    s_mul_i32 s21, s21, 768
    s_add_u32 s21, s21, 256
    v_add_u32 v239, s21, v212
    v_lshlrev_b32 v13, 1, v239
    s_xor_b32 s21, s18, 1
    s_mul_i32 s21, s21, 768
    s_add_u32 s21, s21, 512
    v_add_u32 v240, s21, v212
    v_lshlrev_b32 v14, 1, v240
    s_mul_i32 s21, s18, 768
    v_add_u32 v17, s21, v212
    v_lshlrev_b32 v15, 1, v17
    s_lshl_b32 s21, s18, 10
    v_add_u32 v16, s21, v1
    s_lshl_b32 s42, s18, 18
    s_add_u32 s42, s42, s53
    buffer_store_dwordx4 v[28:31], v22, s[8:11], s42 offen
    s_lshl_b32 s21, s29, 9
    s_add_u32 s21, s21, s42
    buffer_store_dwordx2 v[28:29], v26, s[8:11], s21 offen
    s_xor_b32 s21, s21, 20480
    buffer_store_dwordx2 v[28:29], v26, s[8:11], s21 offen
    s_lshl_b32 s62, s16, 8
    s_add_u32 s62, s62, 0xb200000
    s_cmp_eq_u32 s17, 1
    s_cselect_b32 s21, s62, 0x10000000
    v_mov_b32 v248, 0
    buffer_store_dword v248, v248, s[8:11], s21 offen
    s_add_u32 s21, s21, 4096
    buffer_store_dword v248, v248, s[8:11], s21 offen sc1
    s_mov_b32 s12, s84
    s_and_b32 s13, s85, 0xffff
    s_mov_b32 s14, 0x4000
    s_mov_b32 s15, 0x00020000
    buffer_load_dwordx2 v[232:233], v27, s[12:15], 0 offen
    s_lshl_b32 s20, s16, 10
    s_lshr_b32 s21, s17, 2
    s_lshl_b32 s21, s21, 7
    s_add_u32 s20, s20, s21
    v_bfe_u32 v208, v0, 5, 1
    v_lshlrev_b32 v210, 1, v208
    v_bfe_u32 v208, v0, 3, 1
    v_add_u32 v210, v210, v208
    v_bfe_u32 v208, v0, 4, 1
    v_lshl_add_u32 v210, v208, 3, v210
    v_lshrrev_b32 v208, 6, v0
    v_lshl_add_u32 v210, v208, 8, v210
    v_and_b32 v209, 7, v0
    v_lshlrev_b32 v211, 13, v210
    v_lshl_add_u32 v211, v209, 4, v211
    s_and_b32 s21, s28, 1
    s_lshl_b32 s21, s21, 6
    s_add_u32 s21, s21, s20
    s_lshl_b32 s21, s21, 1
    v_add_u32 v211, s21, v211
    v_add_u32 v212, 0x8000, v211
    v_bfe_u32 v208, v0, 4, 2
    v_lshlrev_b32 v210, 1, v208
    v_bfe_u32 v208, v0, 2, 1
    v_add_u32 v210, v210, v208
    v_bfe_u32 v208, v0, 3, 1
    v_lshl_add_u32 v210, v208, 3, v210
    v_lshrrev_b32 v208, 6, v0
    v_lshl_add_u32 v210, v208, 8, v210
    v_and_b32 v209, 3, v0
    v_lshlrev_b32 v213, 13, v210
    v_lshl_add_u32 v213, v209, 4, v213
    s_and_b32 s21, s17, 3
    s_lshl_b32 s21, s21, 5
    s_add_u32 s21, s21, s20
    s_lshl_b32 s21, s21, 1
    v_add_u32 v213, s21, v213
    v_bfe_u32 v214, v0, 2, 1
    v_bfe_u32 v208, v0, 4, 1
    v_lshl_add_u32 v214, v208, 1, v214
    v_bfe_u32 v208, v0, 3, 1
    v_lshl_add_u32 v214, v208, 2, v214
    v_bfe_u32 v208, v0, 5, 1
    v_lshl_add_u32 v214, v208, 4, v214
    v_lshrrev_b32 v208, 6, v0
    v_lshl_add_u32 v214, v208, 8, v214
    s_lshl_b32 s21, s16, 10
    v_add_u32 v214, s21, v214
    v_lshlrev_b32 v214, 11, v214
    v_lshl_add_u32 v214, v209, 4, v214
    s_lshl_b32 s21, s29, 6
    v_add_u32 v214, s21, v214
    s_lshl_b32 s22, s18, 15
    s_add_u32 s22, s22, 32768
    s_mov_b32 s12, s90
    s_and_b32 s13, s91, 0xffff
    s_mov_b32 s14, 0x800000
    s_mov_b32 s15, 0x00020000
    s_and_b32 s21, s17, 1
    s_mul_i32 s21, s21, 1048576
    s_xor_b32 s23, s21, 0x0
    buffer_load_dwordx4 v[32:35], v213, s[12:15], s23 offen nt
    s_xor_b32 s23, s21, 0x20000
    buffer_load_dwordx4 v[36:39], v213, s[12:15], s23 offen nt
    s_xor_b32 s23, s21, 0x40000
    buffer_load_dwordx4 v[40:43], v213, s[12:15], s23 offen nt
    s_xor_b32 s23, s21, 0x60000
    buffer_load_dwordx4 v[44:47], v213, s[12:15], s23 offen nt
    s_xor_b32 s23, s21, 0x80000
    buffer_load_dwordx4 v[48:51], v213, s[12:15], s23 offen nt
    s_xor_b32 s23, s21, 0xa0000
    buffer_load_dwordx4 v[52:55], v213, s[12:15], s23 offen nt
    s_xor_b32 s23, s21, 0xc0000
    buffer_load_dwordx4 v[56:59], v213, s[12:15], s23 offen nt
    s_xor_b32 s23, s21, 0xe0000
    buffer_load_dwordx4 v[60:63], v213, s[12:15], s23 offen nt
    s_mov_b32 s12, s92
    s_and_b32 s13, s93, 0xffff
    s_mov_b32 s14, 0x800000
    s_mov_b32 s15, 0x00020000
    s_and_b32 s21, s17, 1
    s_mul_i32 s21, s21, 262144
    s_xor_b32 s23, s21, 0x0
    buffer_load_dwordx4 v[96:99], v214, s[12:15], s23 offen nt
    s_xor_b32 s23, s21, 0x4000
    buffer_load_dwordx4 v[100:103], v214, s[12:15], s23 offen nt
    s_xor_b32 s23, s21, 0x10000
    buffer_load_dwordx4 v[104:107], v214, s[12:15], s23 offen nt
    s_xor_b32 s23, s21, 0x14000
    buffer_load_dwordx4 v[108:111], v214, s[12:15], s23 offen nt
    s_xor_b32 s23, s21, 0x20000
    buffer_load_dwordx4 v[112:115], v214, s[12:15], s23 offen nt
    s_xor_b32 s23, s21, 0x24000
    buffer_load_dwordx4 v[116:119], v214, s[12:15], s23 offen nt
    s_xor_b32 s23, s21, 0x30000
    buffer_load_dwordx4 v[120:123], v214, s[12:15], s23 offen nt
    s_xor_b32 s23, s21, 0x34000
    buffer_load_dwordx4 v[124:127], v214, s[12:15], s23 offen nt
    s_bitcmp1_b32 s28, 1
    s_cselect_b32 s12, s88, s86
    s_cselect_b32 s13, s89, s87
    s_and_b32 s13, s13, 0xffff
    s_mov_b32 s14, 0x800000
    s_mov_b32 s15, 0x00020000
    s_add_u32 m0, s22, 0
    s_mov_b32 s23, 0
    buffer_load_dwordx4 v211, s[12:15], s23 offen nt lds
    s_add_u32 m0, s22, 1024
    s_mov_b32 s23, 0
    buffer_load_dwordx4 v212, s[12:15], s23 offen nt lds
    s_add_u32 m0, s22, 2048
    s_mov_b32 s23, 131072
    buffer_load_dwordx4 v211, s[12:15], s23 offen nt lds
    s_add_u32 m0, s22, 3072
    s_mov_b32 s23, 131072
    buffer_load_dwordx4 v212, s[12:15], s23 offen nt lds
    s_add_u32 m0, s22, 4096
    s_mov_b32 s23, 262144
    buffer_load_dwordx4 v211, s[12:15], s23 offen nt lds
    s_add_u32 m0, s22, 5120
    s_mov_b32 s23, 262144
    buffer_load_dwordx4 v212, s[12:15], s23 offen nt lds
    s_add_u32 m0, s22, 6144
    s_mov_b32 s23, 393216
    buffer_load_dwordx4 v211, s[12:15], s23 offen nt lds
    s_add_u32 m0, s22, 7168
    s_mov_b32 s23, 393216
    buffer_load_dwordx4 v212, s[12:15], s23 offen nt lds
    s_add_u32 m0, s22, 8192
    s_mov_b32 s23, 524288
    buffer_load_dwordx4 v211, s[12:15], s23 offen nt lds
    s_add_u32 m0, s22, 9216
    s_mov_b32 s23, 524288
    buffer_load_dwordx4 v212, s[12:15], s23 offen nt lds
    s_add_u32 m0, s22, 10240
    s_mov_b32 s23, 655360
    buffer_load_dwordx4 v211, s[12:15], s23 offen nt lds
    s_add_u32 m0, s22, 11264
    s_mov_b32 s23, 655360
    buffer_load_dwordx4 v212, s[12:15], s23 offen nt lds
    s_add_u32 m0, s22, 12288
    s_mov_b32 s23, 786432
    buffer_load_dwordx4 v211, s[12:15], s23 offen nt lds
    s_add_u32 m0, s22, 13312
    s_mov_b32 s23, 786432
    buffer_load_dwordx4 v212, s[12:15], s23 offen nt lds
    s_add_u32 m0, s22, 14336
    s_mov_b32 s23, 917504
    buffer_load_dwordx4 v211, s[12:15], s23 offen nt lds
    s_add_u32 m0, s22, 15360
    s_mov_b32 s23, 917504
    buffer_load_dwordx4 v212, s[12:15], s23 offen nt lds
    s_add_u32 m0, s22, 16384
    s_mov_b32 s23, 1048576
    buffer_load_dwordx4 v211, s[12:15], s23 offen nt lds
    s_add_u32 m0, s22, 17408
    s_mov_b32 s23, 1048576
    buffer_load_dwordx4 v212, s[12:15], s23 offen nt lds
    s_add_u32 m0, s22, 18432
    s_mov_b32 s23, 1179648
    buffer_load_dwordx4 v211, s[12:15], s23 offen nt lds
    s_add_u32 m0, s22, 19456
    s_mov_b32 s23, 1179648
    buffer_load_dwordx4 v212, s[12:15], s23 offen nt lds
    s_add_u32 m0, s22, 20480
    s_mov_b32 s23, 1310720
    buffer_load_dwordx4 v211, s[12:15], s23 offen nt lds
    s_add_u32 m0, s22, 21504
    s_mov_b32 s23, 1310720
    buffer_load_dwordx4 v212, s[12:15], s23 offen nt lds
    s_add_u32 m0, s22, 22528
    s_mov_b32 s23, 1441792
    buffer_load_dwordx4 v211, s[12:15], s23 offen nt lds
    s_add_u32 m0, s22, 23552
    s_mov_b32 s23, 1441792
    buffer_load_dwordx4 v212, s[12:15], s23 offen nt lds
    s_add_u32 m0, s22, 24576
    s_mov_b32 s23, 1572864
    buffer_load_dwordx4 v211, s[12:15], s23 offen nt lds
    s_add_u32 m0, s22, 25600
    s_mov_b32 s23, 1572864
    buffer_load_dwordx4 v212, s[12:15], s23 offen nt lds
    s_add_u32 m0, s22, 26624
    s_mov_b32 s23, 1703936
    buffer_load_dwordx4 v211, s[12:15], s23 offen nt lds
    s_add_u32 m0, s22, 27648
    s_mov_b32 s23, 1703936
    buffer_load_dwordx4 v212, s[12:15], s23 offen nt lds
    s_add_u32 m0, s22, 28672
    s_mov_b32 s23, 1835008
    buffer_load_dwordx4 v211, s[12:15], s23 offen nt lds
    s_add_u32 m0, s22, 29696
    s_mov_b32 s23, 1835008
    buffer_load_dwordx4 v212, s[12:15], s23 offen nt lds
    s_add_u32 m0, s22, 30720
    s_mov_b32 s23, 1966080
    buffer_load_dwordx4 v211, s[12:15], s23 offen nt lds
    s_add_u32 m0, s22, 31744
    s_mov_b32 s23, 1966080
    buffer_load_dwordx4 v212, s[12:15], s23 offen nt lds
    s_waitcnt vmcnt(40)
    s_mov_b32 s12, s90
    s_and_b32 s13, s91, 0xffff
    s_mov_b32 s14, 0x800000
    s_mov_b32 s15, 0x00020000
    s_and_b32 s21, s17, 1
    s_mul_i32 s21, s21, 1048576
    s_xor_b32 s23, s21, 0x100000
    buffer_load_dwordx4 v[64:67], v213, s[12:15], s23 offen nt
    s_xor_b32 s23, s21, 0x120000
    buffer_load_dwordx4 v[68:71], v213, s[12:15], s23 offen nt
    s_xor_b32 s23, s21, 0x140000
    buffer_load_dwordx4 v[72:75], v213, s[12:15], s23 offen nt
    s_xor_b32 s23, s21, 0x160000
    buffer_load_dwordx4 v[76:79], v213, s[12:15], s23 offen nt
    s_xor_b32 s23, s21, 0x180000
    buffer_load_dwordx4 v[80:83], v213, s[12:15], s23 offen nt
    s_xor_b32 s23, s21, 0x1a0000
    buffer_load_dwordx4 v[84:87], v213, s[12:15], s23 offen nt
    s_xor_b32 s23, s21, 0x1c0000
    buffer_load_dwordx4 v[88:91], v213, s[12:15], s23 offen nt
    s_xor_b32 s23, s21, 0x1e0000
    buffer_load_dwordx4 v[92:95], v213, s[12:15], s23 offen nt
    s_mov_b32 s12, s92
    s_and_b32 s13, s93, 0xffff
    s_mov_b32 s14, 0x800000
    s_mov_b32 s15, 0x00020000
    s_and_b32 s21, s17, 1
    s_mul_i32 s21, s21, 262144
    s_xor_b32 s23, s21, 0x40000
    buffer_load_dwordx4 v[128:131], v214, s[12:15], s23 offen nt
    s_xor_b32 s23, s21, 0x44000
    buffer_load_dwordx4 v[132:135], v214, s[12:15], s23 offen nt
    s_xor_b32 s23, s21, 0x50000
    buffer_load_dwordx4 v[136:139], v214, s[12:15], s23 offen nt
    s_xor_b32 s23, s21, 0x54000
    buffer_load_dwordx4 v[140:143], v214, s[12:15], s23 offen nt
    s_xor_b32 s23, s21, 0x60000
    buffer_load_dwordx4 v[144:147], v214, s[12:15], s23 offen nt
    s_xor_b32 s23, s21, 0x64000
    buffer_load_dwordx4 v[148:151], v214, s[12:15], s23 offen nt
    s_xor_b32 s23, s21, 0x70000
    buffer_load_dwordx4 v[152:155], v214, s[12:15], s23 offen nt
    s_xor_b32 s23, s21, 0x74000
    buffer_load_dwordx4 v[156:159], v214, s[12:15], s23 offen nt
    s_barrier
    s_cmp_lg_u32 s18, 0
    s_cbranch_scc1 L_m0_3
    s_lshl_b32 s23, s16, 2
    s_add_u32 s23, s23, 160
    s_mov_b32 s21, 1
    s_atomic_add s21, s[60:61], s23
L_m0_3:
    v_bfe_u32 v208, v0, 4, 2
    v_lshlrev_b32 v208, 3, v208
    v_bfe_u32 v210, v0, 2, 2
    v_add_u32 v208, v208, v210
    v_and_b32 v209, 3, v0
    v_bfe_u32 v211, v0, 3, 1
    v_lshlrev_b32 v210, 7, v208
    v_and_b32 v212, 1, v0
    v_lshl_add_u32 v210, v212, 5, v210
    v_bfe_u32 v212, v0, 1, 1
    v_lshl_add_u32 v210, v212, 3, v210
    v_lshl_add_u32 v210, v211, 4, v210
    s_lshr_b32 s21, s18, 1
    s_xor_b32 s21, s21, 1
    s_lshl_b32 s21, s21, 6
    s_add_u32 s21, s21, s22
    v_add_u32 v215, s21, v210
    v_xor_b32 v216, 256, v215
    s_lshr_b32 s21, s18, 1
    s_xor_b32 s21, s21, 0
    s_lshl_b32 s21, s21, 6
    s_add_u32 s21, s21, s22
    v_add_u32 v217, s21, v210
    v_xor_b32 v218, 256, v217
    s_waitcnt vmcnt(16)
    ds_read_b64_tr_b16 a[0:1], v215 offset:0
    ds_read_b64_tr_b16 a[2:3], v215 offset:512
    ds_read_b64_tr_b16 a[4:5], v215 offset:4096
    ds_read_b64_tr_b16 a[6:7], v215 offset:4608
    ds_read_b64_tr_b16 a[32:33], v216 offset:0
    ds_read_b64_tr_b16 a[34:35], v216 offset:512
    ds_read_b64_tr_b16 a[36:37], v216 offset:4096
    ds_read_b64_tr_b16 a[38:39], v216 offset:4608
    s_waitcnt lgkmcnt(0)
    ds_read_b64_tr_b16 a[64:65], v217 offset:0
    ds_read_b64_tr_b16 a[66:67], v217 offset:512
    ds_read_b64_tr_b16 a[68:69], v217 offset:4096
    ds_read_b64_tr_b16 a[70:71], v217 offset:4608
    ds_read_b64_tr_b16 a[96:97], v218 offset:0
    ds_read_b64_tr_b16 a[98:99], v218 offset:512
    ds_read_b64_tr_b16 a[100:101], v218 offset:4096
    ds_read_b64_tr_b16 a[102:103], v218 offset:4608
    s_waitcnt lgkmcnt(0)
    ds_read_b64_tr_b16 a[8:9], v215 offset:8192
    ds_read_b64_tr_b16 a[10:11], v215 offset:8704
    ds_read_b64_tr_b16 a[12:13], v215 offset:12288
    ds_read_b64_tr_b16 a[14:15], v215 offset:12800
    ds_read_b64_tr_b16 a[40:41], v216 offset:8192
    ds_read_b64_tr_b16 a[42:43], v216 offset:8704
    ds_read_b64_tr_b16 a[44:45], v216 offset:12288
    ds_read_b64_tr_b16 a[46:47], v216 offset:12800
    s_waitcnt lgkmcnt(0)
    ds_read_b64_tr_b16 a[72:73], v217 offset:8192
    ds_read_b64_tr_b16 a[74:75], v217 offset:8704
    ds_read_b64_tr_b16 a[76:77], v217 offset:12288
    ds_read_b64_tr_b16 a[78:79], v217 offset:12800
    ds_read_b64_tr_b16 a[104:105], v218 offset:8192
    ds_read_b64_tr_b16 a[106:107], v218 offset:8704
    ds_read_b64_tr_b16 a[108:109], v218 offset:12288
    ds_read_b64_tr_b16 a[110:111], v218 offset:12800
    s_waitcnt lgkmcnt(0)
    ds_read_b64_tr_b16 a[16:17], v215 offset:16384
    ds_read_b64_tr_b16 a[18:19], v215 offset:16896
    ds_read_b64_tr_b16 a[20:21], v215 offset:20480
    ds_read_b64_tr_b16 a[22:23], v215 offset:20992
    ds_read_b64_tr_b16 a[48:49], v216 offset:16384
    ds_read_b64_tr_b16 a[50:51], v216 offset:16896
    ds_read_b64_tr_b16 a[52:53], v216 offset:20480
    ds_read_b64_tr_b16 a[54:55], v216 offset:20992
    s_waitcnt lgkmcnt(0)
    ds_read_b64_tr_b16 a[80:81], v217 offset:16384
    ds_read_b64_tr_b16 a[82:83], v217 offset:16896
    ds_read_b64_tr_b16 a[84:85], v217 offset:20480
    ds_read_b64_tr_b16 a[86:87], v217 offset:20992
    ds_read_b64_tr_b16 a[112:113], v218 offset:16384
    ds_read_b64_tr_b16 a[114:115], v218 offset:16896
    ds_read_b64_tr_b16 a[116:117], v218 offset:20480
    ds_read_b64_tr_b16 a[118:119], v218 offset:20992
    s_waitcnt lgkmcnt(0)
    ds_read_b64_tr_b16 a[24:25], v215 offset:24576
    ds_read_b64_tr_b16 a[26:27], v215 offset:25088
    ds_read_b64_tr_b16 a[28:29], v215 offset:28672
    ds_read_b64_tr_b16 a[30:31], v215 offset:29184
    ds_read_b64_tr_b16 a[56:57], v216 offset:24576
    ds_read_b64_tr_b16 a[58:59], v216 offset:25088
    ds_read_b64_tr_b16 a[60:61], v216 offset:28672
    ds_read_b64_tr_b16 a[62:63], v216 offset:29184
    s_waitcnt lgkmcnt(0)
    ds_read_b64_tr_b16 a[88:89], v217 offset:24576
    ds_read_b64_tr_b16 a[90:91], v217 offset:25088
    ds_read_b64_tr_b16 a[92:93], v217 offset:28672
    ds_read_b64_tr_b16 a[94:95], v217 offset:29184
    ds_read_b64_tr_b16 a[120:121], v218 offset:24576
    ds_read_b64_tr_b16 a[122:123], v218 offset:25088
    ds_read_b64_tr_b16 a[124:125], v218 offset:28672
    ds_read_b64_tr_b16 a[126:127], v218 offset:29184
    s_waitcnt lgkmcnt(0)
    s_and_b32 s21, s17, 1
    s_lshl_b32 s21, s21, 13
    s_add_u32 s21, s21, s22
    v_add_u32 v219, s21, v1
    v_xor_b32 v215, 0x2000, v219
    v_lshlrev_b32 v210, 6, v208
    v_add_u32 v210, s22, v210
    v_lshl_add_u32 v217, v209, 3, v210
    v_lshl_add_u32 v217, v211, 5, v217
    v_xor_b32 v218, 128, v217
    s_waitcnt vmcnt(8)
    ds_write_b128 v219, v[32:35] offset:0
    ds_write_b128 v219, v[36:39] offset:1024
    ds_write_b128 v219, v[40:43] offset:2048
    ds_write_b128 v219, v[44:47] offset:3072
    ds_write_b128 v219, v[48:51] offset:4096
    ds_write_b128 v219, v[52:55] offset:5120
    ds_write_b128 v219, v[56:59] offset:6144
    ds_write_b128 v219, v[60:63] offset:7168
    ds_write_b128 v215, v[64:67] offset:0
    ds_write_b128 v215, v[68:71] offset:1024
    ds_write_b128 v215, v[72:75] offset:2048
    ds_write_b128 v215, v[76:79] offset:3072
    ds_write_b128 v215, v[80:83] offset:4096
    ds_write_b128 v215, v[84:87] offset:5120
    ds_write_b128 v215, v[88:91] offset:6144
    ds_write_b128 v215, v[92:95] offset:7168
    s_waitcnt lgkmcnt(0)
    ds_read_b64_tr_b16 a[128:129], v217 offset:0
    ds_read_b64_tr_b16 a[130:131], v217 offset:256
    ds_read_b64_tr_b16 a[132:133], v217 offset:2048
    ds_read_b64_tr_b16 a[134:135], v217 offset:2304
    ds_read_b64_tr_b16 a[160:161], v218 offset:0
    ds_read_b64_tr_b16 a[162:163], v218 offset:256
    ds_read_b64_tr_b16 a[164:165], v218 offset:2048
    ds_read_b64_tr_b16 a[166:167], v218 offset:2304
    s_waitcnt lgkmcnt(0)
    ds_read_b64_tr_b16 a[136:137], v217 offset:4096
    ds_read_b64_tr_b16 a[138:139], v217 offset:4352
    ds_read_b64_tr_b16 a[140:141], v217 offset:6144
    ds_read_b64_tr_b16 a[142:143], v217 offset:6400
    ds_read_b64_tr_b16 a[168:169], v218 offset:4096
    ds_read_b64_tr_b16 a[170:171], v218 offset:4352
    ds_read_b64_tr_b16 a[172:173], v218 offset:6144
    ds_read_b64_tr_b16 a[174:175], v218 offset:6400
    s_waitcnt lgkmcnt(0)
    ds_read_b64_tr_b16 a[144:145], v217 offset:8192
    ds_read_b64_tr_b16 a[146:147], v217 offset:8448
    ds_read_b64_tr_b16 a[148:149], v217 offset:10240
    ds_read_b64_tr_b16 a[150:151], v217 offset:10496
    ds_read_b64_tr_b16 a[176:177], v218 offset:8192
    ds_read_b64_tr_b16 a[178:179], v218 offset:8448
    ds_read_b64_tr_b16 a[180:181], v218 offset:10240
    ds_read_b64_tr_b16 a[182:183], v218 offset:10496
    s_waitcnt lgkmcnt(0)
    ds_read_b64_tr_b16 a[152:153], v217 offset:12288
    ds_read_b64_tr_b16 a[154:155], v217 offset:12544
    ds_read_b64_tr_b16 a[156:157], v217 offset:14336
    ds_read_b64_tr_b16 a[158:159], v217 offset:14592
    ds_read_b64_tr_b16 a[184:185], v218 offset:12288
    ds_read_b64_tr_b16 a[186:187], v218 offset:12544
    ds_read_b64_tr_b16 a[188:189], v218 offset:14336
    ds_read_b64_tr_b16 a[190:191], v218 offset:14592
    s_waitcnt lgkmcnt(0)
    s_waitcnt vmcnt(0)
    ds_write_b128 v219, v[96:99] offset:16384
    ds_write_b128 v219, v[100:103] offset:17408
    ds_write_b128 v219, v[104:107] offset:18432
    ds_write_b128 v219, v[108:111] offset:19456
    ds_write_b128 v219, v[112:115] offset:20480
    ds_write_b128 v219, v[116:119] offset:21504
    ds_write_b128 v219, v[120:123] offset:22528
    ds_write_b128 v219, v[124:127] offset:23552
    ds_write_b128 v215, v[128:131] offset:16384
    ds_write_b128 v215, v[132:135] offset:17408
    ds_write_b128 v215, v[136:139] offset:18432
    ds_write_b128 v215, v[140:143] offset:19456
    ds_write_b128 v215, v[144:147] offset:20480
    ds_write_b128 v215, v[148:151] offset:21504
    ds_write_b128 v215, v[152:155] offset:22528
    ds_write_b128 v215, v[156:159] offset:23552
    s_waitcnt lgkmcnt(0)
    ds_read_b64_tr_b16 a[192:193], v217 offset:16384
    ds_read_b64_tr_b16 a[194:195], v217 offset:16640
    ds_read_b64_tr_b16 a[196:197], v217 offset:18432
    ds_read_b64_tr_b16 a[198:199], v217 offset:18688
    ds_read_b64_tr_b16 a[224:225], v218 offset:16384
    ds_read_b64_tr_b16 a[226:227], v218 offset:16640
    ds_read_b64_tr_b16 a[228:229], v218 offset:18432
    ds_read_b64_tr_b16 a[230:231], v218 offset:18688
    s_waitcnt lgkmcnt(0)
    ds_read_b64_tr_b16 a[200:201], v217 offset:20480
    ds_read_b64_tr_b16 a[202:203], v217 offset:20736
    ds_read_b64_tr_b16 a[204:205], v217 offset:22528
    ds_read_b64_tr_b16 a[206:207], v217 offset:22784
    ds_read_b64_tr_b16 a[232:233], v218 offset:20480
    ds_read_b64_tr_b16 a[234:235], v218 offset:20736
    ds_read_b64_tr_b16 a[236:237], v218 offset:22528
    ds_read_b64_tr_b16 a[238:239], v218 offset:22784
    s_waitcnt lgkmcnt(0)
    ds_read_b64_tr_b16 a[208:209], v217 offset:24576
    ds_read_b64_tr_b16 a[210:211], v217 offset:24832
    ds_read_b64_tr_b16 a[212:213], v217 offset:26624
    ds_read_b64_tr_b16 a[214:215], v217 offset:26880
    ds_read_b64_tr_b16 a[240:241], v218 offset:24576
    ds_read_b64_tr_b16 a[242:243], v218 offset:24832
    ds_read_b64_tr_b16 a[244:245], v218 offset:26624
    ds_read_b64_tr_b16 a[246:247], v218 offset:26880
    s_waitcnt lgkmcnt(0)
    ds_read_b64_tr_b16 a[216:217], v217 offset:28672
    ds_read_b64_tr_b16 a[218:219], v217 offset:28928
    ds_read_b64_tr_b16 a[220:221], v217 offset:30720
    ds_read_b64_tr_b16 a[222:223], v217 offset:30976
    ds_read_b64_tr_b16 a[248:249], v218 offset:28672
    ds_read_b64_tr_b16 a[250:251], v218 offset:28928
    ds_read_b64_tr_b16 a[252:253], v218 offset:30720
    ds_read_b64_tr_b16 a[254:255], v218 offset:30976
    s_waitcnt lgkmcnt(0)
    v_and_b32 v208, 15, v0
    v_lshlrev_b32 v208, 7, v208
    s_lshl_b32 s21, s17, 11
    s_add_u32 s21, s21, s42
    buffer_load_dword v209, v208, s[8:11], s21 offen sc1
    s_cmp_lg_u32 s18, 0
    s_cbranch_scc1 L_init_4
    s_lshl_b32 s21, s29, 9
    s_add_u32 s21, s21, s53
    v_min_u32 v232, 0xfffffffe, v232
    v_min_u32 v233, 0xfffffffe, v233
    buffer_store_dwordx2 v[232:233], v26, s[8:11], s21 offen
L_init_4:
    s_lshl_b32 s23, s16, 2
    s_add_u32 s23, s23, 160
    v_mov_b32 v248, s23
L_kvw_5:
    global_load_dword v249, v248, s[60:61] sc1
    s_add_u32 s33, s33, 1
    s_cmp_gt_u32 s33, 0x100000
    s_cbranch_scc1 chain_kernel_abort
    s_waitcnt vmcnt(0)
    v_readfirstlane_b32 s20, v249
    s_cmp_ge_u32 s20, 32
    s_cbranch_scc1 L_kvok_6
    s_sleep 16
    s_branch L_kvw_5
L_kvok_6:
    s_mov_b32 s19, 0
    s_mov_b32 s55, 0
    s_mov_b32 s30, 0xc0000
    s_mov_b32 s41, s53
    v_mov_b32 v197, 0
    v_mov_b32 v198, 0
    v_mov_b32 v248, 4
L_kvw_7:
    global_load_dword v249, v248, s[60:61] sc1
    s_add_u32 s33, s33, 1
    s_cmp_gt_u32 s33, 0x100000
    s_cbranch_scc1 chain_kernel_abort
    s_waitcnt vmcnt(0)
    v_readfirstlane_b32 s20, v249
    s_and_b32 s21, s20, 0xff
    s_cmp_ge_u32 s21, 15
    s_cbranch_scc1 L_kvok_8
    s_sleep 16
    s_branch L_kvw_7
L_kvok_8:
    s_cmp_ge_u32 s20, 0x800
    s_cselect_b32 s50, 0x2000, 0
    s_add_u32 s52, s50, 0x8000000
    s_add_u32 s48, s48, s50
    v_and_b32 v208, 63, v0
    v_lshlrev_b32 v208, 2, v208
    s_lshr_b32 s22, s17, 3
    s_lshl_b32 s22, s22, 14
    s_and_b32 s23, s17, 7
    s_lshl_b32 s23, s23, 10
    s_add_u32 s22, s22, s23
    s_lshl_b32 s23, s18, 8
    s_add_u32 s22, s22, s23
    s_xor_b32 s21, s16, 0
    s_lshl_b32 s21, s21, 16
    s_add_u32 s21, s21, s22
    v_add_u32 v8, s21, v208
    s_xor_b32 s21, s16, 1
    s_lshl_b32 s21, s21, 16
    s_add_u32 s21, s21, s22
    v_add_u32 v9, s21, v208
    s_xor_b32 s21, s16, 2
    s_lshl_b32 s21, s21, 16
    s_add_u32 s21, s21, s22
    v_add_u32 v10, s21, v208
    s_xor_b32 s21, s16, 3
    s_lshl_b32 s21, s21, 16
    s_add_u32 s21, s21, s22
    v_add_u32 v11, s21, v208
    s_barrier
    v_and_b32 v208, 15, v0
    v_bfe_u32 v209, v0, 6, 1
    v_lshl_add_u32 v208, v209, 4, v208
    v_bfe_u32 v209, v0, 4, 2
    v_lshlrev_b32 v209, 2, v209
    v_sub_u32 v208, v208, v209
    v_mov_b32 v209, 0xff800000
    v_cmp_gt_i32 vcc, 0, v208
    s_nop 1
    v_cndmask_b32 v96, 0, v209, vcc
    v_cmp_gt_i32 vcc, 1, v208
    s_nop 1
    v_cndmask_b32 v97, 0, v209, vcc
    v_cmp_gt_i32 vcc, 2, v208
    s_nop 1
    v_cndmask_b32 v98, 0, v209, vcc
    v_cmp_gt_i32 vcc, 3, v208
    s_nop 1
    v_cndmask_b32 v99, 0, v209, vcc
    v_cmp_gt_i32 vcc, 16, v208
    s_nop 1
    v_cndmask_b32 v100, 0, v209, vcc
    v_cmp_gt_i32 vcc, 17, v208
    s_nop 1
    v_cndmask_b32 v101, 0, v209, vcc
    v_cmp_gt_i32 vcc, 18, v208
    s_nop 1
    v_cndmask_b32 v102, 0, v209, vcc
    v_cmp_gt_i32 vcc, 19, v208
    s_nop 1
    v_cndmask_b32 v103, 0, v209, vcc
    s_add_u32 s21, s19, 0
    s_min_u32 s21, s21, 63
    s_lshl_b32 s31, s21, 21
    s_lshl_b32 s21, s21, 13
    s_and_b32 s21, s21, 0x2000
    s_xor_b32 s21, s21, s48
    s_add_u32 s31, s31, s21
    s_cmp_lg_u32 s18, 1
    s_cbranch_scc1 L_init0_9
    v_mov_b32 v248, 0
    s_lshl2_add_u32 s20, s17, s18
    s_cmp_lg_u32 s20, 5
    s_cbranch_scc1 L_rlo_11
L_rl_10:
    s_load_dword s20, s[60:61], 64 glc
    s_add_u32 s33, s33, 1
    s_cmp_gt_u32 s33, 0x100000
    s_cbranch_scc1 chain_kernel_abort
    s_waitcnt lgkmcnt(0)
    s_cmp_lt_u32 s20, 96
    s_cbranch_scc1 L_rl_10
    v_mov_b32 v249, 1
    buffer_store_dword v249, v248, s[8:11], s62 offen
    s_branch L_rlok_12
L_rlo_11:
    buffer_load_dword v249, v248, s[8:11], s62 offen sc1
    s_add_u32 s33, s33, 1
    s_cmp_gt_u32 s33, 0x100000
    s_cbranch_scc1 chain_kernel_abort
    s_waitcnt vmcnt(0)
    v_readfirstlane_b32 s20, v249
    s_cmp_ge_u32 s20, 1
    s_cbranch_scc1 L_rlok_12
    s_sleep 1
    s_branch L_rlo_11
L_rlok_12:
    s_mov_b32 m0, 40960
    s_nop 0
    buffer_load_dwordx4 v237, s[8:11], s31 offen offset:0 lds
    buffer_load_dwordx4 v237, s[8:11], s31 offen offset:1024 lds
L_init0_9:
    s_barrier
    s_mov_b32 m0, s54
    s_nop 0
    buffer_load_dwordx4 v235, s[8:11], s31 offen offset:0 lds
    buffer_load_dwordx4 v235, s[8:11], s31 offen offset:1024 lds
    buffer_load_dwordx4 v235, s[8:11], s31 offen offset:2048 lds
    buffer_load_dwordx4 v235, s[8:11], s31 offen offset:3072 lds
    s_waitcnt vmcnt(0) lgkmcnt(0)
    s_barrier
chain_kernel_loop:
    s_mov_b32 s40, s41
    s_add_u32 s30, s30, 0x40000
    s_and_b32 s30, s30, 0xc0000
    s_xor_b32 s20, s30, 0x80000
    s_add_u32 s42, s53, s20
    s_lshl_b32 s43, s19, 19
    s_lshl_b32 s20, s19, 11
    s_and_b32 s20, s20, 0x2000
    s_xor_b32 s20, s20, s52
    s_add_u32 s43, s43, s20
    s_add_u32 s44, s43, 0x40000
    s_add_u32 s20, s30, 0x40000
    s_and_b32 s20, s20, 0xc0000
    s_add_u32 s41, s53, s20
    v_mov_b32 v64, 0
    v_mov_b32 v65, 0
    v_mov_b32 v66, 0
    v_mov_b32 v67, 0
    v_mov_b32 v68, 0
    v_mov_b32 v69, 0
    v_mov_b32 v70, 0
    v_mov_b32 v71, 0
    v_mov_b32 v72, 0
    v_mov_b32 v73, 0
    v_mov_b32 v74, 0
    v_mov_b32 v75, 0
    v_mov_b32 v76, 0
    v_mov_b32 v77, 0
    v_mov_b32 v78, 0
    v_mov_b32 v79, 0
    v_cvt_pk_bf16_f32 v200, v200, v201
    v_cvt_pk_bf16_f32 v201, v202, v203
    v_cvt_pk_bf16_f32 v202, v204, v205
    v_cvt_pk_bf16_f32 v203, v206, v207
    s_add_u32 s21, s19, -1
    s_lshl_b32 s32, s21, 21
    s_lshl_b32 s21, s21, 13
    s_and_b32 s21, s21, 0x2000
    s_xor_b32 s21, s21, s48
    s_add_u32 s32, s32, s21
    s_or_b32 s32, s32, s38
    s_nop 2
    buffer_load_dwordx4 v[32:35], v2, s[8:11], s40 offen offset:0 sc1
    s_nop 13
    buffer_load_dwordx4 v[36:39], v2, s[8:11], s40 offen offset:1024 sc1
    s_nop 13
    buffer_load_dwordx4 v[40:43], v2, s[8:11], s40 offen offset:2048 sc1
    s_nop 13
    buffer_load_dwordx4 v[44:47], v2, s[8:11], s40 offen offset:3072 sc1
Gq_15_s0123:
    s_waitcnt vmcnt(3)
    v_cmp_eq_u32 vcc, -1, v32
    v_mov_b32_dpp v48, v32 row_ror:8 row_mask:0xf bank_mask:0xf
    v_mov_b32_dpp v49, v33 row_ror:8 row_mask:0xf bank_mask:0xf
    v_mov_b32_dpp v50, v34 row_ror:8 row_mask:0xf bank_mask:0xf
    v_mov_b32_dpp v51, v35 row_ror:8 row_mask:0xf bank_mask:0xf
    s_cbranch_vccnz Gq_15_f0123
    v_smfmac_f32_16x16x64_bf16 v[64:67], v[32:35], a[0:7], v19
    v_smfmac_f32_16x16x64_bf16 v[68:71], v[32:35], a[64:71], v19
Gq_15_s123p0:
    s_waitcnt vmcnt(2)
    v_cmp_eq_u32 vcc, -1, v36
    v_smfmac_f32_16x16x64_bf16 v[64:67], v[48:51], a[32:39], v19
    v_mov_b32_dpp v52, v36 row_ror:8 row_mask:0xf bank_mask:0xf
    v_mov_b32_dpp v53, v37 row_ror:8 row_mask:0xf bank_mask:0xf
    v_smfmac_f32_16x16x64_bf16 v[68:71], v[48:51], a[96:103], v19
    v_mov_b32_dpp v54, v38 row_ror:8 row_mask:0xf bank_mask:0xf
    v_mov_b32_dpp v55, v39 row_ror:8 row_mask:0xf bank_mask:0xf
    s_cbranch_vccnz Gq_15_f123p0
    v_smfmac_f32_16x16x64_bf16 v[64:67], v[36:39], a[8:15], v19
    v_smfmac_f32_16x16x64_bf16 v[68:71], v[36:39], a[72:79], v19
Gq_15_s23p1:
    s_waitcnt vmcnt(1)
    v_cmp_eq_u32 vcc, -1, v40
    v_smfmac_f32_16x16x64_bf16 v[64:67], v[52:55], a[40:47], v19
    v_mov_b32_dpp v56, v40 row_ror:8 row_mask:0xf bank_mask:0xf
    v_mov_b32_dpp v57, v41 row_ror:8 row_mask:0xf bank_mask:0xf
    v_smfmac_f32_16x16x64_bf16 v[68:71], v[52:55], a[104:111], v19
    v_mov_b32_dpp v58, v42 row_ror:8 row_mask:0xf bank_mask:0xf
    v_mov_b32_dpp v59, v43 row_ror:8 row_mask:0xf bank_mask:0xf
    s_cbranch_vccnz Gq_15_f23p1
    v_smfmac_f32_16x16x64_bf16 v[64:67], v[40:43], a[16:23], v19
    v_smfmac_f32_16x16x64_bf16 v[68:71], v[40:43], a[80:87], v19
Gq_15_s3p2:
    s_waitcnt vmcnt(0)
    v_cmp_eq_u32 vcc, -1, v44
    v_smfmac_f32_16x16x64_bf16 v[64:67], v[56:59], a[48:55], v19
    v_mov_b32_dpp v60, v44 row_ror:8 row_mask:0xf bank_mask:0xf
    v_mov_b32_dpp v61, v45 row_ror:8 row_mask:0xf bank_mask:0xf
    v_smfmac_f32_16x16x64_bf16 v[68:71], v[56:59], a[112:119], v19
    v_mov_b32_dpp v62, v46 row_ror:8 row_mask:0xf bank_mask:0xf
    v_mov_b32_dpp v63, v47 row_ror:8 row_mask:0xf bank_mask:0xf
    s_cbranch_vccnz Gq_15_f3p2
    v_smfmac_f32_16x16x64_bf16 v[64:67], v[44:47], a[24:31], v19
    v_smfmac_f32_16x16x64_bf16 v[68:71], v[44:47], a[88:95], v19
    v_smfmac_f32_16x16x64_bf16 v[64:67], v[60:63], a[56:63], v19
    v_smfmac_f32_16x16x64_bf16 v[68:71], v[60:63], a[120:127], v19
Gq_15_done:
    v_max3_u32 v20, v33, v34, v35
    v_max3_u32 v208, v37, v38, v39
    v_max3_u32 v209, v41, v42, v43
    v_max3_u32 v210, v45, v46, v47
    ds_write_b64 v12, v[64:65] offset:0
    ds_write_b64 v13, v[66:67] offset:0
    v_max_u32 v20, v20, v208
    v_max3_u32 v20, v20, v209, v210
    ds_write_b64 v14, v[68:69] offset:0
    v_cmp_eq_u32 vcc, -1, v20
    v_smfmac_f32_16x16x64_bf16 v[72:75], v[32:35], a[128:135], v19
    v_smfmac_f32_16x16x64_bf16 v[72:75], v[48:51], a[160:167], v19
    s_cbranch_vccnz Gq_15_redo
    s_waitcnt lgkmcnt(0)
    s_barrier
    ds_read_b64 v[80:81], v15 offset:0
    ds_read_b64 v[82:83], v15 offset:512
    ds_read_b64 v[84:85], v15 offset:1024
    buffer_store_dwordx4 v[200:203], v23, s[8:11], s32 offen sc1
    v_smfmac_f32_16x16x64_bf16 v[72:75], v[36:39], a[136:143], v19
    v_smfmac_f32_16x16x64_bf16 v[72:75], v[52:55], a[168:175], v19
    s_waitcnt lgkmcnt(2)
    v_pk_add_f32 v[70:71], v[70:71], v[80:81]
    s_waitcnt lgkmcnt(0)
    v_pk_add_f32 v[82:83], v[82:83], v[84:85]
    v_pk_add_f32 v[70:71], v[70:71], v[82:83]
    v_cvt_pk_bf16_f32 v70, v70, v71
    s_cmp_lg_u32 s18, 0
    s_nop 0
    v_mov_b32_dpp v71, v70 quad_perm:[1,0,3,2] row_mask:0xf bank_mask:0xf
    v_perm_b32 v70, v71, v70, v18
    v_min_u32 v70, 0xfffffffe, v70
    buffer_store_dword v70, v4, s[8:11], s40 offen
    v_smfmac_f32_16x16x64_bf16 v[72:75], v[40:43], a[144:151], v19
    v_smfmac_f32_16x16x64_bf16 v[72:75], v[56:59], a[176:183], v19
    v_smfmac_f32_16x16x64_bf16 v[72:75], v[44:47], a[152:159], v19
    v_smfmac_f32_16x16x64_bf16 v[72:75], v[60:63], a[184:191], v19
    s_nop 7
    ds_write_b128 v16, v[72:75] offset:12288
    s_cbranch_scc1 L_help_13
    s_nop 15
    s_nop 3
    buffer_load_dwordx4 v[148:151], v5, s[8:11], s40 offen offset:0 sc1
    buffer_load_dwordx4 v[152:155], v5, s[8:11], s40 offen offset:1024 sc1
    buffer_load_dwordx4 v[156:159], v5, s[8:11], s40 offen offset:2048 sc1
    buffer_load_dwordx4 v[160:163], v5, s[8:11], s40 offen offset:3072 sc1
    s_waitcnt lgkmcnt(0)
    s_barrier
    ds_read_b128 v[104:107], v1 offset:32768
    ds_read_b128 v[108:111], v1 offset:33792
    ds_read_b128 v[112:115], v1 offset:34816
    ds_read_b128 v[116:119], v1 offset:35840
    ds_read_b128 v[120:123], v1 offset:36864
    ds_read_b128 v[124:127], v1 offset:37888
    ds_read_b128 v[128:131], v1 offset:38912
    ds_read_b128 v[132:135], v1 offset:39936
    ds_read_b128 v[136:139], v1 offset:40960
    ds_read_b128 v[140:143], v1 offset:41984
    buffer_load_dwordx4 v[164:167], v5, s[8:11], s40 offen offset:0 sc1
    buffer_load_dwordx4 v[168:171], v5, s[8:11], s40 offen offset:1024 sc1
    buffer_load_dwordx4 v[172:175], v5, s[8:11], s40 offen offset:2048 sc1
    buffer_load_dwordx4 v[176:179], v5, s[8:11], s40 offen offset:3072 sc1
    s_nop 13
    buffer_load_dwordx4 v[32:35], v5, s[8:11], s40 offen offset:0 sc1
    buffer_load_dwordx4 v[36:39], v5, s[8:11], s40 offen offset:1024 sc1
    buffer_load_dwordx4 v[40:43], v5, s[8:11], s40 offen offset:2048 sc1
    buffer_load_dwordx4 v[44:47], v5, s[8:11], s40 offen offset:3072 sc1
    s_waitcnt lgkmcnt(0)
L_sd_16_0_0:
    s_waitcnt vmcnt(11)
    v_max3_u32 v20, v148, v149, v150
    v_mfma_f32_16x16x32_bf16 v[88:91], v[148:151], v[148:151], 0
    v_max_u32 v20, v20, v151
    v_cmp_eq_u32 vcc, -1, v20
    v_mfma_f32_16x16x32_bf16 v[84:87], v[120:123], v[148:151], 0
    v_mfma_f32_16x16x32_bf16 v[80:83], v[104:107], v[148:151], 0
    s_cbranch_vccnz L_sd_16_1_0
L_sd_16_0_1:
    s_waitcnt vmcnt(10)
    v_max3_u32 v20, v152, v153, v154
    v_mfma_f32_16x16x32_bf16 v[100:103], v[152:155], v[152:155], v[88:91]
    v_max_u32 v20, v20, v155
    v_cmp_eq_u32 vcc, -1, v20
    v_mfma_f32_16x16x32_bf16 v[96:99], v[124:127], v[152:155], v[84:87]
    v_mfma_f32_16x16x32_bf16 v[92:95], v[108:111], v[152:155], v[80:83]
    s_cbranch_vccnz L_sd_16_1_1
L_sd_16_0_2:
    s_waitcnt vmcnt(9)
    v_max3_u32 v20, v156, v157, v158
    v_mfma_f32_16x16x32_bf16 v[228:231], v[156:159], v[156:159], v[100:103]
    v_max_u32 v20, v20, v159
    v_cmp_eq_u32 vcc, -1, v20
    v_mfma_f32_16x16x32_bf16 v[224:227], v[128:131], v[156:159], v[96:99]
    v_mfma_f32_16x16x32_bf16 v[220:223], v[112:115], v[156:159], v[92:95]
    s_cbranch_vccnz L_sd_16_1_2
L_sd_16_0_3:
    s_waitcnt vmcnt(8)
    v_max3_u32 v20, v160, v161, v162
    v_mfma_f32_16x16x32_bf16 v[188:191], v[160:163], v[160:163], v[228:231]
    v_max_u32 v20, v20, v163
    v_cmp_eq_u32 vcc, -1, v20
    v_mfma_f32_16x16x32_bf16 v[184:187], v[132:135], v[160:163], v[224:227]
    v_mfma_f32_16x16x32_bf16 v[180:183], v[116:119], v[160:163], v[220:223]
    v_mov_b32_dpp v188, v189 row_ror:8 row_mask:0xf bank_mask:0xc
    v_mov_b32_dpp v190, v191 row_ror:8 row_mask:0xf bank_mask:0xc
    s_cbranch_vccnz L_sd_16_1_3
L_sd_16:
    s_barrier
    v_permlane32_swap_b32 v188, v190
    ds_read_b64 v[144:145], v26 offset:28672
    s_cmp_eq_u32 s19, 63
    s_cbranch_scc1 chain_kernel_fin
    v_mov_b32_dpp v180, v184 row_ror:8 row_mask:0xf bank_mask:0xc
    v_mov_b32_dpp v181, v185 row_ror:8 row_mask:0xf bank_mask:0xc
    v_mov_b32_dpp v182, v186 row_ror:8 row_mask:0xf bank_mask:0xc
    v_mov_b32_dpp v183, v187 row_ror:8 row_mask:0xf bank_mask:0xc
    v_max3_f32 v208, v190, v180, v181
    v_max3_f32 v208, v208, v182, v183
    v_cvt_pk_bf16_f32 v180, 0, v180
    v_cvt_pk_bf16_f32 v181, 0, v181
    v_max_f32_dpp v208, v208, v208 row_ror:8 row_mask:0xf bank_mask:0xf
    v_mov_b32 v209, v208
    v_cvt_pk_bf16_f32 v182, 0, v182
    v_cvt_pk_bf16_f32 v183, 0, v183
    v_permlane16_swap_b32 v208, v209
    v_cvt_pk_bf16_f32 v190, 0, v190
    v_max_f32 v208, v208, v209
    v_mov_b32 v209, v208
    v_pk_mul_f32 v[180:181], v[180:181], s[58:59]
    v_pk_mul_f32 v[182:183], v[182:183], s[58:59]
    v_permlane32_swap_b32 v208, v209
    v_mul_f32 v190, s58, v190
    v_max_f32 v208, v208, v209
    v_cvt_pk_bf16_f32 v180, 0, v180
    v_cvt_pk_bf16_f32 v208, 0, v208
    v_cvt_pk_bf16_f32 v181, 0, v181
    v_mul_f32 v208, s58, v208
    v_cvt_pk_bf16_f32 v182, 0, v182
    v_cvt_pk_bf16_f32 v208, 0, v208
    v_cvt_pk_bf16_f32 v183, 0, v183
    v_mul_f32 v208, s56, v208
    v_cvt_pk_bf16_f32 v190, 0, v190
    v_pk_fma_f32 v[180:181], v[180:181], s[56:57], v[208:209] op_sel_hi:[1,1,0] neg_lo:[0,0,1] neg_hi:[0,0,1]
    v_pk_fma_f32 v[182:183], v[182:183], s[56:57], v[208:209] op_sel_hi:[1,1,0] neg_lo:[0,0,1] neg_hi:[0,0,1]
    v_fma_f32 v190, v190, s56, -v208
    v_exp_f32 v180, v180
    v_exp_f32 v181, v181
    v_exp_f32 v182, v182
    v_exp_f32 v183, v183
    v_exp_f32 v190, v190
    v_cvt_pk_bf16_f32 v192, v180, v181
    v_cvt_pk_bf16_f32 v193, v182, v183
    v_mov_b32_dpp v209, v190 row_ror:8 row_mask:0xf bank_mask:0xf
    v_mov_b32_dpp v194, v192 row_ror:8 row_mask:0xf bank_mask:0xf
    v_mov_b32_dpp v195, v193 row_ror:8 row_mask:0xf bank_mask:0xf
    v_cvt_pk_bf16_f32 v196, v190, v209
    v_pk_add_f32 v[210:211], v[180:181], v[182:183]
    v_mfma_f32_16x16x32_bf16 v[200:203], v[136:139], v[192:195], 0
    v_add_f32 v210, v210, v190
    v_add_f32 v210, v210, v211
    v_mfma_f32_16x16x32_bf16 v[204:207], v[140:143], v[192:195], 0
    v_cvt_pk_bf16_f32 v199, v190, v209
    s_waitcnt lgkmcnt(0)
    v_add_f32_dpp v210, v210, v210 row_ror:8 row_mask:0xf bank_mask:0xf
    v_mfma_f32_16x16x16_bf16 v[200:203], v[144:145], v[196:197], v[200:203]
    v_mov_b32 v209, v210
    s_nop 0
    v_mfma_f32_16x16x16_bf16 v[204:207], v[144:145], v[198:199], v[204:207]
    v_permlane16_swap_b32 v210, v209
    v_add_f32 v210, v210, v209
    v_mov_b32 v209, v210
    s_nop 1
    v_permlane32_swap_b32 v210, v209
    v_add_f32 v210, v210, v209
    v_rcp_f32 v210, v210
    s_mov_b64 exec, s[24:25]
    v_pk_mul_f32 v[200:201], v[200:201], v[210:211] op_sel_hi:[1,0]
    v_pk_mul_f32 v[202:203], v[202:203], v[210:211] op_sel_hi:[1,0]
    v_pk_mul_f32 v[204:205], v[204:205], v[210:211] op_sel_hi:[1,0]
    v_pk_mul_f32 v[206:207], v[206:207], v[210:211] op_sel_hi:[1,0]
    v_cvt_pk_bf16_f32 v200, v200, v201
    v_cvt_pk_bf16_f32 v201, v202, v203
    v_cvt_pk_bf16_f32 v202, v204, v205
    v_cvt_pk_bf16_f32 v203, v206, v207
    v_min_u32 v200, 0xfffffffe, v200
    v_min_u32 v201, 0xfffffffe, v201
    v_min_u32 v202, 0xfffffffe, v202
    v_min_u32 v203, 0xfffffffe, v203
    buffer_store_dwordx4 v[200:203], v6, s[8:11], s40 offen
    s_mov_b64 exec, -1
L_b4_14:
    s_barrier
    s_add_u32 s21, s19, 1
    s_min_u32 s21, s21, 63
    s_lshl_b32 s31, s21, 21
    s_lshl_b32 s21, s21, 13
    s_and_b32 s21, s21, 0x2000
    s_xor_b32 s21, s21, s48
    s_add_u32 s31, s31, s21
    s_add_u32 s19, s19, 1
    s_nop 15
    s_nop 11
    buffer_load_dwordx4 v[32:35], v3, s[8:11], s40 offen offset:0 sc1
    s_nop 13
    buffer_load_dwordx4 v[36:39], v3, s[8:11], s40 offen offset:1024 sc1
    s_nop 13
    buffer_load_dwordx4 v[40:43], v3, s[8:11], s40 offen offset:2048 sc1
    s_nop 13
    buffer_load_dwordx4 v[44:47], v3, s[8:11], s40 offen offset:3072 sc1
Go_17_s0123:
    s_waitcnt vmcnt(3)
    v_cmp_eq_u32 vcc, -1, v32
    v_mov_b32_dpp v48, v32 row_ror:8 row_mask:0xf bank_mask:0xf
    v_mov_b32_dpp v49, v33 row_ror:8 row_mask:0xf bank_mask:0xf
    v_mov_b32_dpp v50, v34 row_ror:8 row_mask:0xf bank_mask:0xf
    v_mov_b32_dpp v51, v35 row_ror:8 row_mask:0xf bank_mask:0xf
    s_cbranch_vccnz Go_17_f0123
    v_smfmac_f32_16x16x64_bf16 v[76:79], v[32:35], a[192:199], v19
    v_smfmac_f32_16x16x64_bf16 v[76:79], v[48:51], a[224:231], v19
Go_17_s123:
    s_waitcnt vmcnt(2)
    v_cmp_eq_u32 vcc, -1, v36
    v_mov_b32_dpp v52, v36 row_ror:8 row_mask:0xf bank_mask:0xf
    v_mov_b32_dpp v53, v37 row_ror:8 row_mask:0xf bank_mask:0xf
    v_mov_b32_dpp v54, v38 row_ror:8 row_mask:0xf bank_mask:0xf
    v_mov_b32_dpp v55, v39 row_ror:8 row_mask:0xf bank_mask:0xf
    s_cbranch_vccnz Go_17_f123
    v_smfmac_f32_16x16x64_bf16 v[76:79], v[36:39], a[200:207], v19
    v_smfmac_f32_16x16x64_bf16 v[76:79], v[52:55], a[232:239], v19
Go_17_s23:
    s_waitcnt vmcnt(1)
    v_cmp_eq_u32 vcc, -1, v40
    v_mov_b32_dpp v56, v40 row_ror:8 row_mask:0xf bank_mask:0xf
    v_mov_b32_dpp v57, v41 row_ror:8 row_mask:0xf bank_mask:0xf
    v_mov_b32_dpp v58, v42 row_ror:8 row_mask:0xf bank_mask:0xf
    v_mov_b32_dpp v59, v43 row_ror:8 row_mask:0xf bank_mask:0xf
    s_cbranch_vccnz Go_17_f23
    v_smfmac_f32_16x16x64_bf16 v[76:79], v[40:43], a[208:215], v19
    v_smfmac_f32_16x16x64_bf16 v[76:79], v[56:59], a[240:247], v19
Go_17_s3:
    s_waitcnt vmcnt(0)
    v_cmp_eq_u32 vcc, -1, v44
    v_mov_b32_dpp v60, v44 row_ror:8 row_mask:0xf bank_mask:0xf
    v_mov_b32_dpp v61, v45 row_ror:8 row_mask:0xf bank_mask:0xf
    v_mov_b32_dpp v62, v46 row_ror:8 row_mask:0xf bank_mask:0xf
    v_mov_b32_dpp v63, v47 row_ror:8 row_mask:0xf bank_mask:0xf
    s_cbranch_vccnz Go_17_f3
    v_smfmac_f32_16x16x64_bf16 v[76:79], v[44:47], a[216:223], v19
    v_smfmac_f32_16x16x64_bf16 v[76:79], v[60:63], a[248:255], v19
Go_17_done:
    v_max3_u32 v20, v33, v34, v35
    v_max3_u32 v208, v37, v38, v39
    v_max3_u32 v209, v41, v42, v43
    v_max3_u32 v210, v45, v46, v47
    v_max_u32 v20, v20, v208
    v_max3_u32 v20, v20, v209, v210
    v_cmp_eq_u32 vcc, -1, v20
    s_nop 0
    ds_write_b32 v238, v76 offset:20480
    ds_write_b32 v239, v77 offset:20480
    ds_write_b32 v240, v78 offset:20480
    s_cbranch_vccnz Go_17_redo
    s_waitcnt lgkmcnt(0)
    s_barrier
    ds_read_b32 v80, v17 offset:20480
    ds_read_b32 v81, v17 offset:20736
    ds_read_b32 v82, v17 offset:20992
    s_waitcnt lgkmcnt(2)
    v_add_f32 v80, v80, v79
    s_waitcnt lgkmcnt(0)
    v_add_f32 v81, v81, v82
    v_add_f32 v80, v80, v81
    v_min_u32 v80, 0xfffffffe, v80
    buffer_store_dword v80, v8, s[8:11], s43 offen sc1
    buffer_store_dword v80, v8, s[8:11], s44 offen sc1
    ds_read_b128 v[164:167], v241 offset:51200
    ds_read_b128 v[168:171], v241 offset:51712
    ds_read_b128 v[172:175], v241 offset:52224
    ds_read_b128 v[176:179], v241 offset:52736
    s_waitcnt lgkmcnt(3)
    v_mfma_f32_16x16x32_bf16 v[188:191], v[164:167], v[148:151], 0
    s_waitcnt lgkmcnt(2)
    v_mfma_f32_16x16x32_bf16 v[188:191], v[168:171], v[152:155], v[188:191]
    s_waitcnt lgkmcnt(1)
    v_mfma_f32_16x16x32_bf16 v[188:191], v[172:175], v[156:159], v[188:191]
    s_waitcnt lgkmcnt(0)
    v_mfma_f32_16x16x32_bf16 v[188:191], v[176:179], v[160:163], v[188:191]
    s_nop 7
    v_cvt_pk_bf16_f32 v188, 0, v188
    v_cvt_pk_bf16_f32 v189, 0, v189
    v_pk_mul_f32 v[188:189], v[188:189], s[58:59]
    v_cvt_pk_bf16_f32 v188, 0, v188
    v_cvt_pk_bf16_f32 v189, 0, v189
    v_max3_f32 v212, v212, v188, v189
    v_mov_b32 v213, v212
    s_nop 1
    v_permlane16_swap_b32 v212, v213
    buffer_load_dword v220, v9, s[8:11], s43 offen sc1
    buffer_load_dword v221, v10, s[8:11], s43 offen sc1
    buffer_load_dword v222, v11, s[8:11], s43 offen sc1
    v_max_f32 v212, v212, v213
    v_mov_b32 v213, v212
    s_nop 1
    v_permlane32_swap_b32 v212, v213
    v_max_f32 v212, v212, v213
    v_mul_f32 v212, s56, v212
    v_pk_fma_f32 v[180:181], v[180:181], s[56:57], v[212:213] op_sel_hi:[1,1,0] neg_lo:[0,0,1] neg_hi:[0,0,1]
    v_pk_fma_f32 v[182:183], v[182:183], s[56:57], v[212:213] op_sel_hi:[1,1,0] neg_lo:[0,0,1] neg_hi:[0,0,1]
    v_pk_fma_f32 v[184:185], v[184:185], s[56:57], v[212:213] op_sel_hi:[1,1,0] neg_lo:[0,0,1] neg_hi:[0,0,1]
    v_pk_fma_f32 v[186:187], v[186:187], s[56:57], v[212:213] op_sel_hi:[1,1,0] neg_lo:[0,0,1] neg_hi:[0,0,1]
    v_pk_fma_f32 v[188:189], v[188:189], s[56:57], v[212:213] op_sel_hi:[1,1,0] neg_lo:[0,0,1] neg_hi:[0,0,1]
    v_exp_f32 v180, v180
    v_exp_f32 v181, v181
    v_exp_f32 v182, v182
    v_exp_f32 v183, v183
    v_exp_f32 v184, v184
    v_exp_f32 v185, v185
    v_exp_f32 v186, v186
    buffer_load_dword v223, v9, s[8:11], s44 offen sc1
    buffer_load_dword v224, v10, s[8:11], s44 offen sc1
    buffer_load_dword v225, v11, s[8:11], s44 offen sc1
    s_mov_b32 m0, s54
    v_exp_f32 v187, v187
    v_exp_f32 v188, v188
    v_exp_f32 v189, v189
    v_pk_add_f32 v[214:215], v[180:181], v[182:183]
    v_pk_add_f32 v[216:217], v[184:185], v[186:187]
    v_pk_add_f32 v[214:215], v[214:215], v[188:189]
    buffer_load_dwordx4 v235, s[8:11], s31 offen offset:0 lds
    v_pk_add_f32 v[214:215], v[214:215], v[216:217]
    v_add_f32 v214, v214, v215
    v_mov_b32 v213, v214
    s_nop 1
    v_permlane16_swap_b32 v214, v213
    v_add_f32 v214, v214, v213
    buffer_load_dwordx4 v235, s[8:11], s31 offen offset:1024 lds
    v_mov_b32 v213, v214
    s_nop 1
    v_permlane32_swap_b32 v214, v213
    v_add_f32 v214, v214, v213
    v_rcp_f32 v214, v214
    s_nop 0
    buffer_load_dwordx4 v235, s[8:11], s31 offen offset:2048 lds
    v_pk_mul_f32 v[180:181], v[180:181], v[214:215] op_sel_hi:[1,0]
    v_pk_mul_f32 v[182:183], v[182:183], v[214:215] op_sel_hi:[1,0]
    v_pk_mul_f32 v[184:185], v[184:185], v[214:215] op_sel_hi:[1,0]
    v_pk_mul_f32 v[186:187], v[186:187], v[214:215] op_sel_hi:[1,0]
    v_pk_mul_f32 v[188:189], v[188:189], v[214:215] op_sel_hi:[1,0]
    v_cvt_pk_bf16_f32 v192, v180, v181
    buffer_load_dwordx4 v235, s[8:11], s31 offen offset:3072 lds
    v_cvt_pk_bf16_f32 v193, v182, v183
    v_cvt_pk_bf16_f32 v194, v184, v185
    v_cvt_pk_bf16_f32 v195, v186, v187
    v_cvt_pk_bf16_f32 v196, v188, v189
    v_cvt_pk_bf16_f32 v199, v188, v189
    v_mfma_f32_16x16x32_bf16 v[200:203], v[136:139], v[192:195], 0
    v_mfma_f32_16x16x32_bf16 v[204:207], v[140:143], v[192:195], 0
    v_mfma_f32_16x16x16_bf16 v[200:203], v[144:145], v[196:197], v[200:203]
    v_mfma_f32_16x16x16_bf16 v[204:207], v[144:145], v[198:199], v[204:207]
    s_waitcnt vmcnt(9)
    v_add_f32 v208, v80, v220
    s_waitcnt vmcnt(7)
    v_add_f32 v209, v221, v222
    v_max3_u32 v20, v220, v221, v222
    v_add_f32 v208, v208, v209
    v_cmp_eq_u32 vcc, -1, v20
    s_nop 0
    v_mov_b32_dpp v209, v208 quad_perm:[1,0,3,2] row_mask:0xf bank_mask:0xf
    s_mov_b64 exec, s[26:27]
    v_cvt_pk_bf16_f32 v208, v208, v209
    v_min_u32 v208, 0xfffffffe, v208
    s_cbranch_vccnz L_pf_22
L_pd_21:
    buffer_store_dword v208, v7, s[8:11], s41 offen
    s_mov_b64 exec, -1
    s_branch chain_kernel_loop
L_help_13:
    s_waitcnt lgkmcnt(0)
    s_barrier
    s_cmp_ge_u32 s18, 2
    s_cbranch_scc1 L_w2_26
    ds_read_b128 v[80:83], v1 offset:12288
    ds_read_b128 v[84:87], v1 offset:14336
    ds_read_b128 v[88:91], v1 offset:15360
    s_waitcnt lgkmcnt(2)
    v_pk_add_f32 v[72:73], v[72:73], v[82:83]
    v_pk_add_f32 v[74:75], v[74:75], v[80:81]
    s_waitcnt lgkmcnt(1)
    v_pk_add_f32 v[72:73], v[72:73], v[86:87]
    v_pk_add_f32 v[74:75], v[74:75], v[84:85]
    s_waitcnt lgkmcnt(0)
    v_pk_add_f32 v[72:73], v[72:73], v[88:89]
    v_pk_add_f32 v[74:75], v[74:75], v[90:91]
    v_cvt_pk_bf16_f32 v144, v72, v73
    v_cvt_pk_bf16_f32 v145, v74, v75
    s_nop 1
    v_permlane32_swap_b32 v144, v145
    s_nop 1
    ds_write_b64 v26, v[144:145] offset:28672
    s_add_u32 s20, s19, 2
    s_min_u32 s20, s20, 63
    s_bfm_b64 s[22:23], s20, 0
    s_and_b32 s22, s22, 0x808088af
    s_and_b32 s23, s23, 0x80808080
    s_bcnt1_i32_b64 s32, s[22:23]
    s_lshl_b32 s32, s32, 2
    s_add_u32 s32, s32, 64
    s_cmp_eq_u32 s47, 1
    s_cselect_b32 s32, s32, s55
    s_add_u32 s21, s19, 1
    s_min_u32 s21, s21, 63
    s_lshl_b32 s31, s21, 21
    s_lshl_b32 s21, s21, 13
    s_and_b32 s21, s21, 0x2000
    s_xor_b32 s21, s21, s48
    s_add_u32 s31, s31, s21
    s_waitcnt lgkmcnt(0)
    s_cmp_eq_u32 s32, s55
    s_cbranch_scc1 L_nog_29
    s_load_dword s22, s[60:61], s32 glc
L_nog_29:
    s_mov_b32 s23, 1
    s_barrier
    s_cmp_lg_u32 s19, 0
    s_cbranch_scc1 L_ns0_32
    v_mov_b32 v248, 0
    s_lshl2_add_u32 s20, s17, s18
    s_cmp_lg_u32 s20, 5
    s_cbranch_scc1 L_rlo_34
L_rl_33:
    s_load_dword s20, s[60:61], 68 glc
    s_add_u32 s33, s33, 1
    s_cmp_gt_u32 s33, 0x100000
    s_cbranch_scc1 chain_kernel_abort
    s_waitcnt lgkmcnt(0)
    s_cmp_lt_u32 s20, 96
    s_cbranch_scc1 L_rl_33
    v_mov_b32 v249, 2
    buffer_store_dword v249, v248, s[8:11], s62 offen
    s_branch L_rlok_35
L_rlo_34:
    buffer_load_dword v249, v248, s[8:11], s62 offen sc1
    s_add_u32 s33, s33, 1
    s_cmp_gt_u32 s33, 0x100000
    s_cbranch_scc1 chain_kernel_abort
    s_waitcnt vmcnt(0)
    v_readfirstlane_b32 s20, v249
    s_cmp_ge_u32 s20, 2
    s_cbranch_scc1 L_rlok_35
    s_sleep 1
    s_branch L_rlo_34
L_rlok_35:
L_ns0_32:
    buffer_load_dword v250, v236, s[8:11], s31 offen
    s_mov_b32 m0, 40960
    s_nop 0
    buffer_load_dwordx4 v237, s[8:11], s31 offen offset:0 lds
    buffer_load_dwordx4 v237, s[8:11], s31 offen offset:1024 lds
    s_cmp_lg_u32 s47, 0
    s_cbranch_scc1 L_nof_31
    s_atomic_add s23, s[60:61], 176
L_nof_31:
    buffer_store_dwordx4 v[28:31], v22, s[8:11], s42 offen
    s_lshl_b32 s21, s29, 9
    s_add_u32 s21, s21, s42
    buffer_store_dwordx2 v[28:29], v26, s[8:11], s21 offen
    s_xor_b32 s21, s21, 20480
    buffer_store_dwordx2 v[28:29], v26, s[8:11], s21 offen
    s_cmp_eq_u32 s32, s55
    s_cbranch_scc1 L_he_28
    s_mov_b32 s55, s32
L_gr_30:
    s_waitcnt lgkmcnt(0)
    s_cmp_ge_u32 s22, 96
    s_cbranch_scc1 L_he_28
    s_add_u32 s33, s33, 1
    s_cmp_gt_u32 s33, 0x100000
    s_cbranch_scc1 chain_kernel_abort
    s_load_dword s22, s[60:61], s32 glc
    s_branch L_gr_30
L_w2_26:
    ds_read_b128 v[148:151], v242 offset:43008
    ds_read_b128 v[104:107], v1 offset:32768
    ds_read_b128 v[108:111], v1 offset:36864
    ds_read_b128 v[152:155], v242 offset:44032
    ds_read_b128 v[112:115], v1 offset:33792
    ds_read_b128 v[116:119], v1 offset:37888
    ds_read_b128 v[156:159], v242 offset:45056
    ds_read_b128 v[120:123], v1 offset:34816
    ds_read_b128 v[124:127], v1 offset:38912
    ds_read_b128 v[160:163], v242 offset:46080
    ds_read_b128 v[128:131], v1 offset:35840
    ds_read_b128 v[132:135], v1 offset:39936
    ds_read_b128 v[136:139], v1 offset:40960
    ds_read_b128 v[140:143], v1 offset:41984
    s_waitcnt lgkmcnt(11)
    v_mfma_f32_16x16x32_bf16 v[180:183], v[104:107], v[148:151], 0
    v_mfma_f32_16x16x32_bf16 v[184:187], v[108:111], v[148:151], 0
    s_waitcnt lgkmcnt(8)
    v_mfma_f32_16x16x32_bf16 v[180:183], v[112:115], v[152:155], v[180:183]
    v_mfma_f32_16x16x32_bf16 v[184:187], v[116:119], v[152:155], v[184:187]
    s_waitcnt lgkmcnt(5)
    v_mfma_f32_16x16x32_bf16 v[180:183], v[120:123], v[156:159], v[180:183]
    v_mfma_f32_16x16x32_bf16 v[184:187], v[124:127], v[156:159], v[184:187]
    s_waitcnt lgkmcnt(2)
    v_mfma_f32_16x16x32_bf16 v[180:183], v[128:131], v[160:163], v[180:183]
    v_mfma_f32_16x16x32_bf16 v[184:187], v[132:135], v[160:163], v[184:187]
    s_add_u32 s21, s19, -1
    s_lshl_b32 s32, s21, 21
    s_lshl_b32 s21, s21, 13
    s_and_b32 s21, s21, 0x2000
    s_xor_b32 s21, s21, s48
    s_add_u32 s32, s32, s21
    s_nop 0
    v_cvt_pk_bf16_f32 v180, 0, v180
    v_cvt_pk_bf16_f32 v181, 0, v181
    v_cvt_pk_bf16_f32 v182, 0, v182
    v_cvt_pk_bf16_f32 v183, 0, v183
    v_cvt_pk_bf16_f32 v184, 0, v184
    v_cvt_pk_bf16_f32 v185, 0, v185
    v_cvt_pk_bf16_f32 v186, 0, v186
    v_cvt_pk_bf16_f32 v187, 0, v187
    v_pk_mul_f32 v[180:181], v[180:181], s[58:59]
    v_pk_mul_f32 v[182:183], v[182:183], s[58:59]
    v_pk_mul_f32 v[184:185], v[184:185], s[58:59]
    v_pk_mul_f32 v[186:187], v[186:187], s[58:59]
    v_cvt_pk_bf16_f32 v180, 0, v180
    v_cvt_pk_bf16_f32 v181, 0, v181
    v_cvt_pk_bf16_f32 v182, 0, v182
    v_cvt_pk_bf16_f32 v183, 0, v183
    v_cvt_pk_bf16_f32 v184, 0, v184
    v_cvt_pk_bf16_f32 v185, 0, v185
    v_cvt_pk_bf16_f32 v186, 0, v186
    v_cvt_pk_bf16_f32 v187, 0, v187
    v_pk_add_f32 v[180:181], v[180:181], v[96:97]
    v_pk_add_f32 v[182:183], v[182:183], v[98:99]
    v_pk_add_f32 v[184:185], v[184:185], v[100:101]
    v_pk_add_f32 v[186:187], v[186:187], v[102:103]
    v_max3_f32 v212, v180, v181, v182
    v_max3_f32 v213, v183, v184, v185
    v_max3_f32 v212, v212, v186, v187
    v_max_f32 v212, v212, v213
    s_cmp_eq_u32 s18, 3
    s_waitcnt lgkmcnt(0)
    s_barrier
    ds_read_b64 v[144:145], v26 offset:28672
    s_cbranch_scc0 L_he_28
    s_mov_b32 m0, 51200
    s_nop 0
    buffer_load_dwordx4 v24, s[8:11], s40 offen offset:0 sc1 lds
    s_mov_b32 m0, 50176
    s_nop 0
    buffer_load_dwordx4 v24, s[8:11], s40 offen offset:2048 sc1 lds
L_he_28:
    s_cmp_lg_u32 s19, 63
    s_cbranch_scc1 L_b4_14
chain_kernel_fin:
    s_waitcnt vmcnt(0) lgkmcnt(0)
    s_barrier
    s_cmp_lt_u32 s18, 2
    s_cbranch_scc1 L_f2_36
    ds_read_b128 v[164:167], v241 offset:51200
    ds_read_b128 v[168:171], v241 offset:51712
    ds_read_b128 v[172:175], v241 offset:52224
    ds_read_b128 v[176:179], v241 offset:52736
    s_waitcnt lgkmcnt(3)
    v_mfma_f32_16x16x32_bf16 v[188:191], v[164:167], v[148:151], 0
    s_waitcnt lgkmcnt(2)
    v_mfma_f32_16x16x32_bf16 v[188:191], v[168:171], v[152:155], v[188:191]
    s_waitcnt lgkmcnt(1)
    v_mfma_f32_16x16x32_bf16 v[188:191], v[172:175], v[156:159], v[188:191]
    s_waitcnt lgkmcnt(0)
    v_mfma_f32_16x16x32_bf16 v[188:191], v[176:179], v[160:163], v[188:191]
    s_nop 7
    v_cvt_pk_bf16_f32 v188, 0, v188
    v_cvt_pk_bf16_f32 v189, 0, v189
    v_pk_mul_f32 v[188:189], v[188:189], s[58:59]
    v_cvt_pk_bf16_f32 v188, 0, v188
    v_cvt_pk_bf16_f32 v189, 0, v189
    v_max3_f32 v212, v212, v188, v189
    v_mov_b32 v213, v212
    s_nop 1
    v_permlane16_swap_b32 v212, v213
    v_max_f32 v212, v212, v213
    v_mov_b32 v213, v212
    s_nop 1
    v_permlane32_swap_b32 v212, v213
    v_max_f32 v212, v212, v213
    v_mul_f32 v212, s56, v212
    v_pk_fma_f32 v[180:181], v[180:181], s[56:57], v[212:213] op_sel_hi:[1,1,0] neg_lo:[0,0,1] neg_hi:[0,0,1]
    v_pk_fma_f32 v[182:183], v[182:183], s[56:57], v[212:213] op_sel_hi:[1,1,0] neg_lo:[0,0,1] neg_hi:[0,0,1]
    v_pk_fma_f32 v[184:185], v[184:185], s[56:57], v[212:213] op_sel_hi:[1,1,0] neg_lo:[0,0,1] neg_hi:[0,0,1]
    v_pk_fma_f32 v[186:187], v[186:187], s[56:57], v[212:213] op_sel_hi:[1,1,0] neg_lo:[0,0,1] neg_hi:[0,0,1]
    v_pk_fma_f32 v[188:189], v[188:189], s[56:57], v[212:213] op_sel_hi:[1,1,0] neg_lo:[0,0,1] neg_hi:[0,0,1]
    v_exp_f32 v180, v180
    v_exp_f32 v181, v181
    v_exp_f32 v182, v182
    v_exp_f32 v183, v183
    v_exp_f32 v184, v184
    v_exp_f32 v185, v185
    v_exp_f32 v186, v186
    v_exp_f32 v187, v187
    v_exp_f32 v188, v188
    v_exp_f32 v189, v189
    v_pk_add_f32 v[214:215], v[180:181], v[182:183]
    v_pk_add_f32 v[216:217], v[184:185], v[186:187]
    v_pk_add_f32 v[214:215], v[214:215], v[188:189]
    v_pk_add_f32 v[214:215], v[214:215], v[216:217]
    v_add_f32 v214, v214, v215
    v_mov_b32 v213, v214
    s_nop 1
    v_permlane16_swap_b32 v214, v213
    v_add_f32 v214, v214, v213
    v_mov_b32 v213, v214
    s_nop 1
    v_permlane32_swap_b32 v214, v213
    v_add_f32 v214, v214, v213
    v_rcp_f32 v214, v214
    s_nop 0
    v_pk_mul_f32 v[180:181], v[180:181], v[214:215] op_sel_hi:[1,0]
    v_pk_mul_f32 v[182:183], v[182:183], v[214:215] op_sel_hi:[1,0]
    v_pk_mul_f32 v[184:185], v[184:185], v[214:215] op_sel_hi:[1,0]
    v_pk_mul_f32 v[186:187], v[186:187], v[214:215] op_sel_hi:[1,0]
    v_pk_mul_f32 v[188:189], v[188:189], v[214:215] op_sel_hi:[1,0]
    v_cvt_pk_bf16_f32 v192, v180, v181
    v_cvt_pk_bf16_f32 v193, v182, v183
    v_cvt_pk_bf16_f32 v194, v184, v185
    v_cvt_pk_bf16_f32 v195, v186, v187
    v_cvt_pk_bf16_f32 v196, v188, v189
    v_cvt_pk_bf16_f32 v199, v188, v189
    v_mfma_f32_16x16x32_bf16 v[200:203], v[136:139], v[192:195], 0
    v_mfma_f32_16x16x32_bf16 v[204:207], v[140:143], v[192:195], 0
    v_mfma_f32_16x16x16_bf16 v[200:203], v[144:145], v[196:197], v[200:203]
    v_mfma_f32_16x16x16_bf16 v[204:207], v[144:145], v[198:199], v[204:207]
    s_add_u32 s21, s19, 0
    s_min_u32 s21, s21, 63
    s_lshl_b32 s32, s21, 21
    s_lshl_b32 s21, s21, 13
    s_and_b32 s21, s21, 0x2000
    s_xor_b32 s21, s21, s48
    s_add_u32 s32, s32, s21
    s_nop 1
    v_cvt_pk_bf16_f32 v200, v200, v201
    v_cvt_pk_bf16_f32 v201, v202, v203
    v_cvt_pk_bf16_f32 v202, v204, v205
    v_cvt_pk_bf16_f32 v203, v206, v207
    buffer_store_dwordx4 v[200:203], v23, s[8:11], s32 offen sc1
    s_waitcnt vmcnt(0)
L_f2_36:
    s_barrier
    s_cmp_lg_u32 s18, 0
    s_cbranch_scc1 chain_kernel_done
    s_add_u32 s20, s62, 4096
    s_mov_b32 s21, 1
    s_atomic_add s21, s[100:101], s20
    s_branch chain_kernel_done
Gq_15_f0123:
    buffer_load_dwordx4 v[32:35], v2, s[8:11], s40 offen offset:0 sc1
    s_branch Gq_15_s1230
Gq_15_f123p0:
    buffer_load_dwordx4 v[36:39], v2, s[8:11], s40 offen offset:1024 sc1
    s_add_u32 s33, s33, 1
    s_cmp_gt_u32 s33, 0x100000
    s_cbranch_scc1 chain_kernel_abort
    s_branch Gq_15_s231
Gq_15_f23p1:
    buffer_load_dwordx4 v[40:43], v2, s[8:11], s40 offen offset:2048 sc1
    s_add_u32 s33, s33, 1
    s_cmp_gt_u32 s33, 0x100000
    s_cbranch_scc1 chain_kernel_abort
    s_branch Gq_15_s32
Gq_15_f3p2:
    buffer_load_dwordx4 v[44:47], v2, s[8:11], s40 offen offset:3072 sc1
    s_add_u32 s33, s33, 1
    s_cmp_gt_u32 s33, 0x100000
    s_cbranch_scc1 chain_kernel_abort
    s_branch Gq_15_s3
Gq_15_redo:
    buffer_load_dwordx4 v[32:35], v2, s[8:11], s40 offen offset:0 sc1
    buffer_load_dwordx4 v[36:39], v2, s[8:11], s40 offen offset:1024 sc1
    buffer_load_dwordx4 v[40:43], v2, s[8:11], s40 offen offset:2048 sc1
    buffer_load_dwordx4 v[44:47], v2, s[8:11], s40 offen offset:3072 sc1
    s_add_u32 s33, s33, 1
    s_cmp_gt_u32 s33, 0x100000
    s_cbranch_scc1 chain_kernel_abort
    s_nop 5
    v_mov_b32 v64, 0
    v_mov_b32 v65, 0
    v_mov_b32 v66, 0
    v_mov_b32 v67, 0
    v_mov_b32 v68, 0
    v_mov_b32 v69, 0
    v_mov_b32 v70, 0
    v_mov_b32 v71, 0
    v_mov_b32 v72, 0
    v_mov_b32 v73, 0
    v_mov_b32 v74, 0
    v_mov_b32 v75, 0
    s_branch Gq_15_s0123
Gq_15_s1230:
    s_waitcnt vmcnt(3)
    v_cmp_eq_u32 vcc, -1, v36
    v_mov_b32_dpp v52, v36 row_ror:8 row_mask:0xf bank_mask:0xf
    v_mov_b32_dpp v53, v37 row_ror:8 row_mask:0xf bank_mask:0xf
    v_mov_b32_dpp v54, v38 row_ror:8 row_mask:0xf bank_mask:0xf
    v_mov_b32_dpp v55, v39 row_ror:8 row_mask:0xf bank_mask:0xf
    s_cbranch_vccnz Gq_15_f1230
    v_smfmac_f32_16x16x64_bf16 v[64:67], v[36:39], a[8:15], v19
    v_smfmac_f32_16x16x64_bf16 v[68:71], v[36:39], a[72:79], v19
Gq_15_s230p1:
    s_waitcnt vmcnt(2)
    v_cmp_eq_u32 vcc, -1, v40
    v_smfmac_f32_16x16x64_bf16 v[64:67], v[52:55], a[40:47], v19
    v_mov_b32_dpp v56, v40 row_ror:8 row_mask:0xf bank_mask:0xf
    v_mov_b32_dpp v57, v41 row_ror:8 row_mask:0xf bank_mask:0xf
    v_smfmac_f32_16x16x64_bf16 v[68:71], v[52:55], a[104:111], v19
    v_mov_b32_dpp v58, v42 row_ror:8 row_mask:0xf bank_mask:0xf
    v_mov_b32_dpp v59, v43 row_ror:8 row_mask:0xf bank_mask:0xf
    s_cbranch_vccnz Gq_15_f230p1
    v_smfmac_f32_16x16x64_bf16 v[64:67], v[40:43], a[16:23], v19
    v_smfmac_f32_16x16x64_bf16 v[68:71], v[40:43], a[80:87], v19
Gq_15_s30p2:
    s_waitcnt vmcnt(1)
    v_cmp_eq_u32 vcc, -1, v44
    v_smfmac_f32_16x16x64_bf16 v[64:67], v[56:59], a[48:55], v19
    v_mov_b32_dpp v60, v44 row_ror:8 row_mask:0xf bank_mask:0xf
    v_mov_b32_dpp v61, v45 row_ror:8 row_mask:0xf bank_mask:0xf
    v_smfmac_f32_16x16x64_bf16 v[68:71], v[56:59], a[112:119], v19
    v_mov_b32_dpp v62, v46 row_ror:8 row_mask:0xf bank_mask:0xf
    v_mov_b32_dpp v63, v47 row_ror:8 row_mask:0xf bank_mask:0xf
    s_cbranch_vccnz Gq_15_f30p2
    v_smfmac_f32_16x16x64_bf16 v[64:67], v[44:47], a[24:31], v19
    v_smfmac_f32_16x16x64_bf16 v[68:71], v[44:47], a[88:95], v19
Gq_15_s0p3:
    s_waitcnt vmcnt(0)
    v_cmp_eq_u32 vcc, -1, v32
    v_smfmac_f32_16x16x64_bf16 v[64:67], v[60:63], a[56:63], v19
    v_mov_b32_dpp v48, v32 row_ror:8 row_mask:0xf bank_mask:0xf
    v_mov_b32_dpp v49, v33 row_ror:8 row_mask:0xf bank_mask:0xf
    v_smfmac_f32_16x16x64_bf16 v[68:71], v[60:63], a[120:127], v19
    v_mov_b32_dpp v50, v34 row_ror:8 row_mask:0xf bank_mask:0xf
    v_mov_b32_dpp v51, v35 row_ror:8 row_mask:0xf bank_mask:0xf
    s_cbranch_vccnz Gq_15_f0p3
    v_smfmac_f32_16x16x64_bf16 v[64:67], v[32:35], a[0:7], v19
    v_smfmac_f32_16x16x64_bf16 v[68:71], v[32:35], a[64:71], v19
    v_smfmac_f32_16x16x64_bf16 v[64:67], v[48:51], a[32:39], v19
    v_smfmac_f32_16x16x64_bf16 v[68:71], v[48:51], a[96:103], v19
    s_branch Gq_15_done
Gq_15_f1230:
    buffer_load_dwordx4 v[36:39], v2, s[8:11], s40 offen offset:1024 sc1
    s_add_u32 s33, s33, 1
    s_cmp_gt_u32 s33, 0x100000
    s_cbranch_scc1 chain_kernel_abort
    s_branch Gq_15_s2301
Gq_15_f230p1:
    buffer_load_dwordx4 v[40:43], v2, s[8:11], s40 offen offset:2048 sc1
    s_add_u32 s33, s33, 1
    s_cmp_gt_u32 s33, 0x100000
    s_cbranch_scc1 chain_kernel_abort
    s_branch Gq_15_s302
Gq_15_f30p2:
    buffer_load_dwordx4 v[44:47], v2, s[8:11], s40 offen offset:3072 sc1
    s_add_u32 s33, s33, 1
    s_cmp_gt_u32 s33, 0x100000
    s_cbranch_scc1 chain_kernel_abort
    s_branch Gq_15_s03
Gq_15_f0p3:
    buffer_load_dwordx4 v[32:35], v2, s[8:11], s40 offen offset:0 sc1
    s_add_u32 s33, s33, 1
    s_cmp_gt_u32 s33, 0x100000
    s_cbranch_scc1 chain_kernel_abort
    s_branch Gq_15_s0
Gq_15_s231:
    s_waitcnt vmcnt(2)
    v_cmp_eq_u32 vcc, -1, v40
    v_mov_b32_dpp v56, v40 row_ror:8 row_mask:0xf bank_mask:0xf
    v_mov_b32_dpp v57, v41 row_ror:8 row_mask:0xf bank_mask:0xf
    v_mov_b32_dpp v58, v42 row_ror:8 row_mask:0xf bank_mask:0xf
    v_mov_b32_dpp v59, v43 row_ror:8 row_mask:0xf bank_mask:0xf
    s_cbranch_vccnz Gq_15_f231
    v_smfmac_f32_16x16x64_bf16 v[64:67], v[40:43], a[16:23], v19
    v_smfmac_f32_16x16x64_bf16 v[68:71], v[40:43], a[80:87], v19
Gq_15_s31p2:
    s_waitcnt vmcnt(1)
    v_cmp_eq_u32 vcc, -1, v44
    v_smfmac_f32_16x16x64_bf16 v[64:67], v[56:59], a[48:55], v19
    v_mov_b32_dpp v60, v44 row_ror:8 row_mask:0xf bank_mask:0xf
    v_mov_b32_dpp v61, v45 row_ror:8 row_mask:0xf bank_mask:0xf
    v_smfmac_f32_16x16x64_bf16 v[68:71], v[56:59], a[112:119], v19
    v_mov_b32_dpp v62, v46 row_ror:8 row_mask:0xf bank_mask:0xf
    v_mov_b32_dpp v63, v47 row_ror:8 row_mask:0xf bank_mask:0xf
    s_cbranch_vccnz Gq_15_f31p2
    v_smfmac_f32_16x16x64_bf16 v[64:67], v[44:47], a[24:31], v19
    v_smfmac_f32_16x16x64_bf16 v[68:71], v[44:47], a[88:95], v19
Gq_15_s1p3:
    s_waitcnt vmcnt(0)
    v_cmp_eq_u32 vcc, -1, v36
    v_smfmac_f32_16x16x64_bf16 v[64:67], v[60:63], a[56:63], v19
    v_mov_b32_dpp v52, v36 row_ror:8 row_mask:0xf bank_mask:0xf
    v_mov_b32_dpp v53, v37 row_ror:8 row_mask:0xf bank_mask:0xf
    v_smfmac_f32_16x16x64_bf16 v[68:71], v[60:63], a[120:127], v19
    v_mov_b32_dpp v54, v38 row_ror:8 row_mask:0xf bank_mask:0xf
    v_mov_b32_dpp v55, v39 row_ror:8 row_mask:0xf bank_mask:0xf
    s_cbranch_vccnz Gq_15_f1p3
    v_smfmac_f32_16x16x64_bf16 v[64:67], v[36:39], a[8:15], v19
    v_smfmac_f32_16x16x64_bf16 v[68:71], v[36:39], a[72:79], v19
    v_smfmac_f32_16x16x64_bf16 v[64:67], v[52:55], a[40:47], v19
    v_smfmac_f32_16x16x64_bf16 v[68:71], v[52:55], a[104:111], v19
    s_branch Gq_15_done
Gq_15_f231:
    buffer_load_dwordx4 v[40:43], v2, s[8:11], s40 offen offset:2048 sc1
    s_add_u32 s33, s33, 1
    s_cmp_gt_u32 s33, 0x100000
    s_cbranch_scc1 chain_kernel_abort
    s_branch Gq_15_s312
Gq_15_f31p2:
    buffer_load_dwordx4 v[44:47], v2, s[8:11], s40 offen offset:3072 sc1
    s_add_u32 s33, s33, 1
    s_cmp_gt_u32 s33, 0x100000
    s_cbranch_scc1 chain_kernel_abort
    s_branch Gq_15_s13
Gq_15_f1p3:
    buffer_load_dwordx4 v[36:39], v2, s[8:11], s40 offen offset:1024 sc1
    s_add_u32 s33, s33, 1
    s_cmp_gt_u32 s33, 0x100000
    s_cbranch_scc1 chain_kernel_abort
    s_branch Gq_15_s1
Gq_15_s32:
    s_waitcnt vmcnt(1)
    v_cmp_eq_u32 vcc, -1, v44
    v_mov_b32_dpp v60, v44 row_ror:8 row_mask:0xf bank_mask:0xf
    v_mov_b32_dpp v61, v45 row_ror:8 row_mask:0xf bank_mask:0xf
    v_mov_b32_dpp v62, v46 row_ror:8 row_mask:0xf bank_mask:0xf
    v_mov_b32_dpp v63, v47 row_ror:8 row_mask:0xf bank_mask:0xf
    s_cbranch_vccnz Gq_15_f32
    v_smfmac_f32_16x16x64_bf16 v[64:67], v[44:47], a[24:31], v19
    v_smfmac_f32_16x16x64_bf16 v[68:71], v[44:47], a[88:95], v19
Gq_15_s2p3:
    s_waitcnt vmcnt(0)
    v_cmp_eq_u32 vcc, -1, v40
    v_smfmac_f32_16x16x64_bf16 v[64:67], v[60:63], a[56:63], v19
    v_mov_b32_dpp v56, v40 row_ror:8 row_mask:0xf bank_mask:0xf
    v_mov_b32_dpp v57, v41 row_ror:8 row_mask:0xf bank_mask:0xf
    v_smfmac_f32_16x16x64_bf16 v[68:71], v[60:63], a[120:127], v19
    v_mov_b32_dpp v58, v42 row_ror:8 row_mask:0xf bank_mask:0xf
    v_mov_b32_dpp v59, v43 row_ror:8 row_mask:0xf bank_mask:0xf
    s_cbranch_vccnz Gq_15_f2p3
    v_smfmac_f32_16x16x64_bf16 v[64:67], v[40:43], a[16:23], v19
    v_smfmac_f32_16x16x64_bf16 v[68:71], v[40:43], a[80:87], v19
    v_smfmac_f32_16x16x64_bf16 v[64:67], v[56:59], a[48:55], v19
    v_smfmac_f32_16x16x64_bf16 v[68:71], v[56:59], a[112:119], v19
    s_branch Gq_15_done
Gq_15_f32:
    buffer_load_dwordx4 v[44:47], v2, s[8:11], s40 offen offset:3072 sc1
    s_add_u32 s33, s33, 1
    s_cmp_gt_u32 s33, 0x100000
    s_cbranch_scc1 chain_kernel_abort
    s_branch Gq_15_s23
Gq_15_f2p3:
    buffer_load_dwordx4 v[40:43], v2, s[8:11], s40 offen offset:2048 sc1
    s_add_u32 s33, s33, 1
    s_cmp_gt_u32 s33, 0x100000
    s_cbranch_scc1 chain_kernel_abort
    s_branch Gq_15_s2
Gq_15_s3:
    s_waitcnt vmcnt(0)
    v_cmp_eq_u32 vcc, -1, v44
    v_mov_b32_dpp v60, v44 row_ror:8 row_mask:0xf bank_mask:0xf
    v_mov_b32_dpp v61, v45 row_ror:8 row_mask:0xf bank_mask:0xf
    v_mov_b32_dpp v62, v46 row_ror:8 row_mask:0xf bank_mask:0xf
    v_mov_b32_dpp v63, v47 row_ror:8 row_mask:0xf bank_mask:0xf
    s_cbranch_vccnz Gq_15_f3
    v_smfmac_f32_16x16x64_bf16 v[64:67], v[44:47], a[24:31], v19
    v_smfmac_f32_16x16x64_bf16 v[68:71], v[44:47], a[88:95], v19
    v_smfmac_f32_16x16x64_bf16 v[64:67], v[60:63], a[56:63], v19
    v_smfmac_f32_16x16x64_bf16 v[68:71], v[60:63], a[120:127], v19
    s_branch Gq_15_done
Gq_15_f3:
    buffer_load_dwordx4 v[44:47], v2, s[8:11], s40 offen offset:3072 sc1
    s_add_u32 s33, s33, 1
    s_cmp_gt_u32 s33, 0x100000
    s_cbranch_scc1 chain_kernel_abort
    s_branch Gq_15_s3
Gq_15_s2301:
    s_waitcnt vmcnt(3)
    v_cmp_eq_u32 vcc, -1, v40
    v_mov_b32_dpp v56, v40 row_ror:8 row_mask:0xf bank_mask:0xf
    v_mov_b32_dpp v57, v41 row_ror:8 row_mask:0xf bank_mask:0xf
    v_mov_b32_dpp v58, v42 row_ror:8 row_mask:0xf bank_mask:0xf
    v_mov_b32_dpp v59, v43 row_ror:8 row_mask:0xf bank_mask:0xf
    s_cbranch_vccnz Gq_15_f2301
    v_smfmac_f32_16x16x64_bf16 v[64:67], v[40:43], a[16:23], v19
    v_smfmac_f32_16x16x64_bf16 v[68:71], v[40:43], a[80:87], v19
Gq_15_s301p2:
    s_waitcnt vmcnt(2)
    v_cmp_eq_u32 vcc, -1, v44
    v_smfmac_f32_16x16x64_bf16 v[64:67], v[56:59], a[48:55], v19
    v_mov_b32_dpp v60, v44 row_ror:8 row_mask:0xf bank_mask:0xf
    v_mov_b32_dpp v61, v45 row_ror:8 row_mask:0xf bank_mask:0xf
    v_smfmac_f32_16x16x64_bf16 v[68:71], v[56:59], a[112:119], v19
    v_mov_b32_dpp v62, v46 row_ror:8 row_mask:0xf bank_mask:0xf
    v_mov_b32_dpp v63, v47 row_ror:8 row_mask:0xf bank_mask:0xf
    s_cbranch_vccnz Gq_15_f301p2
    v_smfmac_f32_16x16x64_bf16 v[64:67], v[44:47], a[24:31], v19
    v_smfmac_f32_16x16x64_bf16 v[68:71], v[44:47], a[88:95], v19
Gq_15_s01p3:
    s_waitcnt vmcnt(1)
    v_cmp_eq_u32 vcc, -1, v32
    v_smfmac_f32_16x16x64_bf16 v[64:67], v[60:63], a[56:63], v19
    v_mov_b32_dpp v48, v32 row_ror:8 row_mask:0xf bank_mask:0xf
    v_mov_b32_dpp v49, v33 row_ror:8 row_mask:0xf bank_mask:0xf
    v_smfmac_f32_16x16x64_bf16 v[68:71], v[60:63], a[120:127], v19
    v_mov_b32_dpp v50, v34 row_ror:8 row_mask:0xf bank_mask:0xf
    v_mov_b32_dpp v51, v35 row_ror:8 row_mask:0xf bank_mask:0xf
    s_cbranch_vccnz Gq_15_f01p3
    v_smfmac_f32_16x16x64_bf16 v[64:67], v[32:35], a[0:7], v19
    v_smfmac_f32_16x16x64_bf16 v[68:71], v[32:35], a[64:71], v19
Gq_15_s1p0:
    s_waitcnt vmcnt(0)
    v_cmp_eq_u32 vcc, -1, v36
    v_smfmac_f32_16x16x64_bf16 v[64:67], v[48:51], a[32:39], v19
    v_mov_b32_dpp v52, v36 row_ror:8 row_mask:0xf bank_mask:0xf
    v_mov_b32_dpp v53, v37 row_ror:8 row_mask:0xf bank_mask:0xf
    v_smfmac_f32_16x16x64_bf16 v[68:71], v[48:51], a[96:103], v19
    v_mov_b32_dpp v54, v38 row_ror:8 row_mask:0xf bank_mask:0xf
    v_mov_b32_dpp v55, v39 row_ror:8 row_mask:0xf bank_mask:0xf
    s_cbranch_vccnz Gq_15_f1p0
    v_smfmac_f32_16x16x64_bf16 v[64:67], v[36:39], a[8:15], v19
    v_smfmac_f32_16x16x64_bf16 v[68:71], v[36:39], a[72:79], v19
    v_smfmac_f32_16x16x64_bf16 v[64:67], v[52:55], a[40:47], v19
    v_smfmac_f32_16x16x64_bf16 v[68:71], v[52:55], a[104:111], v19
    s_branch Gq_15_done
Gq_15_f2301:
    buffer_load_dwordx4 v[40:43], v2, s[8:11], s40 offen offset:2048 sc1
    s_add_u32 s33, s33, 1
    s_cmp_gt_u32 s33, 0x100000
    s_cbranch_scc1 chain_kernel_abort
    s_branch Gq_15_s3012
Gq_15_f301p2:
    buffer_load_dwordx4 v[44:47], v2, s[8:11], s40 offen offset:3072 sc1
    s_add_u32 s33, s33, 1
    s_cmp_gt_u32 s33, 0x100000
    s_cbranch_scc1 chain_kernel_abort
    s_branch Gq_15_s013
Gq_15_f01p3:
    buffer_load_dwordx4 v[32:35], v2, s[8:11], s40 offen offset:0 sc1
    s_add_u32 s33, s33, 1
    s_cmp_gt_u32 s33, 0x100000
    s_cbranch_scc1 chain_kernel_abort
    s_branch Gq_15_s10
Gq_15_f1p0:
    buffer_load_dwordx4 v[36:39], v2, s[8:11], s40 offen offset:1024 sc1
    s_add_u32 s33, s33, 1
    s_cmp_gt_u32 s33, 0x100000
    s_cbranch_scc1 chain_kernel_abort
    s_branch Gq_15_s1
Gq_15_s302:
    s_waitcnt vmcnt(2)
    v_cmp_eq_u32 vcc, -1, v44
    v_mov_b32_dpp v60, v44 row_ror:8 row_mask:0xf bank_mask:0xf
    v_mov_b32_dpp v61, v45 row_ror:8 row_mask:0xf bank_mask:0xf
    v_mov_b32_dpp v62, v46 row_ror:8 row_mask:0xf bank_mask:0xf
    v_mov_b32_dpp v63, v47 row_ror:8 row_mask:0xf bank_mask:0xf
    s_cbranch_vccnz Gq_15_f302
    v_smfmac_f32_16x16x64_bf16 v[64:67], v[44:47], a[24:31], v19
    v_smfmac_f32_16x16x64_bf16 v[68:71], v[44:47], a[88:95], v19
Gq_15_s02p3:
    s_waitcnt vmcnt(1)
    v_cmp_eq_u32 vcc, -1, v32
    v_smfmac_f32_16x16x64_bf16 v[64:67], v[60:63], a[56:63], v19
    v_mov_b32_dpp v48, v32 row_ror:8 row_mask:0xf bank_mask:0xf
    v_mov_b32_dpp v49, v33 row_ror:8 row_mask:0xf bank_mask:0xf
    v_smfmac_f32_16x16x64_bf16 v[68:71], v[60:63], a[120:127], v19
    v_mov_b32_dpp v50, v34 row_ror:8 row_mask:0xf bank_mask:0xf
    v_mov_b32_dpp v51, v35 row_ror:8 row_mask:0xf bank_mask:0xf
    s_cbranch_vccnz Gq_15_f02p3
    v_smfmac_f32_16x16x64_bf16 v[64:67], v[32:35], a[0:7], v19
    v_smfmac_f32_16x16x64_bf16 v[68:71], v[32:35], a[64:71], v19
Gq_15_s2p0:
    s_waitcnt vmcnt(0)
    v_cmp_eq_u32 vcc, -1, v40
    v_smfmac_f32_16x16x64_bf16 v[64:67], v[48:51], a[32:39], v19
    v_mov_b32_dpp v56, v40 row_ror:8 row_mask:0xf bank_mask:0xf
    v_mov_b32_dpp v57, v41 row_ror:8 row_mask:0xf bank_mask:0xf
    v_smfmac_f32_16x16x64_bf16 v[68:71], v[48:51], a[96:103], v19
    v_mov_b32_dpp v58, v42 row_ror:8 row_mask:0xf bank_mask:0xf
    v_mov_b32_dpp v59, v43 row_ror:8 row_mask:0xf bank_mask:0xf
    s_cbranch_vccnz Gq_15_f2p0
    v_smfmac_f32_16x16x64_bf16 v[64:67], v[40:43], a[16:23], v19
    v_smfmac_f32_16x16x64_bf16 v[68:71], v[40:43], a[80:87], v19
    v_smfmac_f32_16x16x64_bf16 v[64:67], v[56:59], a[48:55], v19
    v_smfmac_f32_16x16x64_bf16 v[68:71], v[56:59], a[112:119], v19
    s_branch Gq_15_done
Gq_15_f302:
    buffer_load_dwordx4 v[44:47], v2, s[8:11], s40 offen offset:3072 sc1
    s_add_u32 s33, s33, 1
    s_cmp_gt_u32 s33, 0x100000
    s_cbranch_scc1 chain_kernel_abort
    s_branch Gq_15_s023
Gq_15_f02p3:
    buffer_load_dwordx4 v[32:35], v2, s[8:11], s40 offen offset:0 sc1
    s_add_u32 s33, s33, 1
    s_cmp_gt_u32 s33, 0x100000
    s_cbranch_scc1 chain_kernel_abort
    s_branch Gq_15_s20
Gq_15_f2p0:
    buffer_load_dwordx4 v[40:43], v2, s[8:11], s40 offen offset:2048 sc1
    s_add_u32 s33, s33, 1
    s_cmp_gt_u32 s33, 0x100000
    s_cbranch_scc1 chain_kernel_abort
    s_branch Gq_15_s2
Gq_15_s03:
    s_waitcnt vmcnt(1)
    v_cmp_eq_u32 vcc, -1, v32
    v_mov_b32_dpp v48, v32 row_ror:8 row_mask:0xf bank_mask:0xf
    v_mov_b32_dpp v49, v33 row_ror:8 row_mask:0xf bank_mask:0xf
    v_mov_b32_dpp v50, v34 row_ror:8 row_mask:0xf bank_mask:0xf
    v_mov_b32_dpp v51, v35 row_ror:8 row_mask:0xf bank_mask:0xf
    s_cbranch_vccnz Gq_15_f03
    v_smfmac_f32_16x16x64_bf16 v[64:67], v[32:35], a[0:7], v19
    v_smfmac_f32_16x16x64_bf16 v[68:71], v[32:35], a[64:71], v19
Gq_15_s3p0:
    s_waitcnt vmcnt(0)
    v_cmp_eq_u32 vcc, -1, v44
    v_smfmac_f32_16x16x64_bf16 v[64:67], v[48:51], a[32:39], v19
    v_mov_b32_dpp v60, v44 row_ror:8 row_mask:0xf bank_mask:0xf
    v_mov_b32_dpp v61, v45 row_ror:8 row_mask:0xf bank_mask:0xf
    v_smfmac_f32_16x16x64_bf16 v[68:71], v[48:51], a[96:103], v19
    v_mov_b32_dpp v62, v46 row_ror:8 row_mask:0xf bank_mask:0xf
    v_mov_b32_dpp v63, v47 row_ror:8 row_mask:0xf bank_mask:0xf
    s_cbranch_vccnz Gq_15_f3p0
    v_smfmac_f32_16x16x64_bf16 v[64:67], v[44:47], a[24:31], v19
    v_smfmac_f32_16x16x64_bf16 v[68:71], v[44:47], a[88:95], v19
    v_smfmac_f32_16x16x64_bf16 v[64:67], v[60:63], a[56:63], v19
    v_smfmac_f32_16x16x64_bf16 v[68:71], v[60:63], a[120:127], v19
    s_branch Gq_15_done
Gq_15_f03:
    buffer_load_dwordx4 v[32:35], v2, s[8:11], s40 offen offset:0 sc1
    s_add_u32 s33, s33, 1
    s_cmp_gt_u32 s33, 0x100000
    s_cbranch_scc1 chain_kernel_abort
    s_branch Gq_15_s30
Gq_15_f3p0:
    buffer_load_dwordx4 v[44:47], v2, s[8:11], s40 offen offset:3072 sc1
    s_add_u32 s33, s33, 1
    s_cmp_gt_u32 s33, 0x100000
    s_cbranch_scc1 chain_kernel_abort
    s_branch Gq_15_s3
Gq_15_s0:
    s_waitcnt vmcnt(0)
    v_cmp_eq_u32 vcc, -1, v32
    v_mov_b32_dpp v48, v32 row_ror:8 row_mask:0xf bank_mask:0xf
    v_mov_b32_dpp v49, v33 row_ror:8 row_mask:0xf bank_mask:0xf
    v_mov_b32_dpp v50, v34 row_ror:8 row_mask:0xf bank_mask:0xf
    v_mov_b32_dpp v51, v35 row_ror:8 row_mask:0xf bank_mask:0xf
    s_cbranch_vccnz Gq_15_f0
    v_smfmac_f32_16x16x64_bf16 v[64:67], v[32:35], a[0:7], v19
    v_smfmac_f32_16x16x64_bf16 v[68:71], v[32:35], a[64:71], v19
    v_smfmac_f32_16x16x64_bf16 v[64:67], v[48:51], a[32:39], v19
    v_smfmac_f32_16x16x64_bf16 v[68:71], v[48:51], a[96:103], v19
    s_branch Gq_15_done
Gq_15_f0:
    buffer_load_dwordx4 v[32:35], v2, s[8:11], s40 offen offset:0 sc1
    s_add_u32 s33, s33, 1
    s_cmp_gt_u32 s33, 0x100000
    s_cbranch_scc1 chain_kernel_abort
    s_branch Gq_15_s0
Gq_15_s312:
    s_waitcnt vmcnt(2)
    v_cmp_eq_u32 vcc, -1, v44
    v_mov_b32_dpp v60, v44 row_ror:8 row_mask:0xf bank_mask:0xf
    v_mov_b32_dpp v61, v45 row_ror:8 row_mask:0xf bank_mask:0xf
    v_mov_b32_dpp v62, v46 row_ror:8 row_mask:0xf bank_mask:0xf
    v_mov_b32_dpp v63, v47 row_ror:8 row_mask:0xf bank_mask:0xf
    s_cbranch_vccnz Gq_15_f312
    v_smfmac_f32_16x16x64_bf16 v[64:67], v[44:47], a[24:31], v19
    v_smfmac_f32_16x16x64_bf16 v[68:71], v[44:47], a[88:95], v19
Gq_15_s12p3:
    s_waitcnt vmcnt(1)
    v_cmp_eq_u32 vcc, -1, v36
    v_smfmac_f32_16x16x64_bf16 v[64:67], v[60:63], a[56:63], v19
    v_mov_b32_dpp v52, v36 row_ror:8 row_mask:0xf bank_mask:0xf
    v_mov_b32_dpp v53, v37 row_ror:8 row_mask:0xf bank_mask:0xf
    v_smfmac_f32_16x16x64_bf16 v[68:71], v[60:63], a[120:127], v19
    v_mov_b32_dpp v54, v38 row_ror:8 row_mask:0xf bank_mask:0xf
    v_mov_b32_dpp v55, v39 row_ror:8 row_mask:0xf bank_mask:0xf
    s_cbranch_vccnz Gq_15_f12p3
    v_smfmac_f32_16x16x64_bf16 v[64:67], v[36:39], a[8:15], v19
    v_smfmac_f32_16x16x64_bf16 v[68:71], v[36:39], a[72:79], v19
Gq_15_s2p1:
    s_waitcnt vmcnt(0)
    v_cmp_eq_u32 vcc, -1, v40
    v_smfmac_f32_16x16x64_bf16 v[64:67], v[52:55], a[40:47], v19
    v_mov_b32_dpp v56, v40 row_ror:8 row_mask:0xf bank_mask:0xf
    v_mov_b32_dpp v57, v41 row_ror:8 row_mask:0xf bank_mask:0xf
    v_smfmac_f32_16x16x64_bf16 v[68:71], v[52:55], a[104:111], v19
    v_mov_b32_dpp v58, v42 row_ror:8 row_mask:0xf bank_mask:0xf
    v_mov_b32_dpp v59, v43 row_ror:8 row_mask:0xf bank_mask:0xf
    s_cbranch_vccnz Gq_15_f2p1
    v_smfmac_f32_16x16x64_bf16 v[64:67], v[40:43], a[16:23], v19
    v_smfmac_f32_16x16x64_bf16 v[68:71], v[40:43], a[80:87], v19
    v_smfmac_f32_16x16x64_bf16 v[64:67], v[56:59], a[48:55], v19
    v_smfmac_f32_16x16x64_bf16 v[68:71], v[56:59], a[112:119], v19
    s_branch Gq_15_done
Gq_15_f312:
    buffer_load_dwordx4 v[44:47], v2, s[8:11], s40 offen offset:3072 sc1
    s_add_u32 s33, s33, 1
    s_cmp_gt_u32 s33, 0x100000
    s_cbranch_scc1 chain_kernel_abort
    s_branch Gq_15_s123
Gq_15_f12p3:
    buffer_load_dwordx4 v[36:39], v2, s[8:11], s40 offen offset:1024 sc1
    s_add_u32 s33, s33, 1
    s_cmp_gt_u32 s33, 0x100000
    s_cbranch_scc1 chain_kernel_abort
    s_branch Gq_15_s21
Gq_15_f2p1:
    buffer_load_dwordx4 v[40:43], v2, s[8:11], s40 offen offset:2048 sc1
    s_add_u32 s33, s33, 1
    s_cmp_gt_u32 s33, 0x100000
    s_cbranch_scc1 chain_kernel_abort
    s_branch Gq_15_s2
Gq_15_s13:
    s_waitcnt vmcnt(1)
    v_cmp_eq_u32 vcc, -1, v36
    v_mov_b32_dpp v52, v36 row_ror:8 row_mask:0xf bank_mask:0xf
    v_mov_b32_dpp v53, v37 row_ror:8 row_mask:0xf bank_mask:0xf
    v_mov_b32_dpp v54, v38 row_ror:8 row_mask:0xf bank_mask:0xf
    v_mov_b32_dpp v55, v39 row_ror:8 row_mask:0xf bank_mask:0xf
    s_cbranch_vccnz Gq_15_f13
    v_smfmac_f32_16x16x64_bf16 v[64:67], v[36:39], a[8:15], v19
    v_smfmac_f32_16x16x64_bf16 v[68:71], v[36:39], a[72:79], v19
Gq_15_s3p1:
    s_waitcnt vmcnt(0)
    v_cmp_eq_u32 vcc, -1, v44
    v_smfmac_f32_16x16x64_bf16 v[64:67], v[52:55], a[40:47], v19
    v_mov_b32_dpp v60, v44 row_ror:8 row_mask:0xf bank_mask:0xf
    v_mov_b32_dpp v61, v45 row_ror:8 row_mask:0xf bank_mask:0xf
    v_smfmac_f32_16x16x64_bf16 v[68:71], v[52:55], a[104:111], v19
    v_mov_b32_dpp v62, v46 row_ror:8 row_mask:0xf bank_mask:0xf
    v_mov_b32_dpp v63, v47 row_ror:8 row_mask:0xf bank_mask:0xf
    s_cbranch_vccnz Gq_15_f3p1
    v_smfmac_f32_16x16x64_bf16 v[64:67], v[44:47], a[24:31], v19
    v_smfmac_f32_16x16x64_bf16 v[68:71], v[44:47], a[88:95], v19
    v_smfmac_f32_16x16x64_bf16 v[64:67], v[60:63], a[56:63], v19
    v_smfmac_f32_16x16x64_bf16 v[68:71], v[60:63], a[120:127], v19
    s_branch Gq_15_done
Gq_15_f13:
    buffer_load_dwordx4 v[36:39], v2, s[8:11], s40 offen offset:1024 sc1
    s_add_u32 s33, s33, 1
    s_cmp_gt_u32 s33, 0x100000
    s_cbranch_scc1 chain_kernel_abort
    s_branch Gq_15_s31
Gq_15_f3p1:
    buffer_load_dwordx4 v[44:47], v2, s[8:11], s40 offen offset:3072 sc1
    s_add_u32 s33, s33, 1
    s_cmp_gt_u32 s33, 0x100000
    s_cbranch_scc1 chain_kernel_abort
    s_branch Gq_15_s3
Gq_15_s1:
    s_waitcnt vmcnt(0)
    v_cmp_eq_u32 vcc, -1, v36
    v_mov_b32_dpp v52, v36 row_ror:8 row_mask:0xf bank_mask:0xf
    v_mov_b32_dpp v53, v37 row_ror:8 row_mask:0xf bank_mask:0xf
    v_mov_b32_dpp v54, v38 row_ror:8 row_mask:0xf bank_mask:0xf
    v_mov_b32_dpp v55, v39 row_ror:8 row_mask:0xf bank_mask:0xf
    s_cbranch_vccnz Gq_15_f1
    v_smfmac_f32_16x16x64_bf16 v[64:67], v[36:39], a[8:15], v19
    v_smfmac_f32_16x16x64_bf16 v[68:71], v[36:39], a[72:79], v19
    v_smfmac_f32_16x16x64_bf16 v[64:67], v[52:55], a[40:47], v19
    v_smfmac_f32_16x16x64_bf16 v[68:71], v[52:55], a[104:111], v19
    s_branch Gq_15_done
Gq_15_f1:
    buffer_load_dwordx4 v[36:39], v2, s[8:11], s40 offen offset:1024 sc1
    s_add_u32 s33, s33, 1
    s_cmp_gt_u32 s33, 0x100000
    s_cbranch_scc1 chain_kernel_abort
    s_branch Gq_15_s1
Gq_15_s23:
    s_waitcnt vmcnt(1)
    v_cmp_eq_u32 vcc, -1, v40
    v_mov_b32_dpp v56, v40 row_ror:8 row_mask:0xf bank_mask:0xf
    v_mov_b32_dpp v57, v41 row_ror:8 row_mask:0xf bank_mask:0xf
    v_mov_b32_dpp v58, v42 row_ror:8 row_mask:0xf bank_mask:0xf
    v_mov_b32_dpp v59, v43 row_ror:8 row_mask:0xf bank_mask:0xf
    s_cbranch_vccnz Gq_15_f23
    v_smfmac_f32_16x16x64_bf16 v[64:67], v[40:43], a[16:23], v19
    v_smfmac_f32_16x16x64_bf16 v[68:71], v[40:43], a[80:87], v19
    s_branch Gq_15_s3p2
Gq_15_f23:
    buffer_load_dwordx4 v[40:43], v2, s[8:11], s40 offen offset:2048 sc1
    s_add_u32 s33, s33, 1
    s_cmp_gt_u32 s33, 0x100000
    s_cbranch_scc1 chain_kernel_abort
    s_branch Gq_15_s32
Gq_15_s2:
    s_waitcnt vmcnt(0)
    v_cmp_eq_u32 vcc, -1, v40
    v_mov_b32_dpp v56, v40 row_ror:8 row_mask:0xf bank_mask:0xf
    v_mov_b32_dpp v57, v41 row_ror:8 row_mask:0xf bank_mask:0xf
    v_mov_b32_dpp v58, v42 row_ror:8 row_mask:0xf bank_mask:0xf
    v_mov_b32_dpp v59, v43 row_ror:8 row_mask:0xf bank_mask:0xf
    s_cbranch_vccnz Gq_15_f2
    v_smfmac_f32_16x16x64_bf16 v[64:67], v[40:43], a[16:23], v19
    v_smfmac_f32_16x16x64_bf16 v[68:71], v[40:43], a[80:87], v19
    v_smfmac_f32_16x16x64_bf16 v[64:67], v[56:59], a[48:55], v19
    v_smfmac_f32_16x16x64_bf16 v[68:71], v[56:59], a[112:119], v19
    s_branch Gq_15_done
Gq_15_f2:
    buffer_load_dwordx4 v[40:43], v2, s[8:11], s40 offen offset:2048 sc1
    s_add_u32 s33, s33, 1
    s_cmp_gt_u32 s33, 0x100000
    s_cbranch_scc1 chain_kernel_abort
    s_branch Gq_15_s2
Gq_15_s3012:
    s_waitcnt vmcnt(3)
    v_cmp_eq_u32 vcc, -1, v44
    v_mov_b32_dpp v60, v44 row_ror:8 row_mask:0xf bank_mask:0xf
    v_mov_b32_dpp v61, v45 row_ror:8 row_mask:0xf bank_mask:0xf
    v_mov_b32_dpp v62, v46 row_ror:8 row_mask:0xf bank_mask:0xf
    v_mov_b32_dpp v63, v47 row_ror:8 row_mask:0xf bank_mask:0xf
    s_cbranch_vccnz Gq_15_f3012
    v_smfmac_f32_16x16x64_bf16 v[64:67], v[44:47], a[24:31], v19
    v_smfmac_f32_16x16x64_bf16 v[68:71], v[44:47], a[88:95], v19
Gq_15_s012p3:
    s_waitcnt vmcnt(2)
    v_cmp_eq_u32 vcc, -1, v32
    v_smfmac_f32_16x16x64_bf16 v[64:67], v[60:63], a[56:63], v19
    v_mov_b32_dpp v48, v32 row_ror:8 row_mask:0xf bank_mask:0xf
    v_mov_b32_dpp v49, v33 row_ror:8 row_mask:0xf bank_mask:0xf
    v_smfmac_f32_16x16x64_bf16 v[68:71], v[60:63], a[120:127], v19
    v_mov_b32_dpp v50, v34 row_ror:8 row_mask:0xf bank_mask:0xf
    v_mov_b32_dpp v51, v35 row_ror:8 row_mask:0xf bank_mask:0xf
    s_cbranch_vccnz Gq_15_f012p3
    v_smfmac_f32_16x16x64_bf16 v[64:67], v[32:35], a[0:7], v19
    v_smfmac_f32_16x16x64_bf16 v[68:71], v[32:35], a[64:71], v19
Gq_15_s12p0:
    s_waitcnt vmcnt(1)
    v_cmp_eq_u32 vcc, -1, v36
    v_smfmac_f32_16x16x64_bf16 v[64:67], v[48:51], a[32:39], v19
    v_mov_b32_dpp v52, v36 row_ror:8 row_mask:0xf bank_mask:0xf
    v_mov_b32_dpp v53, v37 row_ror:8 row_mask:0xf bank_mask:0xf
    v_smfmac_f32_16x16x64_bf16 v[68:71], v[48:51], a[96:103], v19
    v_mov_b32_dpp v54, v38 row_ror:8 row_mask:0xf bank_mask:0xf
    v_mov_b32_dpp v55, v39 row_ror:8 row_mask:0xf bank_mask:0xf
    s_cbranch_vccnz Gq_15_f12p0
    v_smfmac_f32_16x16x64_bf16 v[64:67], v[36:39], a[8:15], v19
    v_smfmac_f32_16x16x64_bf16 v[68:71], v[36:39], a[72:79], v19
    s_branch Gq_15_s2p1
Gq_15_f3012:
    buffer_load_dwordx4 v[44:47], v2, s[8:11], s40 offen offset:3072 sc1
    s_add_u32 s33, s33, 1
    s_cmp_gt_u32 s33, 0x100000
    s_cbranch_scc1 chain_kernel_abort
    s_branch Gq_15_s0123
Gq_15_f012p3:
    buffer_load_dwordx4 v[32:35], v2, s[8:11], s40 offen offset:0 sc1
    s_add_u32 s33, s33, 1
    s_cmp_gt_u32 s33, 0x100000
    s_cbranch_scc1 chain_kernel_abort
    s_branch Gq_15_s120
Gq_15_f12p0:
    buffer_load_dwordx4 v[36:39], v2, s[8:11], s40 offen offset:1024 sc1
    s_add_u32 s33, s33, 1
    s_cmp_gt_u32 s33, 0x100000
    s_cbranch_scc1 chain_kernel_abort
    s_branch Gq_15_s21
Gq_15_s013:
    s_waitcnt vmcnt(2)
    v_cmp_eq_u32 vcc, -1, v32
    v_mov_b32_dpp v48, v32 row_ror:8 row_mask:0xf bank_mask:0xf
    v_mov_b32_dpp v49, v33 row_ror:8 row_mask:0xf bank_mask:0xf
    v_mov_b32_dpp v50, v34 row_ror:8 row_mask:0xf bank_mask:0xf
    v_mov_b32_dpp v51, v35 row_ror:8 row_mask:0xf bank_mask:0xf
    s_cbranch_vccnz Gq_15_f013
    v_smfmac_f32_16x16x64_bf16 v[64:67], v[32:35], a[0:7], v19
    v_smfmac_f32_16x16x64_bf16 v[68:71], v[32:35], a[64:71], v19
Gq_15_s13p0:
    s_waitcnt vmcnt(1)
    v_cmp_eq_u32 vcc, -1, v36
    v_smfmac_f32_16x16x64_bf16 v[64:67], v[48:51], a[32:39], v19
    v_mov_b32_dpp v52, v36 row_ror:8 row_mask:0xf bank_mask:0xf
    v_mov_b32_dpp v53, v37 row_ror:8 row_mask:0xf bank_mask:0xf
    v_smfmac_f32_16x16x64_bf16 v[68:71], v[48:51], a[96:103], v19
    v_mov_b32_dpp v54, v38 row_ror:8 row_mask:0xf bank_mask:0xf
    v_mov_b32_dpp v55, v39 row_ror:8 row_mask:0xf bank_mask:0xf
    s_cbranch_vccnz Gq_15_f13p0
    v_smfmac_f32_16x16x64_bf16 v[64:67], v[36:39], a[8:15], v19
    v_smfmac_f32_16x16x64_bf16 v[68:71], v[36:39], a[72:79], v19
    s_branch Gq_15_s3p1
Gq_15_f013:
    buffer_load_dwordx4 v[32:35], v2, s[8:11], s40 offen offset:0 sc1
    s_add_u32 s33, s33, 1
    s_cmp_gt_u32 s33, 0x100000
    s_cbranch_scc1 chain_kernel_abort
    s_branch Gq_15_s130
Gq_15_f13p0:
    buffer_load_dwordx4 v[36:39], v2, s[8:11], s40 offen offset:1024 sc1
    s_add_u32 s33, s33, 1
    s_cmp_gt_u32 s33, 0x100000
    s_cbranch_scc1 chain_kernel_abort
    s_branch Gq_15_s31
Gq_15_s10:
    s_waitcnt vmcnt(1)
    v_cmp_eq_u32 vcc, -1, v36
    v_mov_b32_dpp v52, v36 row_ror:8 row_mask:0xf bank_mask:0xf
    v_mov_b32_dpp v53, v37 row_ror:8 row_mask:0xf bank_mask:0xf
    v_mov_b32_dpp v54, v38 row_ror:8 row_mask:0xf bank_mask:0xf
    v_mov_b32_dpp v55, v39 row_ror:8 row_mask:0xf bank_mask:0xf
    s_cbranch_vccnz Gq_15_f10
    v_smfmac_f32_16x16x64_bf16 v[64:67], v[36:39], a[8:15], v19
    v_smfmac_f32_16x16x64_bf16 v[68:71], v[36:39], a[72:79], v19
Gq_15_s0p1:
    s_waitcnt vmcnt(0)
    v_cmp_eq_u32 vcc, -1, v32
    v_smfmac_f32_16x16x64_bf16 v[64:67], v[52:55], a[40:47], v19
    v_mov_b32_dpp v48, v32 row_ror:8 row_mask:0xf bank_mask:0xf
    v_mov_b32_dpp v49, v33 row_ror:8 row_mask:0xf bank_mask:0xf
    v_smfmac_f32_16x16x64_bf16 v[68:71], v[52:55], a[104:111], v19
    v_mov_b32_dpp v50, v34 row_ror:8 row_mask:0xf bank_mask:0xf
    v_mov_b32_dpp v51, v35 row_ror:8 row_mask:0xf bank_mask:0xf
    s_cbranch_vccnz Gq_15_f0p1
    v_smfmac_f32_16x16x64_bf16 v[64:67], v[32:35], a[0:7], v19
    v_smfmac_f32_16x16x64_bf16 v[68:71], v[32:35], a[64:71], v19
    v_smfmac_f32_16x16x64_bf16 v[64:67], v[48:51], a[32:39], v19
    v_smfmac_f32_16x16x64_bf16 v[68:71], v[48:51], a[96:103], v19
    s_branch Gq_15_done
Gq_15_f10:
    buffer_load_dwordx4 v[36:39], v2, s[8:11], s40 offen offset:1024 sc1
    s_add_u32 s33, s33, 1
    s_cmp_gt_u32 s33, 0x100000
    s_cbranch_scc1 chain_kernel_abort
    s_branch Gq_15_s01
Gq_15_f0p1:
    buffer_load_dwordx4 v[32:35], v2, s[8:11], s40 offen offset:0 sc1
    s_add_u32 s33, s33, 1
    s_cmp_gt_u32 s33, 0x100000
    s_cbranch_scc1 chain_kernel_abort
    s_branch Gq_15_s0
Gq_15_s023:
    s_waitcnt vmcnt(2)
    v_cmp_eq_u32 vcc, -1, v32
    v_mov_b32_dpp v48, v32 row_ror:8 row_mask:0xf bank_mask:0xf
    v_mov_b32_dpp v49, v33 row_ror:8 row_mask:0xf bank_mask:0xf
    v_mov_b32_dpp v50, v34 row_ror:8 row_mask:0xf bank_mask:0xf
    v_mov_b32_dpp v51, v35 row_ror:8 row_mask:0xf bank_mask:0xf
    s_cbranch_vccnz Gq_15_f023
    v_smfmac_f32_16x16x64_bf16 v[64:67], v[32:35], a[0:7], v19
    v_smfmac_f32_16x16x64_bf16 v[68:71], v[32:35], a[64:71], v19
Gq_15_s23p0:
    s_waitcnt vmcnt(1)
    v_cmp_eq_u32 vcc, -1, v40
    v_smfmac_f32_16x16x64_bf16 v[64:67], v[48:51], a[32:39], v19
    v_mov_b32_dpp v56, v40 row_ror:8 row_mask:0xf bank_mask:0xf
    v_mov_b32_dpp v57, v41 row_ror:8 row_mask:0xf bank_mask:0xf
    v_smfmac_f32_16x16x64_bf16 v[68:71], v[48:51], a[96:103], v19
    v_mov_b32_dpp v58, v42 row_ror:8 row_mask:0xf bank_mask:0xf
    v_mov_b32_dpp v59, v43 row_ror:8 row_mask:0xf bank_mask:0xf
    s_cbranch_vccnz Gq_15_f23p0
    v_smfmac_f32_16x16x64_bf16 v[64:67], v[40:43], a[16:23], v19
    v_smfmac_f32_16x16x64_bf16 v[68:71], v[40:43], a[80:87], v19
    s_branch Gq_15_s3p2
Gq_15_f023:
    buffer_load_dwordx4 v[32:35], v2, s[8:11], s40 offen offset:0 sc1
    s_add_u32 s33, s33, 1
    s_cmp_gt_u32 s33, 0x100000
    s_cbranch_scc1 chain_kernel_abort
    s_branch Gq_15_s230
Gq_15_f23p0:
    buffer_load_dwordx4 v[40:43], v2, s[8:11], s40 offen offset:2048 sc1
    s_add_u32 s33, s33, 1
    s_cmp_gt_u32 s33, 0x100000
    s_cbranch_scc1 chain_kernel_abort
    s_branch Gq_15_s32
Gq_15_s20:
    s_waitcnt vmcnt(1)
    v_cmp_eq_u32 vcc, -1, v40
    v_mov_b32_dpp v56, v40 row_ror:8 row_mask:0xf bank_mask:0xf
    v_mov_b32_dpp v57, v41 row_ror:8 row_mask:0xf bank_mask:0xf
    v_mov_b32_dpp v58, v42 row_ror:8 row_mask:0xf bank_mask:0xf
    v_mov_b32_dpp v59, v43 row_ror:8 row_mask:0xf bank_mask:0xf
    s_cbranch_vccnz Gq_15_f20
    v_smfmac_f32_16x16x64_bf16 v[64:67], v[40:43], a[16:23], v19
    v_smfmac_f32_16x16x64_bf16 v[68:71], v[40:43], a[80:87], v19
Gq_15_s0p2:
    s_waitcnt vmcnt(0)
    v_cmp_eq_u32 vcc, -1, v32
    v_smfmac_f32_16x16x64_bf16 v[64:67], v[56:59], a[48:55], v19
    v_mov_b32_dpp v48, v32 row_ror:8 row_mask:0xf bank_mask:0xf
    v_mov_b32_dpp v49, v33 row_ror:8 row_mask:0xf bank_mask:0xf
    v_smfmac_f32_16x16x64_bf16 v[68:71], v[56:59], a[112:119], v19
    v_mov_b32_dpp v50, v34 row_ror:8 row_mask:0xf bank_mask:0xf
    v_mov_b32_dpp v51, v35 row_ror:8 row_mask:0xf bank_mask:0xf
    s_cbranch_vccnz Gq_15_f0p2
    v_smfmac_f32_16x16x64_bf16 v[64:67], v[32:35], a[0:7], v19
    v_smfmac_f32_16x16x64_bf16 v[68:71], v[32:35], a[64:71], v19
    v_smfmac_f32_16x16x64_bf16 v[64:67], v[48:51], a[32:39], v19
    v_smfmac_f32_16x16x64_bf16 v[68:71], v[48:51], a[96:103], v19
    s_branch Gq_15_done
Gq_15_f20:
    buffer_load_dwordx4 v[40:43], v2, s[8:11], s40 offen offset:2048 sc1
    s_add_u32 s33, s33, 1
    s_cmp_gt_u32 s33, 0x100000
    s_cbranch_scc1 chain_kernel_abort
    s_branch Gq_15_s02
Gq_15_f0p2:
    buffer_load_dwordx4 v[32:35], v2, s[8:11], s40 offen offset:0 sc1
    s_add_u32 s33, s33, 1
    s_cmp_gt_u32 s33, 0x100000
    s_cbranch_scc1 chain_kernel_abort
    s_branch Gq_15_s0
Gq_15_s30:
    s_waitcnt vmcnt(1)
    v_cmp_eq_u32 vcc, -1, v44
    v_mov_b32_dpp v60, v44 row_ror:8 row_mask:0xf bank_mask:0xf
    v_mov_b32_dpp v61, v45 row_ror:8 row_mask:0xf bank_mask:0xf
    v_mov_b32_dpp v62, v46 row_ror:8 row_mask:0xf bank_mask:0xf
    v_mov_b32_dpp v63, v47 row_ror:8 row_mask:0xf bank_mask:0xf
    s_cbranch_vccnz Gq_15_f30
    v_smfmac_f32_16x16x64_bf16 v[64:67], v[44:47], a[24:31], v19
    v_smfmac_f32_16x16x64_bf16 v[68:71], v[44:47], a[88:95], v19
    s_branch Gq_15_s0p3
Gq_15_f30:
    buffer_load_dwordx4 v[44:47], v2, s[8:11], s40 offen offset:3072 sc1
    s_add_u32 s33, s33, 1
    s_cmp_gt_u32 s33, 0x100000
    s_cbranch_scc1 chain_kernel_abort
    s_branch Gq_15_s03
Gq_15_s123:
    s_waitcnt vmcnt(2)
    v_cmp_eq_u32 vcc, -1, v36
    v_mov_b32_dpp v52, v36 row_ror:8 row_mask:0xf bank_mask:0xf
    v_mov_b32_dpp v53, v37 row_ror:8 row_mask:0xf bank_mask:0xf
    v_mov_b32_dpp v54, v38 row_ror:8 row_mask:0xf bank_mask:0xf
    v_mov_b32_dpp v55, v39 row_ror:8 row_mask:0xf bank_mask:0xf
    s_cbranch_vccnz Gq_15_f123
    v_smfmac_f32_16x16x64_bf16 v[64:67], v[36:39], a[8:15], v19
    v_smfmac_f32_16x16x64_bf16 v[68:71], v[36:39], a[72:79], v19
    s_branch Gq_15_s23p1
Gq_15_f123:
    buffer_load_dwordx4 v[36:39], v2, s[8:11], s40 offen offset:1024 sc1
    s_add_u32 s33, s33, 1
    s_cmp_gt_u32 s33, 0x100000
    s_cbranch_scc1 chain_kernel_abort
    s_branch Gq_15_s231
Gq_15_s21:
    s_waitcnt vmcnt(1)
    v_cmp_eq_u32 vcc, -1, v40
    v_mov_b32_dpp v56, v40 row_ror:8 row_mask:0xf bank_mask:0xf
    v_mov_b32_dpp v57, v41 row_ror:8 row_mask:0xf bank_mask:0xf
    v_mov_b32_dpp v58, v42 row_ror:8 row_mask:0xf bank_mask:0xf
    v_mov_b32_dpp v59, v43 row_ror:8 row_mask:0xf bank_mask:0xf
    s_cbranch_vccnz Gq_15_f21
    v_smfmac_f32_16x16x64_bf16 v[64:67], v[40:43], a[16:23], v19
    v_smfmac_f32_16x16x64_bf16 v[68:71], v[40:43], a[80:87], v19
Gq_15_s1p2:
    s_waitcnt vmcnt(0)
    v_cmp_eq_u32 vcc, -1, v36
    v_smfmac_f32_16x16x64_bf16 v[64:67], v[56:59], a[48:55], v19
    v_mov_b32_dpp v52, v36 row_ror:8 row_mask:0xf bank_mask:0xf
    v_mov_b32_dpp v53, v37 row_ror:8 row_mask:0xf bank_mask:0xf
    v_smfmac_f32_16x16x64_bf16 v[68:71], v[56:59], a[112:119], v19
    v_mov_b32_dpp v54, v38 row_ror:8 row_mask:0xf bank_mask:0xf
    v_mov_b32_dpp v55, v39 row_ror:8 row_mask:0xf bank_mask:0xf
    s_cbranch_vccnz Gq_15_f1p2
    v_smfmac_f32_16x16x64_bf16 v[64:67], v[36:39], a[8:15], v19
    v_smfmac_f32_16x16x64_bf16 v[68:71], v[36:39], a[72:79], v19
    v_smfmac_f32_16x16x64_bf16 v[64:67], v[52:55], a[40:47], v19
    v_smfmac_f32_16x16x64_bf16 v[68:71], v[52:55], a[104:111], v19
    s_branch Gq_15_done
Gq_15_f21:
    buffer_load_dwordx4 v[40:43], v2, s[8:11], s40 offen offset:2048 sc1
    s_add_u32 s33, s33, 1
    s_cmp_gt_u32 s33, 0x100000
    s_cbranch_scc1 chain_kernel_abort
    s_branch Gq_15_s12
Gq_15_f1p2:
    buffer_load_dwordx4 v[36:39], v2, s[8:11], s40 offen offset:1024 sc1
    s_add_u32 s33, s33, 1
    s_cmp_gt_u32 s33, 0x100000
    s_cbranch_scc1 chain_kernel_abort
    s_branch Gq_15_s1
Gq_15_s31:
    s_waitcnt vmcnt(1)
    v_cmp_eq_u32 vcc, -1, v44
    v_mov_b32_dpp v60, v44 row_ror:8 row_mask:0xf bank_mask:0xf
    v_mov_b32_dpp v61, v45 row_ror:8 row_mask:0xf bank_mask:0xf
    v_mov_b32_dpp v62, v46 row_ror:8 row_mask:0xf bank_mask:0xf
    v_mov_b32_dpp v63, v47 row_ror:8 row_mask:0xf bank_mask:0xf
    s_cbranch_vccnz Gq_15_f31
    v_smfmac_f32_16x16x64_bf16 v[64:67], v[44:47], a[24:31], v19
    v_smfmac_f32_16x16x64_bf16 v[68:71], v[44:47], a[88:95], v19
    s_branch Gq_15_s1p3
Gq_15_f31:
    buffer_load_dwordx4 v[44:47], v2, s[8:11], s40 offen offset:3072 sc1
    s_add_u32 s33, s33, 1
    s_cmp_gt_u32 s33, 0x100000
    s_cbranch_scc1 chain_kernel_abort
    s_branch Gq_15_s13
Gq_15_s120:
    s_waitcnt vmcnt(2)
    v_cmp_eq_u32 vcc, -1, v36
    v_mov_b32_dpp v52, v36 row_ror:8 row_mask:0xf bank_mask:0xf
    v_mov_b32_dpp v53, v37 row_ror:8 row_mask:0xf bank_mask:0xf
    v_mov_b32_dpp v54, v38 row_ror:8 row_mask:0xf bank_mask:0xf
    v_mov_b32_dpp v55, v39 row_ror:8 row_mask:0xf bank_mask:0xf
    s_cbranch_vccnz Gq_15_f120
    v_smfmac_f32_16x16x64_bf16 v[64:67], v[36:39], a[8:15], v19
    v_smfmac_f32_16x16x64_bf16 v[68:71], v[36:39], a[72:79], v19
Gq_15_s20p1:
    s_waitcnt vmcnt(1)
    v_cmp_eq_u32 vcc, -1, v40
    v_smfmac_f32_16x16x64_bf16 v[64:67], v[52:55], a[40:47], v19
    v_mov_b32_dpp v56, v40 row_ror:8 row_mask:0xf bank_mask:0xf
    v_mov_b32_dpp v57, v41 row_ror:8 row_mask:0xf bank_mask:0xf
    v_smfmac_f32_16x16x64_bf16 v[68:71], v[52:55], a[104:111], v19
    v_mov_b32_dpp v58, v42 row_ror:8 row_mask:0xf bank_mask:0xf
    v_mov_b32_dpp v59, v43 row_ror:8 row_mask:0xf bank_mask:0xf
    s_cbranch_vccnz Gq_15_f20p1
    v_smfmac_f32_16x16x64_bf16 v[64:67], v[40:43], a[16:23], v19
    v_smfmac_f32_16x16x64_bf16 v[68:71], v[40:43], a[80:87], v19
    s_branch Gq_15_s0p2
Gq_15_f120:
    buffer_load_dwordx4 v[36:39], v2, s[8:11], s40 offen offset:1024 sc1
    s_add_u32 s33, s33, 1
    s_cmp_gt_u32 s33, 0x100000
    s_cbranch_scc1 chain_kernel_abort
    s_branch Gq_15_s201
Gq_15_f20p1:
    buffer_load_dwordx4 v[40:43], v2, s[8:11], s40 offen offset:2048 sc1
    s_add_u32 s33, s33, 1
    s_cmp_gt_u32 s33, 0x100000
    s_cbranch_scc1 chain_kernel_abort
    s_branch Gq_15_s02
Gq_15_s130:
    s_waitcnt vmcnt(2)
    v_cmp_eq_u32 vcc, -1, v36
    v_mov_b32_dpp v52, v36 row_ror:8 row_mask:0xf bank_mask:0xf
    v_mov_b32_dpp v53, v37 row_ror:8 row_mask:0xf bank_mask:0xf
    v_mov_b32_dpp v54, v38 row_ror:8 row_mask:0xf bank_mask:0xf
    v_mov_b32_dpp v55, v39 row_ror:8 row_mask:0xf bank_mask:0xf
    s_cbranch_vccnz Gq_15_f130
    v_smfmac_f32_16x16x64_bf16 v[64:67], v[36:39], a[8:15], v19
    v_smfmac_f32_16x16x64_bf16 v[68:71], v[36:39], a[72:79], v19
Gq_15_s30p1:
    s_waitcnt vmcnt(1)
    v_cmp_eq_u32 vcc, -1, v44
    v_smfmac_f32_16x16x64_bf16 v[64:67], v[52:55], a[40:47], v19
    v_mov_b32_dpp v60, v44 row_ror:8 row_mask:0xf bank_mask:0xf
    v_mov_b32_dpp v61, v45 row_ror:8 row_mask:0xf bank_mask:0xf
    v_smfmac_f32_16x16x64_bf16 v[68:71], v[52:55], a[104:111], v19
    v_mov_b32_dpp v62, v46 row_ror:8 row_mask:0xf bank_mask:0xf
    v_mov_b32_dpp v63, v47 row_ror:8 row_mask:0xf bank_mask:0xf
    s_cbranch_vccnz Gq_15_f30p1
    v_smfmac_f32_16x16x64_bf16 v[64:67], v[44:47], a[24:31], v19
    v_smfmac_f32_16x16x64_bf16 v[68:71], v[44:47], a[88:95], v19
    s_branch Gq_15_s0p3
Gq_15_f130:
    buffer_load_dwordx4 v[36:39], v2, s[8:11], s40 offen offset:1024 sc1
    s_add_u32 s33, s33, 1
    s_cmp_gt_u32 s33, 0x100000
    s_cbranch_scc1 chain_kernel_abort
    s_branch Gq_15_s301
Gq_15_f30p1:
    buffer_load_dwordx4 v[44:47], v2, s[8:11], s40 offen offset:3072 sc1
    s_add_u32 s33, s33, 1
    s_cmp_gt_u32 s33, 0x100000
    s_cbranch_scc1 chain_kernel_abort
    s_branch Gq_15_s03
Gq_15_s01:
    s_waitcnt vmcnt(1)
    v_cmp_eq_u32 vcc, -1, v32
    v_mov_b32_dpp v48, v32 row_ror:8 row_mask:0xf bank_mask:0xf
    v_mov_b32_dpp v49, v33 row_ror:8 row_mask:0xf bank_mask:0xf
    v_mov_b32_dpp v50, v34 row_ror:8 row_mask:0xf bank_mask:0xf
    v_mov_b32_dpp v51, v35 row_ror:8 row_mask:0xf bank_mask:0xf
    s_cbranch_vccnz Gq_15_f01
    v_smfmac_f32_16x16x64_bf16 v[64:67], v[32:35], a[0:7], v19
    v_smfmac_f32_16x16x64_bf16 v[68:71], v[32:35], a[64:71], v19
    s_branch Gq_15_s1p0
Gq_15_f01:
    buffer_load_dwordx4 v[32:35], v2, s[8:11], s40 offen offset:0 sc1
    s_add_u32 s33, s33, 1
    s_cmp_gt_u32 s33, 0x100000
    s_cbranch_scc1 chain_kernel_abort
    s_branch Gq_15_s10
Gq_15_s230:
    s_waitcnt vmcnt(2)
    v_cmp_eq_u32 vcc, -1, v40
    v_mov_b32_dpp v56, v40 row_ror:8 row_mask:0xf bank_mask:0xf
    v_mov_b32_dpp v57, v41 row_ror:8 row_mask:0xf bank_mask:0xf
    v_mov_b32_dpp v58, v42 row_ror:8 row_mask:0xf bank_mask:0xf
    v_mov_b32_dpp v59, v43 row_ror:8 row_mask:0xf bank_mask:0xf
    s_cbranch_vccnz Gq_15_f230
    v_smfmac_f32_16x16x64_bf16 v[64:67], v[40:43], a[16:23], v19
    v_smfmac_f32_16x16x64_bf16 v[68:71], v[40:43], a[80:87], v19
    s_branch Gq_15_s30p2
Gq_15_f230:
    buffer_load_dwordx4 v[40:43], v2, s[8:11], s40 offen offset:2048 sc1
    s_add_u32 s33, s33, 1
    s_cmp_gt_u32 s33, 0x100000
    s_cbranch_scc1 chain_kernel_abort
    s_branch Gq_15_s302
Gq_15_s02:
    s_waitcnt vmcnt(1)
    v_cmp_eq_u32 vcc, -1, v32
    v_mov_b32_dpp v48, v32 row_ror:8 row_mask:0xf bank_mask:0xf
    v_mov_b32_dpp v49, v33 row_ror:8 row_mask:0xf bank_mask:0xf
    v_mov_b32_dpp v50, v34 row_ror:8 row_mask:0xf bank_mask:0xf
    v_mov_b32_dpp v51, v35 row_ror:8 row_mask:0xf bank_mask:0xf
    s_cbranch_vccnz Gq_15_f02
    v_smfmac_f32_16x16x64_bf16 v[64:67], v[32:35], a[0:7], v19
    v_smfmac_f32_16x16x64_bf16 v[68:71], v[32:35], a[64:71], v19
    s_branch Gq_15_s2p0
Gq_15_f02:
    buffer_load_dwordx4 v[32:35], v2, s[8:11], s40 offen offset:0 sc1
    s_add_u32 s33, s33, 1
    s_cmp_gt_u32 s33, 0x100000
    s_cbranch_scc1 chain_kernel_abort
    s_branch Gq_15_s20
Gq_15_s12:
    s_waitcnt vmcnt(1)
    v_cmp_eq_u32 vcc, -1, v36
    v_mov_b32_dpp v52, v36 row_ror:8 row_mask:0xf bank_mask:0xf
    v_mov_b32_dpp v53, v37 row_ror:8 row_mask:0xf bank_mask:0xf
    v_mov_b32_dpp v54, v38 row_ror:8 row_mask:0xf bank_mask:0xf
    v_mov_b32_dpp v55, v39 row_ror:8 row_mask:0xf bank_mask:0xf
    s_cbranch_vccnz Gq_15_f12
    v_smfmac_f32_16x16x64_bf16 v[64:67], v[36:39], a[8:15], v19
    v_smfmac_f32_16x16x64_bf16 v[68:71], v[36:39], a[72:79], v19
    s_branch Gq_15_s2p1
Gq_15_f12:
    buffer_load_dwordx4 v[36:39], v2, s[8:11], s40 offen offset:1024 sc1
    s_add_u32 s33, s33, 1
    s_cmp_gt_u32 s33, 0x100000
    s_cbranch_scc1 chain_kernel_abort
    s_branch Gq_15_s21
Gq_15_s201:
    s_waitcnt vmcnt(2)
    v_cmp_eq_u32 vcc, -1, v40
    v_mov_b32_dpp v56, v40 row_ror:8 row_mask:0xf bank_mask:0xf
    v_mov_b32_dpp v57, v41 row_ror:8 row_mask:0xf bank_mask:0xf
    v_mov_b32_dpp v58, v42 row_ror:8 row_mask:0xf bank_mask:0xf
    v_mov_b32_dpp v59, v43 row_ror:8 row_mask:0xf bank_mask:0xf
    s_cbranch_vccnz Gq_15_f201
    v_smfmac_f32_16x16x64_bf16 v[64:67], v[40:43], a[16:23], v19
    v_smfmac_f32_16x16x64_bf16 v[68:71], v[40:43], a[80:87], v19
Gq_15_s01p2:
    s_waitcnt vmcnt(1)
    v_cmp_eq_u32 vcc, -1, v32
    v_smfmac_f32_16x16x64_bf16 v[64:67], v[56:59], a[48:55], v19
    v_mov_b32_dpp v48, v32 row_ror:8 row_mask:0xf bank_mask:0xf
    v_mov_b32_dpp v49, v33 row_ror:8 row_mask:0xf bank_mask:0xf
    v_smfmac_f32_16x16x64_bf16 v[68:71], v[56:59], a[112:119], v19
    v_mov_b32_dpp v50, v34 row_ror:8 row_mask:0xf bank_mask:0xf
    v_mov_b32_dpp v51, v35 row_ror:8 row_mask:0xf bank_mask:0xf
    s_cbranch_vccnz Gq_15_f01p2
    v_smfmac_f32_16x16x64_bf16 v[64:67], v[32:35], a[0:7], v19
    v_smfmac_f32_16x16x64_bf16 v[68:71], v[32:35], a[64:71], v19
    s_branch Gq_15_s1p0
Gq_15_f201:
    buffer_load_dwordx4 v[40:43], v2, s[8:11], s40 offen offset:2048 sc1
    s_add_u32 s33, s33, 1
    s_cmp_gt_u32 s33, 0x100000
    s_cbranch_scc1 chain_kernel_abort
    s_branch Gq_15_s012
Gq_15_f01p2:
    buffer_load_dwordx4 v[32:35], v2, s[8:11], s40 offen offset:0 sc1
    s_add_u32 s33, s33, 1
    s_cmp_gt_u32 s33, 0x100000
    s_cbranch_scc1 chain_kernel_abort
    s_branch Gq_15_s10
Gq_15_s301:
    s_waitcnt vmcnt(2)
    v_cmp_eq_u32 vcc, -1, v44
    v_mov_b32_dpp v60, v44 row_ror:8 row_mask:0xf bank_mask:0xf
    v_mov_b32_dpp v61, v45 row_ror:8 row_mask:0xf bank_mask:0xf
    v_mov_b32_dpp v62, v46 row_ror:8 row_mask:0xf bank_mask:0xf
    v_mov_b32_dpp v63, v47 row_ror:8 row_mask:0xf bank_mask:0xf
    s_cbranch_vccnz Gq_15_f301
    v_smfmac_f32_16x16x64_bf16 v[64:67], v[44:47], a[24:31], v19
    v_smfmac_f32_16x16x64_bf16 v[68:71], v[44:47], a[88:95], v19
    s_branch Gq_15_s01p3
Gq_15_f301:
    buffer_load_dwordx4 v[44:47], v2, s[8:11], s40 offen offset:3072 sc1
    s_add_u32 s33, s33, 1
    s_cmp_gt_u32 s33, 0x100000
    s_cbranch_scc1 chain_kernel_abort
    s_branch Gq_15_s013
Gq_15_s012:
    s_waitcnt vmcnt(2)
    v_cmp_eq_u32 vcc, -1, v32
    v_mov_b32_dpp v48, v32 row_ror:8 row_mask:0xf bank_mask:0xf
    v_mov_b32_dpp v49, v33 row_ror:8 row_mask:0xf bank_mask:0xf
    v_mov_b32_dpp v50, v34 row_ror:8 row_mask:0xf bank_mask:0xf
    v_mov_b32_dpp v51, v35 row_ror:8 row_mask:0xf bank_mask:0xf
    s_cbranch_vccnz Gq_15_f012
    v_smfmac_f32_16x16x64_bf16 v[64:67], v[32:35], a[0:7], v19
    v_smfmac_f32_16x16x64_bf16 v[68:71], v[32:35], a[64:71], v19
    s_branch Gq_15_s12p0
Gq_15_f012:
    buffer_load_dwordx4 v[32:35], v2, s[8:11], s40 offen offset:0 sc1
    s_add_u32 s33, s33, 1
    s_cmp_gt_u32 s33, 0x100000
    s_cbranch_scc1 chain_kernel_abort
    s_branch Gq_15_s120
L_sd_16_0_0f:
    s_branch L_sd_16_1_0
L_sd_16_0_1f:
    s_branch L_sd_16_1_1
L_sd_16_0_2f:
    s_branch L_sd_16_1_2
L_sd_16_0_3f:
    s_branch L_sd_16_1_3
L_sd_16_1_0:
    s_waitcnt vmcnt(7)
    v_max3_u32 v20, v164, v165, v166
    v_mfma_f32_16x16x32_bf16 v[88:91], v[164:167], v[164:167], 0
    v_max_u32 v20, v20, v167
    v_cmp_eq_u32 vcc, -1, v20
    v_mfma_f32_16x16x32_bf16 v[84:87], v[120:123], v[164:167], 0
    v_mfma_f32_16x16x32_bf16 v[80:83], v[104:107], v[164:167], 0
    s_cbranch_vccnz L_sd_16_2_0
L_sd_16_1_1:
    s_waitcnt vmcnt(6)
    v_max3_u32 v20, v168, v169, v170
    v_mfma_f32_16x16x32_bf16 v[100:103], v[168:171], v[168:171], v[88:91]
    v_max_u32 v20, v20, v171
    v_cmp_eq_u32 vcc, -1, v20
    v_mfma_f32_16x16x32_bf16 v[96:99], v[124:127], v[168:171], v[84:87]
    v_mfma_f32_16x16x32_bf16 v[92:95], v[108:111], v[168:171], v[80:83]
    s_cbranch_vccnz L_sd_16_2_1
L_sd_16_1_2:
    s_waitcnt vmcnt(5)
    v_max3_u32 v20, v172, v173, v174
    v_mfma_f32_16x16x32_bf16 v[228:231], v[172:175], v[172:175], v[100:103]
    v_max_u32 v20, v20, v175
    v_cmp_eq_u32 vcc, -1, v20
    v_mfma_f32_16x16x32_bf16 v[224:227], v[128:131], v[172:175], v[96:99]
    v_mfma_f32_16x16x32_bf16 v[220:223], v[112:115], v[172:175], v[92:95]
    s_cbranch_vccnz L_sd_16_2_2
L_sd_16_1_3:
    s_waitcnt vmcnt(4)
    v_max3_u32 v20, v176, v177, v178
    v_mfma_f32_16x16x32_bf16 v[188:191], v[176:179], v[176:179], v[228:231]
    v_max_u32 v20, v20, v179
    v_cmp_eq_u32 vcc, -1, v20
    v_mfma_f32_16x16x32_bf16 v[184:187], v[132:135], v[176:179], v[224:227]
    v_mfma_f32_16x16x32_bf16 v[180:183], v[116:119], v[176:179], v[220:223]
    v_mov_b32_dpp v188, v189 row_ror:8 row_mask:0xf bank_mask:0xc
    v_mov_b32_dpp v190, v191 row_ror:8 row_mask:0xf bank_mask:0xc
    s_cbranch_vccnz L_sd_16_2_3
    s_branch L_sd_16
L_sd_16_1_0f:
    s_branch L_sd_16_2_0
L_sd_16_1_1f:
    s_branch L_sd_16_2_1
L_sd_16_1_2f:
    s_branch L_sd_16_2_2
L_sd_16_1_3f:
    s_branch L_sd_16_2_3
L_sd_16_2_0:
    s_waitcnt vmcnt(3)
    v_max3_u32 v20, v32, v33, v34
    v_mfma_f32_16x16x32_bf16 v[88:91], v[32:35], v[32:35], 0
    v_max_u32 v20, v20, v35
    v_cmp_eq_u32 vcc, -1, v20
    v_mfma_f32_16x16x32_bf16 v[84:87], v[120:123], v[32:35], 0
    v_mfma_f32_16x16x32_bf16 v[80:83], v[104:107], v[32:35], 0
    s_cbranch_vccnz L_sd_16_2_0f
L_sd_16_2_1:
    s_waitcnt vmcnt(2)
    v_max3_u32 v20, v36, v37, v38
    v_mfma_f32_16x16x32_bf16 v[100:103], v[36:39], v[36:39], v[88:91]
    v_max_u32 v20, v20, v39
    v_cmp_eq_u32 vcc, -1, v20
    v_mfma_f32_16x16x32_bf16 v[96:99], v[124:127], v[36:39], v[84:87]
    v_mfma_f32_16x16x32_bf16 v[92:95], v[108:111], v[36:39], v[80:83]
    s_cbranch_vccnz L_sd_16_2_1f
L_sd_16_2_2:
    s_waitcnt vmcnt(1)
    v_max3_u32 v20, v40, v41, v42
    v_mfma_f32_16x16x32_bf16 v[228:231], v[40:43], v[40:43], v[100:103]
    v_max_u32 v20, v20, v43
    v_cmp_eq_u32 vcc, -1, v20
    v_mfma_f32_16x16x32_bf16 v[224:227], v[128:131], v[40:43], v[96:99]
    v_mfma_f32_16x16x32_bf16 v[220:223], v[112:115], v[40:43], v[92:95]
    s_cbranch_vccnz L_sd_16_2_2f
L_sd_16_2_3:
    s_waitcnt vmcnt(0)
    v_max3_u32 v20, v44, v45, v46
    v_mfma_f32_16x16x32_bf16 v[188:191], v[44:47], v[44:47], v[228:231]
    v_max_u32 v20, v20, v47
    v_cmp_eq_u32 vcc, -1, v20
    v_mfma_f32_16x16x32_bf16 v[184:187], v[132:135], v[44:47], v[224:227]
    v_mfma_f32_16x16x32_bf16 v[180:183], v[116:119], v[44:47], v[220:223]
    v_mov_b32_dpp v188, v189 row_ror:8 row_mask:0xf bank_mask:0xc
    v_mov_b32_dpp v190, v191 row_ror:8 row_mask:0xf bank_mask:0xc
    s_cbranch_vccnz L_sd_16_2_3f
    s_branch L_sd_16
L_sd_16_2_0f:
    buffer_load_dwordx4 v[148:151], v5, s[8:11], s40 offen offset:0 sc1
    buffer_load_dwordx4 v[152:155], v5, s[8:11], s40 offen offset:1024 sc1
    buffer_load_dwordx4 v[156:159], v5, s[8:11], s40 offen offset:2048 sc1
    buffer_load_dwordx4 v[160:163], v5, s[8:11], s40 offen offset:3072 sc1
    s_add_u32 s33, s33, 1
    s_cmp_gt_u32 s33, 0x100000
    s_cbranch_scc1 chain_kernel_abort
    s_branch L_sd_16_3_0
L_sd_16_2_1f:
    buffer_load_dwordx4 v[152:155], v5, s[8:11], s40 offen offset:1024 sc1
    buffer_load_dwordx4 v[156:159], v5, s[8:11], s40 offen offset:2048 sc1
    buffer_load_dwordx4 v[160:163], v5, s[8:11], s40 offen offset:3072 sc1
    s_add_u32 s33, s33, 1
    s_cmp_gt_u32 s33, 0x100000
    s_cbranch_scc1 chain_kernel_abort
    s_branch L_sd_16_3_1
L_sd_16_2_2f:
    buffer_load_dwordx4 v[156:159], v5, s[8:11], s40 offen offset:2048 sc1
    buffer_load_dwordx4 v[160:163], v5, s[8:11], s40 offen offset:3072 sc1
    s_add_u32 s33, s33, 1
    s_cmp_gt_u32 s33, 0x100000
    s_cbranch_scc1 chain_kernel_abort
    s_branch L_sd_16_3_2
L_sd_16_2_3f:
    buffer_load_dwordx4 v[160:163], v5, s[8:11], s40 offen offset:3072 sc1
    s_add_u32 s33, s33, 1
    s_cmp_gt_u32 s33, 0x100000
    s_cbranch_scc1 chain_kernel_abort
    s_branch L_sd_16_3_3
L_sd_16_3_0:
    s_waitcnt vmcnt(3)
    v_max3_u32 v20, v148, v149, v150
    v_mfma_f32_16x16x32_bf16 v[88:91], v[148:151], v[148:151], 0
    v_max_u32 v20, v20, v151
    v_cmp_eq_u32 vcc, -1, v20
    v_mfma_f32_16x16x32_bf16 v[84:87], v[120:123], v[148:151], 0
    v_mfma_f32_16x16x32_bf16 v[80:83], v[104:107], v[148:151], 0
    s_cbranch_vccnz L_sd_16_3_0f
L_sd_16_3_1:
    s_waitcnt vmcnt(2)
    v_max3_u32 v20, v152, v153, v154
    v_mfma_f32_16x16x32_bf16 v[100:103], v[152:155], v[152:155], v[88:91]
    v_max_u32 v20, v20, v155
    v_cmp_eq_u32 vcc, -1, v20
    v_mfma_f32_16x16x32_bf16 v[96:99], v[124:127], v[152:155], v[84:87]
    v_mfma_f32_16x16x32_bf16 v[92:95], v[108:111], v[152:155], v[80:83]
    s_cbranch_vccnz L_sd_16_3_1f
L_sd_16_3_2:
    s_waitcnt vmcnt(1)
    v_max3_u32 v20, v156, v157, v158
    v_mfma_f32_16x16x32_bf16 v[228:231], v[156:159], v[156:159], v[100:103]
    v_max_u32 v20, v20, v159
    v_cmp_eq_u32 vcc, -1, v20
    v_mfma_f32_16x16x32_bf16 v[224:227], v[128:131], v[156:159], v[96:99]
    v_mfma_f32_16x16x32_bf16 v[220:223], v[112:115], v[156:159], v[92:95]
    s_cbranch_vccnz L_sd_16_3_2f
L_sd_16_3_3:
    s_waitcnt vmcnt(0)
    v_max3_u32 v20, v160, v161, v162
    v_mfma_f32_16x16x32_bf16 v[188:191], v[160:163], v[160:163], v[228:231]
    v_max_u32 v20, v20, v163
    v_cmp_eq_u32 vcc, -1, v20
    v_mfma_f32_16x16x32_bf16 v[184:187], v[132:135], v[160:163], v[224:227]
    v_mfma_f32_16x16x32_bf16 v[180:183], v[116:119], v[160:163], v[220:223]
    v_mov_b32_dpp v188, v189 row_ror:8 row_mask:0xf bank_mask:0xc
    v_mov_b32_dpp v190, v191 row_ror:8 row_mask:0xf bank_mask:0xc
    s_cbranch_vccnz L_sd_16_3_3f
    s_branch L_sd_16
L_sd_16_3_0f:
    buffer_load_dwordx4 v[148:151], v5, s[8:11], s40 offen offset:0 sc1
    buffer_load_dwordx4 v[152:155], v5, s[8:11], s40 offen offset:1024 sc1
    buffer_load_dwordx4 v[156:159], v5, s[8:11], s40 offen offset:2048 sc1
    buffer_load_dwordx4 v[160:163], v5, s[8:11], s40 offen offset:3072 sc1
    s_add_u32 s33, s33, 1
    s_cmp_gt_u32 s33, 0x100000
    s_cbranch_scc1 chain_kernel_abort
    s_branch L_sd_16_3_0
L_sd_16_3_1f:
    buffer_load_dwordx4 v[152:155], v5, s[8:11], s40 offen offset:1024 sc1
    buffer_load_dwordx4 v[156:159], v5, s[8:11], s40 offen offset:2048 sc1
    buffer_load_dwordx4 v[160:163], v5, s[8:11], s40 offen offset:3072 sc1
    s_add_u32 s33, s33, 1
    s_cmp_gt_u32 s33, 0x100000
    s_cbranch_scc1 chain_kernel_abort
    s_branch L_sd_16_3_1
L_sd_16_3_2f:
    buffer_load_dwordx4 v[156:159], v5, s[8:11], s40 offen offset:2048 sc1
    buffer_load_dwordx4 v[160:163], v5, s[8:11], s40 offen offset:3072 sc1
    s_add_u32 s33, s33, 1
    s_cmp_gt_u32 s33, 0x100000
    s_cbranch_scc1 chain_kernel_abort
    s_branch L_sd_16_3_2
L_sd_16_3_3f:
    buffer_load_dwordx4 v[160:163], v5, s[8:11], s40 offen offset:3072 sc1
    s_add_u32 s33, s33, 1
    s_cmp_gt_u32 s33, 0x100000
    s_cbranch_scc1 chain_kernel_abort
    s_branch L_sd_16_3_3
Go_17_f0123:
    buffer_load_dwordx4 v[32:35], v3, s[8:11], s40 offen offset:0 sc1
    s_branch Go_17_s1230
Go_17_f123:
    buffer_load_dwordx4 v[36:39], v3, s[8:11], s40 offen offset:1024 sc1
    s_add_u32 s33, s33, 1
    s_cmp_gt_u32 s33, 0x100000
    s_cbranch_scc1 chain_kernel_abort
    s_branch Go_17_s231
Go_17_f23:
    buffer_load_dwordx4 v[40:43], v3, s[8:11], s40 offen offset:2048 sc1
    s_add_u32 s33, s33, 1
    s_cmp_gt_u32 s33, 0x100000
    s_cbranch_scc1 chain_kernel_abort
    s_branch Go_17_s32
Go_17_f3:
    buffer_load_dwordx4 v[44:47], v3, s[8:11], s40 offen offset:3072 sc1
    s_add_u32 s33, s33, 1
    s_cmp_gt_u32 s33, 0x100000
    s_cbranch_scc1 chain_kernel_abort
    s_branch Go_17_s3
Go_17_redo:
    buffer_load_dwordx4 v[32:35], v3, s[8:11], s40 offen offset:0 sc1
    buffer_load_dwordx4 v[36:39], v3, s[8:11], s40 offen offset:1024 sc1
    buffer_load_dwordx4 v[40:43], v3, s[8:11], s40 offen offset:2048 sc1
    buffer_load_dwordx4 v[44:47], v3, s[8:11], s40 offen offset:3072 sc1
    s_add_u32 s33, s33, 1
    s_cmp_gt_u32 s33, 0x100000
    s_cbranch_scc1 chain_kernel_abort
    s_nop 5
    v_mov_b32 v76, 0
    v_mov_b32 v77, 0
    v_mov_b32 v78, 0
    v_mov_b32 v79, 0
    s_branch Go_17_s0123
Go_17_s1230:
    s_waitcnt vmcnt(3)
    v_cmp_eq_u32 vcc, -1, v36
    v_mov_b32_dpp v52, v36 row_ror:8 row_mask:0xf bank_mask:0xf
    v_mov_b32_dpp v53, v37 row_ror:8 row_mask:0xf bank_mask:0xf
    v_mov_b32_dpp v54, v38 row_ror:8 row_mask:0xf bank_mask:0xf
    v_mov_b32_dpp v55, v39 row_ror:8 row_mask:0xf bank_mask:0xf
    s_cbranch_vccnz Go_17_f1230
    v_smfmac_f32_16x16x64_bf16 v[76:79], v[36:39], a[200:207], v19
    v_smfmac_f32_16x16x64_bf16 v[76:79], v[52:55], a[232:239], v19
Go_17_s230:
    s_waitcnt vmcnt(2)
    v_cmp_eq_u32 vcc, -1, v40
    v_mov_b32_dpp v56, v40 row_ror:8 row_mask:0xf bank_mask:0xf
    v_mov_b32_dpp v57, v41 row_ror:8 row_mask:0xf bank_mask:0xf
    v_mov_b32_dpp v58, v42 row_ror:8 row_mask:0xf bank_mask:0xf
    v_mov_b32_dpp v59, v43 row_ror:8 row_mask:0xf bank_mask:0xf
    s_cbranch_vccnz Go_17_f230
    v_smfmac_f32_16x16x64_bf16 v[76:79], v[40:43], a[208:215], v19
    v_smfmac_f32_16x16x64_bf16 v[76:79], v[56:59], a[240:247], v19
Go_17_s30:
    s_waitcnt vmcnt(1)
    v_cmp_eq_u32 vcc, -1, v44
    v_mov_b32_dpp v60, v44 row_ror:8 row_mask:0xf bank_mask:0xf
    v_mov_b32_dpp v61, v45 row_ror:8 row_mask:0xf bank_mask:0xf
    v_mov_b32_dpp v62, v46 row_ror:8 row_mask:0xf bank_mask:0xf
    v_mov_b32_dpp v63, v47 row_ror:8 row_mask:0xf bank_mask:0xf
    s_cbranch_vccnz Go_17_f30
    v_smfmac_f32_16x16x64_bf16 v[76:79], v[44:47], a[216:223], v19
    v_smfmac_f32_16x16x64_bf16 v[76:79], v[60:63], a[248:255], v19
Go_17_s0:
    s_waitcnt vmcnt(0)
    v_cmp_eq_u32 vcc, -1, v32
    v_mov_b32_dpp v48, v32 row_ror:8 row_mask:0xf bank_mask:0xf
    v_mov_b32_dpp v49, v33 row_ror:8 row_mask:0xf bank_mask:0xf
    v_mov_b32_dpp v50, v34 row_ror:8 row_mask:0xf bank_mask:0xf
    v_mov_b32_dpp v51, v35 row_ror:8 row_mask:0xf bank_mask:0xf
    s_cbranch_vccnz Go_17_f0
    v_smfmac_f32_16x16x64_bf16 v[76:79], v[32:35], a[192:199], v19
    v_smfmac_f32_16x16x64_bf16 v[76:79], v[48:51], a[224:231], v19
    s_branch Go_17_done
Go_17_f1230:
    buffer_load_dwordx4 v[36:39], v3, s[8:11], s40 offen offset:1024 sc1
    s_add_u32 s33, s33, 1
    s_cmp_gt_u32 s33, 0x100000
    s_cbranch_scc1 chain_kernel_abort
    s_branch Go_17_s2301
Go_17_f230:
    buffer_load_dwordx4 v[40:43], v3, s[8:11], s40 offen offset:2048 sc1
    s_add_u32 s33, s33, 1
    s_cmp_gt_u32 s33, 0x100000
    s_cbranch_scc1 chain_kernel_abort
    s_branch Go_17_s302
Go_17_f30:
    buffer_load_dwordx4 v[44:47], v3, s[8:11], s40 offen offset:3072 sc1
    s_add_u32 s33, s33, 1
    s_cmp_gt_u32 s33, 0x100000
    s_cbranch_scc1 chain_kernel_abort
    s_branch Go_17_s03
Go_17_f0:
    buffer_load_dwordx4 v[32:35], v3, s[8:11], s40 offen offset:0 sc1
    s_add_u32 s33, s33, 1
    s_cmp_gt_u32 s33, 0x100000
    s_cbranch_scc1 chain_kernel_abort
    s_branch Go_17_s0
Go_17_s231:
    s_waitcnt vmcnt(2)
    v_cmp_eq_u32 vcc, -1, v40
    v_mov_b32_dpp v56, v40 row_ror:8 row_mask:0xf bank_mask:0xf
    v_mov_b32_dpp v57, v41 row_ror:8 row_mask:0xf bank_mask:0xf
    v_mov_b32_dpp v58, v42 row_ror:8 row_mask:0xf bank_mask:0xf
    v_mov_b32_dpp v59, v43 row_ror:8 row_mask:0xf bank_mask:0xf
    s_cbranch_vccnz Go_17_f231
    v_smfmac_f32_16x16x64_bf16 v[76:79], v[40:43], a[208:215], v19
    v_smfmac_f32_16x16x64_bf16 v[76:79], v[56:59], a[240:247], v19
Go_17_s31:
    s_waitcnt vmcnt(1)
    v_cmp_eq_u32 vcc, -1, v44
    v_mov_b32_dpp v60, v44 row_ror:8 row_mask:0xf bank_mask:0xf
    v_mov_b32_dpp v61, v45 row_ror:8 row_mask:0xf bank_mask:0xf
    v_mov_b32_dpp v62, v46 row_ror:8 row_mask:0xf bank_mask:0xf
    v_mov_b32_dpp v63, v47 row_ror:8 row_mask:0xf bank_mask:0xf
    s_cbranch_vccnz Go_17_f31
    v_smfmac_f32_16x16x64_bf16 v[76:79], v[44:47], a[216:223], v19
    v_smfmac_f32_16x16x64_bf16 v[76:79], v[60:63], a[248:255], v19
Go_17_s1:
    s_waitcnt vmcnt(0)
    v_cmp_eq_u32 vcc, -1, v36
    v_mov_b32_dpp v52, v36 row_ror:8 row_mask:0xf bank_mask:0xf
    v_mov_b32_dpp v53, v37 row_ror:8 row_mask:0xf bank_mask:0xf
    v_mov_b32_dpp v54, v38 row_ror:8 row_mask:0xf bank_mask:0xf
    v_mov_b32_dpp v55, v39 row_ror:8 row_mask:0xf bank_mask:0xf
    s_cbranch_vccnz Go_17_f1
    v_smfmac_f32_16x16x64_bf16 v[76:79], v[36:39], a[200:207], v19
    v_smfmac_f32_16x16x64_bf16 v[76:79], v[52:55], a[232:239], v19
    s_branch Go_17_done
Go_17_f231:
    buffer_load_dwordx4 v[40:43], v3, s[8:11], s40 offen offset:2048 sc1
    s_add_u32 s33, s33, 1
    s_cmp_gt_u32 s33, 0x100000
    s_cbranch_scc1 chain_kernel_abort
    s_branch Go_17_s312
Go_17_f31:
    buffer_load_dwordx4 v[44:47], v3, s[8:11], s40 offen offset:3072 sc1
    s_add_u32 s33, s33, 1
    s_cmp_gt_u32 s33, 0x100000
    s_cbranch_scc1 chain_kernel_abort
    s_branch Go_17_s13
Go_17_f1:
    buffer_load_dwordx4 v[36:39], v3, s[8:11], s40 offen offset:1024 sc1
    s_add_u32 s33, s33, 1
    s_cmp_gt_u32 s33, 0x100000
    s_cbranch_scc1 chain_kernel_abort
    s_branch Go_17_s1
Go_17_s32:
    s_waitcnt vmcnt(1)
    v_cmp_eq_u32 vcc, -1, v44
    v_mov_b32_dpp v60, v44 row_ror:8 row_mask:0xf bank_mask:0xf
    v_mov_b32_dpp v61, v45 row_ror:8 row_mask:0xf bank_mask:0xf
    v_mov_b32_dpp v62, v46 row_ror:8 row_mask:0xf bank_mask:0xf
    v_mov_b32_dpp v63, v47 row_ror:8 row_mask:0xf bank_mask:0xf
    s_cbranch_vccnz Go_17_f32
    v_smfmac_f32_16x16x64_bf16 v[76:79], v[44:47], a[216:223], v19
    v_smfmac_f32_16x16x64_bf16 v[76:79], v[60:63], a[248:255], v19
Go_17_s2:
    s_waitcnt vmcnt(0)
    v_cmp_eq_u32 vcc, -1, v40
    v_mov_b32_dpp v56, v40 row_ror:8 row_mask:0xf bank_mask:0xf
    v_mov_b32_dpp v57, v41 row_ror:8 row_mask:0xf bank_mask:0xf
    v_mov_b32_dpp v58, v42 row_ror:8 row_mask:0xf bank_mask:0xf
    v_mov_b32_dpp v59, v43 row_ror:8 row_mask:0xf bank_mask:0xf
    s_cbranch_vccnz Go_17_f2
    v_smfmac_f32_16x16x64_bf16 v[76:79], v[40:43], a[208:215], v19
    v_smfmac_f32_16x16x64_bf16 v[76:79], v[56:59], a[240:247], v19
    s_branch Go_17_done
Go_17_f32:
    buffer_load_dwordx4 v[44:47], v3, s[8:11], s40 offen offset:3072 sc1
    s_add_u32 s33, s33, 1
    s_cmp_gt_u32 s33, 0x100000
    s_cbranch_scc1 chain_kernel_abort
    s_branch Go_17_s23
Go_17_f2:
    buffer_load_dwordx4 v[40:43], v3, s[8:11], s40 offen offset:2048 sc1
    s_add_u32 s33, s33, 1
    s_cmp_gt_u32 s33, 0x100000
    s_cbranch_scc1 chain_kernel_abort
    s_branch Go_17_s2
Go_17_s2301:
    s_waitcnt vmcnt(3)
    v_cmp_eq_u32 vcc, -1, v40
    v_mov_b32_dpp v56, v40 row_ror:8 row_mask:0xf bank_mask:0xf
    v_mov_b32_dpp v57, v41 row_ror:8 row_mask:0xf bank_mask:0xf
    v_mov_b32_dpp v58, v42 row_ror:8 row_mask:0xf bank_mask:0xf
    v_mov_b32_dpp v59, v43 row_ror:8 row_mask:0xf bank_mask:0xf
    s_cbranch_vccnz Go_17_f2301
    v_smfmac_f32_16x16x64_bf16 v[76:79], v[40:43], a[208:215], v19
    v_smfmac_f32_16x16x64_bf16 v[76:79], v[56:59], a[240:247], v19
Go_17_s301:
    s_waitcnt vmcnt(2)
    v_cmp_eq_u32 vcc, -1, v44
    v_mov_b32_dpp v60, v44 row_ror:8 row_mask:0xf bank_mask:0xf
    v_mov_b32_dpp v61, v45 row_ror:8 row_mask:0xf bank_mask:0xf
    v_mov_b32_dpp v62, v46 row_ror:8 row_mask:0xf bank_mask:0xf
    v_mov_b32_dpp v63, v47 row_ror:8 row_mask:0xf bank_mask:0xf
    s_cbranch_vccnz Go_17_f301
    v_smfmac_f32_16x16x64_bf16 v[76:79], v[44:47], a[216:223], v19
    v_smfmac_f32_16x16x64_bf16 v[76:79], v[60:63], a[248:255], v19
Go_17_s01:
    s_waitcnt vmcnt(1)
    v_cmp_eq_u32 vcc, -1, v32
    v_mov_b32_dpp v48, v32 row_ror:8 row_mask:0xf bank_mask:0xf
    v_mov_b32_dpp v49, v33 row_ror:8 row_mask:0xf bank_mask:0xf
    v_mov_b32_dpp v50, v34 row_ror:8 row_mask:0xf bank_mask:0xf
    v_mov_b32_dpp v51, v35 row_ror:8 row_mask:0xf bank_mask:0xf
    s_cbranch_vccnz Go_17_f01
    v_smfmac_f32_16x16x64_bf16 v[76:79], v[32:35], a[192:199], v19
    v_smfmac_f32_16x16x64_bf16 v[76:79], v[48:51], a[224:231], v19
    s_branch Go_17_s1
Go_17_f2301:
    buffer_load_dwordx4 v[40:43], v3, s[8:11], s40 offen offset:2048 sc1
    s_add_u32 s33, s33, 1
    s_cmp_gt_u32 s33, 0x100000
    s_cbranch_scc1 chain_kernel_abort
    s_branch Go_17_s3012
Go_17_f301:
    buffer_load_dwordx4 v[44:47], v3, s[8:11], s40 offen offset:3072 sc1
    s_add_u32 s33, s33, 1
    s_cmp_gt_u32 s33, 0x100000
    s_cbranch_scc1 chain_kernel_abort
    s_branch Go_17_s013
Go_17_f01:
    buffer_load_dwordx4 v[32:35], v3, s[8:11], s40 offen offset:0 sc1
    s_add_u32 s33, s33, 1
    s_cmp_gt_u32 s33, 0x100000
    s_cbranch_scc1 chain_kernel_abort
    s_branch Go_17_s10
Go_17_s302:
    s_waitcnt vmcnt(2)
    v_cmp_eq_u32 vcc, -1, v44
    v_mov_b32_dpp v60, v44 row_ror:8 row_mask:0xf bank_mask:0xf
    v_mov_b32_dpp v61, v45 row_ror:8 row_mask:0xf bank_mask:0xf
    v_mov_b32_dpp v62, v46 row_ror:8 row_mask:0xf bank_mask:0xf
    v_mov_b32_dpp v63, v47 row_ror:8 row_mask:0xf bank_mask:0xf
    s_cbranch_vccnz Go_17_f302
    v_smfmac_f32_16x16x64_bf16 v[76:79], v[44:47], a[216:223], v19
    v_smfmac_f32_16x16x64_bf16 v[76:79], v[60:63], a[248:255], v19
Go_17_s02:
    s_waitcnt vmcnt(1)
    v_cmp_eq_u32 vcc, -1, v32
    v_mov_b32_dpp v48, v32 row_ror:8 row_mask:0xf bank_mask:0xf
    v_mov_b32_dpp v49, v33 row_ror:8 row_mask:0xf bank_mask:0xf
    v_mov_b32_dpp v50, v34 row_ror:8 row_mask:0xf bank_mask:0xf
    v_mov_b32_dpp v51, v35 row_ror:8 row_mask:0xf bank_mask:0xf
    s_cbranch_vccnz Go_17_f02
    v_smfmac_f32_16x16x64_bf16 v[76:79], v[32:35], a[192:199], v19
    v_smfmac_f32_16x16x64_bf16 v[76:79], v[48:51], a[224:231], v19
    s_branch Go_17_s2
Go_17_f302:
    buffer_load_dwordx4 v[44:47], v3, s[8:11], s40 offen offset:3072 sc1
    s_add_u32 s33, s33, 1
    s_cmp_gt_u32 s33, 0x100000
    s_cbranch_scc1 chain_kernel_abort
    s_branch Go_17_s023
Go_17_f02:
    buffer_load_dwordx4 v[32:35], v3, s[8:11], s40 offen offset:0 sc1
    s_add_u32 s33, s33, 1
    s_cmp_gt_u32 s33, 0x100000
    s_cbranch_scc1 chain_kernel_abort
    s_branch Go_17_s20
Go_17_s03:
    s_waitcnt vmcnt(1)
    v_cmp_eq_u32 vcc, -1, v32
    v_mov_b32_dpp v48, v32 row_ror:8 row_mask:0xf bank_mask:0xf
    v_mov_b32_dpp v49, v33 row_ror:8 row_mask:0xf bank_mask:0xf
    v_mov_b32_dpp v50, v34 row_ror:8 row_mask:0xf bank_mask:0xf
    v_mov_b32_dpp v51, v35 row_ror:8 row_mask:0xf bank_mask:0xf
    s_cbranch_vccnz Go_17_f03
    v_smfmac_f32_16x16x64_bf16 v[76:79], v[32:35], a[192:199], v19
    v_smfmac_f32_16x16x64_bf16 v[76:79], v[48:51], a[224:231], v19
    s_branch Go_17_s3
Go_17_f03:
    buffer_load_dwordx4 v[32:35], v3, s[8:11], s40 offen offset:0 sc1
    s_add_u32 s33, s33, 1
    s_cmp_gt_u32 s33, 0x100000
    s_cbranch_scc1 chain_kernel_abort
    s_branch Go_17_s30
Go_17_s312:
    s_waitcnt vmcnt(2)
    v_cmp_eq_u32 vcc, -1, v44
    v_mov_b32_dpp v60, v44 row_ror:8 row_mask:0xf bank_mask:0xf
    v_mov_b32_dpp v61, v45 row_ror:8 row_mask:0xf bank_mask:0xf
    v_mov_b32_dpp v62, v46 row_ror:8 row_mask:0xf bank_mask:0xf
    v_mov_b32_dpp v63, v47 row_ror:8 row_mask:0xf bank_mask:0xf
    s_cbranch_vccnz Go_17_f312
    v_smfmac_f32_16x16x64_bf16 v[76:79], v[44:47], a[216:223], v19
    v_smfmac_f32_16x16x64_bf16 v[76:79], v[60:63], a[248:255], v19
Go_17_s12:
    s_waitcnt vmcnt(1)
    v_cmp_eq_u32 vcc, -1, v36
    v_mov_b32_dpp v52, v36 row_ror:8 row_mask:0xf bank_mask:0xf
    v_mov_b32_dpp v53, v37 row_ror:8 row_mask:0xf bank_mask:0xf
    v_mov_b32_dpp v54, v38 row_ror:8 row_mask:0xf bank_mask:0xf
    v_mov_b32_dpp v55, v39 row_ror:8 row_mask:0xf bank_mask:0xf
    s_cbranch_vccnz Go_17_f12
    v_smfmac_f32_16x16x64_bf16 v[76:79], v[36:39], a[200:207], v19
    v_smfmac_f32_16x16x64_bf16 v[76:79], v[52:55], a[232:239], v19
    s_branch Go_17_s2
Go_17_f312:
    buffer_load_dwordx4 v[44:47], v3, s[8:11], s40 offen offset:3072 sc1
    s_add_u32 s33, s33, 1
    s_cmp_gt_u32 s33, 0x100000
    s_cbranch_scc1 chain_kernel_abort
    s_branch Go_17_s123
Go_17_f12:
    buffer_load_dwordx4 v[36:39], v3, s[8:11], s40 offen offset:1024 sc1
    s_add_u32 s33, s33, 1
    s_cmp_gt_u32 s33, 0x100000
    s_cbranch_scc1 chain_kernel_abort
    s_branch Go_17_s21
Go_17_s13:
    s_waitcnt vmcnt(1)
    v_cmp_eq_u32 vcc, -1, v36
    v_mov_b32_dpp v52, v36 row_ror:8 row_mask:0xf bank_mask:0xf
    v_mov_b32_dpp v53, v37 row_ror:8 row_mask:0xf bank_mask:0xf
    v_mov_b32_dpp v54, v38 row_ror:8 row_mask:0xf bank_mask:0xf
    v_mov_b32_dpp v55, v39 row_ror:8 row_mask:0xf bank_mask:0xf
    s_cbranch_vccnz Go_17_f13
    v_smfmac_f32_16x16x64_bf16 v[76:79], v[36:39], a[200:207], v19
    v_smfmac_f32_16x16x64_bf16 v[76:79], v[52:55], a[232:239], v19
    s_branch Go_17_s3
Go_17_f13:
    buffer_load_dwordx4 v[36:39], v3, s[8:11], s40 offen offset:1024 sc1
    s_add_u32 s33, s33, 1
    s_cmp_gt_u32 s33, 0x100000
    s_cbranch_scc1 chain_kernel_abort
    s_branch Go_17_s31
Go_17_s3012:
    s_waitcnt vmcnt(3)
    v_cmp_eq_u32 vcc, -1, v44
    v_mov_b32_dpp v60, v44 row_ror:8 row_mask:0xf bank_mask:0xf
    v_mov_b32_dpp v61, v45 row_ror:8 row_mask:0xf bank_mask:0xf
    v_mov_b32_dpp v62, v46 row_ror:8 row_mask:0xf bank_mask:0xf
    v_mov_b32_dpp v63, v47 row_ror:8 row_mask:0xf bank_mask:0xf
    s_cbranch_vccnz Go_17_f3012
    v_smfmac_f32_16x16x64_bf16 v[76:79], v[44:47], a[216:223], v19
    v_smfmac_f32_16x16x64_bf16 v[76:79], v[60:63], a[248:255], v19
Go_17_s012:
    s_waitcnt vmcnt(2)
    v_cmp_eq_u32 vcc, -1, v32
    v_mov_b32_dpp v48, v32 row_ror:8 row_mask:0xf bank_mask:0xf
    v_mov_b32_dpp v49, v33 row_ror:8 row_mask:0xf bank_mask:0xf
    v_mov_b32_dpp v50, v34 row_ror:8 row_mask:0xf bank_mask:0xf
    v_mov_b32_dpp v51, v35 row_ror:8 row_mask:0xf bank_mask:0xf
    s_cbranch_vccnz Go_17_f012
    v_smfmac_f32_16x16x64_bf16 v[76:79], v[32:35], a[192:199], v19
    v_smfmac_f32_16x16x64_bf16 v[76:79], v[48:51], a[224:231], v19
    s_branch Go_17_s12
Go_17_f3012:
    buffer_load_dwordx4 v[44:47], v3, s[8:11], s40 offen offset:3072 sc1
    s_add_u32 s33, s33, 1
    s_cmp_gt_u32 s33, 0x100000
    s_cbranch_scc1 chain_kernel_abort
    s_branch Go_17_s0123
Go_17_f012:
    buffer_load_dwordx4 v[32:35], v3, s[8:11], s40 offen offset:0 sc1
    s_add_u32 s33, s33, 1
    s_cmp_gt_u32 s33, 0x100000
    s_cbranch_scc1 chain_kernel_abort
    s_branch Go_17_s120
Go_17_s013:
    s_waitcnt vmcnt(2)
    v_cmp_eq_u32 vcc, -1, v32
    v_mov_b32_dpp v48, v32 row_ror:8 row_mask:0xf bank_mask:0xf
    v_mov_b32_dpp v49, v33 row_ror:8 row_mask:0xf bank_mask:0xf
    v_mov_b32_dpp v50, v34 row_ror:8 row_mask:0xf bank_mask:0xf
    v_mov_b32_dpp v51, v35 row_ror:8 row_mask:0xf bank_mask:0xf
    s_cbranch_vccnz Go_17_f013
    v_smfmac_f32_16x16x64_bf16 v[76:79], v[32:35], a[192:199], v19
    v_smfmac_f32_16x16x64_bf16 v[76:79], v[48:51], a[224:231], v19
    s_branch Go_17_s13
Go_17_f013:
    buffer_load_dwordx4 v[32:35], v3, s[8:11], s40 offen offset:0 sc1
    s_add_u32 s33, s33, 1
    s_cmp_gt_u32 s33, 0x100000
    s_cbranch_scc1 chain_kernel_abort
    s_branch Go_17_s130
Go_17_s10:
    s_waitcnt vmcnt(1)
    v_cmp_eq_u32 vcc, -1, v36
    v_mov_b32_dpp v52, v36 row_ror:8 row_mask:0xf bank_mask:0xf
    v_mov_b32_dpp v53, v37 row_ror:8 row_mask:0xf bank_mask:0xf
    v_mov_b32_dpp v54, v38 row_ror:8 row_mask:0xf bank_mask:0xf
    v_mov_b32_dpp v55, v39 row_ror:8 row_mask:0xf bank_mask:0xf
    s_cbranch_vccnz Go_17_f10
    v_smfmac_f32_16x16x64_bf16 v[76:79], v[36:39], a[200:207], v19
    v_smfmac_f32_16x16x64_bf16 v[76:79], v[52:55], a[232:239], v19
    s_branch Go_17_s0
Go_17_f10:
    buffer_load_dwordx4 v[36:39], v3, s[8:11], s40 offen offset:1024 sc1
    s_add_u32 s33, s33, 1
    s_cmp_gt_u32 s33, 0x100000
    s_cbranch_scc1 chain_kernel_abort
    s_branch Go_17_s01
Go_17_s023:
    s_waitcnt vmcnt(2)
    v_cmp_eq_u32 vcc, -1, v32
    v_mov_b32_dpp v48, v32 row_ror:8 row_mask:0xf bank_mask:0xf
    v_mov_b32_dpp v49, v33 row_ror:8 row_mask:0xf bank_mask:0xf
    v_mov_b32_dpp v50, v34 row_ror:8 row_mask:0xf bank_mask:0xf
    v_mov_b32_dpp v51, v35 row_ror:8 row_mask:0xf bank_mask:0xf
    s_cbranch_vccnz Go_17_f023
    v_smfmac_f32_16x16x64_bf16 v[76:79], v[32:35], a[192:199], v19
    v_smfmac_f32_16x16x64_bf16 v[76:79], v[48:51], a[224:231], v19
    s_branch Go_17_s23
Go_17_f023:
    buffer_load_dwordx4 v[32:35], v3, s[8:11], s40 offen offset:0 sc1
    s_add_u32 s33, s33, 1
    s_cmp_gt_u32 s33, 0x100000
    s_cbranch_scc1 chain_kernel_abort
    s_branch Go_17_s230
Go_17_s20:
    s_waitcnt vmcnt(1)
    v_cmp_eq_u32 vcc, -1, v40
    v_mov_b32_dpp v56, v40 row_ror:8 row_mask:0xf bank_mask:0xf
    v_mov_b32_dpp v57, v41 row_ror:8 row_mask:0xf bank_mask:0xf
    v_mov_b32_dpp v58, v42 row_ror:8 row_mask:0xf bank_mask:0xf
    v_mov_b32_dpp v59, v43 row_ror:8 row_mask:0xf bank_mask:0xf
    s_cbranch_vccnz Go_17_f20
    v_smfmac_f32_16x16x64_bf16 v[76:79], v[40:43], a[208:215], v19
    v_smfmac_f32_16x16x64_bf16 v[76:79], v[56:59], a[240:247], v19
    s_branch Go_17_s0
Go_17_f20:
    buffer_load_dwordx4 v[40:43], v3, s[8:11], s40 offen offset:2048 sc1
    s_add_u32 s33, s33, 1
    s_cmp_gt_u32 s33, 0x100000
    s_cbranch_scc1 chain_kernel_abort
    s_branch Go_17_s02
Go_17_s21:
    s_waitcnt vmcnt(1)
    v_cmp_eq_u32 vcc, -1, v40
    v_mov_b32_dpp v56, v40 row_ror:8 row_mask:0xf bank_mask:0xf
    v_mov_b32_dpp v57, v41 row_ror:8 row_mask:0xf bank_mask:0xf
    v_mov_b32_dpp v58, v42 row_ror:8 row_mask:0xf bank_mask:0xf
    v_mov_b32_dpp v59, v43 row_ror:8 row_mask:0xf bank_mask:0xf
    s_cbranch_vccnz Go_17_f21
    v_smfmac_f32_16x16x64_bf16 v[76:79], v[40:43], a[208:215], v19
    v_smfmac_f32_16x16x64_bf16 v[76:79], v[56:59], a[240:247], v19
    s_branch Go_17_s1
Go_17_f21:
    buffer_load_dwordx4 v[40:43], v3, s[8:11], s40 offen offset:2048 sc1
    s_add_u32 s33, s33, 1
    s_cmp_gt_u32 s33, 0x100000
    s_cbranch_scc1 chain_kernel_abort
    s_branch Go_17_s12
Go_17_s120:
    s_waitcnt vmcnt(2)
    v_cmp_eq_u32 vcc, -1, v36
    v_mov_b32_dpp v52, v36 row_ror:8 row_mask:0xf bank_mask:0xf
    v_mov_b32_dpp v53, v37 row_ror:8 row_mask:0xf bank_mask:0xf
    v_mov_b32_dpp v54, v38 row_ror:8 row_mask:0xf bank_mask:0xf
    v_mov_b32_dpp v55, v39 row_ror:8 row_mask:0xf bank_mask:0xf
    s_cbranch_vccnz Go_17_f120
    v_smfmac_f32_16x16x64_bf16 v[76:79], v[36:39], a[200:207], v19
    v_smfmac_f32_16x16x64_bf16 v[76:79], v[52:55], a[232:239], v19
    s_branch Go_17_s20
Go_17_f120:
    buffer_load_dwordx4 v[36:39], v3, s[8:11], s40 offen offset:1024 sc1
    s_add_u32 s33, s33, 1
    s_cmp_gt_u32 s33, 0x100000
    s_cbranch_scc1 chain_kernel_abort
    s_branch Go_17_s201
Go_17_s130:
    s_waitcnt vmcnt(2)
    v_cmp_eq_u32 vcc, -1, v36
    v_mov_b32_dpp v52, v36 row_ror:8 row_mask:0xf bank_mask:0xf
    v_mov_b32_dpp v53, v37 row_ror:8 row_mask:0xf bank_mask:0xf
    v_mov_b32_dpp v54, v38 row_ror:8 row_mask:0xf bank_mask:0xf
    v_mov_b32_dpp v55, v39 row_ror:8 row_mask:0xf bank_mask:0xf
    s_cbranch_vccnz Go_17_f130
    v_smfmac_f32_16x16x64_bf16 v[76:79], v[36:39], a[200:207], v19
    v_smfmac_f32_16x16x64_bf16 v[76:79], v[52:55], a[232:239], v19
    s_branch Go_17_s30
Go_17_f130:
    buffer_load_dwordx4 v[36:39], v3, s[8:11], s40 offen offset:1024 sc1
    s_add_u32 s33, s33, 1
    s_cmp_gt_u32 s33, 0x100000
    s_cbranch_scc1 chain_kernel_abort
    s_branch Go_17_s301
Go_17_s201:
    s_waitcnt vmcnt(2)
    v_cmp_eq_u32 vcc, -1, v40
    v_mov_b32_dpp v56, v40 row_ror:8 row_mask:0xf bank_mask:0xf
    v_mov_b32_dpp v57, v41 row_ror:8 row_mask:0xf bank_mask:0xf
    v_mov_b32_dpp v58, v42 row_ror:8 row_mask:0xf bank_mask:0xf
    v_mov_b32_dpp v59, v43 row_ror:8 row_mask:0xf bank_mask:0xf
    s_cbranch_vccnz Go_17_f201
    v_smfmac_f32_16x16x64_bf16 v[76:79], v[40:43], a[208:215], v19
    v_smfmac_f32_16x16x64_bf16 v[76:79], v[56:59], a[240:247], v19
    s_branch Go_17_s01
Go_17_f201:
    buffer_load_dwordx4 v[40:43], v3, s[8:11], s40 offen offset:2048 sc1
    s_add_u32 s33, s33, 1
    s_cmp_gt_u32 s33, 0x100000
    s_cbranch_scc1 chain_kernel_abort
    s_branch Go_17_s012
L_pf_22:
    s_mov_b64 exec, -1
    buffer_load_dword v220, v9, s[8:11], s43 offen sc1
    buffer_load_dword v221, v10, s[8:11], s43 offen sc1
    buffer_load_dword v222, v11, s[8:11], s43 offen sc1
    s_add_u32 s33, s33, 1
    s_cmp_gt_u32 s33, 0x100000
    s_cbranch_scc1 chain_kernel_abort
    s_branch L_pb1_20
L_pb1_20:
    s_waitcnt vmcnt(9)
    v_add_f32 v208, v80, v223
    s_waitcnt vmcnt(7)
    v_add_f32 v209, v224, v225
    v_max3_u32 v20, v223, v224, v225
    v_add_f32 v208, v208, v209
    v_cmp_eq_u32 vcc, -1, v20
    s_nop 0
    v_mov_b32_dpp v209, v208 quad_perm:[1,0,3,2] row_mask:0xf bank_mask:0xf
    s_mov_b64 exec, s[26:27]
    v_cvt_pk_bf16_f32 v208, v208, v209
    v_min_u32 v208, 0xfffffffe, v208
    s_cbranch_vccnz L_pf_23
    s_branch L_pd_21
L_pf_23:
    s_mov_b64 exec, -1
    buffer_load_dword v223, v9, s[8:11], s44 offen sc1
    buffer_load_dword v224, v10, s[8:11], s44 offen sc1
    buffer_load_dword v225, v11, s[8:11], s44 offen sc1
    s_add_u32 s33, s33, 1
    s_cmp_gt_u32 s33, 0x100000
    s_cbranch_scc1 chain_kernel_abort
    s_branch L_pa_18
L_pa_18:
    s_waitcnt vmcnt(5)
    v_add_f32 v208, v80, v220
    s_waitcnt vmcnt(3)
    v_add_f32 v209, v221, v222
    v_max3_u32 v20, v220, v221, v222
    v_add_f32 v208, v208, v209
    v_cmp_eq_u32 vcc, -1, v20
    s_nop 0
    v_mov_b32_dpp v209, v208 quad_perm:[1,0,3,2] row_mask:0xf bank_mask:0xf
    s_mov_b64 exec, s[26:27]
    v_cvt_pk_bf16_f32 v208, v208, v209
    v_min_u32 v208, 0xfffffffe, v208
    s_cbranch_vccnz L_pf_24
    s_branch L_pd_21
L_pf_24:
    s_mov_b64 exec, -1
    buffer_load_dword v220, v9, s[8:11], s43 offen sc1
    buffer_load_dword v221, v10, s[8:11], s43 offen sc1
    buffer_load_dword v222, v11, s[8:11], s43 offen sc1
    s_add_u32 s33, s33, 1
    s_cmp_gt_u32 s33, 0x100000
    s_cbranch_scc1 chain_kernel_abort
    s_branch L_pb_19
L_pb_19:
    s_waitcnt vmcnt(5)
    v_add_f32 v208, v80, v223
    s_waitcnt vmcnt(3)
    v_add_f32 v209, v224, v225
    v_max3_u32 v20, v223, v224, v225
    v_add_f32 v208, v208, v209
    v_cmp_eq_u32 vcc, -1, v20
    s_nop 0
    v_mov_b32_dpp v209, v208 quad_perm:[1,0,3,2] row_mask:0xf bank_mask:0xf
    s_mov_b64 exec, s[26:27]
    v_cvt_pk_bf16_f32 v208, v208, v209
    v_min_u32 v208, 0xfffffffe, v208
    s_cbranch_vccnz L_pf_25
    s_branch L_pd_21
L_pf_25:
    s_mov_b64 exec, -1
    buffer_load_dword v223, v9, s[8:11], s44 offen sc1
    buffer_load_dword v224, v10, s[8:11], s44 offen sc1
    buffer_load_dword v225, v11, s[8:11], s44 offen sc1
    s_add_u32 s33, s33, 1
    s_cmp_gt_u32 s33, 0x100000
    s_cbranch_scc1 chain_kernel_abort
    s_branch L_pa_18
chain_kernel_abort:
    s_mov_b32 s12, s98
    s_and_b32 s13, s99, 0xffff
    s_mov_b32 s14, 0x100
    s_mov_b32 s15, 0x00020000
    s_mov_b64 exec, 1
    v_mov_b32 v1, s19
    v_or_b32 v1, 0xdead0000, v1
    v_mov_b32 v2, 124
    buffer_store_dword v1, v2, s[12:15], 0 offen
chain_kernel_done:
    s_endpgm
chain_kernel_end:
    s_endpgm
chain_kernel_worker:
    s_sub_u32 s56, s16, 4
    s_mov_b32 s57, s17
    s_mov_b32 s58, s18
    s_cmp_eq_u32 s56, 0
    s_cbranch_scc1 L_big_37
    s_cmp_eq_u32 s56, 3
    s_cselect_b64 s[12:13], s[90:91], s[88:89]
    s_cmp_eq_u32 s56, 1
    s_cselect_b64 s[12:13], s[86:87], s[12:13]
    s_and_b32 s13, s13, 0xffff
    s_mov_b32 s14, 0x800000
    s_mov_b32 s15, 0x00020000
    s_lshl_b32 s28, s57, 8
    v_bfe_u32 v24, v0, 4, 3
    v_lshlrev_b32 v24, 1, v24
    v_and_b32 v25, 15, v0
    v_xor_b32 v24, v24, v25
    v_lshlrev_b32 v6, 4, v24
    v_bfe_u32 v24, v0, 4, 2
    v_lshl_add_u32 v6, v24, 13, v6
    v_bfe_u32 v24, v0, 6, 1
    v_lshl_add_u32 v6, v24, 16, v6
    v_bfe_u32 v24, v0, 7, 1
    v_lshl_add_u32 v6, v24, 15, v6
    s_and_b32 s60, s58, 1
    s_lshl_b32 s61, s60, 11
    s_lshr_b32 s60, s58, 1
    s_lshl_b32 s60, s60, 10
    s_add_u32 s32, s60, s61
    s_add_u32 m0, s32, 0
    s_add_u32 s61, s28, 0x0
    buffer_load_dwordx4 v6, s[12:15], s61 offen nt lds
    s_add_u32 m0, s32, 4096
    s_add_u32 s61, s28, 0x20000
    buffer_load_dwordx4 v6, s[12:15], s61 offen nt lds
    s_add_u32 m0, s32, 8192
    s_add_u32 s61, s28, 0x40000
    buffer_load_dwordx4 v6, s[12:15], s61 offen nt lds
    s_add_u32 m0, s32, 12288
    s_add_u32 s61, s28, 0x60000
    buffer_load_dwordx4 v6, s[12:15], s61 offen nt lds
    s_add_u32 m0, s32, 16384
    s_add_u32 s61, s28, 0x80000
    buffer_load_dwordx4 v6, s[12:15], s61 offen nt lds
    s_add_u32 m0, s32, 20480
    s_add_u32 s61, s28, 0xa0000
    buffer_load_dwordx4 v6, s[12:15], s61 offen nt lds
    s_add_u32 m0, s32, 24576
    s_add_u32 s61, s28, 0xc0000
    buffer_load_dwordx4 v6, s[12:15], s61 offen nt lds
    s_add_u32 m0, s32, 28672
    s_add_u32 s61, s28, 0xe0000
    buffer_load_dwordx4 v6, s[12:15], s61 offen nt lds
    s_mov_b32 s8, s82
    s_and_b32 s9, s83, 0xffff
    s_mov_b32 s10, 0x400000
    s_mov_b32 s11, 0x00020000
    s_mov_b32 s16, s100
    s_and_b32 s17, s101, 0xffff
    s_mov_b32 s18, 0xa000000
    s_mov_b32 s19, 0x00020000
    v_and_b32 v24, 63, v0
    v_lshlrev_b32 v1, 4, v24
    v_add_u32 v12, 4096, v1
    v_lshlrev_b32 v10, 7, v24
    s_lshl_b32 s27, s57, 13
    s_and_b32 s60, s58, 1
    s_lshl_b32 s60, s60, 18
    s_add_u32 s60, s60, s27
    buffer_load_dword v13, v10, s[8:11], s60 offen
    s_add_u32 s27, s27, 0x80000
    s_add_u32 m0, s32, 32768
    s_add_u32 s61, s28, 0x100000
    buffer_load_dwordx4 v6, s[12:15], s61 offen nt lds
    s_add_u32 m0, s32, 36864
    s_add_u32 s61, s28, 0x120000
    buffer_load_dwordx4 v6, s[12:15], s61 offen nt lds
    s_add_u32 m0, s32, 40960
    s_add_u32 s61, s28, 0x140000
    buffer_load_dwordx4 v6, s[12:15], s61 offen nt lds
    s_add_u32 m0, s32, 45056
    s_add_u32 s61, s28, 0x160000
    buffer_load_dwordx4 v6, s[12:15], s61 offen nt lds
    s_add_u32 m0, s32, 49152
    s_add_u32 s61, s28, 0x180000
    buffer_load_dwordx4 v6, s[12:15], s61 offen nt lds
    s_add_u32 m0, s32, 53248
    s_add_u32 s61, s28, 0x1a0000
    buffer_load_dwordx4 v6, s[12:15], s61 offen nt lds
    s_add_u32 m0, s32, 57344
    s_add_u32 s61, s28, 0x1c0000
    buffer_load_dwordx4 v6, s[12:15], s61 offen nt lds
    s_add_u32 m0, s32, 61440
    s_add_u32 s61, s28, 0x1e0000
    buffer_load_dwordx4 v6, s[12:15], s61 offen nt lds
    s_add_u32 m0, s32, 65536
    s_add_u32 s61, s28, 0x200000
    buffer_load_dwordx4 v6, s[12:15], s61 offen nt lds
    s_add_u32 m0, s32, 69632
    s_add_u32 s61, s28, 0x220000
    buffer_load_dwordx4 v6, s[12:15], s61 offen nt lds
    s_add_u32 m0, s32, 73728
    s_add_u32 s61, s28, 0x240000
    buffer_load_dwordx4 v6, s[12:15], s61 offen nt lds
    s_add_u32 m0, s32, 77824
    s_add_u32 s61, s28, 0x260000
    buffer_load_dwordx4 v6, s[12:15], s61 offen nt lds
    s_add_u32 m0, s32, 81920
    s_add_u32 s61, s28, 0x280000
    buffer_load_dwordx4 v6, s[12:15], s61 offen nt lds
    s_add_u32 m0, s32, 86016
    s_add_u32 s61, s28, 0x2a0000
    buffer_load_dwordx4 v6, s[12:15], s61 offen nt lds
    s_add_u32 m0, s32, 90112
    s_add_u32 s61, s28, 0x2c0000
    buffer_load_dwordx4 v6, s[12:15], s61 offen nt lds
    s_add_u32 m0, s32, 94208
    s_add_u32 s61, s28, 0x2e0000
    buffer_load_dwordx4 v6, s[12:15], s61 offen nt lds
    s_add_u32 m0, s32, 98304
    s_add_u32 s61, s28, 0x300000
    buffer_load_dwordx4 v6, s[12:15], s61 offen nt lds
    s_add_u32 m0, s32, 102400
    s_add_u32 s61, s28, 0x320000
    buffer_load_dwordx4 v6, s[12:15], s61 offen nt lds
    s_add_u32 m0, s32, 106496
    s_add_u32 s61, s28, 0x340000
    buffer_load_dwordx4 v6, s[12:15], s61 offen nt lds
    s_add_u32 m0, s32, 110592
    s_add_u32 s61, s28, 0x360000
    buffer_load_dwordx4 v6, s[12:15], s61 offen nt lds
    s_add_u32 m0, s32, 114688
    s_add_u32 s61, s28, 0x380000
    buffer_load_dwordx4 v6, s[12:15], s61 offen nt lds
    s_add_u32 m0, s32, 118784
    s_add_u32 s61, s28, 0x3a0000
    buffer_load_dwordx4 v6, s[12:15], s61 offen nt lds
    s_add_u32 m0, s32, 122880
    s_add_u32 s61, s28, 0x3c0000
    buffer_load_dwordx4 v6, s[12:15], s61 offen nt lds
    s_add_u32 m0, s32, 126976
    s_add_u32 s61, s28, 0x3e0000
    buffer_load_dwordx4 v6, s[12:15], s61 offen nt lds
    s_add_u32 m0, s32, 131072
    s_add_u32 s61, s28, 0x400000
    buffer_load_dwordx4 v6, s[12:15], s61 offen nt lds
    s_add_u32 m0, s32, 135168
    s_add_u32 s61, s28, 0x420000
    buffer_load_dwordx4 v6, s[12:15], s61 offen nt lds
    s_add_u32 m0, s32, 139264
    s_add_u32 s61, s28, 0x440000
    buffer_load_dwordx4 v6, s[12:15], s61 offen nt lds
    s_add_u32 m0, s32, 143360
    s_add_u32 s61, s28, 0x460000
    buffer_load_dwordx4 v6, s[12:15], s61 offen nt lds
    s_add_u32 m0, s32, 147456
    s_add_u32 s61, s28, 0x480000
    buffer_load_dwordx4 v6, s[12:15], s61 offen nt lds
    s_add_u32 m0, s32, 151552
    s_add_u32 s61, s28, 0x4a0000
    buffer_load_dwordx4 v6, s[12:15], s61 offen nt lds
    s_add_u32 m0, s32, 155648
    s_add_u32 s61, s28, 0x4c0000
    buffer_load_dwordx4 v6, s[12:15], s61 offen nt lds
    s_add_u32 m0, s32, 159744
    s_add_u32 s61, s28, 0x4e0000
    buffer_load_dwordx4 v6, s[12:15], s61 offen nt lds
    v_bfe_u32 v24, v0, 4, 3
    v_and_b32 v25, 7, v0
    v_xor_b32 v24, v24, v25
    v_lshlrev_b32 v2, 4, v24
    v_lshrrev_b32 v24, 3, v0
    v_lshl_add_u32 v2, v24, 11, v2
    v_bfe_u32 v24, v0, 1, 3
    v_bfe_u32 v25, v0, 4, 2
    v_xor_b32 v24, v24, v25
    v_lshlrev_b32 v4, 4, v24
    v_and_b32 v25, 15, v0
    v_lshl_add_u32 v4, v25, 7, v4
    v_add_u32 v4, 98304, v4
    v_xor_b32 v5, 64, v4
    v_bfe_u32 v24, v0, 2, 3
    v_lshrrev_b32 v25, 6, v0
    v_lshlrev_b32 v25, 1, v25
    v_xor_b32 v24, v24, v25
    v_lshlrev_b32 v8, 5, v24
    v_bfe_u32 v24, v0, 0, 2
    v_lshl_add_u32 v8, v24, 3, v8
    v_bfe_u32 v24, v0, 2, 2
    v_lshl_add_u32 v8, v24, 8, v8
    v_bfe_u32 v24, v0, 4, 2
    v_lshl_add_u32 v8, v24, 11, v8
    v_xor_b32 v9, 32, v8
    v_mov_b32 v28, -1
    v_mov_b32 v29, -1
    v_mov_b32 v30, -1
    v_mov_b32 v31, -1
    s_lshl_b32 s20, s58, 10
    s_add_u32 s20, s20, 98304
    s_mov_b32 s21, 98304
    s_mov_b32 s23, 0
    s_mov_b32 s29, 32768
    s_lshl_b32 s30, s57, 16
    s_cmp_eq_u32 s56, 3
    s_cselect_b32 s60, 11, 10
    s_cselect_b32 s61, 0x4000, 0
    s_lshl_b32 s60, s58, s60
    s_add_u32 s30, s30, s60
    s_add_u32 s30, s30, s61
    s_lshl_b32 s31, s57, 14
    s_lshr_b32 s61, s61, 2
    s_add_u32 s31, s31, s61
    s_lshl_b32 s60, s58, 10
    s_add_u32 s31, s31, s60
    s_add_u32 s31, s31, 0x8000000
    s_cmp_eq_u32 s56, 1
    s_cselect_b32 s31, 0xa000000, s31
    s_cselect_b32 s60, 0x8000, 0
    s_add_u32 s30, s30, s60
    s_waitcnt vmcnt(33)
    s_barrier
    ds_read_b64_tr_b16 a[0:1], v8 offset:0
    ds_read_b64_tr_b16 a[2:3], v8 offset:1024
    ds_read_b64_tr_b16 a[4:5], v9 offset:0
    ds_read_b64_tr_b16 a[6:7], v9 offset:1024
    ds_read_b64_tr_b16 a[8:9], v8 offset:8192
    ds_read_b64_tr_b16 a[10:11], v8 offset:9216
    ds_read_b64_tr_b16 a[12:13], v9 offset:8192
    ds_read_b64_tr_b16 a[14:15], v9 offset:9216
    s_waitcnt lgkmcnt(0)
    ds_read_b64_tr_b16 a[16:17], v8 offset:16384
    ds_read_b64_tr_b16 a[18:19], v8 offset:17408
    ds_read_b64_tr_b16 a[20:21], v9 offset:16384
    ds_read_b64_tr_b16 a[22:23], v9 offset:17408
    ds_read_b64_tr_b16 a[24:25], v8 offset:24576
    ds_read_b64_tr_b16 a[26:27], v8 offset:25600
    ds_read_b64_tr_b16 a[28:29], v9 offset:24576
    ds_read_b64_tr_b16 a[30:31], v9 offset:25600
    s_waitcnt lgkmcnt(0)
    s_waitcnt vmcnt(24)
    s_barrier
    s_add_u32 m0, s32, 0
    s_add_u32 s61, s28, 0x500000
    buffer_load_dwordx4 v6, s[12:15], s61 offen nt lds
    s_add_u32 m0, s32, 4096
    s_add_u32 s61, s28, 0x520000
    buffer_load_dwordx4 v6, s[12:15], s61 offen nt lds
    s_add_u32 m0, s32, 8192
    s_add_u32 s61, s28, 0x540000
    buffer_load_dwordx4 v6, s[12:15], s61 offen nt lds
    s_add_u32 m0, s32, 12288
    s_add_u32 s61, s28, 0x560000
    buffer_load_dwordx4 v6, s[12:15], s61 offen nt lds
    s_add_u32 m0, s32, 16384
    s_add_u32 s61, s28, 0x580000
    buffer_load_dwordx4 v6, s[12:15], s61 offen nt lds
    s_add_u32 m0, s32, 20480
    s_add_u32 s61, s28, 0x5a0000
    buffer_load_dwordx4 v6, s[12:15], s61 offen nt lds
    s_add_u32 m0, s32, 24576
    s_add_u32 s61, s28, 0x5c0000
    buffer_load_dwordx4 v6, s[12:15], s61 offen nt lds
    s_add_u32 m0, s32, 28672
    s_add_u32 s61, s28, 0x5e0000
    buffer_load_dwordx4 v6, s[12:15], s61 offen nt lds
    ds_read_b64_tr_b16 a[32:33], v8 offset:32768
    ds_read_b64_tr_b16 a[34:35], v8 offset:33792
    ds_read_b64_tr_b16 a[36:37], v9 offset:32768
    ds_read_b64_tr_b16 a[38:39], v9 offset:33792
    ds_read_b64_tr_b16 a[40:41], v8 offset:40960
    ds_read_b64_tr_b16 a[42:43], v8 offset:41984
    ds_read_b64_tr_b16 a[44:45], v9 offset:40960
    ds_read_b64_tr_b16 a[46:47], v9 offset:41984
    s_waitcnt lgkmcnt(0)
    ds_read_b64_tr_b16 a[48:49], v8 offset:49152
    ds_read_b64_tr_b16 a[50:51], v8 offset:50176
    ds_read_b64_tr_b16 a[52:53], v9 offset:49152
    ds_read_b64_tr_b16 a[54:55], v9 offset:50176
    ds_read_b64_tr_b16 a[56:57], v8 offset:57344
    ds_read_b64_tr_b16 a[58:59], v8 offset:58368
    ds_read_b64_tr_b16 a[60:61], v9 offset:57344
    ds_read_b64_tr_b16 a[62:63], v9 offset:58368
    s_waitcnt lgkmcnt(0)
    s_waitcnt vmcnt(24)
    s_barrier
    s_add_u32 m0, s32, 32768
    s_add_u32 s61, s28, 0x600000
    buffer_load_dwordx4 v6, s[12:15], s61 offen nt lds
    s_add_u32 m0, s32, 36864
    s_add_u32 s61, s28, 0x620000
    buffer_load_dwordx4 v6, s[12:15], s61 offen nt lds
    s_add_u32 m0, s32, 40960
    s_add_u32 s61, s28, 0x640000
    buffer_load_dwordx4 v6, s[12:15], s61 offen nt lds
    s_add_u32 m0, s32, 45056
    s_add_u32 s61, s28, 0x660000
    buffer_load_dwordx4 v6, s[12:15], s61 offen nt lds
    s_add_u32 m0, s32, 49152
    s_add_u32 s61, s28, 0x680000
    buffer_load_dwordx4 v6, s[12:15], s61 offen nt lds
    s_add_u32 m0, s32, 53248
    s_add_u32 s61, s28, 0x6a0000
    buffer_load_dwordx4 v6, s[12:15], s61 offen nt lds
    s_add_u32 m0, s32, 57344
    s_add_u32 s61, s28, 0x6c0000
    buffer_load_dwordx4 v6, s[12:15], s61 offen nt lds
    s_add_u32 m0, s32, 61440
    s_add_u32 s61, s28, 0x6e0000
    buffer_load_dwordx4 v6, s[12:15], s61 offen nt lds
    v_add_u32 v8, 0x10000, v8
    v_add_u32 v9, 0x10000, v9
    ds_read_b64_tr_b16 a[64:65], v8 offset:0
    ds_read_b64_tr_b16 a[66:67], v8 offset:1024
    ds_read_b64_tr_b16 a[68:69], v9 offset:0
    ds_read_b64_tr_b16 a[70:71], v9 offset:1024
    ds_read_b64_tr_b16 a[72:73], v8 offset:8192
    ds_read_b64_tr_b16 a[74:75], v8 offset:9216
    ds_read_b64_tr_b16 a[76:77], v9 offset:8192
    ds_read_b64_tr_b16 a[78:79], v9 offset:9216
    s_waitcnt lgkmcnt(0)
    ds_read_b64_tr_b16 a[80:81], v8 offset:16384
    ds_read_b64_tr_b16 a[82:83], v8 offset:17408
    ds_read_b64_tr_b16 a[84:85], v9 offset:16384
    ds_read_b64_tr_b16 a[86:87], v9 offset:17408
    ds_read_b64_tr_b16 a[88:89], v8 offset:24576
    ds_read_b64_tr_b16 a[90:91], v8 offset:25600
    ds_read_b64_tr_b16 a[92:93], v9 offset:24576
    ds_read_b64_tr_b16 a[94:95], v9 offset:25600
    s_waitcnt lgkmcnt(0)
    s_waitcnt vmcnt(24)
    s_barrier
    s_add_u32 m0, s32, 65536
    s_add_u32 s61, s28, 0x700000
    buffer_load_dwordx4 v6, s[12:15], s61 offen nt lds
    s_add_u32 m0, s32, 69632
    s_add_u32 s61, s28, 0x720000
    buffer_load_dwordx4 v6, s[12:15], s61 offen nt lds
    s_add_u32 m0, s32, 73728
    s_add_u32 s61, s28, 0x740000
    buffer_load_dwordx4 v6, s[12:15], s61 offen nt lds
    s_add_u32 m0, s32, 77824
    s_add_u32 s61, s28, 0x760000
    buffer_load_dwordx4 v6, s[12:15], s61 offen nt lds
    s_add_u32 m0, s32, 81920
    s_add_u32 s61, s28, 0x780000
    buffer_load_dwordx4 v6, s[12:15], s61 offen nt lds
    s_add_u32 m0, s32, 86016
    s_add_u32 s61, s28, 0x7a0000
    buffer_load_dwordx4 v6, s[12:15], s61 offen nt lds
    s_add_u32 m0, s32, 90112
    s_add_u32 s61, s28, 0x7c0000
    buffer_load_dwordx4 v6, s[12:15], s61 offen nt lds
    s_add_u32 m0, s32, 94208
    s_add_u32 s61, s28, 0x7e0000
    buffer_load_dwordx4 v6, s[12:15], s61 offen nt lds
    v_mov_b32 v24, 4
    global_load_dword v11, v24, s[98:99] sc1
    ds_read_b64_tr_b16 a[96:97], v8 offset:32768
    ds_read_b64_tr_b16 a[98:99], v8 offset:33792
    ds_read_b64_tr_b16 a[100:101], v9 offset:32768
    ds_read_b64_tr_b16 a[102:103], v9 offset:33792
    ds_read_b64_tr_b16 a[104:105], v8 offset:40960
    ds_read_b64_tr_b16 a[106:107], v8 offset:41984
    ds_read_b64_tr_b16 a[108:109], v9 offset:40960
    ds_read_b64_tr_b16 a[110:111], v9 offset:41984
    s_waitcnt lgkmcnt(0)
    ds_read_b64_tr_b16 a[112:113], v8 offset:49152
    ds_read_b64_tr_b16 a[114:115], v8 offset:50176
    ds_read_b64_tr_b16 a[116:117], v9 offset:49152
    ds_read_b64_tr_b16 a[118:119], v9 offset:50176
    ds_read_b64_tr_b16 a[120:121], v8 offset:57344
    ds_read_b64_tr_b16 a[122:123], v8 offset:58368
    ds_read_b64_tr_b16 a[124:125], v9 offset:57344
    ds_read_b64_tr_b16 a[126:127], v9 offset:58368
    s_waitcnt lgkmcnt(0)
    s_waitcnt vmcnt(24)
    s_barrier
    s_add_u32 m0, s20, 0
    s_nop 0
    buffer_load_dwordx4 v2, s[8:11], s23 offen offset:0 lds
    s_add_u32 m0, s20, 3968
    s_nop 0
    buffer_load_dwordx4 v2, s[8:11], s23 offen offset:128 lds
    s_add_u32 m0, s20, 7936
    s_nop 0
    buffer_load_dwordx4 v2, s[8:11], s23 offen offset:256 lds
    s_add_u32 m0, s20, 11904
    s_nop 0
    buffer_load_dwordx4 v2, s[8:11], s23 offen offset:384 lds
    s_add_u32 m0, s20, 15872
    s_nop 0
    buffer_load_dwordx4 v2, s[8:11], s23 offen offset:512 lds
    s_add_u32 m0, s20, 19840
    s_nop 0
    buffer_load_dwordx4 v2, s[8:11], s23 offen offset:640 lds
    s_add_u32 m0, s20, 23808
    s_nop 0
    buffer_load_dwordx4 v2, s[8:11], s23 offen offset:768 lds
    s_add_u32 m0, s20, 27776
    s_nop 0
    buffer_load_dwordx4 v2, s[8:11], s23 offen offset:896 lds
    s_add_u32 s23, s23, 1024
    s_bitcmp1_b32 s23, 11
    s_cselect_b32 s60, 0xf800, 0
    s_add_u32 s23, s23, s60
    s_add_u32 s20, s20, 32768
    s_cmp_ge_u32 s20, 163840
    s_cselect_b32 s60, 163840, 0
    s_sub_u32 s20, s20, s60
    v_add_u32 v8, 0x10000, v8
    v_add_u32 v9, 0x10000, v9
    ds_read_b64_tr_b16 a[128:129], v8 offset:0
    ds_read_b64_tr_b16 a[130:131], v8 offset:1024
    ds_read_b64_tr_b16 a[132:133], v9 offset:0
    ds_read_b64_tr_b16 a[134:135], v9 offset:1024
    ds_read_b64_tr_b16 a[136:137], v8 offset:8192
    ds_read_b64_tr_b16 a[138:139], v8 offset:9216
    ds_read_b64_tr_b16 a[140:141], v9 offset:8192
    ds_read_b64_tr_b16 a[142:143], v9 offset:9216
    s_waitcnt lgkmcnt(0)
    ds_read_b64_tr_b16 a[144:145], v8 offset:16384
    ds_read_b64_tr_b16 a[146:147], v8 offset:17408
    ds_read_b64_tr_b16 a[148:149], v9 offset:16384
    ds_read_b64_tr_b16 a[150:151], v9 offset:17408
    ds_read_b64_tr_b16 a[152:153], v8 offset:24576
    ds_read_b64_tr_b16 a[154:155], v8 offset:25600
    ds_read_b64_tr_b16 a[156:157], v9 offset:24576
    ds_read_b64_tr_b16 a[158:159], v9 offset:25600
    s_waitcnt lgkmcnt(0)
    s_waitcnt vmcnt(24)
    s_barrier
    s_add_u32 m0, s20, 0
    s_nop 0
    buffer_load_dwordx4 v2, s[8:11], s23 offen offset:0 lds
    s_add_u32 m0, s20, 3968
    s_nop 0
    buffer_load_dwordx4 v2, s[8:11], s23 offen offset:128 lds
    s_add_u32 m0, s20, 7936
    s_nop 0
    buffer_load_dwordx4 v2, s[8:11], s23 offen offset:256 lds
    s_add_u32 m0, s20, 11904
    s_nop 0
    buffer_load_dwordx4 v2, s[8:11], s23 offen offset:384 lds
    s_add_u32 m0, s20, 15872
    s_nop 0
    buffer_load_dwordx4 v2, s[8:11], s23 offen offset:512 lds
    s_add_u32 m0, s20, 19840
    s_nop 0
    buffer_load_dwordx4 v2, s[8:11], s23 offen offset:640 lds
    s_add_u32 m0, s20, 23808
    s_nop 0
    buffer_load_dwordx4 v2, s[8:11], s23 offen offset:768 lds
    s_add_u32 m0, s20, 27776
    s_nop 0
    buffer_load_dwordx4 v2, s[8:11], s23 offen offset:896 lds
    s_add_u32 s23, s23, 1024
    s_bitcmp1_b32 s23, 11
    s_cselect_b32 s60, 0xf800, 0
    s_add_u32 s23, s23, s60
    s_add_u32 s20, s20, 32768
    s_cmp_ge_u32 s20, 163840
    s_cselect_b32 s60, 163840, 0
    s_sub_u32 s20, s20, s60
    v_add_u32 v8, 0xfffe0000, v8
    v_add_u32 v9, 0xfffe0000, v9
    ds_read_b64_tr_b16 a[160:161], v8 offset:0
    ds_read_b64_tr_b16 a[162:163], v8 offset:1024
    ds_read_b64_tr_b16 a[164:165], v9 offset:0
    ds_read_b64_tr_b16 a[166:167], v9 offset:1024
    ds_read_b64_tr_b16 a[168:169], v8 offset:8192
    ds_read_b64_tr_b16 a[170:171], v8 offset:9216
    ds_read_b64_tr_b16 a[172:173], v9 offset:8192
    ds_read_b64_tr_b16 a[174:175], v9 offset:9216
    s_waitcnt lgkmcnt(0)
    ds_read_b64_tr_b16 a[176:177], v8 offset:16384
    ds_read_b64_tr_b16 a[178:179], v8 offset:17408
    ds_read_b64_tr_b16 a[180:181], v9 offset:16384
    ds_read_b64_tr_b16 a[182:183], v9 offset:17408
    ds_read_b64_tr_b16 a[184:185], v8 offset:24576
    ds_read_b64_tr_b16 a[186:187], v8 offset:25600
    ds_read_b64_tr_b16 a[188:189], v9 offset:24576
    ds_read_b64_tr_b16 a[190:191], v9 offset:25600
    s_waitcnt lgkmcnt(0)
    s_waitcnt vmcnt(24)
    s_barrier
    s_add_u32 m0, s20, 0
    s_nop 0
    buffer_load_dwordx4 v2, s[8:11], s23 offen offset:0 lds
    s_add_u32 m0, s20, 3968
    s_nop 0
    buffer_load_dwordx4 v2, s[8:11], s23 offen offset:128 lds
    s_add_u32 m0, s20, 7936
    s_nop 0
    buffer_load_dwordx4 v2, s[8:11], s23 offen offset:256 lds
    s_add_u32 m0, s20, 11904
    s_nop 0
    buffer_load_dwordx4 v2, s[8:11], s23 offen offset:384 lds
    s_add_u32 m0, s20, 15872
    s_nop 0
    buffer_load_dwordx4 v2, s[8:11], s23 offen offset:512 lds
    s_add_u32 m0, s20, 19840
    s_nop 0
    buffer_load_dwordx4 v2, s[8:11], s23 offen offset:640 lds
    s_add_u32 m0, s20, 23808
    s_nop 0
    buffer_load_dwordx4 v2, s[8:11], s23 offen offset:768 lds
    s_add_u32 m0, s20, 27776
    s_nop 0
    buffer_load_dwordx4 v2, s[8:11], s23 offen offset:896 lds
    s_add_u32 s23, s23, 1024
    s_bitcmp1_b32 s23, 11
    s_cselect_b32 s60, 0xf800, 0
    s_add_u32 s23, s23, s60
    s_add_u32 s20, s20, 32768
    s_cmp_ge_u32 s20, 163840
    s_cselect_b32 s60, 163840, 0
    s_sub_u32 s20, s20, s60
    ds_read_b64_tr_b16 a[192:193], v8 offset:32768
    ds_read_b64_tr_b16 a[194:195], v8 offset:33792
    ds_read_b64_tr_b16 a[196:197], v9 offset:32768
    ds_read_b64_tr_b16 a[198:199], v9 offset:33792
    ds_read_b64_tr_b16 a[200:201], v8 offset:40960
    ds_read_b64_tr_b16 a[202:203], v8 offset:41984
    ds_read_b64_tr_b16 a[204:205], v9 offset:40960
    ds_read_b64_tr_b16 a[206:207], v9 offset:41984
    s_waitcnt lgkmcnt(0)
    ds_read_b64_tr_b16 a[208:209], v8 offset:49152
    ds_read_b64_tr_b16 a[210:211], v8 offset:50176
    ds_read_b64_tr_b16 a[212:213], v9 offset:49152
    ds_read_b64_tr_b16 a[214:215], v9 offset:50176
    ds_read_b64_tr_b16 a[216:217], v8 offset:57344
    ds_read_b64_tr_b16 a[218:219], v8 offset:58368
    ds_read_b64_tr_b16 a[220:221], v9 offset:57344
    ds_read_b64_tr_b16 a[222:223], v9 offset:58368
    s_waitcnt lgkmcnt(0)
    s_waitcnt vmcnt(24)
    s_barrier
    v_add_u32 v8, 0x10000, v8
    v_add_u32 v9, 0x10000, v9
    ds_read_b64_tr_b16 a[224:225], v8 offset:0
    ds_read_b64_tr_b16 a[226:227], v8 offset:1024
    ds_read_b64_tr_b16 a[228:229], v9 offset:0
    ds_read_b64_tr_b16 a[230:231], v9 offset:1024
    ds_read_b64_tr_b16 a[232:233], v8 offset:8192
    ds_read_b64_tr_b16 a[234:235], v8 offset:9216
    ds_read_b64_tr_b16 a[236:237], v9 offset:8192
    ds_read_b64_tr_b16 a[238:239], v9 offset:9216
    s_waitcnt lgkmcnt(0)
    ds_read_b64_tr_b16 a[240:241], v8 offset:16384
    ds_read_b64_tr_b16 a[242:243], v8 offset:17408
    ds_read_b64_tr_b16 a[244:245], v9 offset:16384
    ds_read_b64_tr_b16 a[246:247], v9 offset:17408
    ds_read_b64_tr_b16 a[248:249], v8 offset:24576
    ds_read_b64_tr_b16 a[250:251], v8 offset:25600
    ds_read_b64_tr_b16 a[252:253], v9 offset:24576
    ds_read_b64_tr_b16 a[254:255], v9 offset:25600
    s_waitcnt lgkmcnt(0)
    s_waitcnt vmcnt(16)
    s_barrier
    s_mov_b32 s62, 0
L_pp_38:
    v_readfirstlane_b32 s59, v11
    s_and_b32 s60, s59, 0xff
    s_cmp_ge_u32 s60, 15
    s_cbranch_scc1 L_pok_39
    v_mov_b32 v24, 4
    global_load_dword v11, v24, s[98:99] sc1
    s_add_u32 s62, s62, 1
    s_cmp_gt_u32 s62, 0x200000
    s_cbranch_scc1 chain_kernel_wabort
    s_waitcnt vmcnt(0)
    s_branch L_pp_38
L_pok_39:
    s_cmp_ge_u32 s59, 0x800
    s_cselect_b32 s59, 0x2000, 0
    s_xor_b32 s31, s31, s59
    s_xor_b32 s30, s30, s59
    s_mov_b32 s24, 0
    s_mov_b32 s18, 0
    s_cmp_eq_u32 s56, 3
    s_cbranch_scc1 L_kvv_40
    ds_read_b128 v[72:75], v4 offset:0
    ds_read_b128 v[76:79], v4 offset:2048
    ds_read_b128 v[80:83], v5 offset:0
    ds_read_b128 v[84:87], v5 offset:2048
    ds_read_b128 v[88:91], v4 offset:4096
    ds_read_b128 v[92:95], v4 offset:6144
    s_mov_b32 s34, 0x808088a8
    s_mov_b32 s35, 0x40808080
    s_cmp_eq_u32 s58, 0
    s_cselect_b32 s33, s27, 0x400000
    s_mov_b32 s25, 0
    s_mov_b32 s26, 0
kvsk:
    s_waitcnt lgkmcnt(4)
    v_mfma_f32_16x16x32_bf16 v[32:35], a[0:3], v[72:75], 0
    ds_read_b128 v[96:99], v5 offset:4096
    v_mfma_f32_16x16x32_bf16 v[36:39], a[4:7], v[72:75], 0
    ds_read_b128 v[100:103], v5 offset:6144
    v_mfma_f32_16x16x32_bf16 v[44:47], a[4:7], v[76:79], 0
    v_mfma_f32_16x16x32_bf16 v[40:43], a[0:3], v[76:79], 0
    v_cvt_pk_bf16_f32 v64, v48, v49
    s_waitcnt lgkmcnt(4)
    v_mfma_f32_16x16x32_bf16 v[32:35], a[8:11], v[80:83], v[32:35]
    ds_read_b128 v[72:75], v4 offset:8192
    v_cvt_pk_bf16_f32 v65, v50, v51
    v_mfma_f32_16x16x32_bf16 v[36:39], a[12:15], v[80:83], v[36:39]
    ds_read_b128 v[76:79], v4 offset:10240
    v_cvt_pk_bf16_f32 v66, v52, v53
    v_mfma_f32_16x16x32_bf16 v[44:47], a[12:15], v[84:87], v[44:47]
    v_cvt_pk_bf16_f32 v67, v54, v55
    v_cvt_pk_bf16_f32 v68, v56, v57
    v_mfma_f32_16x16x32_bf16 v[40:43], a[8:11], v[84:87], v[40:43]
    v_cvt_pk_bf16_f32 v69, v58, v59
    s_waitcnt lgkmcnt(4)
    v_mfma_f32_16x16x32_bf16 v[32:35], a[16:19], v[88:91], v[32:35]
    ds_read_b128 v[80:83], v5 offset:8192
    v_cvt_pk_bf16_f32 v70, v60, v61
    v_mfma_f32_16x16x32_bf16 v[36:39], a[20:23], v[88:91], v[36:39]
    ds_read_b128 v[84:87], v5 offset:10240
    v_cvt_pk_bf16_f32 v71, v62, v63
    v_mfma_f32_16x16x32_bf16 v[44:47], a[20:23], v[92:95], v[44:47]
    buffer_store_dwordx4 v[64:67], v1, s[16:19], s25 offen sc1
    v_mfma_f32_16x16x32_bf16 v[40:43], a[16:19], v[92:95], v[40:43]
    s_waitcnt lgkmcnt(4)
    v_mfma_f32_16x16x32_bf16 v[32:35], a[24:27], v[96:99], v[32:35]
    ds_read_b128 v[88:91], v4 offset:12288
    buffer_store_dwordx4 v[68:71], v12, s[16:19], s25 offen sc1
    v_mfma_f32_16x16x32_bf16 v[36:39], a[28:31], v[96:99], v[36:39]
    ds_read_b128 v[92:95], v4 offset:14336
    v_mfma_f32_16x16x32_bf16 v[44:47], a[28:31], v[100:103], v[44:47]
    v_mfma_f32_16x16x32_bf16 v[40:43], a[24:27], v[100:103], v[40:43]
    s_waitcnt lgkmcnt(4)
    v_mfma_f32_16x16x32_bf16 v[32:35], a[32:35], v[72:75], v[32:35]
    ds_read_b128 v[96:99], v5 offset:12288
    buffer_store_dwordx4 v[28:31], v1, s[16:19], s26 offen sc1
    v_mfma_f32_16x16x32_bf16 v[36:39], a[36:39], v[72:75], v[36:39]
    ds_read_b128 v[100:103], v5 offset:14336
    buffer_load_dword v13, v10, s[8:11], s33 offen
    v_mfma_f32_16x16x32_bf16 v[44:47], a[36:39], v[76:79], v[44:47]
    v_mfma_f32_16x16x32_bf16 v[40:43], a[32:35], v[76:79], v[40:43]
    s_waitcnt lgkmcnt(4)
    v_mfma_f32_16x16x32_bf16 v[32:35], a[40:43], v[80:83], v[32:35]
    ds_read_b128 v[72:75], v4 offset:16384
    v_mfma_f32_16x16x32_bf16 v[36:39], a[44:47], v[80:83], v[36:39]
    ds_read_b128 v[76:79], v4 offset:18432
    v_mfma_f32_16x16x32_bf16 v[44:47], a[44:47], v[84:87], v[44:47]
    s_add_u32 m0, s20, 0
    v_mfma_f32_16x16x32_bf16 v[40:43], a[40:43], v[84:87], v[40:43]
    buffer_load_dwordx4 v2, s[8:11], s23 offen offset:0 lds
    s_waitcnt lgkmcnt(4)
    v_mfma_f32_16x16x32_bf16 v[32:35], a[48:51], v[88:91], v[32:35]
    ds_read_b128 v[80:83], v5 offset:16384
    v_mfma_f32_16x16x32_bf16 v[36:39], a[52:55], v[88:91], v[36:39]
    ds_read_b128 v[84:87], v5 offset:18432
    s_add_u32 m0, s20, 3968
    v_mfma_f32_16x16x32_bf16 v[44:47], a[52:55], v[92:95], v[44:47]
    buffer_load_dwordx4 v2, s[8:11], s23 offen offset:128 lds
    v_mfma_f32_16x16x32_bf16 v[40:43], a[48:51], v[92:95], v[40:43]
    s_waitcnt lgkmcnt(4)
    v_mfma_f32_16x16x32_bf16 v[32:35], a[56:59], v[96:99], v[32:35]
    ds_read_b128 v[88:91], v4 offset:20480
    s_add_u32 m0, s20, 7936
    v_mfma_f32_16x16x32_bf16 v[36:39], a[60:63], v[96:99], v[36:39]
    ds_read_b128 v[92:95], v4 offset:22528
    buffer_load_dwordx4 v2, s[8:11], s23 offen offset:256 lds
    v_mfma_f32_16x16x32_bf16 v[44:47], a[60:63], v[100:103], v[44:47]
    v_mfma_f32_16x16x32_bf16 v[40:43], a[56:59], v[100:103], v[40:43]
    s_add_u32 m0, s20, 11904
    s_waitcnt lgkmcnt(4)
    v_mfma_f32_16x16x32_bf16 v[32:35], a[64:67], v[72:75], v[32:35]
    ds_read_b128 v[96:99], v5 offset:20480
    buffer_load_dwordx4 v2, s[8:11], s23 offen offset:384 lds
    v_mfma_f32_16x16x32_bf16 v[36:39], a[68:71], v[72:75], v[36:39]
    ds_read_b128 v[100:103], v5 offset:22528
    v_mfma_f32_16x16x32_bf16 v[44:47], a[68:71], v[76:79], v[44:47]
    s_add_u32 m0, s20, 15872
    v_mfma_f32_16x16x32_bf16 v[40:43], a[64:67], v[76:79], v[40:43]
    buffer_load_dwordx4 v2, s[8:11], s23 offen offset:512 lds
    s_waitcnt lgkmcnt(4)
    v_mfma_f32_16x16x32_bf16 v[32:35], a[72:75], v[80:83], v[32:35]
    ds_read_b128 v[72:75], v4 offset:24576
    v_mfma_f32_16x16x32_bf16 v[36:39], a[76:79], v[80:83], v[36:39]
    ds_read_b128 v[76:79], v4 offset:26624
    s_add_u32 m0, s20, 19840
    v_mfma_f32_16x16x32_bf16 v[44:47], a[76:79], v[84:87], v[44:47]
    buffer_load_dwordx4 v2, s[8:11], s23 offen offset:640 lds
    v_mfma_f32_16x16x32_bf16 v[40:43], a[72:75], v[84:87], v[40:43]
    s_waitcnt lgkmcnt(4)
    v_mfma_f32_16x16x32_bf16 v[32:35], a[80:83], v[88:91], v[32:35]
    ds_read_b128 v[80:83], v5 offset:24576
    s_add_u32 m0, s20, 23808
    v_mfma_f32_16x16x32_bf16 v[36:39], a[84:87], v[88:91], v[36:39]
    ds_read_b128 v[84:87], v5 offset:26624
    buffer_load_dwordx4 v2, s[8:11], s23 offen offset:768 lds
    v_mfma_f32_16x16x32_bf16 v[44:47], a[84:87], v[92:95], v[44:47]
    s_cmp_ge_u32 s21, 131072
    s_cselect_b32 s22, 0xfffe0000, s29
    v_mfma_f32_16x16x32_bf16 v[40:43], a[80:83], v[92:95], v[40:43]
    s_add_u32 s21, s21, s22
    s_waitcnt lgkmcnt(4)
    v_mfma_f32_16x16x32_bf16 v[32:35], a[88:91], v[96:99], v[32:35]
    ds_read_b128 v[88:91], v4 offset:28672
    s_add_u32 m0, s20, 27776
    v_mfma_f32_16x16x32_bf16 v[36:39], a[92:95], v[96:99], v[36:39]
    ds_read_b128 v[92:95], v4 offset:30720
    buffer_load_dwordx4 v2, s[8:11], s23 offen offset:896 lds
    v_mfma_f32_16x16x32_bf16 v[44:47], a[92:95], v[100:103], v[44:47]
    v_add_u32 v4, s22, v4
    v_mfma_f32_16x16x32_bf16 v[40:43], a[88:91], v[100:103], v[40:43]
    s_waitcnt lgkmcnt(4)
    v_mfma_f32_16x16x32_bf16 v[32:35], a[96:99], v[72:75], v[32:35]
    ds_read_b128 v[96:99], v5 offset:28672
    v_mfma_f32_16x16x32_bf16 v[36:39], a[100:103], v[72:75], v[36:39]
    ds_read_b128 v[100:103], v5 offset:30720
    v_mfma_f32_16x16x32_bf16 v[44:47], a[100:103], v[76:79], v[44:47]
    v_add_u32 v5, s22, v5
    s_cmp_lt_u32 s24, 4
    v_mfma_f32_16x16x32_bf16 v[40:43], a[96:99], v[76:79], v[40:43]
    s_waitcnt vmcnt(20)
    s_cbranch_scc1 kvsk_early
    s_barrier
kvsk_mid:
    s_waitcnt lgkmcnt(4)
    v_mfma_f32_16x16x32_bf16 v[32:35], a[104:107], v[80:83], v[32:35]
    ds_read_b128 v[72:75], v4 offset:0
    s_add_u32 s23, s23, 1024
    v_mfma_f32_16x16x32_bf16 v[36:39], a[108:111], v[80:83], v[36:39]
    ds_read_b128 v[76:79], v4 offset:2048
    s_bitcmp1_b32 s23, 11
    v_mfma_f32_16x16x32_bf16 v[44:47], a[108:111], v[84:87], v[44:47]
    s_cselect_b32 s60, 0xf800, 0
    s_add_u32 s23, s23, s60
    v_mfma_f32_16x16x32_bf16 v[40:43], a[104:107], v[84:87], v[40:43]
    s_add_u32 s20, s20, 32768
    s_waitcnt lgkmcnt(4)
    v_mfma_f32_16x16x32_bf16 v[32:35], a[112:115], v[88:91], v[32:35]
    ds_read_b128 v[80:83], v5 offset:0
    s_cmp_ge_u32 s20, 163840
    v_mfma_f32_16x16x32_bf16 v[36:39], a[116:119], v[88:91], v[36:39]
    ds_read_b128 v[84:87], v5 offset:2048
    s_cselect_b32 s60, 163840, 0
    v_mfma_f32_16x16x32_bf16 v[44:47], a[116:119], v[92:95], v[44:47]
    s_sub_u32 s20, s20, s60
    v_mfma_f32_16x16x32_bf16 v[40:43], a[112:115], v[92:95], v[40:43]
    s_waitcnt lgkmcnt(4)
    v_mfma_f32_16x16x32_bf16 v[32:35], a[120:123], v[96:99], v[32:35]
    ds_read_b128 v[88:91], v4 offset:4096
    v_mfma_f32_16x16x32_bf16 v[36:39], a[124:127], v[96:99], v[36:39]
    ds_read_b128 v[92:95], v4 offset:6144
    v_mfma_f32_16x16x32_bf16 v[44:47], a[124:127], v[100:103], v[44:47]
    v_mfma_f32_16x16x32_bf16 v[40:43], a[120:123], v[100:103], v[40:43]
    s_waitcnt lgkmcnt(4)
    v_mfma_f32_16x16x32_bf16 v[32:35], a[128:131], v[72:75], v[32:35]
    ds_read_b128 v[96:99], v5 offset:4096
    s_mov_b32 s18, 0xa000000
    v_mfma_f32_16x16x32_bf16 v[36:39], a[132:135], v[72:75], v[36:39]
    ds_read_b128 v[100:103], v5 offset:6144
    v_mfma_f32_16x16x32_bf16 v[44:47], a[132:135], v[76:79], v[44:47]
    s_add_u32 m0, s20, 0
    v_mfma_f32_16x16x32_bf16 v[40:43], a[128:131], v[76:79], v[40:43]
    buffer_load_dwordx4 v2, s[8:11], s23 offen offset:0 lds
    s_waitcnt lgkmcnt(4)
    v_mfma_f32_16x16x32_bf16 v[32:35], a[136:139], v[80:83], v[32:35]
    ds_read_b128 v[72:75], v4 offset:8192
    s_lshl_b32 s25, s24, 21
    v_mfma_f32_16x16x32_bf16 v[36:39], a[140:143], v[80:83], v[36:39]
    ds_read_b128 v[76:79], v4 offset:10240
    s_lshl_b32 s62, s24, 13
    v_mfma_f32_16x16x32_bf16 v[44:47], a[140:143], v[84:87], v[44:47]
    s_and_b32 s62, s62, 0x2000
    v_mfma_f32_16x16x32_bf16 v[40:43], a[136:139], v[84:87], v[40:43]
    s_add_u32 m0, s20, 3968
    s_waitcnt lgkmcnt(4)
    v_mfma_f32_16x16x32_bf16 v[32:35], a[144:147], v[88:91], v[32:35]
    ds_read_b128 v[80:83], v5 offset:8192
    buffer_load_dwordx4 v2, s[8:11], s23 offen offset:128 lds
    v_mfma_f32_16x16x32_bf16 v[36:39], a[148:151], v[88:91], v[36:39]
    ds_read_b128 v[84:87], v5 offset:10240
    s_xor_b32 s62, s62, s30
    v_mfma_f32_16x16x32_bf16 v[44:47], a[148:151], v[92:95], v[44:47]
    s_add_u32 s25, s25, s62
    s_lshl_b32 s26, s24, 19
    v_mfma_f32_16x16x32_bf16 v[40:43], a[144:147], v[92:95], v[40:43]
    s_waitcnt lgkmcnt(4)
    v_mfma_f32_16x16x32_bf16 v[32:35], a[152:155], v[96:99], v[32:35]
    ds_read_b128 v[88:91], v4 offset:12288
    s_add_u32 m0, s20, 7936
    v_mfma_f32_16x16x32_bf16 v[36:39], a[156:159], v[96:99], v[36:39]
    ds_read_b128 v[92:95], v4 offset:14336
    buffer_load_dwordx4 v2, s[8:11], s23 offen offset:256 lds
    v_mfma_f32_16x16x32_bf16 v[44:47], a[156:159], v[100:103], v[44:47]
    s_lshl_b32 s62, s24, 11
    s_and_b32 s62, s62, 0x2000
    v_mfma_f32_16x16x32_bf16 v[40:43], a[152:155], v[100:103], v[40:43]
    s_waitcnt lgkmcnt(4)
    v_mfma_f32_16x16x32_bf16 v[32:35], a[160:163], v[72:75], v[32:35]
    ds_read_b128 v[96:99], v5 offset:12288
    v_mfma_f32_16x16x32_bf16 v[36:39], a[164:167], v[72:75], v[36:39]
    ds_read_b128 v[100:103], v5 offset:14336
    s_add_u32 m0, s20, 11904
    v_mfma_f32_16x16x32_bf16 v[44:47], a[164:167], v[76:79], v[44:47]
    buffer_load_dwordx4 v2, s[8:11], s23 offen offset:384 lds
    v_mfma_f32_16x16x32_bf16 v[40:43], a[160:163], v[76:79], v[40:43]
    s_xor_b32 s62, s62, s31
    s_waitcnt lgkmcnt(4)
    v_mfma_f32_16x16x32_bf16 v[32:35], a[168:171], v[80:83], v[32:35]
    ds_read_b128 v[72:75], v4 offset:16384
    s_add_u32 s26, s26, s62
    v_mfma_f32_16x16x32_bf16 v[36:39], a[172:175], v[80:83], v[36:39]
    ds_read_b128 v[76:79], v4 offset:18432
    v_mfma_f32_16x16x32_bf16 v[44:47], a[172:175], v[84:87], v[44:47]
    s_add_u32 m0, s20, 15872
    v_mfma_f32_16x16x32_bf16 v[40:43], a[168:171], v[84:87], v[40:43]
    buffer_load_dwordx4 v2, s[8:11], s23 offen offset:512 lds
    s_waitcnt lgkmcnt(4)
    v_mfma_f32_16x16x32_bf16 v[32:35], a[176:179], v[88:91], v[32:35]
    ds_read_b128 v[80:83], v5 offset:16384
    s_add_u32 s27, s27, 0x10000
    v_mfma_f32_16x16x32_bf16 v[36:39], a[180:183], v[88:91], v[36:39]
    ds_read_b128 v[84:87], v5 offset:18432
    s_andn2_b32 s61, 3, s24
    v_mfma_f32_16x16x32_bf16 v[44:47], a[180:183], v[92:95], v[44:47]
    s_or_b32 s61, s61, s58
    s_cselect_b32 s33, 0x400000, s27
    v_mfma_f32_16x16x32_bf16 v[40:43], a[176:179], v[92:95], v[40:43]
    s_add_u32 m0, s20, 19840
    s_waitcnt lgkmcnt(4)
    v_mfma_f32_16x16x32_bf16 v[32:35], a[184:187], v[96:99], v[32:35]
    ds_read_b128 v[88:91], v4 offset:20480
    buffer_load_dwordx4 v2, s[8:11], s23 offen offset:640 lds
    v_mfma_f32_16x16x32_bf16 v[36:39], a[188:191], v[96:99], v[36:39]
    ds_read_b128 v[92:95], v4 offset:22528
    v_mfma_f32_16x16x32_bf16 v[44:47], a[188:191], v[100:103], v[44:47]
    v_mfma_f32_16x16x32_bf16 v[40:43], a[184:187], v[100:103], v[40:43]
    s_waitcnt lgkmcnt(4)
    v_mfma_f32_16x16x32_bf16 v[32:35], a[192:195], v[72:75], v[32:35]
    ds_read_b128 v[96:99], v5 offset:20480
    s_add_u32 m0, s20, 23808
    v_mfma_f32_16x16x32_bf16 v[36:39], a[196:199], v[72:75], v[36:39]
    ds_read_b128 v[100:103], v5 offset:22528
    buffer_load_dwordx4 v2, s[8:11], s23 offen offset:768 lds
    v_mfma_f32_16x16x32_bf16 v[44:47], a[196:199], v[76:79], v[44:47]
    s_cmp_ge_u32 s21, 131072
    s_cselect_b32 s22, 0xfffe0000, s29
    v_mfma_f32_16x16x32_bf16 v[40:43], a[192:195], v[76:79], v[40:43]
    s_add_u32 s21, s21, s22
    s_waitcnt lgkmcnt(4)
    v_mfma_f32_16x16x32_bf16 v[32:35], a[200:203], v[80:83], v[32:35]
    ds_read_b128 v[72:75], v4 offset:24576
    v_mfma_f32_16x16x32_bf16 v[36:39], a[204:207], v[80:83], v[36:39]
    ds_read_b128 v[76:79], v4 offset:26624
    s_add_u32 m0, s20, 27776
    v_mfma_f32_16x16x32_bf16 v[44:47], a[204:207], v[84:87], v[44:47]
    buffer_load_dwordx4 v2, s[8:11], s23 offen offset:896 lds
    v_mfma_f32_16x16x32_bf16 v[40:43], a[200:203], v[84:87], v[40:43]
    s_waitcnt lgkmcnt(4)
    v_mfma_f32_16x16x32_bf16 v[32:35], a[208:211], v[88:91], v[32:35]
    ds_read_b128 v[80:83], v5 offset:24576
    v_mfma_f32_16x16x32_bf16 v[36:39], a[212:215], v[88:91], v[36:39]
    ds_read_b128 v[84:87], v5 offset:26624
    v_mfma_f32_16x16x32_bf16 v[44:47], a[212:215], v[92:95], v[44:47]
    v_mfma_f32_16x16x32_bf16 v[40:43], a[208:211], v[92:95], v[40:43]
    s_waitcnt lgkmcnt(4)
    v_mfma_f32_16x16x32_bf16 v[32:35], a[216:219], v[96:99], v[32:35]
    ds_read_b128 v[88:91], v4 offset:28672
    v_mfma_f32_16x16x32_bf16 v[36:39], a[220:223], v[96:99], v[36:39]
    ds_read_b128 v[92:95], v4 offset:30720
    v_mfma_f32_16x16x32_bf16 v[44:47], a[220:223], v[100:103], v[44:47]
    v_add_u32 v4, s22, v4
    v_mfma_f32_16x16x32_bf16 v[40:43], a[216:219], v[100:103], v[40:43]
    s_waitcnt lgkmcnt(4)
    v_mfma_f32_16x16x32_bf16 v[32:35], a[224:227], v[72:75], v[32:35]
    ds_read_b128 v[96:99], v5 offset:28672
    v_mfma_f32_16x16x32_bf16 v[36:39], a[228:231], v[72:75], v[36:39]
    ds_read_b128 v[100:103], v5 offset:30720
    v_mfma_f32_16x16x32_bf16 v[44:47], a[228:231], v[76:79], v[44:47]
    v_add_u32 v5, s22, v5
    v_mfma_f32_16x16x32_bf16 v[40:43], a[224:227], v[76:79], v[40:43]
    s_waitcnt vmcnt(16)
    s_barrier
    s_waitcnt lgkmcnt(4)
    v_mfma_f32_16x16x32_bf16 v[32:35], a[232:235], v[80:83], v[32:35]
    ds_read_b128 v[72:75], v4 offset:0
    s_add_u32 s23, s23, 1024
    v_mfma_f32_16x16x32_bf16 v[36:39], a[236:239], v[80:83], v[36:39]
    ds_read_b128 v[76:79], v4 offset:2048
    s_bitcmp1_b32 s23, 11
    v_mfma_f32_16x16x32_bf16 v[44:47], a[236:239], v[84:87], v[44:47]
    s_cselect_b32 s60, 0xf800, 0
    s_add_u32 s23, s23, s60
    v_mfma_f32_16x16x32_bf16 v[40:43], a[232:235], v[84:87], v[40:43]
    s_add_u32 s20, s20, 32768
    s_waitcnt lgkmcnt(4)
    v_mfma_f32_16x16x32_bf16 v[32:35], a[240:243], v[88:91], v[32:35]
    ds_read_b128 v[80:83], v5 offset:0
    s_cmp_ge_u32 s20, 163840
    v_mfma_f32_16x16x32_bf16 v[36:39], a[244:247], v[88:91], v[36:39]
    ds_read_b128 v[84:87], v5 offset:2048
    s_cselect_b32 s60, 163840, 0
    v_mfma_f32_16x16x32_bf16 v[44:47], a[244:247], v[92:95], v[44:47]
    s_sub_u32 s20, s20, s60
    s_add_u32 s24, s24, 1
    v_mfma_f32_16x16x32_bf16 v[40:43], a[240:243], v[92:95], v[40:43]
    s_sub_u32 s61, s24, 2
    s_waitcnt lgkmcnt(4)
    v_mfma_f32_16x16x32_bf16 v[48:51], a[248:251], v[96:99], v[32:35]
    ds_read_b128 v[88:91], v4 offset:4096
    s_bitcmp1_b64 s[34:35], s61
    v_mfma_f32_16x16x32_bf16 v[52:55], a[252:255], v[96:99], v[36:39]
    ds_read_b128 v[92:95], v4 offset:6144
    v_mfma_f32_16x16x32_bf16 v[60:63], a[252:255], v[100:103], v[44:47]
    v_mfma_f32_16x16x32_bf16 v[56:59], a[248:251], v[100:103], v[40:43]
    s_cbranch_scc0 kvsk
    s_cmp_eq_u32 s24, 64
    s_cbranch_scc1 kvsk_fin
    s_cmp_lg_u32 s58, 0
    s_cbranch_scc1 kvsk
    s_bfm_b64 s[62:63], s61, 0
    s_and_b32 s62, s62, 0x808088af
    s_and_b32 s63, s63, 0x80808080
    s_bcnt1_i32_b64 s60, s[62:63]
    s_lshl_b32 s60, s60, 2
    s_add_u32 s60, s60, 64
    v_mov_b32 v24, s60
    v_mov_b32 v25, 1
    s_mov_b64 exec, 1
    global_atomic_add v24, v25, s[98:99] sc1
    s_mov_b64 exec, -1
    s_branch kvsk
kvsk_early:
    s_waitcnt vmcnt(8)
    s_barrier
    s_cmp_eq_u32 s24, 0
    s_cbranch_scc1 kvsk_mid
    s_cmp_lg_u32 s58, 0
    s_cbranch_scc1 kvsk_mid
    s_lshl_b32 s60, s24, 2
    s_add_u32 s60, s60, 60
    v_mov_b32 v24, s60
    v_mov_b32 v25, 1
    s_mov_b64 exec, 1
    global_atomic_add v24, v25, s[98:99] sc1
    s_mov_b64 exec, -1
    s_branch kvsk_mid
kvsk_fin:
    s_nop 7
    v_cvt_pk_bf16_f32 v64, v48, v49
    v_cvt_pk_bf16_f32 v65, v50, v51
    v_cvt_pk_bf16_f32 v66, v52, v53
    v_cvt_pk_bf16_f32 v67, v54, v55
    v_cvt_pk_bf16_f32 v68, v56, v57
    v_cvt_pk_bf16_f32 v69, v58, v59
    v_cvt_pk_bf16_f32 v70, v60, v61
    v_cvt_pk_bf16_f32 v71, v62, v63
    buffer_store_dwordx4 v[64:67], v1, s[16:19], s25 offen sc1
    buffer_store_dwordx4 v[68:71], v12, s[16:19], s25 offen sc1
    buffer_store_dwordx4 v[28:31], v1, s[16:19], s26 offen sc1
    s_waitcnt vmcnt(0) lgkmcnt(0)
    s_barrier
    s_cmp_lg_u32 s58, 0
    s_cbranch_scc1 L_kve_41
    s_mov_b32 s60, 116
    v_mov_b32 v24, s60
    v_mov_b32 v25, 1
    s_mov_b64 exec, 1
    global_atomic_add v24, v25, s[98:99] sc1
    s_mov_b64 exec, -1
    s_branch L_kve_41
L_kvv_40:
    ds_read_b128 v[72:75], v4 offset:0
    ds_read_b128 v[76:79], v4 offset:2048
    ds_read_b128 v[80:83], v5 offset:0
    ds_read_b128 v[84:87], v5 offset:2048
    ds_read_b128 v[88:91], v4 offset:4096
    ds_read_b128 v[92:95], v4 offset:6144
    s_mov_b32 s34, 0x808088a8
    s_mov_b32 s35, 0x40808080
    s_cmp_eq_u32 s58, 0
    s_cselect_b32 s33, s27, 0x400000
    s_mov_b32 s25, 0
    s_mov_b32 s26, 0
kvsv:
    s_waitcnt lgkmcnt(4)
    v_mfma_f32_16x16x32_bf16 v[32:35], v[72:75], a[0:3], 0
    ds_read_b128 v[96:99], v5 offset:4096
    v_mfma_f32_16x16x32_bf16 v[40:43], v[72:75], a[4:7], 0
    ds_read_b128 v[100:103], v5 offset:6144
    v_mfma_f32_16x16x32_bf16 v[44:47], v[76:79], a[4:7], 0
    v_mfma_f32_16x16x32_bf16 v[36:39], v[76:79], a[0:3], 0
    v_cvt_pk_bf16_f32 v64, v48, v49
    s_waitcnt lgkmcnt(4)
    v_mfma_f32_16x16x32_bf16 v[32:35], v[80:83], a[8:11], v[32:35]
    ds_read_b128 v[72:75], v4 offset:8192
    v_cvt_pk_bf16_f32 v65, v50, v51
    v_mfma_f32_16x16x32_bf16 v[40:43], v[80:83], a[12:15], v[40:43]
    ds_read_b128 v[76:79], v4 offset:10240
    v_cvt_pk_bf16_f32 v66, v52, v53
    v_mfma_f32_16x16x32_bf16 v[44:47], v[84:87], a[12:15], v[44:47]
    v_cvt_pk_bf16_f32 v67, v54, v55
    v_cvt_pk_bf16_f32 v68, v56, v57
    v_mfma_f32_16x16x32_bf16 v[36:39], v[84:87], a[8:11], v[36:39]
    v_cvt_pk_bf16_f32 v69, v58, v59
    s_waitcnt lgkmcnt(4)
    v_mfma_f32_16x16x32_bf16 v[32:35], v[88:91], a[16:19], v[32:35]
    ds_read_b128 v[80:83], v5 offset:8192
    v_cvt_pk_bf16_f32 v70, v60, v61
    v_mfma_f32_16x16x32_bf16 v[40:43], v[88:91], a[20:23], v[40:43]
    ds_read_b128 v[84:87], v5 offset:10240
    v_cvt_pk_bf16_f32 v71, v62, v63
    v_mfma_f32_16x16x32_bf16 v[44:47], v[92:95], a[20:23], v[44:47]
    buffer_store_dwordx4 v[64:67], v1, s[16:19], s25 offen sc1
    v_mfma_f32_16x16x32_bf16 v[36:39], v[92:95], a[16:19], v[36:39]
    s_waitcnt lgkmcnt(4)
    v_mfma_f32_16x16x32_bf16 v[32:35], v[96:99], a[24:27], v[32:35]
    ds_read_b128 v[88:91], v4 offset:12288
    buffer_store_dwordx4 v[68:71], v1, s[16:19], s25 offen offset:1024 sc1
    v_mfma_f32_16x16x32_bf16 v[40:43], v[96:99], a[28:31], v[40:43]
    ds_read_b128 v[92:95], v4 offset:14336
    v_mfma_f32_16x16x32_bf16 v[44:47], v[100:103], a[28:31], v[44:47]
    v_mfma_f32_16x16x32_bf16 v[36:39], v[100:103], a[24:27], v[36:39]
    s_waitcnt lgkmcnt(4)
    v_mfma_f32_16x16x32_bf16 v[32:35], v[72:75], a[32:35], v[32:35]
    ds_read_b128 v[96:99], v5 offset:12288
    buffer_store_dwordx4 v[28:31], v1, s[16:19], s26 offen sc1
    v_mfma_f32_16x16x32_bf16 v[40:43], v[72:75], a[36:39], v[40:43]
    ds_read_b128 v[100:103], v5 offset:14336
    buffer_load_dword v13, v10, s[8:11], s33 offen
    v_mfma_f32_16x16x32_bf16 v[44:47], v[76:79], a[36:39], v[44:47]
    v_mfma_f32_16x16x32_bf16 v[36:39], v[76:79], a[32:35], v[36:39]
    s_waitcnt lgkmcnt(4)
    v_mfma_f32_16x16x32_bf16 v[32:35], v[80:83], a[40:43], v[32:35]
    ds_read_b128 v[72:75], v4 offset:16384
    v_mfma_f32_16x16x32_bf16 v[40:43], v[80:83], a[44:47], v[40:43]
    ds_read_b128 v[76:79], v4 offset:18432
    v_mfma_f32_16x16x32_bf16 v[44:47], v[84:87], a[44:47], v[44:47]
    s_add_u32 m0, s20, 0
    v_mfma_f32_16x16x32_bf16 v[36:39], v[84:87], a[40:43], v[36:39]
    buffer_load_dwordx4 v2, s[8:11], s23 offen offset:0 lds
    s_waitcnt lgkmcnt(4)
    v_mfma_f32_16x16x32_bf16 v[32:35], v[88:91], a[48:51], v[32:35]
    ds_read_b128 v[80:83], v5 offset:16384
    v_mfma_f32_16x16x32_bf16 v[40:43], v[88:91], a[52:55], v[40:43]
    ds_read_b128 v[84:87], v5 offset:18432
    s_add_u32 m0, s20, 3968
    v_mfma_f32_16x16x32_bf16 v[44:47], v[92:95], a[52:55], v[44:47]
    buffer_load_dwordx4 v2, s[8:11], s23 offen offset:128 lds
    v_mfma_f32_16x16x32_bf16 v[36:39], v[92:95], a[48:51], v[36:39]
    s_waitcnt lgkmcnt(4)
    v_mfma_f32_16x16x32_bf16 v[32:35], v[96:99], a[56:59], v[32:35]
    ds_read_b128 v[88:91], v4 offset:20480
    s_add_u32 m0, s20, 7936
    v_mfma_f32_16x16x32_bf16 v[40:43], v[96:99], a[60:63], v[40:43]
    ds_read_b128 v[92:95], v4 offset:22528
    buffer_load_dwordx4 v2, s[8:11], s23 offen offset:256 lds
    v_mfma_f32_16x16x32_bf16 v[44:47], v[100:103], a[60:63], v[44:47]
    v_mfma_f32_16x16x32_bf16 v[36:39], v[100:103], a[56:59], v[36:39]
    s_add_u32 m0, s20, 11904
    s_waitcnt lgkmcnt(4)
    v_mfma_f32_16x16x32_bf16 v[32:35], v[72:75], a[64:67], v[32:35]
    ds_read_b128 v[96:99], v5 offset:20480
    buffer_load_dwordx4 v2, s[8:11], s23 offen offset:384 lds
    v_mfma_f32_16x16x32_bf16 v[40:43], v[72:75], a[68:71], v[40:43]
    ds_read_b128 v[100:103], v5 offset:22528
    v_mfma_f32_16x16x32_bf16 v[44:47], v[76:79], a[68:71], v[44:47]
    s_add_u32 m0, s20, 15872
    v_mfma_f32_16x16x32_bf16 v[36:39], v[76:79], a[64:67], v[36:39]
    buffer_load_dwordx4 v2, s[8:11], s23 offen offset:512 lds
    s_waitcnt lgkmcnt(4)
    v_mfma_f32_16x16x32_bf16 v[32:35], v[80:83], a[72:75], v[32:35]
    ds_read_b128 v[72:75], v4 offset:24576
    v_mfma_f32_16x16x32_bf16 v[40:43], v[80:83], a[76:79], v[40:43]
    ds_read_b128 v[76:79], v4 offset:26624
    s_add_u32 m0, s20, 19840
    v_mfma_f32_16x16x32_bf16 v[44:47], v[84:87], a[76:79], v[44:47]
    buffer_load_dwordx4 v2, s[8:11], s23 offen offset:640 lds
    v_mfma_f32_16x16x32_bf16 v[36:39], v[84:87], a[72:75], v[36:39]
    s_waitcnt lgkmcnt(4)
    v_mfma_f32_16x16x32_bf16 v[32:35], v[88:91], a[80:83], v[32:35]
    ds_read_b128 v[80:83], v5 offset:24576
    s_add_u32 m0, s20, 23808
    v_mfma_f32_16x16x32_bf16 v[40:43], v[88:91], a[84:87], v[40:43]
    ds_read_b128 v[84:87], v5 offset:26624
    buffer_load_dwordx4 v2, s[8:11], s23 offen offset:768 lds
    v_mfma_f32_16x16x32_bf16 v[44:47], v[92:95], a[84:87], v[44:47]
    s_cmp_ge_u32 s21, 131072
    s_cselect_b32 s22, 0xfffe0000, s29
    v_mfma_f32_16x16x32_bf16 v[36:39], v[92:95], a[80:83], v[36:39]
    s_add_u32 s21, s21, s22
    s_waitcnt lgkmcnt(4)
    v_mfma_f32_16x16x32_bf16 v[32:35], v[96:99], a[88:91], v[32:35]
    ds_read_b128 v[88:91], v4 offset:28672
    s_add_u32 m0, s20, 27776
    v_mfma_f32_16x16x32_bf16 v[40:43], v[96:99], a[92:95], v[40:43]
    ds_read_b128 v[92:95], v4 offset:30720
    buffer_load_dwordx4 v2, s[8:11], s23 offen offset:896 lds
    v_mfma_f32_16x16x32_bf16 v[44:47], v[100:103], a[92:95], v[44:47]
    v_add_u32 v4, s22, v4
    v_mfma_f32_16x16x32_bf16 v[36:39], v[100:103], a[88:91], v[36:39]
    s_waitcnt lgkmcnt(4)
    v_mfma_f32_16x16x32_bf16 v[32:35], v[72:75], a[96:99], v[32:35]
    ds_read_b128 v[96:99], v5 offset:28672
    v_mfma_f32_16x16x32_bf16 v[40:43], v[72:75], a[100:103], v[40:43]
    ds_read_b128 v[100:103], v5 offset:30720
    v_mfma_f32_16x16x32_bf16 v[44:47], v[76:79], a[100:103], v[44:47]
    v_add_u32 v5, s22, v5
    s_cmp_lt_u32 s24, 4
    v_mfma_f32_16x16x32_bf16 v[36:39], v[76:79], a[96:99], v[36:39]
    s_waitcnt vmcnt(20)
    s_cbranch_scc1 kvsv_early
    s_barrier
kvsv_mid:
    s_waitcnt lgkmcnt(4)
    v_mfma_f32_16x16x32_bf16 v[32:35], v[80:83], a[104:107], v[32:35]
    ds_read_b128 v[72:75], v4 offset:0
    s_add_u32 s23, s23, 1024
    v_mfma_f32_16x16x32_bf16 v[40:43], v[80:83], a[108:111], v[40:43]
    ds_read_b128 v[76:79], v4 offset:2048
    s_bitcmp1_b32 s23, 11
    v_mfma_f32_16x16x32_bf16 v[44:47], v[84:87], a[108:111], v[44:47]
    s_cselect_b32 s60, 0xf800, 0
    s_add_u32 s23, s23, s60
    v_mfma_f32_16x16x32_bf16 v[36:39], v[84:87], a[104:107], v[36:39]
    s_add_u32 s20, s20, 32768
    s_waitcnt lgkmcnt(4)
    v_mfma_f32_16x16x32_bf16 v[32:35], v[88:91], a[112:115], v[32:35]
    ds_read_b128 v[80:83], v5 offset:0
    s_cmp_ge_u32 s20, 163840
    v_mfma_f32_16x16x32_bf16 v[40:43], v[88:91], a[116:119], v[40:43]
    ds_read_b128 v[84:87], v5 offset:2048
    s_cselect_b32 s60, 163840, 0
    v_mfma_f32_16x16x32_bf16 v[44:47], v[92:95], a[116:119], v[44:47]
    s_sub_u32 s20, s20, s60
    v_mfma_f32_16x16x32_bf16 v[36:39], v[92:95], a[112:115], v[36:39]
    s_waitcnt lgkmcnt(4)
    v_mfma_f32_16x16x32_bf16 v[32:35], v[96:99], a[120:123], v[32:35]
    ds_read_b128 v[88:91], v4 offset:4096
    v_mfma_f32_16x16x32_bf16 v[40:43], v[96:99], a[124:127], v[40:43]
    ds_read_b128 v[92:95], v4 offset:6144
    v_mfma_f32_16x16x32_bf16 v[44:47], v[100:103], a[124:127], v[44:47]
    v_mfma_f32_16x16x32_bf16 v[36:39], v[100:103], a[120:123], v[36:39]
    s_waitcnt lgkmcnt(4)
    v_mfma_f32_16x16x32_bf16 v[32:35], v[72:75], a[128:131], v[32:35]
    ds_read_b128 v[96:99], v5 offset:4096
    s_mov_b32 s18, 0xa000000
    v_mfma_f32_16x16x32_bf16 v[40:43], v[72:75], a[132:135], v[40:43]
    ds_read_b128 v[100:103], v5 offset:6144
    v_mfma_f32_16x16x32_bf16 v[44:47], v[76:79], a[132:135], v[44:47]
    s_add_u32 m0, s20, 0
    v_mfma_f32_16x16x32_bf16 v[36:39], v[76:79], a[128:131], v[36:39]
    buffer_load_dwordx4 v2, s[8:11], s23 offen offset:0 lds
    s_waitcnt lgkmcnt(4)
    v_mfma_f32_16x16x32_bf16 v[32:35], v[80:83], a[136:139], v[32:35]
    ds_read_b128 v[72:75], v4 offset:8192
    s_lshl_b32 s25, s24, 21
    v_mfma_f32_16x16x32_bf16 v[40:43], v[80:83], a[140:143], v[40:43]
    ds_read_b128 v[76:79], v4 offset:10240
    s_lshl_b32 s62, s24, 13
    v_mfma_f32_16x16x32_bf16 v[44:47], v[84:87], a[140:143], v[44:47]
    s_and_b32 s62, s62, 0x2000
    v_mfma_f32_16x16x32_bf16 v[36:39], v[84:87], a[136:139], v[36:39]
    s_add_u32 m0, s20, 3968
    s_waitcnt lgkmcnt(4)
    v_mfma_f32_16x16x32_bf16 v[32:35], v[88:91], a[144:147], v[32:35]
    ds_read_b128 v[80:83], v5 offset:8192
    buffer_load_dwordx4 v2, s[8:11], s23 offen offset:128 lds
    v_mfma_f32_16x16x32_bf16 v[40:43], v[88:91], a[148:151], v[40:43]
    ds_read_b128 v[84:87], v5 offset:10240
    s_xor_b32 s62, s62, s30
    v_mfma_f32_16x16x32_bf16 v[44:47], v[92:95], a[148:151], v[44:47]
    s_add_u32 s25, s25, s62
    s_lshl_b32 s26, s24, 19
    v_mfma_f32_16x16x32_bf16 v[36:39], v[92:95], a[144:147], v[36:39]
    s_waitcnt lgkmcnt(4)
    v_mfma_f32_16x16x32_bf16 v[32:35], v[96:99], a[152:155], v[32:35]
    ds_read_b128 v[88:91], v4 offset:12288
    s_add_u32 m0, s20, 7936
    v_mfma_f32_16x16x32_bf16 v[40:43], v[96:99], a[156:159], v[40:43]
    ds_read_b128 v[92:95], v4 offset:14336
    buffer_load_dwordx4 v2, s[8:11], s23 offen offset:256 lds
    v_mfma_f32_16x16x32_bf16 v[44:47], v[100:103], a[156:159], v[44:47]
    s_lshl_b32 s62, s24, 11
    s_and_b32 s62, s62, 0x2000
    v_mfma_f32_16x16x32_bf16 v[36:39], v[100:103], a[152:155], v[36:39]
    s_waitcnt lgkmcnt(4)
    v_mfma_f32_16x16x32_bf16 v[32:35], v[72:75], a[160:163], v[32:35]
    ds_read_b128 v[96:99], v5 offset:12288
    v_mfma_f32_16x16x32_bf16 v[40:43], v[72:75], a[164:167], v[40:43]
    ds_read_b128 v[100:103], v5 offset:14336
    s_add_u32 m0, s20, 11904
    v_mfma_f32_16x16x32_bf16 v[44:47], v[76:79], a[164:167], v[44:47]
    buffer_load_dwordx4 v2, s[8:11], s23 offen offset:384 lds
    v_mfma_f32_16x16x32_bf16 v[36:39], v[76:79], a[160:163], v[36:39]
    s_xor_b32 s62, s62, s31
    s_waitcnt lgkmcnt(4)
    v_mfma_f32_16x16x32_bf16 v[32:35], v[80:83], a[168:171], v[32:35]
    ds_read_b128 v[72:75], v4 offset:16384
    s_add_u32 s26, s26, s62
    v_mfma_f32_16x16x32_bf16 v[40:43], v[80:83], a[172:175], v[40:43]
    ds_read_b128 v[76:79], v4 offset:18432
    v_mfma_f32_16x16x32_bf16 v[44:47], v[84:87], a[172:175], v[44:47]
    s_add_u32 m0, s20, 15872
    v_mfma_f32_16x16x32_bf16 v[36:39], v[84:87], a[168:171], v[36:39]
    buffer_load_dwordx4 v2, s[8:11], s23 offen offset:512 lds
    s_waitcnt lgkmcnt(4)
    v_mfma_f32_16x16x32_bf16 v[32:35], v[88:91], a[176:179], v[32:35]
    ds_read_b128 v[80:83], v5 offset:16384
    s_add_u32 s27, s27, 0x10000
    v_mfma_f32_16x16x32_bf16 v[40:43], v[88:91], a[180:183], v[40:43]
    ds_read_b128 v[84:87], v5 offset:18432
    s_andn2_b32 s61, 3, s24
    v_mfma_f32_16x16x32_bf16 v[44:47], v[92:95], a[180:183], v[44:47]
    s_or_b32 s61, s61, s58
    s_cselect_b32 s33, 0x400000, s27
    v_mfma_f32_16x16x32_bf16 v[36:39], v[92:95], a[176:179], v[36:39]
    s_add_u32 m0, s20, 19840
    s_waitcnt lgkmcnt(4)
    v_mfma_f32_16x16x32_bf16 v[32:35], v[96:99], a[184:187], v[32:35]
    ds_read_b128 v[88:91], v4 offset:20480
    buffer_load_dwordx4 v2, s[8:11], s23 offen offset:640 lds
    v_mfma_f32_16x16x32_bf16 v[40:43], v[96:99], a[188:191], v[40:43]
    ds_read_b128 v[92:95], v4 offset:22528
    v_mfma_f32_16x16x32_bf16 v[44:47], v[100:103], a[188:191], v[44:47]
    v_mfma_f32_16x16x32_bf16 v[36:39], v[100:103], a[184:187], v[36:39]
    s_waitcnt lgkmcnt(4)
    v_mfma_f32_16x16x32_bf16 v[32:35], v[72:75], a[192:195], v[32:35]
    ds_read_b128 v[96:99], v5 offset:20480
    s_add_u32 m0, s20, 23808
    v_mfma_f32_16x16x32_bf16 v[40:43], v[72:75], a[196:199], v[40:43]
    ds_read_b128 v[100:103], v5 offset:22528
    buffer_load_dwordx4 v2, s[8:11], s23 offen offset:768 lds
    v_mfma_f32_16x16x32_bf16 v[44:47], v[76:79], a[196:199], v[44:47]
    s_cmp_ge_u32 s21, 131072
    s_cselect_b32 s22, 0xfffe0000, s29
    v_mfma_f32_16x16x32_bf16 v[36:39], v[76:79], a[192:195], v[36:39]
    s_add_u32 s21, s21, s22
    s_waitcnt lgkmcnt(4)
    v_mfma_f32_16x16x32_bf16 v[32:35], v[80:83], a[200:203], v[32:35]
    ds_read_b128 v[72:75], v4 offset:24576
    v_mfma_f32_16x16x32_bf16 v[40:43], v[80:83], a[204:207], v[40:43]
    ds_read_b128 v[76:79], v4 offset:26624
    s_add_u32 m0, s20, 27776
    v_mfma_f32_16x16x32_bf16 v[44:47], v[84:87], a[204:207], v[44:47]
    buffer_load_dwordx4 v2, s[8:11], s23 offen offset:896 lds
    v_mfma_f32_16x16x32_bf16 v[36:39], v[84:87], a[200:203], v[36:39]
    s_waitcnt lgkmcnt(4)
    v_mfma_f32_16x16x32_bf16 v[32:35], v[88:91], a[208:211], v[32:35]
    ds_read_b128 v[80:83], v5 offset:24576
    v_mfma_f32_16x16x32_bf16 v[40:43], v[88:91], a[212:215], v[40:43]
    ds_read_b128 v[84:87], v5 offset:26624
    v_mfma_f32_16x16x32_bf16 v[44:47], v[92:95], a[212:215], v[44:47]
    v_mfma_f32_16x16x32_bf16 v[36:39], v[92:95], a[208:211], v[36:39]
    s_waitcnt lgkmcnt(4)
    v_mfma_f32_16x16x32_bf16 v[32:35], v[96:99], a[216:219], v[32:35]
    ds_read_b128 v[88:91], v4 offset:28672
    v_mfma_f32_16x16x32_bf16 v[40:43], v[96:99], a[220:223], v[40:43]
    ds_read_b128 v[92:95], v4 offset:30720
    v_mfma_f32_16x16x32_bf16 v[44:47], v[100:103], a[220:223], v[44:47]
    v_add_u32 v4, s22, v4
    v_mfma_f32_16x16x32_bf16 v[36:39], v[100:103], a[216:219], v[36:39]
    s_waitcnt lgkmcnt(4)
    v_mfma_f32_16x16x32_bf16 v[32:35], v[72:75], a[224:227], v[32:35]
    ds_read_b128 v[96:99], v5 offset:28672
    v_mfma_f32_16x16x32_bf16 v[40:43], v[72:75], a[228:231], v[40:43]
    ds_read_b128 v[100:103], v5 offset:30720
    v_mfma_f32_16x16x32_bf16 v[44:47], v[76:79], a[228:231], v[44:47]
    v_add_u32 v5, s22, v5
    v_mfma_f32_16x16x32_bf16 v[36:39], v[76:79], a[224:227], v[36:39]
    s_waitcnt vmcnt(16)
    s_barrier
    s_waitcnt lgkmcnt(4)
    v_mfma_f32_16x16x32_bf16 v[32:35], v[80:83], a[232:235], v[32:35]
    ds_read_b128 v[72:75], v4 offset:0
    s_add_u32 s23, s23, 1024
    v_mfma_f32_16x16x32_bf16 v[40:43], v[80:83], a[236:239], v[40:43]
    ds_read_b128 v[76:79], v4 offset:2048
    s_bitcmp1_b32 s23, 11
    v_mfma_f32_16x16x32_bf16 v[44:47], v[84:87], a[236:239], v[44:47]
    s_cselect_b32 s60, 0xf800, 0
    s_add_u32 s23, s23, s60
    v_mfma_f32_16x16x32_bf16 v[36:39], v[84:87], a[232:235], v[36:39]
    s_add_u32 s20, s20, 32768
    s_waitcnt lgkmcnt(4)
    v_mfma_f32_16x16x32_bf16 v[32:35], v[88:91], a[240:243], v[32:35]
    ds_read_b128 v[80:83], v5 offset:0
    s_cmp_ge_u32 s20, 163840
    v_mfma_f32_16x16x32_bf16 v[40:43], v[88:91], a[244:247], v[40:43]
    ds_read_b128 v[84:87], v5 offset:2048
    s_cselect_b32 s60, 163840, 0
    v_mfma_f32_16x16x32_bf16 v[44:47], v[92:95], a[244:247], v[44:47]
    s_sub_u32 s20, s20, s60
    s_add_u32 s24, s24, 1
    v_mfma_f32_16x16x32_bf16 v[36:39], v[92:95], a[240:243], v[36:39]
    s_sub_u32 s61, s24, 2
    s_waitcnt lgkmcnt(4)
    v_mfma_f32_16x16x32_bf16 v[48:51], v[96:99], a[248:251], v[32:35]
    ds_read_b128 v[88:91], v4 offset:4096
    s_bitcmp1_b64 s[34:35], s61
    v_mfma_f32_16x16x32_bf16 v[56:59], v[96:99], a[252:255], v[40:43]
    ds_read_b128 v[92:95], v4 offset:6144
    v_mfma_f32_16x16x32_bf16 v[60:63], v[100:103], a[252:255], v[44:47]
    v_mfma_f32_16x16x32_bf16 v[52:55], v[100:103], a[248:251], v[36:39]
    s_cbranch_scc0 kvsv
    s_cmp_eq_u32 s24, 64
    s_cbranch_scc1 kvsv_fin
    s_cmp_lg_u32 s58, 0
    s_cbranch_scc1 kvsv
    s_bfm_b64 s[62:63], s61, 0
    s_and_b32 s62, s62, 0x808088af
    s_and_b32 s63, s63, 0x80808080
    s_bcnt1_i32_b64 s60, s[62:63]
    s_lshl_b32 s60, s60, 2
    s_add_u32 s60, s60, 64
    v_mov_b32 v24, s60
    v_mov_b32 v25, 1
    s_mov_b64 exec, 1
    global_atomic_add v24, v25, s[98:99] sc1
    s_mov_b64 exec, -1
    s_branch kvsv
kvsv_early:
    s_waitcnt vmcnt(8)
    s_barrier
    s_cmp_eq_u32 s24, 0
    s_cbranch_scc1 kvsv_mid
    s_cmp_lg_u32 s58, 0
    s_cbranch_scc1 kvsv_mid
    s_lshl_b32 s60, s24, 2
    s_add_u32 s60, s60, 60
    v_mov_b32 v24, s60
    v_mov_b32 v25, 1
    s_mov_b64 exec, 1
    global_atomic_add v24, v25, s[98:99] sc1
    s_mov_b64 exec, -1
    s_branch kvsv_mid
kvsv_fin:
    s_nop 7
    v_cvt_pk_bf16_f32 v64, v48, v49
    v_cvt_pk_bf16_f32 v65, v50, v51
    v_cvt_pk_bf16_f32 v66, v52, v53
    v_cvt_pk_bf16_f32 v67, v54, v55
    v_cvt_pk_bf16_f32 v68, v56, v57
    v_cvt_pk_bf16_f32 v69, v58, v59
    v_cvt_pk_bf16_f32 v70, v60, v61
    v_cvt_pk_bf16_f32 v71, v62, v63
    buffer_store_dwordx4 v[64:67], v1, s[16:19], s25 offen sc1
    buffer_store_dwordx4 v[68:71], v1, s[16:19], s25 offen offset:1024 sc1
    buffer_store_dwordx4 v[28:31], v1, s[16:19], s26 offen sc1
    s_waitcnt vmcnt(0) lgkmcnt(0)
    s_barrier
    s_cmp_lg_u32 s58, 0
    s_cbranch_scc1 L_kve_41
    s_mov_b32 s60, 116
    v_mov_b32 v24, s60
    v_mov_b32 v25, 1
    s_mov_b64 exec, 1
    global_atomic_add v24, v25, s[98:99] sc1
    s_mov_b64 exec, -1
    s_branch L_kve_41
L_kve_41:
    s_branch chain_kernel_seg
L_big_37:
    v_and_b32 v24, 63, v0
    v_lshlrev_b32 v1, 4, v24
    v_mov_b32 v2, v1
    v_add_u32 v3, 1024, v1
    v_bfe_u32 v24, v0, 1, 3
    v_bfe_u32 v25, v0, 4, 2
    v_xor_b32 v24, v24, v25
    v_lshlrev_b32 v24, 4, v24
    v_and_b32 v25, 15, v0
    v_lshl_add_u32 v24, v25, 7, v24
    s_lshr_b32 s60, s58, 1
    s_lshl_b32 s60, s60, 14
    v_add_u32 v23, s60, v24
    s_and_b32 s60, s58, 1
    s_lshl_b32 s60, s60, 14
    s_add_u32 s60, s60, 32768
    v_add_u32 v12, s60, v24
    v_xor_b32 v13, 64, v12
    v_bfe_u32 v24, v0, 2, 3
    v_lshlrev_b32 v22, 5, v24
    v_and_b32 v24, 3, v0
    v_lshl_add_u32 v22, v24, 3, v22
    v_bfe_u32 v24, v0, 2, 2
    v_lshl_add_u32 v22, v24, 9, v22
    v_bfe_u32 v24, v0, 4, 2
    v_lshl_add_u32 v22, v24, 12, v22
    v_bfe_u32 v24, v0, 7, 1
    v_lshl_add_u32 v22, v24, 8, v22
    s_mov_b32 s49, 0
    s_mov_b32 s48, 32768
    s_lshl_b32 s45, s58, 12
    s_add_u32 s44, s45, 32768
    s_mov_b32 s11, 0x00020000
    s_mov_b32 s15, 0x00020000
    s_mov_b32 s19, 0x00020000
    s_and_b32 s0, s57, 3
    s_lshr_b32 s85, s57, 2
    s_mov_b32 s84, s0
    s_lshl_b32 s94, s85, 0
    s_lshl_b32 s60, s85, 19
    s_mov_b32 s30, s64
    s_and_b32 s31, s65, 0xffff
    s_mov_b32 s32, 0x400000
    s_mov_b32 s33, s60
    s_mov_b32 s34, 0x2000
    s_mov_b32 s35, 0x40000
    s_lshl_b32 s60, s0, 18
    s_mov_b32 s36, s70
    s_and_b32 s37, s71, 0xffff
    s_mov_b32 s38, 0x200000
    s_mov_b32 s39, s60
    s_mov_b32 s40, 0x8000
    s_mov_b32 s41, 0x20000
    s_mov_b32 s42, 0x80
    s_cmp_ge_u32 s58, 2
    s_cselect_b32 s36, s72, s70
    s_cselect_b32 s37, s73, s71
    s_and_b32 s37, s37, 0xffff
    v_bfe_u32 v24, v0, 4, 2
    v_and_b32 v25, 7, v0
    v_xor_b32 v24, v24, v25
    v_lshlrev_b32 v8, 4, v24
    v_bfe_u32 v24, v0, 3, 2
    v_lshl_add_u32 v8, v24, 11, v8
    v_bfe_u32 v24, v0, 5, 1
    v_lshl_add_u32 v8, v24, 16, v8
    v_lshrrev_b32 v24, 6, v0
    v_lshl_add_u32 v8, v24, 14, v8
    v_xor_b32 v9, 64, v8
    v_add_u32 v9, 0x20000, v9
    v_bfe_u32 v24, v0, 4, 2
    v_and_b32 v25, 7, v0
    v_xor_b32 v24, v24, v25
    v_lshlrev_b32 v10, 4, v24
    v_bfe_u32 v24, v0, 3, 3
    v_lshl_add_u32 v10, v24, 11, v10
    v_bfe_u32 v24, v0, 6, 1
    v_lshl_add_u32 v10, v24, 16, v10
    v_xor_b32 v11, 64, v10
    v_add_u32 v11, 0x4000, v11
    v_and_b32 v24, 15, v0
    v_bfe_u32 v25, v0, 7, 1
    v_lshl_add_u32 v24, v25, 6, v24
    v_lshlrev_b32 v24, 1, v24
    s_lshl_b32 s53, s0, 8
    s_mov_b32 s60, s66
    s_and_b32 s61, s67, 0xffff
    s_mov_b32 s62, 0x800
    s_mov_b32 s63, 0x00020000
    buffer_load_ushort v192, v24, s[60:63], s53 offen offset:0
    buffer_load_ushort v200, v24, s[60:63], s53 offen offset:32
    buffer_load_ushort v208, v24, s[60:63], s53 offen offset:64
    buffer_load_ushort v216, v24, s[60:63], s53 offen offset:96
    s_mov_b32 s60, s68
    s_and_b32 s61, s69, 0xffff
    s_mov_b32 s62, 0x800
    s_mov_b32 s63, 0x00020000
    buffer_load_ushort v193, v24, s[60:63], s53 offen offset:0
    buffer_load_ushort v201, v24, s[60:63], s53 offen offset:32
    buffer_load_ushort v209, v24, s[60:63], s53 offen offset:64
    buffer_load_ushort v217, v24, s[60:63], s53 offen offset:96
    s_mov_b32 s60, s78
    s_and_b32 s61, s79, 0xffff
    s_mov_b32 s62, 0x800
    s_mov_b32 s63, 0x00020000
    buffer_load_ushort v194, v24, s[60:63], s53 offen offset:0
    buffer_load_ushort v202, v24, s[60:63], s53 offen offset:32
    buffer_load_ushort v210, v24, s[60:63], s53 offen offset:64
    buffer_load_ushort v218, v24, s[60:63], s53 offen offset:96
    s_mov_b32 s6, 0xfffe8000
    s_mov_b32 s7, 65536
    s_mov_b32 s12, s36
    s_mov_b32 s13, s37
    s_mov_b32 s14, s38
    s_and_b32 s45, s45, 0xffffb7ff
    s_bitcmp1_b32 s94, 1
    s_cselect_b32 s24, s41, 0
    s_cselect_b32 s26, 0, s41
    s_cselect_b32 s60, 0x4000, 0
    s_or_b32 s45, s45, s60
    s_add_u32 s24, s24, s39
    s_add_u32 s26, s26, s39
    s_bitcmp1_b32 s94, 0
    s_cselect_b32 s61, s40, 0
    s_cselect_b32 s62, 0, s40
    s_cselect_b32 s60, 0x800, 0
    s_or_b32 s45, s45, s60
    s_add_u32 s25, s24, s62
    s_add_u32 s24, s24, s61
    s_add_u32 s27, s26, s62
    s_add_u32 s26, s26, s61
    s_mov_b32 s28, s42
    v_mov_b32 v6, v10
    v_mov_b32 v7, v11
    s_mov_b32 s8, s30
    s_mov_b32 s9, s31
    s_mov_b32 s10, s32
    s_and_b32 s44, s44, 0xffffb7ff
    s_bitcmp1_b32 s84, 1
    s_cselect_b32 s20, s35, 0
    s_cselect_b32 s22, 0, s35
    s_cselect_b32 s60, 0x4000, 0
    s_or_b32 s44, s44, s60
    s_add_u32 s20, s20, s33
    s_add_u32 s22, s22, s33
    s_bitcmp1_b32 s84, 0
    s_cselect_b32 s61, s34, 0
    s_cselect_b32 s62, 0, s34
    s_cselect_b32 s60, 0x800, 0
    s_or_b32 s44, s44, s60
    s_add_u32 s21, s20, s62
    s_add_u32 s20, s20, s61
    s_add_u32 s23, s22, s62
    s_add_u32 s22, s22, s61
    v_mov_b32 v4, v8
    v_mov_b32 v5, v9
    s_xor_b32 m0, s45, 0
    s_nop 0
    buffer_load_dwordx4 v6, s[12:15], s24 offen lds
    s_xor_b32 m0, s45, 1024
    s_nop 0
    buffer_load_dwordx4 v7, s[12:15], s24 offen lds
    s_xor_b32 m0, s45, 2048
    s_nop 0
    buffer_load_dwordx4 v6, s[12:15], s25 offen lds
    s_xor_b32 m0, s45, 3072
    s_nop 0
    buffer_load_dwordx4 v7, s[12:15], s25 offen lds
    s_xor_b32 m0, s45, 16384
    s_nop 0
    buffer_load_dwordx4 v6, s[12:15], s26 offen lds
    s_xor_b32 m0, s45, 17408
    s_nop 0
    buffer_load_dwordx4 v7, s[12:15], s26 offen lds
    s_xor_b32 m0, s45, 18432
    s_nop 0
    buffer_load_dwordx4 v6, s[12:15], s27 offen lds
    s_xor_b32 m0, s45, 19456
    s_nop 0
    buffer_load_dwordx4 v7, s[12:15], s27 offen lds
    s_add_u32 s24, s24, s28
    s_add_u32 s25, s25, s28
    s_add_u32 s26, s26, s28
    s_add_u32 s27, s27, s28
    s_cmp_ge_u32 s45, 98304
    s_cselect_b32 s60, s6, s7
    s_add_u32 s45, s45, s60
    s_xor_b32 m0, s44, 0
    s_nop 0
    buffer_load_dwordx4 v4, s[8:11], s20 offen lds
    s_xor_b32 m0, s44, 1024
    s_nop 0
    buffer_load_dwordx4 v5, s[8:11], s20 offen lds
    s_xor_b32 m0, s44, 2048
    s_nop 0
    buffer_load_dwordx4 v4, s[8:11], s21 offen lds
    s_xor_b32 m0, s44, 3072
    s_nop 0
    buffer_load_dwordx4 v5, s[8:11], s21 offen lds
    s_xor_b32 m0, s44, 16384
    s_nop 0
    buffer_load_dwordx4 v4, s[8:11], s22 offen lds
    s_xor_b32 m0, s44, 17408
    s_nop 0
    buffer_load_dwordx4 v5, s[8:11], s22 offen lds
    s_xor_b32 m0, s44, 18432
    s_nop 0
    buffer_load_dwordx4 v4, s[8:11], s23 offen lds
    s_xor_b32 m0, s44, 19456
    s_nop 0
    buffer_load_dwordx4 v5, s[8:11], s23 offen lds
    s_add_u32 s20, s20, 128
    s_add_u32 s21, s21, 128
    s_add_u32 s22, s22, 128
    s_add_u32 s23, s23, 128
    s_cmp_ge_u32 s44, 98304
    s_cselect_b32 s60, s6, s7
    s_add_u32 s44, s44, s60
    s_xor_b32 m0, s45, 0
    s_nop 0
    buffer_load_dwordx4 v6, s[12:15], s24 offen lds
    s_xor_b32 m0, s45, 1024
    s_nop 0
    buffer_load_dwordx4 v7, s[12:15], s24 offen lds
    s_xor_b32 m0, s45, 2048
    s_nop 0
    buffer_load_dwordx4 v6, s[12:15], s25 offen lds
    s_xor_b32 m0, s45, 3072
    s_nop 0
    buffer_load_dwordx4 v7, s[12:15], s25 offen lds
    s_xor_b32 m0, s45, 16384
    s_nop 0
    buffer_load_dwordx4 v6, s[12:15], s26 offen lds
    s_xor_b32 m0, s45, 17408
    s_nop 0
    buffer_load_dwordx4 v7, s[12:15], s26 offen lds
    s_xor_b32 m0, s45, 18432
    s_nop 0
    buffer_load_dwordx4 v6, s[12:15], s27 offen lds
    s_xor_b32 m0, s45, 19456
    s_nop 0
    buffer_load_dwordx4 v7, s[12:15], s27 offen lds
    s_add_u32 s24, s24, s28
    s_add_u32 s25, s25, s28
    s_add_u32 s26, s26, s28
    s_add_u32 s27, s27, s28
    s_cmp_ge_u32 s45, 98304
    s_cselect_b32 s60, s6, s7
    s_add_u32 s45, s45, s60
    s_add_u32 s39, s39, 0x100000
    s_mov_b32 s16, s100
    s_and_b32 s17, s101, 0xffff
    s_mov_b32 s18, 0xc000000
    s_mov_b32 s19, 0x00020000
    v_mov_b32 v32, -1
    v_mov_b32 v33, -1
    v_mov_b32 v34, -1
    v_mov_b32 v35, -1
    v_lshlrev_b32 v26, 4, v0
    s_lshl_b32 s60, s57, 12
    s_add_u32 s60, s60, 0xb100000
    buffer_store_dwordx4 v[32:35], v26, s[16:19], s60 offen sc1
    s_mov_b32 s18, 0
    s_waitcnt vmcnt(25)
    v_lshlrev_b32 v192, 16, v192
    v_lshlrev_b32 v200, 16, v200
    v_lshlrev_b32 v208, 16, v208
    v_lshlrev_b32 v216, 16, v216
    v_lshlrev_b32 v193, 16, v193
    v_lshlrev_b32 v201, 16, v201
    v_lshlrev_b32 v209, 16, v209
    v_lshlrev_b32 v217, 16, v217
    v_lshlrev_b32 v194, 16, v194
    v_lshlrev_b32 v202, 16, v202
    v_lshlrev_b32 v210, 16, v210
    v_lshlrev_b32 v218, 16, v218
    v_mul_f32 v194, 0x3fb8aa3b, v194
    v_mul_f32 v202, 0x3fb8aa3b, v202
    v_mul_f32 v210, 0x3fb8aa3b, v210
    v_mul_f32 v218, 0x3fb8aa3b, v218
    v_exp_f32 v194, v194
    v_exp_f32 v202, v202
    v_exp_f32 v210, v210
    v_exp_f32 v218, v218
    v_cvt_pk_bf16_f32 v194, 0, v194
    v_cvt_pk_bf16_f32 v202, 0, v202
    v_cvt_pk_bf16_f32 v210, 0, v210
    v_cvt_pk_bf16_f32 v218, 0, v218
    v_mul_f32 v195, v194, v192
    v_mul_f32 v203, v202, v200
    v_mul_f32 v211, v210, v208
    v_mul_f32 v219, v218, v216
    v_mul_f32 v196, v194, v193
    v_mul_f32 v204, v202, v201
    v_mul_f32 v212, v210, v209
    v_mul_f32 v220, v218, v217
    v_mul_f32 v195, 0x3fb8aa3b, v195
    v_mul_f32 v203, 0x3fb8aa3b, v203
    v_mul_f32 v211, 0x3fb8aa3b, v211
    v_mul_f32 v219, 0x3fb8aa3b, v219
    v_exp_f32 v195, v195
    v_exp_f32 v203, v203
    v_exp_f32 v211, v211
    v_exp_f32 v219, v219
    v_mul_f32 v196, 0x3e22f983, v196
    v_mul_f32 v204, 0x3e22f983, v204
    v_mul_f32 v212, 0x3e22f983, v212
    v_mul_f32 v220, 0x3e22f983, v220
    v_fract_f32 v196, v196
    v_fract_f32 v204, v204
    v_fract_f32 v212, v212
    v_fract_f32 v220, v220
    v_cos_f32 v197, v196
    v_cos_f32 v205, v204
    v_cos_f32 v213, v212
    v_cos_f32 v221, v220
    v_sin_f32 v198, v196
    v_sin_f32 v206, v204
    v_sin_f32 v214, v212
    v_sin_f32 v222, v220
    v_mul_f32 v88, v195, v197
    v_mul_f32 v90, v203, v205
    v_mul_f32 v92, v211, v213
    v_mul_f32 v94, v219, v221
    v_mul_f32 v89, v195, v198
    v_mul_f32 v91, v203, v206
    v_mul_f32 v93, v211, v214
    v_mul_f32 v95, v219, v222
    v_add_f32 v197, -1.0, v88
    v_add_f32 v205, -1.0, v90
    v_add_f32 v213, -1.0, v92
    v_add_f32 v221, -1.0, v94
    v_mul_f32 v198, v197, v192
    v_mul_f32 v206, v205, v200
    v_mul_f32 v214, v213, v208
    v_mul_f32 v222, v221, v216
    v_fma_f32 v198, v89, v193, v198
    v_fma_f32 v206, v91, v201, v206
    v_fma_f32 v214, v93, v209, v214
    v_fma_f32 v222, v95, v217, v222
    v_mul_f32 v199, v89, v192
    v_mul_f32 v207, v91, v200
    v_mul_f32 v215, v93, v208
    v_mul_f32 v223, v95, v216
    v_fma_f32 v199, -v197, v193, v199
    v_fma_f32 v207, -v205, v201, v207
    v_fma_f32 v215, -v213, v209, v215
    v_fma_f32 v223, -v221, v217, v223
    v_mul_f32 v195, v192, v192
    v_mul_f32 v203, v200, v200
    v_mul_f32 v211, v208, v208
    v_mul_f32 v219, v216, v216
    v_fma_f32 v195, v193, v193, v195
    v_fma_f32 v203, v201, v201, v203
    v_fma_f32 v211, v209, v209, v211
    v_fma_f32 v219, v217, v217, v219
    v_rcp_f32 v195, v195
    v_rcp_f32 v203, v203
    v_rcp_f32 v211, v211
    v_rcp_f32 v219, v219
    v_add_f32 v195, v195, v195
    v_add_f32 v203, v203, v203
    v_add_f32 v211, v211, v211
    v_add_f32 v219, v219, v219
    v_mul_f32 v96, v198, v195
    v_mul_f32 v98, v206, v203
    v_mul_f32 v100, v214, v211
    v_mul_f32 v102, v222, v219
    v_mul_f32 v97, v199, v195
    v_mul_f32 v99, v207, v203
    v_mul_f32 v101, v215, v211
    v_mul_f32 v103, v223, v219
    v_pk_mul_f32 v[192:193], v[88:89], v[88:89] op_sel:[0,0] op_sel_hi:[0,1]
    v_pk_mul_f32 v[200:201], v[90:91], v[90:91] op_sel:[0,0] op_sel_hi:[0,1]
    v_pk_mul_f32 v[208:209], v[92:93], v[92:93] op_sel:[0,0] op_sel_hi:[0,1]
    v_pk_mul_f32 v[216:217], v[94:95], v[94:95] op_sel:[0,0] op_sel_hi:[0,1]
    v_pk_fma_f32 v[104:105], v[88:89], v[88:89], v[192:193] op_sel:[1,1,0] op_sel_hi:[1,0,1] neg_lo:[1,0,0]
    v_pk_fma_f32 v[106:107], v[90:91], v[90:91], v[200:201] op_sel:[1,1,0] op_sel_hi:[1,0,1] neg_lo:[1,0,0]
    v_pk_fma_f32 v[108:109], v[92:93], v[92:93], v[208:209] op_sel:[1,1,0] op_sel_hi:[1,0,1] neg_lo:[1,0,0]
    v_pk_fma_f32 v[110:111], v[94:95], v[94:95], v[216:217] op_sel:[1,1,0] op_sel_hi:[1,0,1] neg_lo:[1,0,0]
    v_pk_mul_f32 v[192:193], v[104:105], v[104:105] op_sel:[0,0] op_sel_hi:[0,1]
    v_pk_mul_f32 v[200:201], v[106:107], v[106:107] op_sel:[0,0] op_sel_hi:[0,1]
    v_pk_mul_f32 v[208:209], v[108:109], v[108:109] op_sel:[0,0] op_sel_hi:[0,1]
    v_pk_mul_f32 v[216:217], v[110:111], v[110:111] op_sel:[0,0] op_sel_hi:[0,1]
    v_pk_fma_f32 v[104:105], v[104:105], v[104:105], v[192:193] op_sel:[1,1,0] op_sel_hi:[1,0,1] neg_lo:[1,0,0]
    v_pk_fma_f32 v[106:107], v[106:107], v[106:107], v[200:201] op_sel:[1,1,0] op_sel_hi:[1,0,1] neg_lo:[1,0,0]
    v_pk_fma_f32 v[108:109], v[108:109], v[108:109], v[208:209] op_sel:[1,1,0] op_sel_hi:[1,0,1] neg_lo:[1,0,0]
    v_pk_fma_f32 v[110:111], v[110:111], v[110:111], v[216:217] op_sel:[1,1,0] op_sel_hi:[1,0,1] neg_lo:[1,0,0]
    v_pk_mul_f32 v[192:193], v[104:105], v[104:105] op_sel:[0,0] op_sel_hi:[0,1]
    v_pk_mul_f32 v[200:201], v[106:107], v[106:107] op_sel:[0,0] op_sel_hi:[0,1]
    v_pk_mul_f32 v[208:209], v[108:109], v[108:109] op_sel:[0,0] op_sel_hi:[0,1]
    v_pk_mul_f32 v[216:217], v[110:111], v[110:111] op_sel:[0,0] op_sel_hi:[0,1]
    v_pk_fma_f32 v[104:105], v[104:105], v[104:105], v[192:193] op_sel:[1,1,0] op_sel_hi:[1,0,1] neg_lo:[1,0,0]
    v_pk_fma_f32 v[106:107], v[106:107], v[106:107], v[200:201] op_sel:[1,1,0] op_sel_hi:[1,0,1] neg_lo:[1,0,0]
    v_pk_fma_f32 v[108:109], v[108:109], v[108:109], v[208:209] op_sel:[1,1,0] op_sel_hi:[1,0,1] neg_lo:[1,0,0]
    v_pk_fma_f32 v[110:111], v[110:111], v[110:111], v[216:217] op_sel:[1,1,0] op_sel_hi:[1,0,1] neg_lo:[1,0,0]
    v_pk_mul_f32 v[192:193], v[104:105], v[104:105] op_sel:[0,0] op_sel_hi:[0,1]
    v_pk_mul_f32 v[200:201], v[106:107], v[106:107] op_sel:[0,0] op_sel_hi:[0,1]
    v_pk_mul_f32 v[208:209], v[108:109], v[108:109] op_sel:[0,0] op_sel_hi:[0,1]
    v_pk_mul_f32 v[216:217], v[110:111], v[110:111] op_sel:[0,0] op_sel_hi:[0,1]
    v_pk_fma_f32 v[104:105], v[104:105], v[104:105], v[192:193] op_sel:[1,1,0] op_sel_hi:[1,0,1] neg_lo:[1,0,0]
    v_pk_fma_f32 v[106:107], v[106:107], v[106:107], v[200:201] op_sel:[1,1,0] op_sel_hi:[1,0,1] neg_lo:[1,0,0]
    v_pk_fma_f32 v[108:109], v[108:109], v[108:109], v[208:209] op_sel:[1,1,0] op_sel_hi:[1,0,1] neg_lo:[1,0,0]
    v_pk_fma_f32 v[110:111], v[110:111], v[110:111], v[216:217] op_sel:[1,1,0] op_sel_hi:[1,0,1] neg_lo:[1,0,0]
    v_pk_mul_f32 v[192:193], v[104:105], v[104:105] op_sel:[0,0] op_sel_hi:[0,1]
    v_pk_mul_f32 v[200:201], v[106:107], v[106:107] op_sel:[0,0] op_sel_hi:[0,1]
    v_pk_mul_f32 v[208:209], v[108:109], v[108:109] op_sel:[0,0] op_sel_hi:[0,1]
    v_pk_mul_f32 v[216:217], v[110:111], v[110:111] op_sel:[0,0] op_sel_hi:[0,1]
    v_pk_fma_f32 v[104:105], v[104:105], v[104:105], v[192:193] op_sel:[1,1,0] op_sel_hi:[1,0,1] neg_lo:[1,0,0]
    v_pk_fma_f32 v[106:107], v[106:107], v[106:107], v[200:201] op_sel:[1,1,0] op_sel_hi:[1,0,1] neg_lo:[1,0,0]
    v_pk_fma_f32 v[108:109], v[108:109], v[108:109], v[208:209] op_sel:[1,1,0] op_sel_hi:[1,0,1] neg_lo:[1,0,0]
    v_pk_fma_f32 v[110:111], v[110:111], v[110:111], v[216:217] op_sel:[1,1,0] op_sel_hi:[1,0,1] neg_lo:[1,0,0]
    v_pk_mul_f32 v[192:193], v[104:105], v[104:105] op_sel:[0,0] op_sel_hi:[0,1]
    v_pk_mul_f32 v[200:201], v[106:107], v[106:107] op_sel:[0,0] op_sel_hi:[0,1]
    v_pk_mul_f32 v[208:209], v[108:109], v[108:109] op_sel:[0,0] op_sel_hi:[0,1]
    v_pk_mul_f32 v[216:217], v[110:111], v[110:111] op_sel:[0,0] op_sel_hi:[0,1]
    v_pk_fma_f32 v[112:113], v[104:105], v[104:105], v[192:193] op_sel:[1,1,0] op_sel_hi:[1,0,1] neg_lo:[1,0,0]
    v_pk_fma_f32 v[114:115], v[106:107], v[106:107], v[200:201] op_sel:[1,1,0] op_sel_hi:[1,0,1] neg_lo:[1,0,0]
    v_pk_fma_f32 v[116:117], v[108:109], v[108:109], v[208:209] op_sel:[1,1,0] op_sel_hi:[1,0,1] neg_lo:[1,0,0]
    v_pk_fma_f32 v[118:119], v[110:111], v[110:111], v[216:217] op_sel:[1,1,0] op_sel_hi:[1,0,1] neg_lo:[1,0,0]
    v_pk_mul_f32 v[192:193], v[112:113], v[112:113] op_sel:[0,0] op_sel_hi:[0,1]
    v_pk_mul_f32 v[200:201], v[114:115], v[114:115] op_sel:[0,0] op_sel_hi:[0,1]
    v_pk_mul_f32 v[208:209], v[116:117], v[116:117] op_sel:[0,0] op_sel_hi:[0,1]
    v_pk_mul_f32 v[216:217], v[118:119], v[118:119] op_sel:[0,0] op_sel_hi:[0,1]
    v_pk_fma_f32 v[196:197], v[112:113], v[112:113], v[192:193] op_sel:[1,1,0] op_sel_hi:[1,0,1] neg_lo:[1,0,0]
    v_pk_fma_f32 v[204:205], v[114:115], v[114:115], v[200:201] op_sel:[1,1,0] op_sel_hi:[1,0,1] neg_lo:[1,0,0]
    v_pk_fma_f32 v[212:213], v[116:117], v[116:117], v[208:209] op_sel:[1,1,0] op_sel_hi:[1,0,1] neg_lo:[1,0,0]
    v_pk_fma_f32 v[220:221], v[118:119], v[118:119], v[216:217] op_sel:[1,1,0] op_sel_hi:[1,0,1] neg_lo:[1,0,0]
    s_mov_b32 exec_lo, 0xffffffff
    s_mov_b32 exec_hi, 0xffffffff
    v_mov_b32 v120, v196
    v_mov_b32 v121, v197
    s_mov_b32 exec_lo, 0xffff0000
    s_mov_b32 exec_hi, 0xffffffff
    v_mov_b32 v120, v204
    v_mov_b32 v121, v205
    s_mov_b32 exec_lo, 0x0
    s_mov_b32 exec_hi, 0xffffffff
    v_mov_b32 v120, v212
    v_mov_b32 v121, v213
    s_mov_b32 exec_lo, 0x0
    s_mov_b32 exec_hi, 0xffff0000
    v_mov_b32 v120, v220
    v_mov_b32 v121, v221
    s_mov_b64 exec, -1
    s_cmp_eq_u32 s58, 0
    s_cselect_b32 s1, 20, 0
    s_mov_b32 s4, 0
    s_mov_b32 s3, 20
    s_mov_b32 s2, 32
    s_mov_b32 s50, 0
    s_mov_b32 s5, 0
    s_mov_b32 s51, 0
    s_mov_b32 s52, 0
    s_waitcnt vmcnt(9)
    s_barrier
    s_call_b64 s[54:55], t_g1
    v_mov_b32 v125, 0
    s_mov_b32 s62, 0
L_pp_42:
    v_readfirstlane_b32 s59, v125
    s_and_b32 s60, s59, 0xff
    s_cmp_ge_u32 s60, 15
    s_cbranch_scc1 L_pok_43
    v_mov_b32 v24, 4
    global_load_dword v125, v24, s[98:99] sc1
    s_add_u32 s62, s62, 1
    s_cmp_gt_u32 s62, 0x200000
    s_cbranch_scc1 chain_kernel_wabort
    s_waitcnt vmcnt(0)
    s_branch L_pp_42
L_pok_43:
    s_cmp_ge_u32 s59, 0x800
    s_cselect_b32 s59, 0x2000, 0
    s_call_b64 s[54:55], t_scan
    s_add_u32 s0, s0, 4
    v_and_b32 v24, 15, v0
    v_bfe_u32 v25, v0, 7, 1
    v_lshl_add_u32 v24, v25, 6, v24
    v_lshlrev_b32 v24, 1, v24
    s_lshl_b32 s53, s0, 8
    s_mov_b32 s60, s66
    s_and_b32 s61, s67, 0xffff
    s_mov_b32 s62, 0x800
    s_mov_b32 s63, 0x00020000
    buffer_load_ushort v40, v24, s[60:63], s53 offen offset:0
    buffer_load_ushort v48, v24, s[60:63], s53 offen offset:32
    buffer_load_ushort v56, v24, s[60:63], s53 offen offset:64
    buffer_load_ushort v64, v24, s[60:63], s53 offen offset:96
    s_mov_b32 s60, s68
    s_and_b32 s61, s69, 0xffff
    s_mov_b32 s62, 0x800
    s_mov_b32 s63, 0x00020000
    buffer_load_ushort v41, v24, s[60:63], s53 offen offset:0
    buffer_load_ushort v49, v24, s[60:63], s53 offen offset:32
    buffer_load_ushort v57, v24, s[60:63], s53 offen offset:64
    buffer_load_ushort v65, v24, s[60:63], s53 offen offset:96
    s_mov_b32 s60, s78
    s_and_b32 s61, s79, 0xffff
    s_mov_b32 s62, 0x800
    s_mov_b32 s63, 0x00020000
    buffer_load_ushort v42, v24, s[60:63], s53 offen offset:0
    buffer_load_ushort v50, v24, s[60:63], s53 offen offset:32
    buffer_load_ushort v58, v24, s[60:63], s53 offen offset:64
    buffer_load_ushort v66, v24, s[60:63], s53 offen offset:96
    s_and_b32 s62, s57, 7
    s_lshr_b32 s63, s57, 3
    s_lshl_b32 s60, s63, 19
    s_add_u32 s60, s60, 0
    s_mov_b32 s30, s74
    s_and_b32 s31, s75, 0xffff
    s_mov_b32 s32, 0x200000
    s_mov_b32 s33, s60
    s_mov_b32 s34, 0x8000
    s_mov_b32 s35, 0x40000
    s_lshl_b32 s61, s62, 13
    s_andn2_b32 s61, 0x2000, s61
    s_xor_b32 s61, s61, s59
    s_lshl_b32 s60, s62, 21
    s_add_u32 s60, s60, s61
    s_add_u32 s60, s60, 0x0
    s_add_u32 s36, s100, 0xa000000
    s_addc_u32 s37, s101, 0
    s_and_b32 s37, s37, 0xffff
    s_mov_b32 s38, 0x1000000
    s_mov_b32 s39, s60
    s_mov_b32 s40, 0x800
    s_mov_b32 s41, 0x8000
    s_mov_b32 s42, 0x10000
    s_mov_b32 s84, s62
    s_lshl_b32 s94, s63, 0
    v_bfe_u32 v24, v0, 4, 2
    v_and_b32 v25, 7, v0
    v_xor_b32 v24, v24, v25
    v_lshlrev_b32 v8, 4, v24
    v_bfe_u32 v24, v0, 3, 3
    v_lshl_add_u32 v8, v24, 11, v8
    v_bfe_u32 v24, v0, 6, 2
    v_lshl_add_u32 v8, v24, 16, v8
    v_xor_b32 v9, 64, v8
    v_add_u32 v9, 0x4000, v9
    s_lshr_b32 s61, s58, 1
    s_lshl_b32 s61, s61, 14
    v_add_u32 v10, s61, v1
    s_and_b32 s61, s58, 1
    s_lshl_b32 s61, s61, 12
    v_add_u32 v10, s61, v10
    v_add_u32 v11, 1024, v10
    s_mov_b32 s18, 0xc000000
    s_mov_b32 s4, 12
    s_mov_b32 s3, 12
    s_waitcnt vmcnt(0)
    v_lshlrev_b32 v40, 16, v40
    v_lshlrev_b32 v48, 16, v48
    v_lshlrev_b32 v56, 16, v56
    v_lshlrev_b32 v64, 16, v64
    v_lshlrev_b32 v41, 16, v41
    v_lshlrev_b32 v49, 16, v49
    v_lshlrev_b32 v57, 16, v57
    v_lshlrev_b32 v65, 16, v65
    v_lshlrev_b32 v42, 16, v42
    v_lshlrev_b32 v50, 16, v50
    v_lshlrev_b32 v58, 16, v58
    v_lshlrev_b32 v66, 16, v66
    v_mul_f32 v42, 0x3fb8aa3b, v42
    v_mul_f32 v50, 0x3fb8aa3b, v50
    v_mul_f32 v58, 0x3fb8aa3b, v58
    v_mul_f32 v66, 0x3fb8aa3b, v66
    v_exp_f32 v42, v42
    v_exp_f32 v50, v50
    v_exp_f32 v58, v58
    v_exp_f32 v66, v66
    v_cvt_pk_bf16_f32 v42, 0, v42
    v_cvt_pk_bf16_f32 v50, 0, v50
    v_cvt_pk_bf16_f32 v58, 0, v58
    v_cvt_pk_bf16_f32 v66, 0, v66
    v_mul_f32 v43, v42, v40
    v_mul_f32 v51, v50, v48
    v_mul_f32 v59, v58, v56
    v_mul_f32 v67, v66, v64
    v_mul_f32 v44, v42, v41
    v_mul_f32 v52, v50, v49
    v_mul_f32 v60, v58, v57
    v_mul_f32 v68, v66, v65
    v_mul_f32 v43, 0x3fb8aa3b, v43
    v_mul_f32 v51, 0x3fb8aa3b, v51
    v_mul_f32 v59, 0x3fb8aa3b, v59
    v_mul_f32 v67, 0x3fb8aa3b, v67
    v_exp_f32 v43, v43
    v_exp_f32 v51, v51
    v_exp_f32 v59, v59
    v_exp_f32 v67, v67
    v_mul_f32 v44, 0x3e22f983, v44
    v_mul_f32 v52, 0x3e22f983, v52
    v_mul_f32 v60, 0x3e22f983, v60
    v_mul_f32 v68, 0x3e22f983, v68
    v_fract_f32 v44, v44
    v_fract_f32 v52, v52
    v_fract_f32 v60, v60
    v_fract_f32 v68, v68
    v_cos_f32 v45, v44
    v_cos_f32 v53, v52
    v_cos_f32 v61, v60
    v_cos_f32 v69, v68
    v_sin_f32 v46, v44
    v_sin_f32 v54, v52
    v_sin_f32 v62, v60
    v_sin_f32 v70, v68
    v_mul_f32 v88, v43, v45
    v_mul_f32 v90, v51, v53
    v_mul_f32 v92, v59, v61
    v_mul_f32 v94, v67, v69
    v_mul_f32 v89, v43, v46
    v_mul_f32 v91, v51, v54
    v_mul_f32 v93, v59, v62
    v_mul_f32 v95, v67, v70
    v_add_f32 v45, -1.0, v88
    v_add_f32 v53, -1.0, v90
    v_add_f32 v61, -1.0, v92
    v_add_f32 v69, -1.0, v94
    v_mul_f32 v46, v45, v40
    v_mul_f32 v54, v53, v48
    v_mul_f32 v62, v61, v56
    v_mul_f32 v70, v69, v64
    v_fma_f32 v46, v89, v41, v46
    v_fma_f32 v54, v91, v49, v54
    v_fma_f32 v62, v93, v57, v62
    v_fma_f32 v70, v95, v65, v70
    v_mul_f32 v47, v89, v40
    v_mul_f32 v55, v91, v48
    v_mul_f32 v63, v93, v56
    v_mul_f32 v71, v95, v64
    v_fma_f32 v47, -v45, v41, v47
    v_fma_f32 v55, -v53, v49, v55
    v_fma_f32 v63, -v61, v57, v63
    v_fma_f32 v71, -v69, v65, v71
    v_mul_f32 v43, v40, v40
    v_mul_f32 v51, v48, v48
    v_mul_f32 v59, v56, v56
    v_mul_f32 v67, v64, v64
    v_fma_f32 v43, v41, v41, v43
    v_fma_f32 v51, v49, v49, v51
    v_fma_f32 v59, v57, v57, v59
    v_fma_f32 v67, v65, v65, v67
    v_rcp_f32 v43, v43
    v_rcp_f32 v51, v51
    v_rcp_f32 v59, v59
    v_rcp_f32 v67, v67
    v_add_f32 v43, v43, v43
    v_add_f32 v51, v51, v51
    v_add_f32 v59, v59, v59
    v_add_f32 v67, v67, v67
    v_mul_f32 v96, v46, v43
    v_mul_f32 v98, v54, v51
    v_mul_f32 v100, v62, v59
    v_mul_f32 v102, v70, v67
    v_mul_f32 v97, v47, v43
    v_mul_f32 v99, v55, v51
    v_mul_f32 v101, v63, v59
    v_mul_f32 v103, v71, v67
    v_pk_mul_f32 v[40:41], v[88:89], v[88:89] op_sel:[0,0] op_sel_hi:[0,1]
    v_pk_mul_f32 v[48:49], v[90:91], v[90:91] op_sel:[0,0] op_sel_hi:[0,1]
    v_pk_mul_f32 v[56:57], v[92:93], v[92:93] op_sel:[0,0] op_sel_hi:[0,1]
    v_pk_mul_f32 v[64:65], v[94:95], v[94:95] op_sel:[0,0] op_sel_hi:[0,1]
    v_pk_fma_f32 v[104:105], v[88:89], v[88:89], v[40:41] op_sel:[1,1,0] op_sel_hi:[1,0,1] neg_lo:[1,0,0]
    v_pk_fma_f32 v[106:107], v[90:91], v[90:91], v[48:49] op_sel:[1,1,0] op_sel_hi:[1,0,1] neg_lo:[1,0,0]
    v_pk_fma_f32 v[108:109], v[92:93], v[92:93], v[56:57] op_sel:[1,1,0] op_sel_hi:[1,0,1] neg_lo:[1,0,0]
    v_pk_fma_f32 v[110:111], v[94:95], v[94:95], v[64:65] op_sel:[1,1,0] op_sel_hi:[1,0,1] neg_lo:[1,0,0]
    v_pk_mul_f32 v[40:41], v[104:105], v[104:105] op_sel:[0,0] op_sel_hi:[0,1]
    v_pk_mul_f32 v[48:49], v[106:107], v[106:107] op_sel:[0,0] op_sel_hi:[0,1]
    v_pk_mul_f32 v[56:57], v[108:109], v[108:109] op_sel:[0,0] op_sel_hi:[0,1]
    v_pk_mul_f32 v[64:65], v[110:111], v[110:111] op_sel:[0,0] op_sel_hi:[0,1]
    v_pk_fma_f32 v[104:105], v[104:105], v[104:105], v[40:41] op_sel:[1,1,0] op_sel_hi:[1,0,1] neg_lo:[1,0,0]
    v_pk_fma_f32 v[106:107], v[106:107], v[106:107], v[48:49] op_sel:[1,1,0] op_sel_hi:[1,0,1] neg_lo:[1,0,0]
    v_pk_fma_f32 v[108:109], v[108:109], v[108:109], v[56:57] op_sel:[1,1,0] op_sel_hi:[1,0,1] neg_lo:[1,0,0]
    v_pk_fma_f32 v[110:111], v[110:111], v[110:111], v[64:65] op_sel:[1,1,0] op_sel_hi:[1,0,1] neg_lo:[1,0,0]
    v_pk_mul_f32 v[40:41], v[104:105], v[104:105] op_sel:[0,0] op_sel_hi:[0,1]
    v_pk_mul_f32 v[48:49], v[106:107], v[106:107] op_sel:[0,0] op_sel_hi:[0,1]
    v_pk_mul_f32 v[56:57], v[108:109], v[108:109] op_sel:[0,0] op_sel_hi:[0,1]
    v_pk_mul_f32 v[64:65], v[110:111], v[110:111] op_sel:[0,0] op_sel_hi:[0,1]
    v_pk_fma_f32 v[104:105], v[104:105], v[104:105], v[40:41] op_sel:[1,1,0] op_sel_hi:[1,0,1] neg_lo:[1,0,0]
    v_pk_fma_f32 v[106:107], v[106:107], v[106:107], v[48:49] op_sel:[1,1,0] op_sel_hi:[1,0,1] neg_lo:[1,0,0]
    v_pk_fma_f32 v[108:109], v[108:109], v[108:109], v[56:57] op_sel:[1,1,0] op_sel_hi:[1,0,1] neg_lo:[1,0,0]
    v_pk_fma_f32 v[110:111], v[110:111], v[110:111], v[64:65] op_sel:[1,1,0] op_sel_hi:[1,0,1] neg_lo:[1,0,0]
    v_pk_mul_f32 v[40:41], v[104:105], v[104:105] op_sel:[0,0] op_sel_hi:[0,1]
    v_pk_mul_f32 v[48:49], v[106:107], v[106:107] op_sel:[0,0] op_sel_hi:[0,1]
    v_pk_mul_f32 v[56:57], v[108:109], v[108:109] op_sel:[0,0] op_sel_hi:[0,1]
    v_pk_mul_f32 v[64:65], v[110:111], v[110:111] op_sel:[0,0] op_sel_hi:[0,1]
    v_pk_fma_f32 v[104:105], v[104:105], v[104:105], v[40:41] op_sel:[1,1,0] op_sel_hi:[1,0,1] neg_lo:[1,0,0]
    v_pk_fma_f32 v[106:107], v[106:107], v[106:107], v[48:49] op_sel:[1,1,0] op_sel_hi:[1,0,1] neg_lo:[1,0,0]
    v_pk_fma_f32 v[108:109], v[108:109], v[108:109], v[56:57] op_sel:[1,1,0] op_sel_hi:[1,0,1] neg_lo:[1,0,0]
    v_pk_fma_f32 v[110:111], v[110:111], v[110:111], v[64:65] op_sel:[1,1,0] op_sel_hi:[1,0,1] neg_lo:[1,0,0]
    v_pk_mul_f32 v[40:41], v[104:105], v[104:105] op_sel:[0,0] op_sel_hi:[0,1]
    v_pk_mul_f32 v[48:49], v[106:107], v[106:107] op_sel:[0,0] op_sel_hi:[0,1]
    v_pk_mul_f32 v[56:57], v[108:109], v[108:109] op_sel:[0,0] op_sel_hi:[0,1]
    v_pk_mul_f32 v[64:65], v[110:111], v[110:111] op_sel:[0,0] op_sel_hi:[0,1]
    v_pk_fma_f32 v[104:105], v[104:105], v[104:105], v[40:41] op_sel:[1,1,0] op_sel_hi:[1,0,1] neg_lo:[1,0,0]
    v_pk_fma_f32 v[106:107], v[106:107], v[106:107], v[48:49] op_sel:[1,1,0] op_sel_hi:[1,0,1] neg_lo:[1,0,0]
    v_pk_fma_f32 v[108:109], v[108:109], v[108:109], v[56:57] op_sel:[1,1,0] op_sel_hi:[1,0,1] neg_lo:[1,0,0]
    v_pk_fma_f32 v[110:111], v[110:111], v[110:111], v[64:65] op_sel:[1,1,0] op_sel_hi:[1,0,1] neg_lo:[1,0,0]
    v_pk_mul_f32 v[40:41], v[104:105], v[104:105] op_sel:[0,0] op_sel_hi:[0,1]
    v_pk_mul_f32 v[48:49], v[106:107], v[106:107] op_sel:[0,0] op_sel_hi:[0,1]
    v_pk_mul_f32 v[56:57], v[108:109], v[108:109] op_sel:[0,0] op_sel_hi:[0,1]
    v_pk_mul_f32 v[64:65], v[110:111], v[110:111] op_sel:[0,0] op_sel_hi:[0,1]
    v_pk_fma_f32 v[112:113], v[104:105], v[104:105], v[40:41] op_sel:[1,1,0] op_sel_hi:[1,0,1] neg_lo:[1,0,0]
    v_pk_fma_f32 v[114:115], v[106:107], v[106:107], v[48:49] op_sel:[1,1,0] op_sel_hi:[1,0,1] neg_lo:[1,0,0]
    v_pk_fma_f32 v[116:117], v[108:109], v[108:109], v[56:57] op_sel:[1,1,0] op_sel_hi:[1,0,1] neg_lo:[1,0,0]
    v_pk_fma_f32 v[118:119], v[110:111], v[110:111], v[64:65] op_sel:[1,1,0] op_sel_hi:[1,0,1] neg_lo:[1,0,0]
    v_pk_mul_f32 v[40:41], v[112:113], v[112:113] op_sel:[0,0] op_sel_hi:[0,1]
    v_pk_mul_f32 v[48:49], v[114:115], v[114:115] op_sel:[0,0] op_sel_hi:[0,1]
    v_pk_mul_f32 v[56:57], v[116:117], v[116:117] op_sel:[0,0] op_sel_hi:[0,1]
    v_pk_mul_f32 v[64:65], v[118:119], v[118:119] op_sel:[0,0] op_sel_hi:[0,1]
    v_pk_fma_f32 v[44:45], v[112:113], v[112:113], v[40:41] op_sel:[1,1,0] op_sel_hi:[1,0,1] neg_lo:[1,0,0]
    v_pk_fma_f32 v[52:53], v[114:115], v[114:115], v[48:49] op_sel:[1,1,0] op_sel_hi:[1,0,1] neg_lo:[1,0,0]
    v_pk_fma_f32 v[60:61], v[116:117], v[116:117], v[56:57] op_sel:[1,1,0] op_sel_hi:[1,0,1] neg_lo:[1,0,0]
    v_pk_fma_f32 v[68:69], v[118:119], v[118:119], v[64:65] op_sel:[1,1,0] op_sel_hi:[1,0,1] neg_lo:[1,0,0]
    s_mov_b32 exec_lo, 0xffffffff
    s_mov_b32 exec_hi, 0xffffffff
    v_mov_b32 v120, v44
    v_mov_b32 v121, v45
    s_mov_b32 exec_lo, 0xffff0000
    s_mov_b32 exec_hi, 0xffffffff
    v_mov_b32 v120, v52
    v_mov_b32 v121, v53
    s_mov_b32 exec_lo, 0x0
    s_mov_b32 exec_hi, 0xffffffff
    v_mov_b32 v120, v60
    v_mov_b32 v121, v61
    s_mov_b32 exec_lo, 0x0
    s_mov_b32 exec_hi, 0xffff0000
    v_mov_b32 v120, v68
    v_mov_b32 v121, v69
    s_mov_b64 exec, -1
    s_call_b64 s[54:55], t_g1
    s_call_b64 s[54:55], t_scan
    s_and_b32 s62, s57, 7
    s_lshr_b32 s63, s57, 3
    s_lshl_b32 s60, s63, 19
    s_add_u32 s60, s60, 0
    s_mov_b32 s30, s76
    s_and_b32 s31, s77, 0xffff
    s_mov_b32 s32, 0x200000
    s_mov_b32 s33, s60
    s_mov_b32 s34, 0x8000
    s_mov_b32 s35, 0x40000
    s_lshl_b32 s61, s62, 13
    s_andn2_b32 s61, 0x2000, s61
    s_xor_b32 s61, s61, s59
    s_lshl_b32 s60, s62, 21
    s_add_u32 s60, s60, s61
    s_add_u32 s60, s60, 0x80000
    s_add_u32 s36, s100, 0xa000000
    s_addc_u32 s37, s101, 0
    s_and_b32 s37, s37, 0xffff
    s_mov_b32 s38, 0x1000000
    s_mov_b32 s39, s60
    s_mov_b32 s40, 0x800
    s_mov_b32 s41, 0x8000
    s_mov_b32 s42, 0x10000
    s_mov_b32 s84, s62
    s_lshl_b32 s94, s63, 0
    s_mov_b32 s3, 0
    s_call_b64 s[54:55], t_g2
    s_and_b32 s62, s57, 7
    s_lshr_b32 s63, s57, 3
    s_lshl_b32 s60, s63, 19
    s_add_u32 s60, s60, 1024
    s_mov_b32 s30, s74
    s_and_b32 s31, s75, 0xffff
    s_mov_b32 s32, 0x200000
    s_mov_b32 s33, s60
    s_mov_b32 s34, 0x8000
    s_mov_b32 s35, 0x40000
    s_lshl_b32 s61, s62, 13
    s_andn2_b32 s61, 0x2000, s61
    s_xor_b32 s61, s61, s59
    s_lshl_b32 s60, s62, 21
    s_add_u32 s60, s60, s61
    s_add_u32 s60, s60, 0x100000
    s_add_u32 s36, s100, 0xa000000
    s_addc_u32 s37, s101, 0
    s_and_b32 s37, s37, 0xffff
    s_mov_b32 s38, 0x1000000
    s_mov_b32 s39, s60
    s_mov_b32 s40, 0x800
    s_mov_b32 s41, 0x8000
    s_mov_b32 s42, 0x10000
    s_mov_b32 s84, s62
    s_lshl_b32 s94, s63, 0
    s_mov_b32 s18, 0
    s_cmp_eq_u32 s58, 0
    s_cselect_b32 s1, 16, 0
    s_mov_b32 s3, 16
    s_call_b64 s[54:55], t_g2_c
    s_and_b32 s62, s57, 7
    s_lshr_b32 s63, s57, 3
    s_lshl_b32 s60, s63, 19
    s_add_u32 s60, s60, 1024
    s_mov_b32 s30, s76
    s_and_b32 s31, s77, 0xffff
    s_mov_b32 s32, 0x200000
    s_mov_b32 s33, s60
    s_mov_b32 s34, 0x8000
    s_mov_b32 s35, 0x40000
    s_lshl_b32 s61, s62, 13
    s_andn2_b32 s61, 0x2000, s61
    s_xor_b32 s61, s61, s59
    s_lshl_b32 s60, s62, 21
    s_add_u32 s60, s60, s61
    s_add_u32 s60, s60, 0x180000
    s_add_u32 s36, s100, 0xa000000
    s_addc_u32 s37, s101, 0
    s_and_b32 s37, s37, 0xffff
    s_mov_b32 s38, 0x1000000
    s_mov_b32 s39, s60
    s_mov_b32 s40, 0x800
    s_mov_b32 s41, 0x8000
    s_mov_b32 s42, 0x10000
    s_mov_b32 s84, s62
    s_lshl_b32 s94, s63, 0
    s_mov_b32 s3, 0
    s_call_b64 s[54:55], t_g2_c
    s_mov_b32 s32, 0
    s_mov_b32 s38, 0
    s_call_b64 s[54:55], t_g2_c
    s_and_b32 s85, s57, 7
    s_lshr_b32 s0, s57, 3
    s_waitcnt vmcnt(0)
    s_barrier
    v_and_b32 v26, 31, v0
    v_bfe_u32 v25, v0, 6, 1
    v_lshl_add_u32 v27, v25, 5, v26
    v_bfe_u32 v28, v0, 5, 1
    v_bfe_u32 v24, v0, 7, 1
    v_lshl_add_u32 v24, v24, 7, v28
    v_lshlrev_b32 v25, 13, v24
    v_lshl_add_u32 v25, v27, 4, v25
    v_lshlrev_b32 v24, 11, v24
    v_lshl_add_u32 v24, v27, 3, v24
    v_lshlrev_b32 v27, 3, v27
    s_mov_b32 s60, s80
    s_and_b32 s61, s81, 0xffff
    s_mov_b32 s62, 0x800
    s_mov_b32 s63, 0x00020000
    s_lshl_b32 s53, s0, 9
    buffer_load_dwordx2 v[44:45], v27, s[60:63], s53 offen
    s_mov_b32 s8, s64
    s_and_b32 s9, s65, 0xffff
    s_mov_b32 s10, 0x400000
    s_mov_b32 s11, 0x00020000
    s_mov_b32 s12, s96
    s_and_b32 s13, s97, 0xffff
    s_mov_b32 s14, 0x1000000
    s_mov_b32 s15, 0x00020000
    s_lshl_b32 s50, s85, 19
    s_add_u32 s50, s50, s53
    s_add_u32 s53, s50, 0x0
    buffer_load_dwordx2 v[128:129], v24, s[8:11], s53 offen
    s_add_u32 s53, s50, 0x1000
    buffer_load_dwordx2 v[130:131], v24, s[8:11], s53 offen
    s_add_u32 s53, s50, 0x2000
    buffer_load_dwordx2 v[132:133], v24, s[8:11], s53 offen
    s_add_u32 s53, s50, 0x3000
    buffer_load_dwordx2 v[134:135], v24, s[8:11], s53 offen
    s_add_u32 s53, s50, 0x10000
    buffer_load_dwordx2 v[136:137], v24, s[8:11], s53 offen
    s_add_u32 s53, s50, 0x11000
    buffer_load_dwordx2 v[138:139], v24, s[8:11], s53 offen
    s_add_u32 s53, s50, 0x12000
    buffer_load_dwordx2 v[140:141], v24, s[8:11], s53 offen
    s_add_u32 s53, s50, 0x13000
    buffer_load_dwordx2 v[142:143], v24, s[8:11], s53 offen
    s_add_u32 s53, s50, 0x20000
    buffer_load_dwordx2 v[144:145], v24, s[8:11], s53 offen
    s_add_u32 s53, s50, 0x21000
    buffer_load_dwordx2 v[146:147], v24, s[8:11], s53 offen
    s_add_u32 s53, s50, 0x22000
    buffer_load_dwordx2 v[148:149], v24, s[8:11], s53 offen
    s_add_u32 s53, s50, 0x23000
    buffer_load_dwordx2 v[150:151], v24, s[8:11], s53 offen
    s_add_u32 s53, s50, 0x30000
    buffer_load_dwordx2 v[152:153], v24, s[8:11], s53 offen
    s_add_u32 s53, s50, 0x31000
    buffer_load_dwordx2 v[154:155], v24, s[8:11], s53 offen
    s_add_u32 s53, s50, 0x32000
    buffer_load_dwordx2 v[156:157], v24, s[8:11], s53 offen
    s_add_u32 s53, s50, 0x33000
    buffer_load_dwordx2 v[158:159], v24, s[8:11], s53 offen
    s_add_u32 s53, s50, 0x4000
    buffer_load_dwordx2 v[160:161], v24, s[8:11], s53 offen
    s_add_u32 s53, s50, 0x5000
    buffer_load_dwordx2 v[162:163], v24, s[8:11], s53 offen
    s_add_u32 s53, s50, 0x6000
    buffer_load_dwordx2 v[164:165], v24, s[8:11], s53 offen
    s_add_u32 s53, s50, 0x7000
    buffer_load_dwordx2 v[166:167], v24, s[8:11], s53 offen
    s_add_u32 s53, s50, 0x14000
    buffer_load_dwordx2 v[168:169], v24, s[8:11], s53 offen
    s_add_u32 s53, s50, 0x15000
    buffer_load_dwordx2 v[170:171], v24, s[8:11], s53 offen
    s_add_u32 s53, s50, 0x16000
    buffer_load_dwordx2 v[172:173], v24, s[8:11], s53 offen
    s_add_u32 s53, s50, 0x17000
    buffer_load_dwordx2 v[174:175], v24, s[8:11], s53 offen
    s_add_u32 s53, s50, 0x24000
    buffer_load_dwordx2 v[176:177], v24, s[8:11], s53 offen
    s_add_u32 s53, s50, 0x25000
    buffer_load_dwordx2 v[178:179], v24, s[8:11], s53 offen
    s_add_u32 s53, s50, 0x26000
    buffer_load_dwordx2 v[180:181], v24, s[8:11], s53 offen
    s_add_u32 s53, s50, 0x27000
    buffer_load_dwordx2 v[182:183], v24, s[8:11], s53 offen
    s_add_u32 s53, s50, 0x34000
    buffer_load_dwordx2 v[184:185], v24, s[8:11], s53 offen
    s_add_u32 s53, s50, 0x35000
    buffer_load_dwordx2 v[186:187], v24, s[8:11], s53 offen
    s_add_u32 s53, s50, 0x36000
    buffer_load_dwordx2 v[188:189], v24, s[8:11], s53 offen
    s_add_u32 s53, s50, 0x37000
    buffer_load_dwordx2 v[190:191], v24, s[8:11], s53 offen
    s_mul_i32 s60, s58, 33792
    v_mul_u32_u24 v28, 528, v28
    v_lshl_add_u32 v28, v26, 4, v28
    v_add_u32 v28, s60, v28
    v_and_b32 v27, 15, v0
    v_mul_u32_u24 v27, 528, v27
    v_bfe_u32 v26, v0, 4, 2
    v_lshl_add_u32 v27, v26, 4, v27
    v_add_u32 v27, s60, v27
    s_lshl_b32 s51, s85, 21
    s_lshl_b32 s52, s0, 10
    s_add_u32 s51, s51, s52
    ds_write_b128 v27, a[0:3] offset:0
    ds_write_b128 v27, a[32:35] offset:64
    ds_write_b128 v27, a[64:67] offset:128
    ds_write_b128 v27, a[96:99] offset:192
    ds_write_b128 v27, a[128:131] offset:256
    ds_write_b128 v27, a[160:163] offset:320
    ds_write_b128 v27, a[192:195] offset:384
    ds_write_b128 v27, a[224:227] offset:448
    ds_read_b128 v[48:51], v28 offset:0
    ds_read_b128 v[52:55], v28 offset:1056
    ds_read_b128 v[56:59], v28 offset:2112
    ds_read_b128 v[60:63], v28 offset:3168
    ds_read_b128 v[64:67], v28 offset:4224
    ds_read_b128 v[68:71], v28 offset:5280
    ds_read_b128 v[72:75], v28 offset:6336
    ds_read_b128 v[76:79], v28 offset:7392
    ds_write_b128 v27, a[4:7] offset:8448
    ds_write_b128 v27, a[36:39] offset:8512
    ds_write_b128 v27, a[68:71] offset:8576
    ds_write_b128 v27, a[100:103] offset:8640
    ds_write_b128 v27, a[132:135] offset:8704
    ds_write_b128 v27, a[164:167] offset:8768
    ds_write_b128 v27, a[196:199] offset:8832
    ds_write_b128 v27, a[228:231] offset:8896
    s_waitcnt vmcnt(32)
    v_lshlrev_b32 v40, 16, v44
    v_and_b32 v41, 0xffff0000, v44
    v_lshlrev_b32 v42, 16, v45
    v_and_b32 v43, 0xffff0000, v45
    s_waitcnt vmcnt(24) lgkmcnt(8)
    ds_read_b128 v[80:83], v28 offset:8448
    ds_read_b128 v[84:87], v28 offset:9504
    ds_read_b128 v[88:91], v28 offset:10560
    ds_read_b128 v[92:95], v28 offset:11616
    ds_read_b128 v[96:99], v28 offset:12672
    ds_read_b128 v[100:103], v28 offset:13728
    ds_read_b128 v[104:107], v28 offset:14784
    ds_read_b128 v[108:111], v28 offset:15840
    ds_write_b128 v27, a[8:11] offset:16896
    ds_write_b128 v27, a[40:43] offset:16960
    ds_write_b128 v27, a[72:75] offset:17024
    ds_write_b128 v27, a[104:107] offset:17088
    ds_write_b128 v27, a[136:139] offset:17152
    ds_write_b128 v27, a[168:171] offset:17216
    ds_write_b128 v27, a[200:203] offset:17280
    ds_write_b128 v27, a[232:235] offset:17344
    v_lshlrev_b32 v112, 16, v128
    v_and_b32 v113, 0xffff0000, v128
    v_lshlrev_b32 v114, 16, v129
    v_and_b32 v115, 0xffff0000, v129
    v_pk_mul_f32 v[112:113], v[112:113], v[40:41]
    v_pk_mul_f32 v[114:115], v[114:115], v[42:43]
    s_add_u32 s52, s51, 0x0
    v_cvt_pk_bf16_f32 v112, 0, v112
    v_cvt_pk_bf16_f32 v113, 0, v113
    v_cvt_pk_bf16_f32 v114, 0, v114
    v_cvt_pk_bf16_f32 v115, 0, v115
    v_pk_add_f32 v[48:49], v[48:49], v[112:113]
    v_pk_add_f32 v[50:51], v[50:51], v[114:115]
    buffer_store_dwordx4 v[48:51], v25, s[12:15], s52 offen
    v_lshlrev_b32 v116, 16, v130
    v_and_b32 v117, 0xffff0000, v130
    v_lshlrev_b32 v118, 16, v131
    v_and_b32 v119, 0xffff0000, v131
    v_pk_mul_f32 v[116:117], v[116:117], v[40:41]
    v_pk_mul_f32 v[118:119], v[118:119], v[42:43]
    s_add_u32 s52, s51, 0x4000
    v_cvt_pk_bf16_f32 v116, 0, v116
    v_cvt_pk_bf16_f32 v117, 0, v117
    v_cvt_pk_bf16_f32 v118, 0, v118
    v_cvt_pk_bf16_f32 v119, 0, v119
    v_pk_add_f32 v[52:53], v[52:53], v[116:117]
    v_pk_add_f32 v[54:55], v[54:55], v[118:119]
    buffer_store_dwordx4 v[52:55], v25, s[12:15], s52 offen
    v_lshlrev_b32 v112, 16, v132
    v_and_b32 v113, 0xffff0000, v132
    v_lshlrev_b32 v114, 16, v133
    v_and_b32 v115, 0xffff0000, v133
    v_pk_mul_f32 v[112:113], v[112:113], v[40:41]
    v_pk_mul_f32 v[114:115], v[114:115], v[42:43]
    s_add_u32 s52, s51, 0x8000
    v_cvt_pk_bf16_f32 v112, 0, v112
    v_cvt_pk_bf16_f32 v113, 0, v113
    v_cvt_pk_bf16_f32 v114, 0, v114
    v_cvt_pk_bf16_f32 v115, 0, v115
    v_pk_add_f32 v[56:57], v[56:57], v[112:113]
    v_pk_add_f32 v[58:59], v[58:59], v[114:115]
    buffer_store_dwordx4 v[56:59], v25, s[12:15], s52 offen
    v_lshlrev_b32 v116, 16, v134
    v_and_b32 v117, 0xffff0000, v134
    v_lshlrev_b32 v118, 16, v135
    v_and_b32 v119, 0xffff0000, v135
    v_pk_mul_f32 v[116:117], v[116:117], v[40:41]
    v_pk_mul_f32 v[118:119], v[118:119], v[42:43]
    s_add_u32 s52, s51, 0xc000
    v_cvt_pk_bf16_f32 v116, 0, v116
    v_cvt_pk_bf16_f32 v117, 0, v117
    v_cvt_pk_bf16_f32 v118, 0, v118
    v_cvt_pk_bf16_f32 v119, 0, v119
    v_pk_add_f32 v[60:61], v[60:61], v[116:117]
    v_pk_add_f32 v[62:63], v[62:63], v[118:119]
    buffer_store_dwordx4 v[60:63], v25, s[12:15], s52 offen
    v_lshlrev_b32 v112, 16, v136
    v_and_b32 v113, 0xffff0000, v136
    v_lshlrev_b32 v114, 16, v137
    v_and_b32 v115, 0xffff0000, v137
    v_pk_mul_f32 v[112:113], v[112:113], v[40:41]
    v_pk_mul_f32 v[114:115], v[114:115], v[42:43]
    s_add_u32 s52, s51, 0x40000
    v_cvt_pk_bf16_f32 v112, 0, v112
    v_cvt_pk_bf16_f32 v113, 0, v113
    v_cvt_pk_bf16_f32 v114, 0, v114
    v_cvt_pk_bf16_f32 v115, 0, v115
    v_pk_add_f32 v[64:65], v[64:65], v[112:113]
    v_pk_add_f32 v[66:67], v[66:67], v[114:115]
    buffer_store_dwordx4 v[64:67], v25, s[12:15], s52 offen
    v_lshlrev_b32 v116, 16, v138
    v_and_b32 v117, 0xffff0000, v138
    v_lshlrev_b32 v118, 16, v139
    v_and_b32 v119, 0xffff0000, v139
    v_pk_mul_f32 v[116:117], v[116:117], v[40:41]
    v_pk_mul_f32 v[118:119], v[118:119], v[42:43]
    s_add_u32 s52, s51, 0x44000
    v_cvt_pk_bf16_f32 v116, 0, v116
    v_cvt_pk_bf16_f32 v117, 0, v117
    v_cvt_pk_bf16_f32 v118, 0, v118
    v_cvt_pk_bf16_f32 v119, 0, v119
    v_pk_add_f32 v[68:69], v[68:69], v[116:117]
    v_pk_add_f32 v[70:71], v[70:71], v[118:119]
    buffer_store_dwordx4 v[68:71], v25, s[12:15], s52 offen
    v_lshlrev_b32 v112, 16, v140
    v_and_b32 v113, 0xffff0000, v140
    v_lshlrev_b32 v114, 16, v141
    v_and_b32 v115, 0xffff0000, v141
    v_pk_mul_f32 v[112:113], v[112:113], v[40:41]
    v_pk_mul_f32 v[114:115], v[114:115], v[42:43]
    s_add_u32 s52, s51, 0x48000
    v_cvt_pk_bf16_f32 v112, 0, v112
    v_cvt_pk_bf16_f32 v113, 0, v113
    v_cvt_pk_bf16_f32 v114, 0, v114
    v_cvt_pk_bf16_f32 v115, 0, v115
    v_pk_add_f32 v[72:73], v[72:73], v[112:113]
    v_pk_add_f32 v[74:75], v[74:75], v[114:115]
    buffer_store_dwordx4 v[72:75], v25, s[12:15], s52 offen
    v_lshlrev_b32 v116, 16, v142
    v_and_b32 v117, 0xffff0000, v142
    v_lshlrev_b32 v118, 16, v143
    v_and_b32 v119, 0xffff0000, v143
    v_pk_mul_f32 v[116:117], v[116:117], v[40:41]
    v_pk_mul_f32 v[118:119], v[118:119], v[42:43]
    s_add_u32 s52, s51, 0x4c000
    v_cvt_pk_bf16_f32 v116, 0, v116
    v_cvt_pk_bf16_f32 v117, 0, v117
    v_cvt_pk_bf16_f32 v118, 0, v118
    v_cvt_pk_bf16_f32 v119, 0, v119
    v_pk_add_f32 v[76:77], v[76:77], v[116:117]
    v_pk_add_f32 v[78:79], v[78:79], v[118:119]
    buffer_store_dwordx4 v[76:79], v25, s[12:15], s52 offen
    s_add_u32 s53, s50, 0x8000
    buffer_load_dwordx2 v[192:193], v24, s[8:11], s53 offen
    s_add_u32 s53, s50, 0x9000
    buffer_load_dwordx2 v[194:195], v24, s[8:11], s53 offen
    s_add_u32 s53, s50, 0xa000
    buffer_load_dwordx2 v[196:197], v24, s[8:11], s53 offen
    s_add_u32 s53, s50, 0xb000
    buffer_load_dwordx2 v[198:199], v24, s[8:11], s53 offen
    s_add_u32 s53, s50, 0x18000
    buffer_load_dwordx2 v[200:201], v24, s[8:11], s53 offen
    s_add_u32 s53, s50, 0x19000
    buffer_load_dwordx2 v[202:203], v24, s[8:11], s53 offen
    s_add_u32 s53, s50, 0x1a000
    buffer_load_dwordx2 v[204:205], v24, s[8:11], s53 offen
    s_add_u32 s53, s50, 0x1b000
    buffer_load_dwordx2 v[206:207], v24, s[8:11], s53 offen
    s_waitcnt vmcnt(32) lgkmcnt(8)
    ds_read_b128 v[48:51], v28 offset:16896
    ds_read_b128 v[52:55], v28 offset:17952
    ds_read_b128 v[56:59], v28 offset:19008
    ds_read_b128 v[60:63], v28 offset:20064
    ds_read_b128 v[64:67], v28 offset:21120
    ds_read_b128 v[68:71], v28 offset:22176
    ds_read_b128 v[72:75], v28 offset:23232
    ds_read_b128 v[76:79], v28 offset:24288
    ds_write_b128 v27, a[12:15] offset:25344
    ds_write_b128 v27, a[44:47] offset:25408
    ds_write_b128 v27, a[76:79] offset:25472
    ds_write_b128 v27, a[108:111] offset:25536
    ds_write_b128 v27, a[140:143] offset:25600
    ds_write_b128 v27, a[172:175] offset:25664
    ds_write_b128 v27, a[204:207] offset:25728
    ds_write_b128 v27, a[236:239] offset:25792
    v_lshlrev_b32 v112, 16, v144
    v_and_b32 v113, 0xffff0000, v144
    v_lshlrev_b32 v114, 16, v145
    v_and_b32 v115, 0xffff0000, v145
    v_pk_mul_f32 v[112:113], v[112:113], v[40:41]
    v_pk_mul_f32 v[114:115], v[114:115], v[42:43]
    s_add_u32 s52, s51, 0x80000
    v_cvt_pk_bf16_f32 v112, 0, v112
    v_cvt_pk_bf16_f32 v113, 0, v113
    v_cvt_pk_bf16_f32 v114, 0, v114
    v_cvt_pk_bf16_f32 v115, 0, v115
    v_pk_add_f32 v[80:81], v[80:81], v[112:113]
    v_pk_add_f32 v[82:83], v[82:83], v[114:115]
    buffer_store_dwordx4 v[80:83], v25, s[12:15], s52 offen
    v_lshlrev_b32 v116, 16, v146
    v_and_b32 v117, 0xffff0000, v146
    v_lshlrev_b32 v118, 16, v147
    v_and_b32 v119, 0xffff0000, v147
    v_pk_mul_f32 v[116:117], v[116:117], v[40:41]
    v_pk_mul_f32 v[118:119], v[118:119], v[42:43]
    s_add_u32 s52, s51, 0x84000
    v_cvt_pk_bf16_f32 v116, 0, v116
    v_cvt_pk_bf16_f32 v117, 0, v117
    v_cvt_pk_bf16_f32 v118, 0, v118
    v_cvt_pk_bf16_f32 v119, 0, v119
    v_pk_add_f32 v[84:85], v[84:85], v[116:117]
    v_pk_add_f32 v[86:87], v[86:87], v[118:119]
    buffer_store_dwordx4 v[84:87], v25, s[12:15], s52 offen
    v_lshlrev_b32 v112, 16, v148
    v_and_b32 v113, 0xffff0000, v148
    v_lshlrev_b32 v114, 16, v149
    v_and_b32 v115, 0xffff0000, v149
    v_pk_mul_f32 v[112:113], v[112:113], v[40:41]
    v_pk_mul_f32 v[114:115], v[114:115], v[42:43]
    s_add_u32 s52, s51, 0x88000
    v_cvt_pk_bf16_f32 v112, 0, v112
    v_cvt_pk_bf16_f32 v113, 0, v113
    v_cvt_pk_bf16_f32 v114, 0, v114
    v_cvt_pk_bf16_f32 v115, 0, v115
    v_pk_add_f32 v[88:89], v[88:89], v[112:113]
    v_pk_add_f32 v[90:91], v[90:91], v[114:115]
    buffer_store_dwordx4 v[88:91], v25, s[12:15], s52 offen
    v_lshlrev_b32 v116, 16, v150
    v_and_b32 v117, 0xffff0000, v150
    v_lshlrev_b32 v118, 16, v151
    v_and_b32 v119, 0xffff0000, v151
    v_pk_mul_f32 v[116:117], v[116:117], v[40:41]
    v_pk_mul_f32 v[118:119], v[118:119], v[42:43]
    s_add_u32 s52, s51, 0x8c000
    v_cvt_pk_bf16_f32 v116, 0, v116
    v_cvt_pk_bf16_f32 v117, 0, v117
    v_cvt_pk_bf16_f32 v118, 0, v118
    v_cvt_pk_bf16_f32 v119, 0, v119
    v_pk_add_f32 v[92:93], v[92:93], v[116:117]
    v_pk_add_f32 v[94:95], v[94:95], v[118:119]
    buffer_store_dwordx4 v[92:95], v25, s[12:15], s52 offen
    v_lshlrev_b32 v112, 16, v152
    v_and_b32 v113, 0xffff0000, v152
    v_lshlrev_b32 v114, 16, v153
    v_and_b32 v115, 0xffff0000, v153
    v_pk_mul_f32 v[112:113], v[112:113], v[40:41]
    v_pk_mul_f32 v[114:115], v[114:115], v[42:43]
    s_add_u32 s52, s51, 0xc0000
    v_cvt_pk_bf16_f32 v112, 0, v112
    v_cvt_pk_bf16_f32 v113, 0, v113
    v_cvt_pk_bf16_f32 v114, 0, v114
    v_cvt_pk_bf16_f32 v115, 0, v115
    v_pk_add_f32 v[96:97], v[96:97], v[112:113]
    v_pk_add_f32 v[98:99], v[98:99], v[114:115]
    buffer_store_dwordx4 v[96:99], v25, s[12:15], s52 offen
    v_lshlrev_b32 v116, 16, v154
    v_and_b32 v117, 0xffff0000, v154
    v_lshlrev_b32 v118, 16, v155
    v_and_b32 v119, 0xffff0000, v155
    v_pk_mul_f32 v[116:117], v[116:117], v[40:41]
    v_pk_mul_f32 v[118:119], v[118:119], v[42:43]
    s_add_u32 s52, s51, 0xc4000
    v_cvt_pk_bf16_f32 v116, 0, v116
    v_cvt_pk_bf16_f32 v117, 0, v117
    v_cvt_pk_bf16_f32 v118, 0, v118
    v_cvt_pk_bf16_f32 v119, 0, v119
    v_pk_add_f32 v[100:101], v[100:101], v[116:117]
    v_pk_add_f32 v[102:103], v[102:103], v[118:119]
    buffer_store_dwordx4 v[100:103], v25, s[12:15], s52 offen
    v_lshlrev_b32 v112, 16, v156
    v_and_b32 v113, 0xffff0000, v156
    v_lshlrev_b32 v114, 16, v157
    v_and_b32 v115, 0xffff0000, v157
    v_pk_mul_f32 v[112:113], v[112:113], v[40:41]
    v_pk_mul_f32 v[114:115], v[114:115], v[42:43]
    s_add_u32 s52, s51, 0xc8000
    v_cvt_pk_bf16_f32 v112, 0, v112
    v_cvt_pk_bf16_f32 v113, 0, v113
    v_cvt_pk_bf16_f32 v114, 0, v114
    v_cvt_pk_bf16_f32 v115, 0, v115
    v_pk_add_f32 v[104:105], v[104:105], v[112:113]
    v_pk_add_f32 v[106:107], v[106:107], v[114:115]
    buffer_store_dwordx4 v[104:107], v25, s[12:15], s52 offen
    v_lshlrev_b32 v116, 16, v158
    v_and_b32 v117, 0xffff0000, v158
    v_lshlrev_b32 v118, 16, v159
    v_and_b32 v119, 0xffff0000, v159
    v_pk_mul_f32 v[116:117], v[116:117], v[40:41]
    v_pk_mul_f32 v[118:119], v[118:119], v[42:43]
    s_add_u32 s52, s51, 0xcc000
    v_cvt_pk_bf16_f32 v116, 0, v116
    v_cvt_pk_bf16_f32 v117, 0, v117
    v_cvt_pk_bf16_f32 v118, 0, v118
    v_cvt_pk_bf16_f32 v119, 0, v119
    v_pk_add_f32 v[108:109], v[108:109], v[116:117]
    v_pk_add_f32 v[110:111], v[110:111], v[118:119]
    buffer_store_dwordx4 v[108:111], v25, s[12:15], s52 offen
    s_add_u32 s53, s50, 0x28000
    buffer_load_dwordx2 v[208:209], v24, s[8:11], s53 offen
    s_add_u32 s53, s50, 0x29000
    buffer_load_dwordx2 v[210:211], v24, s[8:11], s53 offen
    s_add_u32 s53, s50, 0x2a000
    buffer_load_dwordx2 v[212:213], v24, s[8:11], s53 offen
    s_add_u32 s53, s50, 0x2b000
    buffer_load_dwordx2 v[214:215], v24, s[8:11], s53 offen
    s_add_u32 s53, s50, 0x38000
    buffer_load_dwordx2 v[216:217], v24, s[8:11], s53 offen
    s_add_u32 s53, s50, 0x39000
    buffer_load_dwordx2 v[218:219], v24, s[8:11], s53 offen
    s_add_u32 s53, s50, 0x3a000
    buffer_load_dwordx2 v[220:221], v24, s[8:11], s53 offen
    s_add_u32 s53, s50, 0x3b000
    buffer_load_dwordx2 v[222:223], v24, s[8:11], s53 offen
    s_waitcnt vmcnt(40) lgkmcnt(8)
    ds_read_b128 v[80:83], v28 offset:25344
    ds_read_b128 v[84:87], v28 offset:26400
    ds_read_b128 v[88:91], v28 offset:27456
    ds_read_b128 v[92:95], v28 offset:28512
    ds_read_b128 v[96:99], v28 offset:29568
    ds_read_b128 v[100:103], v28 offset:30624
    ds_read_b128 v[104:107], v28 offset:31680
    ds_read_b128 v[108:111], v28 offset:32736
    ds_write_b128 v27, a[16:19] offset:0
    ds_write_b128 v27, a[48:51] offset:64
    ds_write_b128 v27, a[80:83] offset:128
    ds_write_b128 v27, a[112:115] offset:192
    ds_write_b128 v27, a[144:147] offset:256
    ds_write_b128 v27, a[176:179] offset:320
    ds_write_b128 v27, a[208:211] offset:384
    ds_write_b128 v27, a[240:243] offset:448
    v_lshlrev_b32 v112, 16, v160
    v_and_b32 v113, 0xffff0000, v160
    v_lshlrev_b32 v114, 16, v161
    v_and_b32 v115, 0xffff0000, v161
    v_pk_mul_f32 v[112:113], v[112:113], v[40:41]
    v_pk_mul_f32 v[114:115], v[114:115], v[42:43]
    s_add_u32 s52, s51, 0x10000
    v_cvt_pk_bf16_f32 v112, 0, v112
    v_cvt_pk_bf16_f32 v113, 0, v113
    v_cvt_pk_bf16_f32 v114, 0, v114
    v_cvt_pk_bf16_f32 v115, 0, v115
    v_pk_add_f32 v[48:49], v[48:49], v[112:113]
    v_pk_add_f32 v[50:51], v[50:51], v[114:115]
    buffer_store_dwordx4 v[48:51], v25, s[12:15], s52 offen
    v_lshlrev_b32 v116, 16, v162
    v_and_b32 v117, 0xffff0000, v162
    v_lshlrev_b32 v118, 16, v163
    v_and_b32 v119, 0xffff0000, v163
    v_pk_mul_f32 v[116:117], v[116:117], v[40:41]
    v_pk_mul_f32 v[118:119], v[118:119], v[42:43]
    s_add_u32 s52, s51, 0x14000
    v_cvt_pk_bf16_f32 v116, 0, v116
    v_cvt_pk_bf16_f32 v117, 0, v117
    v_cvt_pk_bf16_f32 v118, 0, v118
    v_cvt_pk_bf16_f32 v119, 0, v119
    v_pk_add_f32 v[52:53], v[52:53], v[116:117]
    v_pk_add_f32 v[54:55], v[54:55], v[118:119]
    buffer_store_dwordx4 v[52:55], v25, s[12:15], s52 offen
    v_lshlrev_b32 v112, 16, v164
    v_and_b32 v113, 0xffff0000, v164
    v_lshlrev_b32 v114, 16, v165
    v_and_b32 v115, 0xffff0000, v165
    v_pk_mul_f32 v[112:113], v[112:113], v[40:41]
    v_pk_mul_f32 v[114:115], v[114:115], v[42:43]
    s_add_u32 s52, s51, 0x18000
    v_cvt_pk_bf16_f32 v112, 0, v112
    v_cvt_pk_bf16_f32 v113, 0, v113
    v_cvt_pk_bf16_f32 v114, 0, v114
    v_cvt_pk_bf16_f32 v115, 0, v115
    v_pk_add_f32 v[56:57], v[56:57], v[112:113]
    v_pk_add_f32 v[58:59], v[58:59], v[114:115]
    buffer_store_dwordx4 v[56:59], v25, s[12:15], s52 offen
    v_lshlrev_b32 v116, 16, v166
    v_and_b32 v117, 0xffff0000, v166
    v_lshlrev_b32 v118, 16, v167
    v_and_b32 v119, 0xffff0000, v167
    v_pk_mul_f32 v[116:117], v[116:117], v[40:41]
    v_pk_mul_f32 v[118:119], v[118:119], v[42:43]
    s_add_u32 s52, s51, 0x1c000
    v_cvt_pk_bf16_f32 v116, 0, v116
    v_cvt_pk_bf16_f32 v117, 0, v117
    v_cvt_pk_bf16_f32 v118, 0, v118
    v_cvt_pk_bf16_f32 v119, 0, v119
    v_pk_add_f32 v[60:61], v[60:61], v[116:117]
    v_pk_add_f32 v[62:63], v[62:63], v[118:119]
    buffer_store_dwordx4 v[60:63], v25, s[12:15], s52 offen
    v_lshlrev_b32 v112, 16, v168
    v_and_b32 v113, 0xffff0000, v168
    v_lshlrev_b32 v114, 16, v169
    v_and_b32 v115, 0xffff0000, v169
    v_pk_mul_f32 v[112:113], v[112:113], v[40:41]
    v_pk_mul_f32 v[114:115], v[114:115], v[42:43]
    s_add_u32 s52, s51, 0x50000
    v_cvt_pk_bf16_f32 v112, 0, v112
    v_cvt_pk_bf16_f32 v113, 0, v113
    v_cvt_pk_bf16_f32 v114, 0, v114
    v_cvt_pk_bf16_f32 v115, 0, v115
    v_pk_add_f32 v[64:65], v[64:65], v[112:113]
    v_pk_add_f32 v[66:67], v[66:67], v[114:115]
    buffer_store_dwordx4 v[64:67], v25, s[12:15], s52 offen
    v_lshlrev_b32 v116, 16, v170
    v_and_b32 v117, 0xffff0000, v170
    v_lshlrev_b32 v118, 16, v171
    v_and_b32 v119, 0xffff0000, v171
    v_pk_mul_f32 v[116:117], v[116:117], v[40:41]
    v_pk_mul_f32 v[118:119], v[118:119], v[42:43]
    s_add_u32 s52, s51, 0x54000
    v_cvt_pk_bf16_f32 v116, 0, v116
    v_cvt_pk_bf16_f32 v117, 0, v117
    v_cvt_pk_bf16_f32 v118, 0, v118
    v_cvt_pk_bf16_f32 v119, 0, v119
    v_pk_add_f32 v[68:69], v[68:69], v[116:117]
    v_pk_add_f32 v[70:71], v[70:71], v[118:119]
    buffer_store_dwordx4 v[68:71], v25, s[12:15], s52 offen
    v_lshlrev_b32 v112, 16, v172
    v_and_b32 v113, 0xffff0000, v172
    v_lshlrev_b32 v114, 16, v173
    v_and_b32 v115, 0xffff0000, v173
    v_pk_mul_f32 v[112:113], v[112:113], v[40:41]
    v_pk_mul_f32 v[114:115], v[114:115], v[42:43]
    s_add_u32 s52, s51, 0x58000
    v_cvt_pk_bf16_f32 v112, 0, v112
    v_cvt_pk_bf16_f32 v113, 0, v113
    v_cvt_pk_bf16_f32 v114, 0, v114
    v_cvt_pk_bf16_f32 v115, 0, v115
    v_pk_add_f32 v[72:73], v[72:73], v[112:113]
    v_pk_add_f32 v[74:75], v[74:75], v[114:115]
    buffer_store_dwordx4 v[72:75], v25, s[12:15], s52 offen
    v_lshlrev_b32 v116, 16, v174
    v_and_b32 v117, 0xffff0000, v174
    v_lshlrev_b32 v118, 16, v175
    v_and_b32 v119, 0xffff0000, v175
    v_pk_mul_f32 v[116:117], v[116:117], v[40:41]
    v_pk_mul_f32 v[118:119], v[118:119], v[42:43]
    s_add_u32 s52, s51, 0x5c000
    v_cvt_pk_bf16_f32 v116, 0, v116
    v_cvt_pk_bf16_f32 v117, 0, v117
    v_cvt_pk_bf16_f32 v118, 0, v118
    v_cvt_pk_bf16_f32 v119, 0, v119
    v_pk_add_f32 v[76:77], v[76:77], v[116:117]
    v_pk_add_f32 v[78:79], v[78:79], v[118:119]
    buffer_store_dwordx4 v[76:79], v25, s[12:15], s52 offen
    s_add_u32 s53, s50, 0xc000
    buffer_load_dwordx2 v[224:225], v24, s[8:11], s53 offen
    s_add_u32 s53, s50, 0xd000
    buffer_load_dwordx2 v[226:227], v24, s[8:11], s53 offen
    s_add_u32 s53, s50, 0xe000
    buffer_load_dwordx2 v[228:229], v24, s[8:11], s53 offen
    s_add_u32 s53, s50, 0xf000
    buffer_load_dwordx2 v[230:231], v24, s[8:11], s53 offen
    s_add_u32 s53, s50, 0x1c000
    buffer_load_dwordx2 v[232:233], v24, s[8:11], s53 offen
    s_add_u32 s53, s50, 0x1d000
    buffer_load_dwordx2 v[234:235], v24, s[8:11], s53 offen
    s_add_u32 s53, s50, 0x1e000
    buffer_load_dwordx2 v[236:237], v24, s[8:11], s53 offen
    s_add_u32 s53, s50, 0x1f000
    buffer_load_dwordx2 v[238:239], v24, s[8:11], s53 offen
    s_waitcnt vmcnt(48) lgkmcnt(8)
    ds_read_b128 v[48:51], v28 offset:0
    ds_read_b128 v[52:55], v28 offset:1056
    ds_read_b128 v[56:59], v28 offset:2112
    ds_read_b128 v[60:63], v28 offset:3168
    ds_read_b128 v[64:67], v28 offset:4224
    ds_read_b128 v[68:71], v28 offset:5280
    ds_read_b128 v[72:75], v28 offset:6336
    ds_read_b128 v[76:79], v28 offset:7392
    ds_write_b128 v27, a[20:23] offset:8448
    ds_write_b128 v27, a[52:55] offset:8512
    ds_write_b128 v27, a[84:87] offset:8576
    ds_write_b128 v27, a[116:119] offset:8640
    ds_write_b128 v27, a[148:151] offset:8704
    ds_write_b128 v27, a[180:183] offset:8768
    ds_write_b128 v27, a[212:215] offset:8832
    ds_write_b128 v27, a[244:247] offset:8896
    v_lshlrev_b32 v112, 16, v176
    v_and_b32 v113, 0xffff0000, v176
    v_lshlrev_b32 v114, 16, v177
    v_and_b32 v115, 0xffff0000, v177
    v_pk_mul_f32 v[112:113], v[112:113], v[40:41]
    v_pk_mul_f32 v[114:115], v[114:115], v[42:43]
    s_add_u32 s52, s51, 0x90000
    v_cvt_pk_bf16_f32 v112, 0, v112
    v_cvt_pk_bf16_f32 v113, 0, v113
    v_cvt_pk_bf16_f32 v114, 0, v114
    v_cvt_pk_bf16_f32 v115, 0, v115
    v_pk_add_f32 v[80:81], v[80:81], v[112:113]
    v_pk_add_f32 v[82:83], v[82:83], v[114:115]
    buffer_store_dwordx4 v[80:83], v25, s[12:15], s52 offen
    v_lshlrev_b32 v116, 16, v178
    v_and_b32 v117, 0xffff0000, v178
    v_lshlrev_b32 v118, 16, v179
    v_and_b32 v119, 0xffff0000, v179
    v_pk_mul_f32 v[116:117], v[116:117], v[40:41]
    v_pk_mul_f32 v[118:119], v[118:119], v[42:43]
    s_add_u32 s52, s51, 0x94000
    v_cvt_pk_bf16_f32 v116, 0, v116
    v_cvt_pk_bf16_f32 v117, 0, v117
    v_cvt_pk_bf16_f32 v118, 0, v118
    v_cvt_pk_bf16_f32 v119, 0, v119
    v_pk_add_f32 v[84:85], v[84:85], v[116:117]
    v_pk_add_f32 v[86:87], v[86:87], v[118:119]
    buffer_store_dwordx4 v[84:87], v25, s[12:15], s52 offen
    v_lshlrev_b32 v112, 16, v180
    v_and_b32 v113, 0xffff0000, v180
    v_lshlrev_b32 v114, 16, v181
    v_and_b32 v115, 0xffff0000, v181
    v_pk_mul_f32 v[112:113], v[112:113], v[40:41]
    v_pk_mul_f32 v[114:115], v[114:115], v[42:43]
    s_add_u32 s52, s51, 0x98000
    v_cvt_pk_bf16_f32 v112, 0, v112
    v_cvt_pk_bf16_f32 v113, 0, v113
    v_cvt_pk_bf16_f32 v114, 0, v114
    v_cvt_pk_bf16_f32 v115, 0, v115
    v_pk_add_f32 v[88:89], v[88:89], v[112:113]
    v_pk_add_f32 v[90:91], v[90:91], v[114:115]
    buffer_store_dwordx4 v[88:91], v25, s[12:15], s52 offen
    v_lshlrev_b32 v116, 16, v182
    v_and_b32 v117, 0xffff0000, v182
    v_lshlrev_b32 v118, 16, v183
    v_and_b32 v119, 0xffff0000, v183
    v_pk_mul_f32 v[116:117], v[116:117], v[40:41]
    v_pk_mul_f32 v[118:119], v[118:119], v[42:43]
    s_add_u32 s52, s51, 0x9c000
    v_cvt_pk_bf16_f32 v116, 0, v116
    v_cvt_pk_bf16_f32 v117, 0, v117
    v_cvt_pk_bf16_f32 v118, 0, v118
    v_cvt_pk_bf16_f32 v119, 0, v119
    v_pk_add_f32 v[92:93], v[92:93], v[116:117]
    v_pk_add_f32 v[94:95], v[94:95], v[118:119]
    buffer_store_dwordx4 v[92:95], v25, s[12:15], s52 offen
    v_lshlrev_b32 v112, 16, v184
    v_and_b32 v113, 0xffff0000, v184
    v_lshlrev_b32 v114, 16, v185
    v_and_b32 v115, 0xffff0000, v185
    v_pk_mul_f32 v[112:113], v[112:113], v[40:41]
    v_pk_mul_f32 v[114:115], v[114:115], v[42:43]
    s_add_u32 s52, s51, 0xd0000
    v_cvt_pk_bf16_f32 v112, 0, v112
    v_cvt_pk_bf16_f32 v113, 0, v113
    v_cvt_pk_bf16_f32 v114, 0, v114
    v_cvt_pk_bf16_f32 v115, 0, v115
    v_pk_add_f32 v[96:97], v[96:97], v[112:113]
    v_pk_add_f32 v[98:99], v[98:99], v[114:115]
    buffer_store_dwordx4 v[96:99], v25, s[12:15], s52 offen
    v_lshlrev_b32 v116, 16, v186
    v_and_b32 v117, 0xffff0000, v186
    v_lshlrev_b32 v118, 16, v187
    v_and_b32 v119, 0xffff0000, v187
    v_pk_mul_f32 v[116:117], v[116:117], v[40:41]
    v_pk_mul_f32 v[118:119], v[118:119], v[42:43]
    s_add_u32 s52, s51, 0xd4000
    v_cvt_pk_bf16_f32 v116, 0, v116
    v_cvt_pk_bf16_f32 v117, 0, v117
    v_cvt_pk_bf16_f32 v118, 0, v118
    v_cvt_pk_bf16_f32 v119, 0, v119
    v_pk_add_f32 v[100:101], v[100:101], v[116:117]
    v_pk_add_f32 v[102:103], v[102:103], v[118:119]
    buffer_store_dwordx4 v[100:103], v25, s[12:15], s52 offen
    v_lshlrev_b32 v112, 16, v188
    v_and_b32 v113, 0xffff0000, v188
    v_lshlrev_b32 v114, 16, v189
    v_and_b32 v115, 0xffff0000, v189
    v_pk_mul_f32 v[112:113], v[112:113], v[40:41]
    v_pk_mul_f32 v[114:115], v[114:115], v[42:43]
    s_add_u32 s52, s51, 0xd8000
    v_cvt_pk_bf16_f32 v112, 0, v112
    v_cvt_pk_bf16_f32 v113, 0, v113
    v_cvt_pk_bf16_f32 v114, 0, v114
    v_cvt_pk_bf16_f32 v115, 0, v115
    v_pk_add_f32 v[104:105], v[104:105], v[112:113]
    v_pk_add_f32 v[106:107], v[106:107], v[114:115]
    buffer_store_dwordx4 v[104:107], v25, s[12:15], s52 offen
    v_lshlrev_b32 v116, 16, v190
    v_and_b32 v117, 0xffff0000, v190
    v_lshlrev_b32 v118, 16, v191
    v_and_b32 v119, 0xffff0000, v191
    v_pk_mul_f32 v[116:117], v[116:117], v[40:41]
    v_pk_mul_f32 v[118:119], v[118:119], v[42:43]
    s_add_u32 s52, s51, 0xdc000
    v_cvt_pk_bf16_f32 v116, 0, v116
    v_cvt_pk_bf16_f32 v117, 0, v117
    v_cvt_pk_bf16_f32 v118, 0, v118
    v_cvt_pk_bf16_f32 v119, 0, v119
    v_pk_add_f32 v[108:109], v[108:109], v[116:117]
    v_pk_add_f32 v[110:111], v[110:111], v[118:119]
    buffer_store_dwordx4 v[108:111], v25, s[12:15], s52 offen
    s_add_u32 s53, s50, 0x2c000
    buffer_load_dwordx2 v[240:241], v24, s[8:11], s53 offen
    s_add_u32 s53, s50, 0x2d000
    buffer_load_dwordx2 v[242:243], v24, s[8:11], s53 offen
    s_add_u32 s53, s50, 0x2e000
    buffer_load_dwordx2 v[244:245], v24, s[8:11], s53 offen
    s_add_u32 s53, s50, 0x2f000
    buffer_load_dwordx2 v[246:247], v24, s[8:11], s53 offen
    s_add_u32 s53, s50, 0x3c000
    buffer_load_dwordx2 v[248:249], v24, s[8:11], s53 offen
    s_add_u32 s53, s50, 0x3d000
    buffer_load_dwordx2 v[250:251], v24, s[8:11], s53 offen
    s_add_u32 s53, s50, 0x3e000
    buffer_load_dwordx2 v[252:253], v24, s[8:11], s53 offen
    s_add_u32 s53, s50, 0x3f000
    buffer_load_dwordx2 v[254:255], v24, s[8:11], s53 offen
    s_waitcnt vmcnt(48) lgkmcnt(8)
    ds_read_b128 v[80:83], v28 offset:8448
    ds_read_b128 v[84:87], v28 offset:9504
    ds_read_b128 v[88:91], v28 offset:10560
    ds_read_b128 v[92:95], v28 offset:11616
    ds_read_b128 v[96:99], v28 offset:12672
    ds_read_b128 v[100:103], v28 offset:13728
    ds_read_b128 v[104:107], v28 offset:14784
    ds_read_b128 v[108:111], v28 offset:15840
    ds_write_b128 v27, a[24:27] offset:16896
    ds_write_b128 v27, a[56:59] offset:16960
    ds_write_b128 v27, a[88:91] offset:17024
    ds_write_b128 v27, a[120:123] offset:17088
    ds_write_b128 v27, a[152:155] offset:17152
    ds_write_b128 v27, a[184:187] offset:17216
    ds_write_b128 v27, a[216:219] offset:17280
    ds_write_b128 v27, a[248:251] offset:17344
    v_lshlrev_b32 v112, 16, v192
    v_and_b32 v113, 0xffff0000, v192
    v_lshlrev_b32 v114, 16, v193
    v_and_b32 v115, 0xffff0000, v193
    v_pk_mul_f32 v[112:113], v[112:113], v[40:41]
    v_pk_mul_f32 v[114:115], v[114:115], v[42:43]
    s_add_u32 s52, s51, 0x20000
    v_cvt_pk_bf16_f32 v112, 0, v112
    v_cvt_pk_bf16_f32 v113, 0, v113
    v_cvt_pk_bf16_f32 v114, 0, v114
    v_cvt_pk_bf16_f32 v115, 0, v115
    v_pk_add_f32 v[48:49], v[48:49], v[112:113]
    v_pk_add_f32 v[50:51], v[50:51], v[114:115]
    buffer_store_dwordx4 v[48:51], v25, s[12:15], s52 offen
    v_lshlrev_b32 v116, 16, v194
    v_and_b32 v117, 0xffff0000, v194
    v_lshlrev_b32 v118, 16, v195
    v_and_b32 v119, 0xffff0000, v195
    v_pk_mul_f32 v[116:117], v[116:117], v[40:41]
    v_pk_mul_f32 v[118:119], v[118:119], v[42:43]
    s_add_u32 s52, s51, 0x24000
    v_cvt_pk_bf16_f32 v116, 0, v116
    v_cvt_pk_bf16_f32 v117, 0, v117
    v_cvt_pk_bf16_f32 v118, 0, v118
    v_cvt_pk_bf16_f32 v119, 0, v119
    v_pk_add_f32 v[52:53], v[52:53], v[116:117]
    v_pk_add_f32 v[54:55], v[54:55], v[118:119]
    buffer_store_dwordx4 v[52:55], v25, s[12:15], s52 offen
    v_lshlrev_b32 v112, 16, v196
    v_and_b32 v113, 0xffff0000, v196
    v_lshlrev_b32 v114, 16, v197
    v_and_b32 v115, 0xffff0000, v197
    v_pk_mul_f32 v[112:113], v[112:113], v[40:41]
    v_pk_mul_f32 v[114:115], v[114:115], v[42:43]
    s_add_u32 s52, s51, 0x28000
    v_cvt_pk_bf16_f32 v112, 0, v112
    v_cvt_pk_bf16_f32 v113, 0, v113
    v_cvt_pk_bf16_f32 v114, 0, v114
    v_cvt_pk_bf16_f32 v115, 0, v115
    v_pk_add_f32 v[56:57], v[56:57], v[112:113]
    v_pk_add_f32 v[58:59], v[58:59], v[114:115]
    buffer_store_dwordx4 v[56:59], v25, s[12:15], s52 offen
    v_lshlrev_b32 v116, 16, v198
    v_and_b32 v117, 0xffff0000, v198
    v_lshlrev_b32 v118, 16, v199
    v_and_b32 v119, 0xffff0000, v199
    v_pk_mul_f32 v[116:117], v[116:117], v[40:41]
    v_pk_mul_f32 v[118:119], v[118:119], v[42:43]
    s_add_u32 s52, s51, 0x2c000
    v_cvt_pk_bf16_f32 v116, 0, v116
    v_cvt_pk_bf16_f32 v117, 0, v117
    v_cvt_pk_bf16_f32 v118, 0, v118
    v_cvt_pk_bf16_f32 v119, 0, v119
    v_pk_add_f32 v[60:61], v[60:61], v[116:117]
    v_pk_add_f32 v[62:63], v[62:63], v[118:119]
    buffer_store_dwordx4 v[60:63], v25, s[12:15], s52 offen
    v_lshlrev_b32 v112, 16, v200
    v_and_b32 v113, 0xffff0000, v200
    v_lshlrev_b32 v114, 16, v201
    v_and_b32 v115, 0xffff0000, v201
    v_pk_mul_f32 v[112:113], v[112:113], v[40:41]
    v_pk_mul_f32 v[114:115], v[114:115], v[42:43]
    s_add_u32 s52, s51, 0x60000
    v_cvt_pk_bf16_f32 v112, 0, v112
    v_cvt_pk_bf16_f32 v113, 0, v113
    v_cvt_pk_bf16_f32 v114, 0, v114
    v_cvt_pk_bf16_f32 v115, 0, v115
    v_pk_add_f32 v[64:65], v[64:65], v[112:113]
    v_pk_add_f32 v[66:67], v[66:67], v[114:115]
    buffer_store_dwordx4 v[64:67], v25, s[12:15], s52 offen
    v_lshlrev_b32 v116, 16, v202
    v_and_b32 v117, 0xffff0000, v202
    v_lshlrev_b32 v118, 16, v203
    v_and_b32 v119, 0xffff0000, v203
    v_pk_mul_f32 v[116:117], v[116:117], v[40:41]
    v_pk_mul_f32 v[118:119], v[118:119], v[42:43]
    s_add_u32 s52, s51, 0x64000
    v_cvt_pk_bf16_f32 v116, 0, v116
    v_cvt_pk_bf16_f32 v117, 0, v117
    v_cvt_pk_bf16_f32 v118, 0, v118
    v_cvt_pk_bf16_f32 v119, 0, v119
    v_pk_add_f32 v[68:69], v[68:69], v[116:117]
    v_pk_add_f32 v[70:71], v[70:71], v[118:119]
    buffer_store_dwordx4 v[68:71], v25, s[12:15], s52 offen
    v_lshlrev_b32 v112, 16, v204
    v_and_b32 v113, 0xffff0000, v204
    v_lshlrev_b32 v114, 16, v205
    v_and_b32 v115, 0xffff0000, v205
    v_pk_mul_f32 v[112:113], v[112:113], v[40:41]
    v_pk_mul_f32 v[114:115], v[114:115], v[42:43]
    s_add_u32 s52, s51, 0x68000
    v_cvt_pk_bf16_f32 v112, 0, v112
    v_cvt_pk_bf16_f32 v113, 0, v113
    v_cvt_pk_bf16_f32 v114, 0, v114
    v_cvt_pk_bf16_f32 v115, 0, v115
    v_pk_add_f32 v[72:73], v[72:73], v[112:113]
    v_pk_add_f32 v[74:75], v[74:75], v[114:115]
    buffer_store_dwordx4 v[72:75], v25, s[12:15], s52 offen
    v_lshlrev_b32 v116, 16, v206
    v_and_b32 v117, 0xffff0000, v206
    v_lshlrev_b32 v118, 16, v207
    v_and_b32 v119, 0xffff0000, v207
    v_pk_mul_f32 v[116:117], v[116:117], v[40:41]
    v_pk_mul_f32 v[118:119], v[118:119], v[42:43]
    s_add_u32 s52, s51, 0x6c000
    v_cvt_pk_bf16_f32 v116, 0, v116
    v_cvt_pk_bf16_f32 v117, 0, v117
    v_cvt_pk_bf16_f32 v118, 0, v118
    v_cvt_pk_bf16_f32 v119, 0, v119
    v_pk_add_f32 v[76:77], v[76:77], v[116:117]
    v_pk_add_f32 v[78:79], v[78:79], v[118:119]
    buffer_store_dwordx4 v[76:79], v25, s[12:15], s52 offen
    s_waitcnt vmcnt(40) lgkmcnt(8)
    ds_read_b128 v[48:51], v28 offset:16896
    ds_read_b128 v[52:55], v28 offset:17952
    ds_read_b128 v[56:59], v28 offset:19008
    ds_read_b128 v[60:63], v28 offset:20064
    ds_read_b128 v[64:67], v28 offset:21120
    ds_read_b128 v[68:71], v28 offset:22176
    ds_read_b128 v[72:75], v28 offset:23232
    ds_read_b128 v[76:79], v28 offset:24288
    ds_write_b128 v27, a[28:31] offset:25344
    ds_write_b128 v27, a[60:63] offset:25408
    ds_write_b128 v27, a[92:95] offset:25472
    ds_write_b128 v27, a[124:127] offset:25536
    ds_write_b128 v27, a[156:159] offset:25600
    ds_write_b128 v27, a[188:191] offset:25664
    ds_write_b128 v27, a[220:223] offset:25728
    ds_write_b128 v27, a[252:255] offset:25792
    v_lshlrev_b32 v112, 16, v208
    v_and_b32 v113, 0xffff0000, v208
    v_lshlrev_b32 v114, 16, v209
    v_and_b32 v115, 0xffff0000, v209
    v_pk_mul_f32 v[112:113], v[112:113], v[40:41]
    v_pk_mul_f32 v[114:115], v[114:115], v[42:43]
    s_add_u32 s52, s51, 0xa0000
    v_cvt_pk_bf16_f32 v112, 0, v112
    v_cvt_pk_bf16_f32 v113, 0, v113
    v_cvt_pk_bf16_f32 v114, 0, v114
    v_cvt_pk_bf16_f32 v115, 0, v115
    v_pk_add_f32 v[80:81], v[80:81], v[112:113]
    v_pk_add_f32 v[82:83], v[82:83], v[114:115]
    buffer_store_dwordx4 v[80:83], v25, s[12:15], s52 offen
    v_lshlrev_b32 v116, 16, v210
    v_and_b32 v117, 0xffff0000, v210
    v_lshlrev_b32 v118, 16, v211
    v_and_b32 v119, 0xffff0000, v211
    v_pk_mul_f32 v[116:117], v[116:117], v[40:41]
    v_pk_mul_f32 v[118:119], v[118:119], v[42:43]
    s_add_u32 s52, s51, 0xa4000
    v_cvt_pk_bf16_f32 v116, 0, v116
    v_cvt_pk_bf16_f32 v117, 0, v117
    v_cvt_pk_bf16_f32 v118, 0, v118
    v_cvt_pk_bf16_f32 v119, 0, v119
    v_pk_add_f32 v[84:85], v[84:85], v[116:117]
    v_pk_add_f32 v[86:87], v[86:87], v[118:119]
    buffer_store_dwordx4 v[84:87], v25, s[12:15], s52 offen
    v_lshlrev_b32 v112, 16, v212
    v_and_b32 v113, 0xffff0000, v212
    v_lshlrev_b32 v114, 16, v213
    v_and_b32 v115, 0xffff0000, v213
    v_pk_mul_f32 v[112:113], v[112:113], v[40:41]
    v_pk_mul_f32 v[114:115], v[114:115], v[42:43]
    s_add_u32 s52, s51, 0xa8000
    v_cvt_pk_bf16_f32 v112, 0, v112
    v_cvt_pk_bf16_f32 v113, 0, v113
    v_cvt_pk_bf16_f32 v114, 0, v114
    v_cvt_pk_bf16_f32 v115, 0, v115
    v_pk_add_f32 v[88:89], v[88:89], v[112:113]
    v_pk_add_f32 v[90:91], v[90:91], v[114:115]
    buffer_store_dwordx4 v[88:91], v25, s[12:15], s52 offen
    v_lshlrev_b32 v116, 16, v214
    v_and_b32 v117, 0xffff0000, v214
    v_lshlrev_b32 v118, 16, v215
    v_and_b32 v119, 0xffff0000, v215
    v_pk_mul_f32 v[116:117], v[116:117], v[40:41]
    v_pk_mul_f32 v[118:119], v[118:119], v[42:43]
    s_add_u32 s52, s51, 0xac000
    v_cvt_pk_bf16_f32 v116, 0, v116
    v_cvt_pk_bf16_f32 v117, 0, v117
    v_cvt_pk_bf16_f32 v118, 0, v118
    v_cvt_pk_bf16_f32 v119, 0, v119
    v_pk_add_f32 v[92:93], v[92:93], v[116:117]
    v_pk_add_f32 v[94:95], v[94:95], v[118:119]
    buffer_store_dwordx4 v[92:95], v25, s[12:15], s52 offen
    v_lshlrev_b32 v112, 16, v216
    v_and_b32 v113, 0xffff0000, v216
    v_lshlrev_b32 v114, 16, v217
    v_and_b32 v115, 0xffff0000, v217
    v_pk_mul_f32 v[112:113], v[112:113], v[40:41]
    v_pk_mul_f32 v[114:115], v[114:115], v[42:43]
    s_add_u32 s52, s51, 0xe0000
    v_cvt_pk_bf16_f32 v112, 0, v112
    v_cvt_pk_bf16_f32 v113, 0, v113
    v_cvt_pk_bf16_f32 v114, 0, v114
    v_cvt_pk_bf16_f32 v115, 0, v115
    v_pk_add_f32 v[96:97], v[96:97], v[112:113]
    v_pk_add_f32 v[98:99], v[98:99], v[114:115]
    buffer_store_dwordx4 v[96:99], v25, s[12:15], s52 offen
    v_lshlrev_b32 v116, 16, v218
    v_and_b32 v117, 0xffff0000, v218
    v_lshlrev_b32 v118, 16, v219
    v_and_b32 v119, 0xffff0000, v219
    v_pk_mul_f32 v[116:117], v[116:117], v[40:41]
    v_pk_mul_f32 v[118:119], v[118:119], v[42:43]
    s_add_u32 s52, s51, 0xe4000
    v_cvt_pk_bf16_f32 v116, 0, v116
    v_cvt_pk_bf16_f32 v117, 0, v117
    v_cvt_pk_bf16_f32 v118, 0, v118
    v_cvt_pk_bf16_f32 v119, 0, v119
    v_pk_add_f32 v[100:101], v[100:101], v[116:117]
    v_pk_add_f32 v[102:103], v[102:103], v[118:119]
    buffer_store_dwordx4 v[100:103], v25, s[12:15], s52 offen
    v_lshlrev_b32 v112, 16, v220
    v_and_b32 v113, 0xffff0000, v220
    v_lshlrev_b32 v114, 16, v221
    v_and_b32 v115, 0xffff0000, v221
    v_pk_mul_f32 v[112:113], v[112:113], v[40:41]
    v_pk_mul_f32 v[114:115], v[114:115], v[42:43]
    s_add_u32 s52, s51, 0xe8000
    v_cvt_pk_bf16_f32 v112, 0, v112
    v_cvt_pk_bf16_f32 v113, 0, v113
    v_cvt_pk_bf16_f32 v114, 0, v114
    v_cvt_pk_bf16_f32 v115, 0, v115
    v_pk_add_f32 v[104:105], v[104:105], v[112:113]
    v_pk_add_f32 v[106:107], v[106:107], v[114:115]
    buffer_store_dwordx4 v[104:107], v25, s[12:15], s52 offen
    v_lshlrev_b32 v116, 16, v222
    v_and_b32 v117, 0xffff0000, v222
    v_lshlrev_b32 v118, 16, v223
    v_and_b32 v119, 0xffff0000, v223
    v_pk_mul_f32 v[116:117], v[116:117], v[40:41]
    v_pk_mul_f32 v[118:119], v[118:119], v[42:43]
    s_add_u32 s52, s51, 0xec000
    v_cvt_pk_bf16_f32 v116, 0, v116
    v_cvt_pk_bf16_f32 v117, 0, v117
    v_cvt_pk_bf16_f32 v118, 0, v118
    v_cvt_pk_bf16_f32 v119, 0, v119
    v_pk_add_f32 v[108:109], v[108:109], v[116:117]
    v_pk_add_f32 v[110:111], v[110:111], v[118:119]
    buffer_store_dwordx4 v[108:111], v25, s[12:15], s52 offen
    s_waitcnt vmcnt(32) lgkmcnt(8)
    ds_read_b128 v[80:83], v28 offset:25344
    ds_read_b128 v[84:87], v28 offset:26400
    ds_read_b128 v[88:91], v28 offset:27456
    ds_read_b128 v[92:95], v28 offset:28512
    ds_read_b128 v[96:99], v28 offset:29568
    ds_read_b128 v[100:103], v28 offset:30624
    ds_read_b128 v[104:107], v28 offset:31680
    ds_read_b128 v[108:111], v28 offset:32736
    v_lshlrev_b32 v112, 16, v224
    v_and_b32 v113, 0xffff0000, v224
    v_lshlrev_b32 v114, 16, v225
    v_and_b32 v115, 0xffff0000, v225
    v_pk_mul_f32 v[112:113], v[112:113], v[40:41]
    v_pk_mul_f32 v[114:115], v[114:115], v[42:43]
    s_add_u32 s52, s51, 0x30000
    v_cvt_pk_bf16_f32 v112, 0, v112
    v_cvt_pk_bf16_f32 v113, 0, v113
    v_cvt_pk_bf16_f32 v114, 0, v114
    v_cvt_pk_bf16_f32 v115, 0, v115
    v_pk_add_f32 v[48:49], v[48:49], v[112:113]
    v_pk_add_f32 v[50:51], v[50:51], v[114:115]
    buffer_store_dwordx4 v[48:51], v25, s[12:15], s52 offen
    v_lshlrev_b32 v116, 16, v226
    v_and_b32 v117, 0xffff0000, v226
    v_lshlrev_b32 v118, 16, v227
    v_and_b32 v119, 0xffff0000, v227
    v_pk_mul_f32 v[116:117], v[116:117], v[40:41]
    v_pk_mul_f32 v[118:119], v[118:119], v[42:43]
    s_add_u32 s52, s51, 0x34000
    v_cvt_pk_bf16_f32 v116, 0, v116
    v_cvt_pk_bf16_f32 v117, 0, v117
    v_cvt_pk_bf16_f32 v118, 0, v118
    v_cvt_pk_bf16_f32 v119, 0, v119
    v_pk_add_f32 v[52:53], v[52:53], v[116:117]
    v_pk_add_f32 v[54:55], v[54:55], v[118:119]
    buffer_store_dwordx4 v[52:55], v25, s[12:15], s52 offen
    v_lshlrev_b32 v112, 16, v228
    v_and_b32 v113, 0xffff0000, v228
    v_lshlrev_b32 v114, 16, v229
    v_and_b32 v115, 0xffff0000, v229
    v_pk_mul_f32 v[112:113], v[112:113], v[40:41]
    v_pk_mul_f32 v[114:115], v[114:115], v[42:43]
    s_add_u32 s52, s51, 0x38000
    v_cvt_pk_bf16_f32 v112, 0, v112
    v_cvt_pk_bf16_f32 v113, 0, v113
    v_cvt_pk_bf16_f32 v114, 0, v114
    v_cvt_pk_bf16_f32 v115, 0, v115
    v_pk_add_f32 v[56:57], v[56:57], v[112:113]
    v_pk_add_f32 v[58:59], v[58:59], v[114:115]
    buffer_store_dwordx4 v[56:59], v25, s[12:15], s52 offen
    v_lshlrev_b32 v116, 16, v230
    v_and_b32 v117, 0xffff0000, v230
    v_lshlrev_b32 v118, 16, v231
    v_and_b32 v119, 0xffff0000, v231
    v_pk_mul_f32 v[116:117], v[116:117], v[40:41]
    v_pk_mul_f32 v[118:119], v[118:119], v[42:43]
    s_add_u32 s52, s51, 0x3c000
    v_cvt_pk_bf16_f32 v116, 0, v116
    v_cvt_pk_bf16_f32 v117, 0, v117
    v_cvt_pk_bf16_f32 v118, 0, v118
    v_cvt_pk_bf16_f32 v119, 0, v119
    v_pk_add_f32 v[60:61], v[60:61], v[116:117]
    v_pk_add_f32 v[62:63], v[62:63], v[118:119]
    buffer_store_dwordx4 v[60:63], v25, s[12:15], s52 offen
    v_lshlrev_b32 v112, 16, v232
    v_and_b32 v113, 0xffff0000, v232
    v_lshlrev_b32 v114, 16, v233
    v_and_b32 v115, 0xffff0000, v233
    v_pk_mul_f32 v[112:113], v[112:113], v[40:41]
    v_pk_mul_f32 v[114:115], v[114:115], v[42:43]
    s_add_u32 s52, s51, 0x70000
    v_cvt_pk_bf16_f32 v112, 0, v112
    v_cvt_pk_bf16_f32 v113, 0, v113
    v_cvt_pk_bf16_f32 v114, 0, v114
    v_cvt_pk_bf16_f32 v115, 0, v115
    v_pk_add_f32 v[64:65], v[64:65], v[112:113]
    v_pk_add_f32 v[66:67], v[66:67], v[114:115]
    buffer_store_dwordx4 v[64:67], v25, s[12:15], s52 offen
    v_lshlrev_b32 v116, 16, v234
    v_and_b32 v117, 0xffff0000, v234
    v_lshlrev_b32 v118, 16, v235
    v_and_b32 v119, 0xffff0000, v235
    v_pk_mul_f32 v[116:117], v[116:117], v[40:41]
    v_pk_mul_f32 v[118:119], v[118:119], v[42:43]
    s_add_u32 s52, s51, 0x74000
    v_cvt_pk_bf16_f32 v116, 0, v116
    v_cvt_pk_bf16_f32 v117, 0, v117
    v_cvt_pk_bf16_f32 v118, 0, v118
    v_cvt_pk_bf16_f32 v119, 0, v119
    v_pk_add_f32 v[68:69], v[68:69], v[116:117]
    v_pk_add_f32 v[70:71], v[70:71], v[118:119]
    buffer_store_dwordx4 v[68:71], v25, s[12:15], s52 offen
    v_lshlrev_b32 v112, 16, v236
    v_and_b32 v113, 0xffff0000, v236
    v_lshlrev_b32 v114, 16, v237
    v_and_b32 v115, 0xffff0000, v237
    v_pk_mul_f32 v[112:113], v[112:113], v[40:41]
    v_pk_mul_f32 v[114:115], v[114:115], v[42:43]
    s_add_u32 s52, s51, 0x78000
    v_cvt_pk_bf16_f32 v112, 0, v112
    v_cvt_pk_bf16_f32 v113, 0, v113
    v_cvt_pk_bf16_f32 v114, 0, v114
    v_cvt_pk_bf16_f32 v115, 0, v115
    v_pk_add_f32 v[72:73], v[72:73], v[112:113]
    v_pk_add_f32 v[74:75], v[74:75], v[114:115]
    buffer_store_dwordx4 v[72:75], v25, s[12:15], s52 offen
    v_lshlrev_b32 v116, 16, v238
    v_and_b32 v117, 0xffff0000, v238
    v_lshlrev_b32 v118, 16, v239
    v_and_b32 v119, 0xffff0000, v239
    v_pk_mul_f32 v[116:117], v[116:117], v[40:41]
    v_pk_mul_f32 v[118:119], v[118:119], v[42:43]
    s_add_u32 s52, s51, 0x7c000
    v_cvt_pk_bf16_f32 v116, 0, v116
    v_cvt_pk_bf16_f32 v117, 0, v117
    v_cvt_pk_bf16_f32 v118, 0, v118
    v_cvt_pk_bf16_f32 v119, 0, v119
    v_pk_add_f32 v[76:77], v[76:77], v[116:117]
    v_pk_add_f32 v[78:79], v[78:79], v[118:119]
    buffer_store_dwordx4 v[76:79], v25, s[12:15], s52 offen
    s_waitcnt vmcnt(24) lgkmcnt(0)
    v_lshlrev_b32 v112, 16, v240
    v_and_b32 v113, 0xffff0000, v240
    v_lshlrev_b32 v114, 16, v241
    v_and_b32 v115, 0xffff0000, v241
    v_pk_mul_f32 v[112:113], v[112:113], v[40:41]
    v_pk_mul_f32 v[114:115], v[114:115], v[42:43]
    s_add_u32 s52, s51, 0xb0000
    v_cvt_pk_bf16_f32 v112, 0, v112
    v_cvt_pk_bf16_f32 v113, 0, v113
    v_cvt_pk_bf16_f32 v114, 0, v114
    v_cvt_pk_bf16_f32 v115, 0, v115
    v_pk_add_f32 v[80:81], v[80:81], v[112:113]
    v_pk_add_f32 v[82:83], v[82:83], v[114:115]
    buffer_store_dwordx4 v[80:83], v25, s[12:15], s52 offen
    v_lshlrev_b32 v116, 16, v242
    v_and_b32 v117, 0xffff0000, v242
    v_lshlrev_b32 v118, 16, v243
    v_and_b32 v119, 0xffff0000, v243
    v_pk_mul_f32 v[116:117], v[116:117], v[40:41]
    v_pk_mul_f32 v[118:119], v[118:119], v[42:43]
    s_add_u32 s52, s51, 0xb4000
    v_cvt_pk_bf16_f32 v116, 0, v116
    v_cvt_pk_bf16_f32 v117, 0, v117
    v_cvt_pk_bf16_f32 v118, 0, v118
    v_cvt_pk_bf16_f32 v119, 0, v119
    v_pk_add_f32 v[84:85], v[84:85], v[116:117]
    v_pk_add_f32 v[86:87], v[86:87], v[118:119]
    buffer_store_dwordx4 v[84:87], v25, s[12:15], s52 offen
    v_lshlrev_b32 v112, 16, v244
    v_and_b32 v113, 0xffff0000, v244
    v_lshlrev_b32 v114, 16, v245
    v_and_b32 v115, 0xffff0000, v245
    v_pk_mul_f32 v[112:113], v[112:113], v[40:41]
    v_pk_mul_f32 v[114:115], v[114:115], v[42:43]
    s_add_u32 s52, s51, 0xb8000
    v_cvt_pk_bf16_f32 v112, 0, v112
    v_cvt_pk_bf16_f32 v113, 0, v113
    v_cvt_pk_bf16_f32 v114, 0, v114
    v_cvt_pk_bf16_f32 v115, 0, v115
    v_pk_add_f32 v[88:89], v[88:89], v[112:113]
    v_pk_add_f32 v[90:91], v[90:91], v[114:115]
    buffer_store_dwordx4 v[88:91], v25, s[12:15], s52 offen
    v_lshlrev_b32 v116, 16, v246
    v_and_b32 v117, 0xffff0000, v246
    v_lshlrev_b32 v118, 16, v247
    v_and_b32 v119, 0xffff0000, v247
    v_pk_mul_f32 v[116:117], v[116:117], v[40:41]
    v_pk_mul_f32 v[118:119], v[118:119], v[42:43]
    s_add_u32 s52, s51, 0xbc000
    v_cvt_pk_bf16_f32 v116, 0, v116
    v_cvt_pk_bf16_f32 v117, 0, v117
    v_cvt_pk_bf16_f32 v118, 0, v118
    v_cvt_pk_bf16_f32 v119, 0, v119
    v_pk_add_f32 v[92:93], v[92:93], v[116:117]
    v_pk_add_f32 v[94:95], v[94:95], v[118:119]
    buffer_store_dwordx4 v[92:95], v25, s[12:15], s52 offen
    v_lshlrev_b32 v112, 16, v248
    v_and_b32 v113, 0xffff0000, v248
    v_lshlrev_b32 v114, 16, v249
    v_and_b32 v115, 0xffff0000, v249
    v_pk_mul_f32 v[112:113], v[112:113], v[40:41]
    v_pk_mul_f32 v[114:115], v[114:115], v[42:43]
    s_add_u32 s52, s51, 0xf0000
    v_cvt_pk_bf16_f32 v112, 0, v112
    v_cvt_pk_bf16_f32 v113, 0, v113
    v_cvt_pk_bf16_f32 v114, 0, v114
    v_cvt_pk_bf16_f32 v115, 0, v115
    v_pk_add_f32 v[96:97], v[96:97], v[112:113]
    v_pk_add_f32 v[98:99], v[98:99], v[114:115]
    buffer_store_dwordx4 v[96:99], v25, s[12:15], s52 offen
    v_lshlrev_b32 v116, 16, v250
    v_and_b32 v117, 0xffff0000, v250
    v_lshlrev_b32 v118, 16, v251
    v_and_b32 v119, 0xffff0000, v251
    v_pk_mul_f32 v[116:117], v[116:117], v[40:41]
    v_pk_mul_f32 v[118:119], v[118:119], v[42:43]
    s_add_u32 s52, s51, 0xf4000
    v_cvt_pk_bf16_f32 v116, 0, v116
    v_cvt_pk_bf16_f32 v117, 0, v117
    v_cvt_pk_bf16_f32 v118, 0, v118
    v_cvt_pk_bf16_f32 v119, 0, v119
    v_pk_add_f32 v[100:101], v[100:101], v[116:117]
    v_pk_add_f32 v[102:103], v[102:103], v[118:119]
    buffer_store_dwordx4 v[100:103], v25, s[12:15], s52 offen
    v_lshlrev_b32 v112, 16, v252
    v_and_b32 v113, 0xffff0000, v252
    v_lshlrev_b32 v114, 16, v253
    v_and_b32 v115, 0xffff0000, v253
    v_pk_mul_f32 v[112:113], v[112:113], v[40:41]
    v_pk_mul_f32 v[114:115], v[114:115], v[42:43]
    s_add_u32 s52, s51, 0xf8000
    v_cvt_pk_bf16_f32 v112, 0, v112
    v_cvt_pk_bf16_f32 v113, 0, v113
    v_cvt_pk_bf16_f32 v114, 0, v114
    v_cvt_pk_bf16_f32 v115, 0, v115
    v_pk_add_f32 v[104:105], v[104:105], v[112:113]
    v_pk_add_f32 v[106:107], v[106:107], v[114:115]
    buffer_store_dwordx4 v[104:107], v25, s[12:15], s52 offen
    v_lshlrev_b32 v116, 16, v254
    v_and_b32 v117, 0xffff0000, v254
    v_lshlrev_b32 v118, 16, v255
    v_and_b32 v119, 0xffff0000, v255
    v_pk_mul_f32 v[116:117], v[116:117], v[40:41]
    v_pk_mul_f32 v[118:119], v[118:119], v[42:43]
    s_add_u32 s52, s51, 0xfc000
    v_cvt_pk_bf16_f32 v116, 0, v116
    v_cvt_pk_bf16_f32 v117, 0, v117
    v_cvt_pk_bf16_f32 v118, 0, v118
    v_cvt_pk_bf16_f32 v119, 0, v119
    v_pk_add_f32 v[108:109], v[108:109], v[116:117]
    v_pk_add_f32 v[110:111], v[110:111], v[118:119]
    buffer_store_dwordx4 v[108:111], v25, s[12:15], s52 offen
chain_kernel_seg:
    s_waitcnt vmcnt(0) lgkmcnt(0)
    s_barrier
    s_mov_b32 s12, s92
    s_and_b32 s13, s93, 0xffff
    s_mov_b32 s14, 0x800000
    s_mov_b32 s15, 0x00020000
    s_lshr_b32 s60, s57, 3
    s_lshl_b32 s28, s60, 21
    s_and_b32 s60, s57, 7
    s_lshl_b32 s60, s60, 8
    s_add_u32 s28, s28, s60
    v_bfe_u32 v24, v0, 4, 3
    v_lshlrev_b32 v24, 1, v24
    v_and_b32 v25, 15, v0
    v_xor_b32 v24, v24, v25
    v_lshlrev_b32 v6, 4, v24
    v_bfe_u32 v24, v0, 4, 2
    v_lshl_add_u32 v6, v24, 11, v6
    v_bfe_u32 v24, v0, 6, 1
    v_lshl_add_u32 v6, v24, 13, v6
    v_bfe_u32 v24, v0, 7, 1
    v_lshl_add_u32 v6, v24, 15, v6
    s_and_b32 s60, s58, 1
    s_lshl_b32 s61, s60, 11
    s_lshr_b32 s60, s58, 1
    s_lshl_b32 s60, s60, 10
    s_add_u32 s32, s60, s61
    s_add_u32 m0, s32, 0
    s_add_u32 s61, s28, 0x0
    buffer_load_dwordx4 v6, s[12:15], s61 offen nt lds
    s_add_u32 m0, s32, 4096
    s_add_u32 s61, s28, 0x4000
    buffer_load_dwordx4 v6, s[12:15], s61 offen nt lds
    s_add_u32 m0, s32, 8192
    s_add_u32 s61, s28, 0x10000
    buffer_load_dwordx4 v6, s[12:15], s61 offen nt lds
    s_add_u32 m0, s32, 12288
    s_add_u32 s61, s28, 0x14000
    buffer_load_dwordx4 v6, s[12:15], s61 offen nt lds
    s_add_u32 m0, s32, 16384
    s_add_u32 s61, s28, 0x20000
    buffer_load_dwordx4 v6, s[12:15], s61 offen nt lds
    s_add_u32 m0, s32, 20480
    s_add_u32 s61, s28, 0x24000
    buffer_load_dwordx4 v6, s[12:15], s61 offen nt lds
    s_add_u32 m0, s32, 24576
    s_add_u32 s61, s28, 0x30000
    buffer_load_dwordx4 v6, s[12:15], s61 offen nt lds
    s_add_u32 m0, s32, 28672
    s_add_u32 s61, s28, 0x34000
    buffer_load_dwordx4 v6, s[12:15], s61 offen nt lds
    s_mov_b32 s8, s100
    s_and_b32 s9, s101, 0xffff
    s_mov_b32 s10, 0xc000000
    s_mov_b32 s11, 0x00020000
    s_mov_b32 s16, s96
    s_and_b32 s17, s97, 0xffff
    s_mov_b32 s18, 0x1000000
    s_mov_b32 s19, 0x00020000
    v_and_b32 v24, 63, v0
    v_lshlrev_b32 v1, 4, v24
    v_add_u32 v2, 4096, v1
    v_lshlrev_b32 v10, 7, v24
    v_mov_b32 v11, 0
    s_lshl_b32 s60, s56, 8
    s_add_u32 s60, s60, 0xb300000
    s_lshl2_add_u32 s27, s57, s60
    s_and_b32 s38, s57, 7
    s_lshl_b32 s38, s38, 16
    s_cmp_eq_u32 s58, 0
    s_cselect_b32 s27, s27, 0xc000000
    s_cselect_b32 s38, s38, 0xc000000
    s_add_u32 s60, s60, s100
    s_addc_u32 s61, s101, 0
    v_and_b32 v25, 31, v0
    v_lshlrev_b32 v25, 2, v25
    v_add_u32 v16, s60, v25
    v_mov_b32 v17, s61
    s_add_u32 s60, s98, 176
    s_addc_u32 s61, s99, 0
    v_writelane_b32 v16, s60, 32
    v_writelane_b32 v17, s61, 32
    buffer_store_dword v11, v11, s[8:11], s27 offen
    s_mov_b32 s26, 0
    s_mov_b32 s30, 0
    s_mov_b32 s40, 0
    s_mov_b32 s29, 32768
    v_and_b32 v24, 15, v0
    v_lshlrev_b32 v15, 13, v24
    v_bfe_u32 v24, v0, 4, 2
    v_lshl_add_u32 v15, v24, 4, v15
    s_lshr_b32 s60, s57, 4
    s_lshl_b32 s60, s60, 17
    s_and_b32 s61, s57, 7
    s_lshl_b32 s61, s61, 9
    s_add_u32 s60, s60, s61
    s_lshl_b32 s61, s58, 7
    s_add_u32 s60, s60, s61
    s_and_b32 s61, s57, 8
    s_lshl_b32 s61, s61, 3
    s_add_u32 s60, s60, s61
    s_add_u32 s60, s60, 4096
    v_add_u32 v15, s60, v15
    s_lshl_b32 s61, s58, 12
    s_xor_b32 s60, s57, 24
    s_lshl_b32 s60, s60, 14
    s_add_u32 s60, s60, s61
    s_add_u32 s60, s60, 0
    v_add_u32 v20, s60, v1
    s_xor_b32 s60, s57, 16
    s_lshl_b32 s60, s60, 14
    s_add_u32 s60, s60, s61
    s_add_u32 s60, s60, 1024
    v_add_u32 v21, s60, v1
    s_xor_b32 s60, s57, 8
    s_lshl_b32 s60, s60, 14
    s_add_u32 s60, s60, s61
    s_add_u32 s60, s60, 2048
    v_add_u32 v22, s60, v1
    s_xor_b32 s60, s57, 0
    s_lshl_b32 s60, s60, 14
    s_add_u32 s60, s60, s61
    s_add_u32 s60, s60, 0
    v_add_u32 v23, s60, v1
    s_lshl_b32 s24, s56, 20
    s_add_u32 s24, s24, 0xb800000
    s_and_b32 s60, s57, 24
    s_add_u32 s60, s60, s58
    s_lshl_b32 s31, s60, 16
    s_add_u32 s31, s31, 0xc000
    s_add_u32 s31, s31, s59
    s_mul_i32 s33, s56, 8
    s_lshr_b32 s33, 0x2010000, s33
    s_and_b32 s33, s33, 255
    s_mul_i32 s39, s56, 8
    s_lshr_b32 s39, 0x14141400, s39
    s_and_b32 s39, s39, 255
    s_cmp_eq_u32 s56, 0
    s_cmov_b32 s36, 0x3f3d3c
    s_cmp_eq_u32 s56, 1
    s_cmov_b32 s36, 0x3e
    s_cmp_eq_u32 s56, 2
    s_cmov_b32 s36, 0x0
    s_cmp_eq_u32 s56, 3
    s_cmov_b32 s36, 0x0
    s_add_u32 m0, s32, 32768
    s_add_u32 s61, s28, 0x40000
    buffer_load_dwordx4 v6, s[12:15], s61 offen nt lds
    s_add_u32 m0, s32, 36864
    s_add_u32 s61, s28, 0x44000
    buffer_load_dwordx4 v6, s[12:15], s61 offen nt lds
    s_add_u32 m0, s32, 40960
    s_add_u32 s61, s28, 0x50000
    buffer_load_dwordx4 v6, s[12:15], s61 offen nt lds
    s_add_u32 m0, s32, 45056
    s_add_u32 s61, s28, 0x54000
    buffer_load_dwordx4 v6, s[12:15], s61 offen nt lds
    s_add_u32 m0, s32, 49152
    s_add_u32 s61, s28, 0x60000
    buffer_load_dwordx4 v6, s[12:15], s61 offen nt lds
    s_add_u32 m0, s32, 53248
    s_add_u32 s61, s28, 0x64000
    buffer_load_dwordx4 v6, s[12:15], s61 offen nt lds
    s_add_u32 m0, s32, 57344
    s_add_u32 s61, s28, 0x70000
    buffer_load_dwordx4 v6, s[12:15], s61 offen nt lds
    s_add_u32 m0, s32, 61440
    s_add_u32 s61, s28, 0x74000
    buffer_load_dwordx4 v6, s[12:15], s61 offen nt lds
    s_add_u32 m0, s32, 65536
    s_add_u32 s61, s28, 0x80000
    buffer_load_dwordx4 v6, s[12:15], s61 offen nt lds
    s_add_u32 m0, s32, 69632
    s_add_u32 s61, s28, 0x84000
    buffer_load_dwordx4 v6, s[12:15], s61 offen nt lds
    s_add_u32 m0, s32, 73728
    s_add_u32 s61, s28, 0x90000
    buffer_load_dwordx4 v6, s[12:15], s61 offen nt lds
    s_add_u32 m0, s32, 77824
    s_add_u32 s61, s28, 0x94000
    buffer_load_dwordx4 v6, s[12:15], s61 offen nt lds
    s_add_u32 m0, s32, 81920
    s_add_u32 s61, s28, 0xa0000
    buffer_load_dwordx4 v6, s[12:15], s61 offen nt lds
    s_add_u32 m0, s32, 86016
    s_add_u32 s61, s28, 0xa4000
    buffer_load_dwordx4 v6, s[12:15], s61 offen nt lds
    s_add_u32 m0, s32, 90112
    s_add_u32 s61, s28, 0xb0000
    buffer_load_dwordx4 v6, s[12:15], s61 offen nt lds
    s_add_u32 m0, s32, 94208
    s_add_u32 s61, s28, 0xb4000
    buffer_load_dwordx4 v6, s[12:15], s61 offen nt lds
    s_add_u32 m0, s32, 98304
    s_add_u32 s61, s28, 0xc0000
    buffer_load_dwordx4 v6, s[12:15], s61 offen nt lds
    s_add_u32 m0, s32, 102400
    s_add_u32 s61, s28, 0xc4000
    buffer_load_dwordx4 v6, s[12:15], s61 offen nt lds
    s_add_u32 m0, s32, 106496
    s_add_u32 s61, s28, 0xd0000
    buffer_load_dwordx4 v6, s[12:15], s61 offen nt lds
    s_add_u32 m0, s32, 110592
    s_add_u32 s61, s28, 0xd4000
    buffer_load_dwordx4 v6, s[12:15], s61 offen nt lds
    s_add_u32 m0, s32, 114688
    s_add_u32 s61, s28, 0xe0000
    buffer_load_dwordx4 v6, s[12:15], s61 offen nt lds
    s_add_u32 m0, s32, 118784
    s_add_u32 s61, s28, 0xe4000
    buffer_load_dwordx4 v6, s[12:15], s61 offen nt lds
    s_add_u32 m0, s32, 122880
    s_add_u32 s61, s28, 0xf0000
    buffer_load_dwordx4 v6, s[12:15], s61 offen nt lds
    s_add_u32 m0, s32, 126976
    s_add_u32 s61, s28, 0xf4000
    buffer_load_dwordx4 v6, s[12:15], s61 offen nt lds
    s_add_u32 m0, s32, 131072
    s_add_u32 s61, s28, 0x100000
    buffer_load_dwordx4 v6, s[12:15], s61 offen nt lds
    s_add_u32 m0, s32, 135168
    s_add_u32 s61, s28, 0x104000
    buffer_load_dwordx4 v6, s[12:15], s61 offen nt lds
    s_add_u32 m0, s32, 139264
    s_add_u32 s61, s28, 0x110000
    buffer_load_dwordx4 v6, s[12:15], s61 offen nt lds
    s_add_u32 m0, s32, 143360
    s_add_u32 s61, s28, 0x114000
    buffer_load_dwordx4 v6, s[12:15], s61 offen nt lds
    s_add_u32 m0, s32, 147456
    s_add_u32 s61, s28, 0x120000
    buffer_load_dwordx4 v6, s[12:15], s61 offen nt lds
    s_add_u32 m0, s32, 151552
    s_add_u32 s61, s28, 0x124000
    buffer_load_dwordx4 v6, s[12:15], s61 offen nt lds
    s_add_u32 m0, s32, 155648
    s_add_u32 s61, s28, 0x130000
    buffer_load_dwordx4 v6, s[12:15], s61 offen nt lds
    s_add_u32 m0, s32, 159744
    s_add_u32 s61, s28, 0x134000
    buffer_load_dwordx4 v6, s[12:15], s61 offen nt lds
    s_andn2_b32 s60, 8, s57
    s_lshl_b32 s60, s60, 2
    v_bfe_u32 v24, v0, 2, 3
    v_lshrrev_b32 v25, 6, v0
    v_lshlrev_b32 v25, 1, v25
    v_xor_b32 v24, v24, v25
    v_lshlrev_b32 v8, 5, v24
    v_bfe_u32 v24, v0, 0, 2
    v_lshl_add_u32 v8, v24, 3, v8
    v_bfe_u32 v24, v0, 2, 2
    v_lshl_add_u32 v8, v24, 8, v8
    v_bfe_u32 v24, v0, 4, 2
    v_lshl_add_u32 v8, v24, 11, v8
    v_xor_b32 v8, s60, v8
    v_xor_b32 v9, 32, v8
    s_waitcnt vmcnt(32)
    s_barrier
    s_cmp_lg_u32 s58, 0
    s_cbranch_scc1 L_si_44
    s_lshl_b32 s60, s56, 2
    s_add_u32 s60, s60, 192
    s_mov_b32 s61, 1
    s_atomic_add s61, s[98:99], s60
L_si_44:
    ds_read_b64_tr_b16 a[0:1], v8 offset:0
    ds_read_b64_tr_b16 a[2:3], v8 offset:1024
    ds_read_b64_tr_b16 a[4:5], v9 offset:0
    ds_read_b64_tr_b16 a[6:7], v9 offset:1024
    ds_read_b64_tr_b16 a[8:9], v8 offset:8192
    ds_read_b64_tr_b16 a[10:11], v8 offset:9216
    ds_read_b64_tr_b16 a[12:13], v9 offset:8192
    ds_read_b64_tr_b16 a[14:15], v9 offset:9216
    s_waitcnt lgkmcnt(0)
    ds_read_b64_tr_b16 a[16:17], v8 offset:16384
    ds_read_b64_tr_b16 a[18:19], v8 offset:17408
    ds_read_b64_tr_b16 a[20:21], v9 offset:16384
    ds_read_b64_tr_b16 a[22:23], v9 offset:17408
    ds_read_b64_tr_b16 a[24:25], v8 offset:24576
    ds_read_b64_tr_b16 a[26:27], v8 offset:25600
    ds_read_b64_tr_b16 a[28:29], v9 offset:24576
    ds_read_b64_tr_b16 a[30:31], v9 offset:25600
    s_waitcnt lgkmcnt(0)
    s_waitcnt vmcnt(24)
    s_barrier
    s_add_u32 m0, s32, 0
    s_add_u32 s61, s28, 0x140000
    buffer_load_dwordx4 v6, s[12:15], s61 offen nt lds
    s_add_u32 m0, s32, 4096
    s_add_u32 s61, s28, 0x144000
    buffer_load_dwordx4 v6, s[12:15], s61 offen nt lds
    s_add_u32 m0, s32, 8192
    s_add_u32 s61, s28, 0x150000
    buffer_load_dwordx4 v6, s[12:15], s61 offen nt lds
    s_add_u32 m0, s32, 12288
    s_add_u32 s61, s28, 0x154000
    buffer_load_dwordx4 v6, s[12:15], s61 offen nt lds
    s_add_u32 m0, s32, 16384
    s_add_u32 s61, s28, 0x160000
    buffer_load_dwordx4 v6, s[12:15], s61 offen nt lds
    s_add_u32 m0, s32, 20480
    s_add_u32 s61, s28, 0x164000
    buffer_load_dwordx4 v6, s[12:15], s61 offen nt lds
    s_add_u32 m0, s32, 24576
    s_add_u32 s61, s28, 0x170000
    buffer_load_dwordx4 v6, s[12:15], s61 offen nt lds
    s_add_u32 m0, s32, 28672
    s_add_u32 s61, s28, 0x174000
    buffer_load_dwordx4 v6, s[12:15], s61 offen nt lds
    ds_read_b64_tr_b16 a[32:33], v8 offset:32768
    ds_read_b64_tr_b16 a[34:35], v8 offset:33792
    ds_read_b64_tr_b16 a[36:37], v9 offset:32768
    ds_read_b64_tr_b16 a[38:39], v9 offset:33792
    ds_read_b64_tr_b16 a[40:41], v8 offset:40960
    ds_read_b64_tr_b16 a[42:43], v8 offset:41984
    ds_read_b64_tr_b16 a[44:45], v9 offset:40960
    ds_read_b64_tr_b16 a[46:47], v9 offset:41984
    s_waitcnt lgkmcnt(0)
    ds_read_b64_tr_b16 a[48:49], v8 offset:49152
    ds_read_b64_tr_b16 a[50:51], v8 offset:50176
    ds_read_b64_tr_b16 a[52:53], v9 offset:49152
    ds_read_b64_tr_b16 a[54:55], v9 offset:50176
    ds_read_b64_tr_b16 a[56:57], v8 offset:57344
    ds_read_b64_tr_b16 a[58:59], v8 offset:58368
    ds_read_b64_tr_b16 a[60:61], v9 offset:57344
    ds_read_b64_tr_b16 a[62:63], v9 offset:58368
    s_waitcnt lgkmcnt(0)
    s_waitcnt vmcnt(24)
    s_barrier
    s_add_u32 m0, s32, 32768
    s_add_u32 s61, s28, 0x180000
    buffer_load_dwordx4 v6, s[12:15], s61 offen nt lds
    s_add_u32 m0, s32, 36864
    s_add_u32 s61, s28, 0x184000
    buffer_load_dwordx4 v6, s[12:15], s61 offen nt lds
    s_add_u32 m0, s32, 40960
    s_add_u32 s61, s28, 0x190000
    buffer_load_dwordx4 v6, s[12:15], s61 offen nt lds
    s_add_u32 m0, s32, 45056
    s_add_u32 s61, s28, 0x194000
    buffer_load_dwordx4 v6, s[12:15], s61 offen nt lds
    s_add_u32 m0, s32, 49152
    s_add_u32 s61, s28, 0x1a0000
    buffer_load_dwordx4 v6, s[12:15], s61 offen nt lds
    s_add_u32 m0, s32, 53248
    s_add_u32 s61, s28, 0x1a4000
    buffer_load_dwordx4 v6, s[12:15], s61 offen nt lds
    s_add_u32 m0, s32, 57344
    s_add_u32 s61, s28, 0x1b0000
    buffer_load_dwordx4 v6, s[12:15], s61 offen nt lds
    s_add_u32 m0, s32, 61440
    s_add_u32 s61, s28, 0x1b4000
    buffer_load_dwordx4 v6, s[12:15], s61 offen nt lds
    v_add_u32 v8, 0x10000, v8
    v_add_u32 v9, 0x10000, v9
    ds_read_b64_tr_b16 a[64:65], v8 offset:0
    ds_read_b64_tr_b16 a[66:67], v8 offset:1024
    ds_read_b64_tr_b16 a[68:69], v9 offset:0
    ds_read_b64_tr_b16 a[70:71], v9 offset:1024
    ds_read_b64_tr_b16 a[72:73], v8 offset:8192
    ds_read_b64_tr_b16 a[74:75], v8 offset:9216
    ds_read_b64_tr_b16 a[76:77], v9 offset:8192
    ds_read_b64_tr_b16 a[78:79], v9 offset:9216
    s_waitcnt lgkmcnt(0)
    ds_read_b64_tr_b16 a[80:81], v8 offset:16384
    ds_read_b64_tr_b16 a[82:83], v8 offset:17408
    ds_read_b64_tr_b16 a[84:85], v9 offset:16384
    ds_read_b64_tr_b16 a[86:87], v9 offset:17408
    ds_read_b64_tr_b16 a[88:89], v8 offset:24576
    ds_read_b64_tr_b16 a[90:91], v8 offset:25600
    ds_read_b64_tr_b16 a[92:93], v9 offset:24576
    ds_read_b64_tr_b16 a[94:95], v9 offset:25600
    s_waitcnt lgkmcnt(0)
    s_waitcnt vmcnt(24)
    s_barrier
    s_add_u32 m0, s32, 65536
    s_add_u32 s61, s28, 0x1c0000
    buffer_load_dwordx4 v6, s[12:15], s61 offen nt lds
    s_add_u32 m0, s32, 69632
    s_add_u32 s61, s28, 0x1c4000
    buffer_load_dwordx4 v6, s[12:15], s61 offen nt lds
    s_add_u32 m0, s32, 73728
    s_add_u32 s61, s28, 0x1d0000
    buffer_load_dwordx4 v6, s[12:15], s61 offen nt lds
    s_add_u32 m0, s32, 77824
    s_add_u32 s61, s28, 0x1d4000
    buffer_load_dwordx4 v6, s[12:15], s61 offen nt lds
    s_add_u32 m0, s32, 81920
    s_add_u32 s61, s28, 0x1e0000
    buffer_load_dwordx4 v6, s[12:15], s61 offen nt lds
    s_add_u32 m0, s32, 86016
    s_add_u32 s61, s28, 0x1e4000
    buffer_load_dwordx4 v6, s[12:15], s61 offen nt lds
    s_add_u32 m0, s32, 90112
    s_add_u32 s61, s28, 0x1f0000
    buffer_load_dwordx4 v6, s[12:15], s61 offen nt lds
    s_add_u32 m0, s32, 94208
    s_add_u32 s61, s28, 0x1f4000
    buffer_load_dwordx4 v6, s[12:15], s61 offen nt lds
    ds_read_b64_tr_b16 a[96:97], v8 offset:32768
    ds_read_b64_tr_b16 a[98:99], v8 offset:33792
    ds_read_b64_tr_b16 a[100:101], v9 offset:32768
    ds_read_b64_tr_b16 a[102:103], v9 offset:33792
    ds_read_b64_tr_b16 a[104:105], v8 offset:40960
    ds_read_b64_tr_b16 a[106:107], v8 offset:41984
    ds_read_b64_tr_b16 a[108:109], v9 offset:40960
    ds_read_b64_tr_b16 a[110:111], v9 offset:41984
    s_waitcnt lgkmcnt(0)
    ds_read_b64_tr_b16 a[112:113], v8 offset:49152
    ds_read_b64_tr_b16 a[114:115], v8 offset:50176
    ds_read_b64_tr_b16 a[116:117], v9 offset:49152
    ds_read_b64_tr_b16 a[118:119], v9 offset:50176
    ds_read_b64_tr_b16 a[120:121], v8 offset:57344
    ds_read_b64_tr_b16 a[122:123], v8 offset:58368
    ds_read_b64_tr_b16 a[124:125], v9 offset:57344
    ds_read_b64_tr_b16 a[126:127], v9 offset:58368
    s_waitcnt lgkmcnt(0)
    s_waitcnt vmcnt(24)
    s_barrier
    v_add_u32 v8, 0x10000, v8
    v_add_u32 v9, 0x10000, v9
    ds_read_b64_tr_b16 a[128:129], v8 offset:0
    ds_read_b64_tr_b16 a[130:131], v8 offset:1024
    ds_read_b64_tr_b16 a[132:133], v9 offset:0
    ds_read_b64_tr_b16 a[134:135], v9 offset:1024
    ds_read_b64_tr_b16 a[136:137], v8 offset:8192
    ds_read_b64_tr_b16 a[138:139], v8 offset:9216
    ds_read_b64_tr_b16 a[140:141], v9 offset:8192
    ds_read_b64_tr_b16 a[142:143], v9 offset:9216
    s_waitcnt lgkmcnt(0)
    ds_read_b64_tr_b16 a[144:145], v8 offset:16384
    ds_read_b64_tr_b16 a[146:147], v8 offset:17408
    ds_read_b64_tr_b16 a[148:149], v9 offset:16384
    ds_read_b64_tr_b16 a[150:151], v9 offset:17408
    ds_read_b64_tr_b16 a[152:153], v8 offset:24576
    ds_read_b64_tr_b16 a[154:155], v8 offset:25600
    ds_read_b64_tr_b16 a[156:157], v9 offset:24576
    ds_read_b64_tr_b16 a[158:159], v9 offset:25600
    s_waitcnt lgkmcnt(0)
    s_waitcnt vmcnt(16)
    s_barrier
    v_add_u32 v8, 0xfffe0000, v8
    v_add_u32 v9, 0xfffe0000, v9
    ds_read_b64_tr_b16 a[160:161], v8 offset:0
    ds_read_b64_tr_b16 a[162:163], v8 offset:1024
    ds_read_b64_tr_b16 a[164:165], v9 offset:0
    ds_read_b64_tr_b16 a[166:167], v9 offset:1024
    ds_read_b64_tr_b16 a[168:169], v8 offset:8192
    ds_read_b64_tr_b16 a[170:171], v8 offset:9216
    ds_read_b64_tr_b16 a[172:173], v9 offset:8192
    ds_read_b64_tr_b16 a[174:175], v9 offset:9216
    s_waitcnt lgkmcnt(0)
    ds_read_b64_tr_b16 a[176:177], v8 offset:16384
    ds_read_b64_tr_b16 a[178:179], v8 offset:17408
    ds_read_b64_tr_b16 a[180:181], v9 offset:16384
    ds_read_b64_tr_b16 a[182:183], v9 offset:17408
    ds_read_b64_tr_b16 a[184:185], v8 offset:24576
    ds_read_b64_tr_b16 a[186:187], v8 offset:25600
    ds_read_b64_tr_b16 a[188:189], v9 offset:24576
    ds_read_b64_tr_b16 a[190:191], v9 offset:25600
    s_waitcnt lgkmcnt(0)
    s_waitcnt vmcnt(8)
    s_barrier
    ds_read_b64_tr_b16 a[192:193], v8 offset:32768
    ds_read_b64_tr_b16 a[194:195], v8 offset:33792
    ds_read_b64_tr_b16 a[196:197], v9 offset:32768
    ds_read_b64_tr_b16 a[198:199], v9 offset:33792
    ds_read_b64_tr_b16 a[200:201], v8 offset:40960
    ds_read_b64_tr_b16 a[202:203], v8 offset:41984
    ds_read_b64_tr_b16 a[204:205], v9 offset:40960
    ds_read_b64_tr_b16 a[206:207], v9 offset:41984
    s_waitcnt lgkmcnt(0)
    ds_read_b64_tr_b16 a[208:209], v8 offset:49152
    ds_read_b64_tr_b16 a[210:211], v8 offset:50176
    ds_read_b64_tr_b16 a[212:213], v9 offset:49152
    ds_read_b64_tr_b16 a[214:215], v9 offset:50176
    ds_read_b64_tr_b16 a[216:217], v8 offset:57344
    ds_read_b64_tr_b16 a[218:219], v8 offset:58368
    ds_read_b64_tr_b16 a[220:221], v9 offset:57344
    ds_read_b64_tr_b16 a[222:223], v9 offset:58368
    s_waitcnt lgkmcnt(0)
    s_waitcnt vmcnt(0)
    s_barrier
    v_add_u32 v8, 0x10000, v8
    v_add_u32 v9, 0x10000, v9
    ds_read_b64_tr_b16 a[224:225], v8 offset:0
    ds_read_b64_tr_b16 a[226:227], v8 offset:1024
    ds_read_b64_tr_b16 a[228:229], v9 offset:0
    ds_read_b64_tr_b16 a[230:231], v9 offset:1024
    ds_read_b64_tr_b16 a[232:233], v8 offset:8192
    ds_read_b64_tr_b16 a[234:235], v8 offset:9216
    ds_read_b64_tr_b16 a[236:237], v9 offset:8192
    ds_read_b64_tr_b16 a[238:239], v9 offset:9216
    s_waitcnt lgkmcnt(0)
    ds_read_b64_tr_b16 a[240:241], v8 offset:16384
    ds_read_b64_tr_b16 a[242:243], v8 offset:17408
    ds_read_b64_tr_b16 a[244:245], v9 offset:16384
    ds_read_b64_tr_b16 a[246:247], v9 offset:17408
    ds_read_b64_tr_b16 a[248:249], v8 offset:24576
    ds_read_b64_tr_b16 a[250:251], v8 offset:25600
    ds_read_b64_tr_b16 a[252:253], v9 offset:24576
    ds_read_b64_tr_b16 a[254:255], v9 offset:25600
    s_waitcnt lgkmcnt(0)
    s_cmp_lg_u32 s58, 0
    s_cbranch_scc1 L_si_45
    s_lshl_b32 s60, s56, 2
    s_add_u32 s60, s60, 192
    s_mov_b32 s62, 0
L_sw_46:
    s_load_dword s63, s[98:99], s60 glc
    s_add_u32 s62, s62, 1
    s_cmp_gt_u32 s62, 0x200000
    s_cbranch_scc1 chain_kernel_wabort
    s_waitcnt lgkmcnt(0)
    s_cmp_ge_u32 s63, 32
    s_cbranch_scc1 L_swok_47
    s_sleep 16
    s_branch L_sw_46
L_swok_47:
L_si_45:
    s_barrier
    s_cmp_eq_u32 s39, 0
    s_cbranch_scc1 seg_t0
    s_lshl_b32 s20, s58, 13
    s_mov_b32 s21, 0
    s_lshr_b32 s60, s57, 4
    s_lshl_b32 s60, s60, 12
    v_add_u32 v5, s60, v1
    v_xor_b32 v4, 4096, v5
    s_sub_u32 s60, s39, 1
    s_mul_i32 s60, s60, 3
    s_add_u32 s35, s33, s60
    s_add_u32 s34, s33, 9
    s_lshl_b32 s25, s33, 18
    s_sub_u32 s25, s25, 0x180000
    s_mov_b32 s18, 0
    v_mov_b32 v18, s26
    v_writelane_b32 v18, s34, 32
    v_writelane_b32 v18, s40, 33
L_sp_48:
    global_load_dword v19, v[16:17], off sc1
    s_add_u32 s30, s30, 1
    s_cmp_gt_u32 s30, 0x200000
    s_cbranch_scc1 chain_kernel_wabort
    s_waitcnt vmcnt(0)
    v_cmp_lt_u32 vcc, v19, v18
    s_cbranch_vccz L_spok_49
    s_sleep 4
    s_branch L_sp_48
L_spok_49:
    s_lshl_b32 s61, s33, 13
    s_and_b32 s61, s61, 0x2000
    s_xor_b32 s61, s61, s31
    s_lshl_b32 s23, s33, 21
    s_add_u32 s23, s23, s61
    s_cmp_gt_u32 s33, s35
    s_cselect_b32 s23, 0xc000000, s23
    s_add_u32 m0, s20, 0
    s_nop 0
    buffer_load_dwordx4 v1, s[8:11], s23 offen offset:0 lds
    buffer_load_dwordx4 v1, s[8:11], s23 offen offset:1024 lds
    buffer_load_dwordx4 v1, s[8:11], s23 offen offset:2048 lds
    buffer_load_dwordx4 v1, s[8:11], s23 offen offset:3072 lds
    s_add_u32 m0, s20, 4096
    s_nop 0
    buffer_load_dwordx4 v2, s[8:11], s23 offen offset:0 lds
    buffer_load_dwordx4 v2, s[8:11], s23 offen offset:1024 lds
    buffer_load_dwordx4 v2, s[8:11], s23 offen offset:2048 lds
    buffer_load_dwordx4 v2, s[8:11], s23 offen offset:3072 lds
    s_add_u32 s20, s20, 32768
    s_cmp_ge_u32 s20, 163840
    s_cselect_b32 s60, 163840, 0
    s_sub_u32 s20, s20, s60
    s_add_u32 s23, s23, 0x40000
    s_add_u32 m0, s20, 0
    s_nop 0
    buffer_load_dwordx4 v1, s[8:11], s23 offen offset:0 lds
    buffer_load_dwordx4 v1, s[8:11], s23 offen offset:1024 lds
    buffer_load_dwordx4 v1, s[8:11], s23 offen offset:2048 lds
    buffer_load_dwordx4 v1, s[8:11], s23 offen offset:3072 lds
    s_add_u32 m0, s20, 4096
    s_nop 0
    buffer_load_dwordx4 v2, s[8:11], s23 offen offset:0 lds
    buffer_load_dwordx4 v2, s[8:11], s23 offen offset:1024 lds
    buffer_load_dwordx4 v2, s[8:11], s23 offen offset:2048 lds
    buffer_load_dwordx4 v2, s[8:11], s23 offen offset:3072 lds
    s_add_u32 s20, s20, 32768
    s_cmp_ge_u32 s20, 163840
    s_cselect_b32 s60, 163840, 0
    s_sub_u32 s20, s20, s60
    s_add_u32 s33, s33, 3
    s_lshl_b32 s61, s33, 13
    s_and_b32 s61, s61, 0x2000
    s_xor_b32 s61, s61, s31
    s_lshl_b32 s23, s33, 21
    s_add_u32 s23, s23, s61
    s_cmp_gt_u32 s33, s35
    s_cselect_b32 s23, 0xc000000, s23
    s_add_u32 m0, s20, 0
    s_nop 0
    buffer_load_dwordx4 v1, s[8:11], s23 offen offset:0 lds
    buffer_load_dwordx4 v1, s[8:11], s23 offen offset:1024 lds
    buffer_load_dwordx4 v1, s[8:11], s23 offen offset:2048 lds
    buffer_load_dwordx4 v1, s[8:11], s23 offen offset:3072 lds
    s_add_u32 m0, s20, 4096
    s_nop 0
    buffer_load_dwordx4 v2, s[8:11], s23 offen offset:0 lds
    buffer_load_dwordx4 v2, s[8:11], s23 offen offset:1024 lds
    buffer_load_dwordx4 v2, s[8:11], s23 offen offset:2048 lds
    buffer_load_dwordx4 v2, s[8:11], s23 offen offset:3072 lds
    s_add_u32 s20, s20, 32768
    s_cmp_ge_u32 s20, 163840
    s_cselect_b32 s60, 163840, 0
    s_sub_u32 s20, s20, s60
    s_add_u32 s23, s23, 0x40000
    s_mov_b32 s37, 0xc000000
    s_waitcnt vmcnt(8)
    s_barrier
    ds_read_b128 v[72:75], v4 offset:0
    ds_read_b128 v[76:79], v5 offset:0
    ds_read_b128 v[80:83], v4 offset:1024
    ds_read_b128 v[84:87], v5 offset:1024
    ds_read_b128 v[88:91], v4 offset:2048
    ds_read_b128 v[92:95], v5 offset:2048
seg_p:
    s_waitcnt lgkmcnt(4)
    v_mfma_f32_16x16x32_bf16 v[32:35], a[0:3], v[72:75], 0
    ds_read_b128 v[96:99], v4 offset:3072
    s_waitcnt vmcnt(0)
    v_mfma_f32_16x16x32_bf16 v[36:39], a[4:7], v[72:75], 0
    ds_read_b128 v[100:103], v5 offset:3072
    v_pk_add_f32 v[104:105], v[104:105], v[64:65]
    v_mfma_f32_16x16x32_bf16 v[44:47], a[4:7], v[76:79], 0
    v_pk_add_f32 v[106:107], v[106:107], v[66:67]
    s_xor_b32 s24, s24, 0x80000
    v_mfma_f32_16x16x32_bf16 v[40:43], a[0:3], v[76:79], 0
    buffer_store_dwordx4 v[48:51], v20, s[8:11], s24 offen
    s_waitcnt lgkmcnt(4)
    v_mfma_f32_16x16x32_bf16 v[32:35], a[8:11], v[80:83], v[32:35]
    ds_read_b128 v[72:75], v4 offset:8192
    v_mfma_f32_16x16x32_bf16 v[36:39], a[12:15], v[80:83], v[36:39]
    ds_read_b128 v[76:79], v5 offset:8192
    buffer_store_dwordx4 v[52:55], v21, s[8:11], s24 offen
    v_mfma_f32_16x16x32_bf16 v[44:47], a[12:15], v[84:87], v[44:47]
    v_mfma_f32_16x16x32_bf16 v[40:43], a[8:11], v[84:87], v[40:43]
    buffer_store_dwordx4 v[56:59], v22, s[8:11], s24 offen
    s_waitcnt lgkmcnt(4)
    v_mfma_f32_16x16x32_bf16 v[32:35], a[16:19], v[88:91], v[32:35]
    ds_read_b128 v[80:83], v4 offset:9216
    buffer_load_dword v13, v10, s[8:11], s37 offen
    v_mfma_f32_16x16x32_bf16 v[36:39], a[20:23], v[88:91], v[36:39]
    ds_read_b128 v[84:87], v5 offset:9216
    v_mov_b32 v64, v60
    v_mfma_f32_16x16x32_bf16 v[44:47], a[20:23], v[92:95], v[44:47]
    v_mov_b32 v65, v61
    v_mov_b32 v66, v62
    v_mfma_f32_16x16x32_bf16 v[40:43], a[16:19], v[92:95], v[40:43]
    v_mov_b32 v67, v63
    s_waitcnt lgkmcnt(4)
    v_mfma_f32_16x16x32_bf16 v[32:35], a[24:27], v[96:99], v[32:35]
    ds_read_b128 v[88:91], v4 offset:10240
    v_pk_add_f32 v[108:109], v[108:109], v[112:113]
    v_mfma_f32_16x16x32_bf16 v[36:39], a[28:31], v[96:99], v[36:39]
    ds_read_b128 v[92:95], v5 offset:10240
    v_pk_add_f32 v[110:111], v[110:111], v[114:115]
    v_mfma_f32_16x16x32_bf16 v[44:47], a[28:31], v[100:103], v[44:47]
    v_pk_add_f32 v[104:105], v[104:105], v[108:109]
    v_pk_add_f32 v[106:107], v[106:107], v[110:111]
    v_mfma_f32_16x16x32_bf16 v[40:43], a[24:27], v[100:103], v[40:43]
    v_cvt_pk_bf16_f32 v104, 0, v104
    s_waitcnt lgkmcnt(4)
    v_mfma_f32_16x16x32_bf16 v[32:35], a[32:35], v[72:75], v[32:35]
    ds_read_b128 v[96:99], v4 offset:11264
    v_cvt_pk_bf16_f32 v105, 0, v105
    v_mfma_f32_16x16x32_bf16 v[36:39], a[36:39], v[72:75], v[36:39]
    ds_read_b128 v[100:103], v5 offset:11264
    v_cvt_pk_bf16_f32 v106, 0, v106
    v_mfma_f32_16x16x32_bf16 v[44:47], a[36:39], v[76:79], v[44:47]
    v_cvt_pk_bf16_f32 v107, 0, v107
    buffer_store_dwordx4 v[104:107], v15, s[16:19], s25 offen
    v_mfma_f32_16x16x32_bf16 v[40:43], a[32:35], v[76:79], v[40:43]
    s_waitcnt lgkmcnt(4)
    v_mfma_f32_16x16x32_bf16 v[32:35], a[40:43], v[80:83], v[32:35]
    ds_read_b128 v[72:75], v4 offset:16384
    v_mfma_f32_16x16x32_bf16 v[36:39], a[44:47], v[80:83], v[36:39]
    ds_read_b128 v[76:79], v5 offset:16384
    v_mfma_f32_16x16x32_bf16 v[44:47], a[44:47], v[84:87], v[44:47]
    v_mfma_f32_16x16x32_bf16 v[40:43], a[40:43], v[84:87], v[40:43]
    s_waitcnt lgkmcnt(4)
    v_mfma_f32_16x16x32_bf16 v[32:35], a[48:51], v[88:91], v[32:35]
    ds_read_b128 v[80:83], v4 offset:17408
    s_add_u32 m0, s20, 0
    v_mfma_f32_16x16x32_bf16 v[36:39], a[52:55], v[88:91], v[36:39]
    ds_read_b128 v[84:87], v5 offset:17408
    v_mfma_f32_16x16x32_bf16 v[44:47], a[52:55], v[92:95], v[44:47]
    buffer_load_dwordx4 v1, s[8:11], s23 offen offset:0 lds
    v_mfma_f32_16x16x32_bf16 v[40:43], a[48:51], v[92:95], v[40:43]
    s_waitcnt lgkmcnt(4)
    v_mfma_f32_16x16x32_bf16 v[32:35], a[56:59], v[96:99], v[32:35]
    ds_read_b128 v[88:91], v4 offset:18432
    buffer_load_dwordx4 v1, s[8:11], s23 offen offset:1024 lds
    v_mfma_f32_16x16x32_bf16 v[36:39], a[60:63], v[96:99], v[36:39]
    ds_read_b128 v[92:95], v5 offset:18432
    v_mfma_f32_16x16x32_bf16 v[44:47], a[60:63], v[100:103], v[44:47]
    buffer_load_dwordx4 v1, s[8:11], s23 offen offset:2048 lds
    v_mfma_f32_16x16x32_bf16 v[40:43], a[56:59], v[100:103], v[40:43]
    s_waitcnt lgkmcnt(4)
    v_mfma_f32_16x16x32_bf16 v[32:35], a[64:67], v[72:75], v[32:35]
    ds_read_b128 v[96:99], v4 offset:19456
    buffer_load_dwordx4 v1, s[8:11], s23 offen offset:3072 lds
    v_mfma_f32_16x16x32_bf16 v[36:39], a[68:71], v[72:75], v[36:39]
    ds_read_b128 v[100:103], v5 offset:19456
    v_mfma_f32_16x16x32_bf16 v[44:47], a[68:71], v[76:79], v[44:47]
    s_add_u32 m0, s20, 4096
    v_mfma_f32_16x16x32_bf16 v[40:43], a[64:67], v[76:79], v[40:43]
    s_waitcnt lgkmcnt(4)
    v_mfma_f32_16x16x32_bf16 v[32:35], a[72:75], v[80:83], v[32:35]
    ds_read_b128 v[72:75], v4 offset:24576
    buffer_load_dwordx4 v2, s[8:11], s23 offen offset:0 lds
    v_mfma_f32_16x16x32_bf16 v[36:39], a[76:79], v[80:83], v[36:39]
    ds_read_b128 v[76:79], v5 offset:24576
    v_mfma_f32_16x16x32_bf16 v[44:47], a[76:79], v[84:87], v[44:47]
    buffer_load_dwordx4 v2, s[8:11], s23 offen offset:1024 lds
    v_mfma_f32_16x16x32_bf16 v[40:43], a[72:75], v[84:87], v[40:43]
    s_waitcnt lgkmcnt(4)
    v_mfma_f32_16x16x32_bf16 v[32:35], a[80:83], v[88:91], v[32:35]
    ds_read_b128 v[80:83], v4 offset:25600
    buffer_load_dwordx4 v2, s[8:11], s23 offen offset:2048 lds
    v_mfma_f32_16x16x32_bf16 v[36:39], a[84:87], v[88:91], v[36:39]
    ds_read_b128 v[84:87], v5 offset:25600
    v_mfma_f32_16x16x32_bf16 v[44:47], a[84:87], v[92:95], v[44:47]
    buffer_load_dwordx4 v2, s[8:11], s23 offen offset:3072 lds
    v_mfma_f32_16x16x32_bf16 v[40:43], a[80:83], v[92:95], v[40:43]
    s_cmp_ge_u32 s21, 131072
    s_waitcnt lgkmcnt(4)
    v_mfma_f32_16x16x32_bf16 v[32:35], a[88:91], v[96:99], v[32:35]
    ds_read_b128 v[88:91], v4 offset:26624
    s_cselect_b32 s22, 0xfffe0000, s29
    v_mfma_f32_16x16x32_bf16 v[36:39], a[92:95], v[96:99], v[36:39]
    ds_read_b128 v[92:95], v5 offset:26624
    s_add_u32 s21, s21, s22
    v_mfma_f32_16x16x32_bf16 v[44:47], a[92:95], v[100:103], v[44:47]
    v_mfma_f32_16x16x32_bf16 v[40:43], a[88:91], v[100:103], v[40:43]
    s_waitcnt lgkmcnt(4)
    v_mfma_f32_16x16x32_bf16 v[32:35], a[96:99], v[72:75], v[32:35]
    ds_read_b128 v[96:99], v4 offset:27648
    v_mfma_f32_16x16x32_bf16 v[36:39], a[100:103], v[72:75], v[36:39]
    ds_read_b128 v[100:103], v5 offset:27648
    v_mfma_f32_16x16x32_bf16 v[44:47], a[100:103], v[76:79], v[44:47]
    v_add_u32 v4, s22, v4
    v_add_u32 v5, s22, v5
    v_mfma_f32_16x16x32_bf16 v[40:43], a[96:99], v[76:79], v[40:43]
    s_waitcnt vmcnt(10)
    s_barrier
    s_waitcnt lgkmcnt(4)
    v_mfma_f32_16x16x32_bf16 v[32:35], a[104:107], v[80:83], v[32:35]
    ds_read_b128 v[72:75], v4 offset:0
    s_add_u32 s26, s26, 1
    v_mfma_f32_16x16x32_bf16 v[36:39], a[108:111], v[80:83], v[36:39]
    ds_read_b128 v[76:79], v5 offset:0
    v_mov_b32 v12, s26
    v_mfma_f32_16x16x32_bf16 v[44:47], a[108:111], v[84:87], v[44:47]
    buffer_store_dword v12, v11, s[8:11], s27 offen
    v_mfma_f32_16x16x32_bf16 v[40:43], a[104:107], v[84:87], v[40:43]
    s_add_u32 s20, s20, 32768
    s_waitcnt lgkmcnt(4)
    v_mfma_f32_16x16x32_bf16 v[32:35], a[112:115], v[88:91], v[32:35]
    ds_read_b128 v[80:83], v4 offset:1024
    s_cmp_ge_u32 s20, 163840
    v_mfma_f32_16x16x32_bf16 v[36:39], a[116:119], v[88:91], v[36:39]
    ds_read_b128 v[84:87], v5 offset:1024
    s_cselect_b32 s60, 163840, 0
    v_mfma_f32_16x16x32_bf16 v[44:47], a[116:119], v[92:95], v[44:47]
    s_sub_u32 s20, s20, s60
    s_add_u32 s33, s33, 3
    v_mfma_f32_16x16x32_bf16 v[40:43], a[112:115], v[92:95], v[40:43]
    s_lshl_b32 s61, s33, 13
    s_waitcnt lgkmcnt(4)
    v_mfma_f32_16x16x32_bf16 v[32:35], a[120:123], v[96:99], v[32:35]
    ds_read_b128 v[88:91], v4 offset:2048
    s_and_b32 s61, s61, 0x2000
    v_mfma_f32_16x16x32_bf16 v[36:39], a[124:127], v[96:99], v[36:39]
    ds_read_b128 v[92:95], v5 offset:2048
    s_xor_b32 s61, s61, s31
    v_mfma_f32_16x16x32_bf16 v[44:47], a[124:127], v[100:103], v[44:47]
    s_lshl_b32 s23, s33, 21
    s_add_u32 s23, s23, s61
    v_mfma_f32_16x16x32_bf16 v[40:43], a[120:123], v[100:103], v[40:43]
    s_cmp_gt_u32 s33, s35
    s_waitcnt lgkmcnt(4)
    v_mfma_f32_16x16x32_bf16 v[32:35], a[128:131], v[72:75], v[32:35]
    ds_read_b128 v[96:99], v4 offset:3072
    s_cselect_b32 s23, 0xc000000, s23
    v_mfma_f32_16x16x32_bf16 v[36:39], a[132:135], v[72:75], v[36:39]
    ds_read_b128 v[100:103], v5 offset:3072
    s_add_u32 s34, s34, 3
    v_mfma_f32_16x16x32_bf16 v[44:47], a[132:135], v[76:79], v[44:47]
    s_add_u32 s62, s35, 3
    s_min_u32 s34, s34, s62
    v_mfma_f32_16x16x32_bf16 v[40:43], a[128:131], v[76:79], v[40:43]
    v_mov_b32 v18, s26
    s_waitcnt lgkmcnt(4)
    v_mfma_f32_16x16x32_bf16 v[32:35], a[136:139], v[80:83], v[32:35]
    ds_read_b128 v[72:75], v4 offset:8192
    v_writelane_b32 v18, s34, 32
    v_mfma_f32_16x16x32_bf16 v[36:39], a[140:143], v[80:83], v[36:39]
    ds_read_b128 v[76:79], v5 offset:8192
    v_writelane_b32 v18, s40, 33
    v_mfma_f32_16x16x32_bf16 v[44:47], a[140:143], v[84:87], v[44:47]
    v_mfma_f32_16x16x32_bf16 v[40:43], a[136:139], v[84:87], v[40:43]
    s_waitcnt lgkmcnt(4)
    v_mfma_f32_16x16x32_bf16 v[32:35], a[144:147], v[88:91], v[32:35]
    ds_read_b128 v[80:83], v4 offset:9216
    global_load_dword v19, v[16:17], off sc1
    v_mfma_f32_16x16x32_bf16 v[36:39], a[148:151], v[88:91], v[36:39]
    ds_read_b128 v[84:87], v5 offset:9216
    v_mfma_f32_16x16x32_bf16 v[44:47], a[148:151], v[92:95], v[44:47]
    s_add_u32 m0, s20, 0
    v_mfma_f32_16x16x32_bf16 v[40:43], a[144:147], v[92:95], v[40:43]
    s_waitcnt lgkmcnt(4)
    v_mfma_f32_16x16x32_bf16 v[32:35], a[152:155], v[96:99], v[32:35]
    ds_read_b128 v[88:91], v4 offset:10240
    buffer_load_dwordx4 v1, s[8:11], s23 offen offset:0 lds
    v_mfma_f32_16x16x32_bf16 v[36:39], a[156:159], v[96:99], v[36:39]
    ds_read_b128 v[92:95], v5 offset:10240
    v_mfma_f32_16x16x32_bf16 v[44:47], a[156:159], v[100:103], v[44:47]
    buffer_load_dwordx4 v1, s[8:11], s23 offen offset:1024 lds
    v_mfma_f32_16x16x32_bf16 v[40:43], a[152:155], v[100:103], v[40:43]
    s_waitcnt lgkmcnt(4)
    v_mfma_f32_16x16x32_bf16 v[32:35], a[160:163], v[72:75], v[32:35]
    ds_read_b128 v[96:99], v4 offset:11264
    buffer_load_dwordx4 v1, s[8:11], s23 offen offset:2048 lds
    v_mfma_f32_16x16x32_bf16 v[36:39], a[164:167], v[72:75], v[36:39]
    ds_read_b128 v[100:103], v5 offset:11264
    v_mfma_f32_16x16x32_bf16 v[44:47], a[164:167], v[76:79], v[44:47]
    buffer_load_dwordx4 v1, s[8:11], s23 offen offset:3072 lds
    v_mfma_f32_16x16x32_bf16 v[40:43], a[160:163], v[76:79], v[40:43]
    s_waitcnt lgkmcnt(4)
    v_mfma_f32_16x16x32_bf16 v[32:35], a[168:171], v[80:83], v[32:35]
    ds_read_b128 v[72:75], v4 offset:16384
    s_add_u32 m0, s20, 4096
    v_mfma_f32_16x16x32_bf16 v[36:39], a[172:175], v[80:83], v[36:39]
    ds_read_b128 v[76:79], v5 offset:16384
    v_mfma_f32_16x16x32_bf16 v[44:47], a[172:175], v[84:87], v[44:47]
    buffer_load_dwordx4 v2, s[8:11], s23 offen offset:0 lds
    v_mfma_f32_16x16x32_bf16 v[40:43], a[168:171], v[84:87], v[40:43]
    s_waitcnt lgkmcnt(4)
    v_mfma_f32_16x16x32_bf16 v[32:35], a[176:179], v[88:91], v[32:35]
    ds_read_b128 v[80:83], v4 offset:17408
    buffer_load_dwordx4 v2, s[8:11], s23 offen offset:1024 lds
    v_mfma_f32_16x16x32_bf16 v[36:39], a[180:183], v[88:91], v[36:39]
    ds_read_b128 v[84:87], v5 offset:17408
    v_mfma_f32_16x16x32_bf16 v[44:47], a[180:183], v[92:95], v[44:47]
    buffer_load_dwordx4 v2, s[8:11], s23 offen offset:2048 lds
    v_mfma_f32_16x16x32_bf16 v[40:43], a[176:179], v[92:95], v[40:43]
    s_waitcnt lgkmcnt(4)
    v_mfma_f32_16x16x32_bf16 v[32:35], a[184:187], v[96:99], v[32:35]
    ds_read_b128 v[88:91], v4 offset:18432
    buffer_load_dwordx4 v2, s[8:11], s23 offen offset:3072 lds
    v_mfma_f32_16x16x32_bf16 v[36:39], a[188:191], v[96:99], v[36:39]
    ds_read_b128 v[92:95], v5 offset:18432
    s_cmp_ge_u32 s21, 131072
    v_mfma_f32_16x16x32_bf16 v[44:47], a[188:191], v[100:103], v[44:47]
    s_cselect_b32 s22, 0xfffe0000, s29
    s_add_u32 s21, s21, s22
    v_mfma_f32_16x16x32_bf16 v[40:43], a[184:187], v[100:103], v[40:43]
    s_waitcnt lgkmcnt(4)
    v_mfma_f32_16x16x32_bf16 v[32:35], a[192:195], v[72:75], v[32:35]
    ds_read_b128 v[96:99], v4 offset:19456
    v_mfma_f32_16x16x32_bf16 v[36:39], a[196:199], v[72:75], v[36:39]
    ds_read_b128 v[100:103], v5 offset:19456
    v_mfma_f32_16x16x32_bf16 v[44:47], a[196:199], v[76:79], v[44:47]
    v_mfma_f32_16x16x32_bf16 v[40:43], a[192:195], v[76:79], v[40:43]
    s_waitcnt lgkmcnt(4)
    v_mfma_f32_16x16x32_bf16 v[32:35], a[200:203], v[80:83], v[32:35]
    ds_read_b128 v[72:75], v4 offset:24576
    s_waitcnt vmcnt(8)
    v_cmp_lt_u32 vcc, v19, v18
    v_mfma_f32_16x16x32_bf16 v[36:39], a[204:207], v[80:83], v[36:39]
    ds_read_b128 v[76:79], v5 offset:24576
    v_mfma_f32_16x16x32_bf16 v[44:47], a[204:207], v[84:87], v[44:47]
    v_mfma_f32_16x16x32_bf16 v[40:43], a[200:203], v[84:87], v[40:43]
    s_cbranch_vccnz seg_pslow
seg_pok:
    s_waitcnt lgkmcnt(4)
    v_mfma_f32_16x16x32_bf16 v[32:35], a[208:211], v[88:91], v[32:35]
    ds_read_b128 v[80:83], v4 offset:25600
    buffer_load_dwordx4 v[104:107], v23, s[8:11], s24 offen offset:0 sc1
    v_mfma_f32_16x16x32_bf16 v[36:39], a[212:215], v[88:91], v[36:39]
    ds_read_b128 v[84:87], v5 offset:25600
    buffer_load_dwordx4 v[108:111], v23, s[8:11], s24 offen offset:1024 sc1
    v_mfma_f32_16x16x32_bf16 v[44:47], a[212:215], v[92:95], v[44:47]
    buffer_load_dwordx4 v[112:115], v23, s[8:11], s24 offen offset:2048 sc1
    v_mfma_f32_16x16x32_bf16 v[40:43], a[208:211], v[92:95], v[40:43]
    s_waitcnt lgkmcnt(4)
    v_mfma_f32_16x16x32_bf16 v[32:35], a[216:219], v[96:99], v[32:35]
    ds_read_b128 v[88:91], v4 offset:26624
    v_mfma_f32_16x16x32_bf16 v[36:39], a[220:223], v[96:99], v[36:39]
    ds_read_b128 v[92:95], v5 offset:26624
    v_mfma_f32_16x16x32_bf16 v[44:47], a[220:223], v[100:103], v[44:47]
    v_mfma_f32_16x16x32_bf16 v[40:43], a[216:219], v[100:103], v[40:43]
    s_waitcnt lgkmcnt(4)
    v_mfma_f32_16x16x32_bf16 v[32:35], a[224:227], v[72:75], v[32:35]
    ds_read_b128 v[96:99], v4 offset:27648
    v_mfma_f32_16x16x32_bf16 v[36:39], a[228:231], v[72:75], v[36:39]
    ds_read_b128 v[100:103], v5 offset:27648
    v_mfma_f32_16x16x32_bf16 v[44:47], a[228:231], v[76:79], v[44:47]
    v_add_u32 v4, s22, v4
    v_add_u32 v5, s22, v5
    v_mfma_f32_16x16x32_bf16 v[40:43], a[224:227], v[76:79], v[40:43]
    s_waitcnt vmcnt(29)
    s_barrier
    s_waitcnt lgkmcnt(4)
    v_mfma_f32_16x16x32_bf16 v[32:35], a[232:235], v[80:83], v[32:35]
    ds_read_b128 v[72:75], v4 offset:0
    s_add_u32 s20, s20, 32768
    s_cmp_ge_u32 s20, 163840
    v_mfma_f32_16x16x32_bf16 v[36:39], a[236:239], v[80:83], v[36:39]
    ds_read_b128 v[76:79], v5 offset:0
    s_cselect_b32 s60, 163840, 0
    s_sub_u32 s20, s20, s60
    v_mfma_f32_16x16x32_bf16 v[44:47], a[236:239], v[84:87], v[44:47]
    s_add_u32 s37, s23, 0x600000
    s_xor_b32 s37, s37, 0x2000
    v_mfma_f32_16x16x32_bf16 v[40:43], a[232:235], v[84:87], v[40:43]
    s_cmp_ge_u32 s33, s35
    s_cselect_b32 s62, 0xc000000, s38
    s_waitcnt lgkmcnt(4)
    v_mfma_f32_16x16x32_bf16 v[32:35], a[240:243], v[88:91], v[32:35]
    ds_read_b128 v[80:83], v4 offset:1024
    s_add_u32 s37, s37, s62
    s_add_u32 s23, s23, 0x40000
    v_mfma_f32_16x16x32_bf16 v[36:39], a[244:247], v[88:91], v[36:39]
    ds_read_b128 v[84:87], v5 offset:1024
    s_add_u32 s25, s25, 0xc0000
    s_cmp_ge_u32 s26, 2
    v_mfma_f32_16x16x32_bf16 v[44:47], a[244:247], v[92:95], v[44:47]
    s_cselect_b32 s18, 0x1000000, 0
    s_cmp_lt_u32 s26, s39
    v_mfma_f32_16x16x32_bf16 v[40:43], a[240:243], v[92:95], v[40:43]
    s_waitcnt lgkmcnt(4)
    v_mfma_f32_16x16x32_bf16 v[48:51], a[248:251], v[96:99], v[32:35]
    ds_read_b128 v[88:91], v4 offset:2048
    v_mfma_f32_16x16x32_bf16 v[52:55], a[252:255], v[96:99], v[36:39]
    ds_read_b128 v[92:95], v5 offset:2048
    v_mfma_f32_16x16x32_bf16 v[60:63], a[252:255], v[100:103], v[44:47]
    v_mfma_f32_16x16x32_bf16 v[56:59], a[248:251], v[100:103], v[40:43]
    s_cbranch_scc1 seg_p
    s_xor_b32 s24, s24, 0x80000
    s_waitcnt vmcnt(0)
    v_pk_add_f32 v[104:105], v[104:105], v[64:65]
    v_pk_add_f32 v[106:107], v[106:107], v[66:67]
    v_pk_add_f32 v[108:109], v[108:109], v[112:113]
    v_pk_add_f32 v[110:111], v[110:111], v[114:115]
    v_pk_add_f32 v[104:105], v[104:105], v[108:109]
    v_pk_add_f32 v[106:107], v[106:107], v[110:111]
    v_cvt_pk_bf16_f32 v104, 0, v104
    v_cvt_pk_bf16_f32 v105, 0, v105
    v_cvt_pk_bf16_f32 v106, 0, v106
    v_cvt_pk_bf16_f32 v107, 0, v107
    buffer_store_dwordx4 v[104:107], v15, s[16:19], s25 offen
    buffer_store_dwordx4 v[48:51], v20, s[8:11], s24 offen
    buffer_store_dwordx4 v[52:55], v21, s[8:11], s24 offen
    buffer_store_dwordx4 v[56:59], v22, s[8:11], s24 offen
    s_add_u32 s25, s25, 0xc0000
    s_waitcnt vmcnt(0)
    s_barrier
    s_add_u32 s26, s26, 1
    v_mov_b32 v12, s26
    buffer_store_dword v12, v11, s[8:11], s27 offen
    v_mov_b32 v18, s26
    v_writelane_b32 v18, s34, 32
    v_writelane_b32 v18, s40, 33
L_sp_50:
    global_load_dword v19, v[16:17], off sc1
    s_add_u32 s30, s30, 1
    s_cmp_gt_u32 s30, 0x200000
    s_cbranch_scc1 chain_kernel_wabort
    s_waitcnt vmcnt(0)
    v_cmp_lt_u32 vcc, v19, v18
    s_cbranch_vccz L_spok_51
    s_branch L_sp_50
L_spok_51:
    buffer_load_dwordx4 v[104:107], v23, s[8:11], s24 offen offset:0 sc1
    buffer_load_dwordx4 v[108:111], v23, s[8:11], s24 offen offset:1024 sc1
    buffer_load_dwordx4 v[112:115], v23, s[8:11], s24 offen offset:2048 sc1
    s_waitcnt vmcnt(0) lgkmcnt(0)
    v_pk_add_f32 v[104:105], v[104:105], v[60:61]
    v_pk_add_f32 v[106:107], v[106:107], v[62:63]
    v_pk_add_f32 v[108:109], v[108:109], v[112:113]
    v_pk_add_f32 v[110:111], v[110:111], v[114:115]
    v_pk_add_f32 v[104:105], v[104:105], v[108:109]
    v_pk_add_f32 v[106:107], v[106:107], v[110:111]
    v_cvt_pk_bf16_f32 v104, 0, v104
    v_cvt_pk_bf16_f32 v105, 0, v105
    v_cvt_pk_bf16_f32 v106, 0, v106
    v_cvt_pk_bf16_f32 v107, 0, v107
    buffer_store_dwordx4 v[104:107], v15, s[16:19], s25 offen
seg_t0:
    s_mov_b32 s35, 63
    s_lshr_b32 s60, s57, 3
    s_lshl_b32 s60, s60, 8
    s_add_u32 s60, s60, 0xb201000
    s_add_u32 s37, s60, s100
    s_addc_u32 s38, s101, 0
seg_t:
    s_and_b32 s33, s36, 0xff
    s_cbranch_scc0 seg_end
    s_lshr_b32 s36, s36, 8
    s_lshl_b32 s20, s58, 13
    s_mov_b32 s21, 0
    s_lshr_b32 s60, s57, 4
    s_lshl_b32 s60, s60, 12
    v_add_u32 v5, s60, v1
    v_xor_b32 v4, 4096, v5
    s_lshl_b32 s61, s33, 13
    s_and_b32 s61, s61, 0x2000
    s_xor_b32 s61, s61, s31
    s_lshl_b32 s23, s33, 21
    s_add_u32 s23, s23, s61
    s_cmp_gt_u32 s33, s35
    s_cselect_b32 s23, 0xc000000, s23
    s_xor_b32 s24, s24, 0x80000
    s_lshl_b32 s25, s33, 18
    s_add_u32 s34, s33, 3
    s_min_u32 s34, s34, 64
    v_mov_b32 v18, s26
    v_writelane_b32 v18, s34, 32
    v_writelane_b32 v18, s40, 33
L_sp_52:
    global_load_dword v19, v[16:17], off sc1
    s_add_u32 s30, s30, 1
    s_cmp_gt_u32 s30, 0x200000
    s_cbranch_scc1 chain_kernel_wabort
    s_waitcnt vmcnt(0)
    v_cmp_lt_u32 vcc, v19, v18
    s_cbranch_vccz L_spok_53
    s_sleep 2
    s_branch L_sp_52
L_spok_53:
    s_cmp_lt_u32 s33, 62
    s_cbranch_scc1 L_tf_54
    v_writelane_b32 v16, s37, 33
    v_writelane_b32 v17, s38, 33
    s_mov_b32 s40, 32
    v_mov_b32 v18, s26
    v_writelane_b32 v18, s34, 32
    v_writelane_b32 v18, s40, 33
L_sp_55:
    global_load_dword v19, v[16:17], off sc1
    s_add_u32 s30, s30, 1
    s_cmp_gt_u32 s30, 0x200000
    s_cbranch_scc1 chain_kernel_wabort
    s_waitcnt vmcnt(0)
    v_cmp_lt_u32 vcc, v19, v18
    s_cbranch_vccz L_spok_56
    s_branch L_sp_55
L_spok_56:
L_tf_54:
    s_add_u32 m0, s20, 0
    s_nop 0
    buffer_load_dwordx4 v1, s[8:11], s23 offen offset:0 lds
    buffer_load_dwordx4 v1, s[8:11], s23 offen offset:1024 lds
    buffer_load_dwordx4 v1, s[8:11], s23 offen offset:2048 lds
    buffer_load_dwordx4 v1, s[8:11], s23 offen offset:3072 lds
    s_add_u32 m0, s20, 4096
    s_nop 0
    buffer_load_dwordx4 v2, s[8:11], s23 offen offset:0 lds
    buffer_load_dwordx4 v2, s[8:11], s23 offen offset:1024 lds
    buffer_load_dwordx4 v2, s[8:11], s23 offen offset:2048 lds
    buffer_load_dwordx4 v2, s[8:11], s23 offen offset:3072 lds
    s_add_u32 s20, s20, 32768
    s_cmp_ge_u32 s20, 163840
    s_cselect_b32 s60, 163840, 0
    s_sub_u32 s20, s20, s60
    s_add_u32 s23, s23, 0x40000
    s_add_u32 m0, s20, 0
    s_nop 0
    buffer_load_dwordx4 v1, s[8:11], s23 offen offset:0 lds
    buffer_load_dwordx4 v1, s[8:11], s23 offen offset:1024 lds
    buffer_load_dwordx4 v1, s[8:11], s23 offen offset:2048 lds
    buffer_load_dwordx4 v1, s[8:11], s23 offen offset:3072 lds
    s_add_u32 m0, s20, 4096
    s_nop 0
    buffer_load_dwordx4 v2, s[8:11], s23 offen offset:0 lds
    buffer_load_dwordx4 v2, s[8:11], s23 offen offset:1024 lds
    buffer_load_dwordx4 v2, s[8:11], s23 offen offset:2048 lds
    buffer_load_dwordx4 v2, s[8:11], s23 offen offset:3072 lds
    s_waitcnt vmcnt(8)
    s_barrier
    ds_read_b128 v[72:75], v4 offset:0
    ds_read_b128 v[76:79], v5 offset:0
    ds_read_b128 v[80:83], v4 offset:1024
    ds_read_b128 v[84:87], v5 offset:1024
    ds_read_b128 v[88:91], v4 offset:2048
    ds_read_b128 v[92:95], v5 offset:2048
    s_waitcnt lgkmcnt(4)
    v_mfma_f32_16x16x32_bf16 v[32:35], a[0:3], v[72:75], 0
    ds_read_b128 v[96:99], v4 offset:3072
    v_mfma_f32_16x16x32_bf16 v[36:39], a[4:7], v[72:75], 0
    ds_read_b128 v[100:103], v5 offset:3072
    v_mfma_f32_16x16x32_bf16 v[44:47], a[4:7], v[76:79], 0
    v_mfma_f32_16x16x32_bf16 v[40:43], a[0:3], v[76:79], 0
    s_waitcnt lgkmcnt(4)
    v_mfma_f32_16x16x32_bf16 v[32:35], a[8:11], v[80:83], v[32:35]
    ds_read_b128 v[72:75], v4 offset:8192
    v_mfma_f32_16x16x32_bf16 v[36:39], a[12:15], v[80:83], v[36:39]
    ds_read_b128 v[76:79], v5 offset:8192
    v_mfma_f32_16x16x32_bf16 v[44:47], a[12:15], v[84:87], v[44:47]
    v_mfma_f32_16x16x32_bf16 v[40:43], a[8:11], v[84:87], v[40:43]
    s_waitcnt lgkmcnt(4)
    v_mfma_f32_16x16x32_bf16 v[32:35], a[16:19], v[88:91], v[32:35]
    ds_read_b128 v[80:83], v4 offset:9216
    v_mfma_f32_16x16x32_bf16 v[36:39], a[20:23], v[88:91], v[36:39]
    ds_read_b128 v[84:87], v5 offset:9216
    v_mfma_f32_16x16x32_bf16 v[44:47], a[20:23], v[92:95], v[44:47]
    v_mfma_f32_16x16x32_bf16 v[40:43], a[16:19], v[92:95], v[40:43]
    s_waitcnt lgkmcnt(4)
    v_mfma_f32_16x16x32_bf16 v[32:35], a[24:27], v[96:99], v[32:35]
    ds_read_b128 v[88:91], v4 offset:10240
    v_mfma_f32_16x16x32_bf16 v[36:39], a[28:31], v[96:99], v[36:39]
    ds_read_b128 v[92:95], v5 offset:10240
    v_mfma_f32_16x16x32_bf16 v[44:47], a[28:31], v[100:103], v[44:47]
    v_mfma_f32_16x16x32_bf16 v[40:43], a[24:27], v[100:103], v[40:43]
    s_waitcnt lgkmcnt(4)
    v_mfma_f32_16x16x32_bf16 v[32:35], a[32:35], v[72:75], v[32:35]
    ds_read_b128 v[96:99], v4 offset:11264
    v_mfma_f32_16x16x32_bf16 v[36:39], a[36:39], v[72:75], v[36:39]
    ds_read_b128 v[100:103], v5 offset:11264
    v_mfma_f32_16x16x32_bf16 v[44:47], a[36:39], v[76:79], v[44:47]
    v_mfma_f32_16x16x32_bf16 v[40:43], a[32:35], v[76:79], v[40:43]
    s_waitcnt lgkmcnt(4)
    v_mfma_f32_16x16x32_bf16 v[32:35], a[40:43], v[80:83], v[32:35]
    ds_read_b128 v[72:75], v4 offset:16384
    v_mfma_f32_16x16x32_bf16 v[36:39], a[44:47], v[80:83], v[36:39]
    ds_read_b128 v[76:79], v5 offset:16384
    v_mfma_f32_16x16x32_bf16 v[44:47], a[44:47], v[84:87], v[44:47]
    v_mfma_f32_16x16x32_bf16 v[40:43], a[40:43], v[84:87], v[40:43]
    s_waitcnt lgkmcnt(4)
    v_mfma_f32_16x16x32_bf16 v[32:35], a[48:51], v[88:91], v[32:35]
    ds_read_b128 v[80:83], v4 offset:17408
    v_mfma_f32_16x16x32_bf16 v[36:39], a[52:55], v[88:91], v[36:39]
    ds_read_b128 v[84:87], v5 offset:17408
    v_mfma_f32_16x16x32_bf16 v[44:47], a[52:55], v[92:95], v[44:47]
    v_mfma_f32_16x16x32_bf16 v[40:43], a[48:51], v[92:95], v[40:43]
    s_waitcnt lgkmcnt(4)
    v_mfma_f32_16x16x32_bf16 v[32:35], a[56:59], v[96:99], v[32:35]
    ds_read_b128 v[88:91], v4 offset:18432
    v_mfma_f32_16x16x32_bf16 v[36:39], a[60:63], v[96:99], v[36:39]
    ds_read_b128 v[92:95], v5 offset:18432
    v_mfma_f32_16x16x32_bf16 v[44:47], a[60:63], v[100:103], v[44:47]
    v_mfma_f32_16x16x32_bf16 v[40:43], a[56:59], v[100:103], v[40:43]
    s_waitcnt lgkmcnt(4)
    v_mfma_f32_16x16x32_bf16 v[32:35], a[64:67], v[72:75], v[32:35]
    ds_read_b128 v[96:99], v4 offset:19456
    v_mfma_f32_16x16x32_bf16 v[36:39], a[68:71], v[72:75], v[36:39]
    ds_read_b128 v[100:103], v5 offset:19456
    v_mfma_f32_16x16x32_bf16 v[44:47], a[68:71], v[76:79], v[44:47]
    v_mfma_f32_16x16x32_bf16 v[40:43], a[64:67], v[76:79], v[40:43]
    s_waitcnt lgkmcnt(4)
    v_mfma_f32_16x16x32_bf16 v[32:35], a[72:75], v[80:83], v[32:35]
    ds_read_b128 v[72:75], v4 offset:24576
    v_mfma_f32_16x16x32_bf16 v[36:39], a[76:79], v[80:83], v[36:39]
    ds_read_b128 v[76:79], v5 offset:24576
    v_mfma_f32_16x16x32_bf16 v[44:47], a[76:79], v[84:87], v[44:47]
    v_mfma_f32_16x16x32_bf16 v[40:43], a[72:75], v[84:87], v[40:43]
    s_waitcnt lgkmcnt(4)
    v_mfma_f32_16x16x32_bf16 v[32:35], a[80:83], v[88:91], v[32:35]
    ds_read_b128 v[80:83], v4 offset:25600
    v_mfma_f32_16x16x32_bf16 v[36:39], a[84:87], v[88:91], v[36:39]
    ds_read_b128 v[84:87], v5 offset:25600
    v_mfma_f32_16x16x32_bf16 v[44:47], a[84:87], v[92:95], v[44:47]
    v_mfma_f32_16x16x32_bf16 v[40:43], a[80:83], v[92:95], v[40:43]
    s_waitcnt lgkmcnt(4)
    v_mfma_f32_16x16x32_bf16 v[32:35], a[88:91], v[96:99], v[32:35]
    ds_read_b128 v[88:91], v4 offset:26624
    v_mfma_f32_16x16x32_bf16 v[36:39], a[92:95], v[96:99], v[36:39]
    ds_read_b128 v[92:95], v5 offset:26624
    v_mfma_f32_16x16x32_bf16 v[44:47], a[92:95], v[100:103], v[44:47]
    v_mfma_f32_16x16x32_bf16 v[40:43], a[88:91], v[100:103], v[40:43]
    s_waitcnt lgkmcnt(4)
    v_mfma_f32_16x16x32_bf16 v[32:35], a[96:99], v[72:75], v[32:35]
    ds_read_b128 v[96:99], v4 offset:27648
    v_mfma_f32_16x16x32_bf16 v[36:39], a[100:103], v[72:75], v[36:39]
    ds_read_b128 v[100:103], v5 offset:27648
    v_mfma_f32_16x16x32_bf16 v[44:47], a[100:103], v[76:79], v[44:47]
    v_mfma_f32_16x16x32_bf16 v[40:43], a[96:99], v[76:79], v[40:43]
    s_waitcnt vmcnt(0)
    s_barrier
    s_waitcnt lgkmcnt(4)
    v_mfma_f32_16x16x32_bf16 v[32:35], a[104:107], v[80:83], v[32:35]
    ds_read_b128 v[72:75], v4 offset:32768
    v_mfma_f32_16x16x32_bf16 v[36:39], a[108:111], v[80:83], v[36:39]
    ds_read_b128 v[76:79], v5 offset:32768
    v_mfma_f32_16x16x32_bf16 v[44:47], a[108:111], v[84:87], v[44:47]
    v_mfma_f32_16x16x32_bf16 v[40:43], a[104:107], v[84:87], v[40:43]
    s_waitcnt lgkmcnt(4)
    v_mfma_f32_16x16x32_bf16 v[32:35], a[112:115], v[88:91], v[32:35]
    ds_read_b128 v[80:83], v4 offset:33792
    v_mfma_f32_16x16x32_bf16 v[36:39], a[116:119], v[88:91], v[36:39]
    ds_read_b128 v[84:87], v5 offset:33792
    v_mfma_f32_16x16x32_bf16 v[44:47], a[116:119], v[92:95], v[44:47]
    v_mfma_f32_16x16x32_bf16 v[40:43], a[112:115], v[92:95], v[40:43]
    s_waitcnt lgkmcnt(4)
    v_mfma_f32_16x16x32_bf16 v[32:35], a[120:123], v[96:99], v[32:35]
    ds_read_b128 v[88:91], v4 offset:34816
    v_mfma_f32_16x16x32_bf16 v[36:39], a[124:127], v[96:99], v[36:39]
    ds_read_b128 v[92:95], v5 offset:34816
    v_mfma_f32_16x16x32_bf16 v[44:47], a[124:127], v[100:103], v[44:47]
    v_mfma_f32_16x16x32_bf16 v[40:43], a[120:123], v[100:103], v[40:43]
    s_waitcnt lgkmcnt(4)
    v_mfma_f32_16x16x32_bf16 v[32:35], a[128:131], v[72:75], v[32:35]
    ds_read_b128 v[96:99], v4 offset:35840
    v_mfma_f32_16x16x32_bf16 v[36:39], a[132:135], v[72:75], v[36:39]
    ds_read_b128 v[100:103], v5 offset:35840
    v_mfma_f32_16x16x32_bf16 v[44:47], a[132:135], v[76:79], v[44:47]
    v_mfma_f32_16x16x32_bf16 v[40:43], a[128:131], v[76:79], v[40:43]
    s_waitcnt lgkmcnt(4)
    v_mfma_f32_16x16x32_bf16 v[32:35], a[136:139], v[80:83], v[32:35]
    ds_read_b128 v[72:75], v4 offset:40960
    v_mfma_f32_16x16x32_bf16 v[36:39], a[140:143], v[80:83], v[36:39]
    ds_read_b128 v[76:79], v5 offset:40960
    v_mfma_f32_16x16x32_bf16 v[44:47], a[140:143], v[84:87], v[44:47]
    v_mfma_f32_16x16x32_bf16 v[40:43], a[136:139], v[84:87], v[40:43]
    s_waitcnt lgkmcnt(4)
    v_mfma_f32_16x16x32_bf16 v[32:35], a[144:147], v[88:91], v[32:35]
    ds_read_b128 v[80:83], v4 offset:41984
    v_mfma_f32_16x16x32_bf16 v[36:39], a[148:151], v[88:91], v[36:39]
    ds_read_b128 v[84:87], v5 offset:41984
    v_mfma_f32_16x16x32_bf16 v[44:47], a[148:151], v[92:95], v[44:47]
    v_mfma_f32_16x16x32_bf16 v[40:43], a[144:147], v[92:95], v[40:43]
    s_waitcnt lgkmcnt(4)
    v_mfma_f32_16x16x32_bf16 v[32:35], a[152:155], v[96:99], v[32:35]
    ds_read_b128 v[88:91], v4 offset:43008
    v_mfma_f32_16x16x32_bf16 v[36:39], a[156:159], v[96:99], v[36:39]
    ds_read_b128 v[92:95], v5 offset:43008
    v_mfma_f32_16x16x32_bf16 v[44:47], a[156:159], v[100:103], v[44:47]
    v_mfma_f32_16x16x32_bf16 v[40:43], a[152:155], v[100:103], v[40:43]
    s_waitcnt lgkmcnt(4)
    v_mfma_f32_16x16x32_bf16 v[32:35], a[160:163], v[72:75], v[32:35]
    ds_read_b128 v[96:99], v4 offset:44032
    v_mfma_f32_16x16x32_bf16 v[36:39], a[164:167], v[72:75], v[36:39]
    ds_read_b128 v[100:103], v5 offset:44032
    v_mfma_f32_16x16x32_bf16 v[44:47], a[164:167], v[76:79], v[44:47]
    v_mfma_f32_16x16x32_bf16 v[40:43], a[160:163], v[76:79], v[40:43]
    s_waitcnt lgkmcnt(4)
    v_mfma_f32_16x16x32_bf16 v[32:35], a[168:171], v[80:83], v[32:35]
    ds_read_b128 v[72:75], v4 offset:49152
    v_mfma_f32_16x16x32_bf16 v[36:39], a[172:175], v[80:83], v[36:39]
    ds_read_b128 v[76:79], v5 offset:49152
    v_mfma_f32_16x16x32_bf16 v[44:47], a[172:175], v[84:87], v[44:47]
    v_mfma_f32_16x16x32_bf16 v[40:43], a[168:171], v[84:87], v[40:43]
    s_waitcnt lgkmcnt(4)
    v_mfma_f32_16x16x32_bf16 v[32:35], a[176:179], v[88:91], v[32:35]
    ds_read_b128 v[80:83], v4 offset:50176
    v_mfma_f32_16x16x32_bf16 v[36:39], a[180:183], v[88:91], v[36:39]
    ds_read_b128 v[84:87], v5 offset:50176
    v_mfma_f32_16x16x32_bf16 v[44:47], a[180:183], v[92:95], v[44:47]
    v_mfma_f32_16x16x32_bf16 v[40:43], a[176:179], v[92:95], v[40:43]
    s_waitcnt lgkmcnt(4)
    v_mfma_f32_16x16x32_bf16 v[32:35], a[184:187], v[96:99], v[32:35]
    ds_read_b128 v[88:91], v4 offset:51200
    v_mfma_f32_16x16x32_bf16 v[36:39], a[188:191], v[96:99], v[36:39]
    ds_read_b128 v[92:95], v5 offset:51200
    v_mfma_f32_16x16x32_bf16 v[44:47], a[188:191], v[100:103], v[44:47]
    v_mfma_f32_16x16x32_bf16 v[40:43], a[184:187], v[100:103], v[40:43]
    s_waitcnt lgkmcnt(4)
    v_mfma_f32_16x16x32_bf16 v[32:35], a[192:195], v[72:75], v[32:35]
    ds_read_b128 v[96:99], v4 offset:52224
    v_mfma_f32_16x16x32_bf16 v[36:39], a[196:199], v[72:75], v[36:39]
    ds_read_b128 v[100:103], v5 offset:52224
    v_mfma_f32_16x16x32_bf16 v[44:47], a[196:199], v[76:79], v[44:47]
    v_mfma_f32_16x16x32_bf16 v[40:43], a[192:195], v[76:79], v[40:43]
    s_waitcnt lgkmcnt(4)
    v_mfma_f32_16x16x32_bf16 v[32:35], a[200:203], v[80:83], v[32:35]
    ds_read_b128 v[72:75], v4 offset:57344
    v_mfma_f32_16x16x32_bf16 v[36:39], a[204:207], v[80:83], v[36:39]
    ds_read_b128 v[76:79], v5 offset:57344
    v_mfma_f32_16x16x32_bf16 v[44:47], a[204:207], v[84:87], v[44:47]
    v_mfma_f32_16x16x32_bf16 v[40:43], a[200:203], v[84:87], v[40:43]
    s_waitcnt lgkmcnt(4)
    v_mfma_f32_16x16x32_bf16 v[32:35], a[208:211], v[88:91], v[32:35]
    ds_read_b128 v[80:83], v4 offset:58368
    v_mfma_f32_16x16x32_bf16 v[36:39], a[212:215], v[88:91], v[36:39]
    ds_read_b128 v[84:87], v5 offset:58368
    v_mfma_f32_16x16x32_bf16 v[44:47], a[212:215], v[92:95], v[44:47]
    v_mfma_f32_16x16x32_bf16 v[40:43], a[208:211], v[92:95], v[40:43]
    s_waitcnt lgkmcnt(4)
    v_mfma_f32_16x16x32_bf16 v[32:35], a[216:219], v[96:99], v[32:35]
    ds_read_b128 v[88:91], v4 offset:59392
    v_mfma_f32_16x16x32_bf16 v[36:39], a[220:223], v[96:99], v[36:39]
    ds_read_b128 v[92:95], v5 offset:59392
    v_mfma_f32_16x16x32_bf16 v[44:47], a[220:223], v[100:103], v[44:47]
    v_mfma_f32_16x16x32_bf16 v[40:43], a[216:219], v[100:103], v[40:43]
    s_waitcnt lgkmcnt(4)
    v_mfma_f32_16x16x32_bf16 v[32:35], a[224:227], v[72:75], v[32:35]
    ds_read_b128 v[96:99], v4 offset:60416
    v_mfma_f32_16x16x32_bf16 v[36:39], a[228:231], v[72:75], v[36:39]
    ds_read_b128 v[100:103], v5 offset:60416
    v_mfma_f32_16x16x32_bf16 v[44:47], a[228:231], v[76:79], v[44:47]
    v_mfma_f32_16x16x32_bf16 v[40:43], a[224:227], v[76:79], v[40:43]
    s_waitcnt lgkmcnt(4)
    v_mfma_f32_16x16x32_bf16 v[32:35], a[232:235], v[80:83], v[32:35]
    v_mfma_f32_16x16x32_bf16 v[36:39], a[236:239], v[80:83], v[36:39]
    v_mfma_f32_16x16x32_bf16 v[44:47], a[236:239], v[84:87], v[44:47]
    v_mfma_f32_16x16x32_bf16 v[40:43], a[232:235], v[84:87], v[40:43]
    s_waitcnt lgkmcnt(2)
    v_mfma_f32_16x16x32_bf16 v[32:35], a[240:243], v[88:91], v[32:35]
    v_mfma_f32_16x16x32_bf16 v[36:39], a[244:247], v[88:91], v[36:39]
    v_mfma_f32_16x16x32_bf16 v[44:47], a[244:247], v[92:95], v[44:47]
    v_mfma_f32_16x16x32_bf16 v[40:43], a[240:243], v[92:95], v[40:43]
    s_waitcnt lgkmcnt(0)
    v_mfma_f32_16x16x32_bf16 v[48:51], a[248:251], v[96:99], v[32:35]
    v_mfma_f32_16x16x32_bf16 v[52:55], a[252:255], v[96:99], v[36:39]
    v_mfma_f32_16x16x32_bf16 v[60:63], a[252:255], v[100:103], v[44:47]
    v_mfma_f32_16x16x32_bf16 v[56:59], a[248:251], v[100:103], v[40:43]
    s_nop 7
    buffer_store_dwordx4 v[48:51], v20, s[8:11], s24 offen
    buffer_store_dwordx4 v[52:55], v21, s[8:11], s24 offen
    buffer_store_dwordx4 v[56:59], v22, s[8:11], s24 offen
    s_waitcnt vmcnt(0)
    s_barrier
    s_add_u32 s26, s26, 1
    v_mov_b32 v12, s26
    buffer_store_dword v12, v11, s[8:11], s27 offen
    v_mov_b32 v18, s26
    v_writelane_b32 v18, s34, 32
    v_writelane_b32 v18, s40, 33
L_sp_57:
    global_load_dword v19, v[16:17], off sc1
    s_add_u32 s30, s30, 1
    s_cmp_gt_u32 s30, 0x200000
    s_cbranch_scc1 chain_kernel_wabort
    s_waitcnt vmcnt(0)
    v_cmp_lt_u32 vcc, v19, v18
    s_cbranch_vccz L_spok_58
    s_branch L_sp_57
L_spok_58:
    buffer_load_dwordx4 v[104:107], v23, s[8:11], s24 offen offset:0 sc1
    buffer_load_dwordx4 v[108:111], v23, s[8:11], s24 offen offset:1024 sc1
    buffer_load_dwordx4 v[112:115], v23, s[8:11], s24 offen offset:2048 sc1
    s_waitcnt vmcnt(0)
    v_pk_add_f32 v[104:105], v[104:105], v[60:61]
    v_pk_add_f32 v[106:107], v[106:107], v[62:63]
    v_pk_add_f32 v[108:109], v[108:109], v[112:113]
    v_pk_add_f32 v[110:111], v[110:111], v[114:115]
    v_pk_add_f32 v[104:105], v[104:105], v[108:109]
    v_pk_add_f32 v[106:107], v[106:107], v[110:111]
    v_cvt_pk_bf16_f32 v104, 0, v104
    v_cvt_pk_bf16_f32 v105, 0, v105
    v_cvt_pk_bf16_f32 v106, 0, v106
    v_cvt_pk_bf16_f32 v107, 0, v107
    buffer_store_dwordx4 v[104:107], v15, s[16:19], s25 offen
    s_branch seg_t
seg_end:
    s_endpgm
seg_pslow:
L_sp_59:
    global_load_dword v19, v[16:17], off sc1
    s_add_u32 s30, s30, 1
    s_cmp_gt_u32 s30, 0x200000
    s_cbranch_scc1 chain_kernel_wabort
    s_waitcnt vmcnt(0)
    v_cmp_lt_u32 vcc, v19, v18
    s_cbranch_vccz L_spok_60
    s_sleep 2
    s_branch L_sp_59
L_spok_60:
    s_branch seg_pok
    s_endpgm
chain_kernel_wabort:
    s_mov_b64 exec, 1
    v_mov_b32 v1, 0xdeadbeef
    v_mov_b32 v2, 120
    global_store_dword v2, v1, s[98:99]
    s_endpgm
t_g2_c:
    s_mov_b32 s43, 0
    v_bfe_u32 v16, v0, 5, 1
    v_lshlrev_b32 v23, 13, v16
    v_bfe_u32 v16, v0, 7, 1
    v_lshl_add_u32 v23, v16, 12, v23
    v_bfe_u32 v16, v0, 1, 1
    v_lshl_add_u32 v23, v16, 8, v23
    v_bfe_u32 v16, v0, 1, 1
    v_lshl_add_u32 v23, v16, 6, v23
    v_bfe_u32 v16, v0, 4, 1
    v_lshl_add_u32 v23, v16, 7, v23
    v_bfe_u32 v16, v0, 2, 2
    v_lshl_add_u32 v23, v16, 4, v23
    v_bfe_u32 v16, v0, 0, 1
    v_lshl_add_u32 v23, v16, 3, v23
    v_add_u32 v14, s49, v23
    v_xor_b32 v15, 64, v14
    ds_read_b64_tr_b16 v[72:73], v14 offset:0
    ds_read_b64_tr_b16 v[74:75], v15 offset:0
    ds_read_b128 v[44:47], v12 offset:2048
    ds_read_b128 v[40:43], v12 offset:0
    ds_read_b64_tr_b16 v[76:77], v14 offset:512
    ds_read_b64_tr_b16 v[78:79], v15 offset:512
    ds_read_b128 v[52:55], v12 offset:6144
    ds_read_b128 v[48:51], v12 offset:4096
    ds_read_b128 v[60:63], v12 offset:10240
    ds_read_b128 v[56:59], v12 offset:8192
    ds_read_b128 v[68:71], v12 offset:14336
    ds_read_b128 v[64:67], v12 offset:12288
    s_branch t_g2_as
t_g2:
    s_mov_b32 s43, 0
    v_bfe_u32 v16, v0, 5, 1
    v_lshlrev_b32 v23, 13, v16
    v_bfe_u32 v16, v0, 7, 1
    v_lshl_add_u32 v23, v16, 12, v23
    v_bfe_u32 v16, v0, 1, 1
    v_lshl_add_u32 v23, v16, 8, v23
    v_bfe_u32 v16, v0, 1, 1
    v_lshl_add_u32 v23, v16, 6, v23
    v_bfe_u32 v16, v0, 4, 1
    v_lshl_add_u32 v23, v16, 7, v23
    v_bfe_u32 v16, v0, 2, 2
    v_lshl_add_u32 v23, v16, 4, v23
    v_bfe_u32 v16, v0, 0, 1
    v_lshl_add_u32 v23, v16, 3, v23
    v_add_u32 v14, s49, v23
    v_xor_b32 v15, 64, v14
    ds_read_b64_tr_b16 v[72:73], v14 offset:0
    ds_read_b64_tr_b16 v[74:75], v15 offset:0
    ds_read_b128 v[44:47], v12 offset:2048
    ds_read_b128 v[40:43], v12 offset:0
    ds_read_b64_tr_b16 v[76:77], v14 offset:512
    ds_read_b64_tr_b16 v[78:79], v15 offset:512
    ds_read_b128 v[52:55], v12 offset:6144
    ds_read_b128 v[48:51], v12 offset:4096
    ds_read_b128 v[60:63], v12 offset:10240
    ds_read_b128 v[56:59], v12 offset:8192
    ds_read_b128 v[68:71], v12 offset:14336
    ds_read_b128 v[64:67], v12 offset:12288
    s_waitcnt lgkmcnt(8)
    v_mfma_f32_16x16x32_bf16 a[0:3], v[40:43], v[72:75], 0
    s_xor_b32 m0, s44, 0
    v_mfma_f32_16x16x32_bf16 a[32:35], v[44:47], v[72:75], 0
    buffer_load_dwordx4 v4, s[8:11], s20 offen lds
    s_waitcnt lgkmcnt(6)
    v_mfma_f32_16x16x32_bf16 a[36:39], v[44:47], v[76:79], 0
    ds_read_b64_tr_b16 v[80:81], v14 offset:1024
    s_xor_b32 m0, s44, 1024
    v_mfma_f32_16x16x32_bf16 a[4:7], v[40:43], v[76:79], 0
    buffer_load_dwordx4 v5, s[8:11], s20 offen lds
    s_waitcnt lgkmcnt(5)
    v_mfma_f32_16x16x32_bf16 a[64:67], v[48:51], v[72:75], 0
    ds_read_b64_tr_b16 v[82:83], v15 offset:1024
    s_add_u32 s20, s20, 128
    v_mfma_f32_16x16x32_bf16 a[96:99], v[52:55], v[72:75], 0
    s_xor_b32 m0, s45, 0
    v_mfma_f32_16x16x32_bf16 a[100:103], v[52:55], v[76:79], 0
    ds_read_b64_tr_b16 v[84:85], v14 offset:1536
    buffer_load_dwordx4 v6, s[12:15], s24 offen lds
    v_mfma_f32_16x16x32_bf16 a[68:71], v[48:51], v[76:79], 0
    s_xor_b32 m0, s45, 1024
    s_waitcnt lgkmcnt(5)
    v_mfma_f32_16x16x32_bf16 a[128:131], v[56:59], v[72:75], 0
    ds_read_b64_tr_b16 v[86:87], v15 offset:1536
    buffer_load_dwordx4 v7, s[12:15], s24 offen lds
    v_mfma_f32_16x16x32_bf16 a[160:163], v[60:63], v[72:75], 0
    s_add_u32 s24, s24, s28
    s_bitcmp1_b32 s43, 0
    v_mfma_f32_16x16x32_bf16 a[164:167], v[60:63], v[76:79], 0
    s_cselect_b32 s61, s5, 0
    s_lshl1_add_u32 s53, s61, s50
    v_mfma_f32_16x16x32_bf16 a[132:135], v[56:59], v[76:79], 0
    s_bitcmp1_b32 s43, 1
    s_waitcnt lgkmcnt(4)
    v_mfma_f32_16x16x32_bf16 a[192:195], v[64:67], v[72:75], 0
    s_cselect_b32 s61, s51, 0
    s_add_u32 s53, s53, s61
    v_mfma_f32_16x16x32_bf16 a[224:227], v[68:71], v[72:75], 0
    s_bitcmp1_b32 s43, 2
    s_cselect_b32 s61, s52, 0
    v_mfma_f32_16x16x32_bf16 a[228:231], v[68:71], v[76:79], 0
    s_add_u32 s53, s53, s61
    s_lshl_b32 s29, s43, 4
    v_mfma_f32_16x16x32_bf16 a[196:199], v[64:67], v[76:79], 0
    s_waitcnt lgkmcnt(2)
    v_mfma_f32_16x16x32_bf16 a[8:11], v[40:43], v[80:83], 0
    s_set_gpr_idx_on s29, gpr_idx(SRC0)
    v_mov_b32 v24, v128
    v_mov_b32 v25, v129
    v_mov_b32 v26, v130
    v_mov_b32 v27, v131
    s_set_gpr_idx_off
    v_mfma_f32_16x16x32_bf16 a[40:43], v[44:47], v[80:83], 0
    s_waitcnt lgkmcnt(0)
    v_mfma_f32_16x16x32_bf16 a[44:47], v[44:47], v[84:87], 0
    ds_read_b64_tr_b16 v[72:73], v14 offset:2048
    s_set_gpr_idx_on s29, gpr_idx(SRC0)
    v_mov_b32 v28, v132
    v_mov_b32 v29, v133
    v_mov_b32 v30, v134
    v_mov_b32 v31, v135
    s_set_gpr_idx_off
    v_mfma_f32_16x16x32_bf16 a[12:15], v[40:43], v[84:87], 0
    v_mfma_f32_16x16x32_bf16 a[72:75], v[48:51], v[80:83], 0
    ds_read_b64_tr_b16 v[74:75], v15 offset:2048
    s_set_gpr_idx_on s29, gpr_idx(SRC0)
    v_mov_b32 v32, v136
    v_mov_b32 v33, v137
    v_mov_b32 v34, v138
    v_mov_b32 v35, v139
    s_set_gpr_idx_off
    v_mfma_f32_16x16x32_bf16 a[104:107], v[52:55], v[80:83], 0
    v_mfma_f32_16x16x32_bf16 a[108:111], v[52:55], v[84:87], 0
    ds_read_b64_tr_b16 v[76:77], v14 offset:2560
    s_set_gpr_idx_on s29, gpr_idx(SRC0)
    v_mov_b32 v36, v140
    v_mov_b32 v37, v141
    v_mov_b32 v38, v142
    v_mov_b32 v39, v143
    s_set_gpr_idx_off
    v_mfma_f32_16x16x32_bf16 a[76:79], v[48:51], v[84:87], 0
    v_mfma_f32_16x16x32_bf16 a[136:139], v[56:59], v[80:83], 0
    ds_read_b64_tr_b16 v[78:79], v15 offset:2560
    buffer_store_dwordx4 v[24:27], v2, s[16:19], s53 offen sc1
    v_mfma_f32_16x16x32_bf16 a[168:171], v[60:63], v[80:83], 0
    v_mfma_f32_16x16x32_bf16 a[172:175], v[60:63], v[84:87], 0
    buffer_store_dwordx4 v[28:31], v3, s[16:19], s53 offen sc1
    v_mfma_f32_16x16x32_bf16 a[140:143], v[56:59], v[84:87], 0
    s_add_u32 s53, s53, s5
    v_mfma_f32_16x16x32_bf16 a[200:203], v[64:67], v[80:83], 0
    buffer_store_dwordx4 v[32:35], v2, s[16:19], s53 offen sc1
    v_mfma_f32_16x16x32_bf16 a[232:235], v[68:71], v[80:83], 0
    v_mfma_f32_16x16x32_bf16 a[236:239], v[68:71], v[84:87], 0
    buffer_store_dwordx4 v[36:39], v3, s[16:19], s53 offen sc1
    v_mfma_f32_16x16x32_bf16 a[204:207], v[64:67], v[84:87], 0
    s_waitcnt lgkmcnt(2)
    v_mfma_f32_16x16x32_bf16 a[16:19], v[40:43], v[72:75], 0
    v_mfma_f32_16x16x32_bf16 a[48:51], v[44:47], v[72:75], 0
    s_waitcnt lgkmcnt(0)
    v_mfma_f32_16x16x32_bf16 a[52:55], v[44:47], v[76:79], 0
    ds_read_b64_tr_b16 v[80:81], v14 offset:3072
    v_mfma_f32_16x16x32_bf16 a[20:23], v[40:43], v[76:79], 0
    v_mfma_f32_16x16x32_bf16 a[80:83], v[48:51], v[72:75], 0
    ds_read_b64_tr_b16 v[82:83], v15 offset:3072
    v_mfma_f32_16x16x32_bf16 a[112:115], v[52:55], v[72:75], 0
    v_mfma_f32_16x16x32_bf16 a[116:119], v[52:55], v[76:79], 0
    ds_read_b64_tr_b16 v[84:85], v14 offset:3584
    v_mfma_f32_16x16x32_bf16 a[84:87], v[48:51], v[76:79], 0
    v_mfma_f32_16x16x32_bf16 a[144:147], v[56:59], v[72:75], 0
    ds_read_b64_tr_b16 v[86:87], v15 offset:3584
    v_mfma_f32_16x16x32_bf16 a[176:179], v[60:63], v[72:75], 0
    v_mfma_f32_16x16x32_bf16 a[180:183], v[60:63], v[76:79], 0
    v_mfma_f32_16x16x32_bf16 a[148:151], v[56:59], v[76:79], 0
    v_mfma_f32_16x16x32_bf16 a[208:211], v[64:67], v[72:75], 0
    v_mfma_f32_16x16x32_bf16 a[240:243], v[68:71], v[72:75], 0
    v_mfma_f32_16x16x32_bf16 a[244:247], v[68:71], v[76:79], 0
    v_mfma_f32_16x16x32_bf16 a[212:215], v[64:67], v[76:79], 0
    s_waitcnt lgkmcnt(2)
    v_mfma_f32_16x16x32_bf16 a[24:27], v[40:43], v[80:83], 0
    ds_read_b64_tr_b16 v[72:73], v14 offset:16384
    v_mfma_f32_16x16x32_bf16 a[56:59], v[44:47], v[80:83], 0
    ds_read_b64_tr_b16 v[74:75], v15 offset:16384
    s_waitcnt lgkmcnt(2)
    v_mfma_f32_16x16x32_bf16 a[60:63], v[44:47], v[84:87], 0
    ds_read_b128 v[44:47], v13 offset:2048
    v_mfma_f32_16x16x32_bf16 a[28:31], v[40:43], v[84:87], 0
    ds_read_b128 v[40:43], v13 offset:0
    v_mfma_f32_16x16x32_bf16 a[88:91], v[48:51], v[80:83], 0
    ds_read_b64_tr_b16 v[76:77], v14 offset:16896
    v_mfma_f32_16x16x32_bf16 a[120:123], v[52:55], v[80:83], 0
    ds_read_b64_tr_b16 v[78:79], v15 offset:16896
    v_mfma_f32_16x16x32_bf16 a[124:127], v[52:55], v[84:87], 0
    ds_read_b128 v[52:55], v13 offset:6144
    v_mfma_f32_16x16x32_bf16 a[92:95], v[48:51], v[84:87], 0
    ds_read_b128 v[48:51], v13 offset:4096
    v_mfma_f32_16x16x32_bf16 a[152:155], v[56:59], v[80:83], 0
    s_xor_b32 m0, s44, 2048
    v_mfma_f32_16x16x32_bf16 a[184:187], v[60:63], v[80:83], 0
    buffer_load_dwordx4 v4, s[8:11], s21 offen lds
    v_mfma_f32_16x16x32_bf16 a[188:191], v[60:63], v[84:87], 0
    ds_read_b128 v[60:63], v13 offset:10240
    v_mfma_f32_16x16x32_bf16 a[156:159], v[56:59], v[84:87], 0
    ds_read_b128 v[56:59], v13 offset:8192
    v_mfma_f32_16x16x32_bf16 a[216:219], v[64:67], v[80:83], 0
    s_xor_b32 m0, s44, 3072
    v_mfma_f32_16x16x32_bf16 a[248:251], v[68:71], v[80:83], 0
    buffer_load_dwordx4 v5, s[8:11], s21 offen lds
    v_mfma_f32_16x16x32_bf16 a[252:255], v[68:71], v[84:87], 0
    ds_read_b128 v[68:71], v13 offset:14336
    s_add_u32 s21, s21, 128
    v_mfma_f32_16x16x32_bf16 a[220:223], v[64:67], v[84:87], 0
    ds_read_b128 v[64:67], v13 offset:12288
    s_branch t_g2_b
t_g2_hook:
    s_cmp_eq_u32 s43, 1
    s_cbranch_scc1 t_g2_sig0
    s_cmp_eq_u32 s43, 6
    s_cbranch_scc1 t_g2_sws
    s_cmp_eq_u32 s43, 7
    s_cbranch_scc1 t_g2_swp
    s_cmp_lg_u32 s58, 0
    s_cbranch_scc1 t_g2_a
t_g2_wait:
    s_cmp_eq_u32 s3, 0
    s_cbranch_scc1 t_g2_a
    s_mov_b32 s62, 0
L_sw_61:
    s_load_dword s63, s[98:99], s3 glc
    s_add_u32 s62, s62, 1
    s_cmp_gt_u32 s62, 0x200000
    s_cbranch_scc1 chain_kernel_wabort
    s_waitcnt lgkmcnt(0)
    s_cmp_ge_u32 s63, s2
    s_cbranch_scc1 L_swok_62
    s_sleep 16
    s_branch L_sw_61
L_swok_62:
    s_branch t_g2_a
t_g2_sig0:
    s_cmp_eq_u32 s1, 0
    s_cbranch_scc1 t_g2_as
    v_mov_b32 v24, s1
    v_mov_b32 v25, 1
    s_mov_b64 exec, 1
    global_atomic_add v24, v25, s[98:99] sc1
    s_mov_b64 exec, -1
    s_mov_b32 s1, 0
    s_branch t_g2_as
t_g2_sws:
    s_mov_b32 s12, s36
    s_mov_b32 s13, s37
    s_mov_b32 s14, s38
    s_and_b32 s45, s45, 0xffffb7ff
    s_bitcmp1_b32 s94, 1
    s_cselect_b32 s24, s41, 0
    s_cselect_b32 s26, 0, s41
    s_cselect_b32 s60, 0x4000, 0
    s_or_b32 s45, s45, s60
    s_add_u32 s24, s24, s39
    s_add_u32 s26, s26, s39
    s_bitcmp1_b32 s94, 0
    s_cselect_b32 s61, s40, 0
    s_cselect_b32 s62, 0, s40
    s_cselect_b32 s60, 0x800, 0
    s_or_b32 s45, s45, s60
    s_add_u32 s25, s24, s62
    s_add_u32 s24, s24, s61
    s_add_u32 s27, s26, s62
    s_add_u32 s26, s26, s61
    s_mov_b32 s28, s42
    v_mov_b32 v6, v10
    v_mov_b32 v7, v11
    s_branch t_g2_a
t_g2_swp:
    s_mov_b32 s8, s30
    s_mov_b32 s9, s31
    s_mov_b32 s10, s32
    s_and_b32 s44, s44, 0xffffb7ff
    s_bitcmp1_b32 s84, 1
    s_cselect_b32 s20, s35, 0
    s_cselect_b32 s22, 0, s35
    s_cselect_b32 s60, 0x4000, 0
    s_or_b32 s44, s44, s60
    s_add_u32 s20, s20, s33
    s_add_u32 s22, s22, s33
    s_bitcmp1_b32 s84, 0
    s_cselect_b32 s61, s34, 0
    s_cselect_b32 s62, 0, s34
    s_cselect_b32 s60, 0x800, 0
    s_or_b32 s44, s44, s60
    s_add_u32 s21, s20, s62
    s_add_u32 s20, s20, s61
    s_add_u32 s23, s22, s62
    s_add_u32 s22, s22, s61
    v_mov_b32 v4, v8
    v_mov_b32 v5, v9
t_g2_a:
t_g2_as:
    s_waitcnt lgkmcnt(8)
    v_mfma_f32_16x16x32_bf16 a[0:3], v[40:43], v[72:75], a[0:3]
    s_xor_b32 m0, s44, 0
    v_mfma_f32_16x16x32_bf16 a[32:35], v[44:47], v[72:75], a[32:35]
    buffer_load_dwordx4 v4, s[8:11], s20 offen lds
    s_waitcnt lgkmcnt(6)
    v_mfma_f32_16x16x32_bf16 a[36:39], v[44:47], v[76:79], a[36:39]
    ds_read_b64_tr_b16 v[80:81], v14 offset:1024
    s_xor_b32 m0, s44, 1024
    v_mfma_f32_16x16x32_bf16 a[4:7], v[40:43], v[76:79], a[4:7]
    buffer_load_dwordx4 v5, s[8:11], s20 offen lds
    s_waitcnt lgkmcnt(5)
    v_mfma_f32_16x16x32_bf16 a[64:67], v[48:51], v[72:75], a[64:67]
    ds_read_b64_tr_b16 v[82:83], v15 offset:1024
    s_add_u32 s20, s20, 128
    v_mfma_f32_16x16x32_bf16 a[96:99], v[52:55], v[72:75], a[96:99]
    s_xor_b32 m0, s45, 0
    v_mfma_f32_16x16x32_bf16 a[100:103], v[52:55], v[76:79], a[100:103]
    ds_read_b64_tr_b16 v[84:85], v14 offset:1536
    buffer_load_dwordx4 v6, s[12:15], s24 offen lds
    v_mfma_f32_16x16x32_bf16 a[68:71], v[48:51], v[76:79], a[68:71]
    s_xor_b32 m0, s45, 1024
    s_waitcnt lgkmcnt(5)
    v_mfma_f32_16x16x32_bf16 a[128:131], v[56:59], v[72:75], a[128:131]
    ds_read_b64_tr_b16 v[86:87], v15 offset:1536
    buffer_load_dwordx4 v7, s[12:15], s24 offen lds
    v_mfma_f32_16x16x32_bf16 a[160:163], v[60:63], v[72:75], a[160:163]
    s_add_u32 s24, s24, s28
    s_bitcmp1_b32 s43, 0
    v_mfma_f32_16x16x32_bf16 a[164:167], v[60:63], v[76:79], a[164:167]
    s_cselect_b32 s61, s5, 0
    s_lshl1_add_u32 s53, s61, s50
    v_mfma_f32_16x16x32_bf16 a[132:135], v[56:59], v[76:79], a[132:135]
    s_bitcmp1_b32 s43, 1
    s_waitcnt lgkmcnt(4)
    v_mfma_f32_16x16x32_bf16 a[192:195], v[64:67], v[72:75], a[192:195]
    s_cselect_b32 s61, s51, 0
    s_add_u32 s53, s53, s61
    v_mfma_f32_16x16x32_bf16 a[224:227], v[68:71], v[72:75], a[224:227]
    s_bitcmp1_b32 s43, 2
    s_cselect_b32 s61, s52, 0
    v_mfma_f32_16x16x32_bf16 a[228:231], v[68:71], v[76:79], a[228:231]
    s_add_u32 s53, s53, s61
    s_lshl_b32 s29, s43, 4
    v_mfma_f32_16x16x32_bf16 a[196:199], v[64:67], v[76:79], a[196:199]
    s_waitcnt lgkmcnt(2)
    v_mfma_f32_16x16x32_bf16 a[8:11], v[40:43], v[80:83], a[8:11]
    s_set_gpr_idx_on s29, gpr_idx(SRC0)
    v_mov_b32 v24, v128
    v_mov_b32 v25, v129
    v_mov_b32 v26, v130
    v_mov_b32 v27, v131
    s_set_gpr_idx_off
    v_mfma_f32_16x16x32_bf16 a[40:43], v[44:47], v[80:83], a[40:43]
    s_waitcnt lgkmcnt(0)
    v_mfma_f32_16x16x32_bf16 a[44:47], v[44:47], v[84:87], a[44:47]
    ds_read_b64_tr_b16 v[72:73], v14 offset:2048
    s_set_gpr_idx_on s29, gpr_idx(SRC0)
    v_mov_b32 v28, v132
    v_mov_b32 v29, v133
    v_mov_b32 v30, v134
    v_mov_b32 v31, v135
    s_set_gpr_idx_off
    v_mfma_f32_16x16x32_bf16 a[12:15], v[40:43], v[84:87], a[12:15]
    v_mfma_f32_16x16x32_bf16 a[72:75], v[48:51], v[80:83], a[72:75]
    ds_read_b64_tr_b16 v[74:75], v15 offset:2048
    s_set_gpr_idx_on s29, gpr_idx(SRC0)
    v_mov_b32 v32, v136
    v_mov_b32 v33, v137
    v_mov_b32 v34, v138
    v_mov_b32 v35, v139
    s_set_gpr_idx_off
    v_mfma_f32_16x16x32_bf16 a[104:107], v[52:55], v[80:83], a[104:107]
    v_mfma_f32_16x16x32_bf16 a[108:111], v[52:55], v[84:87], a[108:111]
    ds_read_b64_tr_b16 v[76:77], v14 offset:2560
    s_set_gpr_idx_on s29, gpr_idx(SRC0)
    v_mov_b32 v36, v140
    v_mov_b32 v37, v141
    v_mov_b32 v38, v142
    v_mov_b32 v39, v143
    s_set_gpr_idx_off
    v_mfma_f32_16x16x32_bf16 a[76:79], v[48:51], v[84:87], a[76:79]
    v_mfma_f32_16x16x32_bf16 a[136:139], v[56:59], v[80:83], a[136:139]
    ds_read_b64_tr_b16 v[78:79], v15 offset:2560
    buffer_store_dwordx4 v[24:27], v2, s[16:19], s53 offen sc1
    v_mfma_f32_16x16x32_bf16 a[168:171], v[60:63], v[80:83], a[168:171]
    v_mfma_f32_16x16x32_bf16 a[172:175], v[60:63], v[84:87], a[172:175]
    buffer_store_dwordx4 v[28:31], v3, s[16:19], s53 offen sc1
    v_mfma_f32_16x16x32_bf16 a[140:143], v[56:59], v[84:87], a[140:143]
    s_add_u32 s53, s53, s5
    v_mfma_f32_16x16x32_bf16 a[200:203], v[64:67], v[80:83], a[200:203]
    buffer_store_dwordx4 v[32:35], v2, s[16:19], s53 offen sc1
    v_mfma_f32_16x16x32_bf16 a[232:235], v[68:71], v[80:83], a[232:235]
    v_mfma_f32_16x16x32_bf16 a[236:239], v[68:71], v[84:87], a[236:239]
    buffer_store_dwordx4 v[36:39], v3, s[16:19], s53 offen sc1
    v_mfma_f32_16x16x32_bf16 a[204:207], v[64:67], v[84:87], a[204:207]
    s_waitcnt lgkmcnt(2)
    v_mfma_f32_16x16x32_bf16 a[16:19], v[40:43], v[72:75], a[16:19]
    v_mfma_f32_16x16x32_bf16 a[48:51], v[44:47], v[72:75], a[48:51]
    s_waitcnt lgkmcnt(0)
    v_mfma_f32_16x16x32_bf16 a[52:55], v[44:47], v[76:79], a[52:55]
    ds_read_b64_tr_b16 v[80:81], v14 offset:3072
    v_mfma_f32_16x16x32_bf16 a[20:23], v[40:43], v[76:79], a[20:23]
    v_mfma_f32_16x16x32_bf16 a[80:83], v[48:51], v[72:75], a[80:83]
    ds_read_b64_tr_b16 v[82:83], v15 offset:3072
    v_mfma_f32_16x16x32_bf16 a[112:115], v[52:55], v[72:75], a[112:115]
    v_mfma_f32_16x16x32_bf16 a[116:119], v[52:55], v[76:79], a[116:119]
    ds_read_b64_tr_b16 v[84:85], v14 offset:3584
    v_mfma_f32_16x16x32_bf16 a[84:87], v[48:51], v[76:79], a[84:87]
    v_mfma_f32_16x16x32_bf16 a[144:147], v[56:59], v[72:75], a[144:147]
    ds_read_b64_tr_b16 v[86:87], v15 offset:3584
    v_mfma_f32_16x16x32_bf16 a[176:179], v[60:63], v[72:75], a[176:179]
    v_mfma_f32_16x16x32_bf16 a[180:183], v[60:63], v[76:79], a[180:183]
    v_mfma_f32_16x16x32_bf16 a[148:151], v[56:59], v[76:79], a[148:151]
    v_mfma_f32_16x16x32_bf16 a[208:211], v[64:67], v[72:75], a[208:211]
    v_mfma_f32_16x16x32_bf16 a[240:243], v[68:71], v[72:75], a[240:243]
    v_mfma_f32_16x16x32_bf16 a[244:247], v[68:71], v[76:79], a[244:247]
    v_mfma_f32_16x16x32_bf16 a[212:215], v[64:67], v[76:79], a[212:215]
    s_waitcnt lgkmcnt(2)
    v_mfma_f32_16x16x32_bf16 a[24:27], v[40:43], v[80:83], a[24:27]
    ds_read_b64_tr_b16 v[72:73], v14 offset:16384
    v_mfma_f32_16x16x32_bf16 a[56:59], v[44:47], v[80:83], a[56:59]
    ds_read_b64_tr_b16 v[74:75], v15 offset:16384
    s_waitcnt lgkmcnt(2)
    v_mfma_f32_16x16x32_bf16 a[60:63], v[44:47], v[84:87], a[60:63]
    ds_read_b128 v[44:47], v13 offset:2048
    v_mfma_f32_16x16x32_bf16 a[28:31], v[40:43], v[84:87], a[28:31]
    ds_read_b128 v[40:43], v13 offset:0
    v_mfma_f32_16x16x32_bf16 a[88:91], v[48:51], v[80:83], a[88:91]
    ds_read_b64_tr_b16 v[76:77], v14 offset:16896
    v_mfma_f32_16x16x32_bf16 a[120:123], v[52:55], v[80:83], a[120:123]
    ds_read_b64_tr_b16 v[78:79], v15 offset:16896
    v_mfma_f32_16x16x32_bf16 a[124:127], v[52:55], v[84:87], a[124:127]
    ds_read_b128 v[52:55], v13 offset:6144
    v_mfma_f32_16x16x32_bf16 a[92:95], v[48:51], v[84:87], a[92:95]
    ds_read_b128 v[48:51], v13 offset:4096
    v_mfma_f32_16x16x32_bf16 a[152:155], v[56:59], v[80:83], a[152:155]
    s_xor_b32 m0, s44, 2048
    v_mfma_f32_16x16x32_bf16 a[184:187], v[60:63], v[80:83], a[184:187]
    buffer_load_dwordx4 v4, s[8:11], s21 offen lds
    v_mfma_f32_16x16x32_bf16 a[188:191], v[60:63], v[84:87], a[188:191]
    ds_read_b128 v[60:63], v13 offset:10240
    v_mfma_f32_16x16x32_bf16 a[156:159], v[56:59], v[84:87], a[156:159]
    ds_read_b128 v[56:59], v13 offset:8192
    v_mfma_f32_16x16x32_bf16 a[216:219], v[64:67], v[80:83], a[216:219]
    s_xor_b32 m0, s44, 3072
    v_mfma_f32_16x16x32_bf16 a[248:251], v[68:71], v[80:83], a[248:251]
    buffer_load_dwordx4 v5, s[8:11], s21 offen lds
    v_mfma_f32_16x16x32_bf16 a[252:255], v[68:71], v[84:87], a[252:255]
    ds_read_b128 v[68:71], v13 offset:14336
    s_add_u32 s21, s21, 128
    v_mfma_f32_16x16x32_bf16 a[220:223], v[64:67], v[84:87], a[220:223]
    ds_read_b128 v[64:67], v13 offset:12288
t_g2_b:
    s_waitcnt lgkmcnt(8)
    v_mfma_f32_16x16x32_bf16 a[0:3], v[40:43], v[72:75], a[0:3]
    v_mfma_f32_16x16x32_bf16 a[32:35], v[44:47], v[72:75], a[32:35]
    s_xor_b32 m0, s44, 16384
    s_waitcnt lgkmcnt(6)
    v_mfma_f32_16x16x32_bf16 a[36:39], v[44:47], v[76:79], a[36:39]
    ds_read_b64_tr_b16 v[80:81], v14 offset:17408
    buffer_load_dwordx4 v4, s[8:11], s22 offen lds
    v_mfma_f32_16x16x32_bf16 a[4:7], v[40:43], v[76:79], a[4:7]
    s_cmp_ge_u32 s48, 98304
    s_waitcnt lgkmcnt(5)
    v_mfma_f32_16x16x32_bf16 a[64:67], v[48:51], v[72:75], a[64:67]
    ds_read_b64_tr_b16 v[82:83], v15 offset:17408
    s_cselect_b32 s46, s6, s7
    v_mfma_f32_16x16x32_bf16 a[96:99], v[52:55], v[72:75], a[96:99]
    s_add_u32 s48, s48, s46
    s_xor_b32 m0, s44, 17408
    v_mfma_f32_16x16x32_bf16 a[100:103], v[52:55], v[76:79], a[100:103]
    ds_read_b64_tr_b16 v[84:85], v14 offset:17920
    buffer_load_dwordx4 v5, s[8:11], s22 offen lds
    v_mfma_f32_16x16x32_bf16 a[68:71], v[48:51], v[76:79], a[68:71]
    s_add_u32 s22, s22, 128
    s_waitcnt lgkmcnt(5)
    v_mfma_f32_16x16x32_bf16 a[128:131], v[56:59], v[72:75], a[128:131]
    ds_read_b64_tr_b16 v[86:87], v15 offset:17920
    s_cmp_ge_u32 s49, 98304
    v_mfma_f32_16x16x32_bf16 a[160:163], v[60:63], v[72:75], a[160:163]
    s_cselect_b32 s47, s6, s7
    s_add_u32 s49, s49, s47
    v_mfma_f32_16x16x32_bf16 a[164:167], v[60:63], v[76:79], a[164:167]
    s_xor_b32 m0, s44, 18432
    v_mfma_f32_16x16x32_bf16 a[132:135], v[56:59], v[76:79], a[132:135]
    buffer_load_dwordx4 v4, s[8:11], s23 offen lds
    s_waitcnt lgkmcnt(4)
    v_mfma_f32_16x16x32_bf16 a[192:195], v[64:67], v[72:75], a[192:195]
    v_mfma_f32_16x16x32_bf16 a[224:227], v[68:71], v[72:75], a[224:227]
    s_xor_b32 m0, s44, 19456
    v_mfma_f32_16x16x32_bf16 a[228:231], v[68:71], v[76:79], a[228:231]
    buffer_load_dwordx4 v5, s[8:11], s23 offen lds
    v_mfma_f32_16x16x32_bf16 a[196:199], v[64:67], v[76:79], a[196:199]
    s_add_u32 s23, s23, 128
    s_waitcnt lgkmcnt(2)
    v_mfma_f32_16x16x32_bf16 a[8:11], v[40:43], v[80:83], a[8:11]
    s_cmp_ge_u32 s44, 98304
    s_cselect_b32 s60, s6, s7
    v_mfma_f32_16x16x32_bf16 a[40:43], v[44:47], v[80:83], a[40:43]
    s_add_u32 s44, s44, s60
    s_waitcnt lgkmcnt(0)
    v_mfma_f32_16x16x32_bf16 a[44:47], v[44:47], v[84:87], a[44:47]
    ds_read_b64_tr_b16 v[72:73], v14 offset:18432
    v_add_u32 v12, s46, v12
    v_mfma_f32_16x16x32_bf16 a[12:15], v[40:43], v[84:87], a[12:15]
    v_add_u32 v13, s46, v13
    v_mfma_f32_16x16x32_bf16 a[72:75], v[48:51], v[80:83], a[72:75]
    ds_read_b64_tr_b16 v[74:75], v15 offset:18432
    s_xor_b32 m0, s45, 2048
    v_mfma_f32_16x16x32_bf16 a[104:107], v[52:55], v[80:83], a[104:107]
    buffer_load_dwordx4 v6, s[12:15], s25 offen lds
    v_mfma_f32_16x16x32_bf16 a[108:111], v[52:55], v[84:87], a[108:111]
    ds_read_b64_tr_b16 v[76:77], v14 offset:18944
    v_mfma_f32_16x16x32_bf16 a[76:79], v[48:51], v[84:87], a[76:79]
    v_mfma_f32_16x16x32_bf16 a[136:139], v[56:59], v[80:83], a[136:139]
    ds_read_b64_tr_b16 v[78:79], v15 offset:18944
    s_xor_b32 m0, s45, 3072
    v_mfma_f32_16x16x32_bf16 a[168:171], v[60:63], v[80:83], a[168:171]
    buffer_load_dwordx4 v7, s[12:15], s25 offen lds
    v_mfma_f32_16x16x32_bf16 a[172:175], v[60:63], v[84:87], a[172:175]
    s_add_u32 s25, s25, s28
    v_mfma_f32_16x16x32_bf16 a[140:143], v[56:59], v[84:87], a[140:143]
    v_mfma_f32_16x16x32_bf16 a[200:203], v[64:67], v[80:83], a[200:203]
    s_xor_b32 m0, s45, 16384
    v_mfma_f32_16x16x32_bf16 a[232:235], v[68:71], v[80:83], a[232:235]
    buffer_load_dwordx4 v6, s[12:15], s26 offen lds
    v_mfma_f32_16x16x32_bf16 a[236:239], v[68:71], v[84:87], a[236:239]
    v_mfma_f32_16x16x32_bf16 a[204:207], v[64:67], v[84:87], a[204:207]
    s_waitcnt lgkmcnt(2)
    v_mfma_f32_16x16x32_bf16 a[16:19], v[40:43], v[72:75], a[16:19]
    s_xor_b32 m0, s45, 17408
    v_mfma_f32_16x16x32_bf16 a[48:51], v[44:47], v[72:75], a[48:51]
    buffer_load_dwordx4 v7, s[12:15], s26 offen lds
    s_waitcnt lgkmcnt(0)
    v_mfma_f32_16x16x32_bf16 a[52:55], v[44:47], v[76:79], a[52:55]
    ds_read_b64_tr_b16 v[80:81], v14 offset:19456
    s_add_u32 s26, s26, s28
    v_mfma_f32_16x16x32_bf16 a[20:23], v[40:43], v[76:79], a[20:23]
    v_mfma_f32_16x16x32_bf16 a[80:83], v[48:51], v[72:75], a[80:83]
    ds_read_b64_tr_b16 v[82:83], v15 offset:19456
    s_xor_b32 m0, s45, 18432
    v_mfma_f32_16x16x32_bf16 a[112:115], v[52:55], v[72:75], a[112:115]
    buffer_load_dwordx4 v6, s[12:15], s27 offen lds
    v_mfma_f32_16x16x32_bf16 a[116:119], v[52:55], v[76:79], a[116:119]
    ds_read_b64_tr_b16 v[84:85], v14 offset:19968
    v_mfma_f32_16x16x32_bf16 a[84:87], v[48:51], v[76:79], a[84:87]
    s_xor_b32 m0, s45, 19456
    v_mfma_f32_16x16x32_bf16 a[144:147], v[56:59], v[72:75], a[144:147]
    ds_read_b64_tr_b16 v[86:87], v15 offset:19968
    buffer_load_dwordx4 v7, s[12:15], s27 offen lds
    v_mfma_f32_16x16x32_bf16 a[176:179], v[60:63], v[72:75], a[176:179]
    s_add_u32 s27, s27, s28
    s_cmp_ge_u32 s45, 98304
    v_mfma_f32_16x16x32_bf16 a[180:183], v[60:63], v[76:79], a[180:183]
    s_cselect_b32 s60, s6, s7
    s_add_u32 s45, s45, s60
    v_mfma_f32_16x16x32_bf16 a[148:151], v[56:59], v[76:79], a[148:151]
    v_add_u32 v14, s47, v14
    v_add_u32 v15, s47, v15
    v_mfma_f32_16x16x32_bf16 a[208:211], v[64:67], v[72:75], a[208:211]
    s_add_u32 s43, s43, 1
    s_cmp_eq_u32 s43, 8
    v_mfma_f32_16x16x32_bf16 a[240:243], v[68:71], v[72:75], a[240:243]
    v_mfma_f32_16x16x32_bf16 a[244:247], v[68:71], v[76:79], a[244:247]
    v_mfma_f32_16x16x32_bf16 a[212:215], v[64:67], v[76:79], a[212:215]
    s_waitcnt vmcnt(6) lgkmcnt(0)
    s_barrier
    s_cbranch_scc1 t_g2_last
    v_mfma_f32_16x16x32_bf16 a[24:27], v[40:43], v[80:83], a[24:27]
    ds_read_b64_tr_b16 v[72:73], v14 offset:0
    v_mfma_f32_16x16x32_bf16 a[56:59], v[44:47], v[80:83], a[56:59]
    ds_read_b64_tr_b16 v[74:75], v15 offset:0
    v_mfma_f32_16x16x32_bf16 a[60:63], v[44:47], v[84:87], a[60:63]
    ds_read_b128 v[44:47], v12 offset:2048
    v_mfma_f32_16x16x32_bf16 a[28:31], v[40:43], v[84:87], a[28:31]
    ds_read_b128 v[40:43], v12 offset:0
    v_mfma_f32_16x16x32_bf16 a[88:91], v[48:51], v[80:83], a[88:91]
    ds_read_b64_tr_b16 v[76:77], v14 offset:512
    v_mfma_f32_16x16x32_bf16 a[120:123], v[52:55], v[80:83], a[120:123]
    ds_read_b64_tr_b16 v[78:79], v15 offset:512
    v_mfma_f32_16x16x32_bf16 a[124:127], v[52:55], v[84:87], a[124:127]
    ds_read_b128 v[52:55], v12 offset:6144
    v_mfma_f32_16x16x32_bf16 a[92:95], v[48:51], v[84:87], a[92:95]
    ds_read_b128 v[48:51], v12 offset:4096
    v_mfma_f32_16x16x32_bf16 a[152:155], v[56:59], v[80:83], a[152:155]
    v_mfma_f32_16x16x32_bf16 a[184:187], v[60:63], v[80:83], a[184:187]
    v_mfma_f32_16x16x32_bf16 a[188:191], v[60:63], v[84:87], a[188:191]
    ds_read_b128 v[60:63], v12 offset:10240
    v_mfma_f32_16x16x32_bf16 a[156:159], v[56:59], v[84:87], a[156:159]
    ds_read_b128 v[56:59], v12 offset:8192
    v_mfma_f32_16x16x32_bf16 a[216:219], v[64:67], v[80:83], a[216:219]
    s_sub_u32 s61, s43, 2
    s_cmp_lt_u32 s61, 3
    v_mfma_f32_16x16x32_bf16 a[248:251], v[68:71], v[80:83], a[248:251]
    v_mfma_f32_16x16x32_bf16 a[252:255], v[68:71], v[84:87], a[252:255]
    ds_read_b128 v[68:71], v12 offset:14336
    v_mfma_f32_16x16x32_bf16 a[220:223], v[64:67], v[84:87], a[220:223]
    ds_read_b128 v[64:67], v12 offset:12288
    s_cbranch_scc1 t_g2_a
    s_branch t_g2_hook
t_g2_last:
    v_mfma_f32_16x16x32_bf16 a[24:27], v[40:43], v[80:83], a[24:27]
    v_mfma_f32_16x16x32_bf16 a[56:59], v[44:47], v[80:83], a[56:59]
    v_mfma_f32_16x16x32_bf16 a[60:63], v[44:47], v[84:87], a[60:63]
    v_mfma_f32_16x16x32_bf16 a[28:31], v[40:43], v[84:87], a[28:31]
    v_mfma_f32_16x16x32_bf16 a[88:91], v[48:51], v[80:83], a[88:91]
    v_mfma_f32_16x16x32_bf16 a[120:123], v[52:55], v[80:83], a[120:123]
    v_mfma_f32_16x16x32_bf16 a[124:127], v[52:55], v[84:87], a[124:127]
    v_mfma_f32_16x16x32_bf16 a[92:95], v[48:51], v[84:87], a[92:95]
    v_mfma_f32_16x16x32_bf16 a[152:155], v[56:59], v[80:83], a[152:155]
    v_mfma_f32_16x16x32_bf16 a[184:187], v[60:63], v[80:83], a[184:187]
    v_mfma_f32_16x16x32_bf16 a[188:191], v[60:63], v[84:87], a[188:191]
    v_mfma_f32_16x16x32_bf16 a[156:159], v[56:59], v[84:87], a[156:159]
    v_mfma_f32_16x16x32_bf16 a[216:219], v[64:67], v[80:83], a[216:219]
    v_mfma_f32_16x16x32_bf16 a[248:251], v[68:71], v[80:83], a[248:251]
    v_mfma_f32_16x16x32_bf16 a[252:255], v[68:71], v[84:87], a[252:255]
    v_mfma_f32_16x16x32_bf16 a[220:223], v[64:67], v[84:87], a[220:223]
    s_setpc_b64 s[54:55]
t_g1:
    s_mov_b32 s43, 0
    v_add_u32 v14, s49, v23
    v_xor_b32 v15, 64, v14
    ds_read_b128 v[72:75], v14 offset:0
    ds_read_b128 v[76:79], v14 offset:2048
    ds_read_b128 v[44:47], v12 offset:2048
    ds_read_b128 v[40:43], v12 offset:0
    ds_read_b128 v[52:55], v12 offset:6144
    ds_read_b128 v[48:51], v12 offset:4096
    ds_read_b128 v[60:63], v12 offset:10240
    ds_read_b128 v[56:59], v12 offset:8192
    ds_read_b128 v[68:71], v12 offset:14336
    ds_read_b128 v[64:67], v12 offset:12288
    s_waitcnt lgkmcnt(6)
    v_mfma_f32_16x16x32_bf16 a[0:3], v[40:43], v[72:75], 0
    s_xor_b32 m0, s44, 0
    v_mfma_f32_16x16x32_bf16 a[32:35], v[44:47], v[72:75], 0
    buffer_load_dwordx4 v4, s[8:11], s20 offen lds
    v_mfma_f32_16x16x32_bf16 a[36:39], v[44:47], v[76:79], 0
    ds_read_b128 v[80:83], v14 offset:4096
    s_xor_b32 m0, s44, 1024
    v_mfma_f32_16x16x32_bf16 a[4:7], v[40:43], v[76:79], 0
    buffer_load_dwordx4 v5, s[8:11], s20 offen lds
    s_waitcnt lgkmcnt(5)
    v_mfma_f32_16x16x32_bf16 a[64:67], v[48:51], v[72:75], 0
    ds_read_b128 v[84:87], v14 offset:6144
    s_add_u32 s20, s20, 128
    v_mfma_f32_16x16x32_bf16 a[96:99], v[52:55], v[72:75], 0
    s_xor_b32 m0, s45, 0
    v_mfma_f32_16x16x32_bf16 a[100:103], v[52:55], v[76:79], 0
    buffer_load_dwordx4 v6, s[12:15], s24 offen lds
    v_mfma_f32_16x16x32_bf16 a[68:71], v[48:51], v[76:79], 0
    s_xor_b32 m0, s45, 1024
    s_waitcnt lgkmcnt(4)
    v_mfma_f32_16x16x32_bf16 a[128:131], v[56:59], v[72:75], 0
    buffer_load_dwordx4 v7, s[12:15], s24 offen lds
    v_mfma_f32_16x16x32_bf16 a[160:163], v[60:63], v[72:75], 0
    s_add_u32 s24, s24, s28
    s_bitcmp1_b32 s43, 0
    v_mfma_f32_16x16x32_bf16 a[164:167], v[60:63], v[76:79], 0
    s_cselect_b32 s61, s5, 0
    s_lshl1_add_u32 s53, s61, s50
    v_mfma_f32_16x16x32_bf16 a[132:135], v[56:59], v[76:79], 0
    s_bitcmp1_b32 s43, 1
    s_waitcnt lgkmcnt(2)
    v_mfma_f32_16x16x32_bf16 a[192:195], v[64:67], v[72:75], 0
    s_cselect_b32 s61, s51, 0
    s_add_u32 s53, s53, s61
    v_mfma_f32_16x16x32_bf16 a[224:227], v[68:71], v[72:75], 0
    s_bitcmp1_b32 s43, 2
    s_cselect_b32 s61, s52, 0
    v_mfma_f32_16x16x32_bf16 a[228:231], v[68:71], v[76:79], 0
    s_add_u32 s53, s53, s61
    s_lshl_b32 s29, s43, 4
    v_mfma_f32_16x16x32_bf16 a[196:199], v[64:67], v[76:79], 0
    s_waitcnt lgkmcnt(1)
    v_mfma_f32_16x16x32_bf16 a[8:11], v[40:43], v[80:83], 0
    s_set_gpr_idx_on s29, gpr_idx(SRC0)
    v_mov_b32 v24, v128
    v_mov_b32 v25, v129
    v_mov_b32 v26, v130
    v_mov_b32 v27, v131
    s_set_gpr_idx_off
    v_mfma_f32_16x16x32_bf16 a[40:43], v[44:47], v[80:83], 0
    s_waitcnt lgkmcnt(0)
    v_mfma_f32_16x16x32_bf16 a[44:47], v[44:47], v[84:87], 0
    ds_read_b128 v[72:75], v14 offset:8192
    s_set_gpr_idx_on s29, gpr_idx(SRC0)
    v_mov_b32 v28, v132
    v_mov_b32 v29, v133
    v_mov_b32 v30, v134
    v_mov_b32 v31, v135
    s_set_gpr_idx_off
    v_mfma_f32_16x16x32_bf16 a[12:15], v[40:43], v[84:87], 0
    v_mfma_f32_16x16x32_bf16 a[72:75], v[48:51], v[80:83], 0
    ds_read_b128 v[76:79], v14 offset:10240
    s_set_gpr_idx_on s29, gpr_idx(SRC0)
    v_mov_b32 v32, v136
    v_mov_b32 v33, v137
    v_mov_b32 v34, v138
    v_mov_b32 v35, v139
    s_set_gpr_idx_off
    v_mfma_f32_16x16x32_bf16 a[104:107], v[52:55], v[80:83], 0
    v_mfma_f32_16x16x32_bf16 a[108:111], v[52:55], v[84:87], 0
    s_set_gpr_idx_on s29, gpr_idx(SRC0)
    v_mov_b32 v36, v140
    v_mov_b32 v37, v141
    v_mov_b32 v38, v142
    v_mov_b32 v39, v143
    s_set_gpr_idx_off
    v_mfma_f32_16x16x32_bf16 a[76:79], v[48:51], v[84:87], 0
    v_mfma_f32_16x16x32_bf16 a[136:139], v[56:59], v[80:83], 0
    buffer_store_dwordx4 v[24:27], v2, s[16:19], s53 offen sc1
    v_mfma_f32_16x16x32_bf16 a[168:171], v[60:63], v[80:83], 0
    v_mfma_f32_16x16x32_bf16 a[172:175], v[60:63], v[84:87], 0
    buffer_store_dwordx4 v[28:31], v3, s[16:19], s53 offen sc1
    v_mfma_f32_16x16x32_bf16 a[140:143], v[56:59], v[84:87], 0
    s_add_u32 s53, s53, s5
    v_mfma_f32_16x16x32_bf16 a[200:203], v[64:67], v[80:83], 0
    buffer_store_dwordx4 v[32:35], v2, s[16:19], s53 offen sc1
    v_mfma_f32_16x16x32_bf16 a[232:235], v[68:71], v[80:83], 0
    v_mfma_f32_16x16x32_bf16 a[236:239], v[68:71], v[84:87], 0
    buffer_store_dwordx4 v[36:39], v3, s[16:19], s53 offen sc1
    v_mfma_f32_16x16x32_bf16 a[204:207], v[64:67], v[84:87], 0
    s_waitcnt lgkmcnt(1)
    v_mfma_f32_16x16x32_bf16 a[16:19], v[40:43], v[72:75], 0
    v_mfma_f32_16x16x32_bf16 a[48:51], v[44:47], v[72:75], 0
    s_waitcnt lgkmcnt(0)
    v_mfma_f32_16x16x32_bf16 a[52:55], v[44:47], v[76:79], 0
    ds_read_b128 v[80:83], v14 offset:12288
    v_mfma_f32_16x16x32_bf16 a[20:23], v[40:43], v[76:79], 0
    v_mfma_f32_16x16x32_bf16 a[80:83], v[48:51], v[72:75], 0
    ds_read_b128 v[84:87], v14 offset:14336
    v_mfma_f32_16x16x32_bf16 a[112:115], v[52:55], v[72:75], 0
    v_mfma_f32_16x16x32_bf16 a[116:119], v[52:55], v[76:79], 0
    v_mfma_f32_16x16x32_bf16 a[84:87], v[48:51], v[76:79], 0
    v_mfma_f32_16x16x32_bf16 a[144:147], v[56:59], v[72:75], 0
    v_mfma_f32_16x16x32_bf16 a[176:179], v[60:63], v[72:75], 0
    v_mfma_f32_16x16x32_bf16 a[180:183], v[60:63], v[76:79], 0
    v_mfma_f32_16x16x32_bf16 a[148:151], v[56:59], v[76:79], 0
    v_mfma_f32_16x16x32_bf16 a[208:211], v[64:67], v[72:75], 0
    v_mfma_f32_16x16x32_bf16 a[240:243], v[68:71], v[72:75], 0
    v_mfma_f32_16x16x32_bf16 a[244:247], v[68:71], v[76:79], 0
    v_mfma_f32_16x16x32_bf16 a[212:215], v[64:67], v[76:79], 0
    s_waitcnt lgkmcnt(1)
    v_mfma_f32_16x16x32_bf16 a[24:27], v[40:43], v[80:83], 0
    ds_read_b128 v[72:75], v15 offset:0
    v_mfma_f32_16x16x32_bf16 a[56:59], v[44:47], v[80:83], 0
    ds_read_b128 v[76:79], v15 offset:2048
    s_waitcnt lgkmcnt(2)
    v_mfma_f32_16x16x32_bf16 a[60:63], v[44:47], v[84:87], 0
    ds_read_b128 v[44:47], v13 offset:2048
    v_mfma_f32_16x16x32_bf16 a[28:31], v[40:43], v[84:87], 0
    ds_read_b128 v[40:43], v13 offset:0
    v_mfma_f32_16x16x32_bf16 a[88:91], v[48:51], v[80:83], 0
    v_mfma_f32_16x16x32_bf16 a[120:123], v[52:55], v[80:83], 0
    v_mfma_f32_16x16x32_bf16 a[124:127], v[52:55], v[84:87], 0
    ds_read_b128 v[52:55], v13 offset:6144
    v_mfma_f32_16x16x32_bf16 a[92:95], v[48:51], v[84:87], 0
    ds_read_b128 v[48:51], v13 offset:4096
    v_mfma_f32_16x16x32_bf16 a[152:155], v[56:59], v[80:83], 0
    s_xor_b32 m0, s44, 2048
    v_mfma_f32_16x16x32_bf16 a[184:187], v[60:63], v[80:83], 0
    buffer_load_dwordx4 v4, s[8:11], s21 offen lds
    v_mfma_f32_16x16x32_bf16 a[188:191], v[60:63], v[84:87], 0
    ds_read_b128 v[60:63], v13 offset:10240
    v_mfma_f32_16x16x32_bf16 a[156:159], v[56:59], v[84:87], 0
    ds_read_b128 v[56:59], v13 offset:8192
    v_mfma_f32_16x16x32_bf16 a[216:219], v[64:67], v[80:83], 0
    s_xor_b32 m0, s44, 3072
    v_mfma_f32_16x16x32_bf16 a[248:251], v[68:71], v[80:83], 0
    buffer_load_dwordx4 v5, s[8:11], s21 offen lds
    v_mfma_f32_16x16x32_bf16 a[252:255], v[68:71], v[84:87], 0
    ds_read_b128 v[68:71], v13 offset:14336
    s_add_u32 s21, s21, 128
    v_mfma_f32_16x16x32_bf16 a[220:223], v[64:67], v[84:87], 0
    ds_read_b128 v[64:67], v13 offset:12288
    s_branch t_g1_b
t_g1_as:
    s_waitcnt lgkmcnt(6)
    v_mfma_f32_16x16x32_bf16 a[0:3], v[40:43], v[72:75], a[0:3]
    s_xor_b32 m0, s44, 0
    v_mfma_f32_16x16x32_bf16 a[32:35], v[44:47], v[72:75], a[32:35]
    buffer_load_dwordx4 v4, s[8:11], s20 offen lds
    v_mfma_f32_16x16x32_bf16 a[36:39], v[44:47], v[76:79], a[36:39]
    ds_read_b128 v[80:83], v14 offset:4096
    s_xor_b32 m0, s44, 1024
    v_mfma_f32_16x16x32_bf16 a[4:7], v[40:43], v[76:79], a[4:7]
    buffer_load_dwordx4 v5, s[8:11], s20 offen lds
    s_waitcnt lgkmcnt(5)
    v_mfma_f32_16x16x32_bf16 a[64:67], v[48:51], v[72:75], a[64:67]
    ds_read_b128 v[84:87], v14 offset:6144
    s_add_u32 s20, s20, 128
    v_mfma_f32_16x16x32_bf16 a[96:99], v[52:55], v[72:75], a[96:99]
    s_xor_b32 m0, s45, 0
    v_mfma_f32_16x16x32_bf16 a[100:103], v[52:55], v[76:79], a[100:103]
    buffer_load_dwordx4 v6, s[12:15], s24 offen lds
    v_mfma_f32_16x16x32_bf16 a[68:71], v[48:51], v[76:79], a[68:71]
    s_xor_b32 m0, s45, 1024
    s_waitcnt lgkmcnt(4)
    v_mfma_f32_16x16x32_bf16 a[128:131], v[56:59], v[72:75], a[128:131]
    buffer_load_dwordx4 v7, s[12:15], s24 offen lds
    v_mfma_f32_16x16x32_bf16 a[160:163], v[60:63], v[72:75], a[160:163]
    s_add_u32 s24, s24, s28
    s_bitcmp1_b32 s43, 0
    v_mfma_f32_16x16x32_bf16 a[164:167], v[60:63], v[76:79], a[164:167]
    s_cselect_b32 s61, s5, 0
    s_lshl1_add_u32 s53, s61, s50
    v_mfma_f32_16x16x32_bf16 a[132:135], v[56:59], v[76:79], a[132:135]
    s_bitcmp1_b32 s43, 1
    s_waitcnt lgkmcnt(2)
    v_mfma_f32_16x16x32_bf16 a[192:195], v[64:67], v[72:75], a[192:195]
    s_cselect_b32 s61, s51, 0
    s_add_u32 s53, s53, s61
    v_mfma_f32_16x16x32_bf16 a[224:227], v[68:71], v[72:75], a[224:227]
    s_bitcmp1_b32 s43, 2
    s_cselect_b32 s61, s52, 0
    v_mfma_f32_16x16x32_bf16 a[228:231], v[68:71], v[76:79], a[228:231]
    s_add_u32 s53, s53, s61
    s_lshl_b32 s29, s43, 4
    v_mfma_f32_16x16x32_bf16 a[196:199], v[64:67], v[76:79], a[196:199]
    s_waitcnt lgkmcnt(1)
    v_mfma_f32_16x16x32_bf16 a[8:11], v[40:43], v[80:83], a[8:11]
    s_set_gpr_idx_on s29, gpr_idx(SRC0)
    v_mov_b32 v24, v128
    v_mov_b32 v25, v129
    v_mov_b32 v26, v130
    v_mov_b32 v27, v131
    s_set_gpr_idx_off
    v_mfma_f32_16x16x32_bf16 a[40:43], v[44:47], v[80:83], a[40:43]
    s_waitcnt lgkmcnt(0)
    v_mfma_f32_16x16x32_bf16 a[44:47], v[44:47], v[84:87], a[44:47]
    ds_read_b128 v[72:75], v14 offset:8192
    s_set_gpr_idx_on s29, gpr_idx(SRC0)
    v_mov_b32 v28, v132
    v_mov_b32 v29, v133
    v_mov_b32 v30, v134
    v_mov_b32 v31, v135
    s_set_gpr_idx_off
    v_mfma_f32_16x16x32_bf16 a[12:15], v[40:43], v[84:87], a[12:15]
    v_mfma_f32_16x16x32_bf16 a[72:75], v[48:51], v[80:83], a[72:75]
    ds_read_b128 v[76:79], v14 offset:10240
    s_set_gpr_idx_on s29, gpr_idx(SRC0)
    v_mov_b32 v32, v136
    v_mov_b32 v33, v137
    v_mov_b32 v34, v138
    v_mov_b32 v35, v139
    s_set_gpr_idx_off
    v_mfma_f32_16x16x32_bf16 a[104:107], v[52:55], v[80:83], a[104:107]
    v_mfma_f32_16x16x32_bf16 a[108:111], v[52:55], v[84:87], a[108:111]
    s_set_gpr_idx_on s29, gpr_idx(SRC0)
    v_mov_b32 v36, v140
    v_mov_b32 v37, v141
    v_mov_b32 v38, v142
    v_mov_b32 v39, v143
    s_set_gpr_idx_off
    v_mfma_f32_16x16x32_bf16 a[76:79], v[48:51], v[84:87], a[76:79]
    v_mfma_f32_16x16x32_bf16 a[136:139], v[56:59], v[80:83], a[136:139]
    buffer_store_dwordx4 v[24:27], v2, s[16:19], s53 offen sc1
    v_mfma_f32_16x16x32_bf16 a[168:171], v[60:63], v[80:83], a[168:171]
    v_mfma_f32_16x16x32_bf16 a[172:175], v[60:63], v[84:87], a[172:175]
    buffer_store_dwordx4 v[28:31], v3, s[16:19], s53 offen sc1
    v_mfma_f32_16x16x32_bf16 a[140:143], v[56:59], v[84:87], a[140:143]
    s_add_u32 s53, s53, s5
    v_mfma_f32_16x16x32_bf16 a[200:203], v[64:67], v[80:83], a[200:203]
    buffer_store_dwordx4 v[32:35], v2, s[16:19], s53 offen sc1
    v_mfma_f32_16x16x32_bf16 a[232:235], v[68:71], v[80:83], a[232:235]
    v_mfma_f32_16x16x32_bf16 a[236:239], v[68:71], v[84:87], a[236:239]
    buffer_store_dwordx4 v[36:39], v3, s[16:19], s53 offen sc1
    v_mfma_f32_16x16x32_bf16 a[204:207], v[64:67], v[84:87], a[204:207]
    s_waitcnt lgkmcnt(1)
    v_mfma_f32_16x16x32_bf16 a[16:19], v[40:43], v[72:75], a[16:19]
    v_mfma_f32_16x16x32_bf16 a[48:51], v[44:47], v[72:75], a[48:51]
    s_waitcnt lgkmcnt(0)
    v_mfma_f32_16x16x32_bf16 a[52:55], v[44:47], v[76:79], a[52:55]
    ds_read_b128 v[80:83], v14 offset:12288
    v_mfma_f32_16x16x32_bf16 a[20:23], v[40:43], v[76:79], a[20:23]
    v_mfma_f32_16x16x32_bf16 a[80:83], v[48:51], v[72:75], a[80:83]
    ds_read_b128 v[84:87], v14 offset:14336
    v_mfma_f32_16x16x32_bf16 a[112:115], v[52:55], v[72:75], a[112:115]
    v_mfma_f32_16x16x32_bf16 a[116:119], v[52:55], v[76:79], a[116:119]
    v_mfma_f32_16x16x32_bf16 a[84:87], v[48:51], v[76:79], a[84:87]
    v_mfma_f32_16x16x32_bf16 a[144:147], v[56:59], v[72:75], a[144:147]
    v_mfma_f32_16x16x32_bf16 a[176:179], v[60:63], v[72:75], a[176:179]
    v_mfma_f32_16x16x32_bf16 a[180:183], v[60:63], v[76:79], a[180:183]
    v_mfma_f32_16x16x32_bf16 a[148:151], v[56:59], v[76:79], a[148:151]
    v_mfma_f32_16x16x32_bf16 a[208:211], v[64:67], v[72:75], a[208:211]
    v_mfma_f32_16x16x32_bf16 a[240:243], v[68:71], v[72:75], a[240:243]
    v_mfma_f32_16x16x32_bf16 a[244:247], v[68:71], v[76:79], a[244:247]
    v_mfma_f32_16x16x32_bf16 a[212:215], v[64:67], v[76:79], a[212:215]
    s_waitcnt lgkmcnt(1)
    v_mfma_f32_16x16x32_bf16 a[24:27], v[40:43], v[80:83], a[24:27]
    ds_read_b128 v[72:75], v15 offset:0
    v_mfma_f32_16x16x32_bf16 a[56:59], v[44:47], v[80:83], a[56:59]
    ds_read_b128 v[76:79], v15 offset:2048
    s_waitcnt lgkmcnt(2)
    v_mfma_f32_16x16x32_bf16 a[60:63], v[44:47], v[84:87], a[60:63]
    ds_read_b128 v[44:47], v13 offset:2048
    v_mfma_f32_16x16x32_bf16 a[28:31], v[40:43], v[84:87], a[28:31]
    ds_read_b128 v[40:43], v13 offset:0
    v_mfma_f32_16x16x32_bf16 a[88:91], v[48:51], v[80:83], a[88:91]
    v_mfma_f32_16x16x32_bf16 a[120:123], v[52:55], v[80:83], a[120:123]
    v_mfma_f32_16x16x32_bf16 a[124:127], v[52:55], v[84:87], a[124:127]
    ds_read_b128 v[52:55], v13 offset:6144
    v_mfma_f32_16x16x32_bf16 a[92:95], v[48:51], v[84:87], a[92:95]
    ds_read_b128 v[48:51], v13 offset:4096
    v_mfma_f32_16x16x32_bf16 a[152:155], v[56:59], v[80:83], a[152:155]
    s_xor_b32 m0, s44, 2048
    v_mfma_f32_16x16x32_bf16 a[184:187], v[60:63], v[80:83], a[184:187]
    buffer_load_dwordx4 v4, s[8:11], s21 offen lds
    v_mfma_f32_16x16x32_bf16 a[188:191], v[60:63], v[84:87], a[188:191]
    ds_read_b128 v[60:63], v13 offset:10240
    v_mfma_f32_16x16x32_bf16 a[156:159], v[56:59], v[84:87], a[156:159]
    ds_read_b128 v[56:59], v13 offset:8192
    v_mfma_f32_16x16x32_bf16 a[216:219], v[64:67], v[80:83], a[216:219]
    s_xor_b32 m0, s44, 3072
    v_mfma_f32_16x16x32_bf16 a[248:251], v[68:71], v[80:83], a[248:251]
    buffer_load_dwordx4 v5, s[8:11], s21 offen lds
    v_mfma_f32_16x16x32_bf16 a[252:255], v[68:71], v[84:87], a[252:255]
    ds_read_b128 v[68:71], v13 offset:14336
    s_add_u32 s21, s21, 128
    v_mfma_f32_16x16x32_bf16 a[220:223], v[64:67], v[84:87], a[220:223]
    ds_read_b128 v[64:67], v13 offset:12288
    s_branch t_g1_b
t_g1_hook:
    s_cmp_eq_u32 s43, 1
    s_cbranch_scc1 t_g1_sig0
    s_cmp_lt_u32 s43, 8
    s_cbranch_scc1 t_g1_as
    s_cmp_eq_u32 s43, 14
    s_cbranch_scc1 t_g1_sws
    s_cmp_eq_u32 s43, 15
    s_cbranch_scc1 t_g1_swp
    s_cmp_lg_u32 s58, 0
    s_cbranch_scc1 t_g1_a
    s_cmp_eq_u32 s43, 13
    s_cbranch_scc1 t_g1_wait
    s_cmp_lg_u32 s43, 9
    s_cbranch_scc1 t_g1_a
    s_cmp_eq_u32 s4, 0
    s_cbranch_scc1 t_g1_a
    v_mov_b32 v24, s4
    v_mov_b32 v25, 1
    s_mov_b64 exec, 1
    global_atomic_add v24, v25, s[98:99] sc1
    s_mov_b64 exec, -1
    s_branch t_g1_a
t_g1_wait:
    s_cmp_eq_u32 s3, 0
    s_cbranch_scc1 t_g1_a
    s_mov_b32 s62, 0
L_sw_63:
    s_load_dword s63, s[98:99], s3 glc
    s_add_u32 s62, s62, 1
    s_cmp_gt_u32 s62, 0x200000
    s_cbranch_scc1 chain_kernel_wabort
    s_waitcnt lgkmcnt(0)
    s_cmp_ge_u32 s63, s2
    s_cbranch_scc1 L_swok_64
    s_sleep 16
    s_branch L_sw_63
L_swok_64:
    s_branch t_g1_a
t_g1_sig0:
    s_cmp_eq_u32 s1, 0
    s_cbranch_scc1 t_g1_as
    v_mov_b32 v24, s1
    v_mov_b32 v25, 1
    s_mov_b64 exec, 1
    global_atomic_add v24, v25, s[98:99] sc1
    s_mov_b64 exec, -1
    s_mov_b32 s1, 0
    s_branch t_g1_as
t_g1_sws:
    s_mov_b32 s12, s36
    s_mov_b32 s13, s37
    s_mov_b32 s14, s38
    s_and_b32 s45, s45, 0xffffb7ff
    s_bitcmp1_b32 s94, 1
    s_cselect_b32 s24, s41, 0
    s_cselect_b32 s26, 0, s41
    s_cselect_b32 s60, 0x4000, 0
    s_or_b32 s45, s45, s60
    s_add_u32 s24, s24, s39
    s_add_u32 s26, s26, s39
    s_bitcmp1_b32 s94, 0
    s_cselect_b32 s61, s40, 0
    s_cselect_b32 s62, 0, s40
    s_cselect_b32 s60, 0x800, 0
    s_or_b32 s45, s45, s60
    s_add_u32 s25, s24, s62
    s_add_u32 s24, s24, s61
    s_add_u32 s27, s26, s62
    s_add_u32 s26, s26, s61
    s_mov_b32 s28, s42
    v_mov_b32 v6, v10
    v_mov_b32 v7, v11
    s_branch t_g1_a
t_g1_swp:
    s_mov_b32 s8, s30
    s_mov_b32 s9, s31
    s_mov_b32 s10, s32
    s_and_b32 s44, s44, 0xffffb7ff
    s_bitcmp1_b32 s84, 1
    s_cselect_b32 s20, s35, 0
    s_cselect_b32 s22, 0, s35
    s_cselect_b32 s60, 0x4000, 0
    s_or_b32 s44, s44, s60
    s_add_u32 s20, s20, s33
    s_add_u32 s22, s22, s33
    s_bitcmp1_b32 s84, 0
    s_cselect_b32 s61, s34, 0
    s_cselect_b32 s62, 0, s34
    s_cselect_b32 s60, 0x800, 0
    s_or_b32 s44, s44, s60
    s_add_u32 s21, s20, s62
    s_add_u32 s20, s20, s61
    s_add_u32 s23, s22, s62
    s_add_u32 s22, s22, s61
    v_mov_b32 v4, v8
    v_mov_b32 v5, v9
t_g1_a:
    s_waitcnt lgkmcnt(6)
    v_mfma_f32_16x16x32_bf16 a[0:3], v[40:43], v[72:75], a[0:3]
    s_xor_b32 m0, s44, 0
    v_mfma_f32_16x16x32_bf16 a[32:35], v[44:47], v[72:75], a[32:35]
    buffer_load_dwordx4 v4, s[8:11], s20 offen lds
    v_mfma_f32_16x16x32_bf16 a[36:39], v[44:47], v[76:79], a[36:39]
    ds_read_b128 v[80:83], v14 offset:4096
    s_xor_b32 m0, s44, 1024
    v_mfma_f32_16x16x32_bf16 a[4:7], v[40:43], v[76:79], a[4:7]
    buffer_load_dwordx4 v5, s[8:11], s20 offen lds
    s_waitcnt lgkmcnt(5)
    v_mfma_f32_16x16x32_bf16 a[64:67], v[48:51], v[72:75], a[64:67]
    ds_read_b128 v[84:87], v14 offset:6144
    s_add_u32 s20, s20, 128
    v_mfma_f32_16x16x32_bf16 a[96:99], v[52:55], v[72:75], a[96:99]
    s_xor_b32 m0, s45, 0
    v_mfma_f32_16x16x32_bf16 a[100:103], v[52:55], v[76:79], a[100:103]
    buffer_load_dwordx4 v6, s[12:15], s24 offen lds
    v_mfma_f32_16x16x32_bf16 a[68:71], v[48:51], v[76:79], a[68:71]
    s_xor_b32 m0, s45, 1024
    s_waitcnt lgkmcnt(4)
    v_mfma_f32_16x16x32_bf16 a[128:131], v[56:59], v[72:75], a[128:131]
    buffer_load_dwordx4 v7, s[12:15], s24 offen lds
    v_mfma_f32_16x16x32_bf16 a[160:163], v[60:63], v[72:75], a[160:163]
    s_add_u32 s24, s24, s28
    v_mfma_f32_16x16x32_bf16 a[164:167], v[60:63], v[76:79], a[164:167]
    v_mfma_f32_16x16x32_bf16 a[132:135], v[56:59], v[76:79], a[132:135]
    s_waitcnt lgkmcnt(2)
    v_mfma_f32_16x16x32_bf16 a[192:195], v[64:67], v[72:75], a[192:195]
    v_mfma_f32_16x16x32_bf16 a[224:227], v[68:71], v[72:75], a[224:227]
    v_mfma_f32_16x16x32_bf16 a[228:231], v[68:71], v[76:79], a[228:231]
    v_mfma_f32_16x16x32_bf16 a[196:199], v[64:67], v[76:79], a[196:199]
    s_waitcnt lgkmcnt(1)
    v_mfma_f32_16x16x32_bf16 a[8:11], v[40:43], v[80:83], a[8:11]
    v_mfma_f32_16x16x32_bf16 a[40:43], v[44:47], v[80:83], a[40:43]
    s_waitcnt lgkmcnt(0)
    v_mfma_f32_16x16x32_bf16 a[44:47], v[44:47], v[84:87], a[44:47]
    ds_read_b128 v[72:75], v14 offset:8192
    v_mfma_f32_16x16x32_bf16 a[12:15], v[40:43], v[84:87], a[12:15]
    v_mfma_f32_16x16x32_bf16 a[72:75], v[48:51], v[80:83], a[72:75]
    ds_read_b128 v[76:79], v14 offset:10240
    v_mfma_f32_16x16x32_bf16 a[104:107], v[52:55], v[80:83], a[104:107]
    v_mfma_f32_16x16x32_bf16 a[108:111], v[52:55], v[84:87], a[108:111]
    v_mfma_f32_16x16x32_bf16 a[76:79], v[48:51], v[84:87], a[76:79]
    v_mfma_f32_16x16x32_bf16 a[136:139], v[56:59], v[80:83], a[136:139]
    v_mfma_f32_16x16x32_bf16 a[168:171], v[60:63], v[80:83], a[168:171]
    v_mfma_f32_16x16x32_bf16 a[172:175], v[60:63], v[84:87], a[172:175]
    v_mfma_f32_16x16x32_bf16 a[140:143], v[56:59], v[84:87], a[140:143]
    v_mfma_f32_16x16x32_bf16 a[200:203], v[64:67], v[80:83], a[200:203]
    v_mfma_f32_16x16x32_bf16 a[232:235], v[68:71], v[80:83], a[232:235]
    v_mfma_f32_16x16x32_bf16 a[236:239], v[68:71], v[84:87], a[236:239]
    v_mfma_f32_16x16x32_bf16 a[204:207], v[64:67], v[84:87], a[204:207]
    s_waitcnt lgkmcnt(1)
    v_mfma_f32_16x16x32_bf16 a[16:19], v[40:43], v[72:75], a[16:19]
    v_mfma_f32_16x16x32_bf16 a[48:51], v[44:47], v[72:75], a[48:51]
    s_waitcnt lgkmcnt(0)
    v_mfma_f32_16x16x32_bf16 a[52:55], v[44:47], v[76:79], a[52:55]
    ds_read_b128 v[80:83], v14 offset:12288
    v_mfma_f32_16x16x32_bf16 a[20:23], v[40:43], v[76:79], a[20:23]
    v_mfma_f32_16x16x32_bf16 a[80:83], v[48:51], v[72:75], a[80:83]
    ds_read_b128 v[84:87], v14 offset:14336
    v_mfma_f32_16x16x32_bf16 a[112:115], v[52:55], v[72:75], a[112:115]
    v_mfma_f32_16x16x32_bf16 a[116:119], v[52:55], v[76:79], a[116:119]
    v_mfma_f32_16x16x32_bf16 a[84:87], v[48:51], v[76:79], a[84:87]
    v_mfma_f32_16x16x32_bf16 a[144:147], v[56:59], v[72:75], a[144:147]
    v_mfma_f32_16x16x32_bf16 a[176:179], v[60:63], v[72:75], a[176:179]
    v_mfma_f32_16x16x32_bf16 a[180:183], v[60:63], v[76:79], a[180:183]
    v_mfma_f32_16x16x32_bf16 a[148:151], v[56:59], v[76:79], a[148:151]
    v_mfma_f32_16x16x32_bf16 a[208:211], v[64:67], v[72:75], a[208:211]
    v_mfma_f32_16x16x32_bf16 a[240:243], v[68:71], v[72:75], a[240:243]
    v_mfma_f32_16x16x32_bf16 a[244:247], v[68:71], v[76:79], a[244:247]
    v_mfma_f32_16x16x32_bf16 a[212:215], v[64:67], v[76:79], a[212:215]
    s_waitcnt lgkmcnt(1)
    v_mfma_f32_16x16x32_bf16 a[24:27], v[40:43], v[80:83], a[24:27]
    ds_read_b128 v[72:75], v15 offset:0
    v_mfma_f32_16x16x32_bf16 a[56:59], v[44:47], v[80:83], a[56:59]
    ds_read_b128 v[76:79], v15 offset:2048
    s_waitcnt lgkmcnt(2)
    v_mfma_f32_16x16x32_bf16 a[60:63], v[44:47], v[84:87], a[60:63]
    ds_read_b128 v[44:47], v13 offset:2048
    v_mfma_f32_16x16x32_bf16 a[28:31], v[40:43], v[84:87], a[28:31]
    ds_read_b128 v[40:43], v13 offset:0
    v_mfma_f32_16x16x32_bf16 a[88:91], v[48:51], v[80:83], a[88:91]
    v_mfma_f32_16x16x32_bf16 a[120:123], v[52:55], v[80:83], a[120:123]
    v_mfma_f32_16x16x32_bf16 a[124:127], v[52:55], v[84:87], a[124:127]
    ds_read_b128 v[52:55], v13 offset:6144
    v_mfma_f32_16x16x32_bf16 a[92:95], v[48:51], v[84:87], a[92:95]
    ds_read_b128 v[48:51], v13 offset:4096
    v_mfma_f32_16x16x32_bf16 a[152:155], v[56:59], v[80:83], a[152:155]
    s_xor_b32 m0, s44, 2048
    v_mfma_f32_16x16x32_bf16 a[184:187], v[60:63], v[80:83], a[184:187]
    buffer_load_dwordx4 v4, s[8:11], s21 offen lds
    v_mfma_f32_16x16x32_bf16 a[188:191], v[60:63], v[84:87], a[188:191]
    ds_read_b128 v[60:63], v13 offset:10240
    v_mfma_f32_16x16x32_bf16 a[156:159], v[56:59], v[84:87], a[156:159]
    ds_read_b128 v[56:59], v13 offset:8192
    v_mfma_f32_16x16x32_bf16 a[216:219], v[64:67], v[80:83], a[216:219]
    s_xor_b32 m0, s44, 3072
    v_mfma_f32_16x16x32_bf16 a[248:251], v[68:71], v[80:83], a[248:251]
    buffer_load_dwordx4 v5, s[8:11], s21 offen lds
    v_mfma_f32_16x16x32_bf16 a[252:255], v[68:71], v[84:87], a[252:255]
    ds_read_b128 v[68:71], v13 offset:14336
    s_add_u32 s21, s21, 128
    v_mfma_f32_16x16x32_bf16 a[220:223], v[64:67], v[84:87], a[220:223]
    ds_read_b128 v[64:67], v13 offset:12288
t_g1_b:
    s_waitcnt lgkmcnt(6)
    v_mfma_f32_16x16x32_bf16 a[0:3], v[40:43], v[72:75], a[0:3]
    v_mfma_f32_16x16x32_bf16 a[32:35], v[44:47], v[72:75], a[32:35]
    s_xor_b32 m0, s44, 16384
    v_mfma_f32_16x16x32_bf16 a[36:39], v[44:47], v[76:79], a[36:39]
    ds_read_b128 v[80:83], v15 offset:4096
    buffer_load_dwordx4 v4, s[8:11], s22 offen lds
    v_mfma_f32_16x16x32_bf16 a[4:7], v[40:43], v[76:79], a[4:7]
    s_cmp_ge_u32 s48, 98304
    s_waitcnt lgkmcnt(5)
    v_mfma_f32_16x16x32_bf16 a[64:67], v[48:51], v[72:75], a[64:67]
    ds_read_b128 v[84:87], v15 offset:6144
    s_cselect_b32 s46, s6, s7
    v_mfma_f32_16x16x32_bf16 a[96:99], v[52:55], v[72:75], a[96:99]
    s_add_u32 s48, s48, s46
    s_xor_b32 m0, s44, 17408
    v_mfma_f32_16x16x32_bf16 a[100:103], v[52:55], v[76:79], a[100:103]
    buffer_load_dwordx4 v5, s[8:11], s22 offen lds
    v_mfma_f32_16x16x32_bf16 a[68:71], v[48:51], v[76:79], a[68:71]
    s_add_u32 s22, s22, 128
    s_waitcnt lgkmcnt(4)
    v_mfma_f32_16x16x32_bf16 a[128:131], v[56:59], v[72:75], a[128:131]
    s_cmp_ge_u32 s49, 98304
    s_cselect_b32 s47, s6, s7
    v_mfma_f32_16x16x32_bf16 a[160:163], v[60:63], v[72:75], a[160:163]
    s_add_u32 s49, s49, s47
    s_xor_b32 m0, s44, 18432
    v_mfma_f32_16x16x32_bf16 a[164:167], v[60:63], v[76:79], a[164:167]
    buffer_load_dwordx4 v4, s[8:11], s23 offen lds
    v_mfma_f32_16x16x32_bf16 a[132:135], v[56:59], v[76:79], a[132:135]
    s_waitcnt lgkmcnt(2)
    v_mfma_f32_16x16x32_bf16 a[192:195], v[64:67], v[72:75], a[192:195]
    v_mfma_f32_16x16x32_bf16 a[224:227], v[68:71], v[72:75], a[224:227]
    s_xor_b32 m0, s44, 19456
    v_mfma_f32_16x16x32_bf16 a[228:231], v[68:71], v[76:79], a[228:231]
    buffer_load_dwordx4 v5, s[8:11], s23 offen lds
    v_mfma_f32_16x16x32_bf16 a[196:199], v[64:67], v[76:79], a[196:199]
    s_add_u32 s23, s23, 128
    s_waitcnt lgkmcnt(1)
    v_mfma_f32_16x16x32_bf16 a[8:11], v[40:43], v[80:83], a[8:11]
    s_cmp_ge_u32 s44, 98304
    s_cselect_b32 s60, s6, s7
    v_mfma_f32_16x16x32_bf16 a[40:43], v[44:47], v[80:83], a[40:43]
    s_add_u32 s44, s44, s60
    s_waitcnt lgkmcnt(0)
    v_mfma_f32_16x16x32_bf16 a[44:47], v[44:47], v[84:87], a[44:47]
    ds_read_b128 v[72:75], v15 offset:8192
    v_add_u32 v12, s46, v12
    v_mfma_f32_16x16x32_bf16 a[12:15], v[40:43], v[84:87], a[12:15]
    v_add_u32 v13, s46, v13
    v_add_u32 v14, s47, v14
    v_mfma_f32_16x16x32_bf16 a[72:75], v[48:51], v[80:83], a[72:75]
    ds_read_b128 v[76:79], v15 offset:10240
    s_xor_b32 m0, s45, 2048
    v_mfma_f32_16x16x32_bf16 a[104:107], v[52:55], v[80:83], a[104:107]
    buffer_load_dwordx4 v6, s[12:15], s25 offen lds
    v_mfma_f32_16x16x32_bf16 a[108:111], v[52:55], v[84:87], a[108:111]
    v_mfma_f32_16x16x32_bf16 a[76:79], v[48:51], v[84:87], a[76:79]
    v_mfma_f32_16x16x32_bf16 a[136:139], v[56:59], v[80:83], a[136:139]
    s_xor_b32 m0, s45, 3072
    v_mfma_f32_16x16x32_bf16 a[168:171], v[60:63], v[80:83], a[168:171]
    buffer_load_dwordx4 v7, s[12:15], s25 offen lds
    v_mfma_f32_16x16x32_bf16 a[172:175], v[60:63], v[84:87], a[172:175]
    s_add_u32 s25, s25, s28
    v_mfma_f32_16x16x32_bf16 a[140:143], v[56:59], v[84:87], a[140:143]
    v_mfma_f32_16x16x32_bf16 a[200:203], v[64:67], v[80:83], a[200:203]
    s_xor_b32 m0, s45, 16384
    v_mfma_f32_16x16x32_bf16 a[232:235], v[68:71], v[80:83], a[232:235]
    buffer_load_dwordx4 v6, s[12:15], s26 offen lds
    v_mfma_f32_16x16x32_bf16 a[236:239], v[68:71], v[84:87], a[236:239]
    v_mfma_f32_16x16x32_bf16 a[204:207], v[64:67], v[84:87], a[204:207]
    s_waitcnt lgkmcnt(1)
    v_mfma_f32_16x16x32_bf16 a[16:19], v[40:43], v[72:75], a[16:19]
    s_xor_b32 m0, s45, 17408
    v_mfma_f32_16x16x32_bf16 a[48:51], v[44:47], v[72:75], a[48:51]
    buffer_load_dwordx4 v7, s[12:15], s26 offen lds
    s_waitcnt lgkmcnt(0)
    v_mfma_f32_16x16x32_bf16 a[52:55], v[44:47], v[76:79], a[52:55]
    ds_read_b128 v[80:83], v15 offset:12288
    s_add_u32 s26, s26, s28
    v_mfma_f32_16x16x32_bf16 a[20:23], v[40:43], v[76:79], a[20:23]
    v_mfma_f32_16x16x32_bf16 a[80:83], v[48:51], v[72:75], a[80:83]
    ds_read_b128 v[84:87], v15 offset:14336
    s_xor_b32 m0, s45, 18432
    v_mfma_f32_16x16x32_bf16 a[112:115], v[52:55], v[72:75], a[112:115]
    buffer_load_dwordx4 v6, s[12:15], s27 offen lds
    v_mfma_f32_16x16x32_bf16 a[116:119], v[52:55], v[76:79], a[116:119]
    v_mfma_f32_16x16x32_bf16 a[84:87], v[48:51], v[76:79], a[84:87]
    s_xor_b32 m0, s45, 19456
    v_mfma_f32_16x16x32_bf16 a[144:147], v[56:59], v[72:75], a[144:147]
    buffer_load_dwordx4 v7, s[12:15], s27 offen lds
    v_mfma_f32_16x16x32_bf16 a[176:179], v[60:63], v[72:75], a[176:179]
    s_add_u32 s27, s27, s28
    s_cmp_ge_u32 s45, 98304
    v_mfma_f32_16x16x32_bf16 a[180:183], v[60:63], v[76:79], a[180:183]
    s_cselect_b32 s60, s6, s7
    s_add_u32 s45, s45, s60
    v_mfma_f32_16x16x32_bf16 a[148:151], v[56:59], v[76:79], a[148:151]
    v_add_u32 v15, s47, v15
    v_mfma_f32_16x16x32_bf16 a[208:211], v[64:67], v[72:75], a[208:211]
    s_add_u32 s43, s43, 1
    s_cmp_eq_u32 s43, 16
    v_mfma_f32_16x16x32_bf16 a[240:243], v[68:71], v[72:75], a[240:243]
    v_mfma_f32_16x16x32_bf16 a[244:247], v[68:71], v[76:79], a[244:247]
    v_mfma_f32_16x16x32_bf16 a[212:215], v[64:67], v[76:79], a[212:215]
    s_waitcnt vmcnt(6) lgkmcnt(0)
    s_barrier
    s_cbranch_scc1 t_g1_last
    v_mfma_f32_16x16x32_bf16 a[24:27], v[40:43], v[80:83], a[24:27]
    ds_read_b128 v[72:75], v14 offset:0
    v_mfma_f32_16x16x32_bf16 a[56:59], v[44:47], v[80:83], a[56:59]
    ds_read_b128 v[76:79], v14 offset:2048
    v_mfma_f32_16x16x32_bf16 a[60:63], v[44:47], v[84:87], a[60:63]
    ds_read_b128 v[44:47], v12 offset:2048
    v_mfma_f32_16x16x32_bf16 a[28:31], v[40:43], v[84:87], a[28:31]
    ds_read_b128 v[40:43], v12 offset:0
    v_mfma_f32_16x16x32_bf16 a[88:91], v[48:51], v[80:83], a[88:91]
    v_mfma_f32_16x16x32_bf16 a[120:123], v[52:55], v[80:83], a[120:123]
    v_mfma_f32_16x16x32_bf16 a[124:127], v[52:55], v[84:87], a[124:127]
    ds_read_b128 v[52:55], v12 offset:6144
    v_mfma_f32_16x16x32_bf16 a[92:95], v[48:51], v[84:87], a[92:95]
    ds_read_b128 v[48:51], v12 offset:4096
    v_mfma_f32_16x16x32_bf16 a[152:155], v[56:59], v[80:83], a[152:155]
    v_mfma_f32_16x16x32_bf16 a[184:187], v[60:63], v[80:83], a[184:187]
    v_mfma_f32_16x16x32_bf16 a[188:191], v[60:63], v[84:87], a[188:191]
    ds_read_b128 v[60:63], v12 offset:10240
    v_mfma_f32_16x16x32_bf16 a[156:159], v[56:59], v[84:87], a[156:159]
    ds_read_b128 v[56:59], v12 offset:8192
    v_mfma_f32_16x16x32_bf16 a[216:219], v[64:67], v[80:83], a[216:219]
    s_sub_u32 s61, s43, 10
    s_cmp_lt_u32 s61, 3
    v_mfma_f32_16x16x32_bf16 a[248:251], v[68:71], v[80:83], a[248:251]
    v_mfma_f32_16x16x32_bf16 a[252:255], v[68:71], v[84:87], a[252:255]
    ds_read_b128 v[68:71], v12 offset:14336
    v_mfma_f32_16x16x32_bf16 a[220:223], v[64:67], v[84:87], a[220:223]
    ds_read_b128 v[64:67], v12 offset:12288
    s_cbranch_scc1 t_g1_a
    s_branch t_g1_hook
t_g1_last:
    v_mfma_f32_16x16x32_bf16 a[24:27], v[40:43], v[80:83], a[24:27]
    v_mfma_f32_16x16x32_bf16 a[56:59], v[44:47], v[80:83], a[56:59]
    v_mfma_f32_16x16x32_bf16 a[60:63], v[44:47], v[84:87], a[60:63]
    v_mfma_f32_16x16x32_bf16 a[28:31], v[40:43], v[84:87], a[28:31]
    v_mfma_f32_16x16x32_bf16 a[88:91], v[48:51], v[80:83], a[88:91]
    v_mfma_f32_16x16x32_bf16 a[120:123], v[52:55], v[80:83], a[120:123]
    v_mfma_f32_16x16x32_bf16 a[124:127], v[52:55], v[84:87], a[124:127]
    v_mfma_f32_16x16x32_bf16 a[92:95], v[48:51], v[84:87], a[92:95]
    v_mfma_f32_16x16x32_bf16 a[152:155], v[56:59], v[80:83], a[152:155]
    v_mfma_f32_16x16x32_bf16 a[184:187], v[60:63], v[80:83], a[184:187]
    v_mfma_f32_16x16x32_bf16 a[188:191], v[60:63], v[84:87], a[188:191]
    v_mfma_f32_16x16x32_bf16 a[156:159], v[56:59], v[84:87], a[156:159]
    v_mfma_f32_16x16x32_bf16 a[216:219], v[64:67], v[80:83], a[216:219]
    v_mfma_f32_16x16x32_bf16 a[248:251], v[68:71], v[80:83], a[248:251]
    v_mfma_f32_16x16x32_bf16 a[252:255], v[68:71], v[84:87], a[252:255]
    v_mfma_f32_16x16x32_bf16 a[220:223], v[64:67], v[84:87], a[220:223]
    s_setpc_b64 s[54:55]
t_scan:
    s_nop 7
    v_accvgpr_read_b32 v40, a0
    v_accvgpr_read_b32 v42, a4
    v_accvgpr_read_b32 v44, a8
    v_accvgpr_read_b32 v46, a12
    v_accvgpr_read_b32 v41, a16
    v_accvgpr_read_b32 v43, a20
    v_accvgpr_read_b32 v45, a24
    v_accvgpr_read_b32 v47, a28
    v_accvgpr_read_b32 v48, a1
    v_accvgpr_read_b32 v50, a5
    v_accvgpr_read_b32 v52, a9
    v_accvgpr_read_b32 v54, a13
    v_accvgpr_read_b32 v49, a17
    v_accvgpr_read_b32 v51, a21
    v_accvgpr_read_b32 v53, a25
    v_accvgpr_read_b32 v55, a29
    v_pk_fma_f32 v[56:57], v[88:89], v[40:41], v[48:49] op_sel:[0,0,0] op_sel_hi:[0,1,1]
    v_pk_fma_f32 v[58:59], v[90:91], v[42:43], v[50:51] op_sel:[0,0,0] op_sel_hi:[0,1,1]
    v_pk_fma_f32 v[60:61], v[92:93], v[44:45], v[52:53] op_sel:[0,0,0] op_sel_hi:[0,1,1]
    v_pk_fma_f32 v[62:63], v[94:95], v[46:47], v[54:55] op_sel:[0,0,0] op_sel_hi:[0,1,1]
    v_pk_fma_f32 v[40:41], v[88:89], v[40:41], v[56:57] op_sel:[1,1,0] op_sel_hi:[1,0,1] neg_lo:[1,0,0]
    v_pk_fma_f32 v[42:43], v[90:91], v[42:43], v[58:59] op_sel:[1,1,0] op_sel_hi:[1,0,1] neg_lo:[1,0,0]
    v_pk_fma_f32 v[44:45], v[92:93], v[44:45], v[60:61] op_sel:[1,1,0] op_sel_hi:[1,0,1] neg_lo:[1,0,0]
    v_pk_fma_f32 v[46:47], v[94:95], v[46:47], v[62:63] op_sel:[1,1,0] op_sel_hi:[1,0,1] neg_lo:[1,0,0]
    v_accvgpr_read_b32 v64, a2
    v_accvgpr_read_b32 v66, a6
    v_accvgpr_read_b32 v68, a10
    v_accvgpr_read_b32 v70, a14
    v_accvgpr_read_b32 v65, a18
    v_accvgpr_read_b32 v67, a22
    v_accvgpr_read_b32 v69, a26
    v_accvgpr_read_b32 v71, a30
    v_pk_fma_f32 v[56:57], v[88:89], v[40:41], v[64:65] op_sel:[0,0,0] op_sel_hi:[0,1,1]
    v_pk_fma_f32 v[58:59], v[90:91], v[42:43], v[66:67] op_sel:[0,0,0] op_sel_hi:[0,1,1]
    v_pk_fma_f32 v[60:61], v[92:93], v[44:45], v[68:69] op_sel:[0,0,0] op_sel_hi:[0,1,1]
    v_pk_fma_f32 v[62:63], v[94:95], v[46:47], v[70:71] op_sel:[0,0,0] op_sel_hi:[0,1,1]
    v_pk_fma_f32 v[40:41], v[88:89], v[40:41], v[56:57] op_sel:[1,1,0] op_sel_hi:[1,0,1] neg_lo:[1,0,0]
    v_pk_fma_f32 v[42:43], v[90:91], v[42:43], v[58:59] op_sel:[1,1,0] op_sel_hi:[1,0,1] neg_lo:[1,0,0]
    v_pk_fma_f32 v[44:45], v[92:93], v[44:45], v[60:61] op_sel:[1,1,0] op_sel_hi:[1,0,1] neg_lo:[1,0,0]
    v_pk_fma_f32 v[46:47], v[94:95], v[46:47], v[62:63] op_sel:[1,1,0] op_sel_hi:[1,0,1] neg_lo:[1,0,0]
    v_accvgpr_read_b32 v48, a3
    v_accvgpr_read_b32 v50, a7
    v_accvgpr_read_b32 v52, a11
    v_accvgpr_read_b32 v54, a15
    v_accvgpr_read_b32 v49, a19
    v_accvgpr_read_b32 v51, a23
    v_accvgpr_read_b32 v53, a27
    v_accvgpr_read_b32 v55, a31
    v_pk_fma_f32 v[56:57], v[88:89], v[40:41], v[48:49] op_sel:[0,0,0] op_sel_hi:[0,1,1]
    v_pk_fma_f32 v[58:59], v[90:91], v[42:43], v[50:51] op_sel:[0,0,0] op_sel_hi:[0,1,1]
    v_pk_fma_f32 v[60:61], v[92:93], v[44:45], v[52:53] op_sel:[0,0,0] op_sel_hi:[0,1,1]
    v_pk_fma_f32 v[62:63], v[94:95], v[46:47], v[54:55] op_sel:[0,0,0] op_sel_hi:[0,1,1]
    v_pk_fma_f32 v[40:41], v[88:89], v[40:41], v[56:57] op_sel:[1,1,0] op_sel_hi:[1,0,1] neg_lo:[1,0,0]
    v_pk_fma_f32 v[42:43], v[90:91], v[42:43], v[58:59] op_sel:[1,1,0] op_sel_hi:[1,0,1] neg_lo:[1,0,0]
    v_pk_fma_f32 v[44:45], v[92:93], v[44:45], v[60:61] op_sel:[1,1,0] op_sel_hi:[1,0,1] neg_lo:[1,0,0]
    v_pk_fma_f32 v[46:47], v[94:95], v[46:47], v[62:63] op_sel:[1,1,0] op_sel_hi:[1,0,1] neg_lo:[1,0,0]
    v_accvgpr_read_b32 v64, a32
    v_accvgpr_read_b32 v66, a36
    v_accvgpr_read_b32 v68, a40
    v_accvgpr_read_b32 v70, a44
    v_accvgpr_read_b32 v65, a48
    v_accvgpr_read_b32 v67, a52
    v_accvgpr_read_b32 v69, a56
    v_accvgpr_read_b32 v71, a60
    v_pk_fma_f32 v[56:57], v[88:89], v[40:41], v[64:65] op_sel:[0,0,0] op_sel_hi:[0,1,1]
    v_pk_fma_f32 v[58:59], v[90:91], v[42:43], v[66:67] op_sel:[0,0,0] op_sel_hi:[0,1,1]
    v_pk_fma_f32 v[60:61], v[92:93], v[44:45], v[68:69] op_sel:[0,0,0] op_sel_hi:[0,1,1]
    v_pk_fma_f32 v[62:63], v[94:95], v[46:47], v[70:71] op_sel:[0,0,0] op_sel_hi:[0,1,1]
    v_pk_fma_f32 v[40:41], v[88:89], v[40:41], v[56:57] op_sel:[1,1,0] op_sel_hi:[1,0,1] neg_lo:[1,0,0]
    v_pk_fma_f32 v[42:43], v[90:91], v[42:43], v[58:59] op_sel:[1,1,0] op_sel_hi:[1,0,1] neg_lo:[1,0,0]
    v_pk_fma_f32 v[44:45], v[92:93], v[44:45], v[60:61] op_sel:[1,1,0] op_sel_hi:[1,0,1] neg_lo:[1,0,0]
    v_pk_fma_f32 v[46:47], v[94:95], v[46:47], v[62:63] op_sel:[1,1,0] op_sel_hi:[1,0,1] neg_lo:[1,0,0]
    v_accvgpr_read_b32 v48, a33
    v_accvgpr_read_b32 v50, a37
    v_accvgpr_read_b32 v52, a41
    v_accvgpr_read_b32 v54, a45
    v_accvgpr_read_b32 v49, a49
    v_accvgpr_read_b32 v51, a53
    v_accvgpr_read_b32 v53, a57
    v_accvgpr_read_b32 v55, a61
    v_pk_fma_f32 v[56:57], v[88:89], v[40:41], v[48:49] op_sel:[0,0,0] op_sel_hi:[0,1,1]
    v_pk_fma_f32 v[58:59], v[90:91], v[42:43], v[50:51] op_sel:[0,0,0] op_sel_hi:[0,1,1]
    v_pk_fma_f32 v[60:61], v[92:93], v[44:45], v[52:53] op_sel:[0,0,0] op_sel_hi:[0,1,1]
    v_pk_fma_f32 v[62:63], v[94:95], v[46:47], v[54:55] op_sel:[0,0,0] op_sel_hi:[0,1,1]
    v_pk_fma_f32 v[40:41], v[88:89], v[40:41], v[56:57] op_sel:[1,1,0] op_sel_hi:[1,0,1] neg_lo:[1,0,0]
    v_pk_fma_f32 v[42:43], v[90:91], v[42:43], v[58:59] op_sel:[1,1,0] op_sel_hi:[1,0,1] neg_lo:[1,0,0]
    v_pk_fma_f32 v[44:45], v[92:93], v[44:45], v[60:61] op_sel:[1,1,0] op_sel_hi:[1,0,1] neg_lo:[1,0,0]
    v_pk_fma_f32 v[46:47], v[94:95], v[46:47], v[62:63] op_sel:[1,1,0] op_sel_hi:[1,0,1] neg_lo:[1,0,0]
    v_accvgpr_read_b32 v64, a34
    v_accvgpr_read_b32 v66, a38
    v_accvgpr_read_b32 v68, a42
    v_accvgpr_read_b32 v70, a46
    v_accvgpr_read_b32 v65, a50
    v_accvgpr_read_b32 v67, a54
    v_accvgpr_read_b32 v69, a58
    v_accvgpr_read_b32 v71, a62
    v_pk_fma_f32 v[56:57], v[88:89], v[40:41], v[64:65] op_sel:[0,0,0] op_sel_hi:[0,1,1]
    v_pk_fma_f32 v[58:59], v[90:91], v[42:43], v[66:67] op_sel:[0,0,0] op_sel_hi:[0,1,1]
    v_pk_fma_f32 v[60:61], v[92:93], v[44:45], v[68:69] op_sel:[0,0,0] op_sel_hi:[0,1,1]
    v_pk_fma_f32 v[62:63], v[94:95], v[46:47], v[70:71] op_sel:[0,0,0] op_sel_hi:[0,1,1]
    v_pk_fma_f32 v[40:41], v[88:89], v[40:41], v[56:57] op_sel:[1,1,0] op_sel_hi:[1,0,1] neg_lo:[1,0,0]
    v_pk_fma_f32 v[42:43], v[90:91], v[42:43], v[58:59] op_sel:[1,1,0] op_sel_hi:[1,0,1] neg_lo:[1,0,0]
    v_pk_fma_f32 v[44:45], v[92:93], v[44:45], v[60:61] op_sel:[1,1,0] op_sel_hi:[1,0,1] neg_lo:[1,0,0]
    v_pk_fma_f32 v[46:47], v[94:95], v[46:47], v[62:63] op_sel:[1,1,0] op_sel_hi:[1,0,1] neg_lo:[1,0,0]
    v_accvgpr_read_b32 v48, a35
    v_accvgpr_read_b32 v50, a39
    v_accvgpr_read_b32 v52, a43
    v_accvgpr_read_b32 v54, a47
    v_accvgpr_read_b32 v49, a51
    v_accvgpr_read_b32 v51, a55
    v_accvgpr_read_b32 v53, a59
    v_accvgpr_read_b32 v55, a63
    v_pk_fma_f32 v[56:57], v[88:89], v[40:41], v[48:49] op_sel:[0,0,0] op_sel_hi:[0,1,1]
    v_pk_fma_f32 v[58:59], v[90:91], v[42:43], v[50:51] op_sel:[0,0,0] op_sel_hi:[0,1,1]
    v_pk_fma_f32 v[60:61], v[92:93], v[44:45], v[52:53] op_sel:[0,0,0] op_sel_hi:[0,1,1]
    v_pk_fma_f32 v[62:63], v[94:95], v[46:47], v[54:55] op_sel:[0,0,0] op_sel_hi:[0,1,1]
    v_pk_fma_f32 v[40:41], v[88:89], v[40:41], v[56:57] op_sel:[1,1,0] op_sel_hi:[1,0,1] neg_lo:[1,0,0]
    v_pk_fma_f32 v[42:43], v[90:91], v[42:43], v[58:59] op_sel:[1,1,0] op_sel_hi:[1,0,1] neg_lo:[1,0,0]
    v_pk_fma_f32 v[44:45], v[92:93], v[44:45], v[60:61] op_sel:[1,1,0] op_sel_hi:[1,0,1] neg_lo:[1,0,0]
    v_pk_fma_f32 v[46:47], v[94:95], v[46:47], v[62:63] op_sel:[1,1,0] op_sel_hi:[1,0,1] neg_lo:[1,0,0]
    v_accvgpr_read_b32 v64, a64
    v_accvgpr_read_b32 v66, a68
    v_accvgpr_read_b32 v68, a72
    v_accvgpr_read_b32 v70, a76
    v_accvgpr_read_b32 v65, a80
    v_accvgpr_read_b32 v67, a84
    v_accvgpr_read_b32 v69, a88
    v_accvgpr_read_b32 v71, a92
    v_pk_fma_f32 v[56:57], v[88:89], v[40:41], v[64:65] op_sel:[0,0,0] op_sel_hi:[0,1,1]
    v_pk_fma_f32 v[58:59], v[90:91], v[42:43], v[66:67] op_sel:[0,0,0] op_sel_hi:[0,1,1]
    v_pk_fma_f32 v[60:61], v[92:93], v[44:45], v[68:69] op_sel:[0,0,0] op_sel_hi:[0,1,1]
    v_pk_fma_f32 v[62:63], v[94:95], v[46:47], v[70:71] op_sel:[0,0,0] op_sel_hi:[0,1,1]
    v_pk_fma_f32 v[40:41], v[88:89], v[40:41], v[56:57] op_sel:[1,1,0] op_sel_hi:[1,0,1] neg_lo:[1,0,0]
    v_pk_fma_f32 v[42:43], v[90:91], v[42:43], v[58:59] op_sel:[1,1,0] op_sel_hi:[1,0,1] neg_lo:[1,0,0]
    v_pk_fma_f32 v[44:45], v[92:93], v[44:45], v[60:61] op_sel:[1,1,0] op_sel_hi:[1,0,1] neg_lo:[1,0,0]
    v_pk_fma_f32 v[46:47], v[94:95], v[46:47], v[62:63] op_sel:[1,1,0] op_sel_hi:[1,0,1] neg_lo:[1,0,0]
    v_accvgpr_read_b32 v48, a65
    v_accvgpr_read_b32 v50, a69
    v_accvgpr_read_b32 v52, a73
    v_accvgpr_read_b32 v54, a77
    v_accvgpr_read_b32 v49, a81
    v_accvgpr_read_b32 v51, a85
    v_accvgpr_read_b32 v53, a89
    v_accvgpr_read_b32 v55, a93
    v_pk_fma_f32 v[56:57], v[88:89], v[40:41], v[48:49] op_sel:[0,0,0] op_sel_hi:[0,1,1]
    v_pk_fma_f32 v[58:59], v[90:91], v[42:43], v[50:51] op_sel:[0,0,0] op_sel_hi:[0,1,1]
    v_pk_fma_f32 v[60:61], v[92:93], v[44:45], v[52:53] op_sel:[0,0,0] op_sel_hi:[0,1,1]
    v_pk_fma_f32 v[62:63], v[94:95], v[46:47], v[54:55] op_sel:[0,0,0] op_sel_hi:[0,1,1]
    v_pk_fma_f32 v[40:41], v[88:89], v[40:41], v[56:57] op_sel:[1,1,0] op_sel_hi:[1,0,1] neg_lo:[1,0,0]
    v_pk_fma_f32 v[42:43], v[90:91], v[42:43], v[58:59] op_sel:[1,1,0] op_sel_hi:[1,0,1] neg_lo:[1,0,0]
    v_pk_fma_f32 v[44:45], v[92:93], v[44:45], v[60:61] op_sel:[1,1,0] op_sel_hi:[1,0,1] neg_lo:[1,0,0]
    v_pk_fma_f32 v[46:47], v[94:95], v[46:47], v[62:63] op_sel:[1,1,0] op_sel_hi:[1,0,1] neg_lo:[1,0,0]
    v_accvgpr_read_b32 v64, a66
    v_accvgpr_read_b32 v66, a70
    v_accvgpr_read_b32 v68, a74
    v_accvgpr_read_b32 v70, a78
    v_accvgpr_read_b32 v65, a82
    v_accvgpr_read_b32 v67, a86
    v_accvgpr_read_b32 v69, a90
    v_accvgpr_read_b32 v71, a94
    v_pk_fma_f32 v[56:57], v[88:89], v[40:41], v[64:65] op_sel:[0,0,0] op_sel_hi:[0,1,1]
    v_pk_fma_f32 v[58:59], v[90:91], v[42:43], v[66:67] op_sel:[0,0,0] op_sel_hi:[0,1,1]
    v_pk_fma_f32 v[60:61], v[92:93], v[44:45], v[68:69] op_sel:[0,0,0] op_sel_hi:[0,1,1]
    v_pk_fma_f32 v[62:63], v[94:95], v[46:47], v[70:71] op_sel:[0,0,0] op_sel_hi:[0,1,1]
    v_pk_fma_f32 v[40:41], v[88:89], v[40:41], v[56:57] op_sel:[1,1,0] op_sel_hi:[1,0,1] neg_lo:[1,0,0]
    v_pk_fma_f32 v[42:43], v[90:91], v[42:43], v[58:59] op_sel:[1,1,0] op_sel_hi:[1,0,1] neg_lo:[1,0,0]
    v_pk_fma_f32 v[44:45], v[92:93], v[44:45], v[60:61] op_sel:[1,1,0] op_sel_hi:[1,0,1] neg_lo:[1,0,0]
    v_pk_fma_f32 v[46:47], v[94:95], v[46:47], v[62:63] op_sel:[1,1,0] op_sel_hi:[1,0,1] neg_lo:[1,0,0]
    v_accvgpr_read_b32 v48, a67
    v_accvgpr_read_b32 v50, a71
    v_accvgpr_read_b32 v52, a75
    v_accvgpr_read_b32 v54, a79
    v_accvgpr_read_b32 v49, a83
    v_accvgpr_read_b32 v51, a87
    v_accvgpr_read_b32 v53, a91
    v_accvgpr_read_b32 v55, a95
    v_pk_fma_f32 v[56:57], v[88:89], v[40:41], v[48:49] op_sel:[0,0,0] op_sel_hi:[0,1,1]
    v_pk_fma_f32 v[58:59], v[90:91], v[42:43], v[50:51] op_sel:[0,0,0] op_sel_hi:[0,1,1]
    v_pk_fma_f32 v[60:61], v[92:93], v[44:45], v[52:53] op_sel:[0,0,0] op_sel_hi:[0,1,1]
    v_pk_fma_f32 v[62:63], v[94:95], v[46:47], v[54:55] op_sel:[0,0,0] op_sel_hi:[0,1,1]
    v_pk_fma_f32 v[40:41], v[88:89], v[40:41], v[56:57] op_sel:[1,1,0] op_sel_hi:[1,0,1] neg_lo:[1,0,0]
    v_pk_fma_f32 v[42:43], v[90:91], v[42:43], v[58:59] op_sel:[1,1,0] op_sel_hi:[1,0,1] neg_lo:[1,0,0]
    v_pk_fma_f32 v[44:45], v[92:93], v[44:45], v[60:61] op_sel:[1,1,0] op_sel_hi:[1,0,1] neg_lo:[1,0,0]
    v_pk_fma_f32 v[46:47], v[94:95], v[46:47], v[62:63] op_sel:[1,1,0] op_sel_hi:[1,0,1] neg_lo:[1,0,0]
    v_accvgpr_read_b32 v64, a96
    v_accvgpr_read_b32 v66, a100
    v_accvgpr_read_b32 v68, a104
    v_accvgpr_read_b32 v70, a108
    v_accvgpr_read_b32 v65, a112
    v_accvgpr_read_b32 v67, a116
    v_accvgpr_read_b32 v69, a120
    v_accvgpr_read_b32 v71, a124
    v_pk_fma_f32 v[56:57], v[88:89], v[40:41], v[64:65] op_sel:[0,0,0] op_sel_hi:[0,1,1]
    v_pk_fma_f32 v[58:59], v[90:91], v[42:43], v[66:67] op_sel:[0,0,0] op_sel_hi:[0,1,1]
    v_pk_fma_f32 v[60:61], v[92:93], v[44:45], v[68:69] op_sel:[0,0,0] op_sel_hi:[0,1,1]
    v_pk_fma_f32 v[62:63], v[94:95], v[46:47], v[70:71] op_sel:[0,0,0] op_sel_hi:[0,1,1]
    v_pk_fma_f32 v[40:41], v[88:89], v[40:41], v[56:57] op_sel:[1,1,0] op_sel_hi:[1,0,1] neg_lo:[1,0,0]
    v_pk_fma_f32 v[42:43], v[90:91], v[42:43], v[58:59] op_sel:[1,1,0] op_sel_hi:[1,0,1] neg_lo:[1,0,0]
    v_pk_fma_f32 v[44:45], v[92:93], v[44:45], v[60:61] op_sel:[1,1,0] op_sel_hi:[1,0,1] neg_lo:[1,0,0]
    v_pk_fma_f32 v[46:47], v[94:95], v[46:47], v[62:63] op_sel:[1,1,0] op_sel_hi:[1,0,1] neg_lo:[1,0,0]
    v_accvgpr_read_b32 v48, a97
    v_accvgpr_read_b32 v50, a101
    v_accvgpr_read_b32 v52, a105
    v_accvgpr_read_b32 v54, a109
    v_accvgpr_read_b32 v49, a113
    v_accvgpr_read_b32 v51, a117
    v_accvgpr_read_b32 v53, a121
    v_accvgpr_read_b32 v55, a125
    v_pk_fma_f32 v[56:57], v[88:89], v[40:41], v[48:49] op_sel:[0,0,0] op_sel_hi:[0,1,1]
    v_pk_fma_f32 v[58:59], v[90:91], v[42:43], v[50:51] op_sel:[0,0,0] op_sel_hi:[0,1,1]
    v_pk_fma_f32 v[60:61], v[92:93], v[44:45], v[52:53] op_sel:[0,0,0] op_sel_hi:[0,1,1]
    v_pk_fma_f32 v[62:63], v[94:95], v[46:47], v[54:55] op_sel:[0,0,0] op_sel_hi:[0,1,1]
    v_pk_fma_f32 v[40:41], v[88:89], v[40:41], v[56:57] op_sel:[1,1,0] op_sel_hi:[1,0,1] neg_lo:[1,0,0]
    v_pk_fma_f32 v[42:43], v[90:91], v[42:43], v[58:59] op_sel:[1,1,0] op_sel_hi:[1,0,1] neg_lo:[1,0,0]
    v_pk_fma_f32 v[44:45], v[92:93], v[44:45], v[60:61] op_sel:[1,1,0] op_sel_hi:[1,0,1] neg_lo:[1,0,0]
    v_pk_fma_f32 v[46:47], v[94:95], v[46:47], v[62:63] op_sel:[1,1,0] op_sel_hi:[1,0,1] neg_lo:[1,0,0]
    v_accvgpr_read_b32 v64, a98
    v_accvgpr_read_b32 v66, a102
    v_accvgpr_read_b32 v68, a106
    v_accvgpr_read_b32 v70, a110
    v_accvgpr_read_b32 v65, a114
    v_accvgpr_read_b32 v67, a118
    v_accvgpr_read_b32 v69, a122
    v_accvgpr_read_b32 v71, a126
    v_pk_fma_f32 v[56:57], v[88:89], v[40:41], v[64:65] op_sel:[0,0,0] op_sel_hi:[0,1,1]
    v_pk_fma_f32 v[58:59], v[90:91], v[42:43], v[66:67] op_sel:[0,0,0] op_sel_hi:[0,1,1]
    v_pk_fma_f32 v[60:61], v[92:93], v[44:45], v[68:69] op_sel:[0,0,0] op_sel_hi:[0,1,1]
    v_pk_fma_f32 v[62:63], v[94:95], v[46:47], v[70:71] op_sel:[0,0,0] op_sel_hi:[0,1,1]
    v_pk_fma_f32 v[40:41], v[88:89], v[40:41], v[56:57] op_sel:[1,1,0] op_sel_hi:[1,0,1] neg_lo:[1,0,0]
    v_pk_fma_f32 v[42:43], v[90:91], v[42:43], v[58:59] op_sel:[1,1,0] op_sel_hi:[1,0,1] neg_lo:[1,0,0]
    v_pk_fma_f32 v[44:45], v[92:93], v[44:45], v[60:61] op_sel:[1,1,0] op_sel_hi:[1,0,1] neg_lo:[1,0,0]
    v_pk_fma_f32 v[46:47], v[94:95], v[46:47], v[62:63] op_sel:[1,1,0] op_sel_hi:[1,0,1] neg_lo:[1,0,0]
    v_accvgpr_read_b32 v48, a99
    v_accvgpr_read_b32 v50, a103
    v_accvgpr_read_b32 v52, a107
    v_accvgpr_read_b32 v54, a111
    v_accvgpr_read_b32 v49, a115
    v_accvgpr_read_b32 v51, a119
    v_accvgpr_read_b32 v53, a123
    v_accvgpr_read_b32 v55, a127
    v_pk_fma_f32 v[56:57], v[88:89], v[40:41], v[48:49] op_sel:[0,0,0] op_sel_hi:[0,1,1]
    v_pk_fma_f32 v[58:59], v[90:91], v[42:43], v[50:51] op_sel:[0,0,0] op_sel_hi:[0,1,1]
    v_pk_fma_f32 v[60:61], v[92:93], v[44:45], v[52:53] op_sel:[0,0,0] op_sel_hi:[0,1,1]
    v_pk_fma_f32 v[62:63], v[94:95], v[46:47], v[54:55] op_sel:[0,0,0] op_sel_hi:[0,1,1]
    v_pk_fma_f32 v[40:41], v[88:89], v[40:41], v[56:57] op_sel:[1,1,0] op_sel_hi:[1,0,1] neg_lo:[1,0,0]
    v_pk_fma_f32 v[42:43], v[90:91], v[42:43], v[58:59] op_sel:[1,1,0] op_sel_hi:[1,0,1] neg_lo:[1,0,0]
    v_pk_fma_f32 v[44:45], v[92:93], v[44:45], v[60:61] op_sel:[1,1,0] op_sel_hi:[1,0,1] neg_lo:[1,0,0]
    v_pk_fma_f32 v[46:47], v[94:95], v[46:47], v[62:63] op_sel:[1,1,0] op_sel_hi:[1,0,1] neg_lo:[1,0,0]
    v_accvgpr_read_b32 v64, a128
    v_accvgpr_read_b32 v66, a132
    v_accvgpr_read_b32 v68, a136
    v_accvgpr_read_b32 v70, a140
    v_accvgpr_read_b32 v65, a144
    v_accvgpr_read_b32 v67, a148
    v_accvgpr_read_b32 v69, a152
    v_accvgpr_read_b32 v71, a156
    v_pk_fma_f32 v[56:57], v[88:89], v[40:41], v[64:65] op_sel:[0,0,0] op_sel_hi:[0,1,1]
    v_pk_fma_f32 v[58:59], v[90:91], v[42:43], v[66:67] op_sel:[0,0,0] op_sel_hi:[0,1,1]
    v_pk_fma_f32 v[60:61], v[92:93], v[44:45], v[68:69] op_sel:[0,0,0] op_sel_hi:[0,1,1]
    v_pk_fma_f32 v[62:63], v[94:95], v[46:47], v[70:71] op_sel:[0,0,0] op_sel_hi:[0,1,1]
    v_pk_fma_f32 v[40:41], v[88:89], v[40:41], v[56:57] op_sel:[1,1,0] op_sel_hi:[1,0,1] neg_lo:[1,0,0]
    v_pk_fma_f32 v[42:43], v[90:91], v[42:43], v[58:59] op_sel:[1,1,0] op_sel_hi:[1,0,1] neg_lo:[1,0,0]
    v_pk_fma_f32 v[44:45], v[92:93], v[44:45], v[60:61] op_sel:[1,1,0] op_sel_hi:[1,0,1] neg_lo:[1,0,0]
    v_pk_fma_f32 v[46:47], v[94:95], v[46:47], v[62:63] op_sel:[1,1,0] op_sel_hi:[1,0,1] neg_lo:[1,0,0]
    v_accvgpr_read_b32 v48, a129
    v_accvgpr_read_b32 v50, a133
    v_accvgpr_read_b32 v52, a137
    v_accvgpr_read_b32 v54, a141
    v_accvgpr_read_b32 v49, a145
    v_accvgpr_read_b32 v51, a149
    v_accvgpr_read_b32 v53, a153
    v_accvgpr_read_b32 v55, a157
    v_pk_fma_f32 v[56:57], v[88:89], v[40:41], v[48:49] op_sel:[0,0,0] op_sel_hi:[0,1,1]
    v_pk_fma_f32 v[58:59], v[90:91], v[42:43], v[50:51] op_sel:[0,0,0] op_sel_hi:[0,1,1]
    v_pk_fma_f32 v[60:61], v[92:93], v[44:45], v[52:53] op_sel:[0,0,0] op_sel_hi:[0,1,1]
    v_pk_fma_f32 v[62:63], v[94:95], v[46:47], v[54:55] op_sel:[0,0,0] op_sel_hi:[0,1,1]
    v_pk_fma_f32 v[40:41], v[88:89], v[40:41], v[56:57] op_sel:[1,1,0] op_sel_hi:[1,0,1] neg_lo:[1,0,0]
    v_pk_fma_f32 v[42:43], v[90:91], v[42:43], v[58:59] op_sel:[1,1,0] op_sel_hi:[1,0,1] neg_lo:[1,0,0]
    v_pk_fma_f32 v[44:45], v[92:93], v[44:45], v[60:61] op_sel:[1,1,0] op_sel_hi:[1,0,1] neg_lo:[1,0,0]
    v_pk_fma_f32 v[46:47], v[94:95], v[46:47], v[62:63] op_sel:[1,1,0] op_sel_hi:[1,0,1] neg_lo:[1,0,0]
    v_accvgpr_read_b32 v64, a130
    v_accvgpr_read_b32 v66, a134
    v_accvgpr_read_b32 v68, a138
    v_accvgpr_read_b32 v70, a142
    v_accvgpr_read_b32 v65, a146
    v_accvgpr_read_b32 v67, a150
    v_accvgpr_read_b32 v69, a154
    v_accvgpr_read_b32 v71, a158
    v_pk_fma_f32 v[56:57], v[88:89], v[40:41], v[64:65] op_sel:[0,0,0] op_sel_hi:[0,1,1]
    v_pk_fma_f32 v[58:59], v[90:91], v[42:43], v[66:67] op_sel:[0,0,0] op_sel_hi:[0,1,1]
    v_pk_fma_f32 v[60:61], v[92:93], v[44:45], v[68:69] op_sel:[0,0,0] op_sel_hi:[0,1,1]
    v_pk_fma_f32 v[62:63], v[94:95], v[46:47], v[70:71] op_sel:[0,0,0] op_sel_hi:[0,1,1]
    v_pk_fma_f32 v[40:41], v[88:89], v[40:41], v[56:57] op_sel:[1,1,0] op_sel_hi:[1,0,1] neg_lo:[1,0,0]
    v_pk_fma_f32 v[42:43], v[90:91], v[42:43], v[58:59] op_sel:[1,1,0] op_sel_hi:[1,0,1] neg_lo:[1,0,0]
    v_pk_fma_f32 v[44:45], v[92:93], v[44:45], v[60:61] op_sel:[1,1,0] op_sel_hi:[1,0,1] neg_lo:[1,0,0]
    v_pk_fma_f32 v[46:47], v[94:95], v[46:47], v[62:63] op_sel:[1,1,0] op_sel_hi:[1,0,1] neg_lo:[1,0,0]
    v_accvgpr_read_b32 v48, a131
    v_accvgpr_read_b32 v50, a135
    v_accvgpr_read_b32 v52, a139
    v_accvgpr_read_b32 v54, a143
    v_accvgpr_read_b32 v49, a147
    v_accvgpr_read_b32 v51, a151
    v_accvgpr_read_b32 v53, a155
    v_accvgpr_read_b32 v55, a159
    v_pk_fma_f32 v[56:57], v[88:89], v[40:41], v[48:49] op_sel:[0,0,0] op_sel_hi:[0,1,1]
    v_pk_fma_f32 v[58:59], v[90:91], v[42:43], v[50:51] op_sel:[0,0,0] op_sel_hi:[0,1,1]
    v_pk_fma_f32 v[60:61], v[92:93], v[44:45], v[52:53] op_sel:[0,0,0] op_sel_hi:[0,1,1]
    v_pk_fma_f32 v[62:63], v[94:95], v[46:47], v[54:55] op_sel:[0,0,0] op_sel_hi:[0,1,1]
    v_pk_fma_f32 v[40:41], v[88:89], v[40:41], v[56:57] op_sel:[1,1,0] op_sel_hi:[1,0,1] neg_lo:[1,0,0]
    v_pk_fma_f32 v[42:43], v[90:91], v[42:43], v[58:59] op_sel:[1,1,0] op_sel_hi:[1,0,1] neg_lo:[1,0,0]
    v_pk_fma_f32 v[44:45], v[92:93], v[44:45], v[60:61] op_sel:[1,1,0] op_sel_hi:[1,0,1] neg_lo:[1,0,0]
    v_pk_fma_f32 v[46:47], v[94:95], v[46:47], v[62:63] op_sel:[1,1,0] op_sel_hi:[1,0,1] neg_lo:[1,0,0]
    v_accvgpr_read_b32 v64, a160
    v_accvgpr_read_b32 v66, a164
    v_accvgpr_read_b32 v68, a168
    v_accvgpr_read_b32 v70, a172
    v_accvgpr_read_b32 v65, a176
    v_accvgpr_read_b32 v67, a180
    v_accvgpr_read_b32 v69, a184
    v_accvgpr_read_b32 v71, a188
    v_pk_fma_f32 v[56:57], v[88:89], v[40:41], v[64:65] op_sel:[0,0,0] op_sel_hi:[0,1,1]
    v_pk_fma_f32 v[58:59], v[90:91], v[42:43], v[66:67] op_sel:[0,0,0] op_sel_hi:[0,1,1]
    v_pk_fma_f32 v[60:61], v[92:93], v[44:45], v[68:69] op_sel:[0,0,0] op_sel_hi:[0,1,1]
    v_pk_fma_f32 v[62:63], v[94:95], v[46:47], v[70:71] op_sel:[0,0,0] op_sel_hi:[0,1,1]
    v_pk_fma_f32 v[40:41], v[88:89], v[40:41], v[56:57] op_sel:[1,1,0] op_sel_hi:[1,0,1] neg_lo:[1,0,0]
    v_pk_fma_f32 v[42:43], v[90:91], v[42:43], v[58:59] op_sel:[1,1,0] op_sel_hi:[1,0,1] neg_lo:[1,0,0]
    v_pk_fma_f32 v[44:45], v[92:93], v[44:45], v[60:61] op_sel:[1,1,0] op_sel_hi:[1,0,1] neg_lo:[1,0,0]
    v_pk_fma_f32 v[46:47], v[94:95], v[46:47], v[62:63] op_sel:[1,1,0] op_sel_hi:[1,0,1] neg_lo:[1,0,0]
    v_accvgpr_read_b32 v48, a161
    v_accvgpr_read_b32 v50, a165
    v_accvgpr_read_b32 v52, a169
    v_accvgpr_read_b32 v54, a173
    v_accvgpr_read_b32 v49, a177
    v_accvgpr_read_b32 v51, a181
    v_accvgpr_read_b32 v53, a185
    v_accvgpr_read_b32 v55, a189
    v_pk_fma_f32 v[56:57], v[88:89], v[40:41], v[48:49] op_sel:[0,0,0] op_sel_hi:[0,1,1]
    v_pk_fma_f32 v[58:59], v[90:91], v[42:43], v[50:51] op_sel:[0,0,0] op_sel_hi:[0,1,1]
    v_pk_fma_f32 v[60:61], v[92:93], v[44:45], v[52:53] op_sel:[0,0,0] op_sel_hi:[0,1,1]
    v_pk_fma_f32 v[62:63], v[94:95], v[46:47], v[54:55] op_sel:[0,0,0] op_sel_hi:[0,1,1]
    v_pk_fma_f32 v[40:41], v[88:89], v[40:41], v[56:57] op_sel:[1,1,0] op_sel_hi:[1,0,1] neg_lo:[1,0,0]
    v_pk_fma_f32 v[42:43], v[90:91], v[42:43], v[58:59] op_sel:[1,1,0] op_sel_hi:[1,0,1] neg_lo:[1,0,0]
    v_pk_fma_f32 v[44:45], v[92:93], v[44:45], v[60:61] op_sel:[1,1,0] op_sel_hi:[1,0,1] neg_lo:[1,0,0]
    v_pk_fma_f32 v[46:47], v[94:95], v[46:47], v[62:63] op_sel:[1,1,0] op_sel_hi:[1,0,1] neg_lo:[1,0,0]
    v_accvgpr_read_b32 v64, a162
    v_accvgpr_read_b32 v66, a166
    v_accvgpr_read_b32 v68, a170
    v_accvgpr_read_b32 v70, a174
    v_accvgpr_read_b32 v65, a178
    v_accvgpr_read_b32 v67, a182
    v_accvgpr_read_b32 v69, a186
    v_accvgpr_read_b32 v71, a190
    v_pk_fma_f32 v[56:57], v[88:89], v[40:41], v[64:65] op_sel:[0,0,0] op_sel_hi:[0,1,1]
    v_pk_fma_f32 v[58:59], v[90:91], v[42:43], v[66:67] op_sel:[0,0,0] op_sel_hi:[0,1,1]
    v_pk_fma_f32 v[60:61], v[92:93], v[44:45], v[68:69] op_sel:[0,0,0] op_sel_hi:[0,1,1]
    v_pk_fma_f32 v[62:63], v[94:95], v[46:47], v[70:71] op_sel:[0,0,0] op_sel_hi:[0,1,1]
    v_pk_fma_f32 v[40:41], v[88:89], v[40:41], v[56:57] op_sel:[1,1,0] op_sel_hi:[1,0,1] neg_lo:[1,0,0]
    v_pk_fma_f32 v[42:43], v[90:91], v[42:43], v[58:59] op_sel:[1,1,0] op_sel_hi:[1,0,1] neg_lo:[1,0,0]
    v_pk_fma_f32 v[44:45], v[92:93], v[44:45], v[60:61] op_sel:[1,1,0] op_sel_hi:[1,0,1] neg_lo:[1,0,0]
    v_pk_fma_f32 v[46:47], v[94:95], v[46:47], v[62:63] op_sel:[1,1,0] op_sel_hi:[1,0,1] neg_lo:[1,0,0]
    v_accvgpr_read_b32 v48, a163
    v_accvgpr_read_b32 v50, a167
    v_accvgpr_read_b32 v52, a171
    v_accvgpr_read_b32 v54, a175
    v_accvgpr_read_b32 v49, a179
    v_accvgpr_read_b32 v51, a183
    v_accvgpr_read_b32 v53, a187
    v_accvgpr_read_b32 v55, a191
    v_pk_fma_f32 v[56:57], v[88:89], v[40:41], v[48:49] op_sel:[0,0,0] op_sel_hi:[0,1,1]
    v_pk_fma_f32 v[58:59], v[90:91], v[42:43], v[50:51] op_sel:[0,0,0] op_sel_hi:[0,1,1]
    v_pk_fma_f32 v[60:61], v[92:93], v[44:45], v[52:53] op_sel:[0,0,0] op_sel_hi:[0,1,1]
    v_pk_fma_f32 v[62:63], v[94:95], v[46:47], v[54:55] op_sel:[0,0,0] op_sel_hi:[0,1,1]
    v_pk_fma_f32 v[40:41], v[88:89], v[40:41], v[56:57] op_sel:[1,1,0] op_sel_hi:[1,0,1] neg_lo:[1,0,0]
    v_pk_fma_f32 v[42:43], v[90:91], v[42:43], v[58:59] op_sel:[1,1,0] op_sel_hi:[1,0,1] neg_lo:[1,0,0]
    v_pk_fma_f32 v[44:45], v[92:93], v[44:45], v[60:61] op_sel:[1,1,0] op_sel_hi:[1,0,1] neg_lo:[1,0,0]
    v_pk_fma_f32 v[46:47], v[94:95], v[46:47], v[62:63] op_sel:[1,1,0] op_sel_hi:[1,0,1] neg_lo:[1,0,0]
    v_accvgpr_read_b32 v64, a192
    v_accvgpr_read_b32 v66, a196
    v_accvgpr_read_b32 v68, a200
    v_accvgpr_read_b32 v70, a204
    v_accvgpr_read_b32 v65, a208
    v_accvgpr_read_b32 v67, a212
    v_accvgpr_read_b32 v69, a216
    v_accvgpr_read_b32 v71, a220
    v_pk_fma_f32 v[56:57], v[88:89], v[40:41], v[64:65] op_sel:[0,0,0] op_sel_hi:[0,1,1]
    v_pk_fma_f32 v[58:59], v[90:91], v[42:43], v[66:67] op_sel:[0,0,0] op_sel_hi:[0,1,1]
    v_pk_fma_f32 v[60:61], v[92:93], v[44:45], v[68:69] op_sel:[0,0,0] op_sel_hi:[0,1,1]
    v_pk_fma_f32 v[62:63], v[94:95], v[46:47], v[70:71] op_sel:[0,0,0] op_sel_hi:[0,1,1]
    v_pk_fma_f32 v[40:41], v[88:89], v[40:41], v[56:57] op_sel:[1,1,0] op_sel_hi:[1,0,1] neg_lo:[1,0,0]
    v_pk_fma_f32 v[42:43], v[90:91], v[42:43], v[58:59] op_sel:[1,1,0] op_sel_hi:[1,0,1] neg_lo:[1,0,0]
    v_pk_fma_f32 v[44:45], v[92:93], v[44:45], v[60:61] op_sel:[1,1,0] op_sel_hi:[1,0,1] neg_lo:[1,0,0]
    v_pk_fma_f32 v[46:47], v[94:95], v[46:47], v[62:63] op_sel:[1,1,0] op_sel_hi:[1,0,1] neg_lo:[1,0,0]
    v_accvgpr_read_b32 v48, a193
    v_accvgpr_read_b32 v50, a197
    v_accvgpr_read_b32 v52, a201
    v_accvgpr_read_b32 v54, a205
    v_accvgpr_read_b32 v49, a209
    v_accvgpr_read_b32 v51, a213
    v_accvgpr_read_b32 v53, a217
    v_accvgpr_read_b32 v55, a221
    v_pk_fma_f32 v[56:57], v[88:89], v[40:41], v[48:49] op_sel:[0,0,0] op_sel_hi:[0,1,1]
    v_pk_fma_f32 v[58:59], v[90:91], v[42:43], v[50:51] op_sel:[0,0,0] op_sel_hi:[0,1,1]
    v_pk_fma_f32 v[60:61], v[92:93], v[44:45], v[52:53] op_sel:[0,0,0] op_sel_hi:[0,1,1]
    v_pk_fma_f32 v[62:63], v[94:95], v[46:47], v[54:55] op_sel:[0,0,0] op_sel_hi:[0,1,1]
    v_pk_fma_f32 v[40:41], v[88:89], v[40:41], v[56:57] op_sel:[1,1,0] op_sel_hi:[1,0,1] neg_lo:[1,0,0]
    v_pk_fma_f32 v[42:43], v[90:91], v[42:43], v[58:59] op_sel:[1,1,0] op_sel_hi:[1,0,1] neg_lo:[1,0,0]
    v_pk_fma_f32 v[44:45], v[92:93], v[44:45], v[60:61] op_sel:[1,1,0] op_sel_hi:[1,0,1] neg_lo:[1,0,0]
    v_pk_fma_f32 v[46:47], v[94:95], v[46:47], v[62:63] op_sel:[1,1,0] op_sel_hi:[1,0,1] neg_lo:[1,0,0]
    v_accvgpr_read_b32 v64, a194
    v_accvgpr_read_b32 v66, a198
    v_accvgpr_read_b32 v68, a202
    v_accvgpr_read_b32 v70, a206
    v_accvgpr_read_b32 v65, a210
    v_accvgpr_read_b32 v67, a214
    v_accvgpr_read_b32 v69, a218
    v_accvgpr_read_b32 v71, a222
    v_pk_fma_f32 v[56:57], v[88:89], v[40:41], v[64:65] op_sel:[0,0,0] op_sel_hi:[0,1,1]
    v_pk_fma_f32 v[58:59], v[90:91], v[42:43], v[66:67] op_sel:[0,0,0] op_sel_hi:[0,1,1]
    v_pk_fma_f32 v[60:61], v[92:93], v[44:45], v[68:69] op_sel:[0,0,0] op_sel_hi:[0,1,1]
    v_pk_fma_f32 v[62:63], v[94:95], v[46:47], v[70:71] op_sel:[0,0,0] op_sel_hi:[0,1,1]
    v_pk_fma_f32 v[40:41], v[88:89], v[40:41], v[56:57] op_sel:[1,1,0] op_sel_hi:[1,0,1] neg_lo:[1,0,0]
    v_pk_fma_f32 v[42:43], v[90:91], v[42:43], v[58:59] op_sel:[1,1,0] op_sel_hi:[1,0,1] neg_lo:[1,0,0]
    v_pk_fma_f32 v[44:45], v[92:93], v[44:45], v[60:61] op_sel:[1,1,0] op_sel_hi:[1,0,1] neg_lo:[1,0,0]
    v_pk_fma_f32 v[46:47], v[94:95], v[46:47], v[62:63] op_sel:[1,1,0] op_sel_hi:[1,0,1] neg_lo:[1,0,0]
    v_accvgpr_read_b32 v48, a195
    v_accvgpr_read_b32 v50, a199
    v_accvgpr_read_b32 v52, a203
    v_accvgpr_read_b32 v54, a207
    v_accvgpr_read_b32 v49, a211
    v_accvgpr_read_b32 v51, a215
    v_accvgpr_read_b32 v53, a219
    v_accvgpr_read_b32 v55, a223
    v_pk_fma_f32 v[56:57], v[88:89], v[40:41], v[48:49] op_sel:[0,0,0] op_sel_hi:[0,1,1]
    v_pk_fma_f32 v[58:59], v[90:91], v[42:43], v[50:51] op_sel:[0,0,0] op_sel_hi:[0,1,1]
    v_pk_fma_f32 v[60:61], v[92:93], v[44:45], v[52:53] op_sel:[0,0,0] op_sel_hi:[0,1,1]
    v_pk_fma_f32 v[62:63], v[94:95], v[46:47], v[54:55] op_sel:[0,0,0] op_sel_hi:[0,1,1]
    v_pk_fma_f32 v[40:41], v[88:89], v[40:41], v[56:57] op_sel:[1,1,0] op_sel_hi:[1,0,1] neg_lo:[1,0,0]
    v_pk_fma_f32 v[42:43], v[90:91], v[42:43], v[58:59] op_sel:[1,1,0] op_sel_hi:[1,0,1] neg_lo:[1,0,0]
    v_pk_fma_f32 v[44:45], v[92:93], v[44:45], v[60:61] op_sel:[1,1,0] op_sel_hi:[1,0,1] neg_lo:[1,0,0]
    v_pk_fma_f32 v[46:47], v[94:95], v[46:47], v[62:63] op_sel:[1,1,0] op_sel_hi:[1,0,1] neg_lo:[1,0,0]
    v_accvgpr_read_b32 v64, a224
    v_accvgpr_read_b32 v66, a228
    v_accvgpr_read_b32 v68, a232
    v_accvgpr_read_b32 v70, a236
    v_accvgpr_read_b32 v65, a240
    v_accvgpr_read_b32 v67, a244
    v_accvgpr_read_b32 v69, a248
    v_accvgpr_read_b32 v71, a252
    v_pk_fma_f32 v[56:57], v[88:89], v[40:41], v[64:65] op_sel:[0,0,0] op_sel_hi:[0,1,1]
    v_pk_fma_f32 v[58:59], v[90:91], v[42:43], v[66:67] op_sel:[0,0,0] op_sel_hi:[0,1,1]
    v_pk_fma_f32 v[60:61], v[92:93], v[44:45], v[68:69] op_sel:[0,0,0] op_sel_hi:[0,1,1]
    v_pk_fma_f32 v[62:63], v[94:95], v[46:47], v[70:71] op_sel:[0,0,0] op_sel_hi:[0,1,1]
    v_pk_fma_f32 v[40:41], v[88:89], v[40:41], v[56:57] op_sel:[1,1,0] op_sel_hi:[1,0,1] neg_lo:[1,0,0]
    v_pk_fma_f32 v[42:43], v[90:91], v[42:43], v[58:59] op_sel:[1,1,0] op_sel_hi:[1,0,1] neg_lo:[1,0,0]
    v_pk_fma_f32 v[44:45], v[92:93], v[44:45], v[60:61] op_sel:[1,1,0] op_sel_hi:[1,0,1] neg_lo:[1,0,0]
    v_pk_fma_f32 v[46:47], v[94:95], v[46:47], v[62:63] op_sel:[1,1,0] op_sel_hi:[1,0,1] neg_lo:[1,0,0]
    v_accvgpr_read_b32 v48, a225
    v_accvgpr_read_b32 v50, a229
    v_accvgpr_read_b32 v52, a233
    v_accvgpr_read_b32 v54, a237
    v_accvgpr_read_b32 v49, a241
    v_accvgpr_read_b32 v51, a245
    v_accvgpr_read_b32 v53, a249
    v_accvgpr_read_b32 v55, a253
    v_pk_fma_f32 v[56:57], v[88:89], v[40:41], v[48:49] op_sel:[0,0,0] op_sel_hi:[0,1,1]
    v_pk_fma_f32 v[58:59], v[90:91], v[42:43], v[50:51] op_sel:[0,0,0] op_sel_hi:[0,1,1]
    v_pk_fma_f32 v[60:61], v[92:93], v[44:45], v[52:53] op_sel:[0,0,0] op_sel_hi:[0,1,1]
    v_pk_fma_f32 v[62:63], v[94:95], v[46:47], v[54:55] op_sel:[0,0,0] op_sel_hi:[0,1,1]
    v_pk_fma_f32 v[40:41], v[88:89], v[40:41], v[56:57] op_sel:[1,1,0] op_sel_hi:[1,0,1] neg_lo:[1,0,0]
    v_pk_fma_f32 v[42:43], v[90:91], v[42:43], v[58:59] op_sel:[1,1,0] op_sel_hi:[1,0,1] neg_lo:[1,0,0]
    v_pk_fma_f32 v[44:45], v[92:93], v[44:45], v[60:61] op_sel:[1,1,0] op_sel_hi:[1,0,1] neg_lo:[1,0,0]
    v_pk_fma_f32 v[46:47], v[94:95], v[46:47], v[62:63] op_sel:[1,1,0] op_sel_hi:[1,0,1] neg_lo:[1,0,0]
    v_accvgpr_read_b32 v64, a226
    v_accvgpr_read_b32 v66, a230
    v_accvgpr_read_b32 v68, a234
    v_accvgpr_read_b32 v70, a238
    v_accvgpr_read_b32 v65, a242
    v_accvgpr_read_b32 v67, a246
    v_accvgpr_read_b32 v69, a250
    v_accvgpr_read_b32 v71, a254
    v_pk_fma_f32 v[56:57], v[88:89], v[40:41], v[64:65] op_sel:[0,0,0] op_sel_hi:[0,1,1]
    v_pk_fma_f32 v[58:59], v[90:91], v[42:43], v[66:67] op_sel:[0,0,0] op_sel_hi:[0,1,1]
    v_pk_fma_f32 v[60:61], v[92:93], v[44:45], v[68:69] op_sel:[0,0,0] op_sel_hi:[0,1,1]
    v_pk_fma_f32 v[62:63], v[94:95], v[46:47], v[70:71] op_sel:[0,0,0] op_sel_hi:[0,1,1]
    v_pk_fma_f32 v[40:41], v[88:89], v[40:41], v[56:57] op_sel:[1,1,0] op_sel_hi:[1,0,1] neg_lo:[1,0,0]
    v_pk_fma_f32 v[42:43], v[90:91], v[42:43], v[58:59] op_sel:[1,1,0] op_sel_hi:[1,0,1] neg_lo:[1,0,0]
    v_pk_fma_f32 v[44:45], v[92:93], v[44:45], v[60:61] op_sel:[1,1,0] op_sel_hi:[1,0,1] neg_lo:[1,0,0]
    v_pk_fma_f32 v[46:47], v[94:95], v[46:47], v[62:63] op_sel:[1,1,0] op_sel_hi:[1,0,1] neg_lo:[1,0,0]
    v_accvgpr_read_b32 v48, a227
    v_accvgpr_read_b32 v50, a231
    v_accvgpr_read_b32 v52, a235
    v_accvgpr_read_b32 v54, a239
    v_accvgpr_read_b32 v49, a243
    v_accvgpr_read_b32 v51, a247
    v_accvgpr_read_b32 v53, a251
    v_accvgpr_read_b32 v55, a255
    v_pk_fma_f32 v[56:57], v[88:89], v[40:41], v[48:49] op_sel:[0,0,0] op_sel_hi:[0,1,1]
    v_pk_fma_f32 v[58:59], v[90:91], v[42:43], v[50:51] op_sel:[0,0,0] op_sel_hi:[0,1,1]
    v_pk_fma_f32 v[60:61], v[92:93], v[44:45], v[52:53] op_sel:[0,0,0] op_sel_hi:[0,1,1]
    v_pk_fma_f32 v[62:63], v[94:95], v[46:47], v[54:55] op_sel:[0,0,0] op_sel_hi:[0,1,1]
    v_pk_fma_f32 v[40:41], v[88:89], v[40:41], v[56:57] op_sel:[1,1,0] op_sel_hi:[1,0,1] neg_lo:[1,0,0]
    v_pk_fma_f32 v[42:43], v[90:91], v[42:43], v[58:59] op_sel:[1,1,0] op_sel_hi:[1,0,1] neg_lo:[1,0,0]
    v_pk_fma_f32 v[44:45], v[92:93], v[44:45], v[60:61] op_sel:[1,1,0] op_sel_hi:[1,0,1] neg_lo:[1,0,0]
    v_pk_fma_f32 v[46:47], v[94:95], v[46:47], v[62:63] op_sel:[1,1,0] op_sel_hi:[1,0,1] neg_lo:[1,0,0]
    v_mov_b32 v64, v40
    v_mov_b32 v72, v40
    v_mov_b32 v65, v41
    v_mov_b32 v73, v41
    v_mov_b32 v66, v42
    v_mov_b32 v74, v42
    v_mov_b32 v67, v43
    v_mov_b32 v75, v43
    v_mov_b32 v68, v44
    v_mov_b32 v76, v44
    v_mov_b32 v69, v45
    v_mov_b32 v77, v45
    v_mov_b32 v70, v46
    v_mov_b32 v78, v46
    v_mov_b32 v71, v47
    v_mov_b32 v79, v47
    s_nop 1
    v_permlane16_swap_b32 v64, v72
    v_permlane16_swap_b32 v65, v73
    v_permlane16_swap_b32 v66, v74
    v_permlane16_swap_b32 v67, v75
    v_permlane16_swap_b32 v68, v76
    v_permlane16_swap_b32 v69, v77
    v_permlane16_swap_b32 v70, v78
    v_permlane16_swap_b32 v71, v79
    v_pk_fma_f32 v[56:57], v[104:105], v[64:65], v[72:73] op_sel:[0,0,0] op_sel_hi:[0,1,1]
    v_pk_fma_f32 v[58:59], v[106:107], v[66:67], v[74:75] op_sel:[0,0,0] op_sel_hi:[0,1,1]
    v_pk_fma_f32 v[60:61], v[108:109], v[68:69], v[76:77] op_sel:[0,0,0] op_sel_hi:[0,1,1]
    v_pk_fma_f32 v[62:63], v[110:111], v[70:71], v[78:79] op_sel:[0,0,0] op_sel_hi:[0,1,1]
    v_pk_fma_f32 v[80:81], v[104:105], v[64:65], v[56:57] op_sel:[1,1,0] op_sel_hi:[1,0,1] neg_lo:[1,0,0]
    v_pk_fma_f32 v[82:83], v[106:107], v[66:67], v[58:59] op_sel:[1,1,0] op_sel_hi:[1,0,1] neg_lo:[1,0,0]
    v_pk_fma_f32 v[84:85], v[108:109], v[68:69], v[60:61] op_sel:[1,1,0] op_sel_hi:[1,0,1] neg_lo:[1,0,0]
    v_pk_fma_f32 v[86:87], v[110:111], v[70:71], v[62:63] op_sel:[1,1,0] op_sel_hi:[1,0,1] neg_lo:[1,0,0]
    v_mov_b32 v24, v80
    v_mov_b32 v25, v81
    v_mov_b32 v26, v82
    v_mov_b32 v27, v83
    v_mov_b32 v28, v84
    v_mov_b32 v29, v85
    v_mov_b32 v30, v86
    v_mov_b32 v31, v87
    s_nop 1
    v_permlane32_swap_b32 v80, v24
    v_permlane32_swap_b32 v81, v25
    v_permlane32_swap_b32 v82, v26
    v_permlane32_swap_b32 v83, v27
    v_permlane32_swap_b32 v84, v28
    v_permlane32_swap_b32 v85, v29
    v_permlane32_swap_b32 v86, v30
    v_permlane32_swap_b32 v87, v31
    v_pk_fma_f32 v[56:57], v[112:113], v[80:81], v[24:25] op_sel:[0,0,0] op_sel_hi:[0,1,1]
    v_pk_fma_f32 v[58:59], v[114:115], v[82:83], v[26:27] op_sel:[0,0,0] op_sel_hi:[0,1,1]
    v_pk_fma_f32 v[60:61], v[116:117], v[84:85], v[28:29] op_sel:[0,0,0] op_sel_hi:[0,1,1]
    v_pk_fma_f32 v[62:63], v[118:119], v[86:87], v[30:31] op_sel:[0,0,0] op_sel_hi:[0,1,1]
    v_pk_fma_f32 v[40:41], v[112:113], v[80:81], v[56:57] op_sel:[1,1,0] op_sel_hi:[1,0,1] neg_lo:[1,0,0]
    v_pk_fma_f32 v[42:43], v[114:115], v[82:83], v[58:59] op_sel:[1,1,0] op_sel_hi:[1,0,1] neg_lo:[1,0,0]
    v_pk_fma_f32 v[44:45], v[116:117], v[84:85], v[60:61] op_sel:[1,1,0] op_sel_hi:[1,0,1] neg_lo:[1,0,0]
    v_pk_fma_f32 v[46:47], v[118:119], v[86:87], v[62:63] op_sel:[1,1,0] op_sel_hi:[1,0,1] neg_lo:[1,0,0]
    s_mov_b32 exec_lo, 0xffffffff
    s_mov_b32 exec_hi, 0xffffffff
    v_mov_b32 v122, v40
    v_mov_b32 v123, v41
    s_mov_b32 exec_lo, 0xffff0000
    s_mov_b32 exec_hi, 0xffffffff
    v_mov_b32 v122, v42
    v_mov_b32 v123, v43
    s_mov_b32 exec_lo, 0x0
    s_mov_b32 exec_hi, 0xffffffff
    v_mov_b32 v122, v44
    v_mov_b32 v123, v45
    s_mov_b32 exec_lo, 0x0
    s_mov_b32 exec_hi, 0xffff0000
    v_mov_b32 v122, v46
    v_mov_b32 v123, v47
    s_mov_b64 exec, -1
    v_min_u32 v122, 0xfffffffe, v122
    v_min_u32 v123, 0xfffffffe, v123
    s_and_b32 s53, s58, 1
    s_lshl1_add_u32 s53, s85, s53
    s_lshl_b32 s53, s53, 13
    s_lshr_b32 s29, s58, 1
    s_lshl1_add_u32 s29, s0, s29
    s_lshl_b32 s29, s29, 9
    s_add_u32 s53, s53, s29
    v_lshrrev_b32 v124, 1, v1
    v_add_u32 v124, s53, v124
    s_add_u32 s60, s100, 0xb100000
    s_addc_u32 s61, s101, 0
    s_and_b32 s61, s61, 0xffff
    s_mov_b32 s62, 0x20000
    s_mov_b32 s63, 0x00020000
    buffer_store_dwordx2 v[122:123], v124, s[60:63], 0 offen sc1
    v_subrev_u32 v160, 8192, v124
    v_subrev_u32 v161, 16384, v124
    v_subrev_u32 v162, 24576, v124
    v_subrev_u32 v163, 32768, v124
    v_subrev_u32 v164, 40960, v124
    v_subrev_u32 v165, 49152, v124
    v_subrev_u32 v166, 57344, v124
    v_subrev_u32 v167, 65536, v124
    v_subrev_u32 v168, 73728, v124
    v_subrev_u32 v169, 81920, v124
    v_subrev_u32 v170, 90112, v124
    v_subrev_u32 v171, 98304, v124
    v_subrev_u32 v172, 106496, v124
    v_subrev_u32 v173, 114688, v124
    v_subrev_u32 v174, 122880, v124
    s_mov_b32 s53, 0
L_lb_65:
    buffer_load_dwordx2 v[128:129], v160, s[60:63], 0 offen sc1
    buffer_load_dwordx2 v[130:131], v161, s[60:63], 0 offen sc1
    buffer_load_dwordx2 v[132:133], v162, s[60:63], 0 offen sc1
    buffer_load_dwordx2 v[134:135], v163, s[60:63], 0 offen sc1
    buffer_load_dwordx2 v[136:137], v164, s[60:63], 0 offen sc1
    buffer_load_dwordx2 v[138:139], v165, s[60:63], 0 offen sc1
    buffer_load_dwordx2 v[140:141], v166, s[60:63], 0 offen sc1
    buffer_load_dwordx2 v[142:143], v167, s[60:63], 0 offen sc1
    buffer_load_dwordx2 v[144:145], v168, s[60:63], 0 offen sc1
    buffer_load_dwordx2 v[146:147], v169, s[60:63], 0 offen sc1
    buffer_load_dwordx2 v[148:149], v170, s[60:63], 0 offen sc1
    buffer_load_dwordx2 v[150:151], v171, s[60:63], 0 offen sc1
    buffer_load_dwordx2 v[152:153], v172, s[60:63], 0 offen sc1
    buffer_load_dwordx2 v[154:155], v173, s[60:63], 0 offen sc1
    buffer_load_dwordx2 v[156:157], v174, s[60:63], 0 offen sc1
    s_add_u32 s53, s53, 1
    s_cmp_gt_u32 s53, 0x200000
    s_cbranch_scc1 chain_kernel_wabort
    s_waitcnt vmcnt(0)
    v_max_u32 v56, v128, v129
    v_max3_u32 v56, v56, v130, v131
    v_max3_u32 v56, v56, v132, v133
    v_max3_u32 v56, v56, v134, v135
    v_max3_u32 v56, v56, v136, v137
    v_max3_u32 v56, v56, v138, v139
    v_max3_u32 v56, v56, v140, v141
    v_max3_u32 v56, v56, v142, v143
    v_max3_u32 v56, v56, v144, v145
    v_max3_u32 v56, v56, v146, v147
    v_max3_u32 v56, v56, v148, v149
    v_max3_u32 v56, v56, v150, v151
    v_max3_u32 v56, v56, v152, v153
    v_max3_u32 v56, v56, v154, v155
    v_max3_u32 v56, v56, v156, v157
    v_cmp_eq_u32 vcc, -1, v56
    s_cbranch_vccnz L_lb_65
    v_pk_fma_f32 v[56:57], v[120:121], v[156:157], v[154:155] op_sel:[0,0,0] op_sel_hi:[0,1,1]
    v_pk_fma_f32 v[154:155], v[120:121], v[156:157], v[56:57] op_sel:[1,1,0] op_sel_hi:[1,0,1] neg_lo:[1,0,0]
    v_pk_fma_f32 v[56:57], v[120:121], v[154:155], v[152:153] op_sel:[0,0,0] op_sel_hi:[0,1,1]
    v_pk_fma_f32 v[152:153], v[120:121], v[154:155], v[56:57] op_sel:[1,1,0] op_sel_hi:[1,0,1] neg_lo:[1,0,0]
    v_pk_fma_f32 v[56:57], v[120:121], v[152:153], v[150:151] op_sel:[0,0,0] op_sel_hi:[0,1,1]
    v_pk_fma_f32 v[150:151], v[120:121], v[152:153], v[56:57] op_sel:[1,1,0] op_sel_hi:[1,0,1] neg_lo:[1,0,0]
    v_pk_fma_f32 v[56:57], v[120:121], v[150:151], v[148:149] op_sel:[0,0,0] op_sel_hi:[0,1,1]
    v_pk_fma_f32 v[148:149], v[120:121], v[150:151], v[56:57] op_sel:[1,1,0] op_sel_hi:[1,0,1] neg_lo:[1,0,0]
    v_pk_fma_f32 v[56:57], v[120:121], v[148:149], v[146:147] op_sel:[0,0,0] op_sel_hi:[0,1,1]
    v_pk_fma_f32 v[146:147], v[120:121], v[148:149], v[56:57] op_sel:[1,1,0] op_sel_hi:[1,0,1] neg_lo:[1,0,0]
    v_pk_fma_f32 v[56:57], v[120:121], v[146:147], v[144:145] op_sel:[0,0,0] op_sel_hi:[0,1,1]
    v_pk_fma_f32 v[144:145], v[120:121], v[146:147], v[56:57] op_sel:[1,1,0] op_sel_hi:[1,0,1] neg_lo:[1,0,0]
    v_pk_fma_f32 v[56:57], v[120:121], v[144:145], v[142:143] op_sel:[0,0,0] op_sel_hi:[0,1,1]
    v_pk_fma_f32 v[142:143], v[120:121], v[144:145], v[56:57] op_sel:[1,1,0] op_sel_hi:[1,0,1] neg_lo:[1,0,0]
    v_pk_fma_f32 v[56:57], v[120:121], v[142:143], v[140:141] op_sel:[0,0,0] op_sel_hi:[0,1,1]
    v_pk_fma_f32 v[140:141], v[120:121], v[142:143], v[56:57] op_sel:[1,1,0] op_sel_hi:[1,0,1] neg_lo:[1,0,0]
    v_pk_fma_f32 v[56:57], v[120:121], v[140:141], v[138:139] op_sel:[0,0,0] op_sel_hi:[0,1,1]
    v_pk_fma_f32 v[138:139], v[120:121], v[140:141], v[56:57] op_sel:[1,1,0] op_sel_hi:[1,0,1] neg_lo:[1,0,0]
    v_pk_fma_f32 v[56:57], v[120:121], v[138:139], v[136:137] op_sel:[0,0,0] op_sel_hi:[0,1,1]
    v_pk_fma_f32 v[136:137], v[120:121], v[138:139], v[56:57] op_sel:[1,1,0] op_sel_hi:[1,0,1] neg_lo:[1,0,0]
    v_pk_fma_f32 v[56:57], v[120:121], v[136:137], v[134:135] op_sel:[0,0,0] op_sel_hi:[0,1,1]
    v_pk_fma_f32 v[134:135], v[120:121], v[136:137], v[56:57] op_sel:[1,1,0] op_sel_hi:[1,0,1] neg_lo:[1,0,0]
    v_pk_fma_f32 v[56:57], v[120:121], v[134:135], v[132:133] op_sel:[0,0,0] op_sel_hi:[0,1,1]
    v_pk_fma_f32 v[132:133], v[120:121], v[134:135], v[56:57] op_sel:[1,1,0] op_sel_hi:[1,0,1] neg_lo:[1,0,0]
    v_pk_fma_f32 v[56:57], v[120:121], v[132:133], v[130:131] op_sel:[0,0,0] op_sel_hi:[0,1,1]
    v_pk_fma_f32 v[130:131], v[120:121], v[132:133], v[56:57] op_sel:[1,1,0] op_sel_hi:[1,0,1] neg_lo:[1,0,0]
    v_pk_fma_f32 v[56:57], v[120:121], v[130:131], v[128:129] op_sel:[0,0,0] op_sel_hi:[0,1,1]
    v_pk_fma_f32 v[128:129], v[120:121], v[130:131], v[56:57] op_sel:[1,1,0] op_sel_hi:[1,0,1] neg_lo:[1,0,0]
    v_mov_b32 v32, v128
    v_mov_b32 v34, v128
    v_mov_b32 v33, v129
    v_mov_b32 v35, v129
    s_nop 1
    v_permlane16_swap_b32 v32, v34
    v_permlane16_swap_b32 v33, v35
    v_mov_b32 v36, v32
    v_mov_b32 v37, v33
    v_mov_b32 v38, v34
    v_mov_b32 v39, v35
    s_nop 1
    v_permlane32_swap_b32 v32, v36
    v_permlane32_swap_b32 v33, v37
    v_permlane32_swap_b32 v34, v38
    v_permlane32_swap_b32 v35, v39
    s_mov_b32 exec_lo, 0
    v_pk_fma_f32 v[56:57], v[112:113], v[32:33], v[80:81] op_sel:[0,0,0] op_sel_hi:[0,1,1]
    v_pk_fma_f32 v[58:59], v[114:115], v[34:35], v[82:83] op_sel:[0,0,0] op_sel_hi:[0,1,1]
    v_pk_fma_f32 v[60:61], v[116:117], v[36:37], v[84:85] op_sel:[0,0,0] op_sel_hi:[0,1,1]
    v_pk_fma_f32 v[62:63], v[118:119], v[38:39], v[86:87] op_sel:[0,0,0] op_sel_hi:[0,1,1]
    v_pk_fma_f32 v[32:33], v[112:113], v[32:33], v[56:57] op_sel:[1,1,0] op_sel_hi:[1,0,1] neg_lo:[1,0,0]
    v_pk_fma_f32 v[34:35], v[114:115], v[34:35], v[58:59] op_sel:[1,1,0] op_sel_hi:[1,0,1] neg_lo:[1,0,0]
    v_pk_fma_f32 v[36:37], v[116:117], v[36:37], v[60:61] op_sel:[1,1,0] op_sel_hi:[1,0,1] neg_lo:[1,0,0]
    v_pk_fma_f32 v[38:39], v[118:119], v[38:39], v[62:63] op_sel:[1,1,0] op_sel_hi:[1,0,1] neg_lo:[1,0,0]
    s_mov_b32 exec_lo, 0xffff0000
    s_mov_b32 exec_hi, 0xffff0000
    v_pk_fma_f32 v[56:57], v[104:105], v[32:33], v[64:65] op_sel:[0,0,0] op_sel_hi:[0,1,1]
    v_pk_fma_f32 v[58:59], v[106:107], v[34:35], v[66:67] op_sel:[0,0,0] op_sel_hi:[0,1,1]
    v_pk_fma_f32 v[60:61], v[108:109], v[36:37], v[68:69] op_sel:[0,0,0] op_sel_hi:[0,1,1]
    v_pk_fma_f32 v[62:63], v[110:111], v[38:39], v[70:71] op_sel:[0,0,0] op_sel_hi:[0,1,1]
    v_pk_fma_f32 v[32:33], v[104:105], v[32:33], v[56:57] op_sel:[1,1,0] op_sel_hi:[1,0,1] neg_lo:[1,0,0]
    v_pk_fma_f32 v[34:35], v[106:107], v[34:35], v[58:59] op_sel:[1,1,0] op_sel_hi:[1,0,1] neg_lo:[1,0,0]
    v_pk_fma_f32 v[36:37], v[108:109], v[36:37], v[60:61] op_sel:[1,1,0] op_sel_hi:[1,0,1] neg_lo:[1,0,0]
    v_pk_fma_f32 v[38:39], v[110:111], v[38:39], v[62:63] op_sel:[1,1,0] op_sel_hi:[1,0,1] neg_lo:[1,0,0]
    s_mov_b64 exec, -1
    v_accvgpr_read_b32 v64, a0
    v_accvgpr_read_b32 v66, a4
    v_accvgpr_read_b32 v68, a8
    v_accvgpr_read_b32 v70, a12
    v_accvgpr_read_b32 v65, a16
    v_accvgpr_read_b32 v67, a20
    v_accvgpr_read_b32 v69, a24
    v_accvgpr_read_b32 v71, a28
    v_pk_fma_f32 v[56:57], v[88:89], v[32:33], v[64:65] op_sel:[0,0,0] op_sel_hi:[0,1,1]
    v_pk_fma_f32 v[58:59], v[90:91], v[34:35], v[66:67] op_sel:[0,0,0] op_sel_hi:[0,1,1]
    v_pk_fma_f32 v[60:61], v[92:93], v[36:37], v[68:69] op_sel:[0,0,0] op_sel_hi:[0,1,1]
    v_pk_fma_f32 v[62:63], v[94:95], v[38:39], v[70:71] op_sel:[0,0,0] op_sel_hi:[0,1,1]
    v_pk_fma_f32 v[32:33], v[88:89], v[32:33], v[56:57] op_sel:[1,1,0] op_sel_hi:[1,0,1] neg_lo:[1,0,0]
    v_pk_fma_f32 v[34:35], v[90:91], v[34:35], v[58:59] op_sel:[1,1,0] op_sel_hi:[1,0,1] neg_lo:[1,0,0]
    v_pk_fma_f32 v[36:37], v[92:93], v[36:37], v[60:61] op_sel:[1,1,0] op_sel_hi:[1,0,1] neg_lo:[1,0,0]
    v_pk_fma_f32 v[38:39], v[94:95], v[38:39], v[62:63] op_sel:[1,1,0] op_sel_hi:[1,0,1] neg_lo:[1,0,0]
    v_pk_mul_f32 v[40:41], v[96:97], v[32:33] op_sel:[0,0] op_sel_hi:[0,1]
    v_pk_mul_f32 v[42:43], v[98:99], v[34:35] op_sel:[0,0] op_sel_hi:[0,1]
    v_pk_mul_f32 v[44:45], v[100:101], v[36:37] op_sel:[0,0] op_sel_hi:[0,1]
    v_pk_mul_f32 v[46:47], v[102:103], v[38:39] op_sel:[0,0] op_sel_hi:[0,1]
    v_pk_fma_f32 v[72:73], v[96:97], v[32:33], v[40:41] op_sel:[1,1,0] op_sel_hi:[1,0,1] neg_lo:[1,0,0] neg_hi:[1,0,1]
    v_pk_fma_f32 v[74:75], v[98:99], v[34:35], v[42:43] op_sel:[1,1,0] op_sel_hi:[1,0,1] neg_lo:[1,0,0] neg_hi:[1,0,1]
    v_pk_fma_f32 v[76:77], v[100:101], v[36:37], v[44:45] op_sel:[1,1,0] op_sel_hi:[1,0,1] neg_lo:[1,0,0] neg_hi:[1,0,1]
    v_pk_fma_f32 v[78:79], v[102:103], v[38:39], v[46:47] op_sel:[1,1,0] op_sel_hi:[1,0,1] neg_lo:[1,0,0] neg_hi:[1,0,1]
    v_accvgpr_read_b32 v48, a1
    v_accvgpr_read_b32 v50, a5
    v_accvgpr_read_b32 v52, a9
    v_accvgpr_read_b32 v54, a13
    v_accvgpr_read_b32 v49, a17
    v_accvgpr_read_b32 v51, a21
    v_accvgpr_read_b32 v53, a25
    v_accvgpr_read_b32 v55, a29
    v_pk_fma_f32 v[56:57], v[88:89], v[32:33], v[48:49] op_sel:[0,0,0] op_sel_hi:[0,1,1]
    v_pk_fma_f32 v[58:59], v[90:91], v[34:35], v[50:51] op_sel:[0,0,0] op_sel_hi:[0,1,1]
    v_pk_fma_f32 v[60:61], v[92:93], v[36:37], v[52:53] op_sel:[0,0,0] op_sel_hi:[0,1,1]
    v_pk_fma_f32 v[62:63], v[94:95], v[38:39], v[54:55] op_sel:[0,0,0] op_sel_hi:[0,1,1]
    v_pk_fma_f32 v[32:33], v[88:89], v[32:33], v[56:57] op_sel:[1,1,0] op_sel_hi:[1,0,1] neg_lo:[1,0,0]
    v_pk_fma_f32 v[34:35], v[90:91], v[34:35], v[58:59] op_sel:[1,1,0] op_sel_hi:[1,0,1] neg_lo:[1,0,0]
    v_pk_fma_f32 v[36:37], v[92:93], v[36:37], v[60:61] op_sel:[1,1,0] op_sel_hi:[1,0,1] neg_lo:[1,0,0]
    v_pk_fma_f32 v[38:39], v[94:95], v[38:39], v[62:63] op_sel:[1,1,0] op_sel_hi:[1,0,1] neg_lo:[1,0,0]
    v_pk_mul_f32 v[40:41], v[96:97], v[32:33] op_sel:[0,0] op_sel_hi:[0,1]
    v_pk_mul_f32 v[42:43], v[98:99], v[34:35] op_sel:[0,0] op_sel_hi:[0,1]
    v_pk_mul_f32 v[44:45], v[100:101], v[36:37] op_sel:[0,0] op_sel_hi:[0,1]
    v_pk_mul_f32 v[46:47], v[102:103], v[38:39] op_sel:[0,0] op_sel_hi:[0,1]
    v_pk_fma_f32 v[80:81], v[96:97], v[32:33], v[40:41] op_sel:[1,1,0] op_sel_hi:[1,0,1] neg_lo:[1,0,0] neg_hi:[1,0,1]
    v_pk_fma_f32 v[82:83], v[98:99], v[34:35], v[42:43] op_sel:[1,1,0] op_sel_hi:[1,0,1] neg_lo:[1,0,0] neg_hi:[1,0,1]
    v_pk_fma_f32 v[84:85], v[100:101], v[36:37], v[44:45] op_sel:[1,1,0] op_sel_hi:[1,0,1] neg_lo:[1,0,0] neg_hi:[1,0,1]
    v_pk_fma_f32 v[86:87], v[102:103], v[38:39], v[46:47] op_sel:[1,1,0] op_sel_hi:[1,0,1] neg_lo:[1,0,0] neg_hi:[1,0,1]
    v_cvt_pk_bf16_f32 v128, v72, v80
    v_cvt_pk_bf16_f32 v136, v74, v82
    v_cvt_pk_bf16_f32 v144, v76, v84
    v_cvt_pk_bf16_f32 v152, v78, v86
    v_cvt_pk_bf16_f32 v192, v73, v81
    v_cvt_pk_bf16_f32 v200, v75, v83
    v_cvt_pk_bf16_f32 v208, v77, v85
    v_cvt_pk_bf16_f32 v216, v79, v87
    v_accvgpr_read_b32 v64, a2
    v_accvgpr_read_b32 v66, a6
    v_accvgpr_read_b32 v68, a10
    v_accvgpr_read_b32 v70, a14
    v_accvgpr_read_b32 v65, a18
    v_accvgpr_read_b32 v67, a22
    v_accvgpr_read_b32 v69, a26
    v_accvgpr_read_b32 v71, a30
    v_pk_fma_f32 v[56:57], v[88:89], v[32:33], v[64:65] op_sel:[0,0,0] op_sel_hi:[0,1,1]
    v_pk_fma_f32 v[58:59], v[90:91], v[34:35], v[66:67] op_sel:[0,0,0] op_sel_hi:[0,1,1]
    v_pk_fma_f32 v[60:61], v[92:93], v[36:37], v[68:69] op_sel:[0,0,0] op_sel_hi:[0,1,1]
    v_pk_fma_f32 v[62:63], v[94:95], v[38:39], v[70:71] op_sel:[0,0,0] op_sel_hi:[0,1,1]
    v_pk_fma_f32 v[32:33], v[88:89], v[32:33], v[56:57] op_sel:[1,1,0] op_sel_hi:[1,0,1] neg_lo:[1,0,0]
    v_pk_fma_f32 v[34:35], v[90:91], v[34:35], v[58:59] op_sel:[1,1,0] op_sel_hi:[1,0,1] neg_lo:[1,0,0]
    v_pk_fma_f32 v[36:37], v[92:93], v[36:37], v[60:61] op_sel:[1,1,0] op_sel_hi:[1,0,1] neg_lo:[1,0,0]
    v_pk_fma_f32 v[38:39], v[94:95], v[38:39], v[62:63] op_sel:[1,1,0] op_sel_hi:[1,0,1] neg_lo:[1,0,0]
    v_pk_mul_f32 v[40:41], v[96:97], v[32:33] op_sel:[0,0] op_sel_hi:[0,1]
    v_pk_mul_f32 v[42:43], v[98:99], v[34:35] op_sel:[0,0] op_sel_hi:[0,1]
    v_pk_mul_f32 v[44:45], v[100:101], v[36:37] op_sel:[0,0] op_sel_hi:[0,1]
    v_pk_mul_f32 v[46:47], v[102:103], v[38:39] op_sel:[0,0] op_sel_hi:[0,1]
    v_pk_fma_f32 v[72:73], v[96:97], v[32:33], v[40:41] op_sel:[1,1,0] op_sel_hi:[1,0,1] neg_lo:[1,0,0] neg_hi:[1,0,1]
    v_pk_fma_f32 v[74:75], v[98:99], v[34:35], v[42:43] op_sel:[1,1,0] op_sel_hi:[1,0,1] neg_lo:[1,0,0] neg_hi:[1,0,1]
    v_pk_fma_f32 v[76:77], v[100:101], v[36:37], v[44:45] op_sel:[1,1,0] op_sel_hi:[1,0,1] neg_lo:[1,0,0] neg_hi:[1,0,1]
    v_pk_fma_f32 v[78:79], v[102:103], v[38:39], v[46:47] op_sel:[1,1,0] op_sel_hi:[1,0,1] neg_lo:[1,0,0] neg_hi:[1,0,1]
    v_accvgpr_read_b32 v48, a3
    v_accvgpr_read_b32 v50, a7
    v_accvgpr_read_b32 v52, a11
    v_accvgpr_read_b32 v54, a15
    v_accvgpr_read_b32 v49, a19
    v_accvgpr_read_b32 v51, a23
    v_accvgpr_read_b32 v53, a27
    v_accvgpr_read_b32 v55, a31
    v_pk_fma_f32 v[56:57], v[88:89], v[32:33], v[48:49] op_sel:[0,0,0] op_sel_hi:[0,1,1]
    v_pk_fma_f32 v[58:59], v[90:91], v[34:35], v[50:51] op_sel:[0,0,0] op_sel_hi:[0,1,1]
    v_pk_fma_f32 v[60:61], v[92:93], v[36:37], v[52:53] op_sel:[0,0,0] op_sel_hi:[0,1,1]
    v_pk_fma_f32 v[62:63], v[94:95], v[38:39], v[54:55] op_sel:[0,0,0] op_sel_hi:[0,1,1]
    v_pk_fma_f32 v[32:33], v[88:89], v[32:33], v[56:57] op_sel:[1,1,0] op_sel_hi:[1,0,1] neg_lo:[1,0,0]
    v_pk_fma_f32 v[34:35], v[90:91], v[34:35], v[58:59] op_sel:[1,1,0] op_sel_hi:[1,0,1] neg_lo:[1,0,0]
    v_pk_fma_f32 v[36:37], v[92:93], v[36:37], v[60:61] op_sel:[1,1,0] op_sel_hi:[1,0,1] neg_lo:[1,0,0]
    v_pk_fma_f32 v[38:39], v[94:95], v[38:39], v[62:63] op_sel:[1,1,0] op_sel_hi:[1,0,1] neg_lo:[1,0,0]
    v_pk_mul_f32 v[40:41], v[96:97], v[32:33] op_sel:[0,0] op_sel_hi:[0,1]
    v_pk_mul_f32 v[42:43], v[98:99], v[34:35] op_sel:[0,0] op_sel_hi:[0,1]
    v_pk_mul_f32 v[44:45], v[100:101], v[36:37] op_sel:[0,0] op_sel_hi:[0,1]
    v_pk_mul_f32 v[46:47], v[102:103], v[38:39] op_sel:[0,0] op_sel_hi:[0,1]
    v_pk_fma_f32 v[80:81], v[96:97], v[32:33], v[40:41] op_sel:[1,1,0] op_sel_hi:[1,0,1] neg_lo:[1,0,0] neg_hi:[1,0,1]
    v_pk_fma_f32 v[82:83], v[98:99], v[34:35], v[42:43] op_sel:[1,1,0] op_sel_hi:[1,0,1] neg_lo:[1,0,0] neg_hi:[1,0,1]
    v_pk_fma_f32 v[84:85], v[100:101], v[36:37], v[44:45] op_sel:[1,1,0] op_sel_hi:[1,0,1] neg_lo:[1,0,0] neg_hi:[1,0,1]
    v_pk_fma_f32 v[86:87], v[102:103], v[38:39], v[46:47] op_sel:[1,1,0] op_sel_hi:[1,0,1] neg_lo:[1,0,0] neg_hi:[1,0,1]
    v_cvt_pk_bf16_f32 v129, v72, v80
    v_cvt_pk_bf16_f32 v137, v74, v82
    v_cvt_pk_bf16_f32 v145, v76, v84
    v_cvt_pk_bf16_f32 v153, v78, v86
    v_cvt_pk_bf16_f32 v193, v73, v81
    v_cvt_pk_bf16_f32 v201, v75, v83
    v_cvt_pk_bf16_f32 v209, v77, v85
    v_cvt_pk_bf16_f32 v217, v79, v87
    v_accvgpr_read_b32 v64, a32
    v_accvgpr_read_b32 v66, a36
    v_accvgpr_read_b32 v68, a40
    v_accvgpr_read_b32 v70, a44
    v_accvgpr_read_b32 v65, a48
    v_accvgpr_read_b32 v67, a52
    v_accvgpr_read_b32 v69, a56
    v_accvgpr_read_b32 v71, a60
    v_pk_fma_f32 v[56:57], v[88:89], v[32:33], v[64:65] op_sel:[0,0,0] op_sel_hi:[0,1,1]
    v_pk_fma_f32 v[58:59], v[90:91], v[34:35], v[66:67] op_sel:[0,0,0] op_sel_hi:[0,1,1]
    v_pk_fma_f32 v[60:61], v[92:93], v[36:37], v[68:69] op_sel:[0,0,0] op_sel_hi:[0,1,1]
    v_pk_fma_f32 v[62:63], v[94:95], v[38:39], v[70:71] op_sel:[0,0,0] op_sel_hi:[0,1,1]
    v_pk_fma_f32 v[32:33], v[88:89], v[32:33], v[56:57] op_sel:[1,1,0] op_sel_hi:[1,0,1] neg_lo:[1,0,0]
    v_pk_fma_f32 v[34:35], v[90:91], v[34:35], v[58:59] op_sel:[1,1,0] op_sel_hi:[1,0,1] neg_lo:[1,0,0]
    v_pk_fma_f32 v[36:37], v[92:93], v[36:37], v[60:61] op_sel:[1,1,0] op_sel_hi:[1,0,1] neg_lo:[1,0,0]
    v_pk_fma_f32 v[38:39], v[94:95], v[38:39], v[62:63] op_sel:[1,1,0] op_sel_hi:[1,0,1] neg_lo:[1,0,0]
    v_pk_mul_f32 v[40:41], v[96:97], v[32:33] op_sel:[0,0] op_sel_hi:[0,1]
    v_pk_mul_f32 v[42:43], v[98:99], v[34:35] op_sel:[0,0] op_sel_hi:[0,1]
    v_pk_mul_f32 v[44:45], v[100:101], v[36:37] op_sel:[0,0] op_sel_hi:[0,1]
    v_pk_mul_f32 v[46:47], v[102:103], v[38:39] op_sel:[0,0] op_sel_hi:[0,1]
    v_pk_fma_f32 v[72:73], v[96:97], v[32:33], v[40:41] op_sel:[1,1,0] op_sel_hi:[1,0,1] neg_lo:[1,0,0] neg_hi:[1,0,1]
    v_pk_fma_f32 v[74:75], v[98:99], v[34:35], v[42:43] op_sel:[1,1,0] op_sel_hi:[1,0,1] neg_lo:[1,0,0] neg_hi:[1,0,1]
    v_pk_fma_f32 v[76:77], v[100:101], v[36:37], v[44:45] op_sel:[1,1,0] op_sel_hi:[1,0,1] neg_lo:[1,0,0] neg_hi:[1,0,1]
    v_pk_fma_f32 v[78:79], v[102:103], v[38:39], v[46:47] op_sel:[1,1,0] op_sel_hi:[1,0,1] neg_lo:[1,0,0] neg_hi:[1,0,1]
    v_accvgpr_read_b32 v48, a33
    v_accvgpr_read_b32 v50, a37
    v_accvgpr_read_b32 v52, a41
    v_accvgpr_read_b32 v54, a45
    v_accvgpr_read_b32 v49, a49
    v_accvgpr_read_b32 v51, a53
    v_accvgpr_read_b32 v53, a57
    v_accvgpr_read_b32 v55, a61
    v_pk_fma_f32 v[56:57], v[88:89], v[32:33], v[48:49] op_sel:[0,0,0] op_sel_hi:[0,1,1]
    v_pk_fma_f32 v[58:59], v[90:91], v[34:35], v[50:51] op_sel:[0,0,0] op_sel_hi:[0,1,1]
    v_pk_fma_f32 v[60:61], v[92:93], v[36:37], v[52:53] op_sel:[0,0,0] op_sel_hi:[0,1,1]
    v_pk_fma_f32 v[62:63], v[94:95], v[38:39], v[54:55] op_sel:[0,0,0] op_sel_hi:[0,1,1]
    v_pk_fma_f32 v[32:33], v[88:89], v[32:33], v[56:57] op_sel:[1,1,0] op_sel_hi:[1,0,1] neg_lo:[1,0,0]
    v_pk_fma_f32 v[34:35], v[90:91], v[34:35], v[58:59] op_sel:[1,1,0] op_sel_hi:[1,0,1] neg_lo:[1,0,0]
    v_pk_fma_f32 v[36:37], v[92:93], v[36:37], v[60:61] op_sel:[1,1,0] op_sel_hi:[1,0,1] neg_lo:[1,0,0]
    v_pk_fma_f32 v[38:39], v[94:95], v[38:39], v[62:63] op_sel:[1,1,0] op_sel_hi:[1,0,1] neg_lo:[1,0,0]
    v_pk_mul_f32 v[40:41], v[96:97], v[32:33] op_sel:[0,0] op_sel_hi:[0,1]
    v_pk_mul_f32 v[42:43], v[98:99], v[34:35] op_sel:[0,0] op_sel_hi:[0,1]
    v_pk_mul_f32 v[44:45], v[100:101], v[36:37] op_sel:[0,0] op_sel_hi:[0,1]
    v_pk_mul_f32 v[46:47], v[102:103], v[38:39] op_sel:[0,0] op_sel_hi:[0,1]
    v_pk_fma_f32 v[80:81], v[96:97], v[32:33], v[40:41] op_sel:[1,1,0] op_sel_hi:[1,0,1] neg_lo:[1,0,0] neg_hi:[1,0,1]
    v_pk_fma_f32 v[82:83], v[98:99], v[34:35], v[42:43] op_sel:[1,1,0] op_sel_hi:[1,0,1] neg_lo:[1,0,0] neg_hi:[1,0,1]
    v_pk_fma_f32 v[84:85], v[100:101], v[36:37], v[44:45] op_sel:[1,1,0] op_sel_hi:[1,0,1] neg_lo:[1,0,0] neg_hi:[1,0,1]
    v_pk_fma_f32 v[86:87], v[102:103], v[38:39], v[46:47] op_sel:[1,1,0] op_sel_hi:[1,0,1] neg_lo:[1,0,0] neg_hi:[1,0,1]
    v_cvt_pk_bf16_f32 v130, v72, v80
    v_cvt_pk_bf16_f32 v138, v74, v82
    v_cvt_pk_bf16_f32 v146, v76, v84
    v_cvt_pk_bf16_f32 v154, v78, v86
    v_cvt_pk_bf16_f32 v194, v73, v81
    v_cvt_pk_bf16_f32 v202, v75, v83
    v_cvt_pk_bf16_f32 v210, v77, v85
    v_cvt_pk_bf16_f32 v218, v79, v87
    v_accvgpr_read_b32 v64, a34
    v_accvgpr_read_b32 v66, a38
    v_accvgpr_read_b32 v68, a42
    v_accvgpr_read_b32 v70, a46
    v_accvgpr_read_b32 v65, a50
    v_accvgpr_read_b32 v67, a54
    v_accvgpr_read_b32 v69, a58
    v_accvgpr_read_b32 v71, a62
    v_pk_fma_f32 v[56:57], v[88:89], v[32:33], v[64:65] op_sel:[0,0,0] op_sel_hi:[0,1,1]
    v_pk_fma_f32 v[58:59], v[90:91], v[34:35], v[66:67] op_sel:[0,0,0] op_sel_hi:[0,1,1]
    v_pk_fma_f32 v[60:61], v[92:93], v[36:37], v[68:69] op_sel:[0,0,0] op_sel_hi:[0,1,1]
    v_pk_fma_f32 v[62:63], v[94:95], v[38:39], v[70:71] op_sel:[0,0,0] op_sel_hi:[0,1,1]
    v_pk_fma_f32 v[32:33], v[88:89], v[32:33], v[56:57] op_sel:[1,1,0] op_sel_hi:[1,0,1] neg_lo:[1,0,0]
    v_pk_fma_f32 v[34:35], v[90:91], v[34:35], v[58:59] op_sel:[1,1,0] op_sel_hi:[1,0,1] neg_lo:[1,0,0]
    v_pk_fma_f32 v[36:37], v[92:93], v[36:37], v[60:61] op_sel:[1,1,0] op_sel_hi:[1,0,1] neg_lo:[1,0,0]
    v_pk_fma_f32 v[38:39], v[94:95], v[38:39], v[62:63] op_sel:[1,1,0] op_sel_hi:[1,0,1] neg_lo:[1,0,0]
    v_pk_mul_f32 v[40:41], v[96:97], v[32:33] op_sel:[0,0] op_sel_hi:[0,1]
    v_pk_mul_f32 v[42:43], v[98:99], v[34:35] op_sel:[0,0] op_sel_hi:[0,1]
    v_pk_mul_f32 v[44:45], v[100:101], v[36:37] op_sel:[0,0] op_sel_hi:[0,1]
    v_pk_mul_f32 v[46:47], v[102:103], v[38:39] op_sel:[0,0] op_sel_hi:[0,1]
    v_pk_fma_f32 v[72:73], v[96:97], v[32:33], v[40:41] op_sel:[1,1,0] op_sel_hi:[1,0,1] neg_lo:[1,0,0] neg_hi:[1,0,1]
    v_pk_fma_f32 v[74:75], v[98:99], v[34:35], v[42:43] op_sel:[1,1,0] op_sel_hi:[1,0,1] neg_lo:[1,0,0] neg_hi:[1,0,1]
    v_pk_fma_f32 v[76:77], v[100:101], v[36:37], v[44:45] op_sel:[1,1,0] op_sel_hi:[1,0,1] neg_lo:[1,0,0] neg_hi:[1,0,1]
    v_pk_fma_f32 v[78:79], v[102:103], v[38:39], v[46:47] op_sel:[1,1,0] op_sel_hi:[1,0,1] neg_lo:[1,0,0] neg_hi:[1,0,1]
    v_accvgpr_read_b32 v48, a35
    v_accvgpr_read_b32 v50, a39
    v_accvgpr_read_b32 v52, a43
    v_accvgpr_read_b32 v54, a47
    v_accvgpr_read_b32 v49, a51
    v_accvgpr_read_b32 v51, a55
    v_accvgpr_read_b32 v53, a59
    v_accvgpr_read_b32 v55, a63
    v_pk_fma_f32 v[56:57], v[88:89], v[32:33], v[48:49] op_sel:[0,0,0] op_sel_hi:[0,1,1]
    v_pk_fma_f32 v[58:59], v[90:91], v[34:35], v[50:51] op_sel:[0,0,0] op_sel_hi:[0,1,1]
    v_pk_fma_f32 v[60:61], v[92:93], v[36:37], v[52:53] op_sel:[0,0,0] op_sel_hi:[0,1,1]
    v_pk_fma_f32 v[62:63], v[94:95], v[38:39], v[54:55] op_sel:[0,0,0] op_sel_hi:[0,1,1]
    v_pk_fma_f32 v[32:33], v[88:89], v[32:33], v[56:57] op_sel:[1,1,0] op_sel_hi:[1,0,1] neg_lo:[1,0,0]
    v_pk_fma_f32 v[34:35], v[90:91], v[34:35], v[58:59] op_sel:[1,1,0] op_sel_hi:[1,0,1] neg_lo:[1,0,0]
    v_pk_fma_f32 v[36:37], v[92:93], v[36:37], v[60:61] op_sel:[1,1,0] op_sel_hi:[1,0,1] neg_lo:[1,0,0]
    v_pk_fma_f32 v[38:39], v[94:95], v[38:39], v[62:63] op_sel:[1,1,0] op_sel_hi:[1,0,1] neg_lo:[1,0,0]
    v_pk_mul_f32 v[40:41], v[96:97], v[32:33] op_sel:[0,0] op_sel_hi:[0,1]
    v_pk_mul_f32 v[42:43], v[98:99], v[34:35] op_sel:[0,0] op_sel_hi:[0,1]
    v_pk_mul_f32 v[44:45], v[100:101], v[36:37] op_sel:[0,0] op_sel_hi:[0,1]
    v_pk_mul_f32 v[46:47], v[102:103], v[38:39] op_sel:[0,0] op_sel_hi:[0,1]
    v_pk_fma_f32 v[80:81], v[96:97], v[32:33], v[40:41] op_sel:[1,1,0] op_sel_hi:[1,0,1] neg_lo:[1,0,0] neg_hi:[1,0,1]
    v_pk_fma_f32 v[82:83], v[98:99], v[34:35], v[42:43] op_sel:[1,1,0] op_sel_hi:[1,0,1] neg_lo:[1,0,0] neg_hi:[1,0,1]
    v_pk_fma_f32 v[84:85], v[100:101], v[36:37], v[44:45] op_sel:[1,1,0] op_sel_hi:[1,0,1] neg_lo:[1,0,0] neg_hi:[1,0,1]
    v_pk_fma_f32 v[86:87], v[102:103], v[38:39], v[46:47] op_sel:[1,1,0] op_sel_hi:[1,0,1] neg_lo:[1,0,0] neg_hi:[1,0,1]
    v_cvt_pk_bf16_f32 v131, v72, v80
    v_cvt_pk_bf16_f32 v139, v74, v82
    v_cvt_pk_bf16_f32 v147, v76, v84
    v_cvt_pk_bf16_f32 v155, v78, v86
    v_cvt_pk_bf16_f32 v195, v73, v81
    v_cvt_pk_bf16_f32 v203, v75, v83
    v_cvt_pk_bf16_f32 v211, v77, v85
    v_cvt_pk_bf16_f32 v219, v79, v87
    v_accvgpr_read_b32 v64, a64
    v_accvgpr_read_b32 v66, a68
    v_accvgpr_read_b32 v68, a72
    v_accvgpr_read_b32 v70, a76
    v_accvgpr_read_b32 v65, a80
    v_accvgpr_read_b32 v67, a84
    v_accvgpr_read_b32 v69, a88
    v_accvgpr_read_b32 v71, a92
    v_pk_fma_f32 v[56:57], v[88:89], v[32:33], v[64:65] op_sel:[0,0,0] op_sel_hi:[0,1,1]
    v_pk_fma_f32 v[58:59], v[90:91], v[34:35], v[66:67] op_sel:[0,0,0] op_sel_hi:[0,1,1]
    v_pk_fma_f32 v[60:61], v[92:93], v[36:37], v[68:69] op_sel:[0,0,0] op_sel_hi:[0,1,1]
    v_pk_fma_f32 v[62:63], v[94:95], v[38:39], v[70:71] op_sel:[0,0,0] op_sel_hi:[0,1,1]
    v_pk_fma_f32 v[32:33], v[88:89], v[32:33], v[56:57] op_sel:[1,1,0] op_sel_hi:[1,0,1] neg_lo:[1,0,0]
    v_pk_fma_f32 v[34:35], v[90:91], v[34:35], v[58:59] op_sel:[1,1,0] op_sel_hi:[1,0,1] neg_lo:[1,0,0]
    v_pk_fma_f32 v[36:37], v[92:93], v[36:37], v[60:61] op_sel:[1,1,0] op_sel_hi:[1,0,1] neg_lo:[1,0,0]
    v_pk_fma_f32 v[38:39], v[94:95], v[38:39], v[62:63] op_sel:[1,1,0] op_sel_hi:[1,0,1] neg_lo:[1,0,0]
    v_pk_mul_f32 v[40:41], v[96:97], v[32:33] op_sel:[0,0] op_sel_hi:[0,1]
    v_pk_mul_f32 v[42:43], v[98:99], v[34:35] op_sel:[0,0] op_sel_hi:[0,1]
    v_pk_mul_f32 v[44:45], v[100:101], v[36:37] op_sel:[0,0] op_sel_hi:[0,1]
    v_pk_mul_f32 v[46:47], v[102:103], v[38:39] op_sel:[0,0] op_sel_hi:[0,1]
    v_pk_fma_f32 v[72:73], v[96:97], v[32:33], v[40:41] op_sel:[1,1,0] op_sel_hi:[1,0,1] neg_lo:[1,0,0] neg_hi:[1,0,1]
    v_pk_fma_f32 v[74:75], v[98:99], v[34:35], v[42:43] op_sel:[1,1,0] op_sel_hi:[1,0,1] neg_lo:[1,0,0] neg_hi:[1,0,1]
    v_pk_fma_f32 v[76:77], v[100:101], v[36:37], v[44:45] op_sel:[1,1,0] op_sel_hi:[1,0,1] neg_lo:[1,0,0] neg_hi:[1,0,1]
    v_pk_fma_f32 v[78:79], v[102:103], v[38:39], v[46:47] op_sel:[1,1,0] op_sel_hi:[1,0,1] neg_lo:[1,0,0] neg_hi:[1,0,1]
    v_accvgpr_read_b32 v48, a65
    v_accvgpr_read_b32 v50, a69
    v_accvgpr_read_b32 v52, a73
    v_accvgpr_read_b32 v54, a77
    v_accvgpr_read_b32 v49, a81
    v_accvgpr_read_b32 v51, a85
    v_accvgpr_read_b32 v53, a89
    v_accvgpr_read_b32 v55, a93
    v_pk_fma_f32 v[56:57], v[88:89], v[32:33], v[48:49] op_sel:[0,0,0] op_sel_hi:[0,1,1]
    v_pk_fma_f32 v[58:59], v[90:91], v[34:35], v[50:51] op_sel:[0,0,0] op_sel_hi:[0,1,1]
    v_pk_fma_f32 v[60:61], v[92:93], v[36:37], v[52:53] op_sel:[0,0,0] op_sel_hi:[0,1,1]
    v_pk_fma_f32 v[62:63], v[94:95], v[38:39], v[54:55] op_sel:[0,0,0] op_sel_hi:[0,1,1]
    v_pk_fma_f32 v[32:33], v[88:89], v[32:33], v[56:57] op_sel:[1,1,0] op_sel_hi:[1,0,1] neg_lo:[1,0,0]
    v_pk_fma_f32 v[34:35], v[90:91], v[34:35], v[58:59] op_sel:[1,1,0] op_sel_hi:[1,0,1] neg_lo:[1,0,0]
    v_pk_fma_f32 v[36:37], v[92:93], v[36:37], v[60:61] op_sel:[1,1,0] op_sel_hi:[1,0,1] neg_lo:[1,0,0]
    v_pk_fma_f32 v[38:39], v[94:95], v[38:39], v[62:63] op_sel:[1,1,0] op_sel_hi:[1,0,1] neg_lo:[1,0,0]
    v_pk_mul_f32 v[40:41], v[96:97], v[32:33] op_sel:[0,0] op_sel_hi:[0,1]
    v_pk_mul_f32 v[42:43], v[98:99], v[34:35] op_sel:[0,0] op_sel_hi:[0,1]
    v_pk_mul_f32 v[44:45], v[100:101], v[36:37] op_sel:[0,0] op_sel_hi:[0,1]
    v_pk_mul_f32 v[46:47], v[102:103], v[38:39] op_sel:[0,0] op_sel_hi:[0,1]
    v_pk_fma_f32 v[80:81], v[96:97], v[32:33], v[40:41] op_sel:[1,1,0] op_sel_hi:[1,0,1] neg_lo:[1,0,0] neg_hi:[1,0,1]
    v_pk_fma_f32 v[82:83], v[98:99], v[34:35], v[42:43] op_sel:[1,1,0] op_sel_hi:[1,0,1] neg_lo:[1,0,0] neg_hi:[1,0,1]
    v_pk_fma_f32 v[84:85], v[100:101], v[36:37], v[44:45] op_sel:[1,1,0] op_sel_hi:[1,0,1] neg_lo:[1,0,0] neg_hi:[1,0,1]
    v_pk_fma_f32 v[86:87], v[102:103], v[38:39], v[46:47] op_sel:[1,1,0] op_sel_hi:[1,0,1] neg_lo:[1,0,0] neg_hi:[1,0,1]
    v_cvt_pk_bf16_f32 v132, v72, v80
    v_cvt_pk_bf16_f32 v140, v74, v82
    v_cvt_pk_bf16_f32 v148, v76, v84
    v_cvt_pk_bf16_f32 v156, v78, v86
    v_cvt_pk_bf16_f32 v196, v73, v81
    v_cvt_pk_bf16_f32 v204, v75, v83
    v_cvt_pk_bf16_f32 v212, v77, v85
    v_cvt_pk_bf16_f32 v220, v79, v87
    v_accvgpr_read_b32 v64, a66
    v_accvgpr_read_b32 v66, a70
    v_accvgpr_read_b32 v68, a74
    v_accvgpr_read_b32 v70, a78
    v_accvgpr_read_b32 v65, a82
    v_accvgpr_read_b32 v67, a86
    v_accvgpr_read_b32 v69, a90
    v_accvgpr_read_b32 v71, a94
    v_pk_fma_f32 v[56:57], v[88:89], v[32:33], v[64:65] op_sel:[0,0,0] op_sel_hi:[0,1,1]
    v_pk_fma_f32 v[58:59], v[90:91], v[34:35], v[66:67] op_sel:[0,0,0] op_sel_hi:[0,1,1]
    v_pk_fma_f32 v[60:61], v[92:93], v[36:37], v[68:69] op_sel:[0,0,0] op_sel_hi:[0,1,1]
    v_pk_fma_f32 v[62:63], v[94:95], v[38:39], v[70:71] op_sel:[0,0,0] op_sel_hi:[0,1,1]
    v_pk_fma_f32 v[32:33], v[88:89], v[32:33], v[56:57] op_sel:[1,1,0] op_sel_hi:[1,0,1] neg_lo:[1,0,0]
    v_pk_fma_f32 v[34:35], v[90:91], v[34:35], v[58:59] op_sel:[1,1,0] op_sel_hi:[1,0,1] neg_lo:[1,0,0]
    v_pk_fma_f32 v[36:37], v[92:93], v[36:37], v[60:61] op_sel:[1,1,0] op_sel_hi:[1,0,1] neg_lo:[1,0,0]
    v_pk_fma_f32 v[38:39], v[94:95], v[38:39], v[62:63] op_sel:[1,1,0] op_sel_hi:[1,0,1] neg_lo:[1,0,0]
    v_pk_mul_f32 v[40:41], v[96:97], v[32:33] op_sel:[0,0] op_sel_hi:[0,1]
    v_pk_mul_f32 v[42:43], v[98:99], v[34:35] op_sel:[0,0] op_sel_hi:[0,1]
    v_pk_mul_f32 v[44:45], v[100:101], v[36:37] op_sel:[0,0] op_sel_hi:[0,1]
    v_pk_mul_f32 v[46:47], v[102:103], v[38:39] op_sel:[0,0] op_sel_hi:[0,1]
    v_pk_fma_f32 v[72:73], v[96:97], v[32:33], v[40:41] op_sel:[1,1,0] op_sel_hi:[1,0,1] neg_lo:[1,0,0] neg_hi:[1,0,1]
    v_pk_fma_f32 v[74:75], v[98:99], v[34:35], v[42:43] op_sel:[1,1,0] op_sel_hi:[1,0,1] neg_lo:[1,0,0] neg_hi:[1,0,1]
    v_pk_fma_f32 v[76:77], v[100:101], v[36:37], v[44:45] op_sel:[1,1,0] op_sel_hi:[1,0,1] neg_lo:[1,0,0] neg_hi:[1,0,1]
    v_pk_fma_f32 v[78:79], v[102:103], v[38:39], v[46:47] op_sel:[1,1,0] op_sel_hi:[1,0,1] neg_lo:[1,0,0] neg_hi:[1,0,1]
    v_accvgpr_read_b32 v48, a67
    v_accvgpr_read_b32 v50, a71
    v_accvgpr_read_b32 v52, a75
    v_accvgpr_read_b32 v54, a79
    v_accvgpr_read_b32 v49, a83
    v_accvgpr_read_b32 v51, a87
    v_accvgpr_read_b32 v53, a91
    v_accvgpr_read_b32 v55, a95
    v_pk_fma_f32 v[56:57], v[88:89], v[32:33], v[48:49] op_sel:[0,0,0] op_sel_hi:[0,1,1]
    v_pk_fma_f32 v[58:59], v[90:91], v[34:35], v[50:51] op_sel:[0,0,0] op_sel_hi:[0,1,1]
    v_pk_fma_f32 v[60:61], v[92:93], v[36:37], v[52:53] op_sel:[0,0,0] op_sel_hi:[0,1,1]
    v_pk_fma_f32 v[62:63], v[94:95], v[38:39], v[54:55] op_sel:[0,0,0] op_sel_hi:[0,1,1]
    v_pk_fma_f32 v[32:33], v[88:89], v[32:33], v[56:57] op_sel:[1,1,0] op_sel_hi:[1,0,1] neg_lo:[1,0,0]
    v_pk_fma_f32 v[34:35], v[90:91], v[34:35], v[58:59] op_sel:[1,1,0] op_sel_hi:[1,0,1] neg_lo:[1,0,0]
    v_pk_fma_f32 v[36:37], v[92:93], v[36:37], v[60:61] op_sel:[1,1,0] op_sel_hi:[1,0,1] neg_lo:[1,0,0]
    v_pk_fma_f32 v[38:39], v[94:95], v[38:39], v[62:63] op_sel:[1,1,0] op_sel_hi:[1,0,1] neg_lo:[1,0,0]
    v_pk_mul_f32 v[40:41], v[96:97], v[32:33] op_sel:[0,0] op_sel_hi:[0,1]
    v_pk_mul_f32 v[42:43], v[98:99], v[34:35] op_sel:[0,0] op_sel_hi:[0,1]
    v_pk_mul_f32 v[44:45], v[100:101], v[36:37] op_sel:[0,0] op_sel_hi:[0,1]
    v_pk_mul_f32 v[46:47], v[102:103], v[38:39] op_sel:[0,0] op_sel_hi:[0,1]
    v_pk_fma_f32 v[80:81], v[96:97], v[32:33], v[40:41] op_sel:[1,1,0] op_sel_hi:[1,0,1] neg_lo:[1,0,0] neg_hi:[1,0,1]
    v_pk_fma_f32 v[82:83], v[98:99], v[34:35], v[42:43] op_sel:[1,1,0] op_sel_hi:[1,0,1] neg_lo:[1,0,0] neg_hi:[1,0,1]
    v_pk_fma_f32 v[84:85], v[100:101], v[36:37], v[44:45] op_sel:[1,1,0] op_sel_hi:[1,0,1] neg_lo:[1,0,0] neg_hi:[1,0,1]
    v_pk_fma_f32 v[86:87], v[102:103], v[38:39], v[46:47] op_sel:[1,1,0] op_sel_hi:[1,0,1] neg_lo:[1,0,0] neg_hi:[1,0,1]
    v_cvt_pk_bf16_f32 v133, v72, v80
    v_cvt_pk_bf16_f32 v141, v74, v82
    v_cvt_pk_bf16_f32 v149, v76, v84
    v_cvt_pk_bf16_f32 v157, v78, v86
    v_cvt_pk_bf16_f32 v197, v73, v81
    v_cvt_pk_bf16_f32 v205, v75, v83
    v_cvt_pk_bf16_f32 v213, v77, v85
    v_cvt_pk_bf16_f32 v221, v79, v87
    v_accvgpr_read_b32 v64, a96
    v_accvgpr_read_b32 v66, a100
    v_accvgpr_read_b32 v68, a104
    v_accvgpr_read_b32 v70, a108
    v_accvgpr_read_b32 v65, a112
    v_accvgpr_read_b32 v67, a116
    v_accvgpr_read_b32 v69, a120
    v_accvgpr_read_b32 v71, a124
    v_pk_fma_f32 v[56:57], v[88:89], v[32:33], v[64:65] op_sel:[0,0,0] op_sel_hi:[0,1,1]
    v_pk_fma_f32 v[58:59], v[90:91], v[34:35], v[66:67] op_sel:[0,0,0] op_sel_hi:[0,1,1]
    v_pk_fma_f32 v[60:61], v[92:93], v[36:37], v[68:69] op_sel:[0,0,0] op_sel_hi:[0,1,1]
    v_pk_fma_f32 v[62:63], v[94:95], v[38:39], v[70:71] op_sel:[0,0,0] op_sel_hi:[0,1,1]
    v_pk_fma_f32 v[32:33], v[88:89], v[32:33], v[56:57] op_sel:[1,1,0] op_sel_hi:[1,0,1] neg_lo:[1,0,0]
    v_pk_fma_f32 v[34:35], v[90:91], v[34:35], v[58:59] op_sel:[1,1,0] op_sel_hi:[1,0,1] neg_lo:[1,0,0]
    v_pk_fma_f32 v[36:37], v[92:93], v[36:37], v[60:61] op_sel:[1,1,0] op_sel_hi:[1,0,1] neg_lo:[1,0,0]
    v_pk_fma_f32 v[38:39], v[94:95], v[38:39], v[62:63] op_sel:[1,1,0] op_sel_hi:[1,0,1] neg_lo:[1,0,0]
    v_pk_mul_f32 v[40:41], v[96:97], v[32:33] op_sel:[0,0] op_sel_hi:[0,1]
    v_pk_mul_f32 v[42:43], v[98:99], v[34:35] op_sel:[0,0] op_sel_hi:[0,1]
    v_pk_mul_f32 v[44:45], v[100:101], v[36:37] op_sel:[0,0] op_sel_hi:[0,1]
    v_pk_mul_f32 v[46:47], v[102:103], v[38:39] op_sel:[0,0] op_sel_hi:[0,1]
    v_pk_fma_f32 v[72:73], v[96:97], v[32:33], v[40:41] op_sel:[1,1,0] op_sel_hi:[1,0,1] neg_lo:[1,0,0] neg_hi:[1,0,1]
    v_pk_fma_f32 v[74:75], v[98:99], v[34:35], v[42:43] op_sel:[1,1,0] op_sel_hi:[1,0,1] neg_lo:[1,0,0] neg_hi:[1,0,1]
    v_pk_fma_f32 v[76:77], v[100:101], v[36:37], v[44:45] op_sel:[1,1,0] op_sel_hi:[1,0,1] neg_lo:[1,0,0] neg_hi:[1,0,1]
    v_pk_fma_f32 v[78:79], v[102:103], v[38:39], v[46:47] op_sel:[1,1,0] op_sel_hi:[1,0,1] neg_lo:[1,0,0] neg_hi:[1,0,1]
    v_accvgpr_read_b32 v48, a97
    v_accvgpr_read_b32 v50, a101
    v_accvgpr_read_b32 v52, a105
    v_accvgpr_read_b32 v54, a109
    v_accvgpr_read_b32 v49, a113
    v_accvgpr_read_b32 v51, a117
    v_accvgpr_read_b32 v53, a121
    v_accvgpr_read_b32 v55, a125
    v_pk_fma_f32 v[56:57], v[88:89], v[32:33], v[48:49] op_sel:[0,0,0] op_sel_hi:[0,1,1]
    v_pk_fma_f32 v[58:59], v[90:91], v[34:35], v[50:51] op_sel:[0,0,0] op_sel_hi:[0,1,1]
    v_pk_fma_f32 v[60:61], v[92:93], v[36:37], v[52:53] op_sel:[0,0,0] op_sel_hi:[0,1,1]
    v_pk_fma_f32 v[62:63], v[94:95], v[38:39], v[54:55] op_sel:[0,0,0] op_sel_hi:[0,1,1]
    v_pk_fma_f32 v[32:33], v[88:89], v[32:33], v[56:57] op_sel:[1,1,0] op_sel_hi:[1,0,1] neg_lo:[1,0,0]
    v_pk_fma_f32 v[34:35], v[90:91], v[34:35], v[58:59] op_sel:[1,1,0] op_sel_hi:[1,0,1] neg_lo:[1,0,0]
    v_pk_fma_f32 v[36:37], v[92:93], v[36:37], v[60:61] op_sel:[1,1,0] op_sel_hi:[1,0,1] neg_lo:[1,0,0]
    v_pk_fma_f32 v[38:39], v[94:95], v[38:39], v[62:63] op_sel:[1,1,0] op_sel_hi:[1,0,1] neg_lo:[1,0,0]
    v_pk_mul_f32 v[40:41], v[96:97], v[32:33] op_sel:[0,0] op_sel_hi:[0,1]
    v_pk_mul_f32 v[42:43], v[98:99], v[34:35] op_sel:[0,0] op_sel_hi:[0,1]
    v_pk_mul_f32 v[44:45], v[100:101], v[36:37] op_sel:[0,0] op_sel_hi:[0,1]
    v_pk_mul_f32 v[46:47], v[102:103], v[38:39] op_sel:[0,0] op_sel_hi:[0,1]
    v_pk_fma_f32 v[80:81], v[96:97], v[32:33], v[40:41] op_sel:[1,1,0] op_sel_hi:[1,0,1] neg_lo:[1,0,0] neg_hi:[1,0,1]
    v_pk_fma_f32 v[82:83], v[98:99], v[34:35], v[42:43] op_sel:[1,1,0] op_sel_hi:[1,0,1] neg_lo:[1,0,0] neg_hi:[1,0,1]
    v_pk_fma_f32 v[84:85], v[100:101], v[36:37], v[44:45] op_sel:[1,1,0] op_sel_hi:[1,0,1] neg_lo:[1,0,0] neg_hi:[1,0,1]
    v_pk_fma_f32 v[86:87], v[102:103], v[38:39], v[46:47] op_sel:[1,1,0] op_sel_hi:[1,0,1] neg_lo:[1,0,0] neg_hi:[1,0,1]
    v_cvt_pk_bf16_f32 v134, v72, v80
    v_cvt_pk_bf16_f32 v142, v74, v82
    v_cvt_pk_bf16_f32 v150, v76, v84
    v_cvt_pk_bf16_f32 v158, v78, v86
    v_cvt_pk_bf16_f32 v198, v73, v81
    v_cvt_pk_bf16_f32 v206, v75, v83
    v_cvt_pk_bf16_f32 v214, v77, v85
    v_cvt_pk_bf16_f32 v222, v79, v87
    v_accvgpr_read_b32 v64, a98
    v_accvgpr_read_b32 v66, a102
    v_accvgpr_read_b32 v68, a106
    v_accvgpr_read_b32 v70, a110
    v_accvgpr_read_b32 v65, a114
    v_accvgpr_read_b32 v67, a118
    v_accvgpr_read_b32 v69, a122
    v_accvgpr_read_b32 v71, a126
    v_pk_fma_f32 v[56:57], v[88:89], v[32:33], v[64:65] op_sel:[0,0,0] op_sel_hi:[0,1,1]
    v_pk_fma_f32 v[58:59], v[90:91], v[34:35], v[66:67] op_sel:[0,0,0] op_sel_hi:[0,1,1]
    v_pk_fma_f32 v[60:61], v[92:93], v[36:37], v[68:69] op_sel:[0,0,0] op_sel_hi:[0,1,1]
    v_pk_fma_f32 v[62:63], v[94:95], v[38:39], v[70:71] op_sel:[0,0,0] op_sel_hi:[0,1,1]
    v_pk_fma_f32 v[32:33], v[88:89], v[32:33], v[56:57] op_sel:[1,1,0] op_sel_hi:[1,0,1] neg_lo:[1,0,0]
    v_pk_fma_f32 v[34:35], v[90:91], v[34:35], v[58:59] op_sel:[1,1,0] op_sel_hi:[1,0,1] neg_lo:[1,0,0]
    v_pk_fma_f32 v[36:37], v[92:93], v[36:37], v[60:61] op_sel:[1,1,0] op_sel_hi:[1,0,1] neg_lo:[1,0,0]
    v_pk_fma_f32 v[38:39], v[94:95], v[38:39], v[62:63] op_sel:[1,1,0] op_sel_hi:[1,0,1] neg_lo:[1,0,0]
    v_pk_mul_f32 v[40:41], v[96:97], v[32:33] op_sel:[0,0] op_sel_hi:[0,1]
    v_pk_mul_f32 v[42:43], v[98:99], v[34:35] op_sel:[0,0] op_sel_hi:[0,1]
    v_pk_mul_f32 v[44:45], v[100:101], v[36:37] op_sel:[0,0] op_sel_hi:[0,1]
    v_pk_mul_f32 v[46:47], v[102:103], v[38:39] op_sel:[0,0] op_sel_hi:[0,1]
    v_pk_fma_f32 v[72:73], v[96:97], v[32:33], v[40:41] op_sel:[1,1,0] op_sel_hi:[1,0,1] neg_lo:[1,0,0] neg_hi:[1,0,1]
    v_pk_fma_f32 v[74:75], v[98:99], v[34:35], v[42:43] op_sel:[1,1,0] op_sel_hi:[1,0,1] neg_lo:[1,0,0] neg_hi:[1,0,1]
    v_pk_fma_f32 v[76:77], v[100:101], v[36:37], v[44:45] op_sel:[1,1,0] op_sel_hi:[1,0,1] neg_lo:[1,0,0] neg_hi:[1,0,1]
    v_pk_fma_f32 v[78:79], v[102:103], v[38:39], v[46:47] op_sel:[1,1,0] op_sel_hi:[1,0,1] neg_lo:[1,0,0] neg_hi:[1,0,1]
    v_accvgpr_read_b32 v48, a99
    v_accvgpr_read_b32 v50, a103
    v_accvgpr_read_b32 v52, a107
    v_accvgpr_read_b32 v54, a111
    v_accvgpr_read_b32 v49, a115
    v_accvgpr_read_b32 v51, a119
    v_accvgpr_read_b32 v53, a123
    v_accvgpr_read_b32 v55, a127
    v_pk_fma_f32 v[56:57], v[88:89], v[32:33], v[48:49] op_sel:[0,0,0] op_sel_hi:[0,1,1]
    v_pk_fma_f32 v[58:59], v[90:91], v[34:35], v[50:51] op_sel:[0,0,0] op_sel_hi:[0,1,1]
    v_pk_fma_f32 v[60:61], v[92:93], v[36:37], v[52:53] op_sel:[0,0,0] op_sel_hi:[0,1,1]
    v_pk_fma_f32 v[62:63], v[94:95], v[38:39], v[54:55] op_sel:[0,0,0] op_sel_hi:[0,1,1]
    v_pk_fma_f32 v[32:33], v[88:89], v[32:33], v[56:57] op_sel:[1,1,0] op_sel_hi:[1,0,1] neg_lo:[1,0,0]
    v_pk_fma_f32 v[34:35], v[90:91], v[34:35], v[58:59] op_sel:[1,1,0] op_sel_hi:[1,0,1] neg_lo:[1,0,0]
    v_pk_fma_f32 v[36:37], v[92:93], v[36:37], v[60:61] op_sel:[1,1,0] op_sel_hi:[1,0,1] neg_lo:[1,0,0]
    v_pk_fma_f32 v[38:39], v[94:95], v[38:39], v[62:63] op_sel:[1,1,0] op_sel_hi:[1,0,1] neg_lo:[1,0,0]
    v_pk_mul_f32 v[40:41], v[96:97], v[32:33] op_sel:[0,0] op_sel_hi:[0,1]
    v_pk_mul_f32 v[42:43], v[98:99], v[34:35] op_sel:[0,0] op_sel_hi:[0,1]
    v_pk_mul_f32 v[44:45], v[100:101], v[36:37] op_sel:[0,0] op_sel_hi:[0,1]
    v_pk_mul_f32 v[46:47], v[102:103], v[38:39] op_sel:[0,0] op_sel_hi:[0,1]
    v_pk_fma_f32 v[80:81], v[96:97], v[32:33], v[40:41] op_sel:[1,1,0] op_sel_hi:[1,0,1] neg_lo:[1,0,0] neg_hi:[1,0,1]
    v_pk_fma_f32 v[82:83], v[98:99], v[34:35], v[42:43] op_sel:[1,1,0] op_sel_hi:[1,0,1] neg_lo:[1,0,0] neg_hi:[1,0,1]
    v_pk_fma_f32 v[84:85], v[100:101], v[36:37], v[44:45] op_sel:[1,1,0] op_sel_hi:[1,0,1] neg_lo:[1,0,0] neg_hi:[1,0,1]
    v_pk_fma_f32 v[86:87], v[102:103], v[38:39], v[46:47] op_sel:[1,1,0] op_sel_hi:[1,0,1] neg_lo:[1,0,0] neg_hi:[1,0,1]
    v_cvt_pk_bf16_f32 v135, v72, v80
    v_cvt_pk_bf16_f32 v143, v74, v82
    v_cvt_pk_bf16_f32 v151, v76, v84
    v_cvt_pk_bf16_f32 v159, v78, v86
    v_cvt_pk_bf16_f32 v199, v73, v81
    v_cvt_pk_bf16_f32 v207, v75, v83
    v_cvt_pk_bf16_f32 v215, v77, v85
    v_cvt_pk_bf16_f32 v223, v79, v87
    v_accvgpr_read_b32 v64, a128
    v_accvgpr_read_b32 v66, a132
    v_accvgpr_read_b32 v68, a136
    v_accvgpr_read_b32 v70, a140
    v_accvgpr_read_b32 v65, a144
    v_accvgpr_read_b32 v67, a148
    v_accvgpr_read_b32 v69, a152
    v_accvgpr_read_b32 v71, a156
    v_pk_fma_f32 v[56:57], v[88:89], v[32:33], v[64:65] op_sel:[0,0,0] op_sel_hi:[0,1,1]
    v_pk_fma_f32 v[58:59], v[90:91], v[34:35], v[66:67] op_sel:[0,0,0] op_sel_hi:[0,1,1]
    v_pk_fma_f32 v[60:61], v[92:93], v[36:37], v[68:69] op_sel:[0,0,0] op_sel_hi:[0,1,1]
    v_pk_fma_f32 v[62:63], v[94:95], v[38:39], v[70:71] op_sel:[0,0,0] op_sel_hi:[0,1,1]
    v_pk_fma_f32 v[32:33], v[88:89], v[32:33], v[56:57] op_sel:[1,1,0] op_sel_hi:[1,0,1] neg_lo:[1,0,0]
    v_pk_fma_f32 v[34:35], v[90:91], v[34:35], v[58:59] op_sel:[1,1,0] op_sel_hi:[1,0,1] neg_lo:[1,0,0]
    v_pk_fma_f32 v[36:37], v[92:93], v[36:37], v[60:61] op_sel:[1,1,0] op_sel_hi:[1,0,1] neg_lo:[1,0,0]
    v_pk_fma_f32 v[38:39], v[94:95], v[38:39], v[62:63] op_sel:[1,1,0] op_sel_hi:[1,0,1] neg_lo:[1,0,0]
    v_pk_mul_f32 v[40:41], v[96:97], v[32:33] op_sel:[0,0] op_sel_hi:[0,1]
    v_pk_mul_f32 v[42:43], v[98:99], v[34:35] op_sel:[0,0] op_sel_hi:[0,1]
    v_pk_mul_f32 v[44:45], v[100:101], v[36:37] op_sel:[0,0] op_sel_hi:[0,1]
    v_pk_mul_f32 v[46:47], v[102:103], v[38:39] op_sel:[0,0] op_sel_hi:[0,1]
    v_pk_fma_f32 v[72:73], v[96:97], v[32:33], v[40:41] op_sel:[1,1,0] op_sel_hi:[1,0,1] neg_lo:[1,0,0] neg_hi:[1,0,1]
    v_pk_fma_f32 v[74:75], v[98:99], v[34:35], v[42:43] op_sel:[1,1,0] op_sel_hi:[1,0,1] neg_lo:[1,0,0] neg_hi:[1,0,1]
    v_pk_fma_f32 v[76:77], v[100:101], v[36:37], v[44:45] op_sel:[1,1,0] op_sel_hi:[1,0,1] neg_lo:[1,0,0] neg_hi:[1,0,1]
    v_pk_fma_f32 v[78:79], v[102:103], v[38:39], v[46:47] op_sel:[1,1,0] op_sel_hi:[1,0,1] neg_lo:[1,0,0] neg_hi:[1,0,1]
    v_accvgpr_read_b32 v48, a129
    v_accvgpr_read_b32 v50, a133
    v_accvgpr_read_b32 v52, a137
    v_accvgpr_read_b32 v54, a141
    v_accvgpr_read_b32 v49, a145
    v_accvgpr_read_b32 v51, a149
    v_accvgpr_read_b32 v53, a153
    v_accvgpr_read_b32 v55, a157
    v_pk_fma_f32 v[56:57], v[88:89], v[32:33], v[48:49] op_sel:[0,0,0] op_sel_hi:[0,1,1]
    v_pk_fma_f32 v[58:59], v[90:91], v[34:35], v[50:51] op_sel:[0,0,0] op_sel_hi:[0,1,1]
    v_pk_fma_f32 v[60:61], v[92:93], v[36:37], v[52:53] op_sel:[0,0,0] op_sel_hi:[0,1,1]
    v_pk_fma_f32 v[62:63], v[94:95], v[38:39], v[54:55] op_sel:[0,0,0] op_sel_hi:[0,1,1]
    v_pk_fma_f32 v[32:33], v[88:89], v[32:33], v[56:57] op_sel:[1,1,0] op_sel_hi:[1,0,1] neg_lo:[1,0,0]
    v_pk_fma_f32 v[34:35], v[90:91], v[34:35], v[58:59] op_sel:[1,1,0] op_sel_hi:[1,0,1] neg_lo:[1,0,0]
    v_pk_fma_f32 v[36:37], v[92:93], v[36:37], v[60:61] op_sel:[1,1,0] op_sel_hi:[1,0,1] neg_lo:[1,0,0]
    v_pk_fma_f32 v[38:39], v[94:95], v[38:39], v[62:63] op_sel:[1,1,0] op_sel_hi:[1,0,1] neg_lo:[1,0,0]
    v_pk_mul_f32 v[40:41], v[96:97], v[32:33] op_sel:[0,0] op_sel_hi:[0,1]
    v_pk_mul_f32 v[42:43], v[98:99], v[34:35] op_sel:[0,0] op_sel_hi:[0,1]
    v_pk_mul_f32 v[44:45], v[100:101], v[36:37] op_sel:[0,0] op_sel_hi:[0,1]
    v_pk_mul_f32 v[46:47], v[102:103], v[38:39] op_sel:[0,0] op_sel_hi:[0,1]
    v_pk_fma_f32 v[80:81], v[96:97], v[32:33], v[40:41] op_sel:[1,1,0] op_sel_hi:[1,0,1] neg_lo:[1,0,0] neg_hi:[1,0,1]
    v_pk_fma_f32 v[82:83], v[98:99], v[34:35], v[42:43] op_sel:[1,1,0] op_sel_hi:[1,0,1] neg_lo:[1,0,0] neg_hi:[1,0,1]
    v_pk_fma_f32 v[84:85], v[100:101], v[36:37], v[44:45] op_sel:[1,1,0] op_sel_hi:[1,0,1] neg_lo:[1,0,0] neg_hi:[1,0,1]
    v_pk_fma_f32 v[86:87], v[102:103], v[38:39], v[46:47] op_sel:[1,1,0] op_sel_hi:[1,0,1] neg_lo:[1,0,0] neg_hi:[1,0,1]
    v_cvt_pk_bf16_f32 v160, v72, v80
    v_cvt_pk_bf16_f32 v168, v74, v82
    v_cvt_pk_bf16_f32 v176, v76, v84
    v_cvt_pk_bf16_f32 v184, v78, v86
    v_cvt_pk_bf16_f32 v224, v73, v81
    v_cvt_pk_bf16_f32 v232, v75, v83
    v_cvt_pk_bf16_f32 v240, v77, v85
    v_cvt_pk_bf16_f32 v248, v79, v87
    v_accvgpr_read_b32 v64, a130
    v_accvgpr_read_b32 v66, a134
    v_accvgpr_read_b32 v68, a138
    v_accvgpr_read_b32 v70, a142
    v_accvgpr_read_b32 v65, a146
    v_accvgpr_read_b32 v67, a150
    v_accvgpr_read_b32 v69, a154
    v_accvgpr_read_b32 v71, a158
    v_pk_fma_f32 v[56:57], v[88:89], v[32:33], v[64:65] op_sel:[0,0,0] op_sel_hi:[0,1,1]
    v_pk_fma_f32 v[58:59], v[90:91], v[34:35], v[66:67] op_sel:[0,0,0] op_sel_hi:[0,1,1]
    v_pk_fma_f32 v[60:61], v[92:93], v[36:37], v[68:69] op_sel:[0,0,0] op_sel_hi:[0,1,1]
    v_pk_fma_f32 v[62:63], v[94:95], v[38:39], v[70:71] op_sel:[0,0,0] op_sel_hi:[0,1,1]
    v_pk_fma_f32 v[32:33], v[88:89], v[32:33], v[56:57] op_sel:[1,1,0] op_sel_hi:[1,0,1] neg_lo:[1,0,0]
    v_pk_fma_f32 v[34:35], v[90:91], v[34:35], v[58:59] op_sel:[1,1,0] op_sel_hi:[1,0,1] neg_lo:[1,0,0]
    v_pk_fma_f32 v[36:37], v[92:93], v[36:37], v[60:61] op_sel:[1,1,0] op_sel_hi:[1,0,1] neg_lo:[1,0,0]
    v_pk_fma_f32 v[38:39], v[94:95], v[38:39], v[62:63] op_sel:[1,1,0] op_sel_hi:[1,0,1] neg_lo:[1,0,0]
    v_pk_mul_f32 v[40:41], v[96:97], v[32:33] op_sel:[0,0] op_sel_hi:[0,1]
    v_pk_mul_f32 v[42:43], v[98:99], v[34:35] op_sel:[0,0] op_sel_hi:[0,1]
    v_pk_mul_f32 v[44:45], v[100:101], v[36:37] op_sel:[0,0] op_sel_hi:[0,1]
    v_pk_mul_f32 v[46:47], v[102:103], v[38:39] op_sel:[0,0] op_sel_hi:[0,1]
    v_pk_fma_f32 v[72:73], v[96:97], v[32:33], v[40:41] op_sel:[1,1,0] op_sel_hi:[1,0,1] neg_lo:[1,0,0] neg_hi:[1,0,1]
    v_pk_fma_f32 v[74:75], v[98:99], v[34:35], v[42:43] op_sel:[1,1,0] op_sel_hi:[1,0,1] neg_lo:[1,0,0] neg_hi:[1,0,1]
    v_pk_fma_f32 v[76:77], v[100:101], v[36:37], v[44:45] op_sel:[1,1,0] op_sel_hi:[1,0,1] neg_lo:[1,0,0] neg_hi:[1,0,1]
    v_pk_fma_f32 v[78:79], v[102:103], v[38:39], v[46:47] op_sel:[1,1,0] op_sel_hi:[1,0,1] neg_lo:[1,0,0] neg_hi:[1,0,1]
    v_accvgpr_read_b32 v48, a131
    v_accvgpr_read_b32 v50, a135
    v_accvgpr_read_b32 v52, a139
    v_accvgpr_read_b32 v54, a143
    v_accvgpr_read_b32 v49, a147
    v_accvgpr_read_b32 v51, a151
    v_accvgpr_read_b32 v53, a155
    v_accvgpr_read_b32 v55, a159
    v_pk_fma_f32 v[56:57], v[88:89], v[32:33], v[48:49] op_sel:[0,0,0] op_sel_hi:[0,1,1]
    v_pk_fma_f32 v[58:59], v[90:91], v[34:35], v[50:51] op_sel:[0,0,0] op_sel_hi:[0,1,1]
    v_pk_fma_f32 v[60:61], v[92:93], v[36:37], v[52:53] op_sel:[0,0,0] op_sel_hi:[0,1,1]
    v_pk_fma_f32 v[62:63], v[94:95], v[38:39], v[54:55] op_sel:[0,0,0] op_sel_hi:[0,1,1]
    v_pk_fma_f32 v[32:33], v[88:89], v[32:33], v[56:57] op_sel:[1,1,0] op_sel_hi:[1,0,1] neg_lo:[1,0,0]
    v_pk_fma_f32 v[34:35], v[90:91], v[34:35], v[58:59] op_sel:[1,1,0] op_sel_hi:[1,0,1] neg_lo:[1,0,0]
    v_pk_fma_f32 v[36:37], v[92:93], v[36:37], v[60:61] op_sel:[1,1,0] op_sel_hi:[1,0,1] neg_lo:[1,0,0]
    v_pk_fma_f32 v[38:39], v[94:95], v[38:39], v[62:63] op_sel:[1,1,0] op_sel_hi:[1,0,1] neg_lo:[1,0,0]
    v_pk_mul_f32 v[40:41], v[96:97], v[32:33] op_sel:[0,0] op_sel_hi:[0,1]
    v_pk_mul_f32 v[42:43], v[98:99], v[34:35] op_sel:[0,0] op_sel_hi:[0,1]
    v_pk_mul_f32 v[44:45], v[100:101], v[36:37] op_sel:[0,0] op_sel_hi:[0,1]
    v_pk_mul_f32 v[46:47], v[102:103], v[38:39] op_sel:[0,0] op_sel_hi:[0,1]
    v_pk_fma_f32 v[80:81], v[96:97], v[32:33], v[40:41] op_sel:[1,1,0] op_sel_hi:[1,0,1] neg_lo:[1,0,0] neg_hi:[1,0,1]
    v_pk_fma_f32 v[82:83], v[98:99], v[34:35], v[42:43] op_sel:[1,1,0] op_sel_hi:[1,0,1] neg_lo:[1,0,0] neg_hi:[1,0,1]
    v_pk_fma_f32 v[84:85], v[100:101], v[36:37], v[44:45] op_sel:[1,1,0] op_sel_hi:[1,0,1] neg_lo:[1,0,0] neg_hi:[1,0,1]
    v_pk_fma_f32 v[86:87], v[102:103], v[38:39], v[46:47] op_sel:[1,1,0] op_sel_hi:[1,0,1] neg_lo:[1,0,0] neg_hi:[1,0,1]
    v_cvt_pk_bf16_f32 v161, v72, v80
    v_cvt_pk_bf16_f32 v169, v74, v82
    v_cvt_pk_bf16_f32 v177, v76, v84
    v_cvt_pk_bf16_f32 v185, v78, v86
    v_cvt_pk_bf16_f32 v225, v73, v81
    v_cvt_pk_bf16_f32 v233, v75, v83
    v_cvt_pk_bf16_f32 v241, v77, v85
    v_cvt_pk_bf16_f32 v249, v79, v87
    v_accvgpr_read_b32 v64, a160
    v_accvgpr_read_b32 v66, a164
    v_accvgpr_read_b32 v68, a168
    v_accvgpr_read_b32 v70, a172
    v_accvgpr_read_b32 v65, a176
    v_accvgpr_read_b32 v67, a180
    v_accvgpr_read_b32 v69, a184
    v_accvgpr_read_b32 v71, a188
    v_pk_fma_f32 v[56:57], v[88:89], v[32:33], v[64:65] op_sel:[0,0,0] op_sel_hi:[0,1,1]
    v_pk_fma_f32 v[58:59], v[90:91], v[34:35], v[66:67] op_sel:[0,0,0] op_sel_hi:[0,1,1]
    v_pk_fma_f32 v[60:61], v[92:93], v[36:37], v[68:69] op_sel:[0,0,0] op_sel_hi:[0,1,1]
    v_pk_fma_f32 v[62:63], v[94:95], v[38:39], v[70:71] op_sel:[0,0,0] op_sel_hi:[0,1,1]
    v_pk_fma_f32 v[32:33], v[88:89], v[32:33], v[56:57] op_sel:[1,1,0] op_sel_hi:[1,0,1] neg_lo:[1,0,0]
    v_pk_fma_f32 v[34:35], v[90:91], v[34:35], v[58:59] op_sel:[1,1,0] op_sel_hi:[1,0,1] neg_lo:[1,0,0]
    v_pk_fma_f32 v[36:37], v[92:93], v[36:37], v[60:61] op_sel:[1,1,0] op_sel_hi:[1,0,1] neg_lo:[1,0,0]
    v_pk_fma_f32 v[38:39], v[94:95], v[38:39], v[62:63] op_sel:[1,1,0] op_sel_hi:[1,0,1] neg_lo:[1,0,0]
    v_pk_mul_f32 v[40:41], v[96:97], v[32:33] op_sel:[0,0] op_sel_hi:[0,1]
    v_pk_mul_f32 v[42:43], v[98:99], v[34:35] op_sel:[0,0] op_sel_hi:[0,1]
    v_pk_mul_f32 v[44:45], v[100:101], v[36:37] op_sel:[0,0] op_sel_hi:[0,1]
    v_pk_mul_f32 v[46:47], v[102:103], v[38:39] op_sel:[0,0] op_sel_hi:[0,1]
    v_pk_fma_f32 v[72:73], v[96:97], v[32:33], v[40:41] op_sel:[1,1,0] op_sel_hi:[1,0,1] neg_lo:[1,0,0] neg_hi:[1,0,1]
    v_pk_fma_f32 v[74:75], v[98:99], v[34:35], v[42:43] op_sel:[1,1,0] op_sel_hi:[1,0,1] neg_lo:[1,0,0] neg_hi:[1,0,1]
    v_pk_fma_f32 v[76:77], v[100:101], v[36:37], v[44:45] op_sel:[1,1,0] op_sel_hi:[1,0,1] neg_lo:[1,0,0] neg_hi:[1,0,1]
    v_pk_fma_f32 v[78:79], v[102:103], v[38:39], v[46:47] op_sel:[1,1,0] op_sel_hi:[1,0,1] neg_lo:[1,0,0] neg_hi:[1,0,1]
    v_accvgpr_read_b32 v48, a161
    v_accvgpr_read_b32 v50, a165
    v_accvgpr_read_b32 v52, a169
    v_accvgpr_read_b32 v54, a173
    v_accvgpr_read_b32 v49, a177
    v_accvgpr_read_b32 v51, a181
    v_accvgpr_read_b32 v53, a185
    v_accvgpr_read_b32 v55, a189
    v_pk_fma_f32 v[56:57], v[88:89], v[32:33], v[48:49] op_sel:[0,0,0] op_sel_hi:[0,1,1]
    v_pk_fma_f32 v[58:59], v[90:91], v[34:35], v[50:51] op_sel:[0,0,0] op_sel_hi:[0,1,1]
    v_pk_fma_f32 v[60:61], v[92:93], v[36:37], v[52:53] op_sel:[0,0,0] op_sel_hi:[0,1,1]
    v_pk_fma_f32 v[62:63], v[94:95], v[38:39], v[54:55] op_sel:[0,0,0] op_sel_hi:[0,1,1]
    v_pk_fma_f32 v[32:33], v[88:89], v[32:33], v[56:57] op_sel:[1,1,0] op_sel_hi:[1,0,1] neg_lo:[1,0,0]
    v_pk_fma_f32 v[34:35], v[90:91], v[34:35], v[58:59] op_sel:[1,1,0] op_sel_hi:[1,0,1] neg_lo:[1,0,0]
    v_pk_fma_f32 v[36:37], v[92:93], v[36:37], v[60:61] op_sel:[1,1,0] op_sel_hi:[1,0,1] neg_lo:[1,0,0]
    v_pk_fma_f32 v[38:39], v[94:95], v[38:39], v[62:63] op_sel:[1,1,0] op_sel_hi:[1,0,1] neg_lo:[1,0,0]
    v_pk_mul_f32 v[40:41], v[96:97], v[32:33] op_sel:[0,0] op_sel_hi:[0,1]
    v_pk_mul_f32 v[42:43], v[98:99], v[34:35] op_sel:[0,0] op_sel_hi:[0,1]
    v_pk_mul_f32 v[44:45], v[100:101], v[36:37] op_sel:[0,0] op_sel_hi:[0,1]
    v_pk_mul_f32 v[46:47], v[102:103], v[38:39] op_sel:[0,0] op_sel_hi:[0,1]
    v_pk_fma_f32 v[80:81], v[96:97], v[32:33], v[40:41] op_sel:[1,1,0] op_sel_hi:[1,0,1] neg_lo:[1,0,0] neg_hi:[1,0,1]
    v_pk_fma_f32 v[82:83], v[98:99], v[34:35], v[42:43] op_sel:[1,1,0] op_sel_hi:[1,0,1] neg_lo:[1,0,0] neg_hi:[1,0,1]
    v_pk_fma_f32 v[84:85], v[100:101], v[36:37], v[44:45] op_sel:[1,1,0] op_sel_hi:[1,0,1] neg_lo:[1,0,0] neg_hi:[1,0,1]
    v_pk_fma_f32 v[86:87], v[102:103], v[38:39], v[46:47] op_sel:[1,1,0] op_sel_hi:[1,0,1] neg_lo:[1,0,0] neg_hi:[1,0,1]
    v_cvt_pk_bf16_f32 v162, v72, v80
    v_cvt_pk_bf16_f32 v170, v74, v82
    v_cvt_pk_bf16_f32 v178, v76, v84
    v_cvt_pk_bf16_f32 v186, v78, v86
    v_cvt_pk_bf16_f32 v226, v73, v81
    v_cvt_pk_bf16_f32 v234, v75, v83
    v_cvt_pk_bf16_f32 v242, v77, v85
    v_cvt_pk_bf16_f32 v250, v79, v87
    v_accvgpr_read_b32 v64, a162
    v_accvgpr_read_b32 v66, a166
    v_accvgpr_read_b32 v68, a170
    v_accvgpr_read_b32 v70, a174
    v_accvgpr_read_b32 v65, a178
    v_accvgpr_read_b32 v67, a182
    v_accvgpr_read_b32 v69, a186
    v_accvgpr_read_b32 v71, a190
    v_pk_fma_f32 v[56:57], v[88:89], v[32:33], v[64:65] op_sel:[0,0,0] op_sel_hi:[0,1,1]
    v_pk_fma_f32 v[58:59], v[90:91], v[34:35], v[66:67] op_sel:[0,0,0] op_sel_hi:[0,1,1]
    v_pk_fma_f32 v[60:61], v[92:93], v[36:37], v[68:69] op_sel:[0,0,0] op_sel_hi:[0,1,1]
    v_pk_fma_f32 v[62:63], v[94:95], v[38:39], v[70:71] op_sel:[0,0,0] op_sel_hi:[0,1,1]
    v_pk_fma_f32 v[32:33], v[88:89], v[32:33], v[56:57] op_sel:[1,1,0] op_sel_hi:[1,0,1] neg_lo:[1,0,0]
    v_pk_fma_f32 v[34:35], v[90:91], v[34:35], v[58:59] op_sel:[1,1,0] op_sel_hi:[1,0,1] neg_lo:[1,0,0]
    v_pk_fma_f32 v[36:37], v[92:93], v[36:37], v[60:61] op_sel:[1,1,0] op_sel_hi:[1,0,1] neg_lo:[1,0,0]
    v_pk_fma_f32 v[38:39], v[94:95], v[38:39], v[62:63] op_sel:[1,1,0] op_sel_hi:[1,0,1] neg_lo:[1,0,0]
    v_pk_mul_f32 v[40:41], v[96:97], v[32:33] op_sel:[0,0] op_sel_hi:[0,1]
    v_pk_mul_f32 v[42:43], v[98:99], v[34:35] op_sel:[0,0] op_sel_hi:[0,1]
    v_pk_mul_f32 v[44:45], v[100:101], v[36:37] op_sel:[0,0] op_sel_hi:[0,1]
    v_pk_mul_f32 v[46:47], v[102:103], v[38:39] op_sel:[0,0] op_sel_hi:[0,1]
    v_pk_fma_f32 v[72:73], v[96:97], v[32:33], v[40:41] op_sel:[1,1,0] op_sel_hi:[1,0,1] neg_lo:[1,0,0] neg_hi:[1,0,1]
    v_pk_fma_f32 v[74:75], v[98:99], v[34:35], v[42:43] op_sel:[1,1,0] op_sel_hi:[1,0,1] neg_lo:[1,0,0] neg_hi:[1,0,1]
    v_pk_fma_f32 v[76:77], v[100:101], v[36:37], v[44:45] op_sel:[1,1,0] op_sel_hi:[1,0,1] neg_lo:[1,0,0] neg_hi:[1,0,1]
    v_pk_fma_f32 v[78:79], v[102:103], v[38:39], v[46:47] op_sel:[1,1,0] op_sel_hi:[1,0,1] neg_lo:[1,0,0] neg_hi:[1,0,1]
    v_accvgpr_read_b32 v48, a163
    v_accvgpr_read_b32 v50, a167
    v_accvgpr_read_b32 v52, a171
    v_accvgpr_read_b32 v54, a175
    v_accvgpr_read_b32 v49, a179
    v_accvgpr_read_b32 v51, a183
    v_accvgpr_read_b32 v53, a187
    v_accvgpr_read_b32 v55, a191
    v_pk_fma_f32 v[56:57], v[88:89], v[32:33], v[48:49] op_sel:[0,0,0] op_sel_hi:[0,1,1]
    v_pk_fma_f32 v[58:59], v[90:91], v[34:35], v[50:51] op_sel:[0,0,0] op_sel_hi:[0,1,1]
    v_pk_fma_f32 v[60:61], v[92:93], v[36:37], v[52:53] op_sel:[0,0,0] op_sel_hi:[0,1,1]
    v_pk_fma_f32 v[62:63], v[94:95], v[38:39], v[54:55] op_sel:[0,0,0] op_sel_hi:[0,1,1]
    v_pk_fma_f32 v[32:33], v[88:89], v[32:33], v[56:57] op_sel:[1,1,0] op_sel_hi:[1,0,1] neg_lo:[1,0,0]
    v_pk_fma_f32 v[34:35], v[90:91], v[34:35], v[58:59] op_sel:[1,1,0] op_sel_hi:[1,0,1] neg_lo:[1,0,0]
    v_pk_fma_f32 v[36:37], v[92:93], v[36:37], v[60:61] op_sel:[1,1,0] op_sel_hi:[1,0,1] neg_lo:[1,0,0]
    v_pk_fma_f32 v[38:39], v[94:95], v[38:39], v[62:63] op_sel:[1,1,0] op_sel_hi:[1,0,1] neg_lo:[1,0,0]
    v_pk_mul_f32 v[40:41], v[96:97], v[32:33] op_sel:[0,0] op_sel_hi:[0,1]
    v_pk_mul_f32 v[42:43], v[98:99], v[34:35] op_sel:[0,0] op_sel_hi:[0,1]
    v_pk_mul_f32 v[44:45], v[100:101], v[36:37] op_sel:[0,0] op_sel_hi:[0,1]
    v_pk_mul_f32 v[46:47], v[102:103], v[38:39] op_sel:[0,0] op_sel_hi:[0,1]
    v_pk_fma_f32 v[80:81], v[96:97], v[32:33], v[40:41] op_sel:[1,1,0] op_sel_hi:[1,0,1] neg_lo:[1,0,0] neg_hi:[1,0,1]
    v_pk_fma_f32 v[82:83], v[98:99], v[34:35], v[42:43] op_sel:[1,1,0] op_sel_hi:[1,0,1] neg_lo:[1,0,0] neg_hi:[1,0,1]
    v_pk_fma_f32 v[84:85], v[100:101], v[36:37], v[44:45] op_sel:[1,1,0] op_sel_hi:[1,0,1] neg_lo:[1,0,0] neg_hi:[1,0,1]
    v_pk_fma_f32 v[86:87], v[102:103], v[38:39], v[46:47] op_sel:[1,1,0] op_sel_hi:[1,0,1] neg_lo:[1,0,0] neg_hi:[1,0,1]
    v_cvt_pk_bf16_f32 v163, v72, v80
    v_cvt_pk_bf16_f32 v171, v74, v82
    v_cvt_pk_bf16_f32 v179, v76, v84
    v_cvt_pk_bf16_f32 v187, v78, v86
    v_cvt_pk_bf16_f32 v227, v73, v81
    v_cvt_pk_bf16_f32 v235, v75, v83
    v_cvt_pk_bf16_f32 v243, v77, v85
    v_cvt_pk_bf16_f32 v251, v79, v87
    v_accvgpr_read_b32 v64, a192
    v_accvgpr_read_b32 v66, a196
    v_accvgpr_read_b32 v68, a200
    v_accvgpr_read_b32 v70, a204
    v_accvgpr_read_b32 v65, a208
    v_accvgpr_read_b32 v67, a212
    v_accvgpr_read_b32 v69, a216
    v_accvgpr_read_b32 v71, a220
    v_pk_fma_f32 v[56:57], v[88:89], v[32:33], v[64:65] op_sel:[0,0,0] op_sel_hi:[0,1,1]
    v_pk_fma_f32 v[58:59], v[90:91], v[34:35], v[66:67] op_sel:[0,0,0] op_sel_hi:[0,1,1]
    v_pk_fma_f32 v[60:61], v[92:93], v[36:37], v[68:69] op_sel:[0,0,0] op_sel_hi:[0,1,1]
    v_pk_fma_f32 v[62:63], v[94:95], v[38:39], v[70:71] op_sel:[0,0,0] op_sel_hi:[0,1,1]
    v_pk_fma_f32 v[32:33], v[88:89], v[32:33], v[56:57] op_sel:[1,1,0] op_sel_hi:[1,0,1] neg_lo:[1,0,0]
    v_pk_fma_f32 v[34:35], v[90:91], v[34:35], v[58:59] op_sel:[1,1,0] op_sel_hi:[1,0,1] neg_lo:[1,0,0]
    v_pk_fma_f32 v[36:37], v[92:93], v[36:37], v[60:61] op_sel:[1,1,0] op_sel_hi:[1,0,1] neg_lo:[1,0,0]
    v_pk_fma_f32 v[38:39], v[94:95], v[38:39], v[62:63] op_sel:[1,1,0] op_sel_hi:[1,0,1] neg_lo:[1,0,0]
    v_pk_mul_f32 v[40:41], v[96:97], v[32:33] op_sel:[0,0] op_sel_hi:[0,1]
    v_pk_mul_f32 v[42:43], v[98:99], v[34:35] op_sel:[0,0] op_sel_hi:[0,1]
    v_pk_mul_f32 v[44:45], v[100:101], v[36:37] op_sel:[0,0] op_sel_hi:[0,1]
    v_pk_mul_f32 v[46:47], v[102:103], v[38:39] op_sel:[0,0] op_sel_hi:[0,1]
    v_pk_fma_f32 v[72:73], v[96:97], v[32:33], v[40:41] op_sel:[1,1,0] op_sel_hi:[1,0,1] neg_lo:[1,0,0] neg_hi:[1,0,1]
    v_pk_fma_f32 v[74:75], v[98:99], v[34:35], v[42:43] op_sel:[1,1,0] op_sel_hi:[1,0,1] neg_lo:[1,0,0] neg_hi:[1,0,1]
    v_pk_fma_f32 v[76:77], v[100:101], v[36:37], v[44:45] op_sel:[1,1,0] op_sel_hi:[1,0,1] neg_lo:[1,0,0] neg_hi:[1,0,1]
    v_pk_fma_f32 v[78:79], v[102:103], v[38:39], v[46:47] op_sel:[1,1,0] op_sel_hi:[1,0,1] neg_lo:[1,0,0] neg_hi:[1,0,1]
    v_accvgpr_read_b32 v48, a193
    v_accvgpr_read_b32 v50, a197
    v_accvgpr_read_b32 v52, a201
    v_accvgpr_read_b32 v54, a205
    v_accvgpr_read_b32 v49, a209
    v_accvgpr_read_b32 v51, a213
    v_accvgpr_read_b32 v53, a217
    v_accvgpr_read_b32 v55, a221
    v_pk_fma_f32 v[56:57], v[88:89], v[32:33], v[48:49] op_sel:[0,0,0] op_sel_hi:[0,1,1]
    v_pk_fma_f32 v[58:59], v[90:91], v[34:35], v[50:51] op_sel:[0,0,0] op_sel_hi:[0,1,1]
    v_pk_fma_f32 v[60:61], v[92:93], v[36:37], v[52:53] op_sel:[0,0,0] op_sel_hi:[0,1,1]
    v_pk_fma_f32 v[62:63], v[94:95], v[38:39], v[54:55] op_sel:[0,0,0] op_sel_hi:[0,1,1]
    v_pk_fma_f32 v[32:33], v[88:89], v[32:33], v[56:57] op_sel:[1,1,0] op_sel_hi:[1,0,1] neg_lo:[1,0,0]
    v_pk_fma_f32 v[34:35], v[90:91], v[34:35], v[58:59] op_sel:[1,1,0] op_sel_hi:[1,0,1] neg_lo:[1,0,0]
    v_pk_fma_f32 v[36:37], v[92:93], v[36:37], v[60:61] op_sel:[1,1,0] op_sel_hi:[1,0,1] neg_lo:[1,0,0]
    v_pk_fma_f32 v[38:39], v[94:95], v[38:39], v[62:63] op_sel:[1,1,0] op_sel_hi:[1,0,1] neg_lo:[1,0,0]
    v_pk_mul_f32 v[40:41], v[96:97], v[32:33] op_sel:[0,0] op_sel_hi:[0,1]
    v_pk_mul_f32 v[42:43], v[98:99], v[34:35] op_sel:[0,0] op_sel_hi:[0,1]
    v_pk_mul_f32 v[44:45], v[100:101], v[36:37] op_sel:[0,0] op_sel_hi:[0,1]
    v_pk_mul_f32 v[46:47], v[102:103], v[38:39] op_sel:[0,0] op_sel_hi:[0,1]
    v_pk_fma_f32 v[80:81], v[96:97], v[32:33], v[40:41] op_sel:[1,1,0] op_sel_hi:[1,0,1] neg_lo:[1,0,0] neg_hi:[1,0,1]
    v_pk_fma_f32 v[82:83], v[98:99], v[34:35], v[42:43] op_sel:[1,1,0] op_sel_hi:[1,0,1] neg_lo:[1,0,0] neg_hi:[1,0,1]
    v_pk_fma_f32 v[84:85], v[100:101], v[36:37], v[44:45] op_sel:[1,1,0] op_sel_hi:[1,0,1] neg_lo:[1,0,0] neg_hi:[1,0,1]
    v_pk_fma_f32 v[86:87], v[102:103], v[38:39], v[46:47] op_sel:[1,1,0] op_sel_hi:[1,0,1] neg_lo:[1,0,0] neg_hi:[1,0,1]
    v_cvt_pk_bf16_f32 v164, v72, v80
    v_cvt_pk_bf16_f32 v172, v74, v82
    v_cvt_pk_bf16_f32 v180, v76, v84
    v_cvt_pk_bf16_f32 v188, v78, v86
    v_cvt_pk_bf16_f32 v228, v73, v81
    v_cvt_pk_bf16_f32 v236, v75, v83
    v_cvt_pk_bf16_f32 v244, v77, v85
    v_cvt_pk_bf16_f32 v252, v79, v87
    v_accvgpr_read_b32 v64, a194
    v_accvgpr_read_b32 v66, a198
    v_accvgpr_read_b32 v68, a202
    v_accvgpr_read_b32 v70, a206
    v_accvgpr_read_b32 v65, a210
    v_accvgpr_read_b32 v67, a214
    v_accvgpr_read_b32 v69, a218
    v_accvgpr_read_b32 v71, a222
    v_pk_fma_f32 v[56:57], v[88:89], v[32:33], v[64:65] op_sel:[0,0,0] op_sel_hi:[0,1,1]
    v_pk_fma_f32 v[58:59], v[90:91], v[34:35], v[66:67] op_sel:[0,0,0] op_sel_hi:[0,1,1]
    v_pk_fma_f32 v[60:61], v[92:93], v[36:37], v[68:69] op_sel:[0,0,0] op_sel_hi:[0,1,1]
    v_pk_fma_f32 v[62:63], v[94:95], v[38:39], v[70:71] op_sel:[0,0,0] op_sel_hi:[0,1,1]
    v_pk_fma_f32 v[32:33], v[88:89], v[32:33], v[56:57] op_sel:[1,1,0] op_sel_hi:[1,0,1] neg_lo:[1,0,0]
    v_pk_fma_f32 v[34:35], v[90:91], v[34:35], v[58:59] op_sel:[1,1,0] op_sel_hi:[1,0,1] neg_lo:[1,0,0]
    v_pk_fma_f32 v[36:37], v[92:93], v[36:37], v[60:61] op_sel:[1,1,0] op_sel_hi:[1,0,1] neg_lo:[1,0,0]
    v_pk_fma_f32 v[38:39], v[94:95], v[38:39], v[62:63] op_sel:[1,1,0] op_sel_hi:[1,0,1] neg_lo:[1,0,0]
    v_pk_mul_f32 v[40:41], v[96:97], v[32:33] op_sel:[0,0] op_sel_hi:[0,1]
    v_pk_mul_f32 v[42:43], v[98:99], v[34:35] op_sel:[0,0] op_sel_hi:[0,1]
    v_pk_mul_f32 v[44:45], v[100:101], v[36:37] op_sel:[0,0] op_sel_hi:[0,1]
    v_pk_mul_f32 v[46:47], v[102:103], v[38:39] op_sel:[0,0] op_sel_hi:[0,1]
    v_pk_fma_f32 v[72:73], v[96:97], v[32:33], v[40:41] op_sel:[1,1,0] op_sel_hi:[1,0,1] neg_lo:[1,0,0] neg_hi:[1,0,1]
    v_pk_fma_f32 v[74:75], v[98:99], v[34:35], v[42:43] op_sel:[1,1,0] op_sel_hi:[1,0,1] neg_lo:[1,0,0] neg_hi:[1,0,1]
    v_pk_fma_f32 v[76:77], v[100:101], v[36:37], v[44:45] op_sel:[1,1,0] op_sel_hi:[1,0,1] neg_lo:[1,0,0] neg_hi:[1,0,1]
    v_pk_fma_f32 v[78:79], v[102:103], v[38:39], v[46:47] op_sel:[1,1,0] op_sel_hi:[1,0,1] neg_lo:[1,0,0] neg_hi:[1,0,1]
    v_accvgpr_read_b32 v48, a195
    v_accvgpr_read_b32 v50, a199
    v_accvgpr_read_b32 v52, a203
    v_accvgpr_read_b32 v54, a207
    v_accvgpr_read_b32 v49, a211
    v_accvgpr_read_b32 v51, a215
    v_accvgpr_read_b32 v53, a219
    v_accvgpr_read_b32 v55, a223
    v_pk_fma_f32 v[56:57], v[88:89], v[32:33], v[48:49] op_sel:[0,0,0] op_sel_hi:[0,1,1]
    v_pk_fma_f32 v[58:59], v[90:91], v[34:35], v[50:51] op_sel:[0,0,0] op_sel_hi:[0,1,1]
    v_pk_fma_f32 v[60:61], v[92:93], v[36:37], v[52:53] op_sel:[0,0,0] op_sel_hi:[0,1,1]
    v_pk_fma_f32 v[62:63], v[94:95], v[38:39], v[54:55] op_sel:[0,0,0] op_sel_hi:[0,1,1]
    v_pk_fma_f32 v[32:33], v[88:89], v[32:33], v[56:57] op_sel:[1,1,0] op_sel_hi:[1,0,1] neg_lo:[1,0,0]
    v_pk_fma_f32 v[34:35], v[90:91], v[34:35], v[58:59] op_sel:[1,1,0] op_sel_hi:[1,0,1] neg_lo:[1,0,0]
    v_pk_fma_f32 v[36:37], v[92:93], v[36:37], v[60:61] op_sel:[1,1,0] op_sel_hi:[1,0,1] neg_lo:[1,0,0]
    v_pk_fma_f32 v[38:39], v[94:95], v[38:39], v[62:63] op_sel:[1,1,0] op_sel_hi:[1,0,1] neg_lo:[1,0,0]
    v_pk_mul_f32 v[40:41], v[96:97], v[32:33] op_sel:[0,0] op_sel_hi:[0,1]
    v_pk_mul_f32 v[42:43], v[98:99], v[34:35] op_sel:[0,0] op_sel_hi:[0,1]
    v_pk_mul_f32 v[44:45], v[100:101], v[36:37] op_sel:[0,0] op_sel_hi:[0,1]
    v_pk_mul_f32 v[46:47], v[102:103], v[38:39] op_sel:[0,0] op_sel_hi:[0,1]
    v_pk_fma_f32 v[80:81], v[96:97], v[32:33], v[40:41] op_sel:[1,1,0] op_sel_hi:[1,0,1] neg_lo:[1,0,0] neg_hi:[1,0,1]
    v_pk_fma_f32 v[82:83], v[98:99], v[34:35], v[42:43] op_sel:[1,1,0] op_sel_hi:[1,0,1] neg_lo:[1,0,0] neg_hi:[1,0,1]
    v_pk_fma_f32 v[84:85], v[100:101], v[36:37], v[44:45] op_sel:[1,1,0] op_sel_hi:[1,0,1] neg_lo:[1,0,0] neg_hi:[1,0,1]
    v_pk_fma_f32 v[86:87], v[102:103], v[38:39], v[46:47] op_sel:[1,1,0] op_sel_hi:[1,0,1] neg_lo:[1,0,0] neg_hi:[1,0,1]
    v_cvt_pk_bf16_f32 v165, v72, v80
    v_cvt_pk_bf16_f32 v173, v74, v82
    v_cvt_pk_bf16_f32 v181, v76, v84
    v_cvt_pk_bf16_f32 v189, v78, v86
    v_cvt_pk_bf16_f32 v229, v73, v81
    v_cvt_pk_bf16_f32 v237, v75, v83
    v_cvt_pk_bf16_f32 v245, v77, v85
    v_cvt_pk_bf16_f32 v253, v79, v87
    v_accvgpr_read_b32 v64, a224
    v_accvgpr_read_b32 v66, a228
    v_accvgpr_read_b32 v68, a232
    v_accvgpr_read_b32 v70, a236
    v_accvgpr_read_b32 v65, a240
    v_accvgpr_read_b32 v67, a244
    v_accvgpr_read_b32 v69, a248
    v_accvgpr_read_b32 v71, a252
    v_pk_fma_f32 v[56:57], v[88:89], v[32:33], v[64:65] op_sel:[0,0,0] op_sel_hi:[0,1,1]
    v_pk_fma_f32 v[58:59], v[90:91], v[34:35], v[66:67] op_sel:[0,0,0] op_sel_hi:[0,1,1]
    v_pk_fma_f32 v[60:61], v[92:93], v[36:37], v[68:69] op_sel:[0,0,0] op_sel_hi:[0,1,1]
    v_pk_fma_f32 v[62:63], v[94:95], v[38:39], v[70:71] op_sel:[0,0,0] op_sel_hi:[0,1,1]
    v_pk_fma_f32 v[32:33], v[88:89], v[32:33], v[56:57] op_sel:[1,1,0] op_sel_hi:[1,0,1] neg_lo:[1,0,0]
    v_pk_fma_f32 v[34:35], v[90:91], v[34:35], v[58:59] op_sel:[1,1,0] op_sel_hi:[1,0,1] neg_lo:[1,0,0]
    v_pk_fma_f32 v[36:37], v[92:93], v[36:37], v[60:61] op_sel:[1,1,0] op_sel_hi:[1,0,1] neg_lo:[1,0,0]
    v_pk_fma_f32 v[38:39], v[94:95], v[38:39], v[62:63] op_sel:[1,1,0] op_sel_hi:[1,0,1] neg_lo:[1,0,0]
    v_pk_mul_f32 v[40:41], v[96:97], v[32:33] op_sel:[0,0] op_sel_hi:[0,1]
    v_pk_mul_f32 v[42:43], v[98:99], v[34:35] op_sel:[0,0] op_sel_hi:[0,1]
    v_pk_mul_f32 v[44:45], v[100:101], v[36:37] op_sel:[0,0] op_sel_hi:[0,1]
    v_pk_mul_f32 v[46:47], v[102:103], v[38:39] op_sel:[0,0] op_sel_hi:[0,1]
    v_pk_fma_f32 v[72:73], v[96:97], v[32:33], v[40:41] op_sel:[1,1,0] op_sel_hi:[1,0,1] neg_lo:[1,0,0] neg_hi:[1,0,1]
    v_pk_fma_f32 v[74:75], v[98:99], v[34:35], v[42:43] op_sel:[1,1,0] op_sel_hi:[1,0,1] neg_lo:[1,0,0] neg_hi:[1,0,1]
    v_pk_fma_f32 v[76:77], v[100:101], v[36:37], v[44:45] op_sel:[1,1,0] op_sel_hi:[1,0,1] neg_lo:[1,0,0] neg_hi:[1,0,1]
    v_pk_fma_f32 v[78:79], v[102:103], v[38:39], v[46:47] op_sel:[1,1,0] op_sel_hi:[1,0,1] neg_lo:[1,0,0] neg_hi:[1,0,1]
    v_accvgpr_read_b32 v48, a225
    v_accvgpr_read_b32 v50, a229
    v_accvgpr_read_b32 v52, a233
    v_accvgpr_read_b32 v54, a237
    v_accvgpr_read_b32 v49, a241
    v_accvgpr_read_b32 v51, a245
    v_accvgpr_read_b32 v53, a249
    v_accvgpr_read_b32 v55, a253
    v_pk_fma_f32 v[56:57], v[88:89], v[32:33], v[48:49] op_sel:[0,0,0] op_sel_hi:[0,1,1]
    v_pk_fma_f32 v[58:59], v[90:91], v[34:35], v[50:51] op_sel:[0,0,0] op_sel_hi:[0,1,1]
    v_pk_fma_f32 v[60:61], v[92:93], v[36:37], v[52:53] op_sel:[0,0,0] op_sel_hi:[0,1,1]
    v_pk_fma_f32 v[62:63], v[94:95], v[38:39], v[54:55] op_sel:[0,0,0] op_sel_hi:[0,1,1]
    v_pk_fma_f32 v[32:33], v[88:89], v[32:33], v[56:57] op_sel:[1,1,0] op_sel_hi:[1,0,1] neg_lo:[1,0,0]
    v_pk_fma_f32 v[34:35], v[90:91], v[34:35], v[58:59] op_sel:[1,1,0] op_sel_hi:[1,0,1] neg_lo:[1,0,0]
    v_pk_fma_f32 v[36:37], v[92:93], v[36:37], v[60:61] op_sel:[1,1,0] op_sel_hi:[1,0,1] neg_lo:[1,0,0]
    v_pk_fma_f32 v[38:39], v[94:95], v[38:39], v[62:63] op_sel:[1,1,0] op_sel_hi:[1,0,1] neg_lo:[1,0,0]
    v_pk_mul_f32 v[40:41], v[96:97], v[32:33] op_sel:[0,0] op_sel_hi:[0,1]
    v_pk_mul_f32 v[42:43], v[98:99], v[34:35] op_sel:[0,0] op_sel_hi:[0,1]
    v_pk_mul_f32 v[44:45], v[100:101], v[36:37] op_sel:[0,0] op_sel_hi:[0,1]
    v_pk_mul_f32 v[46:47], v[102:103], v[38:39] op_sel:[0,0] op_sel_hi:[0,1]
    v_pk_fma_f32 v[80:81], v[96:97], v[32:33], v[40:41] op_sel:[1,1,0] op_sel_hi:[1,0,1] neg_lo:[1,0,0] neg_hi:[1,0,1]
    v_pk_fma_f32 v[82:83], v[98:99], v[34:35], v[42:43] op_sel:[1,1,0] op_sel_hi:[1,0,1] neg_lo:[1,0,0] neg_hi:[1,0,1]
    v_pk_fma_f32 v[84:85], v[100:101], v[36:37], v[44:45] op_sel:[1,1,0] op_sel_hi:[1,0,1] neg_lo:[1,0,0] neg_hi:[1,0,1]
    v_pk_fma_f32 v[86:87], v[102:103], v[38:39], v[46:47] op_sel:[1,1,0] op_sel_hi:[1,0,1] neg_lo:[1,0,0] neg_hi:[1,0,1]
    v_cvt_pk_bf16_f32 v166, v72, v80
    v_cvt_pk_bf16_f32 v174, v74, v82
    v_cvt_pk_bf16_f32 v182, v76, v84
    v_cvt_pk_bf16_f32 v190, v78, v86
    v_cvt_pk_bf16_f32 v230, v73, v81
    v_cvt_pk_bf16_f32 v238, v75, v83
    v_cvt_pk_bf16_f32 v246, v77, v85
    v_cvt_pk_bf16_f32 v254, v79, v87
    v_accvgpr_read_b32 v64, a226
    v_accvgpr_read_b32 v66, a230
    v_accvgpr_read_b32 v68, a234
    v_accvgpr_read_b32 v70, a238
    v_accvgpr_read_b32 v65, a242
    v_accvgpr_read_b32 v67, a246
    v_accvgpr_read_b32 v69, a250
    v_accvgpr_read_b32 v71, a254
    v_pk_fma_f32 v[56:57], v[88:89], v[32:33], v[64:65] op_sel:[0,0,0] op_sel_hi:[0,1,1]
    v_pk_fma_f32 v[58:59], v[90:91], v[34:35], v[66:67] op_sel:[0,0,0] op_sel_hi:[0,1,1]
    v_pk_fma_f32 v[60:61], v[92:93], v[36:37], v[68:69] op_sel:[0,0,0] op_sel_hi:[0,1,1]
    v_pk_fma_f32 v[62:63], v[94:95], v[38:39], v[70:71] op_sel:[0,0,0] op_sel_hi:[0,1,1]
    v_pk_fma_f32 v[32:33], v[88:89], v[32:33], v[56:57] op_sel:[1,1,0] op_sel_hi:[1,0,1] neg_lo:[1,0,0]
    v_pk_fma_f32 v[34:35], v[90:91], v[34:35], v[58:59] op_sel:[1,1,0] op_sel_hi:[1,0,1] neg_lo:[1,0,0]
    v_pk_fma_f32 v[36:37], v[92:93], v[36:37], v[60:61] op_sel:[1,1,0] op_sel_hi:[1,0,1] neg_lo:[1,0,0]
    v_pk_fma_f32 v[38:39], v[94:95], v[38:39], v[62:63] op_sel:[1,1,0] op_sel_hi:[1,0,1] neg_lo:[1,0,0]
    v_pk_mul_f32 v[40:41], v[96:97], v[32:33] op_sel:[0,0] op_sel_hi:[0,1]
    v_pk_mul_f32 v[42:43], v[98:99], v[34:35] op_sel:[0,0] op_sel_hi:[0,1]
    v_pk_mul_f32 v[44:45], v[100:101], v[36:37] op_sel:[0,0] op_sel_hi:[0,1]
    v_pk_mul_f32 v[46:47], v[102:103], v[38:39] op_sel:[0,0] op_sel_hi:[0,1]
    v_pk_fma_f32 v[72:73], v[96:97], v[32:33], v[40:41] op_sel:[1,1,0] op_sel_hi:[1,0,1] neg_lo:[1,0,0] neg_hi:[1,0,1]
    v_pk_fma_f32 v[74:75], v[98:99], v[34:35], v[42:43] op_sel:[1,1,0] op_sel_hi:[1,0,1] neg_lo:[1,0,0] neg_hi:[1,0,1]
    v_pk_fma_f32 v[76:77], v[100:101], v[36:37], v[44:45] op_sel:[1,1,0] op_sel_hi:[1,0,1] neg_lo:[1,0,0] neg_hi:[1,0,1]
    v_pk_fma_f32 v[78:79], v[102:103], v[38:39], v[46:47] op_sel:[1,1,0] op_sel_hi:[1,0,1] neg_lo:[1,0,0] neg_hi:[1,0,1]
    v_accvgpr_read_b32 v48, a227
    v_accvgpr_read_b32 v50, a231
    v_accvgpr_read_b32 v52, a235
    v_accvgpr_read_b32 v54, a239
    v_accvgpr_read_b32 v49, a243
    v_accvgpr_read_b32 v51, a247
    v_accvgpr_read_b32 v53, a251
    v_accvgpr_read_b32 v55, a255
    v_pk_fma_f32 v[56:57], v[88:89], v[32:33], v[48:49] op_sel:[0,0,0] op_sel_hi:[0,1,1]
    v_pk_fma_f32 v[58:59], v[90:91], v[34:35], v[50:51] op_sel:[0,0,0] op_sel_hi:[0,1,1]
    v_pk_fma_f32 v[60:61], v[92:93], v[36:37], v[52:53] op_sel:[0,0,0] op_sel_hi:[0,1,1]
    v_pk_fma_f32 v[62:63], v[94:95], v[38:39], v[54:55] op_sel:[0,0,0] op_sel_hi:[0,1,1]
    v_pk_fma_f32 v[32:33], v[88:89], v[32:33], v[56:57] op_sel:[1,1,0] op_sel_hi:[1,0,1] neg_lo:[1,0,0]
    v_pk_fma_f32 v[34:35], v[90:91], v[34:35], v[58:59] op_sel:[1,1,0] op_sel_hi:[1,0,1] neg_lo:[1,0,0]
    v_pk_fma_f32 v[36:37], v[92:93], v[36:37], v[60:61] op_sel:[1,1,0] op_sel_hi:[1,0,1] neg_lo:[1,0,0]
    v_pk_fma_f32 v[38:39], v[94:95], v[38:39], v[62:63] op_sel:[1,1,0] op_sel_hi:[1,0,1] neg_lo:[1,0,0]
    v_pk_mul_f32 v[40:41], v[96:97], v[32:33] op_sel:[0,0] op_sel_hi:[0,1]
    v_pk_mul_f32 v[42:43], v[98:99], v[34:35] op_sel:[0,0] op_sel_hi:[0,1]
    v_pk_mul_f32 v[44:45], v[100:101], v[36:37] op_sel:[0,0] op_sel_hi:[0,1]
    v_pk_mul_f32 v[46:47], v[102:103], v[38:39] op_sel:[0,0] op_sel_hi:[0,1]
    v_pk_fma_f32 v[80:81], v[96:97], v[32:33], v[40:41] op_sel:[1,1,0] op_sel_hi:[1,0,1] neg_lo:[1,0,0] neg_hi:[1,0,1]
    v_pk_fma_f32 v[82:83], v[98:99], v[34:35], v[42:43] op_sel:[1,1,0] op_sel_hi:[1,0,1] neg_lo:[1,0,0] neg_hi:[1,0,1]
    v_pk_fma_f32 v[84:85], v[100:101], v[36:37], v[44:45] op_sel:[1,1,0] op_sel_hi:[1,0,1] neg_lo:[1,0,0] neg_hi:[1,0,1]
    v_pk_fma_f32 v[86:87], v[102:103], v[38:39], v[46:47] op_sel:[1,1,0] op_sel_hi:[1,0,1] neg_lo:[1,0,0] neg_hi:[1,0,1]
    v_cvt_pk_bf16_f32 v167, v72, v80
    v_cvt_pk_bf16_f32 v175, v74, v82
    v_cvt_pk_bf16_f32 v183, v76, v84
    v_cvt_pk_bf16_f32 v191, v78, v86
    v_cvt_pk_bf16_f32 v231, v73, v81
    v_cvt_pk_bf16_f32 v239, v75, v83
    v_cvt_pk_bf16_f32 v247, v77, v85
    v_cvt_pk_bf16_f32 v255, v79, v87
    s_lshl_b32 s61, s85, 13
    s_andn2_b32 s61, 0x2000, s61
    s_xor_b32 s61, s61, s59
    s_lshl_b32 s50, s85, 21
    s_add_u32 s50, s50, s61
    s_lshr_b32 s60, s0, 2
    s_lshl_b32 s60, s60, 20
    s_add_u32 s50, s50, s60
    s_lshl_b32 s29, s29, 7
    s_and_b32 s29, s29, 0x7ffff
    s_add_u32 s50, s50, s29
    s_and_b32 s60, s58, 1
    s_lshl_b32 s60, s60, 12
    s_add_u32 s50, s50, s60
    s_add_u32 s50, s50, 0xa000000
    s_mov_b32 s5, 16384
    s_mov_b32 s51, 2048
    s_mov_b32 s52, 0x80000
    v_bfe_u32 v2, v0, 4, 1
    v_lshlrev_b32 v2, 6, v2
    v_xor_b32 v2, v2, v1
    v_add_u32 v3, 1024, v2
    s_setpc_b64 s[54:55]
.section .rodata,"a"
.p2align 6
.amdhsa_kernel chain_kernel
  .amdhsa_next_free_vgpr 512
  .amdhsa_next_free_sgpr 102
  .amdhsa_accum_offset 256
  .amdhsa_group_segment_fixed_size 0
  .amdhsa_kernarg_size 152
  .amdhsa_user_sgpr_count 2
  .amdhsa_user_sgpr_kernarg_segment_ptr 1
  .amdhsa_system_sgpr_workgroup_id_x 1
  .amdhsa_float_denorm_mode_32 3
  .amdhsa_float_denorm_mode_16_64 3
.end_amdhsa_kernel
```

```asm
; @launch kernel=chain_kernel grid=(256,1,1) block=(256,1,1) lds=163840
.amdgcn_target "amdgcn-amd-amdhsa--gfx950"
.text
.globl chain_kernel
.p2align 8
.type chain_kernel,@function
chain_kernel:
    s_cmp_ge_u32 s2, 256
    s_cbranch_scc1 chain_kernel_end
    s_load_dwordx4 s[96:99], s[0:1], 128
    s_load_dwordx2 s[100:101], s[0:1], 144
    s_load_dwordx16 s[64:79], s[0:1], 0
    s_load_dwordx16 s[80:95], s[0:1], 64
    s_getreg_b32 s16, hwreg(HW_REG_XCC_ID)
    s_and_b32 s16, s16, 7
    v_lshrrev_b32 v1, 6, v0
    s_nop 0
    v_readfirstlane_b32 s18, v1
    s_waitcnt lgkmcnt(0)
    s_lshr_b32 s17, s2, 3
    s_mov_b32 s95, 0
    s_cmp_lg_u32 s18, 0
    s_cbranch_scc1 L_role_1
    s_lshl_b32 s12, s16, 8
    s_add_u32 s12, s12, 0xb200000
    v_lshl_add_u32 v1, v0, 2, s12
    v_mov_b32 v2, 0
    global_store_dword v1, v2, s[100:101]
    s_lshl_b32 s12, s16, 3
    s_add_u32 s12, s12, 128
    s_lshl_b32 s0, 1, s17
    s_mov_b32 s1, 0x100
    s_waitcnt vmcnt(0)
    s_atomic_add_x2 s[0:1], s[98:99], s12 glc
L_role_1:
chain_kernel_roles:
    s_cmp_ge_u32 s17, 32
    s_cbranch_scc1 chain_kernel_end
    s_cmp_ge_u32 s16, 4
    s_cbranch_scc1 chain_kernel_worker
    s_mov_b32 s8, s100
    s_and_b32 s9, s101, 0xffff
    s_mov_b32 s10, 0x10000000
    s_mov_b32 s11, 0x00020000
    s_mov_b32 s33, 0
    s_xor_b32 s29, s17, 8
    s_and_b32 s28, s17, 1
    s_bfe_u32 s20, s17, 0x10001
    s_xor_b32 s20, s20, 1
    s_lshl1_add_u32 s28, s28, s20
    s_lshl_b32 s20, s16, 10
    s_lshr_b32 s21, s17, 2
    s_lshl_b32 s21, s21, 7
    s_add_u32 s20, s20, s21
    v_bfe_u32 v160, v0, 5, 1
    v_lshlrev_b32 v162, 1, v160
    v_bfe_u32 v160, v0, 3, 1
    v_add_u32 v162, v162, v160
    v_bfe_u32 v160, v0, 4, 1
    v_lshl_add_u32 v162, v160, 3, v162
    v_lshrrev_b32 v160, 6, v0
    v_lshl_add_u32 v162, v160, 8, v162
    v_and_b32 v161, 7, v0
    v_lshlrev_b32 v163, 13, v162
    v_lshl_add_u32 v163, v161, 4, v163
    s_and_b32 s21, s28, 1
    s_lshl_b32 s21, s21, 6
    s_add_u32 s21, s21, s20
    s_lshl_b32 s21, s21, 1
    v_add_u32 v163, s21, v163
    v_add_u32 v164, 0x8000, v163
    v_bfe_u32 v160, v0, 4, 2
    v_lshlrev_b32 v162, 1, v160
    v_bfe_u32 v160, v0, 2, 1
    v_add_u32 v162, v162, v160
    v_bfe_u32 v160, v0, 3, 1
    v_lshl_add_u32 v162, v160, 3, v162
    v_lshrrev_b32 v160, 6, v0
    v_lshl_add_u32 v162, v160, 8, v162
    v_and_b32 v161, 3, v0
    v_lshlrev_b32 v165, 13, v162
    v_lshl_add_u32 v165, v161, 4, v165
    s_and_b32 s21, s17, 3
    s_lshl_b32 s21, s21, 5
    s_add_u32 s21, s21, s20
    s_lshl_b32 s21, s21, 1
    v_add_u32 v165, s21, v165
    v_bfe_u32 v166, v0, 2, 1
    v_bfe_u32 v160, v0, 4, 1
    v_lshl_add_u32 v166, v160, 1, v166
    v_bfe_u32 v160, v0, 3, 1
    v_lshl_add_u32 v166, v160, 2, v166
    v_bfe_u32 v160, v0, 5, 1
    v_lshl_add_u32 v166, v160, 4, v166
    v_lshrrev_b32 v160, 6, v0
    v_lshl_add_u32 v166, v160, 8, v166
    s_lshl_b32 s21, s16, 10
    v_add_u32 v166, s21, v166
    v_lshlrev_b32 v166, 11, v166
    v_lshl_add_u32 v166, v161, 4, v166
    s_lshl_b32 s21, s29, 6
    v_add_u32 v166, s21, v166
    s_lshl_b32 s72, s18, 15
    s_add_u32 s72, s72, 32768
    s_bitcmp1_b32 s28, 1
    s_cselect_b32 s12, s88, s86
    s_cselect_b32 s13, s89, s87
    s_and_b32 s13, s13, 0xffff
    s_mov_b32 s14, 0x800000
    s_mov_b32 s15, 0x00020000
    s_mov_b32 s68, s90
    s_and_b32 s69, s91, 0xffff
    s_mov_b32 s70, 0x800000
    s_mov_b32 s71, 0x00020000
    s_mov_b32 s64, s92
    s_and_b32 s65, s93, 0xffff
    s_mov_b32 s66, 0x800000
    s_mov_b32 s67, 0x00020000
    s_add_u32 m0, s72, 0
    s_mov_b32 s73, 0
    buffer_load_dwordx4 v163, s[12:15], s73 offen nt lds
    s_add_u32 m0, s72, 1024
    s_mov_b32 s73, 0
    buffer_load_dwordx4 v164, s[12:15], s73 offen nt lds
    s_add_u32 m0, s72, 2048
    s_mov_b32 s73, 131072
    buffer_load_dwordx4 v163, s[12:15], s73 offen nt lds
    s_add_u32 m0, s72, 3072
    s_mov_b32 s73, 131072
    buffer_load_dwordx4 v164, s[12:15], s73 offen nt lds
    s_mov_b32 s73, 0
    buffer_load_dwordx4 v[32:35], v165, s[68:71], s73 offen nt
    s_mov_b32 s73, 0
    buffer_load_dwordx4 v[96:99], v166, s[64:67], s73 offen nt
    s_mov_b32 s73, 131072
    buffer_load_dwordx4 v[36:39], v165, s[68:71], s73 offen nt
    s_mov_b32 s73, 16384
    buffer_load_dwordx4 v[100:103], v166, s[64:67], s73 offen nt
    s_mov_b32 s24, 0x00ff00ff
    s_mov_b32 s25, 0x00ff00ff
    s_mov_b32 s26, 0x55555555
    s_mov_b32 s27, 0x55555555
    s_mov_b32 s56, 0x3fb8aa3b
    s_mov_b32 s57, 0x3fb8aa3b
    s_mov_b32 s58, 0x3db504f3
    s_mov_b32 s59, 0x3db504f3
    s_lshl_b32 s53, s16, 16
    s_add_u32 s53, s53, 0xb000000
    s_lshl_b32 s47, s16, 5
    s_add_u32 s47, s47, s17
    s_mov_b64 s[60:61], s[98:99]
    v_mov_b32 v28, -1
    v_mov_b32 v29, -1
    v_mov_b32 v30, -1
    v_mov_b32 v31, -1
    v_and_b32 v210, 63, v0
    v_and_b32 v208, 15, v0
    v_bfe_u32 v209, v0, 4, 2
    v_lshlrev_b32 v1, 4, v210
    v_lshlrev_b32 v26, 3, v210
    s_lshl_b32 s21, s18, 12
    v_add_u32 v2, s21, v1
    s_xor_b32 s22, s18, 3
    s_lshl_b32 s22, s22, 4
    v_xor_b32 v3, s22, v2
    v_add_u32 v3, 16384, v3
    s_and_b32 s22, s22, 16
    s_lshl_b32 s22, s22, 1
    v_xor_b32 v2, s22, v2
    v_mov_b32 v19, 0xeeeeeeee
    v_mov_b32 v212, 0x44444444
    v_cndmask_b32 v19, v19, v212, s[24:25]
    v_mov_b32 v18, 0x03020706
    v_mov_b32 v212, 0x05040100
    v_cndmask_b32 v18, v18, v212, s[26:27]
    s_lshr_b32 s21, s17, 2
    s_lshl_b32 s21, s21, 12
    s_add_u32 s21, s21, 32768
    v_add_u32 v5, s21, v1
    s_and_b32 s22, s28, 1
    s_lshl_b32 s22, s22, 11
    s_add_u32 s21, s21, s22
    s_bfe_u32 s22, s28, 0x10001
    s_lshl_b32 s22, s22, 7
    s_add_u32 s23, s21, s22
    v_and_b32 v212, 1, v209
    s_add_u32 m0, s72, 4096
    s_mov_b32 s73, 262144
    buffer_load_dwordx4 v163, s[12:15], s73 offen nt lds
    s_add_u32 m0, s72, 5120
    s_mov_b32 s73, 262144
    buffer_load_dwordx4 v164, s[12:15], s73 offen nt lds
    s_add_u32 m0, s72, 6144
    s_mov_b32 s73, 393216
    buffer_load_dwordx4 v163, s[12:15], s73 offen nt lds
    s_add_u32 m0, s72, 7168
    s_mov_b32 s73, 393216
    buffer_load_dwordx4 v164, s[12:15], s73 offen nt lds
    s_mov_b32 s73, 262144
    buffer_load_dwordx4 v[40:43], v165, s[68:71], s73 offen nt
    s_mov_b32 s73, 65536
    buffer_load_dwordx4 v[104:107], v166, s[64:67], s73 offen nt
    s_mov_b32 s73, 393216
    buffer_load_dwordx4 v[44:47], v165, s[68:71], s73 offen nt
    s_mov_b32 s73, 81920
    buffer_load_dwordx4 v[108:111], v166, s[64:67], s73 offen nt
    v_lshlrev_b32 v234, 6, v212
    v_and_b32 v212, 1, v208
    v_lshl_add_u32 v234, v212, 4, v234
    v_bfe_u32 v212, v208, 1, 2
    v_lshl_add_u32 v234, v212, 2, v234
    s_and_b32 s22, s18, 1
    s_lshl_b32 s22, s22, 5
    v_add_u32 v234, s22, v234
    v_lshrrev_b32 v212, 3, v208
    v_and_b32 v213, 2, v209
    v_add_u32 v212, v212, v213
    s_and_b32 s22, s18, 2
    s_lshl_b32 s22, s22, 1
    v_add_u32 v212, s22, v212
    v_lshl_add_u32 v4, v212, 8, v234
    v_lshl_add_u32 v234, v212, 7, v234
    v_add_u32 v4, s23, v4
    v_lshrrev_b32 v212, 3, v210
    v_and_b32 v213, 7, v210
    v_lshlrev_b32 v22, 8, v212
    v_lshl_add_u32 v22, v213, 4, v22
    v_add_u32 v22, s23, v22
    s_lshr_b32 s20, s47, 2
    s_lshl_b32 s48, s20, 16
    s_add_u32 m0, s72, 8192
    s_mov_b32 s73, 524288
    buffer_load_dwordx4 v163, s[12:15], s73 offen nt lds
    s_add_u32 m0, s72, 9216
    s_mov_b32 s73, 524288
    buffer_load_dwordx4 v164, s[12:15], s73 offen nt lds
    s_add_u32 m0, s72, 10240
    s_mov_b32 s73, 655360
    buffer_load_dwordx4 v163, s[12:15], s73 offen nt lds
    s_add_u32 m0, s72, 11264
    s_mov_b32 s73, 655360
    buffer_load_dwordx4 v164, s[12:15], s73 offen nt lds
    s_mov_b32 s73, 524288
    buffer_load_dwordx4 v[48:51], v165, s[68:71], s73 offen nt
    s_mov_b32 s73, 131072
    buffer_load_dwordx4 v[112:115], v166, s[64:67], s73 offen nt
    s_mov_b32 s73, 655360
    buffer_load_dwordx4 v[52:55], v165, s[68:71], s73 offen nt
    s_mov_b32 s73, 147456
    buffer_load_dwordx4 v[116:119], v166, s[64:67], s73 offen nt
    s_and_b32 s21, s17, 3
    s_lshl_b32 s22, s21, 11
    s_add_u32 s22, s22, 0x4000
    v_add_u32 v237, s22, v1
    v_lshlrev_b32 v236, 7, v208
    v_and_b32 v212, 1, v209
    v_lshl_add_u32 v236, v212, 15, v236
    s_lshl_b32 s22, s21, 11
    v_add_u32 v236, s22, v236
    v_mov_b32 v25, v236
    s_cmp_lt_u32 s18, 2
    s_cselect_b32 s38, 0xf0000000, 0
    s_cmp_lg_u32 s18, 1
    s_cselect_b32 s39, 0xf0000000, 0
    s_lshr_b32 s22, s18, 1
    s_mul_i32 s54, s22, 10240
    s_lshl_b32 s22, s22, 15
    s_and_b32 s23, s18, 1
    s_lshl_b32 s23, s23, 12
    s_add_u32 s54, s54, s23
    s_add_u32 s54, s54, 32768
    s_add_u32 s22, s22, s23
    v_add_u32 v235, s22, v1
    s_lshl_b32 s51, s18, 11
    v_add_u32 v243, s51, v1
    s_add_u32 m0, s72, 12288
    s_mov_b32 s73, 786432
    buffer_load_dwordx4 v163, s[12:15], s73 offen nt lds
    s_add_u32 m0, s72, 13312
    s_mov_b32 s73, 786432
    buffer_load_dwordx4 v164, s[12:15], s73 offen nt lds
    s_add_u32 m0, s72, 14336
    s_mov_b32 s73, 917504
    buffer_load_dwordx4 v163, s[12:15], s73 offen nt lds
    s_add_u32 m0, s72, 15360
    s_mov_b32 s73, 917504
    buffer_load_dwordx4 v164, s[12:15], s73 offen nt lds
    s_mov_b32 s73, 786432
    buffer_load_dwordx4 v[56:59], v165, s[68:71], s73 offen nt
    s_mov_b32 s73, 196608
    buffer_load_dwordx4 v[120:123], v166, s[64:67], s73 offen nt
    s_mov_b32 s73, 917504
    buffer_load_dwordx4 v[60:63], v165, s[68:71], s73 offen nt
    s_mov_b32 s73, 212992
    buffer_load_dwordx4 v[124:127], v166, s[64:67], s73 offen nt
    v_add_u32 v244, 0x8000, v243
    v_lshrrev_b32 v212, 3, v210
    v_lshl_add_u32 v24, v212, 7, v5
    v_add_u32 v24, 128, v24
    s_and_b32 s22, s18, 1
    s_lshl_b32 s22, s22, 12
    v_add_u32 v242, s22, v1
    s_lshl_b32 s21, s21, 10
    s_add_u32 s21, s21, 0xc000
    v_add_u32 v23, s21, v242
    v_lshlrev_b32 v241, 7, v209
    v_bfe_u32 v212, v0, 2, 1
    v_lshl_add_u32 v241, v212, 6, v241
    v_bfe_u32 v212, v0, 3, 1
    v_lshl_add_u32 v241, v212, 5, v241
    v_bfe_u32 v212, v0, 0, 1
    v_lshl_add_u32 v241, v212, 4, v241
    v_and_b32 v212, 7, v208
    v_lshlrev_b32 v6, 4, v212
    v_lshl_add_u32 v6, v209, 7, v6
    s_lshl_b32 s21, s17, 9
    s_add_u32 s22, s21, 16384
    v_add_u32 v6, s22, v6
    v_lshrrev_b32 v212, 3, v208
    v_and_b32 v213, 2, v209
    s_add_u32 m0, s72, 16384
    s_mov_b32 s73, 1048576
    buffer_load_dwordx4 v163, s[12:15], s73 offen nt lds
    s_add_u32 m0, s72, 17408
    s_mov_b32 s73, 1048576
    buffer_load_dwordx4 v164, s[12:15], s73 offen nt lds
    s_add_u32 m0, s72, 18432
    s_mov_b32 s73, 1179648
    buffer_load_dwordx4 v163, s[12:15], s73 offen nt lds
    s_add_u32 m0, s72, 19456
    s_mov_b32 s73, 1179648
    buffer_load_dwordx4 v164, s[12:15], s73 offen nt lds
    s_mov_b32 s73, 1048576
    buffer_load_dwordx4 v[64:67], v165, s[68:71], s73 offen nt
    s_mov_b32 s73, 262144
    buffer_load_dwordx4 v[128:131], v166, s[64:67], s73 offen nt
    s_mov_b32 s73, 1179648
    buffer_load_dwordx4 v[68:71], v165, s[68:71], s73 offen nt
    s_mov_b32 s73, 278528
    buffer_load_dwordx4 v[132:135], v166, s[64:67], s73 offen nt
    v_add_u32 v212, v212, v213
    v_lshlrev_b32 v7, 7, v212
    v_and_b32 v212, 1, v209
    v_lshl_add_u32 v7, v212, 6, v7
    v_bfe_u32 v212, v208, 1, 2
    v_lshl_add_u32 v7, v212, 2, v7
    s_lshl_b32 s21, s29, 9
    s_lshl_b32 s22, s18, 4
    s_add_u32 s21, s21, s22
    v_add_u32 v7, s21, v7
    v_bfe_u32 v212, v210, 1, 3
    v_and_b32 v213, 1, v210
    v_lshlrev_b32 v27, 11, v212
    v_lshl_add_u32 v27, v213, 3, v27
    v_lshl_add_u32 v27, v209, 4, v27
    s_lshl_b32 s21, s29, 6
    v_add_u32 v27, s21, v27
    v_lshlrev_b32 v212, 2, v210
    s_xor_b32 s21, s18, 3
    s_mul_i32 s21, s21, 768
    s_add_u32 s21, s21, 0
    v_add_u32 v238, s21, v212
    v_lshlrev_b32 v12, 1, v238
    s_xor_b32 s21, s18, 2
    s_add_u32 m0, s72, 20480
    s_mov_b32 s73, 1310720
    buffer_load_dwordx4 v163, s[12:15], s73 offen nt lds
    s_add_u32 m0, s72, 21504
    s_mov_b32 s73, 1310720
    buffer_load_dwordx4 v164, s[12:15], s73 offen nt lds
    s_add_u32 m0, s72, 22528
    s_mov_b32 s73, 1441792
    buffer_load_dwordx4 v163, s[12:15], s73 offen nt lds
    s_add_u32 m0, s72, 23552
    s_mov_b32 s73, 1441792
    buffer_load_dwordx4 v164, s[12:15], s73 offen nt lds
    s_mov_b32 s73, 1310720
    buffer_load_dwordx4 v[72:75], v165, s[68:71], s73 offen nt
    s_mov_b32 s73, 327680
    buffer_load_dwordx4 v[136:139], v166, s[64:67], s73 offen nt
    s_mov_b32 s73, 1441792
    buffer_load_dwordx4 v[76:79], v165, s[68:71], s73 offen nt
    s_mov_b32 s73, 344064
    buffer_load_dwordx4 v[140:143], v166, s[64:67], s73 offen nt
    s_mul_i32 s21, s21, 768
    s_add_u32 s21, s21, 256
    v_add_u32 v239, s21, v212
    v_lshlrev_b32 v13, 1, v239
    s_xor_b32 s21, s18, 1
    s_mul_i32 s21, s21, 768
    s_add_u32 s21, s21, 512
    v_add_u32 v240, s21, v212
    v_lshlrev_b32 v14, 1, v240
    s_mul_i32 s21, s18, 768
    v_add_u32 v17, s21, v212
    v_lshlrev_b32 v15, 1, v17
    s_lshl_b32 s21, s18, 10
    v_add_u32 v16, s21, v1
    s_mov_b32 s80, s84
    s_and_b32 s81, s85, 0xffff
    s_mov_b32 s82, 0x4000
    s_mov_b32 s83, 0x00020000
    buffer_load_dwordx2 v[246:247], v27, s[80:83], 0 offen
    v_and_b32 v208, 15, v0
    v_bfe_u32 v209, v0, 6, 1
    v_lshl_add_u32 v208, v209, 4, v208
    v_bfe_u32 v209, v0, 4, 2
    v_lshlrev_b32 v209, 2, v209
    v_sub_u32 v208, v208, v209
    s_or_b32 s76, s95, s18
    s_cbranch_scc1 L_rw_2
    s_lshl_b32 s78, s16, 3
    s_add_u32 s78, s78, 128
    s_mov_b32 s79, 0
L_rp_3:
    s_load_dwordx2 s[76:77], s[98:99], s78 glc
    s_add_u32 s79, s79, 1
    s_cmp_gt_u32 s79, 0x100000
    s_cbranch_scc1 chain_kernel_abort
    s_waitcnt lgkmcnt(0)
    s_cmp_lt_u32 s77, 0x2000
    s_cbranch_scc1 L_rp_3
    s_lshr_b32 s77, s1, 8
    s_cmp_eq_u32 s76, -1
    s_cselect_b32 s0, -1, s77
L_rw_2:
    s_waitcnt vmcnt(44)
    s_add_u32 m0, s72, 24576
    s_mov_b32 s73, 1572864
    buffer_load_dwordx4 v163, s[12:15], s73 offen nt lds
    s_add_u32 m0, s72, 25600
    s_mov_b32 s73, 1572864
    buffer_load_dwordx4 v164, s[12:15], s73 offen nt lds
    s_add_u32 m0, s72, 26624
    s_mov_b32 s73, 1703936
    buffer_load_dwordx4 v163, s[12:15], s73 offen nt lds
    s_add_u32 m0, s72, 27648
    s_mov_b32 s73, 1703936
    buffer_load_dwordx4 v164, s[12:15], s73 offen nt lds
    s_mov_b32 s73, 1572864
    buffer_load_dwordx4 v[80:83], v165, s[68:71], s73 offen nt
    s_mov_b32 s73, 393216
    buffer_load_dwordx4 v[144:147], v166, s[64:67], s73 offen nt
    s_mov_b32 s73, 1703936
    buffer_load_dwordx4 v[84:87], v165, s[68:71], s73 offen nt
    s_mov_b32 s73, 409600
    buffer_load_dwordx4 v[148:151], v166, s[64:67], s73 offen nt
    v_mov_b32 v209, 0xff800000
    v_cmp_gt_i32 vcc, 0, v208
    s_nop 1
    v_cndmask_b32 v226, 0, v209, vcc
    v_cmp_gt_i32 vcc, 1, v208
    s_nop 1
    v_cndmask_b32 v227, 0, v209, vcc
    v_cmp_gt_i32 vcc, 2, v208
    s_nop 1
    v_cndmask_b32 v228, 0, v209, vcc
    v_cmp_gt_i32 vcc, 3, v208
    s_nop 1
    v_cndmask_b32 v229, 0, v209, vcc
    v_cmp_gt_i32 vcc, 16, v208
    s_nop 1
    v_cndmask_b32 v230, 0, v209, vcc
    v_cmp_gt_i32 vcc, 17, v208
    s_nop 1
    v_cndmask_b32 v231, 0, v209, vcc
    v_cmp_gt_i32 vcc, 18, v208
    s_nop 1
    v_cndmask_b32 v232, 0, v209, vcc
    v_cmp_gt_i32 vcc, 19, v208
    s_nop 1
    v_cndmask_b32 v233, 0, v209, vcc
    s_waitcnt vmcnt(44)
    s_add_u32 m0, s72, 28672
    s_mov_b32 s73, 1835008
    buffer_load_dwordx4 v163, s[12:15], s73 offen nt lds
    s_add_u32 m0, s72, 29696
    s_mov_b32 s73, 1835008
    buffer_load_dwordx4 v164, s[12:15], s73 offen nt lds
    s_add_u32 m0, s72, 30720
    s_mov_b32 s73, 1966080
    buffer_load_dwordx4 v163, s[12:15], s73 offen nt lds
    s_add_u32 m0, s72, 31744
    s_mov_b32 s73, 1966080
    buffer_load_dwordx4 v164, s[12:15], s73 offen nt lds
    s_mov_b32 s73, 1835008
    buffer_load_dwordx4 v[88:91], v165, s[68:71], s73 offen nt
    s_mov_b32 s73, 458752
    buffer_load_dwordx4 v[152:155], v166, s[64:67], s73 offen nt
    s_mov_b32 s73, 1966080
    buffer_load_dwordx4 v[92:95], v165, s[68:71], s73 offen nt
    s_mov_b32 s73, 475136
    buffer_load_dwordx4 v[156:159], v166, s[64:67], s73 offen nt
    s_cmp_lg_u32 s95, 0
    s_cbranch_scc1 L_rok_4
    v_mov_b32 v208, 31744
    s_cmp_lg_u32 s18, 0
    s_cbranch_scc1 L_rw_5
    v_mov_b32 v209, s0
    ds_write_b32 v208, v209
    s_waitcnt lgkmcnt(0)
L_rw_5:
    s_barrier
    ds_read_b32 v209, v208
    s_waitcnt lgkmcnt(0)
    v_readfirstlane_b32 s20, v209
    s_mov_b32 s95, 1
    s_cmp_eq_u32 s20, -1
    s_cbranch_scc1 L_rok_4
    s_mov_b32 s17, s20
    s_add_u32 s16, s16, 0
    s_mov_b32 s18, s18
    s_waitcnt vmcnt(0)
    s_barrier
    s_branch chain_kernel_roles
L_rok_4:
    s_lshl_b32 s42, s18, 18
    s_add_u32 s42, s42, s53
    buffer_store_dwordx4 v[28:31], v22, s[8:11], s42 offen
    s_lshl_b32 s21, s29, 9
    s_add_u32 s21, s21, s42
    buffer_store_dwordx2 v[28:29], v26, s[8:11], s21 offen
    s_xor_b32 s21, s21, 20480
    buffer_store_dwordx2 v[28:29], v26, s[8:11], s21 offen
    s_lshl_b32 s62, s16, 8
    s_add_u32 s62, s62, 0xb200000
    s_cmp_eq_u32 s17, 1
    s_cselect_b32 s21, s62, 0x10000000
    v_mov_b32 v248, 0
    s_add_u32 s21, s21, 4096
    buffer_store_dword v248, v248, s[8:11], s21 offen sc1
    v_mov_b32 v249, 4
    global_load_dword v249, v249, s[60:61] sc1
    v_bfe_u32 v160, v0, 4, 2
    v_lshlrev_b32 v160, 3, v160
    v_bfe_u32 v162, v0, 2, 2
    v_add_u32 v160, v160, v162
    v_and_b32 v161, 3, v0
    v_bfe_u32 v163, v0, 3, 1
    v_lshlrev_b32 v162, 7, v160
    v_and_b32 v164, 1, v0
    v_lshl_add_u32 v162, v164, 5, v162
    v_bfe_u32 v164, v0, 1, 1
    v_lshl_add_u32 v162, v164, 3, v162
    v_lshl_add_u32 v162, v163, 4, v162
    s_lshr_b32 s21, s18, 1
    s_xor_b32 s21, s21, 1
    s_lshl_b32 s21, s21, 6
    s_add_u32 s21, s21, s72
    v_add_u32 v167, s21, v162
    v_xor_b32 v168, 256, v167
    s_lshr_b32 s21, s18, 1
    s_xor_b32 s21, s21, 0
    s_lshl_b32 s21, s21, 6
    s_add_u32 s21, s21, s72
    v_add_u32 v169, s21, v162
    v_xor_b32 v170, 256, v169
    s_waitcnt vmcnt(44)
    ds_read_b64_tr_b16 a[0:1], v167 offset:0
    ds_read_b64_tr_b16 a[2:3], v167 offset:512
    ds_read_b64_tr_b16 a[4:5], v167 offset:4096
    ds_read_b64_tr_b16 a[6:7], v167 offset:4608
    ds_read_b64_tr_b16 a[32:33], v168 offset:0
    ds_read_b64_tr_b16 a[34:35], v168 offset:512
    ds_read_b64_tr_b16 a[36:37], v168 offset:4096
    ds_read_b64_tr_b16 a[38:39], v168 offset:4608
    s_waitcnt lgkmcnt(0)
    ds_read_b64_tr_b16 a[64:65], v169 offset:0
    ds_read_b64_tr_b16 a[66:67], v169 offset:512
    ds_read_b64_tr_b16 a[68:69], v169 offset:4096
    ds_read_b64_tr_b16 a[70:71], v169 offset:4608
    ds_read_b64_tr_b16 a[96:97], v170 offset:0
    ds_read_b64_tr_b16 a[98:99], v170 offset:512
    ds_read_b64_tr_b16 a[100:101], v170 offset:4096
    ds_read_b64_tr_b16 a[102:103], v170 offset:4608
    s_waitcnt lgkmcnt(0)
    s_waitcnt vmcnt(41)
    ds_read_b64_tr_b16 a[8:9], v167 offset:8192
    ds_read_b64_tr_b16 a[10:11], v167 offset:8704
    ds_read_b64_tr_b16 a[12:13], v167 offset:12288
    ds_read_b64_tr_b16 a[14:15], v167 offset:12800
    ds_read_b64_tr_b16 a[40:41], v168 offset:8192
    ds_read_b64_tr_b16 a[42:43], v168 offset:8704
    ds_read_b64_tr_b16 a[44:45], v168 offset:12288
    ds_read_b64_tr_b16 a[46:47], v168 offset:12800
    s_waitcnt lgkmcnt(0)
    ds_read_b64_tr_b16 a[72:73], v169 offset:8192
    ds_read_b64_tr_b16 a[74:75], v169 offset:8704
    ds_read_b64_tr_b16 a[76:77], v169 offset:12288
    ds_read_b64_tr_b16 a[78:79], v169 offset:12800
    ds_read_b64_tr_b16 a[104:105], v170 offset:8192
    ds_read_b64_tr_b16 a[106:107], v170 offset:8704
    ds_read_b64_tr_b16 a[108:109], v170 offset:12288
    ds_read_b64_tr_b16 a[110:111], v170 offset:12800
    s_waitcnt lgkmcnt(0)
    s_waitcnt vmcnt(25)
    ds_read_b64_tr_b16 a[16:17], v167 offset:16384
    ds_read_b64_tr_b16 a[18:19], v167 offset:16896
    ds_read_b64_tr_b16 a[20:21], v167 offset:20480
    ds_read_b64_tr_b16 a[22:23], v167 offset:20992
    ds_read_b64_tr_b16 a[48:49], v168 offset:16384
    ds_read_b64_tr_b16 a[50:51], v168 offset:16896
    ds_read_b64_tr_b16 a[52:53], v168 offset:20480
    ds_read_b64_tr_b16 a[54:55], v168 offset:20992
    s_waitcnt lgkmcnt(0)
    ds_read_b64_tr_b16 a[80:81], v169 offset:16384
    ds_read_b64_tr_b16 a[82:83], v169 offset:16896
    ds_read_b64_tr_b16 a[84:85], v169 offset:20480
    ds_read_b64_tr_b16 a[86:87], v169 offset:20992
    ds_read_b64_tr_b16 a[112:113], v170 offset:16384
    ds_read_b64_tr_b16 a[114:115], v170 offset:16896
    ds_read_b64_tr_b16 a[116:117], v170 offset:20480
    ds_read_b64_tr_b16 a[118:119], v170 offset:20992
    s_waitcnt lgkmcnt(0)
    s_waitcnt vmcnt(9)
    ds_read_b64_tr_b16 a[24:25], v167 offset:24576
    ds_read_b64_tr_b16 a[26:27], v167 offset:25088
    ds_read_b64_tr_b16 a[28:29], v167 offset:28672
    ds_read_b64_tr_b16 a[30:31], v167 offset:29184
    ds_read_b64_tr_b16 a[56:57], v168 offset:24576
    ds_read_b64_tr_b16 a[58:59], v168 offset:25088
    ds_read_b64_tr_b16 a[60:61], v168 offset:28672
    ds_read_b64_tr_b16 a[62:63], v168 offset:29184
    s_waitcnt lgkmcnt(0)
    ds_read_b64_tr_b16 a[88:89], v169 offset:24576
    ds_read_b64_tr_b16 a[90:91], v169 offset:25088
    ds_read_b64_tr_b16 a[92:93], v169 offset:28672
    ds_read_b64_tr_b16 a[94:95], v169 offset:29184
    ds_read_b64_tr_b16 a[120:121], v170 offset:24576
    ds_read_b64_tr_b16 a[122:123], v170 offset:25088
    ds_read_b64_tr_b16 a[124:125], v170 offset:28672
    ds_read_b64_tr_b16 a[126:127], v170 offset:29184
    s_waitcnt lgkmcnt(0)
    v_add_u32 v171, s72, v1
    v_lshlrev_b32 v162, 6, v160
    v_add_u32 v162, s72, v162
    v_lshl_add_u32 v169, v161, 3, v162
    v_lshl_add_u32 v169, v163, 5, v169
    v_xor_b32 v170, 128, v169
    s_waitcnt vmcnt(0)
    s_barrier
    v_and_b32 v208, 15, v0
    v_lshlrev_b32 v208, 7, v208
    s_lshl_b32 s21, s17, 11
    s_add_u32 s21, s21, s42
    buffer_load_dword v250, v208, s[8:11], s21 offen sc1
    s_cmp_lg_u32 s18, 0
    s_cbranch_scc1 L_m0_6
    s_lshl2_add_u32 s21, s17, s62
    buffer_store_dword v28, v248, s[8:11], s21 offen
    s_lshl_b32 s21, s29, 9
    s_add_u32 s21, s21, s53
    v_min_u32 v246, 0xfffffffe, v246
    v_min_u32 v247, 0xfffffffe, v247
    buffer_store_dwordx2 v[246:247], v26, s[8:11], s21 offen
L_m0_6:
    ds_write_b128 v171, v[32:35] offset:0
    ds_write_b128 v171, v[36:39] offset:1024
    ds_write_b128 v171, v[40:43] offset:2048
    ds_write_b128 v171, v[44:47] offset:3072
    ds_write_b128 v171, v[48:51] offset:4096
    ds_write_b128 v171, v[52:55] offset:5120
    ds_write_b128 v171, v[56:59] offset:6144
    ds_write_b128 v171, v[60:63] offset:7168
    ds_write_b128 v171, v[64:67] offset:8192
    ds_write_b128 v171, v[68:71] offset:9216
    ds_write_b128 v171, v[72:75] offset:10240
    ds_write_b128 v171, v[76:79] offset:11264
    ds_write_b128 v171, v[80:83] offset:12288
    ds_write_b128 v171, v[84:87] offset:13312
    ds_write_b128 v171, v[88:91] offset:14336
    ds_write_b128 v171, v[92:95] offset:15360
    s_waitcnt lgkmcnt(0)
    ds_read_b64_tr_b16 a[128:129], v169 offset:0
    ds_read_b64_tr_b16 a[130:131], v169 offset:256
    ds_read_b64_tr_b16 a[132:133], v169 offset:2048
    ds_read_b64_tr_b16 a[134:135], v169 offset:2304
    ds_read_b64_tr_b16 a[160:161], v170 offset:0
    ds_read_b64_tr_b16 a[162:163], v170 offset:256
    ds_read_b64_tr_b16 a[164:165], v170 offset:2048
    ds_read_b64_tr_b16 a[166:167], v170 offset:2304
    s_waitcnt lgkmcnt(0)
    ds_read_b64_tr_b16 a[136:137], v169 offset:4096
    ds_read_b64_tr_b16 a[138:139], v169 offset:4352
    ds_read_b64_tr_b16 a[140:141], v169 offset:6144
    ds_read_b64_tr_b16 a[142:143], v169 offset:6400
    ds_read_b64_tr_b16 a[168:169], v170 offset:4096
    ds_read_b64_tr_b16 a[170:171], v170 offset:4352
    ds_read_b64_tr_b16 a[172:173], v170 offset:6144
    ds_read_b64_tr_b16 a[174:175], v170 offset:6400
    s_waitcnt lgkmcnt(0)
    ds_read_b64_tr_b16 a[144:145], v169 offset:8192
    ds_read_b64_tr_b16 a[146:147], v169 offset:8448
    ds_read_b64_tr_b16 a[148:149], v169 offset:10240
    ds_read_b64_tr_b16 a[150:151], v169 offset:10496
    ds_read_b64_tr_b16 a[176:177], v170 offset:8192
    ds_read_b64_tr_b16 a[178:179], v170 offset:8448
    ds_read_b64_tr_b16 a[180:181], v170 offset:10240
    ds_read_b64_tr_b16 a[182:183], v170 offset:10496
    s_waitcnt lgkmcnt(0)
    ds_read_b64_tr_b16 a[152:153], v169 offset:12288
    ds_read_b64_tr_b16 a[154:155], v169 offset:12544
    ds_read_b64_tr_b16 a[156:157], v169 offset:14336
    ds_read_b64_tr_b16 a[158:159], v169 offset:14592
    ds_read_b64_tr_b16 a[184:185], v170 offset:12288
    ds_read_b64_tr_b16 a[186:187], v170 offset:12544
    ds_read_b64_tr_b16 a[188:189], v170 offset:14336
    ds_read_b64_tr_b16 a[190:191], v170 offset:14592
    s_waitcnt lgkmcnt(0)
    ds_write_b128 v171, v[96:99] offset:16384
    ds_write_b128 v171, v[100:103] offset:17408
    ds_write_b128 v171, v[104:107] offset:18432
    ds_write_b128 v171, v[108:111] offset:19456
    ds_write_b128 v171, v[112:115] offset:20480
    ds_write_b128 v171, v[116:119] offset:21504
    ds_write_b128 v171, v[120:123] offset:22528
    ds_write_b128 v171, v[124:127] offset:23552
    ds_write_b128 v171, v[128:131] offset:24576
    ds_write_b128 v171, v[132:135] offset:25600
    ds_write_b128 v171, v[136:139] offset:26624
    ds_write_b128 v171, v[140:143] offset:27648
    ds_write_b128 v171, v[144:147] offset:28672
    ds_write_b128 v171, v[148:151] offset:29696
    ds_write_b128 v171, v[152:155] offset:30720
    ds_write_b128 v171, v[156:159] offset:31744
    s_waitcnt lgkmcnt(0)
    ds_read_b64_tr_b16 a[192:193], v169 offset:16384
    ds_read_b64_tr_b16 a[194:195], v169 offset:16640
    ds_read_b64_tr_b16 a[196:197], v169 offset:18432
    ds_read_b64_tr_b16 a[198:199], v169 offset:18688
    ds_read_b64_tr_b16 a[224:225], v170 offset:16384
    ds_read_b64_tr_b16 a[226:227], v170 offset:16640
    ds_read_b64_tr_b16 a[228:229], v170 offset:18432
    ds_read_b64_tr_b16 a[230:231], v170 offset:18688
    s_waitcnt lgkmcnt(0)
    ds_read_b64_tr_b16 a[200:201], v169 offset:20480
    ds_read_b64_tr_b16 a[202:203], v169 offset:20736
    ds_read_b64_tr_b16 a[204:205], v169 offset:22528
    ds_read_b64_tr_b16 a[206:207], v169 offset:22784
    ds_read_b64_tr_b16 a[232:233], v170 offset:20480
    ds_read_b64_tr_b16 a[234:235], v170 offset:20736
    ds_read_b64_tr_b16 a[236:237], v170 offset:22528
    ds_read_b64_tr_b16 a[238:239], v170 offset:22784
    s_waitcnt lgkmcnt(0)
    ds_read_b64_tr_b16 a[208:209], v169 offset:24576
    ds_read_b64_tr_b16 a[210:211], v169 offset:24832
    ds_read_b64_tr_b16 a[212:213], v169 offset:26624
    ds_read_b64_tr_b16 a[214:215], v169 offset:26880
    ds_read_b64_tr_b16 a[240:241], v170 offset:24576
    ds_read_b64_tr_b16 a[242:243], v170 offset:24832
    ds_read_b64_tr_b16 a[244:245], v170 offset:26624
    ds_read_b64_tr_b16 a[246:247], v170 offset:26880
    s_waitcnt lgkmcnt(0)
    ds_read_b64_tr_b16 a[216:217], v169 offset:28672
    ds_read_b64_tr_b16 a[218:219], v169 offset:28928
    ds_read_b64_tr_b16 a[220:221], v169 offset:30720
    ds_read_b64_tr_b16 a[222:223], v169 offset:30976
    ds_read_b64_tr_b16 a[248:249], v170 offset:28672
    ds_read_b64_tr_b16 a[250:251], v170 offset:28928
    ds_read_b64_tr_b16 a[252:253], v170 offset:30720
    ds_read_b64_tr_b16 a[254:255], v170 offset:30976
    s_waitcnt lgkmcnt(0)
    s_mov_b32 s19, 0
    s_mov_b32 s55, 0
    s_mov_b32 s30, 0xc0000
    s_mov_b32 s41, s53
    v_mov_b32 v197, 0
    v_mov_b32 v198, 0
    v_mov_b32 v248, 4
    s_branch L_kvw_7_c
L_kvw_7:
    global_load_dword v249, v248, s[60:61] sc1
    s_add_u32 s33, s33, 1
    s_cmp_gt_u32 s33, 0x100000
    s_cbranch_scc1 chain_kernel_abort
    s_waitcnt vmcnt(0)
L_kvw_7_c:
    v_readfirstlane_b32 s20, v249
    s_and_b32 s21, s20, 0xff
    s_cmp_ge_u32 s21, 15
    s_cbranch_scc1 L_kvok_8
    s_sleep 16
    s_branch L_kvw_7
L_kvok_8:
    s_cmp_ge_u32 s20, 0x800
    s_cselect_b32 s50, 0x2000, 0
    s_add_u32 s52, s50, 0x8000000
    s_add_u32 s48, s48, s50
    v_and_b32 v208, 63, v0
    v_lshlrev_b32 v208, 2, v208
    s_lshr_b32 s22, s17, 3
    s_lshl_b32 s22, s22, 14
    s_and_b32 s23, s17, 7
    s_lshl_b32 s23, s23, 10
    s_add_u32 s22, s22, s23
    s_lshl_b32 s23, s18, 8
    s_add_u32 s22, s22, s23
    s_xor_b32 s21, s16, 0
    s_lshl_b32 s21, s21, 16
    s_add_u32 s21, s21, s22
    v_add_u32 v8, s21, v208
    s_xor_b32 s21, s16, 1
    s_lshl_b32 s21, s21, 16
    s_add_u32 s21, s21, s22
    v_add_u32 v9, s21, v208
    s_xor_b32 s21, s16, 2
    s_lshl_b32 s21, s21, 16
    s_add_u32 s21, s21, s22
    v_add_u32 v10, s21, v208
    s_xor_b32 s21, s16, 3
    s_lshl_b32 s21, s21, 16
    s_add_u32 s21, s21, s22
    v_add_u32 v11, s21, v208
    s_barrier
    s_add_u32 s21, s19, 0
    s_min_u32 s21, s21, 63
    s_lshl_b32 s31, s21, 21
    s_lshl_b32 s21, s21, 13
    s_and_b32 s21, s21, 0x2000
    s_xor_b32 s21, s21, s48
    s_add_u32 s31, s31, s21
    s_cmp_lg_u32 s18, 1
    s_cbranch_scc1 L_init0_9
    v_mov_b32 v248, 0
    s_lshl2_add_u32 s20, s17, s18
    s_cmp_lg_u32 s20, 5
    s_cbranch_scc1 L_rlo_11
L_rl_10:
    s_load_dword s20, s[60:61], 64 glc
    s_add_u32 s33, s33, 1
    s_cmp_gt_u32 s33, 0x100000
    s_cbranch_scc1 chain_kernel_abort
    s_waitcnt lgkmcnt(0)
    s_cmp_lt_u32 s20, 96
    s_cbranch_scc1 L_rl_10
    v_mov_b32 v249, 1
    buffer_store_dword v249, v248, s[8:11], s62 offen offset:128
    s_branch L_rlok_12
L_rlo_11:
    buffer_load_dword v249, v248, s[8:11], s62 offen offset:128 sc1
    s_add_u32 s33, s33, 1
    s_cmp_gt_u32 s33, 0x100000
    s_cbranch_scc1 chain_kernel_abort
    s_waitcnt vmcnt(0)
    v_readfirstlane_b32 s20, v249
    s_cmp_ge_u32 s20, 1
    s_cbranch_scc1 L_rlok_12
    s_sleep 1
    s_branch L_rlo_11
L_rlok_12:
    s_mov_b32 m0, 40960
    s_nop 0
    buffer_load_dwordx4 v237, s[8:11], s31 offen offset:0 lds
    buffer_load_dwordx4 v237, s[8:11], s31 offen offset:1024 lds
L_init0_9:
    s_cmp_lg_u32 s18, 2
    s_cbranch_scc1 L_init2_13
    v_and_b32 v248, 31, v0
    v_lshlrev_b32 v248, 2, v248
L_initp_14:
    buffer_load_dword v249, v248, s[8:11], s62 offen sc1
    s_add_u32 s33, s33, 1
    s_cmp_gt_u32 s33, 0x100000
    s_cbranch_scc1 chain_kernel_abort
    s_waitcnt vmcnt(0)
    v_cmp_eq_u32 vcc, 0, v249
    s_cbranch_vccz L_init2_13
    s_sleep 2
    s_branch L_initp_14
L_init2_13:
    s_barrier
    s_mov_b32 m0, s54
    s_nop 0
    buffer_load_dwordx4 v235, s[8:11], s31 offen offset:0 lds
    buffer_load_dwordx4 v235, s[8:11], s31 offen offset:1024 lds
    buffer_load_dwordx4 v235, s[8:11], s31 offen offset:2048 lds
    buffer_load_dwordx4 v235, s[8:11], s31 offen offset:3072 lds
    s_waitcnt vmcnt(0) lgkmcnt(0)
    s_barrier
chain_kernel_loop:
    s_mov_b32 s40, s41
    s_add_u32 s30, s30, 0x40000
    s_and_b32 s30, s30, 0xc0000
    s_xor_b32 s20, s30, 0x80000
    s_add_u32 s42, s53, s20
    s_lshl_b32 s43, s19, 19
    s_lshl_b32 s20, s19, 11
    s_and_b32 s20, s20, 0x2000
    s_xor_b32 s20, s20, s52
    s_add_u32 s43, s43, s20
    s_add_u32 s44, s43, 0x40000
    s_add_u32 s20, s30, 0x40000
    s_and_b32 s20, s20, 0xc0000
    s_add_u32 s41, s53, s20
    v_mov_b32 v64, 0
    v_mov_b32 v65, 0
    v_mov_b32 v66, 0
    v_mov_b32 v67, 0
    v_mov_b32 v68, 0
    v_mov_b32 v69, 0
    v_mov_b32 v70, 0
    v_mov_b32 v71, 0
    v_mov_b32 v72, 0
    v_mov_b32 v73, 0
    v_mov_b32 v74, 0
    v_mov_b32 v75, 0
    v_mov_b32 v76, 0
    v_mov_b32 v77, 0
    v_mov_b32 v78, 0
    v_mov_b32 v79, 0
    s_nop 13
    buffer_load_dwordx4 v[32:35], v2, s[8:11], s40 offen offset:0 sc1
    s_nop 13
    buffer_load_dwordx4 v[36:39], v2, s[8:11], s40 offen offset:1024 sc1
    s_nop 13
    buffer_load_dwordx4 v[40:43], v2, s[8:11], s40 offen offset:2048 sc1
    s_nop 13
    buffer_load_dwordx4 v[44:47], v2, s[8:11], s40 offen offset:3072 sc1
Gq_17_s0123:
    s_waitcnt vmcnt(3)
    v_cmp_eq_u32 vcc, -1, v32
    v_mov_b32_dpp v48, v32 row_ror:8 row_mask:0xf bank_mask:0xf
    v_mov_b32_dpp v49, v33 row_ror:8 row_mask:0xf bank_mask:0xf
    v_mov_b32_dpp v50, v34 row_ror:8 row_mask:0xf bank_mask:0xf
    v_mov_b32_dpp v51, v35 row_ror:8 row_mask:0xf bank_mask:0xf
    s_cbranch_vccnz Gq_17_f0123
    v_smfmac_f32_16x16x64_bf16 v[64:67], v[32:35], a[0:7], v19
    v_smfmac_f32_16x16x64_bf16 v[68:71], v[32:35], a[64:71], v19
Gq_17_s123p0:
    s_waitcnt vmcnt(2)
    v_cmp_eq_u32 vcc, -1, v36
    v_smfmac_f32_16x16x64_bf16 v[64:67], v[48:51], a[32:39], v19
    v_mov_b32_dpp v52, v36 row_ror:8 row_mask:0xf bank_mask:0xf
    v_mov_b32_dpp v53, v37 row_ror:8 row_mask:0xf bank_mask:0xf
    v_smfmac_f32_16x16x64_bf16 v[68:71], v[48:51], a[96:103], v19
    v_mov_b32_dpp v54, v38 row_ror:8 row_mask:0xf bank_mask:0xf
    v_mov_b32_dpp v55, v39 row_ror:8 row_mask:0xf bank_mask:0xf
    s_cbranch_vccnz Gq_17_f123p0
    v_smfmac_f32_16x16x64_bf16 v[64:67], v[36:39], a[8:15], v19
    v_smfmac_f32_16x16x64_bf16 v[68:71], v[36:39], a[72:79], v19
Gq_17_s23p1:
    s_waitcnt vmcnt(1)
    v_cmp_eq_u32 vcc, -1, v40
    v_smfmac_f32_16x16x64_bf16 v[64:67], v[52:55], a[40:47], v19
    v_mov_b32_dpp v56, v40 row_ror:8 row_mask:0xf bank_mask:0xf
    v_mov_b32_dpp v57, v41 row_ror:8 row_mask:0xf bank_mask:0xf
    v_smfmac_f32_16x16x64_bf16 v[68:71], v[52:55], a[104:111], v19
    v_mov_b32_dpp v58, v42 row_ror:8 row_mask:0xf bank_mask:0xf
    v_mov_b32_dpp v59, v43 row_ror:8 row_mask:0xf bank_mask:0xf
    s_cbranch_vccnz Gq_17_f23p1
    v_smfmac_f32_16x16x64_bf16 v[64:67], v[40:43], a[16:23], v19
    v_smfmac_f32_16x16x64_bf16 v[68:71], v[40:43], a[80:87], v19
Gq_17_s3p2:
    s_waitcnt vmcnt(0)
    v_cmp_eq_u32 vcc, -1, v44
    v_smfmac_f32_16x16x64_bf16 v[64:67], v[56:59], a[48:55], v19
    v_mov_b32_dpp v60, v44 row_ror:8 row_mask:0xf bank_mask:0xf
    v_mov_b32_dpp v61, v45 row_ror:8 row_mask:0xf bank_mask:0xf
    v_smfmac_f32_16x16x64_bf16 v[68:71], v[56:59], a[112:119], v19
    v_mov_b32_dpp v62, v46 row_ror:8 row_mask:0xf bank_mask:0xf
    v_mov_b32_dpp v63, v47 row_ror:8 row_mask:0xf bank_mask:0xf
    s_cbranch_vccnz Gq_17_f3p2
    v_smfmac_f32_16x16x64_bf16 v[64:67], v[44:47], a[24:31], v19
    v_smfmac_f32_16x16x64_bf16 v[68:71], v[44:47], a[88:95], v19
    v_smfmac_f32_16x16x64_bf16 v[64:67], v[60:63], a[56:63], v19
    v_smfmac_f32_16x16x64_bf16 v[68:71], v[60:63], a[120:127], v19
Gq_17_done:
    v_max3_u32 v20, v33, v34, v35
    v_max3_u32 v208, v37, v38, v39
    v_max3_u32 v209, v41, v42, v43
    v_max3_u32 v210, v45, v46, v47
    ds_write_b64 v12, v[64:65] offset:0
    ds_write_b64 v13, v[66:67] offset:0
    v_max_u32 v20, v20, v208
    v_max3_u32 v20, v20, v209, v210
    ds_write_b64 v14, v[68:69] offset:0
    s_add_u32 m0, s51, 32768
    v_cmp_eq_u32 vcc, -1, v20
    buffer_load_dwordx4 v243, s[8:11], s31 offen offset:0 lds
    buffer_load_dwordx4 v243, s[8:11], s31 offen offset:1024 lds
    v_smfmac_f32_16x16x64_bf16 v[72:75], v[32:35], a[128:135], v19
    v_smfmac_f32_16x16x64_bf16 v[72:75], v[48:51], a[160:167], v19
    s_cbranch_vccnz Gq_17_redo
    s_waitcnt lgkmcnt(0)
    s_barrier
    ds_read_b64 v[80:81], v15 offset:0
    ds_read_b64 v[82:83], v15 offset:512
    ds_read_b64 v[84:85], v15 offset:1024
    v_smfmac_f32_16x16x64_bf16 v[72:75], v[36:39], a[136:143], v19
    v_smfmac_f32_16x16x64_bf16 v[72:75], v[52:55], a[168:175], v19
    s_waitcnt lgkmcnt(2)
    v_pk_add_f32 v[70:71], v[70:71], v[80:81]
    s_waitcnt lgkmcnt(0)
    v_pk_add_f32 v[82:83], v[82:83], v[84:85]
    v_pk_add_f32 v[70:71], v[70:71], v[82:83]
    v_cvt_pk_bf16_f32 v70, v70, v71
    s_cmp_lg_u32 s18, 0
    s_nop 0
    v_mov_b32_dpp v71, v70 quad_perm:[1,0,3,2] row_mask:0xf bank_mask:0xf
    v_perm_b32 v70, v71, v70, v18
    v_min_u32 v70, 0xfffffffe, v70
    buffer_store_dword v70, v4, s[8:11], s40 offen
    v_smfmac_f32_16x16x64_bf16 v[72:75], v[40:43], a[144:151], v19
    v_smfmac_f32_16x16x64_bf16 v[72:75], v[56:59], a[176:183], v19
    v_smfmac_f32_16x16x64_bf16 v[72:75], v[44:47], a[152:159], v19
    v_smfmac_f32_16x16x64_bf16 v[72:75], v[60:63], a[184:191], v19
    s_nop 7
    ds_write_b128 v16, v[72:75] offset:12288
    s_cbranch_scc1 L_help_15
    s_nop 15
    s_nop 11
    buffer_load_dwordx4 v[148:151], v5, s[8:11], s40 offen offset:0 sc1
    buffer_load_dwordx4 v[152:155], v5, s[8:11], s40 offen offset:1024 sc1
    buffer_load_dwordx4 v[156:159], v5, s[8:11], s40 offen offset:2048 sc1
    buffer_load_dwordx4 v[160:163], v5, s[8:11], s40 offen offset:3072 sc1
    s_waitcnt vmcnt(5) lgkmcnt(0)
    s_barrier
    ds_read_b128 v[104:107], v1 offset:32768
    ds_read_b128 v[108:111], v1 offset:33792
    ds_read_b128 v[112:115], v1 offset:34816
    ds_read_b128 v[116:119], v1 offset:35840
    ds_read_b128 v[120:123], v1 offset:36864
    ds_read_b128 v[124:127], v1 offset:37888
    ds_read_b128 v[128:131], v1 offset:38912
    ds_read_b128 v[132:135], v1 offset:39936
    ds_read_b128 v[136:139], v1 offset:40960
    ds_read_b128 v[140:143], v1 offset:41984
    buffer_load_dwordx4 v[164:167], v5, s[8:11], s40 offen offset:0 sc1
    buffer_load_dwordx4 v[168:171], v5, s[8:11], s40 offen offset:1024 sc1
    buffer_load_dwordx4 v[172:175], v5, s[8:11], s40 offen offset:2048 sc1
    buffer_load_dwordx4 v[176:179], v5, s[8:11], s40 offen offset:3072 sc1
    s_nop 13
    buffer_load_dwordx4 v[32:35], v5, s[8:11], s40 offen offset:0 sc1
    buffer_load_dwordx4 v[36:39], v5, s[8:11], s40 offen offset:1024 sc1
    buffer_load_dwordx4 v[40:43], v5, s[8:11], s40 offen offset:2048 sc1
    buffer_load_dwordx4 v[44:47], v5, s[8:11], s40 offen offset:3072 sc1
    s_waitcnt lgkmcnt(0)
L_sd_18_0_0:
    s_waitcnt vmcnt(11)
    v_max3_u32 v20, v148, v149, v150
    v_mfma_f32_16x16x32_bf16 v[88:91], v[148:151], v[148:151], 0
    v_max_u32 v20, v20, v151
    v_cmp_eq_u32 vcc, -1, v20
    v_mfma_f32_16x16x32_bf16 v[84:87], v[120:123], v[148:151], 0
    v_mfma_f32_16x16x32_bf16 v[80:83], v[104:107], v[148:151], 0
    s_cbranch_vccnz L_sd_18_1_0
L_sd_18_0_1:
    s_waitcnt vmcnt(10)
    v_max3_u32 v20, v152, v153, v154
    v_mfma_f32_16x16x32_bf16 v[100:103], v[152:155], v[152:155], v[88:91]
    v_max_u32 v20, v20, v155
    v_cmp_eq_u32 vcc, -1, v20
    v_mfma_f32_16x16x32_bf16 v[96:99], v[124:127], v[152:155], v[84:87]
    v_mfma_f32_16x16x32_bf16 v[92:95], v[108:111], v[152:155], v[80:83]
    s_cbranch_vccnz L_sd_18_1_1
L_sd_18_0_2:
    s_waitcnt vmcnt(9)
    v_max3_u32 v20, v156, v157, v158
    v_mfma_f32_16x16x32_bf16 v[228:231], v[156:159], v[156:159], v[100:103]
    v_max_u32 v20, v20, v159
    v_cmp_eq_u32 vcc, -1, v20
    v_mfma_f32_16x16x32_bf16 v[224:227], v[128:131], v[156:159], v[96:99]
    v_mfma_f32_16x16x32_bf16 v[220:223], v[112:115], v[156:159], v[92:95]
    s_cbranch_vccnz L_sd_18_1_2
L_sd_18_0_3:
    s_waitcnt vmcnt(8)
    v_max3_u32 v20, v160, v161, v162
    v_mfma_f32_16x16x32_bf16 v[188:191], v[160:163], v[160:163], v[228:231]
    v_max_u32 v20, v20, v163
    v_cmp_eq_u32 vcc, -1, v20
    v_mfma_f32_16x16x32_bf16 v[184:187], v[132:135], v[160:163], v[224:227]
    v_mfma_f32_16x16x32_bf16 v[180:183], v[116:119], v[160:163], v[220:223]
    v_mov_b32_dpp v188, v189 row_ror:8 row_mask:0xf bank_mask:0xc
    v_mov_b32_dpp v190, v191 row_ror:8 row_mask:0xf bank_mask:0xc
    s_cbranch_vccnz L_sd_18_1_3
L_sd_18:
    s_barrier
    v_permlane32_swap_b32 v188, v190
    ds_read_b64 v[144:145], v26 offset:28672
    s_cmp_eq_u32 s19, 63
    s_cbranch_scc1 chain_kernel_fin
    v_mov_b32_dpp v180, v184 row_ror:8 row_mask:0xf bank_mask:0xc
    v_mov_b32_dpp v181, v185 row_ror:8 row_mask:0xf bank_mask:0xc
    v_mov_b32_dpp v182, v186 row_ror:8 row_mask:0xf bank_mask:0xc
    v_mov_b32_dpp v183, v187 row_ror:8 row_mask:0xf bank_mask:0xc
    v_max3_f32 v208, v190, v180, v181
    v_max3_f32 v208, v208, v182, v183
    v_cvt_pk_bf16_f32 v180, 0, v180
    v_cvt_pk_bf16_f32 v181, 0, v181
    v_max_f32_dpp v208, v208, v208 row_ror:8 row_mask:0xf bank_mask:0xf
    v_mov_b32 v209, v208
    v_cvt_pk_bf16_f32 v182, 0, v182
    v_cvt_pk_bf16_f32 v183, 0, v183
    v_permlane16_swap_b32 v208, v209
    v_cvt_pk_bf16_f32 v190, 0, v190
    v_max_f32 v208, v208, v209
    v_mov_b32 v209, v208
    v_pk_mul_f32 v[180:181], v[180:181], s[58:59]
    v_pk_mul_f32 v[182:183], v[182:183], s[58:59]
    v_permlane32_swap_b32 v208, v209
    v_mul_f32 v190, s58, v190
    v_max_f32 v208, v208, v209
    v_cvt_pk_bf16_f32 v180, 0, v180
    v_cvt_pk_bf16_f32 v208, 0, v208
    v_cvt_pk_bf16_f32 v181, 0, v181
    v_mul_f32 v208, s58, v208
    v_cvt_pk_bf16_f32 v182, 0, v182
    v_cvt_pk_bf16_f32 v208, 0, v208
    v_cvt_pk_bf16_f32 v183, 0, v183
    v_mul_f32 v208, s56, v208
    v_cvt_pk_bf16_f32 v190, 0, v190
    v_pk_fma_f32 v[180:181], v[180:181], s[56:57], v[208:209] op_sel_hi:[1,1,0] neg_lo:[0,0,1] neg_hi:[0,0,1]
    v_pk_fma_f32 v[182:183], v[182:183], s[56:57], v[208:209] op_sel_hi:[1,1,0] neg_lo:[0,0,1] neg_hi:[0,0,1]
    v_fma_f32 v190, v190, s56, -v208
    v_exp_f32 v180, v180
    v_exp_f32 v181, v181
    v_exp_f32 v182, v182
    v_exp_f32 v183, v183
    v_exp_f32 v190, v190
    v_cvt_pk_bf16_f32 v192, v180, v181
    v_cvt_pk_bf16_f32 v193, v182, v183
    v_mov_b32_dpp v209, v190 row_ror:8 row_mask:0xf bank_mask:0xf
    v_mov_b32_dpp v194, v192 row_ror:8 row_mask:0xf bank_mask:0xf
    v_mov_b32_dpp v195, v193 row_ror:8 row_mask:0xf bank_mask:0xf
    v_cvt_pk_bf16_f32 v196, v190, v209
    v_pk_add_f32 v[210:211], v[180:181], v[182:183]
    v_mfma_f32_16x16x32_bf16 v[200:203], v[136:139], v[192:195], 0
    v_add_f32 v210, v210, v190
    v_add_f32 v210, v210, v211
    v_mfma_f32_16x16x32_bf16 v[204:207], v[140:143], v[192:195], 0
    v_cvt_pk_bf16_f32 v199, v190, v209
    s_waitcnt lgkmcnt(0)
    v_add_f32_dpp v210, v210, v210 row_ror:8 row_mask:0xf bank_mask:0xf
    v_mfma_f32_16x16x16_bf16 v[200:203], v[144:145], v[196:197], v[200:203]
    v_mov_b32 v209, v210
    s_nop 0
    v_mfma_f32_16x16x16_bf16 v[204:207], v[144:145], v[198:199], v[204:207]
    v_permlane16_swap_b32 v210, v209
    v_add_f32 v210, v210, v209
    v_mov_b32 v209, v210
    s_nop 1
    v_permlane32_swap_b32 v210, v209
    v_add_f32 v210, v210, v209
    v_rcp_f32 v210, v210
    s_mov_b64 exec, s[24:25]
    v_pk_mul_f32 v[200:201], v[200:201], v[210:211] op_sel_hi:[1,0]
    v_pk_mul_f32 v[202:203], v[202:203], v[210:211] op_sel_hi:[1,0]
    v_pk_mul_f32 v[204:205], v[204:205], v[210:211] op_sel_hi:[1,0]
    v_pk_mul_f32 v[206:207], v[206:207], v[210:211] op_sel_hi:[1,0]
    v_cvt_pk_bf16_f32 v200, v200, v201
    v_cvt_pk_bf16_f32 v201, v202, v203
    v_cvt_pk_bf16_f32 v202, v204, v205
    v_cvt_pk_bf16_f32 v203, v206, v207
    v_min_u32 v200, 0xfffffffe, v200
    v_min_u32 v201, 0xfffffffe, v201
    v_min_u32 v202, 0xfffffffe, v202
    v_min_u32 v203, 0xfffffffe, v203
    buffer_store_dwordx4 v[200:203], v6, s[8:11], s40 offen
    s_mov_b64 exec, -1
L_b4_16:
    s_barrier
    s_add_u32 s21, s19, 1
    s_min_u32 s21, s21, 63
    s_lshl_b32 s31, s21, 21
    s_lshl_b32 s21, s21, 13
    s_and_b32 s21, s21, 0x2000
    s_xor_b32 s21, s21, s48
    s_add_u32 s31, s31, s21
    s_add_u32 s19, s19, 1
    s_nop 15
    s_nop 11
    buffer_load_dwordx4 v[32:35], v3, s[8:11], s40 offen offset:0 sc1
    s_nop 13
    buffer_load_dwordx4 v[36:39], v3, s[8:11], s40 offen offset:1024 sc1
    s_nop 13
    buffer_load_dwordx4 v[40:43], v3, s[8:11], s40 offen offset:2048 sc1
    s_nop 13
    buffer_load_dwordx4 v[44:47], v3, s[8:11], s40 offen offset:3072 sc1
Go_19_s0123:
    s_waitcnt vmcnt(3)
    v_cmp_eq_u32 vcc, -1, v32
    v_mov_b32_dpp v48, v32 row_ror:8 row_mask:0xf bank_mask:0xf
    v_mov_b32_dpp v49, v33 row_ror:8 row_mask:0xf bank_mask:0xf
    v_mov_b32_dpp v50, v34 row_ror:8 row_mask:0xf bank_mask:0xf
    v_mov_b32_dpp v51, v35 row_ror:8 row_mask:0xf bank_mask:0xf
    s_cbranch_vccnz Go_19_f0123
    v_smfmac_f32_16x16x64_bf16 v[76:79], v[32:35], a[192:199], v19
    v_smfmac_f32_16x16x64_bf16 v[76:79], v[48:51], a[224:231], v19
Go_19_s123:
    s_waitcnt vmcnt(2)
    v_cmp_eq_u32 vcc, -1, v36
    v_mov_b32_dpp v52, v36 row_ror:8 row_mask:0xf bank_mask:0xf
    v_mov_b32_dpp v53, v37 row_ror:8 row_mask:0xf bank_mask:0xf
    v_mov_b32_dpp v54, v38 row_ror:8 row_mask:0xf bank_mask:0xf
    v_mov_b32_dpp v55, v39 row_ror:8 row_mask:0xf bank_mask:0xf
    s_cbranch_vccnz Go_19_f123
    v_smfmac_f32_16x16x64_bf16 v[76:79], v[36:39], a[200:207], v19
    v_smfmac_f32_16x16x64_bf16 v[76:79], v[52:55], a[232:239], v19
Go_19_s23:
    s_waitcnt vmcnt(1)
    v_cmp_eq_u32 vcc, -1, v40
    v_mov_b32_dpp v56, v40 row_ror:8 row_mask:0xf bank_mask:0xf
    v_mov_b32_dpp v57, v41 row_ror:8 row_mask:0xf bank_mask:0xf
    v_mov_b32_dpp v58, v42 row_ror:8 row_mask:0xf bank_mask:0xf
    v_mov_b32_dpp v59, v43 row_ror:8 row_mask:0xf bank_mask:0xf
    s_cbranch_vccnz Go_19_f23
    v_smfmac_f32_16x16x64_bf16 v[76:79], v[40:43], a[208:215], v19
    v_smfmac_f32_16x16x64_bf16 v[76:79], v[56:59], a[240:247], v19
Go_19_s3:
    s_waitcnt vmcnt(0)
    v_cmp_eq_u32 vcc, -1, v44
    v_mov_b32_dpp v60, v44 row_ror:8 row_mask:0xf bank_mask:0xf
    v_mov_b32_dpp v61, v45 row_ror:8 row_mask:0xf bank_mask:0xf
    v_mov_b32_dpp v62, v46 row_ror:8 row_mask:0xf bank_mask:0xf
    v_mov_b32_dpp v63, v47 row_ror:8 row_mask:0xf bank_mask:0xf
    s_cbranch_vccnz Go_19_f3
    v_smfmac_f32_16x16x64_bf16 v[76:79], v[44:47], a[216:223], v19
    v_smfmac_f32_16x16x64_bf16 v[76:79], v[60:63], a[248:255], v19
Go_19_done:
    v_max3_u32 v20, v33, v34, v35
    v_max3_u32 v208, v37, v38, v39
    v_max3_u32 v209, v41, v42, v43
    v_max3_u32 v210, v45, v46, v47
    v_max_u32 v20, v20, v208
    v_max3_u32 v20, v20, v209, v210
    v_cmp_eq_u32 vcc, -1, v20
    s_nop 0
    ds_write_b32 v238, v76 offset:20480
    ds_write_b32 v239, v77 offset:20480
    ds_write_b32 v240, v78 offset:20480
    s_cbranch_vccnz Go_19_redo
    s_waitcnt lgkmcnt(0)
    s_barrier
    ds_read_b32 v80, v17 offset:20480
    ds_read_b32 v81, v17 offset:20736
    ds_read_b32 v82, v17 offset:20992
    s_cmp_lt_u32 s18, 2
    s_waitcnt lgkmcnt(2)
    v_add_f32 v80, v80, v79
    s_waitcnt lgkmcnt(0)
    v_add_f32 v81, v81, v82
    v_add_f32 v80, v80, v81
    v_min_u32 v80, 0xfffffffe, v80
    buffer_store_dword v80, v8, s[8:11], s43 offen sc1
    buffer_store_dword v80, v8, s[8:11], s44 offen sc1
    ds_read_b128 v[164:167], v241 offset:51200
    ds_read_b128 v[168:171], v241 offset:51712
    ds_read_b128 v[172:175], v241 offset:52224
    ds_read_b128 v[176:179], v241 offset:52736
    s_waitcnt lgkmcnt(3)
    v_mfma_f32_16x16x32_bf16 v[188:191], v[164:167], v[148:151], 0
    s_waitcnt lgkmcnt(2)
    v_mfma_f32_16x16x32_bf16 v[188:191], v[168:171], v[152:155], v[188:191]
    s_waitcnt lgkmcnt(1)
    v_mfma_f32_16x16x32_bf16 v[188:191], v[172:175], v[156:159], v[188:191]
    s_waitcnt lgkmcnt(0)
    v_mfma_f32_16x16x32_bf16 v[188:191], v[176:179], v[160:163], v[188:191]
    s_nop 7
    v_cvt_pk_bf16_f32 v188, 0, v188
    v_cvt_pk_bf16_f32 v189, 0, v189
    v_pk_mul_f32 v[188:189], v[188:189], s[58:59]
    v_cvt_pk_bf16_f32 v188, 0, v188
    v_cvt_pk_bf16_f32 v189, 0, v189
    v_max3_f32 v212, v212, v188, v189
    v_mov_b32 v213, v212
    s_nop 1
    v_permlane16_swap_b32 v212, v213
    buffer_load_dword v220, v9, s[8:11], s43 offen sc1
    buffer_load_dword v221, v10, s[8:11], s43 offen sc1
    buffer_load_dword v222, v11, s[8:11], s43 offen sc1
    v_max_f32 v212, v212, v213
    v_mov_b32 v213, v212
    s_nop 1
    v_permlane32_swap_b32 v212, v213
    v_max_f32 v212, v212, v213
    v_mul_f32 v212, s56, v212
    v_pk_fma_f32 v[180:181], v[180:181], s[56:57], v[212:213] op_sel_hi:[1,1,0] neg_lo:[0,0,1] neg_hi:[0,0,1]
    v_pk_fma_f32 v[182:183], v[182:183], s[56:57], v[212:213] op_sel_hi:[1,1,0] neg_lo:[0,0,1] neg_hi:[0,0,1]
    v_pk_fma_f32 v[184:185], v[184:185], s[56:57], v[212:213] op_sel_hi:[1,1,0] neg_lo:[0,0,1] neg_hi:[0,0,1]
    v_pk_fma_f32 v[186:187], v[186:187], s[56:57], v[212:213] op_sel_hi:[1,1,0] neg_lo:[0,0,1] neg_hi:[0,0,1]
    v_pk_fma_f32 v[188:189], v[188:189], s[56:57], v[212:213] op_sel_hi:[1,1,0] neg_lo:[0,0,1] neg_hi:[0,0,1]
    v_exp_f32 v180, v180
    v_exp_f32 v181, v181
    v_exp_f32 v182, v182
    v_exp_f32 v183, v183
    v_exp_f32 v184, v184
    v_exp_f32 v185, v185
    v_exp_f32 v186, v186
    buffer_load_dword v223, v9, s[8:11], s44 offen sc1
    buffer_load_dword v224, v10, s[8:11], s44 offen sc1
    buffer_load_dword v225, v11, s[8:11], s44 offen sc1
    s_add_u32 m0, s51, 43008
    v_exp_f32 v187, v187
    v_exp_f32 v188, v188
    v_exp_f32 v189, v189
    v_pk_add_f32 v[214:215], v[180:181], v[182:183]
    v_pk_add_f32 v[216:217], v[184:185], v[186:187]
    v_pk_add_f32 v[214:215], v[214:215], v[188:189]
    buffer_load_dwordx4 v244, s[8:11], s31 offen offset:0 lds
    v_pk_add_f32 v[214:215], v[214:215], v[216:217]
    v_add_f32 v214, v214, v215
    v_mov_b32 v213, v214
    s_nop 1
    v_permlane16_swap_b32 v214, v213
    v_add_f32 v214, v214, v213
    buffer_load_dwordx4 v244, s[8:11], s31 offen offset:1024 lds
    v_mov_b32 v213, v214
    s_nop 1
    v_permlane32_swap_b32 v214, v213
    v_add_f32 v214, v214, v213
    v_rcp_f32 v214, v214
    s_nop 0
    v_pk_mul_f32 v[180:181], v[180:181], v[214:215] op_sel_hi:[1,0]
    v_pk_mul_f32 v[182:183], v[182:183], v[214:215] op_sel_hi:[1,0]
    v_pk_mul_f32 v[184:185], v[184:185], v[214:215] op_sel_hi:[1,0]
    v_pk_mul_f32 v[186:187], v[186:187], v[214:215] op_sel_hi:[1,0]
    v_pk_mul_f32 v[188:189], v[188:189], v[214:215] op_sel_hi:[1,0]
    v_cvt_pk_bf16_f32 v192, v180, v181
    v_cvt_pk_bf16_f32 v193, v182, v183
    v_cvt_pk_bf16_f32 v194, v184, v185
    v_cvt_pk_bf16_f32 v195, v186, v187
    v_cvt_pk_bf16_f32 v196, v188, v189
    v_cvt_pk_bf16_f32 v199, v188, v189
    v_mfma_f32_16x16x32_bf16 v[200:203], v[136:139], v[192:195], 0
    v_mfma_f32_16x16x32_bf16 v[204:207], v[140:143], v[192:195], 0
    v_mfma_f32_16x16x16_bf16 v[200:203], v[144:145], v[196:197], v[200:203]
    v_mfma_f32_16x16x16_bf16 v[204:207], v[144:145], v[198:199], v[204:207]
L_pj_21:
    s_waitcnt vmcnt(7)
    v_add_f32 v208, v80, v220
    s_waitcnt vmcnt(5)
    v_add_f32 v209, v221, v222
    v_max3_u32 v20, v220, v221, v222
    v_add_f32 v208, v208, v209
    v_cmp_eq_u32 vcc, -1, v20
    s_nop 0
    v_mov_b32_dpp v209, v208 quad_perm:[1,0,3,2] row_mask:0xf bank_mask:0xf
    s_mov_b64 exec, s[26:27]
    v_cvt_pk_bf16_f32 v208, v208, v209
    v_min_u32 v208, 0xfffffffe, v208
    s_cbranch_vccnz L_pf_26
L_pd_25:
    buffer_store_dword v208, v7, s[8:11], s41 offen
    s_mov_b64 exec, -1
    s_branch chain_kernel_loop
L_help_15:
    s_waitcnt vmcnt(1) lgkmcnt(0)
    s_barrier
    s_cmp_ge_u32 s18, 2
    s_cbranch_scc1 L_w2_30
    ds_read_b128 v[80:83], v1 offset:12288
    ds_read_b128 v[84:87], v1 offset:14336
    ds_read_b128 v[88:91], v1 offset:15360
    s_waitcnt lgkmcnt(2)
    v_pk_add_f32 v[72:73], v[72:73], v[82:83]
    v_pk_add_f32 v[74:75], v[74:75], v[80:81]
    s_waitcnt lgkmcnt(1)
    v_pk_add_f32 v[72:73], v[72:73], v[86:87]
    v_pk_add_f32 v[74:75], v[74:75], v[84:85]
    s_waitcnt lgkmcnt(0)
    v_pk_add_f32 v[72:73], v[72:73], v[88:89]
    v_pk_add_f32 v[74:75], v[74:75], v[90:91]
    v_cvt_pk_bf16_f32 v144, v72, v73
    v_cvt_pk_bf16_f32 v145, v74, v75
    s_nop 1
    v_permlane32_swap_b32 v144, v145
    s_nop 1
    ds_write_b64 v26, v[144:145] offset:28672
    s_add_u32 s21, s19, 1
    s_min_u32 s21, s21, 63
    s_lshl_b32 s63, s21, 21
    s_lshl_b32 s21, s21, 13
    s_and_b32 s21, s21, 0x2000
    s_xor_b32 s21, s21, s48
    s_add_u32 s63, s63, s21
    s_nop 15
    s_nop 0
    buffer_load_dword v250, v25, s[8:11], s63 offen sc1
    s_add_u32 s20, s19, 2
    s_min_u32 s20, s20, 63
    s_bfm_b64 s[22:23], s20, 0
    s_and_b32 s22, s22, 0x808088af
    s_and_b32 s23, s23, 0x80808080
    s_bcnt1_i32_b64 s32, s[22:23]
    s_lshl_b32 s32, s32, 2
    s_add_u32 s32, s32, 64
    s_cmp_eq_u32 s47, 1
    s_cselect_b32 s32, s32, s55
    s_add_u32 s21, s19, 1
    s_min_u32 s21, s21, 63
    s_lshl_b32 s31, s21, 21
    s_lshl_b32 s21, s21, 13
    s_and_b32 s21, s21, 0x2000
    s_xor_b32 s21, s21, s48
    s_add_u32 s31, s31, s21
    s_waitcnt lgkmcnt(0)
    s_cmp_eq_u32 s32, s55
    s_cbranch_scc1 L_nog_33
    s_load_dword s22, s[60:61], s32 glc
L_nog_33:
    s_mov_b32 s23, 1
    s_barrier
    s_cmp_lg_u32 s19, 0
    s_cbranch_scc1 L_ns0_36
    v_mov_b32 v248, 0
    s_lshl2_add_u32 s20, s17, s18
    s_cmp_lg_u32 s20, 5
    s_cbranch_scc1 L_rlo_38
L_rl_37:
    s_load_dword s20, s[60:61], 68 glc
    s_add_u32 s33, s33, 1
    s_cmp_gt_u32 s33, 0x100000
    s_cbranch_scc1 chain_kernel_abort
    s_waitcnt lgkmcnt(0)
    s_cmp_lt_u32 s20, 96
    s_cbranch_scc1 L_rl_37
    v_mov_b32 v249, 2
    buffer_store_dword v249, v248, s[8:11], s62 offen offset:128
    s_branch L_rlok_39
L_rlo_38:
    buffer_load_dword v249, v248, s[8:11], s62 offen offset:128 sc1
    s_add_u32 s33, s33, 1
    s_cmp_gt_u32 s33, 0x100000
    s_cbranch_scc1 chain_kernel_abort
    s_waitcnt vmcnt(0)
    v_readfirstlane_b32 s20, v249
    s_cmp_ge_u32 s20, 2
    s_cbranch_scc1 L_rlok_39
    s_sleep 1
    s_branch L_rlo_38
L_rlok_39:
L_ns0_36:
    s_mov_b32 m0, 40960
    s_nop 0
    buffer_load_dwordx4 v237, s[8:11], s31 offen offset:0 lds
    buffer_load_dwordx4 v237, s[8:11], s31 offen offset:1024 lds
    s_cmp_lg_u32 s47, 0
    s_cbranch_scc1 L_nof_35
    s_atomic_add s23, s[60:61], 208
L_nof_35:
    buffer_store_dwordx4 v[28:31], v22, s[8:11], s42 offen
    s_lshl_b32 s21, s29, 9
    s_add_u32 s21, s21, s42
    buffer_store_dwordx2 v[28:29], v26, s[8:11], s21 offen
    s_xor_b32 s21, s21, 20480
    buffer_store_dwordx2 v[28:29], v26, s[8:11], s21 offen
    s_cmp_eq_u32 s32, s55
    s_cbranch_scc1 L_he_32
    s_mov_b32 s55, s32
L_gr_34:
    s_waitcnt lgkmcnt(0)
    s_cmp_ge_u32 s22, 96
    s_cbranch_scc1 L_he_32
    s_add_u32 s33, s33, 1
    s_cmp_gt_u32 s33, 0x100000
    s_cbranch_scc1 chain_kernel_abort
    s_load_dword s22, s[60:61], s32 glc
    s_branch L_gr_34
L_w2_30:
    ds_read_b128 v[148:151], v242 offset:43008
    ds_read_b128 v[104:107], v1 offset:32768
    ds_read_b128 v[108:111], v1 offset:36864
    ds_read_b128 v[152:155], v242 offset:44032
    ds_read_b128 v[112:115], v1 offset:33792
    ds_read_b128 v[116:119], v1 offset:37888
    ds_read_b128 v[156:159], v242 offset:45056
    ds_read_b128 v[120:123], v1 offset:34816
    ds_read_b128 v[124:127], v1 offset:38912
    ds_read_b128 v[160:163], v242 offset:46080
    ds_read_b128 v[128:131], v1 offset:35840
    ds_read_b128 v[132:135], v1 offset:39936
    ds_read_b128 v[136:139], v1 offset:40960
    ds_read_b128 v[140:143], v1 offset:41984
    v_cvt_pk_bf16_f32 v200, v200, v201
    v_cvt_pk_bf16_f32 v201, v202, v203
    v_cvt_pk_bf16_f32 v202, v204, v205
    v_cvt_pk_bf16_f32 v203, v206, v207
    s_add_u32 s21, s19, -1
    s_lshl_b32 s32, s21, 21
    s_lshl_b32 s21, s21, 13
    s_and_b32 s21, s21, 0x2000
    s_xor_b32 s21, s21, s48
    s_add_u32 s32, s32, s21
    s_waitcnt lgkmcnt(11)
    v_mfma_f32_16x16x32_bf16 v[180:183], v[104:107], v[148:151], 0
    v_mfma_f32_16x16x32_bf16 v[184:187], v[108:111], v[148:151], 0
    s_waitcnt lgkmcnt(8)
    v_mfma_f32_16x16x32_bf16 v[180:183], v[112:115], v[152:155], v[180:183]
    v_mfma_f32_16x16x32_bf16 v[184:187], v[116:119], v[152:155], v[184:187]
    buffer_store_dwordx4 v[200:203], v23, s[8:11], s32 offen sc1
    s_waitcnt lgkmcnt(5)
    v_mfma_f32_16x16x32_bf16 v[180:183], v[120:123], v[156:159], v[180:183]
    v_mfma_f32_16x16x32_bf16 v[184:187], v[124:127], v[156:159], v[184:187]
    s_waitcnt lgkmcnt(2)
    v_mfma_f32_16x16x32_bf16 v[180:183], v[128:131], v[160:163], v[180:183]
    v_mfma_f32_16x16x32_bf16 v[184:187], v[132:135], v[160:163], v[184:187]
    s_add_u32 s21, s19, 1
    s_min_u32 s21, s21, 63
    s_lshl_b32 s31, s21, 21
    s_lshl_b32 s21, s21, 13
    s_and_b32 s21, s21, 0x2000
    s_xor_b32 s21, s21, s48
    s_add_u32 s31, s31, s21
    v_cvt_pk_bf16_f32 v180, 0, v180
    v_cvt_pk_bf16_f32 v181, 0, v181
    v_cvt_pk_bf16_f32 v182, 0, v182
    v_cvt_pk_bf16_f32 v183, 0, v183
    v_cvt_pk_bf16_f32 v184, 0, v184
    v_cvt_pk_bf16_f32 v185, 0, v185
    v_cvt_pk_bf16_f32 v186, 0, v186
    v_cvt_pk_bf16_f32 v187, 0, v187
    v_pk_mul_f32 v[180:181], v[180:181], s[58:59]
    v_pk_mul_f32 v[182:183], v[182:183], s[58:59]
    v_pk_mul_f32 v[184:185], v[184:185], s[58:59]
    v_pk_mul_f32 v[186:187], v[186:187], s[58:59]
    v_cvt_pk_bf16_f32 v180, 0, v180
    v_cvt_pk_bf16_f32 v181, 0, v181
    v_cvt_pk_bf16_f32 v182, 0, v182
    v_cvt_pk_bf16_f32 v183, 0, v183
    v_cvt_pk_bf16_f32 v184, 0, v184
    v_cvt_pk_bf16_f32 v185, 0, v185
    v_cvt_pk_bf16_f32 v186, 0, v186
    v_cvt_pk_bf16_f32 v187, 0, v187
    v_pk_add_f32 v[180:181], v[180:181], v[226:227]
    v_pk_add_f32 v[182:183], v[182:183], v[228:229]
    v_pk_add_f32 v[184:185], v[184:185], v[230:231]
    v_pk_add_f32 v[186:187], v[186:187], v[232:233]
    v_max3_f32 v212, v180, v181, v182
    v_max3_f32 v213, v183, v184, v185
    v_max3_f32 v212, v212, v186, v187
    v_max_f32 v212, v212, v213
    s_cmp_eq_u32 s18, 3
    s_waitcnt lgkmcnt(0)
    s_barrier
    ds_read_b64 v[144:145], v26 offset:28672
    s_cbranch_scc0 L_he_32
    s_mov_b32 m0, 51200
    s_nop 0
    buffer_load_dwordx4 v24, s[8:11], s40 offen offset:0 sc1 lds
    s_mov_b32 m0, 50176
    s_nop 0
    buffer_load_dwordx4 v24, s[8:11], s40 offen offset:2048 sc1 lds
L_he_32:
    s_cmp_lg_u32 s19, 63
    s_cbranch_scc1 L_b4_16
chain_kernel_fin:
    s_waitcnt vmcnt(0) lgkmcnt(0)
    s_barrier
    s_cmp_lt_u32 s18, 2
    s_cbranch_scc1 L_f2_40
    ds_read_b128 v[164:167], v241 offset:51200
    ds_read_b128 v[168:171], v241 offset:51712
    ds_read_b128 v[172:175], v241 offset:52224
    ds_read_b128 v[176:179], v241 offset:52736
    s_waitcnt lgkmcnt(3)
    v_mfma_f32_16x16x32_bf16 v[188:191], v[164:167], v[148:151], 0
    s_waitcnt lgkmcnt(2)
    v_mfma_f32_16x16x32_bf16 v[188:191], v[168:171], v[152:155], v[188:191]
    s_waitcnt lgkmcnt(1)
    v_mfma_f32_16x16x32_bf16 v[188:191], v[172:175], v[156:159], v[188:191]
    s_waitcnt lgkmcnt(0)
    v_mfma_f32_16x16x32_bf16 v[188:191], v[176:179], v[160:163], v[188:191]
    s_nop 7
    v_cvt_pk_bf16_f32 v188, 0, v188
    v_cvt_pk_bf16_f32 v189, 0, v189
    v_pk_mul_f32 v[188:189], v[188:189], s[58:59]
    v_cvt_pk_bf16_f32 v188, 0, v188
    v_cvt_pk_bf16_f32 v189, 0, v189
    v_max3_f32 v212, v212, v188, v189
    v_mov_b32 v213, v212
    s_nop 1
    v_permlane16_swap_b32 v212, v213
    v_max_f32 v212, v212, v213
    v_mov_b32 v213, v212
    s_nop 1
    v_permlane32_swap_b32 v212, v213
    v_max_f32 v212, v212, v213
    v_mul_f32 v212, s56, v212
    v_pk_fma_f32 v[180:181], v[180:181], s[56:57], v[212:213] op_sel_hi:[1,1,0] neg_lo:[0,0,1] neg_hi:[0,0,1]
    v_pk_fma_f32 v[182:183], v[182:183], s[56:57], v[212:213] op_sel_hi:[1,1,0] neg_lo:[0,0,1] neg_hi:[0,0,1]
    v_pk_fma_f32 v[184:185], v[184:185], s[56:57], v[212:213] op_sel_hi:[1,1,0] neg_lo:[0,0,1] neg_hi:[0,0,1]
    v_pk_fma_f32 v[186:187], v[186:187], s[56:57], v[212:213] op_sel_hi:[1,1,0] neg_lo:[0,0,1] neg_hi:[0,0,1]
    v_pk_fma_f32 v[188:189], v[188:189], s[56:57], v[212:213] op_sel_hi:[1,1,0] neg_lo:[0,0,1] neg_hi:[0,0,1]
    v_exp_f32 v180, v180
    v_exp_f32 v181, v181
    v_exp_f32 v182, v182
    v_exp_f32 v183, v183
    v_exp_f32 v184, v184
    v_exp_f32 v185, v185
    v_exp_f32 v186, v186
    v_exp_f32 v187, v187
    v_exp_f32 v188, v188
    v_exp_f32 v189, v189
    v_pk_add_f32 v[214:215], v[180:181], v[182:183]
    v_pk_add_f32 v[216:217], v[184:185], v[186:187]
    v_pk_add_f32 v[214:215], v[214:215], v[188:189]
    v_pk_add_f32 v[214:215], v[214:215], v[216:217]
    v_add_f32 v214, v214, v215
    v_mov_b32 v213, v214
    s_nop 1
    v_permlane16_swap_b32 v214, v213
    v_add_f32 v214, v214, v213
    v_mov_b32 v213, v214
    s_nop 1
    v_permlane32_swap_b32 v214, v213
    v_add_f32 v214, v214, v213
    v_rcp_f32 v214, v214
    s_nop 0
    v_pk_mul_f32 v[180:181], v[180:181], v[214:215] op_sel_hi:[1,0]
    v_pk_mul_f32 v[182:183], v[182:183], v[214:215] op_sel_hi:[1,0]
    v_pk_mul_f32 v[184:185], v[184:185], v[214:215] op_sel_hi:[1,0]
    v_pk_mul_f32 v[186:187], v[186:187], v[214:215] op_sel_hi:[1,0]
    v_pk_mul_f32 v[188:189], v[188:189], v[214:215] op_sel_hi:[1,0]
    v_cvt_pk_bf16_f32 v192, v180, v181
    v_cvt_pk_bf16_f32 v193, v182, v183
    v_cvt_pk_bf16_f32 v194, v184, v185
    v_cvt_pk_bf16_f32 v195, v186, v187
    v_cvt_pk_bf16_f32 v196, v188, v189
    v_cvt_pk_bf16_f32 v199, v188, v189
    v_mfma_f32_16x16x32_bf16 v[200:203], v[136:139], v[192:195], 0
    v_mfma_f32_16x16x32_bf16 v[204:207], v[140:143], v[192:195], 0
    v_mfma_f32_16x16x16_bf16 v[200:203], v[144:145], v[196:197], v[200:203]
    v_mfma_f32_16x16x16_bf16 v[204:207], v[144:145], v[198:199], v[204:207]
    s_add_u32 s21, s19, 0
    s_min_u32 s21, s21, 63
    s_lshl_b32 s32, s21, 21
    s_lshl_b32 s21, s21, 13
    s_and_b32 s21, s21, 0x2000
    s_xor_b32 s21, s21, s48
    s_add_u32 s32, s32, s21
    s_nop 1
    v_cvt_pk_bf16_f32 v200, v200, v201
    v_cvt_pk_bf16_f32 v201, v202, v203
    v_cvt_pk_bf16_f32 v202, v204, v205
    v_cvt_pk_bf16_f32 v203, v206, v207
    buffer_store_dwordx4 v[200:203], v23, s[8:11], s32 offen sc1
    s_waitcnt vmcnt(0)
L_f2_40:
    s_barrier
    s_cmp_lg_u32 s18, 0
    s_cbranch_scc1 chain_kernel_done
    s_add_u32 s20, s62, 4096
    s_mov_b32 s21, 1
    s_atomic_add s21, s[100:101], s20
    s_branch chain_kernel_done
Gq_17_f0123:
    buffer_load_dwordx4 v[32:35], v2, s[8:11], s40 offen offset:0 sc1
    s_branch Gq_17_s1230
Gq_17_f123p0:
    buffer_load_dwordx4 v[36:39], v2, s[8:11], s40 offen offset:1024 sc1
    s_add_u32 s33, s33, 1
    s_cmp_gt_u32 s33, 0x100000
    s_cbranch_scc1 chain_kernel_abort
    s_branch Gq_17_s231
Gq_17_f23p1:
    buffer_load_dwordx4 v[40:43], v2, s[8:11], s40 offen offset:2048 sc1
    s_add_u32 s33, s33, 1
    s_cmp_gt_u32 s33, 0x100000
    s_cbranch_scc1 chain_kernel_abort
    s_branch Gq_17_s32
Gq_17_f3p2:
    buffer_load_dwordx4 v[44:47], v2, s[8:11], s40 offen offset:3072 sc1
    s_add_u32 s33, s33, 1
    s_cmp_gt_u32 s33, 0x100000
    s_cbranch_scc1 chain_kernel_abort
    s_branch Gq_17_s3
Gq_17_redo:
    buffer_load_dwordx4 v[32:35], v2, s[8:11], s40 offen offset:0 sc1
    buffer_load_dwordx4 v[36:39], v2, s[8:11], s40 offen offset:1024 sc1
    buffer_load_dwordx4 v[40:43], v2, s[8:11], s40 offen offset:2048 sc1
    buffer_load_dwordx4 v[44:47], v2, s[8:11], s40 offen offset:3072 sc1
    s_add_u32 s33, s33, 1
    s_cmp_gt_u32 s33, 0x100000
    s_cbranch_scc1 chain_kernel_abort
    s_nop 5
    v_mov_b32 v64, 0
    v_mov_b32 v65, 0
    v_mov_b32 v66, 0
    v_mov_b32 v67, 0
    v_mov_b32 v68, 0
    v_mov_b32 v69, 0
    v_mov_b32 v70, 0
    v_mov_b32 v71, 0
    v_mov_b32 v72, 0
    v_mov_b32 v73, 0
    v_mov_b32 v74, 0
    v_mov_b32 v75, 0
    s_branch Gq_17_s0123
Gq_17_s1230:
    s_waitcnt vmcnt(3)
    v_cmp_eq_u32 vcc, -1, v36
    v_mov_b32_dpp v52, v36 row_ror:8 row_mask:0xf bank_mask:0xf
    v_mov_b32_dpp v53, v37 row_ror:8 row_mask:0xf bank_mask:0xf
    v_mov_b32_dpp v54, v38 row_ror:8 row_mask:0xf bank_mask:0xf
    v_mov_b32_dpp v55, v39 row_ror:8 row_mask:0xf bank_mask:0xf
    s_cbranch_vccnz Gq_17_f1230
    v_smfmac_f32_16x16x64_bf16 v[64:67], v[36:39], a[8:15], v19
    v_smfmac_f32_16x16x64_bf16 v[68:71], v[36:39], a[72:79], v19
Gq_17_s230p1:
    s_waitcnt vmcnt(2)
    v_cmp_eq_u32 vcc, -1, v40
    v_smfmac_f32_16x16x64_bf16 v[64:67], v[52:55], a[40:47], v19
    v_mov_b32_dpp v56, v40 row_ror:8 row_mask:0xf bank_mask:0xf
    v_mov_b32_dpp v57, v41 row_ror:8 row_mask:0xf bank_mask:0xf
    v_smfmac_f32_16x16x64_bf16 v[68:71], v[52:55], a[104:111], v19
    v_mov_b32_dpp v58, v42 row_ror:8 row_mask:0xf bank_mask:0xf
    v_mov_b32_dpp v59, v43 row_ror:8 row_mask:0xf bank_mask:0xf
    s_cbranch_vccnz Gq_17_f230p1
    v_smfmac_f32_16x16x64_bf16 v[64:67], v[40:43], a[16:23], v19
    v_smfmac_f32_16x16x64_bf16 v[68:71], v[40:43], a[80:87], v19
Gq_17_s30p2:
    s_waitcnt vmcnt(1)
    v_cmp_eq_u32 vcc, -1, v44
    v_smfmac_f32_16x16x64_bf16 v[64:67], v[56:59], a[48:55], v19
    v_mov_b32_dpp v60, v44 row_ror:8 row_mask:0xf bank_mask:0xf
    v_mov_b32_dpp v61, v45 row_ror:8 row_mask:0xf bank_mask:0xf
    v_smfmac_f32_16x16x64_bf16 v[68:71], v[56:59], a[112:119], v19
    v_mov_b32_dpp v62, v46 row_ror:8 row_mask:0xf bank_mask:0xf
    v_mov_b32_dpp v63, v47 row_ror:8 row_mask:0xf bank_mask:0xf
    s_cbranch_vccnz Gq_17_f30p2
    v_smfmac_f32_16x16x64_bf16 v[64:67], v[44:47], a[24:31], v19
    v_smfmac_f32_16x16x64_bf16 v[68:71], v[44:47], a[88:95], v19
Gq_17_s0p3:
    s_waitcnt vmcnt(0)
    v_cmp_eq_u32 vcc, -1, v32
    v_smfmac_f32_16x16x64_bf16 v[64:67], v[60:63], a[56:63], v19
    v_mov_b32_dpp v48, v32 row_ror:8 row_mask:0xf bank_mask:0xf
    v_mov_b32_dpp v49, v33 row_ror:8 row_mask:0xf bank_mask:0xf
    v_smfmac_f32_16x16x64_bf16 v[68:71], v[60:63], a[120:127], v19
    v_mov_b32_dpp v50, v34 row_ror:8 row_mask:0xf bank_mask:0xf
    v_mov_b32_dpp v51, v35 row_ror:8 row_mask:0xf bank_mask:0xf
    s_cbranch_vccnz Gq_17_f0p3
    v_smfmac_f32_16x16x64_bf16 v[64:67], v[32:35], a[0:7], v19
    v_smfmac_f32_16x16x64_bf16 v[68:71], v[32:35], a[64:71], v19
    v_smfmac_f32_16x16x64_bf16 v[64:67], v[48:51], a[32:39], v19
    v_smfmac_f32_16x16x64_bf16 v[68:71], v[48:51], a[96:103], v19
    s_branch Gq_17_done
Gq_17_f1230:
    buffer_load_dwordx4 v[36:39], v2, s[8:11], s40 offen offset:1024 sc1
    s_add_u32 s33, s33, 1
    s_cmp_gt_u32 s33, 0x100000
    s_cbranch_scc1 chain_kernel_abort
    s_branch Gq_17_s2301
Gq_17_f230p1:
    buffer_load_dwordx4 v[40:43], v2, s[8:11], s40 offen offset:2048 sc1
    s_add_u32 s33, s33, 1
    s_cmp_gt_u32 s33, 0x100000
    s_cbranch_scc1 chain_kernel_abort
    s_branch Gq_17_s302
Gq_17_f30p2:
    buffer_load_dwordx4 v[44:47], v2, s[8:11], s40 offen offset:3072 sc1
    s_add_u32 s33, s33, 1
    s_cmp_gt_u32 s33, 0x100000
    s_cbranch_scc1 chain_kernel_abort
    s_branch Gq_17_s03
Gq_17_f0p3:
    buffer_load_dwordx4 v[32:35], v2, s[8:11], s40 offen offset:0 sc1
    s_add_u32 s33, s33, 1
    s_cmp_gt_u32 s33, 0x100000
    s_cbranch_scc1 chain_kernel_abort
    s_branch Gq_17_s0
Gq_17_s231:
    s_waitcnt vmcnt(2)
    v_cmp_eq_u32 vcc, -1, v40
    v_mov_b32_dpp v56, v40 row_ror:8 row_mask:0xf bank_mask:0xf
    v_mov_b32_dpp v57, v41 row_ror:8 row_mask:0xf bank_mask:0xf
    v_mov_b32_dpp v58, v42 row_ror:8 row_mask:0xf bank_mask:0xf
    v_mov_b32_dpp v59, v43 row_ror:8 row_mask:0xf bank_mask:0xf
    s_cbranch_vccnz Gq_17_f231
    v_smfmac_f32_16x16x64_bf16 v[64:67], v[40:43], a[16:23], v19
    v_smfmac_f32_16x16x64_bf16 v[68:71], v[40:43], a[80:87], v19
Gq_17_s31p2:
    s_waitcnt vmcnt(1)
    v_cmp_eq_u32 vcc, -1, v44
    v_smfmac_f32_16x16x64_bf16 v[64:67], v[56:59], a[48:55], v19
    v_mov_b32_dpp v60, v44 row_ror:8 row_mask:0xf bank_mask:0xf
    v_mov_b32_dpp v61, v45 row_ror:8 row_mask:0xf bank_mask:0xf
    v_smfmac_f32_16x16x64_bf16 v[68:71], v[56:59], a[112:119], v19
    v_mov_b32_dpp v62, v46 row_ror:8 row_mask:0xf bank_mask:0xf
    v_mov_b32_dpp v63, v47 row_ror:8 row_mask:0xf bank_mask:0xf
    s_cbranch_vccnz Gq_17_f31p2
    v_smfmac_f32_16x16x64_bf16 v[64:67], v[44:47], a[24:31], v19
    v_smfmac_f32_16x16x64_bf16 v[68:71], v[44:47], a[88:95], v19
Gq_17_s1p3:
    s_waitcnt vmcnt(0)
    v_cmp_eq_u32 vcc, -1, v36
    v_smfmac_f32_16x16x64_bf16 v[64:67], v[60:63], a[56:63], v19
    v_mov_b32_dpp v52, v36 row_ror:8 row_mask:0xf bank_mask:0xf
    v_mov_b32_dpp v53, v37 row_ror:8 row_mask:0xf bank_mask:0xf
    v_smfmac_f32_16x16x64_bf16 v[68:71], v[60:63], a[120:127], v19
    v_mov_b32_dpp v54, v38 row_ror:8 row_mask:0xf bank_mask:0xf
    v_mov_b32_dpp v55, v39 row_ror:8 row_mask:0xf bank_mask:0xf
    s_cbranch_vccnz Gq_17_f1p3
    v_smfmac_f32_16x16x64_bf16 v[64:67], v[36:39], a[8:15], v19
    v_smfmac_f32_16x16x64_bf16 v[68:71], v[36:39], a[72:79], v19
    v_smfmac_f32_16x16x64_bf16 v[64:67], v[52:55], a[40:47], v19
    v_smfmac_f32_16x16x64_bf16 v[68:71], v[52:55], a[104:111], v19
    s_branch Gq_17_done
Gq_17_f231:
    buffer_load_dwordx4 v[40:43], v2, s[8:11], s40 offen offset:2048 sc1
    s_add_u32 s33, s33, 1
    s_cmp_gt_u32 s33, 0x100000
    s_cbranch_scc1 chain_kernel_abort
    s_branch Gq_17_s312
Gq_17_f31p2:
    buffer_load_dwordx4 v[44:47], v2, s[8:11], s40 offen offset:3072 sc1
    s_add_u32 s33, s33, 1
    s_cmp_gt_u32 s33, 0x100000
    s_cbranch_scc1 chain_kernel_abort
    s_branch Gq_17_s13
Gq_17_f1p3:
    buffer_load_dwordx4 v[36:39], v2, s[8:11], s40 offen offset:1024 sc1
    s_add_u32 s33, s33, 1
    s_cmp_gt_u32 s33, 0x100000
    s_cbranch_scc1 chain_kernel_abort
    s_branch Gq_17_s1
Gq_17_s32:
    s_waitcnt vmcnt(1)
    v_cmp_eq_u32 vcc, -1, v44
    v_mov_b32_dpp v60, v44 row_ror:8 row_mask:0xf bank_mask:0xf
    v_mov_b32_dpp v61, v45 row_ror:8 row_mask:0xf bank_mask:0xf
    v_mov_b32_dpp v62, v46 row_ror:8 row_mask:0xf bank_mask:0xf
    v_mov_b32_dpp v63, v47 row_ror:8 row_mask:0xf bank_mask:0xf
    s_cbranch_vccnz Gq_17_f32
    v_smfmac_f32_16x16x64_bf16 v[64:67], v[44:47], a[24:31], v19
    v_smfmac_f32_16x16x64_bf16 v[68:71], v[44:47], a[88:95], v19
Gq_17_s2p3:
    s_waitcnt vmcnt(0)
    v_cmp_eq_u32 vcc, -1, v40
    v_smfmac_f32_16x16x64_bf16 v[64:67], v[60:63], a[56:63], v19
    v_mov_b32_dpp v56, v40 row_ror:8 row_mask:0xf bank_mask:0xf
    v_mov_b32_dpp v57, v41 row_ror:8 row_mask:0xf bank_mask:0xf
    v_smfmac_f32_16x16x64_bf16 v[68:71], v[60:63], a[120:127], v19
    v_mov_b32_dpp v58, v42 row_ror:8 row_mask:0xf bank_mask:0xf
    v_mov_b32_dpp v59, v43 row_ror:8 row_mask:0xf bank_mask:0xf
    s_cbranch_vccnz Gq_17_f2p3
    v_smfmac_f32_16x16x64_bf16 v[64:67], v[40:43], a[16:23], v19
    v_smfmac_f32_16x16x64_bf16 v[68:71], v[40:43], a[80:87], v19
    v_smfmac_f32_16x16x64_bf16 v[64:67], v[56:59], a[48:55], v19
    v_smfmac_f32_16x16x64_bf16 v[68:71], v[56:59], a[112:119], v19
    s_branch Gq_17_done
Gq_17_f32:
    buffer_load_dwordx4 v[44:47], v2, s[8:11], s40 offen offset:3072 sc1
    s_add_u32 s33, s33, 1
    s_cmp_gt_u32 s33, 0x100000
    s_cbranch_scc1 chain_kernel_abort
    s_branch Gq_17_s23
Gq_17_f2p3:
    buffer_load_dwordx4 v[40:43], v2, s[8:11], s40 offen offset:2048 sc1
    s_add_u32 s33, s33, 1
    s_cmp_gt_u32 s33, 0x100000
    s_cbranch_scc1 chain_kernel_abort
    s_branch Gq_17_s2
Gq_17_s3:
    s_waitcnt vmcnt(0)
    v_cmp_eq_u32 vcc, -1, v44
    v_mov_b32_dpp v60, v44 row_ror:8 row_mask:0xf bank_mask:0xf
    v_mov_b32_dpp v61, v45 row_ror:8 row_mask:0xf bank_mask:0xf
    v_mov_b32_dpp v62, v46 row_ror:8 row_mask:0xf bank_mask:0xf
    v_mov_b32_dpp v63, v47 row_ror:8 row_mask:0xf bank_mask:0xf
    s_cbranch_vccnz Gq_17_f3
    v_smfmac_f32_16x16x64_bf16 v[64:67], v[44:47], a[24:31], v19
    v_smfmac_f32_16x16x64_bf16 v[68:71], v[44:47], a[88:95], v19
    v_smfmac_f32_16x16x64_bf16 v[64:67], v[60:63], a[56:63], v19
    v_smfmac_f32_16x16x64_bf16 v[68:71], v[60:63], a[120:127], v19
    s_branch Gq_17_done
Gq_17_f3:
    buffer_load_dwordx4 v[44:47], v2, s[8:11], s40 offen offset:3072 sc1
    s_add_u32 s33, s33, 1
    s_cmp_gt_u32 s33, 0x100000
    s_cbranch_scc1 chain_kernel_abort
    s_branch Gq_17_s3
Gq_17_s2301:
    s_waitcnt vmcnt(3)
    v_cmp_eq_u32 vcc, -1, v40
    v_mov_b32_dpp v56, v40 row_ror:8 row_mask:0xf bank_mask:0xf
    v_mov_b32_dpp v57, v41 row_ror:8 row_mask:0xf bank_mask:0xf
    v_mov_b32_dpp v58, v42 row_ror:8 row_mask:0xf bank_mask:0xf
    v_mov_b32_dpp v59, v43 row_ror:8 row_mask:0xf bank_mask:0xf
    s_cbranch_vccnz Gq_17_f2301
    v_smfmac_f32_16x16x64_bf16 v[64:67], v[40:43], a[16:23], v19
    v_smfmac_f32_16x16x64_bf16 v[68:71], v[40:43], a[80:87], v19
Gq_17_s301p2:
    s_waitcnt vmcnt(2)
    v_cmp_eq_u32 vcc, -1, v44
    v_smfmac_f32_16x16x64_bf16 v[64:67], v[56:59], a[48:55], v19
    v_mov_b32_dpp v60, v44 row_ror:8 row_mask:0xf bank_mask:0xf
    v_mov_b32_dpp v61, v45 row_ror:8 row_mask:0xf bank_mask:0xf
    v_smfmac_f32_16x16x64_bf16 v[68:71], v[56:59], a[112:119], v19
    v_mov_b32_dpp v62, v46 row_ror:8 row_mask:0xf bank_mask:0xf
    v_mov_b32_dpp v63, v47 row_ror:8 row_mask:0xf bank_mask:0xf
    s_cbranch_vccnz Gq_17_f301p2
    v_smfmac_f32_16x16x64_bf16 v[64:67], v[44:47], a[24:31], v19
    v_smfmac_f32_16x16x64_bf16 v[68:71], v[44:47], a[88:95], v19
Gq_17_s01p3:
    s_waitcnt vmcnt(1)
    v_cmp_eq_u32 vcc, -1, v32
    v_smfmac_f32_16x16x64_bf16 v[64:67], v[60:63], a[56:63], v19
    v_mov_b32_dpp v48, v32 row_ror:8 row_mask:0xf bank_mask:0xf
    v_mov_b32_dpp v49, v33 row_ror:8 row_mask:0xf bank_mask:0xf
    v_smfmac_f32_16x16x64_bf16 v[68:71], v[60:63], a[120:127], v19
    v_mov_b32_dpp v50, v34 row_ror:8 row_mask:0xf bank_mask:0xf
    v_mov_b32_dpp v51, v35 row_ror:8 row_mask:0xf bank_mask:0xf
    s_cbranch_vccnz Gq_17_f01p3
    v_smfmac_f32_16x16x64_bf16 v[64:67], v[32:35], a[0:7], v19
    v_smfmac_f32_16x16x64_bf16 v[68:71], v[32:35], a[64:71], v19
Gq_17_s1p0:
    s_waitcnt vmcnt(0)
    v_cmp_eq_u32 vcc, -1, v36
    v_smfmac_f32_16x16x64_bf16 v[64:67], v[48:51], a[32:39], v19
    v_mov_b32_dpp v52, v36 row_ror:8 row_mask:0xf bank_mask:0xf
    v_mov_b32_dpp v53, v37 row_ror:8 row_mask:0xf bank_mask:0xf
    v_smfmac_f32_16x16x64_bf16 v[68:71], v[48:51], a[96:103], v19
    v_mov_b32_dpp v54, v38 row_ror:8 row_mask:0xf bank_mask:0xf
    v_mov_b32_dpp v55, v39 row_ror:8 row_mask:0xf bank_mask:0xf
    s_cbranch_vccnz Gq_17_f1p0
    v_smfmac_f32_16x16x64_bf16 v[64:67], v[36:39], a[8:15], v19
    v_smfmac_f32_16x16x64_bf16 v[68:71], v[36:39], a[72:79], v19
    v_smfmac_f32_16x16x64_bf16 v[64:67], v[52:55], a[40:47], v19
    v_smfmac_f32_16x16x64_bf16 v[68:71], v[52:55], a[104:111], v19
    s_branch Gq_17_done
Gq_17_f2301:
    buffer_load_dwordx4 v[40:43], v2, s[8:11], s40 offen offset:2048 sc1
    s_add_u32 s33, s33, 1
    s_cmp_gt_u32 s33, 0x100000
    s_cbranch_scc1 chain_kernel_abort
    s_branch Gq_17_s3012
Gq_17_f301p2:
    buffer_load_dwordx4 v[44:47], v2, s[8:11], s40 offen offset:3072 sc1
    s_add_u32 s33, s33, 1
    s_cmp_gt_u32 s33, 0x100000
    s_cbranch_scc1 chain_kernel_abort
    s_branch Gq_17_s013
Gq_17_f01p3:
    buffer_load_dwordx4 v[32:35], v2, s[8:11], s40 offen offset:0 sc1
    s_add_u32 s33, s33, 1
    s_cmp_gt_u32 s33, 0x100000
    s_cbranch_scc1 chain_kernel_abort
    s_branch Gq_17_s10
Gq_17_f1p0:
    buffer_load_dwordx4 v[36:39], v2, s[8:11], s40 offen offset:1024 sc1
    s_add_u32 s33, s33, 1
    s_cmp_gt_u32 s33, 0x100000
    s_cbranch_scc1 chain_kernel_abort
    s_branch Gq_17_s1
Gq_17_s302:
    s_waitcnt vmcnt(2)
    v_cmp_eq_u32 vcc, -1, v44
    v_mov_b32_dpp v60, v44 row_ror:8 row_mask:0xf bank_mask:0xf
    v_mov_b32_dpp v61, v45 row_ror:8 row_mask:0xf bank_mask:0xf
    v_mov_b32_dpp v62, v46 row_ror:8 row_mask:0xf bank_mask:0xf
    v_mov_b32_dpp v63, v47 row_ror:8 row_mask:0xf bank_mask:0xf
    s_cbranch_vccnz Gq_17_f302
    v_smfmac_f32_16x16x64_bf16 v[64:67], v[44:47], a[24:31], v19
    v_smfmac_f32_16x16x64_bf16 v[68:71], v[44:47], a[88:95], v19
Gq_17_s02p3:
    s_waitcnt vmcnt(1)
    v_cmp_eq_u32 vcc, -1, v32
    v_smfmac_f32_16x16x64_bf16 v[64:67], v[60:63], a[56:63], v19
    v_mov_b32_dpp v48, v32 row_ror:8 row_mask:0xf bank_mask:0xf
    v_mov_b32_dpp v49, v33 row_ror:8 row_mask:0xf bank_mask:0xf
    v_smfmac_f32_16x16x64_bf16 v[68:71], v[60:63], a[120:127], v19
    v_mov_b32_dpp v50, v34 row_ror:8 row_mask:0xf bank_mask:0xf
    v_mov_b32_dpp v51, v35 row_ror:8 row_mask:0xf bank_mask:0xf
    s_cbranch_vccnz Gq_17_f02p3
    v_smfmac_f32_16x16x64_bf16 v[64:67], v[32:35], a[0:7], v19
    v_smfmac_f32_16x16x64_bf16 v[68:71], v[32:35], a[64:71], v19
Gq_17_s2p0:
    s_waitcnt vmcnt(0)
    v_cmp_eq_u32 vcc, -1, v40
    v_smfmac_f32_16x16x64_bf16 v[64:67], v[48:51], a[32:39], v19
    v_mov_b32_dpp v56, v40 row_ror:8 row_mask:0xf bank_mask:0xf
    v_mov_b32_dpp v57, v41 row_ror:8 row_mask:0xf bank_mask:0xf
    v_smfmac_f32_16x16x64_bf16 v[68:71], v[48:51], a[96:103], v19
    v_mov_b32_dpp v58, v42 row_ror:8 row_mask:0xf bank_mask:0xf
    v_mov_b32_dpp v59, v43 row_ror:8 row_mask:0xf bank_mask:0xf
    s_cbranch_vccnz Gq_17_f2p0
    v_smfmac_f32_16x16x64_bf16 v[64:67], v[40:43], a[16:23], v19
    v_smfmac_f32_16x16x64_bf16 v[68:71], v[40:43], a[80:87], v19
    v_smfmac_f32_16x16x64_bf16 v[64:67], v[56:59], a[48:55], v19
    v_smfmac_f32_16x16x64_bf16 v[68:71], v[56:59], a[112:119], v19
    s_branch Gq_17_done
Gq_17_f302:
    buffer_load_dwordx4 v[44:47], v2, s[8:11], s40 offen offset:3072 sc1
    s_add_u32 s33, s33, 1
    s_cmp_gt_u32 s33, 0x100000
    s_cbranch_scc1 chain_kernel_abort
    s_branch Gq_17_s023
Gq_17_f02p3:
    buffer_load_dwordx4 v[32:35], v2, s[8:11], s40 offen offset:0 sc1
    s_add_u32 s33, s33, 1
    s_cmp_gt_u32 s33, 0x100000
    s_cbranch_scc1 chain_kernel_abort
    s_branch Gq_17_s20
Gq_17_f2p0:
    buffer_load_dwordx4 v[40:43], v2, s[8:11], s40 offen offset:2048 sc1
    s_add_u32 s33, s33, 1
    s_cmp_gt_u32 s33, 0x100000
    s_cbranch_scc1 chain_kernel_abort
    s_branch Gq_17_s2
Gq_17_s03:
    s_waitcnt vmcnt(1)
    v_cmp_eq_u32 vcc, -1, v32
    v_mov_b32_dpp v48, v32 row_ror:8 row_mask:0xf bank_mask:0xf
    v_mov_b32_dpp v49, v33 row_ror:8 row_mask:0xf bank_mask:0xf
    v_mov_b32_dpp v50, v34 row_ror:8 row_mask:0xf bank_mask:0xf
    v_mov_b32_dpp v51, v35 row_ror:8 row_mask:0xf bank_mask:0xf
    s_cbranch_vccnz Gq_17_f03
    v_smfmac_f32_16x16x64_bf16 v[64:67], v[32:35], a[0:7], v19
    v_smfmac_f32_16x16x64_bf16 v[68:71], v[32:35], a[64:71], v19
Gq_17_s3p0:
    s_waitcnt vmcnt(0)
    v_cmp_eq_u32 vcc, -1, v44
    v_smfmac_f32_16x16x64_bf16 v[64:67], v[48:51], a[32:39], v19
    v_mov_b32_dpp v60, v44 row_ror:8 row_mask:0xf bank_mask:0xf
    v_mov_b32_dpp v61, v45 row_ror:8 row_mask:0xf bank_mask:0xf
    v_smfmac_f32_16x16x64_bf16 v[68:71], v[48:51], a[96:103], v19
    v_mov_b32_dpp v62, v46 row_ror:8 row_mask:0xf bank_mask:0xf
    v_mov_b32_dpp v63, v47 row_ror:8 row_mask:0xf bank_mask:0xf
    s_cbranch_vccnz Gq_17_f3p0
    v_smfmac_f32_16x16x64_bf16 v[64:67], v[44:47], a[24:31], v19
    v_smfmac_f32_16x16x64_bf16 v[68:71], v[44:47], a[88:95], v19
    v_smfmac_f32_16x16x64_bf16 v[64:67], v[60:63], a[56:63], v19
    v_smfmac_f32_16x16x64_bf16 v[68:71], v[60:63], a[120:127], v19
    s_branch Gq_17_done
Gq_17_f03:
    buffer_load_dwordx4 v[32:35], v2, s[8:11], s40 offen offset:0 sc1
    s_add_u32 s33, s33, 1
    s_cmp_gt_u32 s33, 0x100000
    s_cbranch_scc1 chain_kernel_abort
    s_branch Gq_17_s30
Gq_17_f3p0:
    buffer_load_dwordx4 v[44:47], v2, s[8:11], s40 offen offset:3072 sc1
    s_add_u32 s33, s33, 1
    s_cmp_gt_u32 s33, 0x100000
    s_cbranch_scc1 chain_kernel_abort
    s_branch Gq_17_s3
Gq_17_s0:
    s_waitcnt vmcnt(0)
    v_cmp_eq_u32 vcc, -1, v32
    v_mov_b32_dpp v48, v32 row_ror:8 row_mask:0xf bank_mask:0xf
    v_mov_b32_dpp v49, v33 row_ror:8 row_mask:0xf bank_mask:0xf
    v_mov_b32_dpp v50, v34 row_ror:8 row_mask:0xf bank_mask:0xf
    v_mov_b32_dpp v51, v35 row_ror:8 row_mask:0xf bank_mask:0xf
    s_cbranch_vccnz Gq_17_f0
    v_smfmac_f32_16x16x64_bf16 v[64:67], v[32:35], a[0:7], v19
    v_smfmac_f32_16x16x64_bf16 v[68:71], v[32:35], a[64:71], v19
    v_smfmac_f32_16x16x64_bf16 v[64:67], v[48:51], a[32:39], v19
    v_smfmac_f32_16x16x64_bf16 v[68:71], v[48:51], a[96:103], v19
    s_branch Gq_17_done
Gq_17_f0:
    buffer_load_dwordx4 v[32:35], v2, s[8:11], s40 offen offset:0 sc1
    s_add_u32 s33, s33, 1
    s_cmp_gt_u32 s33, 0x100000
    s_cbranch_scc1 chain_kernel_abort
    s_branch Gq_17_s0
Gq_17_s312:
    s_waitcnt vmcnt(2)
    v_cmp_eq_u32 vcc, -1, v44
    v_mov_b32_dpp v60, v44 row_ror:8 row_mask:0xf bank_mask:0xf
    v_mov_b32_dpp v61, v45 row_ror:8 row_mask:0xf bank_mask:0xf
    v_mov_b32_dpp v62, v46 row_ror:8 row_mask:0xf bank_mask:0xf
    v_mov_b32_dpp v63, v47 row_ror:8 row_mask:0xf bank_mask:0xf
    s_cbranch_vccnz Gq_17_f312
    v_smfmac_f32_16x16x64_bf16 v[64:67], v[44:47], a[24:31], v19
    v_smfmac_f32_16x16x64_bf16 v[68:71], v[44:47], a[88:95], v19
Gq_17_s12p3:
    s_waitcnt vmcnt(1)
    v_cmp_eq_u32 vcc, -1, v36
    v_smfmac_f32_16x16x64_bf16 v[64:67], v[60:63], a[56:63], v19
    v_mov_b32_dpp v52, v36 row_ror:8 row_mask:0xf bank_mask:0xf
    v_mov_b32_dpp v53, v37 row_ror:8 row_mask:0xf bank_mask:0xf
    v_smfmac_f32_16x16x64_bf16 v[68:71], v[60:63], a[120:127], v19
    v_mov_b32_dpp v54, v38 row_ror:8 row_mask:0xf bank_mask:0xf
    v_mov_b32_dpp v55, v39 row_ror:8 row_mask:0xf bank_mask:0xf
    s_cbranch_vccnz Gq_17_f12p3
    v_smfmac_f32_16x16x64_bf16 v[64:67], v[36:39], a[8:15], v19
    v_smfmac_f32_16x16x64_bf16 v[68:71], v[36:39], a[72:79], v19
Gq_17_s2p1:
    s_waitcnt vmcnt(0)
    v_cmp_eq_u32 vcc, -1, v40
    v_smfmac_f32_16x16x64_bf16 v[64:67], v[52:55], a[40:47], v19
    v_mov_b32_dpp v56, v40 row_ror:8 row_mask:0xf bank_mask:0xf
    v_mov_b32_dpp v57, v41 row_ror:8 row_mask:0xf bank_mask:0xf
    v_smfmac_f32_16x16x64_bf16 v[68:71], v[52:55], a[104:111], v19
    v_mov_b32_dpp v58, v42 row_ror:8 row_mask:0xf bank_mask:0xf
    v_mov_b32_dpp v59, v43 row_ror:8 row_mask:0xf bank_mask:0xf
    s_cbranch_vccnz Gq_17_f2p1
    v_smfmac_f32_16x16x64_bf16 v[64:67], v[40:43], a[16:23], v19
    v_smfmac_f32_16x16x64_bf16 v[68:71], v[40:43], a[80:87], v19
    v_smfmac_f32_16x16x64_bf16 v[64:67], v[56:59], a[48:55], v19
    v_smfmac_f32_16x16x64_bf16 v[68:71], v[56:59], a[112:119], v19
    s_branch Gq_17_done
Gq_17_f312:
    buffer_load_dwordx4 v[44:47], v2, s[8:11], s40 offen offset:3072 sc1
    s_add_u32 s33, s33, 1
    s_cmp_gt_u32 s33, 0x100000
    s_cbranch_scc1 chain_kernel_abort
    s_branch Gq_17_s123
Gq_17_f12p3:
    buffer_load_dwordx4 v[36:39], v2, s[8:11], s40 offen offset:1024 sc1
    s_add_u32 s33, s33, 1
    s_cmp_gt_u32 s33, 0x100000
    s_cbranch_scc1 chain_kernel_abort
    s_branch Gq_17_s21
Gq_17_f2p1:
    buffer_load_dwordx4 v[40:43], v2, s[8:11], s40 offen offset:2048 sc1
    s_add_u32 s33, s33, 1
    s_cmp_gt_u32 s33, 0x100000
    s_cbranch_scc1 chain_kernel_abort
    s_branch Gq_17_s2
Gq_17_s13:
    s_waitcnt vmcnt(1)
    v_cmp_eq_u32 vcc, -1, v36
    v_mov_b32_dpp v52, v36 row_ror:8 row_mask:0xf bank_mask:0xf
    v_mov_b32_dpp v53, v37 row_ror:8 row_mask:0xf bank_mask:0xf
    v_mov_b32_dpp v54, v38 row_ror:8 row_mask:0xf bank_mask:0xf
    v_mov_b32_dpp v55, v39 row_ror:8 row_mask:0xf bank_mask:0xf
    s_cbranch_vccnz Gq_17_f13
    v_smfmac_f32_16x16x64_bf16 v[64:67], v[36:39], a[8:15], v19
    v_smfmac_f32_16x16x64_bf16 v[68:71], v[36:39], a[72:79], v19
Gq_17_s3p1:
    s_waitcnt vmcnt(0)
    v_cmp_eq_u32 vcc, -1, v44
    v_smfmac_f32_16x16x64_bf16 v[64:67], v[52:55], a[40:47], v19
    v_mov_b32_dpp v60, v44 row_ror:8 row_mask:0xf bank_mask:0xf
    v_mov_b32_dpp v61, v45 row_ror:8 row_mask:0xf bank_mask:0xf
    v_smfmac_f32_16x16x64_bf16 v[68:71], v[52:55], a[104:111], v19
    v_mov_b32_dpp v62, v46 row_ror:8 row_mask:0xf bank_mask:0xf
    v_mov_b32_dpp v63, v47 row_ror:8 row_mask:0xf bank_mask:0xf
    s_cbranch_vccnz Gq_17_f3p1
    v_smfmac_f32_16x16x64_bf16 v[64:67], v[44:47], a[24:31], v19
    v_smfmac_f32_16x16x64_bf16 v[68:71], v[44:47], a[88:95], v19
    v_smfmac_f32_16x16x64_bf16 v[64:67], v[60:63], a[56:63], v19
    v_smfmac_f32_16x16x64_bf16 v[68:71], v[60:63], a[120:127], v19
    s_branch Gq_17_done
Gq_17_f13:
    buffer_load_dwordx4 v[36:39], v2, s[8:11], s40 offen offset:1024 sc1
    s_add_u32 s33, s33, 1
    s_cmp_gt_u32 s33, 0x100000
    s_cbranch_scc1 chain_kernel_abort
    s_branch Gq_17_s31
Gq_17_f3p1:
    buffer_load_dwordx4 v[44:47], v2, s[8:11], s40 offen offset:3072 sc1
    s_add_u32 s33, s33, 1
    s_cmp_gt_u32 s33, 0x100000
    s_cbranch_scc1 chain_kernel_abort
    s_branch Gq_17_s3
Gq_17_s1:
    s_waitcnt vmcnt(0)
    v_cmp_eq_u32 vcc, -1, v36
    v_mov_b32_dpp v52, v36 row_ror:8 row_mask:0xf bank_mask:0xf
    v_mov_b32_dpp v53, v37 row_ror:8 row_mask:0xf bank_mask:0xf
    v_mov_b32_dpp v54, v38 row_ror:8 row_mask:0xf bank_mask:0xf
    v_mov_b32_dpp v55, v39 row_ror:8 row_mask:0xf bank_mask:0xf
    s_cbranch_vccnz Gq_17_f1
    v_smfmac_f32_16x16x64_bf16 v[64:67], v[36:39], a[8:15], v19
    v_smfmac_f32_16x16x64_bf16 v[68:71], v[36:39], a[72:79], v19
    v_smfmac_f32_16x16x64_bf16 v[64:67], v[52:55], a[40:47], v19
    v_smfmac_f32_16x16x64_bf16 v[68:71], v[52:55], a[104:111], v19
    s_branch Gq_17_done
Gq_17_f1:
    buffer_load_dwordx4 v[36:39], v2, s[8:11], s40 offen offset:1024 sc1
    s_add_u32 s33, s33, 1
    s_cmp_gt_u32 s33, 0x100000
    s_cbranch_scc1 chain_kernel_abort
    s_branch Gq_17_s1
Gq_17_s23:
    s_waitcnt vmcnt(1)
    v_cmp_eq_u32 vcc, -1, v40
    v_mov_b32_dpp v56, v40 row_ror:8 row_mask:0xf bank_mask:0xf
    v_mov_b32_dpp v57, v41 row_ror:8 row_mask:0xf bank_mask:0xf
    v_mov_b32_dpp v58, v42 row_ror:8 row_mask:0xf bank_mask:0xf
    v_mov_b32_dpp v59, v43 row_ror:8 row_mask:0xf bank_mask:0xf
    s_cbranch_vccnz Gq_17_f23
    v_smfmac_f32_16x16x64_bf16 v[64:67], v[40:43], a[16:23], v19
    v_smfmac_f32_16x16x64_bf16 v[68:71], v[40:43], a[80:87], v19
    s_branch Gq_17_s3p2
Gq_17_f23:
    buffer_load_dwordx4 v[40:43], v2, s[8:11], s40 offen offset:2048 sc1
    s_add_u32 s33, s33, 1
    s_cmp_gt_u32 s33, 0x100000
    s_cbranch_scc1 chain_kernel_abort
    s_branch Gq_17_s32
Gq_17_s2:
    s_waitcnt vmcnt(0)
    v_cmp_eq_u32 vcc, -1, v40
    v_mov_b32_dpp v56, v40 row_ror:8 row_mask:0xf bank_mask:0xf
    v_mov_b32_dpp v57, v41 row_ror:8 row_mask:0xf bank_mask:0xf
    v_mov_b32_dpp v58, v42 row_ror:8 row_mask:0xf bank_mask:0xf
    v_mov_b32_dpp v59, v43 row_ror:8 row_mask:0xf bank_mask:0xf
    s_cbranch_vccnz Gq_17_f2
    v_smfmac_f32_16x16x64_bf16 v[64:67], v[40:43], a[16:23], v19
    v_smfmac_f32_16x16x64_bf16 v[68:71], v[40:43], a[80:87], v19
    v_smfmac_f32_16x16x64_bf16 v[64:67], v[56:59], a[48:55], v19
    v_smfmac_f32_16x16x64_bf16 v[68:71], v[56:59], a[112:119], v19
    s_branch Gq_17_done
Gq_17_f2:
    buffer_load_dwordx4 v[40:43], v2, s[8:11], s40 offen offset:2048 sc1
    s_add_u32 s33, s33, 1
    s_cmp_gt_u32 s33, 0x100000
    s_cbranch_scc1 chain_kernel_abort
    s_branch Gq_17_s2
Gq_17_s3012:
    s_waitcnt vmcnt(3)
    v_cmp_eq_u32 vcc, -1, v44
    v_mov_b32_dpp v60, v44 row_ror:8 row_mask:0xf bank_mask:0xf
    v_mov_b32_dpp v61, v45 row_ror:8 row_mask:0xf bank_mask:0xf
    v_mov_b32_dpp v62, v46 row_ror:8 row_mask:0xf bank_mask:0xf
    v_mov_b32_dpp v63, v47 row_ror:8 row_mask:0xf bank_mask:0xf
    s_cbranch_vccnz Gq_17_f3012
    v_smfmac_f32_16x16x64_bf16 v[64:67], v[44:47], a[24:31], v19
    v_smfmac_f32_16x16x64_bf16 v[68:71], v[44:47], a[88:95], v19
Gq_17_s012p3:
    s_waitcnt vmcnt(2)
    v_cmp_eq_u32 vcc, -1, v32
    v_smfmac_f32_16x16x64_bf16 v[64:67], v[60:63], a[56:63], v19
    v_mov_b32_dpp v48, v32 row_ror:8 row_mask:0xf bank_mask:0xf
    v_mov_b32_dpp v49, v33 row_ror:8 row_mask:0xf bank_mask:0xf
    v_smfmac_f32_16x16x64_bf16 v[68:71], v[60:63], a[120:127], v19
    v_mov_b32_dpp v50, v34 row_ror:8 row_mask:0xf bank_mask:0xf
    v_mov_b32_dpp v51, v35 row_ror:8 row_mask:0xf bank_mask:0xf
    s_cbranch_vccnz Gq_17_f012p3
    v_smfmac_f32_16x16x64_bf16 v[64:67], v[32:35], a[0:7], v19
    v_smfmac_f32_16x16x64_bf16 v[68:71], v[32:35], a[64:71], v19
Gq_17_s12p0:
    s_waitcnt vmcnt(1)
    v_cmp_eq_u32 vcc, -1, v36
    v_smfmac_f32_16x16x64_bf16 v[64:67], v[48:51], a[32:39], v19
    v_mov_b32_dpp v52, v36 row_ror:8 row_mask:0xf bank_mask:0xf
    v_mov_b32_dpp v53, v37 row_ror:8 row_mask:0xf bank_mask:0xf
    v_smfmac_f32_16x16x64_bf16 v[68:71], v[48:51], a[96:103], v19
    v_mov_b32_dpp v54, v38 row_ror:8 row_mask:0xf bank_mask:0xf
    v_mov_b32_dpp v55, v39 row_ror:8 row_mask:0xf bank_mask:0xf
    s_cbranch_vccnz Gq_17_f12p0
    v_smfmac_f32_16x16x64_bf16 v[64:67], v[36:39], a[8:15], v19
    v_smfmac_f32_16x16x64_bf16 v[68:71], v[36:39], a[72:79], v19
    s_branch Gq_17_s2p1
Gq_17_f3012:
    buffer_load_dwordx4 v[44:47], v2, s[8:11], s40 offen offset:3072 sc1
    s_add_u32 s33, s33, 1
    s_cmp_gt_u32 s33, 0x100000
    s_cbranch_scc1 chain_kernel_abort
    s_branch Gq_17_s0123
Gq_17_f012p3:
    buffer_load_dwordx4 v[32:35], v2, s[8:11], s40 offen offset:0 sc1
    s_add_u32 s33, s33, 1
    s_cmp_gt_u32 s33, 0x100000
    s_cbranch_scc1 chain_kernel_abort
    s_branch Gq_17_s120
Gq_17_f12p0:
    buffer_load_dwordx4 v[36:39], v2, s[8:11], s40 offen offset:1024 sc1
    s_add_u32 s33, s33, 1
    s_cmp_gt_u32 s33, 0x100000
    s_cbranch_scc1 chain_kernel_abort
    s_branch Gq_17_s21
Gq_17_s013:
    s_waitcnt vmcnt(2)
    v_cmp_eq_u32 vcc, -1, v32
    v_mov_b32_dpp v48, v32 row_ror:8 row_mask:0xf bank_mask:0xf
    v_mov_b32_dpp v49, v33 row_ror:8 row_mask:0xf bank_mask:0xf
    v_mov_b32_dpp v50, v34 row_ror:8 row_mask:0xf bank_mask:0xf
    v_mov_b32_dpp v51, v35 row_ror:8 row_mask:0xf bank_mask:0xf
    s_cbranch_vccnz Gq_17_f013
    v_smfmac_f32_16x16x64_bf16 v[64:67], v[32:35], a[0:7], v19
    v_smfmac_f32_16x16x64_bf16 v[68:71], v[32:35], a[64:71], v19
Gq_17_s13p0:
    s_waitcnt vmcnt(1)
    v_cmp_eq_u32 vcc, -1, v36
    v_smfmac_f32_16x16x64_bf16 v[64:67], v[48:51], a[32:39], v19
    v_mov_b32_dpp v52, v36 row_ror:8 row_mask:0xf bank_mask:0xf
    v_mov_b32_dpp v53, v37 row_ror:8 row_mask:0xf bank_mask:0xf
    v_smfmac_f32_16x16x64_bf16 v[68:71], v[48:51], a[96:103], v19
    v_mov_b32_dpp v54, v38 row_ror:8 row_mask:0xf bank_mask:0xf
    v_mov_b32_dpp v55, v39 row_ror:8 row_mask:0xf bank_mask:0xf
    s_cbranch_vccnz Gq_17_f13p0
    v_smfmac_f32_16x16x64_bf16 v[64:67], v[36:39], a[8:15], v19
    v_smfmac_f32_16x16x64_bf16 v[68:71], v[36:39], a[72:79], v19
    s_branch Gq_17_s3p1
Gq_17_f013:
    buffer_load_dwordx4 v[32:35], v2, s[8:11], s40 offen offset:0 sc1
    s_add_u32 s33, s33, 1
    s_cmp_gt_u32 s33, 0x100000
    s_cbranch_scc1 chain_kernel_abort
    s_branch Gq_17_s130
Gq_17_f13p0:
    buffer_load_dwordx4 v[36:39], v2, s[8:11], s40 offen offset:1024 sc1
    s_add_u32 s33, s33, 1
    s_cmp_gt_u32 s33, 0x100000
    s_cbranch_scc1 chain_kernel_abort
    s_branch Gq_17_s31
Gq_17_s10:
    s_waitcnt vmcnt(1)
    v_cmp_eq_u32 vcc, -1, v36
    v_mov_b32_dpp v52, v36 row_ror:8 row_mask:0xf bank_mask:0xf
    v_mov_b32_dpp v53, v37 row_ror:8 row_mask:0xf bank_mask:0xf
    v_mov_b32_dpp v54, v38 row_ror:8 row_mask:0xf bank_mask:0xf
    v_mov_b32_dpp v55, v39 row_ror:8 row_mask:0xf bank_mask:0xf
    s_cbranch_vccnz Gq_17_f10
    v_smfmac_f32_16x16x64_bf16 v[64:67], v[36:39], a[8:15], v19
    v_smfmac_f32_16x16x64_bf16 v[68:71], v[36:39], a[72:79], v19
Gq_17_s0p1:
    s_waitcnt vmcnt(0)
    v_cmp_eq_u32 vcc, -1, v32
    v_smfmac_f32_16x16x64_bf16 v[64:67], v[52:55], a[40:47], v19
    v_mov_b32_dpp v48, v32 row_ror:8 row_mask:0xf bank_mask:0xf
    v_mov_b32_dpp v49, v33 row_ror:8 row_mask:0xf bank_mask:0xf
    v_smfmac_f32_16x16x64_bf16 v[68:71], v[52:55], a[104:111], v19
    v_mov_b32_dpp v50, v34 row_ror:8 row_mask:0xf bank_mask:0xf
    v_mov_b32_dpp v51, v35 row_ror:8 row_mask:0xf bank_mask:0xf
    s_cbranch_vccnz Gq_17_f0p1
    v_smfmac_f32_16x16x64_bf16 v[64:67], v[32:35], a[0:7], v19
    v_smfmac_f32_16x16x64_bf16 v[68:71], v[32:35], a[64:71], v19
    v_smfmac_f32_16x16x64_bf16 v[64:67], v[48:51], a[32:39], v19
    v_smfmac_f32_16x16x64_bf16 v[68:71], v[48:51], a[96:103], v19
    s_branch Gq_17_done
Gq_17_f10:
    buffer_load_dwordx4 v[36:39], v2, s[8:11], s40 offen offset:1024 sc1
    s_add_u32 s33, s33, 1
    s_cmp_gt_u32 s33, 0x100000
    s_cbranch_scc1 chain_kernel_abort
    s_branch Gq_17_s01
Gq_17_f0p1:
    buffer_load_dwordx4 v[32:35], v2, s[8:11], s40 offen offset:0 sc1
    s_add_u32 s33, s33, 1
    s_cmp_gt_u32 s33, 0x100000
    s_cbranch_scc1 chain_kernel_abort
    s_branch Gq_17_s0
Gq_17_s023:
    s_waitcnt vmcnt(2)
    v_cmp_eq_u32 vcc, -1, v32
    v_mov_b32_dpp v48, v32 row_ror:8 row_mask:0xf bank_mask:0xf
    v_mov_b32_dpp v49, v33 row_ror:8 row_mask:0xf bank_mask:0xf
    v_mov_b32_dpp v50, v34 row_ror:8 row_mask:0xf bank_mask:0xf
    v_mov_b32_dpp v51, v35 row_ror:8 row_mask:0xf bank_mask:0xf
    s_cbranch_vccnz Gq_17_f023
    v_smfmac_f32_16x16x64_bf16 v[64:67], v[32:35], a[0:7], v19
    v_smfmac_f32_16x16x64_bf16 v[68:71], v[32:35], a[64:71], v19
Gq_17_s23p0:
    s_waitcnt vmcnt(1)
    v_cmp_eq_u32 vcc, -1, v40
    v_smfmac_f32_16x16x64_bf16 v[64:67], v[48:51], a[32:39], v19
    v_mov_b32_dpp v56, v40 row_ror:8 row_mask:0xf bank_mask:0xf
    v_mov_b32_dpp v57, v41 row_ror:8 row_mask:0xf bank_mask:0xf
    v_smfmac_f32_16x16x64_bf16 v[68:71], v[48:51], a[96:103], v19
    v_mov_b32_dpp v58, v42 row_ror:8 row_mask:0xf bank_mask:0xf
    v_mov_b32_dpp v59, v43 row_ror:8 row_mask:0xf bank_mask:0xf
    s_cbranch_vccnz Gq_17_f23p0
    v_smfmac_f32_16x16x64_bf16 v[64:67], v[40:43], a[16:23], v19
    v_smfmac_f32_16x16x64_bf16 v[68:71], v[40:43], a[80:87], v19
    s_branch Gq_17_s3p2
Gq_17_f023:
    buffer_load_dwordx4 v[32:35], v2, s[8:11], s40 offen offset:0 sc1
    s_add_u32 s33, s33, 1
    s_cmp_gt_u32 s33, 0x100000
    s_cbranch_scc1 chain_kernel_abort
    s_branch Gq_17_s230
Gq_17_f23p0:
    buffer_load_dwordx4 v[40:43], v2, s[8:11], s40 offen offset:2048 sc1
    s_add_u32 s33, s33, 1
    s_cmp_gt_u32 s33, 0x100000
    s_cbranch_scc1 chain_kernel_abort
    s_branch Gq_17_s32
Gq_17_s20:
    s_waitcnt vmcnt(1)
    v_cmp_eq_u32 vcc, -1, v40
    v_mov_b32_dpp v56, v40 row_ror:8 row_mask:0xf bank_mask:0xf
    v_mov_b32_dpp v57, v41 row_ror:8 row_mask:0xf bank_mask:0xf
    v_mov_b32_dpp v58, v42 row_ror:8 row_mask:0xf bank_mask:0xf
    v_mov_b32_dpp v59, v43 row_ror:8 row_mask:0xf bank_mask:0xf
    s_cbranch_vccnz Gq_17_f20
    v_smfmac_f32_16x16x64_bf16 v[64:67], v[40:43], a[16:23], v19
    v_smfmac_f32_16x16x64_bf16 v[68:71], v[40:43], a[80:87], v19
Gq_17_s0p2:
    s_waitcnt vmcnt(0)
    v_cmp_eq_u32 vcc, -1, v32
    v_smfmac_f32_16x16x64_bf16 v[64:67], v[56:59], a[48:55], v19
    v_mov_b32_dpp v48, v32 row_ror:8 row_mask:0xf bank_mask:0xf
    v_mov_b32_dpp v49, v33 row_ror:8 row_mask:0xf bank_mask:0xf
    v_smfmac_f32_16x16x64_bf16 v[68:71], v[56:59], a[112:119], v19
    v_mov_b32_dpp v50, v34 row_ror:8 row_mask:0xf bank_mask:0xf
    v_mov_b32_dpp v51, v35 row_ror:8 row_mask:0xf bank_mask:0xf
    s_cbranch_vccnz Gq_17_f0p2
    v_smfmac_f32_16x16x64_bf16 v[64:67], v[32:35], a[0:7], v19
    v_smfmac_f32_16x16x64_bf16 v[68:71], v[32:35], a[64:71], v19
    v_smfmac_f32_16x16x64_bf16 v[64:67], v[48:51], a[32:39], v19
    v_smfmac_f32_16x16x64_bf16 v[68:71], v[48:51], a[96:103], v19
    s_branch Gq_17_done
Gq_17_f20:
    buffer_load_dwordx4 v[40:43], v2, s[8:11], s40 offen offset:2048 sc1
    s_add_u32 s33, s33, 1
    s_cmp_gt_u32 s33, 0x100000
    s_cbranch_scc1 chain_kernel_abort
    s_branch Gq_17_s02
Gq_17_f0p2:
    buffer_load_dwordx4 v[32:35], v2, s[8:11], s40 offen offset:0 sc1
    s_add_u32 s33, s33, 1
    s_cmp_gt_u32 s33, 0x100000
    s_cbranch_scc1 chain_kernel_abort
    s_branch Gq_17_s0
Gq_17_s30:
    s_waitcnt vmcnt(1)
    v_cmp_eq_u32 vcc, -1, v44
    v_mov_b32_dpp v60, v44 row_ror:8 row_mask:0xf bank_mask:0xf
    v_mov_b32_dpp v61, v45 row_ror:8 row_mask:0xf bank_mask:0xf
    v_mov_b32_dpp v62, v46 row_ror:8 row_mask:0xf bank_mask:0xf
    v_mov_b32_dpp v63, v47 row_ror:8 row_mask:0xf bank_mask:0xf
    s_cbranch_vccnz Gq_17_f30
    v_smfmac_f32_16x16x64_bf16 v[64:67], v[44:47], a[24:31], v19
    v_smfmac_f32_16x16x64_bf16 v[68:71], v[44:47], a[88:95], v19
    s_branch Gq_17_s0p3
Gq_17_f30:
    buffer_load_dwordx4 v[44:47], v2, s[8:11], s40 offen offset:3072 sc1
    s_add_u32 s33, s33, 1
    s_cmp_gt_u32 s33, 0x100000
    s_cbranch_scc1 chain_kernel_abort
    s_branch Gq_17_s03
Gq_17_s123:
    s_waitcnt vmcnt(2)
    v_cmp_eq_u32 vcc, -1, v36
    v_mov_b32_dpp v52, v36 row_ror:8 row_mask:0xf bank_mask:0xf
    v_mov_b32_dpp v53, v37 row_ror:8 row_mask:0xf bank_mask:0xf
    v_mov_b32_dpp v54, v38 row_ror:8 row_mask:0xf bank_mask:0xf
    v_mov_b32_dpp v55, v39 row_ror:8 row_mask:0xf bank_mask:0xf
    s_cbranch_vccnz Gq_17_f123
    v_smfmac_f32_16x16x64_bf16 v[64:67], v[36:39], a[8:15], v19
    v_smfmac_f32_16x16x64_bf16 v[68:71], v[36:39], a[72:79], v19
    s_branch Gq_17_s23p1
Gq_17_f123:
    buffer_load_dwordx4 v[36:39], v2, s[8:11], s40 offen offset:1024 sc1
    s_add_u32 s33, s33, 1
    s_cmp_gt_u32 s33, 0x100000
    s_cbranch_scc1 chain_kernel_abort
    s_branch Gq_17_s231
Gq_17_s21:
    s_waitcnt vmcnt(1)
    v_cmp_eq_u32 vcc, -1, v40
    v_mov_b32_dpp v56, v40 row_ror:8 row_mask:0xf bank_mask:0xf
    v_mov_b32_dpp v57, v41 row_ror:8 row_mask:0xf bank_mask:0xf
    v_mov_b32_dpp v58, v42 row_ror:8 row_mask:0xf bank_mask:0xf
    v_mov_b32_dpp v59, v43 row_ror:8 row_mask:0xf bank_mask:0xf
    s_cbranch_vccnz Gq_17_f21
    v_smfmac_f32_16x16x64_bf16 v[64:67], v[40:43], a[16:23], v19
    v_smfmac_f32_16x16x64_bf16 v[68:71], v[40:43], a[80:87], v19
Gq_17_s1p2:
    s_waitcnt vmcnt(0)
    v_cmp_eq_u32 vcc, -1, v36
    v_smfmac_f32_16x16x64_bf16 v[64:67], v[56:59], a[48:55], v19
    v_mov_b32_dpp v52, v36 row_ror:8 row_mask:0xf bank_mask:0xf
    v_mov_b32_dpp v53, v37 row_ror:8 row_mask:0xf bank_mask:0xf
    v_smfmac_f32_16x16x64_bf16 v[68:71], v[56:59], a[112:119], v19
    v_mov_b32_dpp v54, v38 row_ror:8 row_mask:0xf bank_mask:0xf
    v_mov_b32_dpp v55, v39 row_ror:8 row_mask:0xf bank_mask:0xf
    s_cbranch_vccnz Gq_17_f1p2
    v_smfmac_f32_16x16x64_bf16 v[64:67], v[36:39], a[8:15], v19
    v_smfmac_f32_16x16x64_bf16 v[68:71], v[36:39], a[72:79], v19
    v_smfmac_f32_16x16x64_bf16 v[64:67], v[52:55], a[40:47], v19
    v_smfmac_f32_16x16x64_bf16 v[68:71], v[52:55], a[104:111], v19
    s_branch Gq_17_done
Gq_17_f21:
    buffer_load_dwordx4 v[40:43], v2, s[8:11], s40 offen offset:2048 sc1
    s_add_u32 s33, s33, 1
    s_cmp_gt_u32 s33, 0x100000
    s_cbranch_scc1 chain_kernel_abort
    s_branch Gq_17_s12
Gq_17_f1p2:
    buffer_load_dwordx4 v[36:39], v2, s[8:11], s40 offen offset:1024 sc1
    s_add_u32 s33, s33, 1
    s_cmp_gt_u32 s33, 0x100000
    s_cbranch_scc1 chain_kernel_abort
    s_branch Gq_17_s1
Gq_17_s31:
    s_waitcnt vmcnt(1)
    v_cmp_eq_u32 vcc, -1, v44
    v_mov_b32_dpp v60, v44 row_ror:8 row_mask:0xf bank_mask:0xf
    v_mov_b32_dpp v61, v45 row_ror:8 row_mask:0xf bank_mask:0xf
    v_mov_b32_dpp v62, v46 row_ror:8 row_mask:0xf bank_mask:0xf
    v_mov_b32_dpp v63, v47 row_ror:8 row_mask:0xf bank_mask:0xf
    s_cbranch_vccnz Gq_17_f31
    v_smfmac_f32_16x16x64_bf16 v[64:67], v[44:47], a[24:31], v19
    v_smfmac_f32_16x16x64_bf16 v[68:71], v[44:47], a[88:95], v19
    s_branch Gq_17_s1p3
Gq_17_f31:
    buffer_load_dwordx4 v[44:47], v2, s[8:11], s40 offen offset:3072 sc1
    s_add_u32 s33, s33, 1
    s_cmp_gt_u32 s33, 0x100000
    s_cbranch_scc1 chain_kernel_abort
    s_branch Gq_17_s13
Gq_17_s120:
    s_waitcnt vmcnt(2)
    v_cmp_eq_u32 vcc, -1, v36
    v_mov_b32_dpp v52, v36 row_ror:8 row_mask:0xf bank_mask:0xf
    v_mov_b32_dpp v53, v37 row_ror:8 row_mask:0xf bank_mask:0xf
    v_mov_b32_dpp v54, v38 row_ror:8 row_mask:0xf bank_mask:0xf
    v_mov_b32_dpp v55, v39 row_ror:8 row_mask:0xf bank_mask:0xf
    s_cbranch_vccnz Gq_17_f120
    v_smfmac_f32_16x16x64_bf16 v[64:67], v[36:39], a[8:15], v19
    v_smfmac_f32_16x16x64_bf16 v[68:71], v[36:39], a[72:79], v19
Gq_17_s20p1:
    s_waitcnt vmcnt(1)
    v_cmp_eq_u32 vcc, -1, v40
    v_smfmac_f32_16x16x64_bf16 v[64:67], v[52:55], a[40:47], v19
    v_mov_b32_dpp v56, v40 row_ror:8 row_mask:0xf bank_mask:0xf
    v_mov_b32_dpp v57, v41 row_ror:8 row_mask:0xf bank_mask:0xf
    v_smfmac_f32_16x16x64_bf16 v[68:71], v[52:55], a[104:111], v19
    v_mov_b32_dpp v58, v42 row_ror:8 row_mask:0xf bank_mask:0xf
    v_mov_b32_dpp v59, v43 row_ror:8 row_mask:0xf bank_mask:0xf
    s_cbranch_vccnz Gq_17_f20p1
    v_smfmac_f32_16x16x64_bf16 v[64:67], v[40:43], a[16:23], v19
    v_smfmac_f32_16x16x64_bf16 v[68:71], v[40:43], a[80:87], v19
    s_branch Gq_17_s0p2
Gq_17_f120:
    buffer_load_dwordx4 v[36:39], v2, s[8:11], s40 offen offset:1024 sc1
    s_add_u32 s33, s33, 1
    s_cmp_gt_u32 s33, 0x100000
    s_cbranch_scc1 chain_kernel_abort
    s_branch Gq_17_s201
Gq_17_f20p1:
    buffer_load_dwordx4 v[40:43], v2, s[8:11], s40 offen offset:2048 sc1
    s_add_u32 s33, s33, 1
    s_cmp_gt_u32 s33, 0x100000
    s_cbranch_scc1 chain_kernel_abort
    s_branch Gq_17_s02
Gq_17_s130:
    s_waitcnt vmcnt(2)
    v_cmp_eq_u32 vcc, -1, v36
    v_mov_b32_dpp v52, v36 row_ror:8 row_mask:0xf bank_mask:0xf
    v_mov_b32_dpp v53, v37 row_ror:8 row_mask:0xf bank_mask:0xf
    v_mov_b32_dpp v54, v38 row_ror:8 row_mask:0xf bank_mask:0xf
    v_mov_b32_dpp v55, v39 row_ror:8 row_mask:0xf bank_mask:0xf
    s_cbranch_vccnz Gq_17_f130
    v_smfmac_f32_16x16x64_bf16 v[64:67], v[36:39], a[8:15], v19
    v_smfmac_f32_16x16x64_bf16 v[68:71], v[36:39], a[72:79], v19
Gq_17_s30p1:
    s_waitcnt vmcnt(1)
    v_cmp_eq_u32 vcc, -1, v44
    v_smfmac_f32_16x16x64_bf16 v[64:67], v[52:55], a[40:47], v19
    v_mov_b32_dpp v60, v44 row_ror:8 row_mask:0xf bank_mask:0xf
    v_mov_b32_dpp v61, v45 row_ror:8 row_mask:0xf bank_mask:0xf
    v_smfmac_f32_16x16x64_bf16 v[68:71], v[52:55], a[104:111], v19
    v_mov_b32_dpp v62, v46 row_ror:8 row_mask:0xf bank_mask:0xf
    v_mov_b32_dpp v63, v47 row_ror:8 row_mask:0xf bank_mask:0xf
    s_cbranch_vccnz Gq_17_f30p1
    v_smfmac_f32_16x16x64_bf16 v[64:67], v[44:47], a[24:31], v19
    v_smfmac_f32_16x16x64_bf16 v[68:71], v[44:47], a[88:95], v19
    s_branch Gq_17_s0p3
Gq_17_f130:
    buffer_load_dwordx4 v[36:39], v2, s[8:11], s40 offen offset:1024 sc1
    s_add_u32 s33, s33, 1
    s_cmp_gt_u32 s33, 0x100000
    s_cbranch_scc1 chain_kernel_abort
    s_branch Gq_17_s301
Gq_17_f30p1:
    buffer_load_dwordx4 v[44:47], v2, s[8:11], s40 offen offset:3072 sc1
    s_add_u32 s33, s33, 1
    s_cmp_gt_u32 s33, 0x100000
    s_cbranch_scc1 chain_kernel_abort
    s_branch Gq_17_s03
Gq_17_s01:
    s_waitcnt vmcnt(1)
    v_cmp_eq_u32 vcc, -1, v32
    v_mov_b32_dpp v48, v32 row_ror:8 row_mask:0xf bank_mask:0xf
    v_mov_b32_dpp v49, v33 row_ror:8 row_mask:0xf bank_mask:0xf
    v_mov_b32_dpp v50, v34 row_ror:8 row_mask:0xf bank_mask:0xf
    v_mov_b32_dpp v51, v35 row_ror:8 row_mask:0xf bank_mask:0xf
    s_cbranch_vccnz Gq_17_f01
    v_smfmac_f32_16x16x64_bf16 v[64:67], v[32:35], a[0:7], v19
    v_smfmac_f32_16x16x64_bf16 v[68:71], v[32:35], a[64:71], v19
    s_branch Gq_17_s1p0
Gq_17_f01:
    buffer_load_dwordx4 v[32:35], v2, s[8:11], s40 offen offset:0 sc1
    s_add_u32 s33, s33, 1
    s_cmp_gt_u32 s33, 0x100000
    s_cbranch_scc1 chain_kernel_abort
    s_branch Gq_17_s10
Gq_17_s230:
    s_waitcnt vmcnt(2)
    v_cmp_eq_u32 vcc, -1, v40
    v_mov_b32_dpp v56, v40 row_ror:8 row_mask:0xf bank_mask:0xf
    v_mov_b32_dpp v57, v41 row_ror:8 row_mask:0xf bank_mask:0xf
    v_mov_b32_dpp v58, v42 row_ror:8 row_mask:0xf bank_mask:0xf
    v_mov_b32_dpp v59, v43 row_ror:8 row_mask:0xf bank_mask:0xf
    s_cbranch_vccnz Gq_17_f230
    v_smfmac_f32_16x16x64_bf16 v[64:67], v[40:43], a[16:23], v19
    v_smfmac_f32_16x16x64_bf16 v[68:71], v[40:43], a[80:87], v19
    s_branch Gq_17_s30p2
Gq_17_f230:
    buffer_load_dwordx4 v[40:43], v2, s[8:11], s40 offen offset:2048 sc1
    s_add_u32 s33, s33, 1
    s_cmp_gt_u32 s33, 0x100000
    s_cbranch_scc1 chain_kernel_abort
    s_branch Gq_17_s302
Gq_17_s02:
    s_waitcnt vmcnt(1)
    v_cmp_eq_u32 vcc, -1, v32
    v_mov_b32_dpp v48, v32 row_ror:8 row_mask:0xf bank_mask:0xf
    v_mov_b32_dpp v49, v33 row_ror:8 row_mask:0xf bank_mask:0xf
    v_mov_b32_dpp v50, v34 row_ror:8 row_mask:0xf bank_mask:0xf
    v_mov_b32_dpp v51, v35 row_ror:8 row_mask:0xf bank_mask:0xf
    s_cbranch_vccnz Gq_17_f02
    v_smfmac_f32_16x16x64_bf16 v[64:67], v[32:35], a[0:7], v19
    v_smfmac_f32_16x16x64_bf16 v[68:71], v[32:35], a[64:71], v19
    s_branch Gq_17_s2p0
Gq_17_f02:
    buffer_load_dwordx4 v[32:35], v2, s[8:11], s40 offen offset:0 sc1
    s_add_u32 s33, s33, 1
    s_cmp_gt_u32 s33, 0x100000
    s_cbranch_scc1 chain_kernel_abort
    s_branch Gq_17_s20
Gq_17_s12:
    s_waitcnt vmcnt(1)
    v_cmp_eq_u32 vcc, -1, v36
    v_mov_b32_dpp v52, v36 row_ror:8 row_mask:0xf bank_mask:0xf
    v_mov_b32_dpp v53, v37 row_ror:8 row_mask:0xf bank_mask:0xf
    v_mov_b32_dpp v54, v38 row_ror:8 row_mask:0xf bank_mask:0xf
    v_mov_b32_dpp v55, v39 row_ror:8 row_mask:0xf bank_mask:0xf
    s_cbranch_vccnz Gq_17_f12
    v_smfmac_f32_16x16x64_bf16 v[64:67], v[36:39], a[8:15], v19
    v_smfmac_f32_16x16x64_bf16 v[68:71], v[36:39], a[72:79], v19
    s_branch Gq_17_s2p1
Gq_17_f12:
    buffer_load_dwordx4 v[36:39], v2, s[8:11], s40 offen offset:1024 sc1
    s_add_u32 s33, s33, 1
    s_cmp_gt_u32 s33, 0x100000
    s_cbranch_scc1 chain_kernel_abort
    s_branch Gq_17_s21
Gq_17_s201:
    s_waitcnt vmcnt(2)
    v_cmp_eq_u32 vcc, -1, v40
    v_mov_b32_dpp v56, v40 row_ror:8 row_mask:0xf bank_mask:0xf
    v_mov_b32_dpp v57, v41 row_ror:8 row_mask:0xf bank_mask:0xf
    v_mov_b32_dpp v58, v42 row_ror:8 row_mask:0xf bank_mask:0xf
    v_mov_b32_dpp v59, v43 row_ror:8 row_mask:0xf bank_mask:0xf
    s_cbranch_vccnz Gq_17_f201
    v_smfmac_f32_16x16x64_bf16 v[64:67], v[40:43], a[16:23], v19
    v_smfmac_f32_16x16x64_bf16 v[68:71], v[40:43], a[80:87], v19
Gq_17_s01p2:
    s_waitcnt vmcnt(1)
    v_cmp_eq_u32 vcc, -1, v32
    v_smfmac_f32_16x16x64_bf16 v[64:67], v[56:59], a[48:55], v19
    v_mov_b32_dpp v48, v32 row_ror:8 row_mask:0xf bank_mask:0xf
    v_mov_b32_dpp v49, v33 row_ror:8 row_mask:0xf bank_mask:0xf
    v_smfmac_f32_16x16x64_bf16 v[68:71], v[56:59], a[112:119], v19
    v_mov_b32_dpp v50, v34 row_ror:8 row_mask:0xf bank_mask:0xf
    v_mov_b32_dpp v51, v35 row_ror:8 row_mask:0xf bank_mask:0xf
    s_cbranch_vccnz Gq_17_f01p2
    v_smfmac_f32_16x16x64_bf16 v[64:67], v[32:35], a[0:7], v19
    v_smfmac_f32_16x16x64_bf16 v[68:71], v[32:35], a[64:71], v19
    s_branch Gq_17_s1p0
Gq_17_f201:
    buffer_load_dwordx4 v[40:43], v2, s[8:11], s40 offen offset:2048 sc1
    s_add_u32 s33, s33, 1
    s_cmp_gt_u32 s33, 0x100000
    s_cbranch_scc1 chain_kernel_abort
    s_branch Gq_17_s012
Gq_17_f01p2:
    buffer_load_dwordx4 v[32:35], v2, s[8:11], s40 offen offset:0 sc1
    s_add_u32 s33, s33, 1
    s_cmp_gt_u32 s33, 0x100000
    s_cbranch_scc1 chain_kernel_abort
    s_branch Gq_17_s10
Gq_17_s301:
    s_waitcnt vmcnt(2)
    v_cmp_eq_u32 vcc, -1, v44
    v_mov_b32_dpp v60, v44 row_ror:8 row_mask:0xf bank_mask:0xf
    v_mov_b32_dpp v61, v45 row_ror:8 row_mask:0xf bank_mask:0xf
    v_mov_b32_dpp v62, v46 row_ror:8 row_mask:0xf bank_mask:0xf
    v_mov_b32_dpp v63, v47 row_ror:8 row_mask:0xf bank_mask:0xf
    s_cbranch_vccnz Gq_17_f301
    v_smfmac_f32_16x16x64_bf16 v[64:67], v[44:47], a[24:31], v19
    v_smfmac_f32_16x16x64_bf16 v[68:71], v[44:47], a[88:95], v19
    s_branch Gq_17_s01p3
Gq_17_f301:
    buffer_load_dwordx4 v[44:47], v2, s[8:11], s40 offen offset:3072 sc1
    s_add_u32 s33, s33, 1
    s_cmp_gt_u32 s33, 0x100000
    s_cbranch_scc1 chain_kernel_abort
    s_branch Gq_17_s013
Gq_17_s012:
    s_waitcnt vmcnt(2)
    v_cmp_eq_u32 vcc, -1, v32
    v_mov_b32_dpp v48, v32 row_ror:8 row_mask:0xf bank_mask:0xf
    v_mov_b32_dpp v49, v33 row_ror:8 row_mask:0xf bank_mask:0xf
    v_mov_b32_dpp v50, v34 row_ror:8 row_mask:0xf bank_mask:0xf
    v_mov_b32_dpp v51, v35 row_ror:8 row_mask:0xf bank_mask:0xf
    s_cbranch_vccnz Gq_17_f012
    v_smfmac_f32_16x16x64_bf16 v[64:67], v[32:35], a[0:7], v19
    v_smfmac_f32_16x16x64_bf16 v[68:71], v[32:35], a[64:71], v19
    s_branch Gq_17_s12p0
Gq_17_f012:
    buffer_load_dwordx4 v[32:35], v2, s[8:11], s40 offen offset:0 sc1
    s_add_u32 s33, s33, 1
    s_cmp_gt_u32 s33, 0x100000
    s_cbranch_scc1 chain_kernel_abort
    s_branch Gq_17_s120
L_sd_18_0_0f:
    s_branch L_sd_18_1_0
L_sd_18_0_1f:
    s_branch L_sd_18_1_1
L_sd_18_0_2f:
    s_branch L_sd_18_1_2
L_sd_18_0_3f:
    s_branch L_sd_18_1_3
L_sd_18_1_0:
    s_waitcnt vmcnt(7)
    v_max3_u32 v20, v164, v165, v166
    v_mfma_f32_16x16x32_bf16 v[88:91], v[164:167], v[164:167], 0
    v_max_u32 v20, v20, v167
    v_cmp_eq_u32 vcc, -1, v20
    v_mfma_f32_16x16x32_bf16 v[84:87], v[120:123], v[164:167], 0
    v_mfma_f32_16x16x32_bf16 v[80:83], v[104:107], v[164:167], 0
    s_cbranch_vccnz L_sd_18_2_0
L_sd_18_1_1:
    s_waitcnt vmcnt(6)
    v_max3_u32 v20, v168, v169, v170
    v_mfma_f32_16x16x32_bf16 v[100:103], v[168:171], v[168:171], v[88:91]
    v_max_u32 v20, v20, v171
    v_cmp_eq_u32 vcc, -1, v20
    v_mfma_f32_16x16x32_bf16 v[96:99], v[124:127], v[168:171], v[84:87]
    v_mfma_f32_16x16x32_bf16 v[92:95], v[108:111], v[168:171], v[80:83]
    s_cbranch_vccnz L_sd_18_2_1
L_sd_18_1_2:
    s_waitcnt vmcnt(5)
    v_max3_u32 v20, v172, v173, v174
    v_mfma_f32_16x16x32_bf16 v[228:231], v[172:175], v[172:175], v[100:103]
    v_max_u32 v20, v20, v175
    v_cmp_eq_u32 vcc, -1, v20
    v_mfma_f32_16x16x32_bf16 v[224:227], v[128:131], v[172:175], v[96:99]
    v_mfma_f32_16x16x32_bf16 v[220:223], v[112:115], v[172:175], v[92:95]
    s_cbranch_vccnz L_sd_18_2_2
L_sd_18_1_3:
    s_waitcnt vmcnt(4)
    v_max3_u32 v20, v176, v177, v178
    v_mfma_f32_16x16x32_bf16 v[188:191], v[176:179], v[176:179], v[228:231]
    v_max_u32 v20, v20, v179
    v_cmp_eq_u32 vcc, -1, v20
    v_mfma_f32_16x16x32_bf16 v[184:187], v[132:135], v[176:179], v[224:227]
    v_mfma_f32_16x16x32_bf16 v[180:183], v[116:119], v[176:179], v[220:223]
    v_mov_b32_dpp v188, v189 row_ror:8 row_mask:0xf bank_mask:0xc
    v_mov_b32_dpp v190, v191 row_ror:8 row_mask:0xf bank_mask:0xc
    s_cbranch_vccnz L_sd_18_2_3
    s_branch L_sd_18
L_sd_18_1_0f:
    s_branch L_sd_18_2_0
L_sd_18_1_1f:
    s_branch L_sd_18_2_1
L_sd_18_1_2f:
    s_branch L_sd_18_2_2
L_sd_18_1_3f:
    s_branch L_sd_18_2_3
L_sd_18_2_0:
    s_waitcnt vmcnt(3)
    v_max3_u32 v20, v32, v33, v34
    v_mfma_f32_16x16x32_bf16 v[88:91], v[32:35], v[32:35], 0
    v_max_u32 v20, v20, v35
    v_cmp_eq_u32 vcc, -1, v20
    v_mfma_f32_16x16x32_bf16 v[84:87], v[120:123], v[32:35], 0
    v_mfma_f32_16x16x32_bf16 v[80:83], v[104:107], v[32:35], 0
    s_cbranch_vccnz L_sd_18_2_0f
L_sd_18_2_1:
    s_waitcnt vmcnt(2)
    v_max3_u32 v20, v36, v37, v38
    v_mfma_f32_16x16x32_bf16 v[100:103], v[36:39], v[36:39], v[88:91]
    v_max_u32 v20, v20, v39
    v_cmp_eq_u32 vcc, -1, v20
    v_mfma_f32_16x16x32_bf16 v[96:99], v[124:127], v[36:39], v[84:87]
    v_mfma_f32_16x16x32_bf16 v[92:95], v[108:111], v[36:39], v[80:83]
    s_cbranch_vccnz L_sd_18_2_1f
L_sd_18_2_2:
    s_waitcnt vmcnt(1)
    v_max3_u32 v20, v40, v41, v42
    v_mfma_f32_16x16x32_bf16 v[228:231], v[40:43], v[40:43], v[100:103]
    v_max_u32 v20, v20, v43
    v_cmp_eq_u32 vcc, -1, v20
    v_mfma_f32_16x16x32_bf16 v[224:227], v[128:131], v[40:43], v[96:99]
    v_mfma_f32_16x16x32_bf16 v[220:223], v[112:115], v[40:43], v[92:95]
    s_cbranch_vccnz L_sd_18_2_2f
L_sd_18_2_3:
    s_waitcnt vmcnt(0)
    v_max3_u32 v20, v44, v45, v46
    v_mfma_f32_16x16x32_bf16 v[188:191], v[44:47], v[44:47], v[228:231]
    v_max_u32 v20, v20, v47
    v_cmp_eq_u32 vcc, -1, v20
    v_mfma_f32_16x16x32_bf16 v[184:187], v[132:135], v[44:47], v[224:227]
    v_mfma_f32_16x16x32_bf16 v[180:183], v[116:119], v[44:47], v[220:223]
    v_mov_b32_dpp v188, v189 row_ror:8 row_mask:0xf bank_mask:0xc
    v_mov_b32_dpp v190, v191 row_ror:8 row_mask:0xf bank_mask:0xc
    s_cbranch_vccnz L_sd_18_2_3f
    s_branch L_sd_18
L_sd_18_2_0f:
    buffer_load_dwordx4 v[148:151], v5, s[8:11], s40 offen offset:0 sc1
    buffer_load_dwordx4 v[152:155], v5, s[8:11], s40 offen offset:1024 sc1
    buffer_load_dwordx4 v[156:159], v5, s[8:11], s40 offen offset:2048 sc1
    buffer_load_dwordx4 v[160:163], v5, s[8:11], s40 offen offset:3072 sc1
    s_add_u32 s33, s33, 1
    s_cmp_gt_u32 s33, 0x100000
    s_cbranch_scc1 chain_kernel_abort
    s_branch L_sd_18_3_0
L_sd_18_2_1f:
    buffer_load_dwordx4 v[152:155], v5, s[8:11], s40 offen offset:1024 sc1
    buffer_load_dwordx4 v[156:159], v5, s[8:11], s40 offen offset:2048 sc1
    buffer_load_dwordx4 v[160:163], v5, s[8:11], s40 offen offset:3072 sc1
    s_add_u32 s33, s33, 1
    s_cmp_gt_u32 s33, 0x100000
    s_cbranch_scc1 chain_kernel_abort
    s_branch L_sd_18_3_1
L_sd_18_2_2f:
    buffer_load_dwordx4 v[156:159], v5, s[8:11], s40 offen offset:2048 sc1
    buffer_load_dwordx4 v[160:163], v5, s[8:11], s40 offen offset:3072 sc1
    s_add_u32 s33, s33, 1
    s_cmp_gt_u32 s33, 0x100000
    s_cbranch_scc1 chain_kernel_abort
    s_branch L_sd_18_3_2
L_sd_18_2_3f:
    buffer_load_dwordx4 v[160:163], v5, s[8:11], s40 offen offset:3072 sc1
    s_add_u32 s33, s33, 1
    s_cmp_gt_u32 s33, 0x100000
    s_cbranch_scc1 chain_kernel_abort
    s_branch L_sd_18_3_3
L_sd_18_3_0:
    s_waitcnt vmcnt(3)
    v_max3_u32 v20, v148, v149, v150
    v_mfma_f32_16x16x32_bf16 v[88:91], v[148:151], v[148:151], 0
    v_max_u32 v20, v20, v151
    v_cmp_eq_u32 vcc, -1, v20
    v_mfma_f32_16x16x32_bf16 v[84:87], v[120:123], v[148:151], 0
    v_mfma_f32_16x16x32_bf16 v[80:83], v[104:107], v[148:151], 0
    s_cbranch_vccnz L_sd_18_3_0f
L_sd_18_3_1:
    s_waitcnt vmcnt(2)
    v_max3_u32 v20, v152, v153, v154
    v_mfma_f32_16x16x32_bf16 v[100:103], v[152:155], v[152:155], v[88:91]
    v_max_u32 v20, v20, v155
    v_cmp_eq_u32 vcc, -1, v20
    v_mfma_f32_16x16x32_bf16 v[96:99], v[124:127], v[152:155], v[84:87]
    v_mfma_f32_16x16x32_bf16 v[92:95], v[108:111], v[152:155], v[80:83]
    s_cbranch_vccnz L_sd_18_3_1f
L_sd_18_3_2:
    s_waitcnt vmcnt(1)
    v_max3_u32 v20, v156, v157, v158
    v_mfma_f32_16x16x32_bf16 v[228:231], v[156:159], v[156:159], v[100:103]
    v_max_u32 v20, v20, v159
    v_cmp_eq_u32 vcc, -1, v20
    v_mfma_f32_16x16x32_bf16 v[224:227], v[128:131], v[156:159], v[96:99]
    v_mfma_f32_16x16x32_bf16 v[220:223], v[112:115], v[156:159], v[92:95]
    s_cbranch_vccnz L_sd_18_3_2f
L_sd_18_3_3:
    s_waitcnt vmcnt(0)
    v_max3_u32 v20, v160, v161, v162
    v_mfma_f32_16x16x32_bf16 v[188:191], v[160:163], v[160:163], v[228:231]
    v_max_u32 v20, v20, v163
    v_cmp_eq_u32 vcc, -1, v20
    v_mfma_f32_16x16x32_bf16 v[184:187], v[132:135], v[160:163], v[224:227]
    v_mfma_f32_16x16x32_bf16 v[180:183], v[116:119], v[160:163], v[220:223]
    v_mov_b32_dpp v188, v189 row_ror:8 row_mask:0xf bank_mask:0xc
    v_mov_b32_dpp v190, v191 row_ror:8 row_mask:0xf bank_mask:0xc
    s_cbranch_vccnz L_sd_18_3_3f
    s_branch L_sd_18
L_sd_18_3_0f:
    buffer_load_dwordx4 v[148:151], v5, s[8:11], s40 offen offset:0 sc1
    buffer_load_dwordx4 v[152:155], v5, s[8:11], s40 offen offset:1024 sc1
    buffer_load_dwordx4 v[156:159], v5, s[8:11], s40 offen offset:2048 sc1
    buffer_load_dwordx4 v[160:163], v5, s[8:11], s40 offen offset:3072 sc1
    s_add_u32 s33, s33, 1
    s_cmp_gt_u32 s33, 0x100000
    s_cbranch_scc1 chain_kernel_abort
    s_branch L_sd_18_3_0
L_sd_18_3_1f:
    buffer_load_dwordx4 v[152:155], v5, s[8:11], s40 offen offset:1024 sc1
    buffer_load_dwordx4 v[156:159], v5, s[8:11], s40 offen offset:2048 sc1
    buffer_load_dwordx4 v[160:163], v5, s[8:11], s40 offen offset:3072 sc1
    s_add_u32 s33, s33, 1
    s_cmp_gt_u32 s33, 0x100000
    s_cbranch_scc1 chain_kernel_abort
    s_branch L_sd_18_3_1
L_sd_18_3_2f:
    buffer_load_dwordx4 v[156:159], v5, s[8:11], s40 offen offset:2048 sc1
    buffer_load_dwordx4 v[160:163], v5, s[8:11], s40 offen offset:3072 sc1
    s_add_u32 s33, s33, 1
    s_cmp_gt_u32 s33, 0x100000
    s_cbranch_scc1 chain_kernel_abort
    s_branch L_sd_18_3_2
L_sd_18_3_3f:
    buffer_load_dwordx4 v[160:163], v5, s[8:11], s40 offen offset:3072 sc1
    s_add_u32 s33, s33, 1
    s_cmp_gt_u32 s33, 0x100000
    s_cbranch_scc1 chain_kernel_abort
    s_branch L_sd_18_3_3
Go_19_f0123:
    buffer_load_dwordx4 v[32:35], v3, s[8:11], s40 offen offset:0 sc1
    s_branch Go_19_s1230
Go_19_f123:
    buffer_load_dwordx4 v[36:39], v3, s[8:11], s40 offen offset:1024 sc1
    s_add_u32 s33, s33, 1
    s_cmp_gt_u32 s33, 0x100000
    s_cbranch_scc1 chain_kernel_abort
    s_branch Go_19_s231
Go_19_f23:
    buffer_load_dwordx4 v[40:43], v3, s[8:11], s40 offen offset:2048 sc1
    s_add_u32 s33, s33, 1
    s_cmp_gt_u32 s33, 0x100000
    s_cbranch_scc1 chain_kernel_abort
    s_branch Go_19_s32
Go_19_f3:
    buffer_load_dwordx4 v[44:47], v3, s[8:11], s40 offen offset:3072 sc1
    s_add_u32 s33, s33, 1
    s_cmp_gt_u32 s33, 0x100000
    s_cbranch_scc1 chain_kernel_abort
    s_branch Go_19_s3
Go_19_redo:
    buffer_load_dwordx4 v[32:35], v3, s[8:11], s40 offen offset:0 sc1
    buffer_load_dwordx4 v[36:39], v3, s[8:11], s40 offen offset:1024 sc1
    buffer_load_dwordx4 v[40:43], v3, s[8:11], s40 offen offset:2048 sc1
    buffer_load_dwordx4 v[44:47], v3, s[8:11], s40 offen offset:3072 sc1
    s_add_u32 s33, s33, 1
    s_cmp_gt_u32 s33, 0x100000
    s_cbranch_scc1 chain_kernel_abort
    s_nop 5
    v_mov_b32 v76, 0
    v_mov_b32 v77, 0
    v_mov_b32 v78, 0
    v_mov_b32 v79, 0
    s_branch Go_19_s0123
Go_19_s1230:
    s_waitcnt vmcnt(3)
    v_cmp_eq_u32 vcc, -1, v36
    v_mov_b32_dpp v52, v36 row_ror:8 row_mask:0xf bank_mask:0xf
    v_mov_b32_dpp v53, v37 row_ror:8 row_mask:0xf bank_mask:0xf
    v_mov_b32_dpp v54, v38 row_ror:8 row_mask:0xf bank_mask:0xf
    v_mov_b32_dpp v55, v39 row_ror:8 row_mask:0xf bank_mask:0xf
    s_cbranch_vccnz Go_19_f1230
    v_smfmac_f32_16x16x64_bf16 v[76:79], v[36:39], a[200:207], v19
    v_smfmac_f32_16x16x64_bf16 v[76:79], v[52:55], a[232:239], v19
Go_19_s230:
    s_waitcnt vmcnt(2)
    v_cmp_eq_u32 vcc, -1, v40
    v_mov_b32_dpp v56, v40 row_ror:8 row_mask:0xf bank_mask:0xf
    v_mov_b32_dpp v57, v41 row_ror:8 row_mask:0xf bank_mask:0xf
    v_mov_b32_dpp v58, v42 row_ror:8 row_mask:0xf bank_mask:0xf
    v_mov_b32_dpp v59, v43 row_ror:8 row_mask:0xf bank_mask:0xf
    s_cbranch_vccnz Go_19_f230
    v_smfmac_f32_16x16x64_bf16 v[76:79], v[40:43], a[208:215], v19
    v_smfmac_f32_16x16x64_bf16 v[76:79], v[56:59], a[240:247], v19
Go_19_s30:
    s_waitcnt vmcnt(1)
    v_cmp_eq_u32 vcc, -1, v44
    v_mov_b32_dpp v60, v44 row_ror:8 row_mask:0xf bank_mask:0xf
    v_mov_b32_dpp v61, v45 row_ror:8 row_mask:0xf bank_mask:0xf
    v_mov_b32_dpp v62, v46 row_ror:8 row_mask:0xf bank_mask:0xf
    v_mov_b32_dpp v63, v47 row_ror:8 row_mask:0xf bank_mask:0xf
    s_cbranch_vccnz Go_19_f30
    v_smfmac_f32_16x16x64_bf16 v[76:79], v[44:47], a[216:223], v19
    v_smfmac_f32_16x16x64_bf16 v[76:79], v[60:63], a[248:255], v19
Go_19_s0:
    s_waitcnt vmcnt(0)
    v_cmp_eq_u32 vcc, -1, v32
    v_mov_b32_dpp v48, v32 row_ror:8 row_mask:0xf bank_mask:0xf
    v_mov_b32_dpp v49, v33 row_ror:8 row_mask:0xf bank_mask:0xf
    v_mov_b32_dpp v50, v34 row_ror:8 row_mask:0xf bank_mask:0xf
    v_mov_b32_dpp v51, v35 row_ror:8 row_mask:0xf bank_mask:0xf
    s_cbranch_vccnz Go_19_f0
    v_smfmac_f32_16x16x64_bf16 v[76:79], v[32:35], a[192:199], v19
    v_smfmac_f32_16x16x64_bf16 v[76:79], v[48:51], a[224:231], v19
    s_branch Go_19_done
Go_19_f1230:
    buffer_load_dwordx4 v[36:39], v3, s[8:11], s40 offen offset:1024 sc1
    s_add_u32 s33, s33, 1
    s_cmp_gt_u32 s33, 0x100000
    s_cbranch_scc1 chain_kernel_abort
    s_branch Go_19_s2301
Go_19_f230:
    buffer_load_dwordx4 v[40:43], v3, s[8:11], s40 offen offset:2048 sc1
    s_add_u32 s33, s33, 1
    s_cmp_gt_u32 s33, 0x100000
    s_cbranch_scc1 chain_kernel_abort
    s_branch Go_19_s302
Go_19_f30:
    buffer_load_dwordx4 v[44:47], v3, s[8:11], s40 offen offset:3072 sc1
    s_add_u32 s33, s33, 1
    s_cmp_gt_u32 s33, 0x100000
    s_cbranch_scc1 chain_kernel_abort
    s_branch Go_19_s03
Go_19_f0:
    buffer_load_dwordx4 v[32:35], v3, s[8:11], s40 offen offset:0 sc1
    s_add_u32 s33, s33, 1
    s_cmp_gt_u32 s33, 0x100000
    s_cbranch_scc1 chain_kernel_abort
    s_branch Go_19_s0
Go_19_s231:
    s_waitcnt vmcnt(2)
    v_cmp_eq_u32 vcc, -1, v40
    v_mov_b32_dpp v56, v40 row_ror:8 row_mask:0xf bank_mask:0xf
    v_mov_b32_dpp v57, v41 row_ror:8 row_mask:0xf bank_mask:0xf
    v_mov_b32_dpp v58, v42 row_ror:8 row_mask:0xf bank_mask:0xf
    v_mov_b32_dpp v59, v43 row_ror:8 row_mask:0xf bank_mask:0xf
    s_cbranch_vccnz Go_19_f231
    v_smfmac_f32_16x16x64_bf16 v[76:79], v[40:43], a[208:215], v19
    v_smfmac_f32_16x16x64_bf16 v[76:79], v[56:59], a[240:247], v19
Go_19_s31:
    s_waitcnt vmcnt(1)
    v_cmp_eq_u32 vcc, -1, v44
    v_mov_b32_dpp v60, v44 row_ror:8 row_mask:0xf bank_mask:0xf
    v_mov_b32_dpp v61, v45 row_ror:8 row_mask:0xf bank_mask:0xf
    v_mov_b32_dpp v62, v46 row_ror:8 row_mask:0xf bank_mask:0xf
    v_mov_b32_dpp v63, v47 row_ror:8 row_mask:0xf bank_mask:0xf
    s_cbranch_vccnz Go_19_f31
    v_smfmac_f32_16x16x64_bf16 v[76:79], v[44:47], a[216:223], v19
    v_smfmac_f32_16x16x64_bf16 v[76:79], v[60:63], a[248:255], v19
Go_19_s1:
    s_waitcnt vmcnt(0)
    v_cmp_eq_u32 vcc, -1, v36
    v_mov_b32_dpp v52, v36 row_ror:8 row_mask:0xf bank_mask:0xf
    v_mov_b32_dpp v53, v37 row_ror:8 row_mask:0xf bank_mask:0xf
    v_mov_b32_dpp v54, v38 row_ror:8 row_mask:0xf bank_mask:0xf
    v_mov_b32_dpp v55, v39 row_ror:8 row_mask:0xf bank_mask:0xf
    s_cbranch_vccnz Go_19_f1
    v_smfmac_f32_16x16x64_bf16 v[76:79], v[36:39], a[200:207], v19
    v_smfmac_f32_16x16x64_bf16 v[76:79], v[52:55], a[232:239], v19
    s_branch Go_19_done
Go_19_f231:
    buffer_load_dwordx4 v[40:43], v3, s[8:11], s40 offen offset:2048 sc1
    s_add_u32 s33, s33, 1
    s_cmp_gt_u32 s33, 0x100000
    s_cbranch_scc1 chain_kernel_abort
    s_branch Go_19_s312
Go_19_f31:
    buffer_load_dwordx4 v[44:47], v3, s[8:11], s40 offen offset:3072 sc1
    s_add_u32 s33, s33, 1
    s_cmp_gt_u32 s33, 0x100000
    s_cbranch_scc1 chain_kernel_abort
    s_branch Go_19_s13
Go_19_f1:
    buffer_load_dwordx4 v[36:39], v3, s[8:11], s40 offen offset:1024 sc1
    s_add_u32 s33, s33, 1
    s_cmp_gt_u32 s33, 0x100000
    s_cbranch_scc1 chain_kernel_abort
    s_branch Go_19_s1
Go_19_s32:
    s_waitcnt vmcnt(1)
    v_cmp_eq_u32 vcc, -1, v44
    v_mov_b32_dpp v60, v44 row_ror:8 row_mask:0xf bank_mask:0xf
    v_mov_b32_dpp v61, v45 row_ror:8 row_mask:0xf bank_mask:0xf
    v_mov_b32_dpp v62, v46 row_ror:8 row_mask:0xf bank_mask:0xf
    v_mov_b32_dpp v63, v47 row_ror:8 row_mask:0xf bank_mask:0xf
    s_cbranch_vccnz Go_19_f32
    v_smfmac_f32_16x16x64_bf16 v[76:79], v[44:47], a[216:223], v19
    v_smfmac_f32_16x16x64_bf16 v[76:79], v[60:63], a[248:255], v19
Go_19_s2:
    s_waitcnt vmcnt(0)
    v_cmp_eq_u32 vcc, -1, v40
    v_mov_b32_dpp v56, v40 row_ror:8 row_mask:0xf bank_mask:0xf
    v_mov_b32_dpp v57, v41 row_ror:8 row_mask:0xf bank_mask:0xf
    v_mov_b32_dpp v58, v42 row_ror:8 row_mask:0xf bank_mask:0xf
    v_mov_b32_dpp v59, v43 row_ror:8 row_mask:0xf bank_mask:0xf
    s_cbranch_vccnz Go_19_f2
    v_smfmac_f32_16x16x64_bf16 v[76:79], v[40:43], a[208:215], v19
    v_smfmac_f32_16x16x64_bf16 v[76:79], v[56:59], a[240:247], v19
    s_branch Go_19_done
Go_19_f32:
    buffer_load_dwordx4 v[44:47], v3, s[8:11], s40 offen offset:3072 sc1
    s_add_u32 s33, s33, 1
    s_cmp_gt_u32 s33, 0x100000
    s_cbranch_scc1 chain_kernel_abort
    s_branch Go_19_s23
Go_19_f2:
    buffer_load_dwordx4 v[40:43], v3, s[8:11], s40 offen offset:2048 sc1
    s_add_u32 s33, s33, 1
    s_cmp_gt_u32 s33, 0x100000
    s_cbranch_scc1 chain_kernel_abort
    s_branch Go_19_s2
Go_19_s2301:
    s_waitcnt vmcnt(3)
    v_cmp_eq_u32 vcc, -1, v40
    v_mov_b32_dpp v56, v40 row_ror:8 row_mask:0xf bank_mask:0xf
    v_mov_b32_dpp v57, v41 row_ror:8 row_mask:0xf bank_mask:0xf
    v_mov_b32_dpp v58, v42 row_ror:8 row_mask:0xf bank_mask:0xf
    v_mov_b32_dpp v59, v43 row_ror:8 row_mask:0xf bank_mask:0xf
    s_cbranch_vccnz Go_19_f2301
    v_smfmac_f32_16x16x64_bf16 v[76:79], v[40:43], a[208:215], v19
    v_smfmac_f32_16x16x64_bf16 v[76:79], v[56:59], a[240:247], v19
Go_19_s301:
    s_waitcnt vmcnt(2)
    v_cmp_eq_u32 vcc, -1, v44
    v_mov_b32_dpp v60, v44 row_ror:8 row_mask:0xf bank_mask:0xf
    v_mov_b32_dpp v61, v45 row_ror:8 row_mask:0xf bank_mask:0xf
    v_mov_b32_dpp v62, v46 row_ror:8 row_mask:0xf bank_mask:0xf
    v_mov_b32_dpp v63, v47 row_ror:8 row_mask:0xf bank_mask:0xf
    s_cbranch_vccnz Go_19_f301
    v_smfmac_f32_16x16x64_bf16 v[76:79], v[44:47], a[216:223], v19
    v_smfmac_f32_16x16x64_bf16 v[76:79], v[60:63], a[248:255], v19
Go_19_s01:
    s_waitcnt vmcnt(1)
    v_cmp_eq_u32 vcc, -1, v32
    v_mov_b32_dpp v48, v32 row_ror:8 row_mask:0xf bank_mask:0xf
    v_mov_b32_dpp v49, v33 row_ror:8 row_mask:0xf bank_mask:0xf
    v_mov_b32_dpp v50, v34 row_ror:8 row_mask:0xf bank_mask:0xf
    v_mov_b32_dpp v51, v35 row_ror:8 row_mask:0xf bank_mask:0xf
    s_cbranch_vccnz Go_19_f01
    v_smfmac_f32_16x16x64_bf16 v[76:79], v[32:35], a[192:199], v19
    v_smfmac_f32_16x16x64_bf16 v[76:79], v[48:51], a[224:231], v19
    s_branch Go_19_s1
Go_19_f2301:
    buffer_load_dwordx4 v[40:43], v3, s[8:11], s40 offen offset:2048 sc1
    s_add_u32 s33, s33, 1
    s_cmp_gt_u32 s33, 0x100000
    s_cbranch_scc1 chain_kernel_abort
    s_branch Go_19_s3012
Go_19_f301:
    buffer_load_dwordx4 v[44:47], v3, s[8:11], s40 offen offset:3072 sc1
    s_add_u32 s33, s33, 1
    s_cmp_gt_u32 s33, 0x100000
    s_cbranch_scc1 chain_kernel_abort
    s_branch Go_19_s013
Go_19_f01:
    buffer_load_dwordx4 v[32:35], v3, s[8:11], s40 offen offset:0 sc1
    s_add_u32 s33, s33, 1
    s_cmp_gt_u32 s33, 0x100000
    s_cbranch_scc1 chain_kernel_abort
    s_branch Go_19_s10
Go_19_s302:
    s_waitcnt vmcnt(2)
    v_cmp_eq_u32 vcc, -1, v44
    v_mov_b32_dpp v60, v44 row_ror:8 row_mask:0xf bank_mask:0xf
    v_mov_b32_dpp v61, v45 row_ror:8 row_mask:0xf bank_mask:0xf
    v_mov_b32_dpp v62, v46 row_ror:8 row_mask:0xf bank_mask:0xf
    v_mov_b32_dpp v63, v47 row_ror:8 row_mask:0xf bank_mask:0xf
    s_cbranch_vccnz Go_19_f302
    v_smfmac_f32_16x16x64_bf16 v[76:79], v[44:47], a[216:223], v19
    v_smfmac_f32_16x16x64_bf16 v[76:79], v[60:63], a[248:255], v19
Go_19_s02:
    s_waitcnt vmcnt(1)
    v_cmp_eq_u32 vcc, -1, v32
    v_mov_b32_dpp v48, v32 row_ror:8 row_mask:0xf bank_mask:0xf
    v_mov_b32_dpp v49, v33 row_ror:8 row_mask:0xf bank_mask:0xf
    v_mov_b32_dpp v50, v34 row_ror:8 row_mask:0xf bank_mask:0xf
    v_mov_b32_dpp v51, v35 row_ror:8 row_mask:0xf bank_mask:0xf
    s_cbranch_vccnz Go_19_f02
    v_smfmac_f32_16x16x64_bf16 v[76:79], v[32:35], a[192:199], v19
    v_smfmac_f32_16x16x64_bf16 v[76:79], v[48:51], a[224:231], v19
    s_branch Go_19_s2
Go_19_f302:
    buffer_load_dwordx4 v[44:47], v3, s[8:11], s40 offen offset:3072 sc1
    s_add_u32 s33, s33, 1
    s_cmp_gt_u32 s33, 0x100000
    s_cbranch_scc1 chain_kernel_abort
    s_branch Go_19_s023
Go_19_f02:
    buffer_load_dwordx4 v[32:35], v3, s[8:11], s40 offen offset:0 sc1
    s_add_u32 s33, s33, 1
    s_cmp_gt_u32 s33, 0x100000
    s_cbranch_scc1 chain_kernel_abort
    s_branch Go_19_s20
Go_19_s03:
    s_waitcnt vmcnt(1)
    v_cmp_eq_u32 vcc, -1, v32
    v_mov_b32_dpp v48, v32 row_ror:8 row_mask:0xf bank_mask:0xf
    v_mov_b32_dpp v49, v33 row_ror:8 row_mask:0xf bank_mask:0xf
    v_mov_b32_dpp v50, v34 row_ror:8 row_mask:0xf bank_mask:0xf
    v_mov_b32_dpp v51, v35 row_ror:8 row_mask:0xf bank_mask:0xf
    s_cbranch_vccnz Go_19_f03
    v_smfmac_f32_16x16x64_bf16 v[76:79], v[32:35], a[192:199], v19
    v_smfmac_f32_16x16x64_bf16 v[76:79], v[48:51], a[224:231], v19
    s_branch Go_19_s3
Go_19_f03:
    buffer_load_dwordx4 v[32:35], v3, s[8:11], s40 offen offset:0 sc1
    s_add_u32 s33, s33, 1
    s_cmp_gt_u32 s33, 0x100000
    s_cbranch_scc1 chain_kernel_abort
    s_branch Go_19_s30
Go_19_s312:
    s_waitcnt vmcnt(2)
    v_cmp_eq_u32 vcc, -1, v44
    v_mov_b32_dpp v60, v44 row_ror:8 row_mask:0xf bank_mask:0xf
    v_mov_b32_dpp v61, v45 row_ror:8 row_mask:0xf bank_mask:0xf
    v_mov_b32_dpp v62, v46 row_ror:8 row_mask:0xf bank_mask:0xf
    v_mov_b32_dpp v63, v47 row_ror:8 row_mask:0xf bank_mask:0xf
    s_cbranch_vccnz Go_19_f312
    v_smfmac_f32_16x16x64_bf16 v[76:79], v[44:47], a[216:223], v19
    v_smfmac_f32_16x16x64_bf16 v[76:79], v[60:63], a[248:255], v19
Go_19_s12:
    s_waitcnt vmcnt(1)
    v_cmp_eq_u32 vcc, -1, v36
    v_mov_b32_dpp v52, v36 row_ror:8 row_mask:0xf bank_mask:0xf
    v_mov_b32_dpp v53, v37 row_ror:8 row_mask:0xf bank_mask:0xf
    v_mov_b32_dpp v54, v38 row_ror:8 row_mask:0xf bank_mask:0xf
    v_mov_b32_dpp v55, v39 row_ror:8 row_mask:0xf bank_mask:0xf
    s_cbranch_vccnz Go_19_f12
    v_smfmac_f32_16x16x64_bf16 v[76:79], v[36:39], a[200:207], v19
    v_smfmac_f32_16x16x64_bf16 v[76:79], v[52:55], a[232:239], v19
    s_branch Go_19_s2
Go_19_f312:
    buffer_load_dwordx4 v[44:47], v3, s[8:11], s40 offen offset:3072 sc1
    s_add_u32 s33, s33, 1
    s_cmp_gt_u32 s33, 0x100000
    s_cbranch_scc1 chain_kernel_abort
    s_branch Go_19_s123
Go_19_f12:
    buffer_load_dwordx4 v[36:39], v3, s[8:11], s40 offen offset:1024 sc1
    s_add_u32 s33, s33, 1
    s_cmp_gt_u32 s33, 0x100000
    s_cbranch_scc1 chain_kernel_abort
    s_branch Go_19_s21
Go_19_s13:
    s_waitcnt vmcnt(1)
    v_cmp_eq_u32 vcc, -1, v36
    v_mov_b32_dpp v52, v36 row_ror:8 row_mask:0xf bank_mask:0xf
    v_mov_b32_dpp v53, v37 row_ror:8 row_mask:0xf bank_mask:0xf
    v_mov_b32_dpp v54, v38 row_ror:8 row_mask:0xf bank_mask:0xf
    v_mov_b32_dpp v55, v39 row_ror:8 row_mask:0xf bank_mask:0xf
    s_cbranch_vccnz Go_19_f13
    v_smfmac_f32_16x16x64_bf16 v[76:79], v[36:39], a[200:207], v19
    v_smfmac_f32_16x16x64_bf16 v[76:79], v[52:55], a[232:239], v19
    s_branch Go_19_s3
Go_19_f13:
    buffer_load_dwordx4 v[36:39], v3, s[8:11], s40 offen offset:1024 sc1
    s_add_u32 s33, s33, 1
    s_cmp_gt_u32 s33, 0x100000
    s_cbranch_scc1 chain_kernel_abort
    s_branch Go_19_s31
Go_19_s3012:
    s_waitcnt vmcnt(3)
    v_cmp_eq_u32 vcc, -1, v44
    v_mov_b32_dpp v60, v44 row_ror:8 row_mask:0xf bank_mask:0xf
    v_mov_b32_dpp v61, v45 row_ror:8 row_mask:0xf bank_mask:0xf
    v_mov_b32_dpp v62, v46 row_ror:8 row_mask:0xf bank_mask:0xf
    v_mov_b32_dpp v63, v47 row_ror:8 row_mask:0xf bank_mask:0xf
    s_cbranch_vccnz Go_19_f3012
    v_smfmac_f32_16x16x64_bf16 v[76:79], v[44:47], a[216:223], v19
    v_smfmac_f32_16x16x64_bf16 v[76:79], v[60:63], a[248:255], v19
Go_19_s012:
    s_waitcnt vmcnt(2)
    v_cmp_eq_u32 vcc, -1, v32
    v_mov_b32_dpp v48, v32 row_ror:8 row_mask:0xf bank_mask:0xf
    v_mov_b32_dpp v49, v33 row_ror:8 row_mask:0xf bank_mask:0xf
    v_mov_b32_dpp v50, v34 row_ror:8 row_mask:0xf bank_mask:0xf
    v_mov_b32_dpp v51, v35 row_ror:8 row_mask:0xf bank_mask:0xf
    s_cbranch_vccnz Go_19_f012
    v_smfmac_f32_16x16x64_bf16 v[76:79], v[32:35], a[192:199], v19
    v_smfmac_f32_16x16x64_bf16 v[76:79], v[48:51], a[224:231], v19
    s_branch Go_19_s12
Go_19_f3012:
    buffer_load_dwordx4 v[44:47], v3, s[8:11], s40 offen offset:3072 sc1
    s_add_u32 s33, s33, 1
    s_cmp_gt_u32 s33, 0x100000
    s_cbranch_scc1 chain_kernel_abort
    s_branch Go_19_s0123
Go_19_f012:
    buffer_load_dwordx4 v[32:35], v3, s[8:11], s40 offen offset:0 sc1
    s_add_u32 s33, s33, 1
    s_cmp_gt_u32 s33, 0x100000
    s_cbranch_scc1 chain_kernel_abort
    s_branch Go_19_s120
Go_19_s013:
    s_waitcnt vmcnt(2)
    v_cmp_eq_u32 vcc, -1, v32
    v_mov_b32_dpp v48, v32 row_ror:8 row_mask:0xf bank_mask:0xf
    v_mov_b32_dpp v49, v33 row_ror:8 row_mask:0xf bank_mask:0xf
    v_mov_b32_dpp v50, v34 row_ror:8 row_mask:0xf bank_mask:0xf
    v_mov_b32_dpp v51, v35 row_ror:8 row_mask:0xf bank_mask:0xf
    s_cbranch_vccnz Go_19_f013
    v_smfmac_f32_16x16x64_bf16 v[76:79], v[32:35], a[192:199], v19
    v_smfmac_f32_16x16x64_bf16 v[76:79], v[48:51], a[224:231], v19
    s_branch Go_19_s13
Go_19_f013:
    buffer_load_dwordx4 v[32:35], v3, s[8:11], s40 offen offset:0 sc1
    s_add_u32 s33, s33, 1
    s_cmp_gt_u32 s33, 0x100000
    s_cbranch_scc1 chain_kernel_abort
    s_branch Go_19_s130
Go_19_s10:
    s_waitcnt vmcnt(1)
    v_cmp_eq_u32 vcc, -1, v36
    v_mov_b32_dpp v52, v36 row_ror:8 row_mask:0xf bank_mask:0xf
    v_mov_b32_dpp v53, v37 row_ror:8 row_mask:0xf bank_mask:0xf
    v_mov_b32_dpp v54, v38 row_ror:8 row_mask:0xf bank_mask:0xf
    v_mov_b32_dpp v55, v39 row_ror:8 row_mask:0xf bank_mask:0xf
    s_cbranch_vccnz Go_19_f10
    v_smfmac_f32_16x16x64_bf16 v[76:79], v[36:39], a[200:207], v19
    v_smfmac_f32_16x16x64_bf16 v[76:79], v[52:55], a[232:239], v19
    s_branch Go_19_s0
Go_19_f10:
    buffer_load_dwordx4 v[36:39], v3, s[8:11], s40 offen offset:1024 sc1
    s_add_u32 s33, s33, 1
    s_cmp_gt_u32 s33, 0x100000
    s_cbranch_scc1 chain_kernel_abort
    s_branch Go_19_s01
Go_19_s023:
    s_waitcnt vmcnt(2)
    v_cmp_eq_u32 vcc, -1, v32
    v_mov_b32_dpp v48, v32 row_ror:8 row_mask:0xf bank_mask:0xf
    v_mov_b32_dpp v49, v33 row_ror:8 row_mask:0xf bank_mask:0xf
    v_mov_b32_dpp v50, v34 row_ror:8 row_mask:0xf bank_mask:0xf
    v_mov_b32_dpp v51, v35 row_ror:8 row_mask:0xf bank_mask:0xf
    s_cbranch_vccnz Go_19_f023
    v_smfmac_f32_16x16x64_bf16 v[76:79], v[32:35], a[192:199], v19
    v_smfmac_f32_16x16x64_bf16 v[76:79], v[48:51], a[224:231], v19
    s_branch Go_19_s23
Go_19_f023:
    buffer_load_dwordx4 v[32:35], v3, s[8:11], s40 offen offset:0 sc1
    s_add_u32 s33, s33, 1
    s_cmp_gt_u32 s33, 0x100000
    s_cbranch_scc1 chain_kernel_abort
    s_branch Go_19_s230
Go_19_s20:
    s_waitcnt vmcnt(1)
    v_cmp_eq_u32 vcc, -1, v40
    v_mov_b32_dpp v56, v40 row_ror:8 row_mask:0xf bank_mask:0xf
    v_mov_b32_dpp v57, v41 row_ror:8 row_mask:0xf bank_mask:0xf
    v_mov_b32_dpp v58, v42 row_ror:8 row_mask:0xf bank_mask:0xf
    v_mov_b32_dpp v59, v43 row_ror:8 row_mask:0xf bank_mask:0xf
    s_cbranch_vccnz Go_19_f20
    v_smfmac_f32_16x16x64_bf16 v[76:79], v[40:43], a[208:215], v19
    v_smfmac_f32_16x16x64_bf16 v[76:79], v[56:59], a[240:247], v19
    s_branch Go_19_s0
Go_19_f20:
    buffer_load_dwordx4 v[40:43], v3, s[8:11], s40 offen offset:2048 sc1
    s_add_u32 s33, s33, 1
    s_cmp_gt_u32 s33, 0x100000
    s_cbranch_scc1 chain_kernel_abort
    s_branch Go_19_s02
Go_19_s21:
    s_waitcnt vmcnt(1)
    v_cmp_eq_u32 vcc, -1, v40
    v_mov_b32_dpp v56, v40 row_ror:8 row_mask:0xf bank_mask:0xf
    v_mov_b32_dpp v57, v41 row_ror:8 row_mask:0xf bank_mask:0xf
    v_mov_b32_dpp v58, v42 row_ror:8 row_mask:0xf bank_mask:0xf
    v_mov_b32_dpp v59, v43 row_ror:8 row_mask:0xf bank_mask:0xf
    s_cbranch_vccnz Go_19_f21
    v_smfmac_f32_16x16x64_bf16 v[76:79], v[40:43], a[208:215], v19
    v_smfmac_f32_16x16x64_bf16 v[76:79], v[56:59], a[240:247], v19
    s_branch Go_19_s1
Go_19_f21:
    buffer_load_dwordx4 v[40:43], v3, s[8:11], s40 offen offset:2048 sc1
    s_add_u32 s33, s33, 1
    s_cmp_gt_u32 s33, 0x100000
    s_cbranch_scc1 chain_kernel_abort
    s_branch Go_19_s12
Go_19_s120:
    s_waitcnt vmcnt(2)
    v_cmp_eq_u32 vcc, -1, v36
    v_mov_b32_dpp v52, v36 row_ror:8 row_mask:0xf bank_mask:0xf
    v_mov_b32_dpp v53, v37 row_ror:8 row_mask:0xf bank_mask:0xf
    v_mov_b32_dpp v54, v38 row_ror:8 row_mask:0xf bank_mask:0xf
    v_mov_b32_dpp v55, v39 row_ror:8 row_mask:0xf bank_mask:0xf
    s_cbranch_vccnz Go_19_f120
    v_smfmac_f32_16x16x64_bf16 v[76:79], v[36:39], a[200:207], v19
    v_smfmac_f32_16x16x64_bf16 v[76:79], v[52:55], a[232:239], v19
    s_branch Go_19_s20
Go_19_f120:
    buffer_load_dwordx4 v[36:39], v3, s[8:11], s40 offen offset:1024 sc1
    s_add_u32 s33, s33, 1
    s_cmp_gt_u32 s33, 0x100000
    s_cbranch_scc1 chain_kernel_abort
    s_branch Go_19_s201
Go_19_s130:
    s_waitcnt vmcnt(2)
    v_cmp_eq_u32 vcc, -1, v36
    v_mov_b32_dpp v52, v36 row_ror:8 row_mask:0xf bank_mask:0xf
    v_mov_b32_dpp v53, v37 row_ror:8 row_mask:0xf bank_mask:0xf
    v_mov_b32_dpp v54, v38 row_ror:8 row_mask:0xf bank_mask:0xf
    v_mov_b32_dpp v55, v39 row_ror:8 row_mask:0xf bank_mask:0xf
    s_cbranch_vccnz Go_19_f130
    v_smfmac_f32_16x16x64_bf16 v[76:79], v[36:39], a[200:207], v19
    v_smfmac_f32_16x16x64_bf16 v[76:79], v[52:55], a[232:239], v19
    s_branch Go_19_s30
Go_19_f130:
    buffer_load_dwordx4 v[36:39], v3, s[8:11], s40 offen offset:1024 sc1
    s_add_u32 s33, s33, 1
    s_cmp_gt_u32 s33, 0x100000
    s_cbranch_scc1 chain_kernel_abort
    s_branch Go_19_s301
Go_19_s201:
    s_waitcnt vmcnt(2)
    v_cmp_eq_u32 vcc, -1, v40
    v_mov_b32_dpp v56, v40 row_ror:8 row_mask:0xf bank_mask:0xf
    v_mov_b32_dpp v57, v41 row_ror:8 row_mask:0xf bank_mask:0xf
    v_mov_b32_dpp v58, v42 row_ror:8 row_mask:0xf bank_mask:0xf
    v_mov_b32_dpp v59, v43 row_ror:8 row_mask:0xf bank_mask:0xf
    s_cbranch_vccnz Go_19_f201
    v_smfmac_f32_16x16x64_bf16 v[76:79], v[40:43], a[208:215], v19
    v_smfmac_f32_16x16x64_bf16 v[76:79], v[56:59], a[240:247], v19
    s_branch Go_19_s01
Go_19_f201:
    buffer_load_dwordx4 v[40:43], v3, s[8:11], s40 offen offset:2048 sc1
    s_add_u32 s33, s33, 1
    s_cmp_gt_u32 s33, 0x100000
    s_cbranch_scc1 chain_kernel_abort
    s_branch Go_19_s012
L_pf_26:
    s_mov_b64 exec, -1
    buffer_load_dword v220, v9, s[8:11], s43 offen sc1
    buffer_load_dword v221, v10, s[8:11], s43 offen sc1
    buffer_load_dword v222, v11, s[8:11], s43 offen sc1
    s_add_u32 s33, s33, 1
    s_cmp_gt_u32 s33, 0x100000
    s_cbranch_scc1 chain_kernel_abort
    s_branch L_pb1_24
L_pb1_24:
    s_waitcnt vmcnt(7)
    v_add_f32 v208, v80, v223
    s_waitcnt vmcnt(5)
    v_add_f32 v209, v224, v225
    v_max3_u32 v20, v223, v224, v225
    v_add_f32 v208, v208, v209
    v_cmp_eq_u32 vcc, -1, v20
    s_nop 0
    v_mov_b32_dpp v209, v208 quad_perm:[1,0,3,2] row_mask:0xf bank_mask:0xf
    s_mov_b64 exec, s[26:27]
    v_cvt_pk_bf16_f32 v208, v208, v209
    v_min_u32 v208, 0xfffffffe, v208
    s_cbranch_vccnz L_pf_27
    s_branch L_pd_25
L_pf_27:
    s_mov_b64 exec, -1
    buffer_load_dword v223, v9, s[8:11], s44 offen sc1
    buffer_load_dword v224, v10, s[8:11], s44 offen sc1
    buffer_load_dword v225, v11, s[8:11], s44 offen sc1
    s_add_u32 s33, s33, 1
    s_cmp_gt_u32 s33, 0x100000
    s_cbranch_scc1 chain_kernel_abort
    s_branch L_pa_22
L_pa_22:
    s_waitcnt vmcnt(5)
    v_add_f32 v208, v80, v220
    s_waitcnt vmcnt(3)
    v_add_f32 v209, v221, v222
    v_max3_u32 v20, v220, v221, v222
    v_add_f32 v208, v208, v209
    v_cmp_eq_u32 vcc, -1, v20
    s_nop 0
    v_mov_b32_dpp v209, v208 quad_perm:[1,0,3,2] row_mask:0xf bank_mask:0xf
    s_mov_b64 exec, s[26:27]
    v_cvt_pk_bf16_f32 v208, v208, v209
    v_min_u32 v208, 0xfffffffe, v208
    s_cbranch_vccnz L_pf_28
    s_branch L_pd_25
L_pf_28:
    s_mov_b64 exec, -1
    buffer_load_dword v220, v9, s[8:11], s43 offen sc1
    buffer_load_dword v221, v10, s[8:11], s43 offen sc1
    buffer_load_dword v222, v11, s[8:11], s43 offen sc1
    s_add_u32 s33, s33, 1
    s_cmp_gt_u32 s33, 0x100000
    s_cbranch_scc1 chain_kernel_abort
    s_branch L_pb_23
L_pb_23:
    s_waitcnt vmcnt(5)
    v_add_f32 v208, v80, v223
    s_waitcnt vmcnt(3)
    v_add_f32 v209, v224, v225
    v_max3_u32 v20, v223, v224, v225
    v_add_f32 v208, v208, v209
    v_cmp_eq_u32 vcc, -1, v20
    s_nop 0
    v_mov_b32_dpp v209, v208 quad_perm:[1,0,3,2] row_mask:0xf bank_mask:0xf
    s_mov_b64 exec, s[26:27]
    v_cvt_pk_bf16_f32 v208, v208, v209
    v_min_u32 v208, 0xfffffffe, v208
    s_cbranch_vccnz L_pf_29
    s_branch L_pd_25
L_pf_29:
    s_mov_b64 exec, -1
    buffer_load_dword v223, v9, s[8:11], s44 offen sc1
    buffer_load_dword v224, v10, s[8:11], s44 offen sc1
    buffer_load_dword v225, v11, s[8:11], s44 offen sc1
    s_add_u32 s33, s33, 1
    s_cmp_gt_u32 s33, 0x100000
    s_cbranch_scc1 chain_kernel_abort
    s_branch L_pa_22
chain_kernel_abort:
    s_mov_b32 s12, s98
    s_and_b32 s13, s99, 0xffff
    s_mov_b32 s14, 0x100
    s_mov_b32 s15, 0x00020000
    s_mov_b64 exec, 1
    v_mov_b32 v1, s19
    v_or_b32 v1, 0xdead0000, v1
    v_mov_b32 v2, 124
    buffer_store_dword v1, v2, s[12:15], 0 offen
chain_kernel_done:
    s_endpgm
chain_kernel_end:
    s_endpgm
chain_kernel_worker:
    s_sub_u32 s56, s16, 4
    s_mov_b32 s57, s17
    s_mov_b32 s58, s18
    s_cmp_eq_u32 s56, 0
    s_cbranch_scc1 L_big_41
    s_cmp_eq_u32 s56, 3
    s_cselect_b64 s[12:13], s[90:91], s[88:89]
    s_cmp_eq_u32 s56, 1
    s_cselect_b64 s[12:13], s[86:87], s[12:13]
    s_and_b32 s13, s13, 0xffff
    s_mov_b32 s14, 0x800000
    s_mov_b32 s15, 0x00020000
    s_lshl_b32 s28, s57, 8
    v_bfe_u32 v24, v0, 4, 3
    v_lshlrev_b32 v24, 1, v24
    v_and_b32 v25, 15, v0
    v_xor_b32 v24, v24, v25
    v_lshlrev_b32 v6, 4, v24
    v_bfe_u32 v24, v0, 4, 2
    v_lshl_add_u32 v6, v24, 13, v6
    v_bfe_u32 v24, v0, 6, 1
    v_lshl_add_u32 v6, v24, 16, v6
    v_bfe_u32 v24, v0, 7, 1
    v_lshl_add_u32 v6, v24, 15, v6
    s_and_b32 s60, s58, 1
    s_lshl_b32 s61, s60, 11
    s_lshr_b32 s60, s58, 1
    s_lshl_b32 s60, s60, 10
    s_add_u32 s32, s60, s61
    s_add_u32 m0, s32, 0
    s_add_u32 s61, s28, 0x0
    buffer_load_dwordx4 v6, s[12:15], s61 offen nt lds
    s_add_u32 m0, s32, 4096
    s_add_u32 s61, s28, 0x20000
    buffer_load_dwordx4 v6, s[12:15], s61 offen nt lds
    s_add_u32 m0, s32, 8192
    s_add_u32 s61, s28, 0x40000
    buffer_load_dwordx4 v6, s[12:15], s61 offen nt lds
    s_add_u32 m0, s32, 12288
    s_add_u32 s61, s28, 0x60000
    buffer_load_dwordx4 v6, s[12:15], s61 offen nt lds
    s_add_u32 m0, s32, 16384
    s_add_u32 s61, s28, 0x80000
    buffer_load_dwordx4 v6, s[12:15], s61 offen nt lds
    s_add_u32 m0, s32, 20480
    s_add_u32 s61, s28, 0xa0000
    buffer_load_dwordx4 v6, s[12:15], s61 offen nt lds
    s_add_u32 m0, s32, 24576
    s_add_u32 s61, s28, 0xc0000
    buffer_load_dwordx4 v6, s[12:15], s61 offen nt lds
    s_add_u32 m0, s32, 28672
    s_add_u32 s61, s28, 0xe0000
    buffer_load_dwordx4 v6, s[12:15], s61 offen nt lds
    s_mov_b32 s8, s82
    s_and_b32 s9, s83, 0xffff
    s_mov_b32 s10, 0x400000
    s_mov_b32 s11, 0x00020000
    s_mov_b32 s16, s100
    s_and_b32 s17, s101, 0xffff
    s_mov_b32 s18, 0xa000000
    s_mov_b32 s19, 0x00020000
    v_and_b32 v24, 63, v0
    v_lshlrev_b32 v1, 4, v24
    v_add_u32 v12, 4096, v1
    v_lshlrev_b32 v10, 7, v24
    s_lshl_b32 s27, s57, 13
    s_and_b32 s60, s58, 1
    s_lshl_b32 s60, s60, 18
    s_add_u32 s60, s60, s27
    buffer_load_dword v13, v10, s[8:11], s60 offen
    s_add_u32 s27, s27, 0x80000
    s_add_u32 m0, s32, 32768
    s_add_u32 s61, s28, 0x100000
    buffer_load_dwordx4 v6, s[12:15], s61 offen nt lds
    s_add_u32 m0, s32, 36864
    s_add_u32 s61, s28, 0x120000
    buffer_load_dwordx4 v6, s[12:15], s61 offen nt lds
    s_add_u32 m0, s32, 40960
    s_add_u32 s61, s28, 0x140000
    buffer_load_dwordx4 v6, s[12:15], s61 offen nt lds
    s_add_u32 m0, s32, 45056
    s_add_u32 s61, s28, 0x160000
    buffer_load_dwordx4 v6, s[12:15], s61 offen nt lds
    s_add_u32 m0, s32, 49152
    s_add_u32 s61, s28, 0x180000
    buffer_load_dwordx4 v6, s[12:15], s61 offen nt lds
    s_add_u32 m0, s32, 53248
    s_add_u32 s61, s28, 0x1a0000
    buffer_load_dwordx4 v6, s[12:15], s61 offen nt lds
    s_add_u32 m0, s32, 57344
    s_add_u32 s61, s28, 0x1c0000
    buffer_load_dwordx4 v6, s[12:15], s61 offen nt lds
    s_add_u32 m0, s32, 61440
    s_add_u32 s61, s28, 0x1e0000
    buffer_load_dwordx4 v6, s[12:15], s61 offen nt lds
    v_bfe_u32 v24, v0, 4, 3
    v_and_b32 v25, 7, v0
    v_xor_b32 v24, v24, v25
    v_lshlrev_b32 v2, 4, v24
    v_lshrrev_b32 v24, 3, v0
    v_lshl_add_u32 v2, v24, 11, v2
    v_bfe_u32 v24, v0, 1, 3
    v_bfe_u32 v25, v0, 4, 2
    v_xor_b32 v24, v24, v25
    v_lshlrev_b32 v4, 4, v24
    v_and_b32 v25, 15, v0
    v_lshl_add_u32 v4, v25, 7, v4
    v_add_u32 v4, 98304, v4
    v_xor_b32 v5, 64, v4
    s_add_u32 m0, s32, 65536
    s_add_u32 s61, s28, 0x200000
    buffer_load_dwordx4 v6, s[12:15], s61 offen nt lds
    s_add_u32 m0, s32, 69632
    s_add_u32 s61, s28, 0x220000
    buffer_load_dwordx4 v6, s[12:15], s61 offen nt lds
    s_add_u32 m0, s32, 73728
    s_add_u32 s61, s28, 0x240000
    buffer_load_dwordx4 v6, s[12:15], s61 offen nt lds
    s_add_u32 m0, s32, 77824
    s_add_u32 s61, s28, 0x260000
    buffer_load_dwordx4 v6, s[12:15], s61 offen nt lds
    s_add_u32 m0, s32, 81920
    s_add_u32 s61, s28, 0x280000
    buffer_load_dwordx4 v6, s[12:15], s61 offen nt lds
    s_add_u32 m0, s32, 86016
    s_add_u32 s61, s28, 0x2a0000
    buffer_load_dwordx4 v6, s[12:15], s61 offen nt lds
    s_add_u32 m0, s32, 90112
    s_add_u32 s61, s28, 0x2c0000
    buffer_load_dwordx4 v6, s[12:15], s61 offen nt lds
    s_add_u32 m0, s32, 94208
    s_add_u32 s61, s28, 0x2e0000
    buffer_load_dwordx4 v6, s[12:15], s61 offen nt lds
    v_bfe_u32 v24, v0, 2, 3
    v_lshrrev_b32 v25, 6, v0
    v_lshlrev_b32 v25, 1, v25
    v_xor_b32 v24, v24, v25
    v_lshlrev_b32 v8, 5, v24
    v_bfe_u32 v24, v0, 0, 2
    v_lshl_add_u32 v8, v24, 3, v8
    v_bfe_u32 v24, v0, 2, 2
    v_lshl_add_u32 v8, v24, 8, v8
    v_bfe_u32 v24, v0, 4, 2
    v_lshl_add_u32 v8, v24, 11, v8
    v_xor_b32 v9, 32, v8
    v_mov_b32 v28, -1
    v_mov_b32 v29, -1
    v_mov_b32 v30, -1
    v_mov_b32 v31, -1
    s_lshl_b32 s20, s58, 10
    s_add_u32 s20, s20, 98304
    s_mov_b32 s21, 98304
    s_mov_b32 s23, 0
    s_mov_b32 s29, 32768
    s_add_u32 m0, s32, 98304
    s_add_u32 s61, s28, 0x300000
    buffer_load_dwordx4 v6, s[12:15], s61 offen nt lds
    s_add_u32 m0, s32, 102400
    s_add_u32 s61, s28, 0x320000
    buffer_load_dwordx4 v6, s[12:15], s61 offen nt lds
    s_add_u32 m0, s32, 106496
    s_add_u32 s61, s28, 0x340000
    buffer_load_dwordx4 v6, s[12:15], s61 offen nt lds
    s_add_u32 m0, s32, 110592
    s_add_u32 s61, s28, 0x360000
    buffer_load_dwordx4 v6, s[12:15], s61 offen nt lds
    s_add_u32 m0, s32, 114688
    s_add_u32 s61, s28, 0x380000
    buffer_load_dwordx4 v6, s[12:15], s61 offen nt lds
    s_add_u32 m0, s32, 118784
    s_add_u32 s61, s28, 0x3a0000
    buffer_load_dwordx4 v6, s[12:15], s61 offen nt lds
    s_add_u32 m0, s32, 122880
    s_add_u32 s61, s28, 0x3c0000
    buffer_load_dwordx4 v6, s[12:15], s61 offen nt lds
    s_add_u32 m0, s32, 126976
    s_add_u32 s61, s28, 0x3e0000
    buffer_load_dwordx4 v6, s[12:15], s61 offen nt lds
    s_lshl_b32 s30, s57, 16
    s_cmp_eq_u32 s56, 3
    s_cselect_b32 s60, 11, 10
    s_cselect_b32 s61, 0x4000, 0
    s_lshl_b32 s60, s58, s60
    s_add_u32 s30, s30, s60
    s_add_u32 s30, s30, s61
    s_lshl_b32 s31, s57, 14
    s_lshr_b32 s61, s61, 2
    s_add_u32 s31, s31, s61
    s_lshl_b32 s60, s58, 10
    s_add_u32 s31, s31, s60
    s_add_u32 s31, s31, 0x8000000
    s_cmp_eq_u32 s56, 1
    s_cselect_b32 s31, 0xa000000, s31
    s_cselect_b32 s60, 0x8000, 0
    s_add_u32 s30, s30, s60
    s_add_u32 m0, s32, 131072
    s_add_u32 s61, s28, 0x400000
    buffer_load_dwordx4 v6, s[12:15], s61 offen nt lds
    s_add_u32 m0, s32, 135168
    s_add_u32 s61, s28, 0x420000
    buffer_load_dwordx4 v6, s[12:15], s61 offen nt lds
    s_add_u32 m0, s32, 139264
    s_add_u32 s61, s28, 0x440000
    buffer_load_dwordx4 v6, s[12:15], s61 offen nt lds
    s_add_u32 m0, s32, 143360
    s_add_u32 s61, s28, 0x460000
    buffer_load_dwordx4 v6, s[12:15], s61 offen nt lds
    s_add_u32 m0, s32, 147456
    s_add_u32 s61, s28, 0x480000
    buffer_load_dwordx4 v6, s[12:15], s61 offen nt lds
    s_add_u32 m0, s32, 151552
    s_add_u32 s61, s28, 0x4a0000
    buffer_load_dwordx4 v6, s[12:15], s61 offen nt lds
    s_add_u32 m0, s32, 155648
    s_add_u32 s61, s28, 0x4c0000
    buffer_load_dwordx4 v6, s[12:15], s61 offen nt lds
    s_add_u32 m0, s32, 159744
    s_add_u32 s61, s28, 0x4e0000
    buffer_load_dwordx4 v6, s[12:15], s61 offen nt lds
    s_waitcnt vmcnt(33)
    s_barrier
    ds_read_b64_tr_b16 a[0:1], v8 offset:0
    ds_read_b64_tr_b16 a[2:3], v8 offset:1024
    ds_read_b64_tr_b16 a[4:5], v9 offset:0
    ds_read_b64_tr_b16 a[6:7], v9 offset:1024
    ds_read_b64_tr_b16 a[8:9], v8 offset:8192
    ds_read_b64_tr_b16 a[10:11], v8 offset:9216
    ds_read_b64_tr_b16 a[12:13], v9 offset:8192
    ds_read_b64_tr_b16 a[14:15], v9 offset:9216
    s_waitcnt lgkmcnt(0)
    ds_read_b64_tr_b16 a[16:17], v8 offset:16384
    ds_read_b64_tr_b16 a[18:19], v8 offset:17408
    ds_read_b64_tr_b16 a[20:21], v9 offset:16384
    ds_read_b64_tr_b16 a[22:23], v9 offset:17408
    ds_read_b64_tr_b16 a[24:25], v8 offset:24576
    ds_read_b64_tr_b16 a[26:27], v8 offset:25600
    ds_read_b64_tr_b16 a[28:29], v9 offset:24576
    ds_read_b64_tr_b16 a[30:31], v9 offset:25600
    s_waitcnt lgkmcnt(0)
    s_waitcnt vmcnt(24)
    s_barrier
    s_add_u32 m0, s32, 0
    s_add_u32 s61, s28, 0x500000
    buffer_load_dwordx4 v6, s[12:15], s61 offen nt lds
    s_add_u32 m0, s32, 4096
    s_add_u32 s61, s28, 0x520000
    buffer_load_dwordx4 v6, s[12:15], s61 offen nt lds
    s_add_u32 m0, s32, 8192
    s_add_u32 s61, s28, 0x540000
    buffer_load_dwordx4 v6, s[12:15], s61 offen nt lds
    s_add_u32 m0, s32, 12288
    s_add_u32 s61, s28, 0x560000
    buffer_load_dwordx4 v6, s[12:15], s61 offen nt lds
    s_add_u32 m0, s32, 16384
    s_add_u32 s61, s28, 0x580000
    buffer_load_dwordx4 v6, s[12:15], s61 offen nt lds
    s_add_u32 m0, s32, 20480
    s_add_u32 s61, s28, 0x5a0000
    buffer_load_dwordx4 v6, s[12:15], s61 offen nt lds
    s_add_u32 m0, s32, 24576
    s_add_u32 s61, s28, 0x5c0000
    buffer_load_dwordx4 v6, s[12:15], s61 offen nt lds
    s_add_u32 m0, s32, 28672
    s_add_u32 s61, s28, 0x5e0000
    buffer_load_dwordx4 v6, s[12:15], s61 offen nt lds
    ds_read_b64_tr_b16 a[32:33], v8 offset:32768
    ds_read_b64_tr_b16 a[34:35], v8 offset:33792
    ds_read_b64_tr_b16 a[36:37], v9 offset:32768
    ds_read_b64_tr_b16 a[38:39], v9 offset:33792
    ds_read_b64_tr_b16 a[40:41], v8 offset:40960
    ds_read_b64_tr_b16 a[42:43], v8 offset:41984
    ds_read_b64_tr_b16 a[44:45], v9 offset:40960
    ds_read_b64_tr_b16 a[46:47], v9 offset:41984
    s_waitcnt lgkmcnt(0)
    ds_read_b64_tr_b16 a[48:49], v8 offset:49152
    ds_read_b64_tr_b16 a[50:51], v8 offset:50176
    ds_read_b64_tr_b16 a[52:53], v9 offset:49152
    ds_read_b64_tr_b16 a[54:55], v9 offset:50176
    ds_read_b64_tr_b16 a[56:57], v8 offset:57344
    ds_read_b64_tr_b16 a[58:59], v8 offset:58368
    ds_read_b64_tr_b16 a[60:61], v9 offset:57344
    ds_read_b64_tr_b16 a[62:63], v9 offset:58368
    s_waitcnt lgkmcnt(0)
    s_waitcnt vmcnt(24)
    s_barrier
    s_add_u32 m0, s32, 32768
    s_add_u32 s61, s28, 0x600000
    buffer_load_dwordx4 v6, s[12:15], s61 offen nt lds
    s_add_u32 m0, s32, 36864
    s_add_u32 s61, s28, 0x620000
    buffer_load_dwordx4 v6, s[12:15], s61 offen nt lds
    s_add_u32 m0, s32, 40960
    s_add_u32 s61, s28, 0x640000
    buffer_load_dwordx4 v6, s[12:15], s61 offen nt lds
    s_add_u32 m0, s32, 45056
    s_add_u32 s61, s28, 0x660000
    buffer_load_dwordx4 v6, s[12:15], s61 offen nt lds
    s_add_u32 m0, s32, 49152
    s_add_u32 s61, s28, 0x680000
    buffer_load_dwordx4 v6, s[12:15], s61 offen nt lds
    s_add_u32 m0, s32, 53248
    s_add_u32 s61, s28, 0x6a0000
    buffer_load_dwordx4 v6, s[12:15], s61 offen nt lds
    s_add_u32 m0, s32, 57344
    s_add_u32 s61, s28, 0x6c0000
    buffer_load_dwordx4 v6, s[12:15], s61 offen nt lds
    s_add_u32 m0, s32, 61440
    s_add_u32 s61, s28, 0x6e0000
    buffer_load_dwordx4 v6, s[12:15], s61 offen nt lds
    v_add_u32 v8, 0x10000, v8
    v_add_u32 v9, 0x10000, v9
    ds_read_b64_tr_b16 a[64:65], v8 offset:0
    ds_read_b64_tr_b16 a[66:67], v8 offset:1024
    ds_read_b64_tr_b16 a[68:69], v9 offset:0
    ds_read_b64_tr_b16 a[70:71], v9 offset:1024
    ds_read_b64_tr_b16 a[72:73], v8 offset:8192
    ds_read_b64_tr_b16 a[74:75], v8 offset:9216
    ds_read_b64_tr_b16 a[76:77], v9 offset:8192
    ds_read_b64_tr_b16 a[78:79], v9 offset:9216
    s_waitcnt lgkmcnt(0)
    ds_read_b64_tr_b16 a[80:81], v8 offset:16384
    ds_read_b64_tr_b16 a[82:83], v8 offset:17408
    ds_read_b64_tr_b16 a[84:85], v9 offset:16384
    ds_read_b64_tr_b16 a[86:87], v9 offset:17408
    ds_read_b64_tr_b16 a[88:89], v8 offset:24576
    ds_read_b64_tr_b16 a[90:91], v8 offset:25600
    ds_read_b64_tr_b16 a[92:93], v9 offset:24576
    ds_read_b64_tr_b16 a[94:95], v9 offset:25600
    s_waitcnt lgkmcnt(0)
    s_waitcnt vmcnt(24)
    s_barrier
    s_add_u32 m0, s32, 65536
    s_add_u32 s61, s28, 0x700000
    buffer_load_dwordx4 v6, s[12:15], s61 offen nt lds
    s_add_u32 m0, s32, 69632
    s_add_u32 s61, s28, 0x720000
    buffer_load_dwordx4 v6, s[12:15], s61 offen nt lds
    s_add_u32 m0, s32, 73728
    s_add_u32 s61, s28, 0x740000
    buffer_load_dwordx4 v6, s[12:15], s61 offen nt lds
    s_add_u32 m0, s32, 77824
    s_add_u32 s61, s28, 0x760000
    buffer_load_dwordx4 v6, s[12:15], s61 offen nt lds
    s_add_u32 m0, s32, 81920
    s_add_u32 s61, s28, 0x780000
    buffer_load_dwordx4 v6, s[12:15], s61 offen nt lds
    s_add_u32 m0, s32, 86016
    s_add_u32 s61, s28, 0x7a0000
    buffer_load_dwordx4 v6, s[12:15], s61 offen nt lds
    s_add_u32 m0, s32, 90112
    s_add_u32 s61, s28, 0x7c0000
    buffer_load_dwordx4 v6, s[12:15], s61 offen nt lds
    s_add_u32 m0, s32, 94208
    s_add_u32 s61, s28, 0x7e0000
    buffer_load_dwordx4 v6, s[12:15], s61 offen nt lds
    v_mov_b32 v24, 4
    global_load_dword v11, v24, s[98:99] sc1
    s_or_b32 s60, s95, s58
    s_cbranch_scc1 L_rw_42
    s_lshl_b32 s62, s56, 3
    s_add_u32 s62, s62, 160
    s_mov_b32 s63, 0
L_rp_43:
    s_load_dwordx2 s[60:61], s[98:99], s62 glc
    s_add_u32 s63, s63, 1
    s_cmp_gt_u32 s63, 0x100000
    s_cbranch_scc1 chain_kernel_wabort
    s_waitcnt lgkmcnt(0)
    s_cmp_lt_u32 s61, 0x2000
    s_cbranch_scc1 L_rp_43
    s_lshr_b32 s61, s1, 8
    s_cmp_eq_u32 s60, -1
    s_cselect_b32 s0, -1, s61
L_rw_42:
    ds_read_b64_tr_b16 a[96:97], v8 offset:32768
    ds_read_b64_tr_b16 a[98:99], v8 offset:33792
    ds_read_b64_tr_b16 a[100:101], v9 offset:32768
    ds_read_b64_tr_b16 a[102:103], v9 offset:33792
    ds_read_b64_tr_b16 a[104:105], v8 offset:40960
    ds_read_b64_tr_b16 a[106:107], v8 offset:41984
    ds_read_b64_tr_b16 a[108:109], v9 offset:40960
    ds_read_b64_tr_b16 a[110:111], v9 offset:41984
    s_waitcnt lgkmcnt(0)
    ds_read_b64_tr_b16 a[112:113], v8 offset:49152
    ds_read_b64_tr_b16 a[114:115], v8 offset:50176
    ds_read_b64_tr_b16 a[116:117], v9 offset:49152
    ds_read_b64_tr_b16 a[118:119], v9 offset:50176
    ds_read_b64_tr_b16 a[120:121], v8 offset:57344
    ds_read_b64_tr_b16 a[122:123], v8 offset:58368
    ds_read_b64_tr_b16 a[124:125], v9 offset:57344
    ds_read_b64_tr_b16 a[126:127], v9 offset:58368
    s_waitcnt lgkmcnt(0)
    s_waitcnt vmcnt(24)
    s_barrier
    s_add_u32 m0, s20, 0
    s_nop 0
    buffer_load_dwordx4 v2, s[8:11], s23 offen offset:0 lds
    s_add_u32 m0, s20, 3968
    s_nop 0
    buffer_load_dwordx4 v2, s[8:11], s23 offen offset:128 lds
    s_add_u32 m0, s20, 7936
    s_nop 0
    buffer_load_dwordx4 v2, s[8:11], s23 offen offset:256 lds
    s_add_u32 m0, s20, 11904
    s_nop 0
    buffer_load_dwordx4 v2, s[8:11], s23 offen offset:384 lds
    s_add_u32 m0, s20, 15872
    s_nop 0
    buffer_load_dwordx4 v2, s[8:11], s23 offen offset:512 lds
    s_add_u32 m0, s20, 19840
    s_nop 0
    buffer_load_dwordx4 v2, s[8:11], s23 offen offset:640 lds
    s_add_u32 m0, s20, 23808
    s_nop 0
    buffer_load_dwordx4 v2, s[8:11], s23 offen offset:768 lds
    s_add_u32 m0, s20, 27776
    s_nop 0
    buffer_load_dwordx4 v2, s[8:11], s23 offen offset:896 lds
    s_add_u32 s23, s23, 1024
    s_bitcmp1_b32 s23, 11
    s_cselect_b32 s60, 0xf800, 0
    s_add_u32 s23, s23, s60
    s_add_u32 s20, s20, 32768
    s_cmp_ge_u32 s20, 163840
    s_cselect_b32 s60, 163840, 0
    s_sub_u32 s20, s20, s60
    v_add_u32 v8, 0x10000, v8
    v_add_u32 v9, 0x10000, v9
    ds_read_b64_tr_b16 a[128:129], v8 offset:0
    ds_read_b64_tr_b16 a[130:131], v8 offset:1024
    ds_read_b64_tr_b16 a[132:133], v9 offset:0
    ds_read_b64_tr_b16 a[134:135], v9 offset:1024
    ds_read_b64_tr_b16 a[136:137], v8 offset:8192
    ds_read_b64_tr_b16 a[138:139], v8 offset:9216
    ds_read_b64_tr_b16 a[140:141], v9 offset:8192
    ds_read_b64_tr_b16 a[142:143], v9 offset:9216
    s_waitcnt lgkmcnt(0)
    ds_read_b64_tr_b16 a[144:145], v8 offset:16384
    ds_read_b64_tr_b16 a[146:147], v8 offset:17408
    ds_read_b64_tr_b16 a[148:149], v9 offset:16384
    ds_read_b64_tr_b16 a[150:151], v9 offset:17408
    ds_read_b64_tr_b16 a[152:153], v8 offset:24576
    ds_read_b64_tr_b16 a[154:155], v8 offset:25600
    ds_read_b64_tr_b16 a[156:157], v9 offset:24576
    ds_read_b64_tr_b16 a[158:159], v9 offset:25600
    s_waitcnt lgkmcnt(0)
    s_waitcnt vmcnt(24)
    s_barrier
    s_add_u32 m0, s20, 0
    s_nop 0
    buffer_load_dwordx4 v2, s[8:11], s23 offen offset:0 lds
    s_add_u32 m0, s20, 3968
    s_nop 0
    buffer_load_dwordx4 v2, s[8:11], s23 offen offset:128 lds
    s_add_u32 m0, s20, 7936
    s_nop 0
    buffer_load_dwordx4 v2, s[8:11], s23 offen offset:256 lds
    s_add_u32 m0, s20, 11904
    s_nop 0
    buffer_load_dwordx4 v2, s[8:11], s23 offen offset:384 lds
    s_add_u32 m0, s20, 15872
    s_nop 0
    buffer_load_dwordx4 v2, s[8:11], s23 offen offset:512 lds
    s_add_u32 m0, s20, 19840
    s_nop 0
    buffer_load_dwordx4 v2, s[8:11], s23 offen offset:640 lds
    s_add_u32 m0, s20, 23808
    s_nop 0
    buffer_load_dwordx4 v2, s[8:11], s23 offen offset:768 lds
    s_add_u32 m0, s20, 27776
    s_nop 0
    buffer_load_dwordx4 v2, s[8:11], s23 offen offset:896 lds
    s_add_u32 s23, s23, 1024
    s_bitcmp1_b32 s23, 11
    s_cselect_b32 s60, 0xf800, 0
    s_add_u32 s23, s23, s60
    s_add_u32 s20, s20, 32768
    s_cmp_ge_u32 s20, 163840
    s_cselect_b32 s60, 163840, 0
    s_sub_u32 s20, s20, s60
    v_add_u32 v8, 0xfffe0000, v8
    v_add_u32 v9, 0xfffe0000, v9
    ds_read_b64_tr_b16 a[160:161], v8 offset:0
    ds_read_b64_tr_b16 a[162:163], v8 offset:1024
    ds_read_b64_tr_b16 a[164:165], v9 offset:0
    ds_read_b64_tr_b16 a[166:167], v9 offset:1024
    ds_read_b64_tr_b16 a[168:169], v8 offset:8192
    ds_read_b64_tr_b16 a[170:171], v8 offset:9216
    ds_read_b64_tr_b16 a[172:173], v9 offset:8192
    ds_read_b64_tr_b16 a[174:175], v9 offset:9216
    s_waitcnt lgkmcnt(0)
    ds_read_b64_tr_b16 a[176:177], v8 offset:16384
    ds_read_b64_tr_b16 a[178:179], v8 offset:17408
    ds_read_b64_tr_b16 a[180:181], v9 offset:16384
    ds_read_b64_tr_b16 a[182:183], v9 offset:17408
    ds_read_b64_tr_b16 a[184:185], v8 offset:24576
    ds_read_b64_tr_b16 a[186:187], v8 offset:25600
    ds_read_b64_tr_b16 a[188:189], v9 offset:24576
    ds_read_b64_tr_b16 a[190:191], v9 offset:25600
    s_waitcnt lgkmcnt(0)
    s_waitcnt vmcnt(24)
    s_barrier
    s_add_u32 m0, s20, 0
    s_nop 0
    buffer_load_dwordx4 v2, s[8:11], s23 offen offset:0 lds
    s_add_u32 m0, s20, 3968
    s_nop 0
    buffer_load_dwordx4 v2, s[8:11], s23 offen offset:128 lds
    s_add_u32 m0, s20, 7936
    s_nop 0
    buffer_load_dwordx4 v2, s[8:11], s23 offen offset:256 lds
    s_add_u32 m0, s20, 11904
    s_nop 0
    buffer_load_dwordx4 v2, s[8:11], s23 offen offset:384 lds
    s_add_u32 m0, s20, 15872
    s_nop 0
    buffer_load_dwordx4 v2, s[8:11], s23 offen offset:512 lds
    s_add_u32 m0, s20, 19840
    s_nop 0
    buffer_load_dwordx4 v2, s[8:11], s23 offen offset:640 lds
    s_add_u32 m0, s20, 23808
    s_nop 0
    buffer_load_dwordx4 v2, s[8:11], s23 offen offset:768 lds
    s_add_u32 m0, s20, 27776
    s_nop 0
    buffer_load_dwordx4 v2, s[8:11], s23 offen offset:896 lds
    s_add_u32 s23, s23, 1024
    s_bitcmp1_b32 s23, 11
    s_cselect_b32 s60, 0xf800, 0
    s_add_u32 s23, s23, s60
    s_add_u32 s20, s20, 32768
    s_cmp_ge_u32 s20, 163840
    s_cselect_b32 s60, 163840, 0
    s_sub_u32 s20, s20, s60
    ds_read_b64_tr_b16 a[192:193], v8 offset:32768
    ds_read_b64_tr_b16 a[194:195], v8 offset:33792
    ds_read_b64_tr_b16 a[196:197], v9 offset:32768
    ds_read_b64_tr_b16 a[198:199], v9 offset:33792
    ds_read_b64_tr_b16 a[200:201], v8 offset:40960
    ds_read_b64_tr_b16 a[202:203], v8 offset:41984
    ds_read_b64_tr_b16 a[204:205], v9 offset:40960
    ds_read_b64_tr_b16 a[206:207], v9 offset:41984
    s_waitcnt lgkmcnt(0)
    ds_read_b64_tr_b16 a[208:209], v8 offset:49152
    ds_read_b64_tr_b16 a[210:211], v8 offset:50176
    ds_read_b64_tr_b16 a[212:213], v9 offset:49152
    ds_read_b64_tr_b16 a[214:215], v9 offset:50176
    ds_read_b64_tr_b16 a[216:217], v8 offset:57344
    ds_read_b64_tr_b16 a[218:219], v8 offset:58368
    ds_read_b64_tr_b16 a[220:221], v9 offset:57344
    ds_read_b64_tr_b16 a[222:223], v9 offset:58368
    s_waitcnt lgkmcnt(0)
    s_waitcnt vmcnt(24)
    s_barrier
    s_cmp_lg_u32 s95, 0
    s_cbranch_scc1 L_rok_44
    v_mov_b32 v24, 32768
    s_cmp_lg_u32 s58, 0
    s_cbranch_scc1 L_rw_45
    v_mov_b32 v25, s0
    ds_write_b32 v24, v25
    s_waitcnt lgkmcnt(0)
L_rw_45:
    s_barrier
    ds_read_b32 v25, v24
    s_waitcnt lgkmcnt(0)
    v_readfirstlane_b32 s60, v25
    s_mov_b32 s95, 1
    s_cmp_eq_u32 s60, -1
    s_cbranch_scc1 L_rok_44
    s_mov_b32 s17, s60
    s_add_u32 s16, s56, 4
    s_mov_b32 s18, s58
    s_waitcnt vmcnt(0)
    s_barrier
    s_branch chain_kernel_roles
L_rok_44:
    v_add_u32 v8, 0x10000, v8
    v_add_u32 v9, 0x10000, v9
    ds_read_b64_tr_b16 a[224:225], v8 offset:0
    ds_read_b64_tr_b16 a[226:227], v8 offset:1024
    ds_read_b64_tr_b16 a[228:229], v9 offset:0
    ds_read_b64_tr_b16 a[230:231], v9 offset:1024
    ds_read_b64_tr_b16 a[232:233], v8 offset:8192
    ds_read_b64_tr_b16 a[234:235], v8 offset:9216
    ds_read_b64_tr_b16 a[236:237], v9 offset:8192
    ds_read_b64_tr_b16 a[238:239], v9 offset:9216
    s_waitcnt lgkmcnt(0)
    ds_read_b64_tr_b16 a[240:241], v8 offset:16384
    ds_read_b64_tr_b16 a[242:243], v8 offset:17408
    ds_read_b64_tr_b16 a[244:245], v9 offset:16384
    ds_read_b64_tr_b16 a[246:247], v9 offset:17408
    ds_read_b64_tr_b16 a[248:249], v8 offset:24576
    ds_read_b64_tr_b16 a[250:251], v8 offset:25600
    ds_read_b64_tr_b16 a[252:253], v9 offset:24576
    ds_read_b64_tr_b16 a[254:255], v9 offset:25600
    s_waitcnt lgkmcnt(0)
    s_waitcnt vmcnt(16)
    s_barrier
    s_mov_b32 s62, 0
L_pp_46:
    v_readfirstlane_b32 s59, v11
    s_and_b32 s60, s59, 0xff
    s_cmp_ge_u32 s60, 15
    s_cbranch_scc1 L_pok_47
    v_mov_b32 v24, 4
    global_load_dword v11, v24, s[98:99] sc1
    s_add_u32 s62, s62, 1
    s_cmp_gt_u32 s62, 0x200000
    s_cbranch_scc1 chain_kernel_wabort
    s_waitcnt vmcnt(0)
    s_branch L_pp_46
L_pok_47:
    s_cmp_ge_u32 s59, 0x800
    s_cselect_b32 s59, 0x2000, 0
    s_xor_b32 s31, s31, s59
    s_xor_b32 s30, s30, s59
    s_mov_b32 s24, 0
    s_mov_b32 s18, 0
    s_cmp_eq_u32 s56, 3
    s_cbranch_scc1 L_kvv_48
    ds_read_b128 v[72:75], v4 offset:0
    ds_read_b128 v[76:79], v4 offset:2048
    ds_read_b128 v[80:83], v5 offset:0
    ds_read_b128 v[84:87], v5 offset:2048
    ds_read_b128 v[88:91], v4 offset:4096
    ds_read_b128 v[92:95], v4 offset:6144
    s_mov_b32 s34, 0x808088a8
    s_mov_b32 s35, 0x40808080
    s_cmp_eq_u32 s58, 0
    s_cselect_b32 s33, s27, 0x400000
    s_mov_b32 s25, 0
    s_mov_b32 s26, 0
kvsk:
    s_waitcnt lgkmcnt(4)
    v_mfma_f32_16x16x32_bf16 v[32:35], a[0:3], v[72:75], 0
    ds_read_b128 v[96:99], v5 offset:4096
    v_mfma_f32_16x16x32_bf16 v[36:39], a[4:7], v[72:75], 0
    ds_read_b128 v[100:103], v5 offset:6144
    v_mfma_f32_16x16x32_bf16 v[44:47], a[4:7], v[76:79], 0
    v_mfma_f32_16x16x32_bf16 v[40:43], a[0:3], v[76:79], 0
    v_cvt_pk_bf16_f32 v64, v48, v49
    s_waitcnt lgkmcnt(4)
    v_mfma_f32_16x16x32_bf16 v[32:35], a[8:11], v[80:83], v[32:35]
    ds_read_b128 v[72:75], v4 offset:8192
    v_cvt_pk_bf16_f32 v65, v50, v51
    v_mfma_f32_16x16x32_bf16 v[36:39], a[12:15], v[80:83], v[36:39]
    ds_read_b128 v[76:79], v4 offset:10240
    v_cvt_pk_bf16_f32 v66, v52, v53
    v_mfma_f32_16x16x32_bf16 v[44:47], a[12:15], v[84:87], v[44:47]
    v_cvt_pk_bf16_f32 v67, v54, v55
    v_cvt_pk_bf16_f32 v68, v56, v57
    v_mfma_f32_16x16x32_bf16 v[40:43], a[8:11], v[84:87], v[40:43]
    v_cvt_pk_bf16_f32 v69, v58, v59
    s_waitcnt lgkmcnt(4)
    v_mfma_f32_16x16x32_bf16 v[32:35], a[16:19], v[88:91], v[32:35]
    ds_read_b128 v[80:83], v5 offset:8192
    v_cvt_pk_bf16_f32 v70, v60, v61
    v_mfma_f32_16x16x32_bf16 v[36:39], a[20:23], v[88:91], v[36:39]
    ds_read_b128 v[84:87], v5 offset:10240
    v_cvt_pk_bf16_f32 v71, v62, v63
    v_mfma_f32_16x16x32_bf16 v[44:47], a[20:23], v[92:95], v[44:47]
    buffer_store_dwordx4 v[64:67], v1, s[16:19], s25 offen sc1
    v_mfma_f32_16x16x32_bf16 v[40:43], a[16:19], v[92:95], v[40:43]
    s_waitcnt lgkmcnt(4)
    v_mfma_f32_16x16x32_bf16 v[32:35], a[24:27], v[96:99], v[32:35]
    ds_read_b128 v[88:91], v4 offset:12288
    buffer_store_dwordx4 v[68:71], v12, s[16:19], s25 offen sc1
    v_mfma_f32_16x16x32_bf16 v[36:39], a[28:31], v[96:99], v[36:39]
    ds_read_b128 v[92:95], v4 offset:14336
    v_mfma_f32_16x16x32_bf16 v[44:47], a[28:31], v[100:103], v[44:47]
    v_mfma_f32_16x16x32_bf16 v[40:43], a[24:27], v[100:103], v[40:43]
    s_waitcnt lgkmcnt(4)
    v_mfma_f32_16x16x32_bf16 v[32:35], a[32:35], v[72:75], v[32:35]
    ds_read_b128 v[96:99], v5 offset:12288
    buffer_store_dwordx4 v[28:31], v1, s[16:19], s26 offen sc1
    v_mfma_f32_16x16x32_bf16 v[36:39], a[36:39], v[72:75], v[36:39]
    ds_read_b128 v[100:103], v5 offset:14336
    buffer_load_dword v13, v10, s[8:11], s33 offen
    v_mfma_f32_16x16x32_bf16 v[44:47], a[36:39], v[76:79], v[44:47]
    v_mfma_f32_16x16x32_bf16 v[40:43], a[32:35], v[76:79], v[40:43]
    s_waitcnt lgkmcnt(4)
    v_mfma_f32_16x16x32_bf16 v[32:35], a[40:43], v[80:83], v[32:35]
    ds_read_b128 v[72:75], v4 offset:16384
    v_mfma_f32_16x16x32_bf16 v[36:39], a[44:47], v[80:83], v[36:39]
    ds_read_b128 v[76:79], v4 offset:18432
    v_mfma_f32_16x16x32_bf16 v[44:47], a[44:47], v[84:87], v[44:47]
    s_add_u32 m0, s20, 0
    v_mfma_f32_16x16x32_bf16 v[40:43], a[40:43], v[84:87], v[40:43]
    buffer_load_dwordx4 v2, s[8:11], s23 offen offset:0 lds
    s_waitcnt lgkmcnt(4)
    v_mfma_f32_16x16x32_bf16 v[32:35], a[48:51], v[88:91], v[32:35]
    ds_read_b128 v[80:83], v5 offset:16384
    v_mfma_f32_16x16x32_bf16 v[36:39], a[52:55], v[88:91], v[36:39]
    ds_read_b128 v[84:87], v5 offset:18432
    s_add_u32 m0, s20, 3968
    v_mfma_f32_16x16x32_bf16 v[44:47], a[52:55], v[92:95], v[44:47]
    buffer_load_dwordx4 v2, s[8:11], s23 offen offset:128 lds
    v_mfma_f32_16x16x32_bf16 v[40:43], a[48:51], v[92:95], v[40:43]
    s_waitcnt lgkmcnt(4)
    v_mfma_f32_16x16x32_bf16 v[32:35], a[56:59], v[96:99], v[32:35]
    ds_read_b128 v[88:91], v4 offset:20480
    s_add_u32 m0, s20, 7936
    v_mfma_f32_16x16x32_bf16 v[36:39], a[60:63], v[96:99], v[36:39]
    ds_read_b128 v[92:95], v4 offset:22528
    buffer_load_dwordx4 v2, s[8:11], s23 offen offset:256 lds
    v_mfma_f32_16x16x32_bf16 v[44:47], a[60:63], v[100:103], v[44:47]
    v_mfma_f32_16x16x32_bf16 v[40:43], a[56:59], v[100:103], v[40:43]
    s_add_u32 m0, s20, 11904
    s_waitcnt lgkmcnt(4)
    v_mfma_f32_16x16x32_bf16 v[32:35], a[64:67], v[72:75], v[32:35]
    ds_read_b128 v[96:99], v5 offset:20480
    buffer_load_dwordx4 v2, s[8:11], s23 offen offset:384 lds
    v_mfma_f32_16x16x32_bf16 v[36:39], a[68:71], v[72:75], v[36:39]
    ds_read_b128 v[100:103], v5 offset:22528
    v_mfma_f32_16x16x32_bf16 v[44:47], a[68:71], v[76:79], v[44:47]
    s_add_u32 m0, s20, 15872
    v_mfma_f32_16x16x32_bf16 v[40:43], a[64:67], v[76:79], v[40:43]
    buffer_load_dwordx4 v2, s[8:11], s23 offen offset:512 lds
    s_waitcnt lgkmcnt(4)
    v_mfma_f32_16x16x32_bf16 v[32:35], a[72:75], v[80:83], v[32:35]
    ds_read_b128 v[72:75], v4 offset:24576
    v_mfma_f32_16x16x32_bf16 v[36:39], a[76:79], v[80:83], v[36:39]
    ds_read_b128 v[76:79], v4 offset:26624
    s_add_u32 m0, s20, 19840
    v_mfma_f32_16x16x32_bf16 v[44:47], a[76:79], v[84:87], v[44:47]
    buffer_load_dwordx4 v2, s[8:11], s23 offen offset:640 lds
    v_mfma_f32_16x16x32_bf16 v[40:43], a[72:75], v[84:87], v[40:43]
    s_waitcnt lgkmcnt(4)
    v_mfma_f32_16x16x32_bf16 v[32:35], a[80:83], v[88:91], v[32:35]
    ds_read_b128 v[80:83], v5 offset:24576
    s_add_u32 m0, s20, 23808
    v_mfma_f32_16x16x32_bf16 v[36:39], a[84:87], v[88:91], v[36:39]
    ds_read_b128 v[84:87], v5 offset:26624
    buffer_load_dwordx4 v2, s[8:11], s23 offen offset:768 lds
    v_mfma_f32_16x16x32_bf16 v[44:47], a[84:87], v[92:95], v[44:47]
    s_cmp_ge_u32 s21, 131072
    s_cselect_b32 s22, 0xfffe0000, s29
    v_mfma_f32_16x16x32_bf16 v[40:43], a[80:83], v[92:95], v[40:43]
    s_add_u32 s21, s21, s22
    s_waitcnt lgkmcnt(4)
    v_mfma_f32_16x16x32_bf16 v[32:35], a[88:91], v[96:99], v[32:35]
    ds_read_b128 v[88:91], v4 offset:28672
    s_add_u32 m0, s20, 27776
    v_mfma_f32_16x16x32_bf16 v[36:39], a[92:95], v[96:99], v[36:39]
    ds_read_b128 v[92:95], v4 offset:30720
    buffer_load_dwordx4 v2, s[8:11], s23 offen offset:896 lds
    v_mfma_f32_16x16x32_bf16 v[44:47], a[92:95], v[100:103], v[44:47]
    v_add_u32 v4, s22, v4
    v_mfma_f32_16x16x32_bf16 v[40:43], a[88:91], v[100:103], v[40:43]
    s_waitcnt lgkmcnt(4)
    v_mfma_f32_16x16x32_bf16 v[32:35], a[96:99], v[72:75], v[32:35]
    ds_read_b128 v[96:99], v5 offset:28672
    v_mfma_f32_16x16x32_bf16 v[36:39], a[100:103], v[72:75], v[36:39]
    ds_read_b128 v[100:103], v5 offset:30720
    v_mfma_f32_16x16x32_bf16 v[44:47], a[100:103], v[76:79], v[44:47]
    v_add_u32 v5, s22, v5
    s_cmp_lt_u32 s24, 4
    v_mfma_f32_16x16x32_bf16 v[40:43], a[96:99], v[76:79], v[40:43]
    s_waitcnt vmcnt(20)
    s_cbranch_scc1 kvsk_early
    s_barrier
kvsk_mid:
    s_waitcnt lgkmcnt(4)
    v_mfma_f32_16x16x32_bf16 v[32:35], a[104:107], v[80:83], v[32:35]
    ds_read_b128 v[72:75], v4 offset:0
    s_add_u32 s23, s23, 1024
    v_mfma_f32_16x16x32_bf16 v[36:39], a[108:111], v[80:83], v[36:39]
    ds_read_b128 v[76:79], v4 offset:2048
    s_bitcmp1_b32 s23, 11
    v_mfma_f32_16x16x32_bf16 v[44:47], a[108:111], v[84:87], v[44:47]
    s_cselect_b32 s60, 0xf800, 0
    s_add_u32 s23, s23, s60
    v_mfma_f32_16x16x32_bf16 v[40:43], a[104:107], v[84:87], v[40:43]
    s_add_u32 s20, s20, 32768
    s_waitcnt lgkmcnt(4)
    v_mfma_f32_16x16x32_bf16 v[32:35], a[112:115], v[88:91], v[32:35]
    ds_read_b128 v[80:83], v5 offset:0
    s_cmp_ge_u32 s20, 163840
    v_mfma_f32_16x16x32_bf16 v[36:39], a[116:119], v[88:91], v[36:39]
    ds_read_b128 v[84:87], v5 offset:2048
    s_cselect_b32 s60, 163840, 0
    v_mfma_f32_16x16x32_bf16 v[44:47], a[116:119], v[92:95], v[44:47]
    s_sub_u32 s20, s20, s60
    v_mfma_f32_16x16x32_bf16 v[40:43], a[112:115], v[92:95], v[40:43]
    s_waitcnt lgkmcnt(4)
    v_mfma_f32_16x16x32_bf16 v[32:35], a[120:123], v[96:99], v[32:35]
    ds_read_b128 v[88:91], v4 offset:4096
    v_mfma_f32_16x16x32_bf16 v[36:39], a[124:127], v[96:99], v[36:39]
    ds_read_b128 v[92:95], v4 offset:6144
    v_mfma_f32_16x16x32_bf16 v[44:47], a[124:127], v[100:103], v[44:47]
    v_mfma_f32_16x16x32_bf16 v[40:43], a[120:123], v[100:103], v[40:43]
    s_waitcnt lgkmcnt(4)
    v_mfma_f32_16x16x32_bf16 v[32:35], a[128:131], v[72:75], v[32:35]
    ds_read_b128 v[96:99], v5 offset:4096
    s_mov_b32 s18, 0xa000000
    v_mfma_f32_16x16x32_bf16 v[36:39], a[132:135], v[72:75], v[36:39]
    ds_read_b128 v[100:103], v5 offset:6144
    v_mfma_f32_16x16x32_bf16 v[44:47], a[132:135], v[76:79], v[44:47]
    s_add_u32 m0, s20, 0
    v_mfma_f32_16x16x32_bf16 v[40:43], a[128:131], v[76:79], v[40:43]
    buffer_load_dwordx4 v2, s[8:11], s23 offen offset:0 lds
    s_waitcnt lgkmcnt(4)
    v_mfma_f32_16x16x32_bf16 v[32:35], a[136:139], v[80:83], v[32:35]
    ds_read_b128 v[72:75], v4 offset:8192
    s_lshl_b32 s25, s24, 21
    v_mfma_f32_16x16x32_bf16 v[36:39], a[140:143], v[80:83], v[36:39]
    ds_read_b128 v[76:79], v4 offset:10240
    s_lshl_b32 s62, s24, 13
    v_mfma_f32_16x16x32_bf16 v[44:47], a[140:143], v[84:87], v[44:47]
    s_and_b32 s62, s62, 0x2000
    v_mfma_f32_16x16x32_bf16 v[40:43], a[136:139], v[84:87], v[40:43]
    s_add_u32 m0, s20, 3968
    s_waitcnt lgkmcnt(4)
    v_mfma_f32_16x16x32_bf16 v[32:35], a[144:147], v[88:91], v[32:35]
    ds_read_b128 v[80:83], v5 offset:8192
    buffer_load_dwordx4 v2, s[8:11], s23 offen offset:128 lds
    v_mfma_f32_16x16x32_bf16 v[36:39], a[148:151], v[88:91], v[36:39]
    ds_read_b128 v[84:87], v5 offset:10240
    s_xor_b32 s62, s62, s30
    v_mfma_f32_16x16x32_bf16 v[44:47], a[148:151], v[92:95], v[44:47]
    s_add_u32 s25, s25, s62
    s_lshl_b32 s26, s24, 19
    v_mfma_f32_16x16x32_bf16 v[40:43], a[144:147], v[92:95], v[40:43]
    s_waitcnt lgkmcnt(4)
    v_mfma_f32_16x16x32_bf16 v[32:35], a[152:155], v[96:99], v[32:35]
    ds_read_b128 v[88:91], v4 offset:12288
    s_add_u32 m0, s20, 7936
    v_mfma_f32_16x16x32_bf16 v[36:39], a[156:159], v[96:99], v[36:39]
    ds_read_b128 v[92:95], v4 offset:14336
    buffer_load_dwordx4 v2, s[8:11], s23 offen offset:256 lds
    v_mfma_f32_16x16x32_bf16 v[44:47], a[156:159], v[100:103], v[44:47]
    s_lshl_b32 s62, s24, 11
    s_and_b32 s62, s62, 0x2000
    v_mfma_f32_16x16x32_bf16 v[40:43], a[152:155], v[100:103], v[40:43]
    s_waitcnt lgkmcnt(4)
    v_mfma_f32_16x16x32_bf16 v[32:35], a[160:163], v[72:75], v[32:35]
    ds_read_b128 v[96:99], v5 offset:12288
    v_mfma_f32_16x16x32_bf16 v[36:39], a[164:167], v[72:75], v[36:39]
    ds_read_b128 v[100:103], v5 offset:14336
    s_add_u32 m0, s20, 11904
    v_mfma_f32_16x16x32_bf16 v[44:47], a[164:167], v[76:79], v[44:47]
    buffer_load_dwordx4 v2, s[8:11], s23 offen offset:384 lds
    v_mfma_f32_16x16x32_bf16 v[40:43], a[160:163], v[76:79], v[40:43]
    s_xor_b32 s62, s62, s31
    s_waitcnt lgkmcnt(4)
    v_mfma_f32_16x16x32_bf16 v[32:35], a[168:171], v[80:83], v[32:35]
    ds_read_b128 v[72:75], v4 offset:16384
    s_add_u32 s26, s26, s62
    v_mfma_f32_16x16x32_bf16 v[36:39], a[172:175], v[80:83], v[36:39]
    ds_read_b128 v[76:79], v4 offset:18432
    v_mfma_f32_16x16x32_bf16 v[44:47], a[172:175], v[84:87], v[44:47]
    s_add_u32 m0, s20, 15872
    v_mfma_f32_16x16x32_bf16 v[40:43], a[168:171], v[84:87], v[40:43]
    buffer_load_dwordx4 v2, s[8:11], s23 offen offset:512 lds
    s_waitcnt lgkmcnt(4)
    v_mfma_f32_16x16x32_bf16 v[32:35], a[176:179], v[88:91], v[32:35]
    ds_read_b128 v[80:83], v5 offset:16384
    s_add_u32 s27, s27, 0x10000
    v_mfma_f32_16x16x32_bf16 v[36:39], a[180:183], v[88:91], v[36:39]
    ds_read_b128 v[84:87], v5 offset:18432
    s_andn2_b32 s61, 3, s24
    v_mfma_f32_16x16x32_bf16 v[44:47], a[180:183], v[92:95], v[44:47]
    s_or_b32 s61, s61, s58
    s_cselect_b32 s33, 0x400000, s27
    v_mfma_f32_16x16x32_bf16 v[40:43], a[176:179], v[92:95], v[40:43]
    s_add_u32 m0, s20, 19840
    s_waitcnt lgkmcnt(4)
    v_mfma_f32_16x16x32_bf16 v[32:35], a[184:187], v[96:99], v[32:35]
    ds_read_b128 v[88:91], v4 offset:20480
    buffer_load_dwordx4 v2, s[8:11], s23 offen offset:640 lds
    v_mfma_f32_16x16x32_bf16 v[36:39], a[188:191], v[96:99], v[36:39]
    ds_read_b128 v[92:95], v4 offset:22528
    v_mfma_f32_16x16x32_bf16 v[44:47], a[188:191], v[100:103], v[44:47]
    v_mfma_f32_16x16x32_bf16 v[40:43], a[184:187], v[100:103], v[40:43]
    s_waitcnt lgkmcnt(4)
    v_mfma_f32_16x16x32_bf16 v[32:35], a[192:195], v[72:75], v[32:35]
    ds_read_b128 v[96:99], v5 offset:20480
    s_add_u32 m0, s20, 23808
    v_mfma_f32_16x16x32_bf16 v[36:39], a[196:199], v[72:75], v[36:39]
    ds_read_b128 v[100:103], v5 offset:22528
    buffer_load_dwordx4 v2, s[8:11], s23 offen offset:768 lds
    v_mfma_f32_16x16x32_bf16 v[44:47], a[196:199], v[76:79], v[44:47]
    s_cmp_ge_u32 s21, 131072
    s_cselect_b32 s22, 0xfffe0000, s29
    v_mfma_f32_16x16x32_bf16 v[40:43], a[192:195], v[76:79], v[40:43]
    s_add_u32 s21, s21, s22
    s_waitcnt lgkmcnt(4)
    v_mfma_f32_16x16x32_bf16 v[32:35], a[200:203], v[80:83], v[32:35]
    ds_read_b128 v[72:75], v4 offset:24576
    v_mfma_f32_16x16x32_bf16 v[36:39], a[204:207], v[80:83], v[36:39]
    ds_read_b128 v[76:79], v4 offset:26624
    s_add_u32 m0, s20, 27776
    v_mfma_f32_16x16x32_bf16 v[44:47], a[204:207], v[84:87], v[44:47]
    buffer_load_dwordx4 v2, s[8:11], s23 offen offset:896 lds
    v_mfma_f32_16x16x32_bf16 v[40:43], a[200:203], v[84:87], v[40:43]
    s_waitcnt lgkmcnt(4)
    v_mfma_f32_16x16x32_bf16 v[32:35], a[208:211], v[88:91], v[32:35]
    ds_read_b128 v[80:83], v5 offset:24576
    v_mfma_f32_16x16x32_bf16 v[36:39], a[212:215], v[88:91], v[36:39]
    ds_read_b128 v[84:87], v5 offset:26624
    v_mfma_f32_16x16x32_bf16 v[44:47], a[212:215], v[92:95], v[44:47]
    v_mfma_f32_16x16x32_bf16 v[40:43], a[208:211], v[92:95], v[40:43]
    s_waitcnt lgkmcnt(4)
    v_mfma_f32_16x16x32_bf16 v[32:35], a[216:219], v[96:99], v[32:35]
    ds_read_b128 v[88:91], v4 offset:28672
    v_mfma_f32_16x16x32_bf16 v[36:39], a[220:223], v[96:99], v[36:39]
    ds_read_b128 v[92:95], v4 offset:30720
    v_mfma_f32_16x16x32_bf16 v[44:47], a[220:223], v[100:103], v[44:47]
    v_add_u32 v4, s22, v4
    v_mfma_f32_16x16x32_bf16 v[40:43], a[216:219], v[100:103], v[40:43]
    s_waitcnt lgkmcnt(4)
    v_mfma_f32_16x16x32_bf16 v[32:35], a[224:227], v[72:75], v[32:35]
    ds_read_b128 v[96:99], v5 offset:28672
    v_mfma_f32_16x16x32_bf16 v[36:39], a[228:231], v[72:75], v[36:39]
    ds_read_b128 v[100:103], v5 offset:30720
    v_mfma_f32_16x16x32_bf16 v[44:47], a[228:231], v[76:79], v[44:47]
    v_add_u32 v5, s22, v5
    v_mfma_f32_16x16x32_bf16 v[40:43], a[224:227], v[76:79], v[40:43]
    s_waitcnt vmcnt(16)
    s_barrier
    s_waitcnt lgkmcnt(4)
    v_mfma_f32_16x16x32_bf16 v[32:35], a[232:235], v[80:83], v[32:35]
    ds_read_b128 v[72:75], v4 offset:0
    s_add_u32 s23, s23, 1024
    v_mfma_f32_16x16x32_bf16 v[36:39], a[236:239], v[80:83], v[36:39]
    ds_read_b128 v[76:79], v4 offset:2048
    s_bitcmp1_b32 s23, 11
    v_mfma_f32_16x16x32_bf16 v[44:47], a[236:239], v[84:87], v[44:47]
    s_cselect_b32 s60, 0xf800, 0
    s_add_u32 s23, s23, s60
    v_mfma_f32_16x16x32_bf16 v[40:43], a[232:235], v[84:87], v[40:43]
    s_add_u32 s20, s20, 32768
    s_waitcnt lgkmcnt(4)
    v_mfma_f32_16x16x32_bf16 v[32:35], a[240:243], v[88:91], v[32:35]
    ds_read_b128 v[80:83], v5 offset:0
    s_cmp_ge_u32 s20, 163840
    v_mfma_f32_16x16x32_bf16 v[36:39], a[244:247], v[88:91], v[36:39]
    ds_read_b128 v[84:87], v5 offset:2048
    s_cselect_b32 s60, 163840, 0
    v_mfma_f32_16x16x32_bf16 v[44:47], a[244:247], v[92:95], v[44:47]
    s_sub_u32 s20, s20, s60
    s_add_u32 s24, s24, 1
    v_mfma_f32_16x16x32_bf16 v[40:43], a[240:243], v[92:95], v[40:43]
    s_sub_u32 s61, s24, 2
    s_waitcnt lgkmcnt(4)
    v_mfma_f32_16x16x32_bf16 v[48:51], a[248:251], v[96:99], v[32:35]
    ds_read_b128 v[88:91], v4 offset:4096
    s_bitcmp1_b64 s[34:35], s61
    v_mfma_f32_16x16x32_bf16 v[52:55], a[252:255], v[96:99], v[36:39]
    ds_read_b128 v[92:95], v4 offset:6144
    v_mfma_f32_16x16x32_bf16 v[60:63], a[252:255], v[100:103], v[44:47]
    v_mfma_f32_16x16x32_bf16 v[56:59], a[248:251], v[100:103], v[40:43]
    s_cbranch_scc0 kvsk
    s_cmp_eq_u32 s24, 64
    s_cbranch_scc1 kvsk_fin
    s_cmp_lg_u32 s58, 0
    s_cbranch_scc1 kvsk
    s_bfm_b64 s[62:63], s61, 0
    s_and_b32 s62, s62, 0x808088af
    s_and_b32 s63, s63, 0x80808080
    s_bcnt1_i32_b64 s60, s[62:63]
    s_lshl_b32 s60, s60, 2
    s_add_u32 s60, s60, 64
    v_mov_b32 v24, s60
    v_mov_b32 v25, 1
    s_mov_b64 exec, 1
    global_atomic_add v24, v25, s[98:99] sc1
    s_mov_b64 exec, -1
    s_branch kvsk
kvsk_early:
    s_waitcnt vmcnt(8)
    s_barrier
    s_cmp_eq_u32 s24, 0
    s_cbranch_scc1 kvsk_mid
    s_cmp_lg_u32 s58, 0
    s_cbranch_scc1 kvsk_mid
    s_lshl_b32 s60, s24, 2
    s_add_u32 s60, s60, 60
    v_mov_b32 v24, s60
    v_mov_b32 v25, 1
    s_mov_b64 exec, 1
    global_atomic_add v24, v25, s[98:99] sc1
    s_mov_b64 exec, -1
    s_branch kvsk_mid
kvsk_fin:
    s_nop 7
    v_cvt_pk_bf16_f32 v64, v48, v49
    v_cvt_pk_bf16_f32 v65, v50, v51
    v_cvt_pk_bf16_f32 v66, v52, v53
    v_cvt_pk_bf16_f32 v67, v54, v55
    v_cvt_pk_bf16_f32 v68, v56, v57
    v_cvt_pk_bf16_f32 v69, v58, v59
    v_cvt_pk_bf16_f32 v70, v60, v61
    v_cvt_pk_bf16_f32 v71, v62, v63
    buffer_store_dwordx4 v[64:67], v1, s[16:19], s25 offen sc1
    buffer_store_dwordx4 v[68:71], v12, s[16:19], s25 offen sc1
    buffer_store_dwordx4 v[28:31], v1, s[16:19], s26 offen sc1
    s_waitcnt vmcnt(0) lgkmcnt(0)
    s_barrier
    s_cmp_lg_u32 s58, 0
    s_cbranch_scc1 L_kve_49
    s_mov_b32 s60, 116
    v_mov_b32 v24, s60
    v_mov_b32 v25, 1
    s_mov_b64 exec, 1
    global_atomic_add v24, v25, s[98:99] sc1
    s_mov_b64 exec, -1
    s_branch L_kve_49
L_kvv_48:
    ds_read_b128 v[72:75], v4 offset:0
    ds_read_b128 v[76:79], v4 offset:2048
    ds_read_b128 v[80:83], v5 offset:0
    ds_read_b128 v[84:87], v5 offset:2048
    ds_read_b128 v[88:91], v4 offset:4096
    ds_read_b128 v[92:95], v4 offset:6144
    s_mov_b32 s34, 0x808088a8
    s_mov_b32 s35, 0x40808080
    s_cmp_eq_u32 s58, 0
    s_cselect_b32 s33, s27, 0x400000
    s_mov_b32 s25, 0
    s_mov_b32 s26, 0
kvsv:
    s_waitcnt lgkmcnt(4)
    v_mfma_f32_16x16x32_bf16 v[32:35], v[72:75], a[0:3], 0
    ds_read_b128 v[96:99], v5 offset:4096
    v_mfma_f32_16x16x32_bf16 v[40:43], v[72:75], a[4:7], 0
    ds_read_b128 v[100:103], v5 offset:6144
    v_mfma_f32_16x16x32_bf16 v[44:47], v[76:79], a[4:7], 0
    v_mfma_f32_16x16x32_bf16 v[36:39], v[76:79], a[0:3], 0
    v_cvt_pk_bf16_f32 v64, v48, v49
    s_waitcnt lgkmcnt(4)
    v_mfma_f32_16x16x32_bf16 v[32:35], v[80:83], a[8:11], v[32:35]
    ds_read_b128 v[72:75], v4 offset:8192
    v_cvt_pk_bf16_f32 v65, v50, v51
    v_mfma_f32_16x16x32_bf16 v[40:43], v[80:83], a[12:15], v[40:43]
    ds_read_b128 v[76:79], v4 offset:10240
    v_cvt_pk_bf16_f32 v66, v52, v53
    v_mfma_f32_16x16x32_bf16 v[44:47], v[84:87], a[12:15], v[44:47]
    v_cvt_pk_bf16_f32 v67, v54, v55
    v_cvt_pk_bf16_f32 v68, v56, v57
    v_mfma_f32_16x16x32_bf16 v[36:39], v[84:87], a[8:11], v[36:39]
    v_cvt_pk_bf16_f32 v69, v58, v59
    s_waitcnt lgkmcnt(4)
    v_mfma_f32_16x16x32_bf16 v[32:35], v[88:91], a[16:19], v[32:35]
    ds_read_b128 v[80:83], v5 offset:8192
    v_cvt_pk_bf16_f32 v70, v60, v61
    v_mfma_f32_16x16x32_bf16 v[40:43], v[88:91], a[20:23], v[40:43]
    ds_read_b128 v[84:87], v5 offset:10240
    v_cvt_pk_bf16_f32 v71, v62, v63
    v_mfma_f32_16x16x32_bf16 v[44:47], v[92:95], a[20:23], v[44:47]
    buffer_store_dwordx4 v[64:67], v1, s[16:19], s25 offen sc1
    v_mfma_f32_16x16x32_bf16 v[36:39], v[92:95], a[16:19], v[36:39]
    s_waitcnt lgkmcnt(4)
    v_mfma_f32_16x16x32_bf16 v[32:35], v[96:99], a[24:27], v[32:35]
    ds_read_b128 v[88:91], v4 offset:12288
    buffer_store_dwordx4 v[68:71], v1, s[16:19], s25 offen offset:1024 sc1
    v_mfma_f32_16x16x32_bf16 v[40:43], v[96:99], a[28:31], v[40:43]
    ds_read_b128 v[92:95], v4 offset:14336
    v_mfma_f32_16x16x32_bf16 v[44:47], v[100:103], a[28:31], v[44:47]
    v_mfma_f32_16x16x32_bf16 v[36:39], v[100:103], a[24:27], v[36:39]
    s_waitcnt lgkmcnt(4)
    v_mfma_f32_16x16x32_bf16 v[32:35], v[72:75], a[32:35], v[32:35]
    ds_read_b128 v[96:99], v5 offset:12288
    buffer_store_dwordx4 v[28:31], v1, s[16:19], s26 offen sc1
    v_mfma_f32_16x16x32_bf16 v[40:43], v[72:75], a[36:39], v[40:43]
    ds_read_b128 v[100:103], v5 offset:14336
    buffer_load_dword v13, v10, s[8:11], s33 offen
    v_mfma_f32_16x16x32_bf16 v[44:47], v[76:79], a[36:39], v[44:47]
    v_mfma_f32_16x16x32_bf16 v[36:39], v[76:79], a[32:35], v[36:39]
    s_waitcnt lgkmcnt(4)
    v_mfma_f32_16x16x32_bf16 v[32:35], v[80:83], a[40:43], v[32:35]
    ds_read_b128 v[72:75], v4 offset:16384
    v_mfma_f32_16x16x32_bf16 v[40:43], v[80:83], a[44:47], v[40:43]
    ds_read_b128 v[76:79], v4 offset:18432
    v_mfma_f32_16x16x32_bf16 v[44:47], v[84:87], a[44:47], v[44:47]
    s_add_u32 m0, s20, 0
    v_mfma_f32_16x16x32_bf16 v[36:39], v[84:87], a[40:43], v[36:39]
    buffer_load_dwordx4 v2, s[8:11], s23 offen offset:0 lds
    s_waitcnt lgkmcnt(4)
    v_mfma_f32_16x16x32_bf16 v[32:35], v[88:91], a[48:51], v[32:35]
    ds_read_b128 v[80:83], v5 offset:16384
    v_mfma_f32_16x16x32_bf16 v[40:43], v[88:91], a[52:55], v[40:43]
    ds_read_b128 v[84:87], v5 offset:18432
    s_add_u32 m0, s20, 3968
    v_mfma_f32_16x16x32_bf16 v[44:47], v[92:95], a[52:55], v[44:47]
    buffer_load_dwordx4 v2, s[8:11], s23 offen offset:128 lds
    v_mfma_f32_16x16x32_bf16 v[36:39], v[92:95], a[48:51], v[36:39]
    s_waitcnt lgkmcnt(4)
    v_mfma_f32_16x16x32_bf16 v[32:35], v[96:99], a[56:59], v[32:35]
    ds_read_b128 v[88:91], v4 offset:20480
    s_add_u32 m0, s20, 7936
    v_mfma_f32_16x16x32_bf16 v[40:43], v[96:99], a[60:63], v[40:43]
    ds_read_b128 v[92:95], v4 offset:22528
    buffer_load_dwordx4 v2, s[8:11], s23 offen offset:256 lds
    v_mfma_f32_16x16x32_bf16 v[44:47], v[100:103], a[60:63], v[44:47]
    v_mfma_f32_16x16x32_bf16 v[36:39], v[100:103], a[56:59], v[36:39]
    s_add_u32 m0, s20, 11904
    s_waitcnt lgkmcnt(4)
    v_mfma_f32_16x16x32_bf16 v[32:35], v[72:75], a[64:67], v[32:35]
    ds_read_b128 v[96:99], v5 offset:20480
    buffer_load_dwordx4 v2, s[8:11], s23 offen offset:384 lds
    v_mfma_f32_16x16x32_bf16 v[40:43], v[72:75], a[68:71], v[40:43]
    ds_read_b128 v[100:103], v5 offset:22528
    v_mfma_f32_16x16x32_bf16 v[44:47], v[76:79], a[68:71], v[44:47]
    s_add_u32 m0, s20, 15872
    v_mfma_f32_16x16x32_bf16 v[36:39], v[76:79], a[64:67], v[36:39]
    buffer_load_dwordx4 v2, s[8:11], s23 offen offset:512 lds
    s_waitcnt lgkmcnt(4)
    v_mfma_f32_16x16x32_bf16 v[32:35], v[80:83], a[72:75], v[32:35]
    ds_read_b128 v[72:75], v4 offset:24576
    v_mfma_f32_16x16x32_bf16 v[40:43], v[80:83], a[76:79], v[40:43]
    ds_read_b128 v[76:79], v4 offset:26624
    s_add_u32 m0, s20, 19840
    v_mfma_f32_16x16x32_bf16 v[44:47], v[84:87], a[76:79], v[44:47]
    buffer_load_dwordx4 v2, s[8:11], s23 offen offset:640 lds
    v_mfma_f32_16x16x32_bf16 v[36:39], v[84:87], a[72:75], v[36:39]
    s_waitcnt lgkmcnt(4)
    v_mfma_f32_16x16x32_bf16 v[32:35], v[88:91], a[80:83], v[32:35]
    ds_read_b128 v[80:83], v5 offset:24576
    s_add_u32 m0, s20, 23808
    v_mfma_f32_16x16x32_bf16 v[40:43], v[88:91], a[84:87], v[40:43]
    ds_read_b128 v[84:87], v5 offset:26624
    buffer_load_dwordx4 v2, s[8:11], s23 offen offset:768 lds
    v_mfma_f32_16x16x32_bf16 v[44:47], v[92:95], a[84:87], v[44:47]
    s_cmp_ge_u32 s21, 131072
    s_cselect_b32 s22, 0xfffe0000, s29
    v_mfma_f32_16x16x32_bf16 v[36:39], v[92:95], a[80:83], v[36:39]
    s_add_u32 s21, s21, s22
    s_waitcnt lgkmcnt(4)
    v_mfma_f32_16x16x32_bf16 v[32:35], v[96:99], a[88:91], v[32:35]
    ds_read_b128 v[88:91], v4 offset:28672
    s_add_u32 m0, s20, 27776
    v_mfma_f32_16x16x32_bf16 v[40:43], v[96:99], a[92:95], v[40:43]
    ds_read_b128 v[92:95], v4 offset:30720
    buffer_load_dwordx4 v2, s[8:11], s23 offen offset:896 lds
    v_mfma_f32_16x16x32_bf16 v[44:47], v[100:103], a[92:95], v[44:47]
    v_add_u32 v4, s22, v4
    v_mfma_f32_16x16x32_bf16 v[36:39], v[100:103], a[88:91], v[36:39]
    s_waitcnt lgkmcnt(4)
    v_mfma_f32_16x16x32_bf16 v[32:35], v[72:75], a[96:99], v[32:35]
    ds_read_b128 v[96:99], v5 offset:28672
    v_mfma_f32_16x16x32_bf16 v[40:43], v[72:75], a[100:103], v[40:43]
    ds_read_b128 v[100:103], v5 offset:30720
    v_mfma_f32_16x16x32_bf16 v[44:47], v[76:79], a[100:103], v[44:47]
    v_add_u32 v5, s22, v5
    s_cmp_lt_u32 s24, 4
    v_mfma_f32_16x16x32_bf16 v[36:39], v[76:79], a[96:99], v[36:39]
    s_waitcnt vmcnt(20)
    s_cbranch_scc1 kvsv_early
    s_barrier
kvsv_mid:
    s_waitcnt lgkmcnt(4)
    v_mfma_f32_16x16x32_bf16 v[32:35], v[80:83], a[104:107], v[32:35]
    ds_read_b128 v[72:75], v4 offset:0
    s_add_u32 s23, s23, 1024
    v_mfma_f32_16x16x32_bf16 v[40:43], v[80:83], a[108:111], v[40:43]
    ds_read_b128 v[76:79], v4 offset:2048
    s_bitcmp1_b32 s23, 11
    v_mfma_f32_16x16x32_bf16 v[44:47], v[84:87], a[108:111], v[44:47]
    s_cselect_b32 s60, 0xf800, 0
    s_add_u32 s23, s23, s60
    v_mfma_f32_16x16x32_bf16 v[36:39], v[84:87], a[104:107], v[36:39]
    s_add_u32 s20, s20, 32768
    s_waitcnt lgkmcnt(4)
    v_mfma_f32_16x16x32_bf16 v[32:35], v[88:91], a[112:115], v[32:35]
    ds_read_b128 v[80:83], v5 offset:0
    s_cmp_ge_u32 s20, 163840
    v_mfma_f32_16x16x32_bf16 v[40:43], v[88:91], a[116:119], v[40:43]
    ds_read_b128 v[84:87], v5 offset:2048
    s_cselect_b32 s60, 163840, 0
    v_mfma_f32_16x16x32_bf16 v[44:47], v[92:95], a[116:119], v[44:47]
    s_sub_u32 s20, s20, s60
    v_mfma_f32_16x16x32_bf16 v[36:39], v[92:95], a[112:115], v[36:39]
    s_waitcnt lgkmcnt(4)
    v_mfma_f32_16x16x32_bf16 v[32:35], v[96:99], a[120:123], v[32:35]
    ds_read_b128 v[88:91], v4 offset:4096
    v_mfma_f32_16x16x32_bf16 v[40:43], v[96:99], a[124:127], v[40:43]
    ds_read_b128 v[92:95], v4 offset:6144
    v_mfma_f32_16x16x32_bf16 v[44:47], v[100:103], a[124:127], v[44:47]
    v_mfma_f32_16x16x32_bf16 v[36:39], v[100:103], a[120:123], v[36:39]
    s_waitcnt lgkmcnt(4)
    v_mfma_f32_16x16x32_bf16 v[32:35], v[72:75], a[128:131], v[32:35]
    ds_read_b128 v[96:99], v5 offset:4096
    s_mov_b32 s18, 0xa000000
    v_mfma_f32_16x16x32_bf16 v[40:43], v[72:75], a[132:135], v[40:43]
    ds_read_b128 v[100:103], v5 offset:6144
    v_mfma_f32_16x16x32_bf16 v[44:47], v[76:79], a[132:135], v[44:47]
    s_add_u32 m0, s20, 0
    v_mfma_f32_16x16x32_bf16 v[36:39], v[76:79], a[128:131], v[36:39]
    buffer_load_dwordx4 v2, s[8:11], s23 offen offset:0 lds
    s_waitcnt lgkmcnt(4)
    v_mfma_f32_16x16x32_bf16 v[32:35], v[80:83], a[136:139], v[32:35]
    ds_read_b128 v[72:75], v4 offset:8192
    s_lshl_b32 s25, s24, 21
    v_mfma_f32_16x16x32_bf16 v[40:43], v[80:83], a[140:143], v[40:43]
    ds_read_b128 v[76:79], v4 offset:10240
    s_lshl_b32 s62, s24, 13
    v_mfma_f32_16x16x32_bf16 v[44:47], v[84:87], a[140:143], v[44:47]
    s_and_b32 s62, s62, 0x2000
    v_mfma_f32_16x16x32_bf16 v[36:39], v[84:87], a[136:139], v[36:39]
    s_add_u32 m0, s20, 3968
    s_waitcnt lgkmcnt(4)
    v_mfma_f32_16x16x32_bf16 v[32:35], v[88:91], a[144:147], v[32:35]
    ds_read_b128 v[80:83], v5 offset:8192
    buffer_load_dwordx4 v2, s[8:11], s23 offen offset:128 lds
    v_mfma_f32_16x16x32_bf16 v[40:43], v[88:91], a[148:151], v[40:43]
    ds_read_b128 v[84:87], v5 offset:10240
    s_xor_b32 s62, s62, s30
    v_mfma_f32_16x16x32_bf16 v[44:47], v[92:95], a[148:151], v[44:47]
    s_add_u32 s25, s25, s62
    s_lshl_b32 s26, s24, 19
    v_mfma_f32_16x16x32_bf16 v[36:39], v[92:95], a[144:147], v[36:39]
    s_waitcnt lgkmcnt(4)
    v_mfma_f32_16x16x32_bf16 v[32:35], v[96:99], a[152:155], v[32:35]
    ds_read_b128 v[88:91], v4 offset:12288
    s_add_u32 m0, s20, 7936
    v_mfma_f32_16x16x32_bf16 v[40:43], v[96:99], a[156:159], v[40:43]
    ds_read_b128 v[92:95], v4 offset:14336
    buffer_load_dwordx4 v2, s[8:11], s23 offen offset:256 lds
    v_mfma_f32_16x16x32_bf16 v[44:47], v[100:103], a[156:159], v[44:47]
    s_lshl_b32 s62, s24, 11
    s_and_b32 s62, s62, 0x2000
    v_mfma_f32_16x16x32_bf16 v[36:39], v[100:103], a[152:155], v[36:39]
    s_waitcnt lgkmcnt(4)
    v_mfma_f32_16x16x32_bf16 v[32:35], v[72:75], a[160:163], v[32:35]
    ds_read_b128 v[96:99], v5 offset:12288
    v_mfma_f32_16x16x32_bf16 v[40:43], v[72:75], a[164:167], v[40:43]
    ds_read_b128 v[100:103], v5 offset:14336
    s_add_u32 m0, s20, 11904
    v_mfma_f32_16x16x32_bf16 v[44:47], v[76:79], a[164:167], v[44:47]
    buffer_load_dwordx4 v2, s[8:11], s23 offen offset:384 lds
    v_mfma_f32_16x16x32_bf16 v[36:39], v[76:79], a[160:163], v[36:39]
    s_xor_b32 s62, s62, s31
    s_waitcnt lgkmcnt(4)
    v_mfma_f32_16x16x32_bf16 v[32:35], v[80:83], a[168:171], v[32:35]
    ds_read_b128 v[72:75], v4 offset:16384
    s_add_u32 s26, s26, s62
    v_mfma_f32_16x16x32_bf16 v[40:43], v[80:83], a[172:175], v[40:43]
    ds_read_b128 v[76:79], v4 offset:18432
    v_mfma_f32_16x16x32_bf16 v[44:47], v[84:87], a[172:175], v[44:47]
    s_add_u32 m0, s20, 15872
    v_mfma_f32_16x16x32_bf16 v[36:39], v[84:87], a[168:171], v[36:39]
    buffer_load_dwordx4 v2, s[8:11], s23 offen offset:512 lds
    s_waitcnt lgkmcnt(4)
    v_mfma_f32_16x16x32_bf16 v[32:35], v[88:91], a[176:179], v[32:35]
    ds_read_b128 v[80:83], v5 offset:16384
    s_add_u32 s27, s27, 0x10000
    v_mfma_f32_16x16x32_bf16 v[40:43], v[88:91], a[180:183], v[40:43]
    ds_read_b128 v[84:87], v5 offset:18432
    s_andn2_b32 s61, 3, s24
    v_mfma_f32_16x16x32_bf16 v[44:47], v[92:95], a[180:183], v[44:47]
    s_or_b32 s61, s61, s58
    s_cselect_b32 s33, 0x400000, s27
    v_mfma_f32_16x16x32_bf16 v[36:39], v[92:95], a[176:179], v[36:39]
    s_add_u32 m0, s20, 19840
    s_waitcnt lgkmcnt(4)
    v_mfma_f32_16x16x32_bf16 v[32:35], v[96:99], a[184:187], v[32:35]
    ds_read_b128 v[88:91], v4 offset:20480
    buffer_load_dwordx4 v2, s[8:11], s23 offen offset:640 lds
    v_mfma_f32_16x16x32_bf16 v[40:43], v[96:99], a[188:191], v[40:43]
    ds_read_b128 v[92:95], v4 offset:22528
    v_mfma_f32_16x16x32_bf16 v[44:47], v[100:103], a[188:191], v[44:47]
    v_mfma_f32_16x16x32_bf16 v[36:39], v[100:103], a[184:187], v[36:39]
    s_waitcnt lgkmcnt(4)
    v_mfma_f32_16x16x32_bf16 v[32:35], v[72:75], a[192:195], v[32:35]
    ds_read_b128 v[96:99], v5 offset:20480
    s_add_u32 m0, s20, 23808
    v_mfma_f32_16x16x32_bf16 v[40:43], v[72:75], a[196:199], v[40:43]
    ds_read_b128 v[100:103], v5 offset:22528
    buffer_load_dwordx4 v2, s[8:11], s23 offen offset:768 lds
    v_mfma_f32_16x16x32_bf16 v[44:47], v[76:79], a[196:199], v[44:47]
    s_cmp_ge_u32 s21, 131072
    s_cselect_b32 s22, 0xfffe0000, s29
    v_mfma_f32_16x16x32_bf16 v[36:39], v[76:79], a[192:195], v[36:39]
    s_add_u32 s21, s21, s22
    s_waitcnt lgkmcnt(4)
    v_mfma_f32_16x16x32_bf16 v[32:35], v[80:83], a[200:203], v[32:35]
    ds_read_b128 v[72:75], v4 offset:24576
    v_mfma_f32_16x16x32_bf16 v[40:43], v[80:83], a[204:207], v[40:43]
    ds_read_b128 v[76:79], v4 offset:26624
    s_add_u32 m0, s20, 27776
    v_mfma_f32_16x16x32_bf16 v[44:47], v[84:87], a[204:207], v[44:47]
    buffer_load_dwordx4 v2, s[8:11], s23 offen offset:896 lds
    v_mfma_f32_16x16x32_bf16 v[36:39], v[84:87], a[200:203], v[36:39]
    s_waitcnt lgkmcnt(4)
    v_mfma_f32_16x16x32_bf16 v[32:35], v[88:91], a[208:211], v[32:35]
    ds_read_b128 v[80:83], v5 offset:24576
    v_mfma_f32_16x16x32_bf16 v[40:43], v[88:91], a[212:215], v[40:43]
    ds_read_b128 v[84:87], v5 offset:26624
    v_mfma_f32_16x16x32_bf16 v[44:47], v[92:95], a[212:215], v[44:47]
    v_mfma_f32_16x16x32_bf16 v[36:39], v[92:95], a[208:211], v[36:39]
    s_waitcnt lgkmcnt(4)
    v_mfma_f32_16x16x32_bf16 v[32:35], v[96:99], a[216:219], v[32:35]
    ds_read_b128 v[88:91], v4 offset:28672
    v_mfma_f32_16x16x32_bf16 v[40:43], v[96:99], a[220:223], v[40:43]
    ds_read_b128 v[92:95], v4 offset:30720
    v_mfma_f32_16x16x32_bf16 v[44:47], v[100:103], a[220:223], v[44:47]
    v_add_u32 v4, s22, v4
    v_mfma_f32_16x16x32_bf16 v[36:39], v[100:103], a[216:219], v[36:39]
    s_waitcnt lgkmcnt(4)
    v_mfma_f32_16x16x32_bf16 v[32:35], v[72:75], a[224:227], v[32:35]
    ds_read_b128 v[96:99], v5 offset:28672
    v_mfma_f32_16x16x32_bf16 v[40:43], v[72:75], a[228:231], v[40:43]
    ds_read_b128 v[100:103], v5 offset:30720
    v_mfma_f32_16x16x32_bf16 v[44:47], v[76:79], a[228:231], v[44:47]
    v_add_u32 v5, s22, v5
    v_mfma_f32_16x16x32_bf16 v[36:39], v[76:79], a[224:227], v[36:39]
    s_waitcnt vmcnt(16)
    s_barrier
    s_waitcnt lgkmcnt(4)
    v_mfma_f32_16x16x32_bf16 v[32:35], v[80:83], a[232:235], v[32:35]
    ds_read_b128 v[72:75], v4 offset:0
    s_add_u32 s23, s23, 1024
    v_mfma_f32_16x16x32_bf16 v[40:43], v[80:83], a[236:239], v[40:43]
    ds_read_b128 v[76:79], v4 offset:2048
    s_bitcmp1_b32 s23, 11
    v_mfma_f32_16x16x32_bf16 v[44:47], v[84:87], a[236:239], v[44:47]
    s_cselect_b32 s60, 0xf800, 0
    s_add_u32 s23, s23, s60
    v_mfma_f32_16x16x32_bf16 v[36:39], v[84:87], a[232:235], v[36:39]
    s_add_u32 s20, s20, 32768
    s_waitcnt lgkmcnt(4)
    v_mfma_f32_16x16x32_bf16 v[32:35], v[88:91], a[240:243], v[32:35]
    ds_read_b128 v[80:83], v5 offset:0
    s_cmp_ge_u32 s20, 163840
    v_mfma_f32_16x16x32_bf16 v[40:43], v[88:91], a[244:247], v[40:43]
    ds_read_b128 v[84:87], v5 offset:2048
    s_cselect_b32 s60, 163840, 0
    v_mfma_f32_16x16x32_bf16 v[44:47], v[92:95], a[244:247], v[44:47]
    s_sub_u32 s20, s20, s60
    s_add_u32 s24, s24, 1
    v_mfma_f32_16x16x32_bf16 v[36:39], v[92:95], a[240:243], v[36:39]
    s_sub_u32 s61, s24, 2
    s_waitcnt lgkmcnt(4)
    v_mfma_f32_16x16x32_bf16 v[48:51], v[96:99], a[248:251], v[32:35]
    ds_read_b128 v[88:91], v4 offset:4096
    s_bitcmp1_b64 s[34:35], s61
    v_mfma_f32_16x16x32_bf16 v[56:59], v[96:99], a[252:255], v[40:43]
    ds_read_b128 v[92:95], v4 offset:6144
    v_mfma_f32_16x16x32_bf16 v[60:63], v[100:103], a[252:255], v[44:47]
    v_mfma_f32_16x16x32_bf16 v[52:55], v[100:103], a[248:251], v[36:39]
    s_cbranch_scc0 kvsv
    s_cmp_eq_u32 s24, 64
    s_cbranch_scc1 kvsv_fin
    s_cmp_lg_u32 s58, 0
    s_cbranch_scc1 kvsv
    s_bfm_b64 s[62:63], s61, 0
    s_and_b32 s62, s62, 0x808088af
    s_and_b32 s63, s63, 0x80808080
    s_bcnt1_i32_b64 s60, s[62:63]
    s_lshl_b32 s60, s60, 2
    s_add_u32 s60, s60, 64
    v_mov_b32 v24, s60
    v_mov_b32 v25, 1
    s_mov_b64 exec, 1
    global_atomic_add v24, v25, s[98:99] sc1
    s_mov_b64 exec, -1
    s_branch kvsv
kvsv_early:
    s_waitcnt vmcnt(8)
    s_barrier
    s_cmp_eq_u32 s24, 0
    s_cbranch_scc1 kvsv_mid
    s_cmp_lg_u32 s58, 0
    s_cbranch_scc1 kvsv_mid
    s_lshl_b32 s60, s24, 2
    s_add_u32 s60, s60, 60
    v_mov_b32 v24, s60
    v_mov_b32 v25, 1
    s_mov_b64 exec, 1
    global_atomic_add v24, v25, s[98:99] sc1
    s_mov_b64 exec, -1
    s_branch kvsv_mid
kvsv_fin:
    s_nop 7
    v_cvt_pk_bf16_f32 v64, v48, v49
    v_cvt_pk_bf16_f32 v65, v50, v51
    v_cvt_pk_bf16_f32 v66, v52, v53
    v_cvt_pk_bf16_f32 v67, v54, v55
    v_cvt_pk_bf16_f32 v68, v56, v57
    v_cvt_pk_bf16_f32 v69, v58, v59
    v_cvt_pk_bf16_f32 v70, v60, v61
    v_cvt_pk_bf16_f32 v71, v62, v63
    buffer_store_dwordx4 v[64:67], v1, s[16:19], s25 offen sc1
    buffer_store_dwordx4 v[68:71], v1, s[16:19], s25 offen offset:1024 sc1
    buffer_store_dwordx4 v[28:31], v1, s[16:19], s26 offen sc1
    s_waitcnt vmcnt(0) lgkmcnt(0)
    s_barrier
    s_cmp_lg_u32 s58, 0
    s_cbranch_scc1 L_kve_49
    s_mov_b32 s60, 116
    v_mov_b32 v24, s60
    v_mov_b32 v25, 1
    s_mov_b64 exec, 1
    global_atomic_add v24, v25, s[98:99] sc1
    s_mov_b64 exec, -1
    s_branch L_kve_49
L_kve_49:
    s_branch chain_kernel_seg
L_big_41:
    v_and_b32 v24, 63, v0
    v_lshlrev_b32 v1, 4, v24
    v_mov_b32 v2, v1
    v_add_u32 v3, 1024, v1
    v_bfe_u32 v24, v0, 1, 3
    v_bfe_u32 v25, v0, 4, 2
    v_xor_b32 v24, v24, v25
    v_lshlrev_b32 v24, 4, v24
    v_and_b32 v25, 15, v0
    v_lshl_add_u32 v24, v25, 7, v24
    s_lshr_b32 s60, s58, 1
    s_lshl_b32 s60, s60, 14
    v_add_u32 v23, s60, v24
    s_and_b32 s60, s58, 1
    s_lshl_b32 s60, s60, 14
    s_add_u32 s60, s60, 32768
    v_add_u32 v12, s60, v24
    v_xor_b32 v13, 64, v12
    v_bfe_u32 v24, v0, 2, 3
    v_lshlrev_b32 v22, 5, v24
    v_and_b32 v24, 3, v0
    v_lshl_add_u32 v22, v24, 3, v22
    v_bfe_u32 v24, v0, 2, 2
    v_lshl_add_u32 v22, v24, 9, v22
    v_bfe_u32 v24, v0, 4, 2
    v_lshl_add_u32 v22, v24, 12, v22
    v_bfe_u32 v24, v0, 7, 1
    v_lshl_add_u32 v22, v24, 8, v22
    s_mov_b32 s49, 0
    s_mov_b32 s48, 32768
    s_lshl_b32 s45, s58, 12
    s_add_u32 s44, s45, 32768
    s_mov_b32 s11, 0x00020000
    s_mov_b32 s15, 0x00020000
    s_mov_b32 s19, 0x00020000
    s_and_b32 s82, s57, 3
    s_lshr_b32 s85, s57, 2
    s_mov_b32 s84, s82
    s_lshl_b32 s94, s85, 0
    s_lshl_b32 s60, s85, 19
    s_mov_b32 s30, s64
    s_and_b32 s31, s65, 0xffff
    s_mov_b32 s32, 0x400000
    s_mov_b32 s33, s60
    s_mov_b32 s34, 0x2000
    s_mov_b32 s35, 0x40000
    s_lshl_b32 s60, s82, 18
    s_mov_b32 s36, s70
    s_and_b32 s37, s71, 0xffff
    s_mov_b32 s38, 0x200000
    s_mov_b32 s39, s60
    s_mov_b32 s40, 0x8000
    s_mov_b32 s41, 0x20000
    s_mov_b32 s42, 0x80
    s_cmp_ge_u32 s58, 2
    s_cselect_b32 s36, s72, s70
    s_cselect_b32 s37, s73, s71
    s_and_b32 s37, s37, 0xffff
    v_bfe_u32 v24, v0, 4, 2
    v_and_b32 v25, 7, v0
    v_xor_b32 v24, v24, v25
    v_lshlrev_b32 v8, 4, v24
    v_bfe_u32 v24, v0, 3, 2
    v_lshl_add_u32 v8, v24, 11, v8
    v_bfe_u32 v24, v0, 5, 1
    v_lshl_add_u32 v8, v24, 16, v8
    v_lshrrev_b32 v24, 6, v0
    v_lshl_add_u32 v8, v24, 14, v8
    v_xor_b32 v9, 64, v8
    v_add_u32 v9, 0x20000, v9
    v_bfe_u32 v24, v0, 4, 2
    v_and_b32 v25, 7, v0
    v_xor_b32 v24, v24, v25
    v_lshlrev_b32 v10, 4, v24
    v_bfe_u32 v24, v0, 3, 3
    v_lshl_add_u32 v10, v24, 11, v10
    v_bfe_u32 v24, v0, 6, 1
    v_lshl_add_u32 v10, v24, 16, v10
    v_xor_b32 v11, 64, v10
    v_add_u32 v11, 0x4000, v11
    v_and_b32 v24, 15, v0
    v_bfe_u32 v25, v0, 7, 1
    v_lshl_add_u32 v24, v25, 6, v24
    v_lshlrev_b32 v24, 1, v24
    s_lshl_b32 s53, s82, 8
    s_mov_b32 s60, s66
    s_and_b32 s61, s67, 0xffff
    s_mov_b32 s62, 0x800
    s_mov_b32 s63, 0x00020000
    buffer_load_ushort v192, v24, s[60:63], s53 offen offset:0
    buffer_load_ushort v200, v24, s[60:63], s53 offen offset:32
    buffer_load_ushort v208, v24, s[60:63], s53 offen offset:64
    buffer_load_ushort v216, v24, s[60:63], s53 offen offset:96
    s_mov_b32 s60, s68
    s_and_b32 s61, s69, 0xffff
    s_mov_b32 s62, 0x800
    s_mov_b32 s63, 0x00020000
    buffer_load_ushort v193, v24, s[60:63], s53 offen offset:0
    buffer_load_ushort v201, v24, s[60:63], s53 offen offset:32
    buffer_load_ushort v209, v24, s[60:63], s53 offen offset:64
    buffer_load_ushort v217, v24, s[60:63], s53 offen offset:96
    s_mov_b32 s60, s78
    s_and_b32 s61, s79, 0xffff
    s_mov_b32 s62, 0x800
    s_mov_b32 s63, 0x00020000
    buffer_load_ushort v194, v24, s[60:63], s53 offen offset:0
    buffer_load_ushort v202, v24, s[60:63], s53 offen offset:32
    buffer_load_ushort v210, v24, s[60:63], s53 offen offset:64
    buffer_load_ushort v218, v24, s[60:63], s53 offen offset:96
    s_mov_b32 s6, 0xfffe8000
    s_mov_b32 s7, 65536
    s_mov_b32 s12, s36
    s_mov_b32 s13, s37
    s_mov_b32 s14, s38
    s_and_b32 s45, s45, 0xffffb7ff
    s_bitcmp1_b32 s94, 1
    s_cselect_b32 s24, s41, 0
    s_cselect_b32 s26, 0, s41
    s_cselect_b32 s60, 0x4000, 0
    s_or_b32 s45, s45, s60
    s_add_u32 s24, s24, s39
    s_add_u32 s26, s26, s39
    s_bitcmp1_b32 s94, 0
    s_cselect_b32 s61, s40, 0
    s_cselect_b32 s62, 0, s40
    s_cselect_b32 s60, 0x800, 0
    s_or_b32 s45, s45, s60
    s_add_u32 s25, s24, s62
    s_add_u32 s24, s24, s61
    s_add_u32 s27, s26, s62
    s_add_u32 s26, s26, s61
    s_mov_b32 s28, s42
    v_mov_b32 v6, v10
    v_mov_b32 v7, v11
    s_mov_b32 s8, s30
    s_mov_b32 s9, s31
    s_mov_b32 s10, s32
    s_and_b32 s44, s44, 0xffffb7ff
    s_bitcmp1_b32 s84, 1
    s_cselect_b32 s20, s35, 0
    s_cselect_b32 s22, 0, s35
    s_cselect_b32 s60, 0x4000, 0
    s_or_b32 s44, s44, s60
    s_add_u32 s20, s20, s33
    s_add_u32 s22, s22, s33
    s_bitcmp1_b32 s84, 0
    s_cselect_b32 s61, s34, 0
    s_cselect_b32 s62, 0, s34
    s_cselect_b32 s60, 0x800, 0
    s_or_b32 s44, s44, s60
    s_add_u32 s21, s20, s62
    s_add_u32 s20, s20, s61
    s_add_u32 s23, s22, s62
    s_add_u32 s22, s22, s61
    v_mov_b32 v4, v8
    v_mov_b32 v5, v9
    s_xor_b32 m0, s45, 0
    s_nop 0
    buffer_load_dwordx4 v6, s[12:15], s24 offen lds
    s_xor_b32 m0, s45, 1024
    s_nop 0
    buffer_load_dwordx4 v7, s[12:15], s24 offen lds
    s_xor_b32 m0, s45, 2048
    s_nop 0
    buffer_load_dwordx4 v6, s[12:15], s25 offen lds
    s_xor_b32 m0, s45, 3072
    s_nop 0
    buffer_load_dwordx4 v7, s[12:15], s25 offen lds
    s_xor_b32 m0, s45, 16384
    s_nop 0
    buffer_load_dwordx4 v6, s[12:15], s26 offen lds
    s_xor_b32 m0, s45, 17408
    s_nop 0
    buffer_load_dwordx4 v7, s[12:15], s26 offen lds
    s_xor_b32 m0, s45, 18432
    s_nop 0
    buffer_load_dwordx4 v6, s[12:15], s27 offen lds
    s_xor_b32 m0, s45, 19456
    s_nop 0
    buffer_load_dwordx4 v7, s[12:15], s27 offen lds
    s_add_u32 s24, s24, s28
    s_add_u32 s25, s25, s28
    s_add_u32 s26, s26, s28
    s_add_u32 s27, s27, s28
    s_cmp_ge_u32 s45, 98304
    s_cselect_b32 s60, s6, s7
    s_add_u32 s45, s45, s60
    s_xor_b32 m0, s44, 0
    s_nop 0
    buffer_load_dwordx4 v4, s[8:11], s20 offen lds
    s_xor_b32 m0, s44, 1024
    s_nop 0
    buffer_load_dwordx4 v5, s[8:11], s20 offen lds
    s_xor_b32 m0, s44, 2048
    s_nop 0
    buffer_load_dwordx4 v4, s[8:11], s21 offen lds
    s_xor_b32 m0, s44, 3072
    s_nop 0
    buffer_load_dwordx4 v5, s[8:11], s21 offen lds
    s_xor_b32 m0, s44, 16384
    s_nop 0
    buffer_load_dwordx4 v4, s[8:11], s22 offen lds
    s_xor_b32 m0, s44, 17408
    s_nop 0
    buffer_load_dwordx4 v5, s[8:11], s22 offen lds
    s_xor_b32 m0, s44, 18432
    s_nop 0
    buffer_load_dwordx4 v4, s[8:11], s23 offen lds
    s_xor_b32 m0, s44, 19456
    s_nop 0
    buffer_load_dwordx4 v5, s[8:11], s23 offen lds
    s_add_u32 s20, s20, 128
    s_add_u32 s21, s21, 128
    s_add_u32 s22, s22, 128
    s_add_u32 s23, s23, 128
    s_cmp_ge_u32 s44, 98304
    s_cselect_b32 s60, s6, s7
    s_add_u32 s44, s44, s60
    s_xor_b32 m0, s45, 0
    s_nop 0
    buffer_load_dwordx4 v6, s[12:15], s24 offen lds
    s_xor_b32 m0, s45, 1024
    s_nop 0
    buffer_load_dwordx4 v7, s[12:15], s24 offen lds
    s_xor_b32 m0, s45, 2048
    s_nop 0
    buffer_load_dwordx4 v6, s[12:15], s25 offen lds
    s_xor_b32 m0, s45, 3072
    s_nop 0
    buffer_load_dwordx4 v7, s[12:15], s25 offen lds
    s_xor_b32 m0, s45, 16384
    s_nop 0
    buffer_load_dwordx4 v6, s[12:15], s26 offen lds
    s_xor_b32 m0, s45, 17408
    s_nop 0
    buffer_load_dwordx4 v7, s[12:15], s26 offen lds
    s_xor_b32 m0, s45, 18432
    s_nop 0
    buffer_load_dwordx4 v6, s[12:15], s27 offen lds
    s_xor_b32 m0, s45, 19456
    s_nop 0
    buffer_load_dwordx4 v7, s[12:15], s27 offen lds
    s_add_u32 s24, s24, s28
    s_add_u32 s25, s25, s28
    s_add_u32 s26, s26, s28
    s_add_u32 s27, s27, s28
    s_cmp_ge_u32 s45, 98304
    s_cselect_b32 s60, s6, s7
    s_add_u32 s45, s45, s60
    s_or_b32 s60, s95, s58
    s_cbranch_scc1 L_rw_50
    s_lshl_b32 s62, s56, 3
    s_add_u32 s62, s62, 160
    s_mov_b32 s63, 0
L_rp_51:
    s_load_dwordx2 s[60:61], s[98:99], s62 glc
    s_add_u32 s63, s63, 1
    s_cmp_gt_u32 s63, 0x100000
    s_cbranch_scc1 chain_kernel_wabort
    s_waitcnt lgkmcnt(0)
    s_cmp_lt_u32 s61, 0x2000
    s_cbranch_scc1 L_rp_51
    s_lshr_b32 s61, s1, 8
    s_cmp_eq_u32 s60, -1
    s_cselect_b32 s0, -1, s61
L_rw_50:
    s_cmp_lg_u32 s95, 0
    s_cbranch_scc1 L_rok_52
    v_mov_b32 v24, 131072
    s_cmp_lg_u32 s58, 0
    s_cbranch_scc1 L_rw_53
    v_mov_b32 v25, s0
    ds_write_b32 v24, v25
    s_waitcnt lgkmcnt(0)
L_rw_53:
    s_barrier
    ds_read_b32 v25, v24
    s_waitcnt lgkmcnt(0)
    v_readfirstlane_b32 s60, v25
    s_mov_b32 s95, 1
    s_cmp_eq_u32 s60, -1
    s_cbranch_scc1 L_rok_52
    s_mov_b32 s17, s60
    s_add_u32 s16, s56, 4
    s_mov_b32 s18, s58
    s_waitcnt vmcnt(0)
    s_barrier
    s_branch chain_kernel_roles
L_rok_52:
    s_add_u32 s39, s39, 0x100000
    s_mov_b32 s16, s100
    s_and_b32 s17, s101, 0xffff
    s_mov_b32 s18, 0xc000000
    s_mov_b32 s19, 0x00020000
    v_mov_b32 v32, -1
    v_mov_b32 v33, -1
    v_mov_b32 v34, -1
    v_mov_b32 v35, -1
    v_lshlrev_b32 v26, 4, v0
    s_lshl_b32 s60, s57, 12
    s_add_u32 s60, s60, 0xb100000
    buffer_store_dwordx4 v[32:35], v26, s[16:19], s60 offen sc1
    s_mov_b32 s18, 0
    s_cmp_lg_u32 s58, 3
    s_cbranch_scc1 L_cal_54
    s_cmp_ge_u32 s57, 15
    s_cbranch_scc1 L_cal_54
    s_lshl_b32 s60, s57, 14
    s_add_u32 s60, s60, 0xb400000
    s_add_u32 s86, s100, s60
    s_addc_u32 s87, s101, 0
    s_mov_b32 s60, 0
    s_atomic_or s60, s[86:87], 0
    s_atomic_or s60, s[86:87], 0x2000
    s_waitcnt lgkmcnt(0)
    s_mov_b32 s61, -1
    s_mov_b32 s62, -1
    s_memtime s[88:89]
    s_atomic_or s60, s[86:87], 0
    s_waitcnt lgkmcnt(0)
    s_memtime s[90:91]
    s_atomic_or s60, s[86:87], 0x2000
    s_waitcnt lgkmcnt(0)
    s_sub_u32 s63, s90, s88
    s_memtime s[88:89]
    s_min_u32 s61, s61, s63
    s_waitcnt lgkmcnt(0)
    s_sub_u32 s63, s88, s90
    s_min_u32 s62, s62, s63
    s_memtime s[88:89]
    s_atomic_or s60, s[86:87], 0
    s_waitcnt lgkmcnt(0)
    s_memtime s[90:91]
    s_atomic_or s60, s[86:87], 0x2000
    s_waitcnt lgkmcnt(0)
    s_sub_u32 s63, s90, s88
    s_memtime s[88:89]
    s_min_u32 s61, s61, s63
    s_waitcnt lgkmcnt(0)
    s_sub_u32 s63, s88, s90
    s_min_u32 s62, s62, s63
    s_memtime s[88:89]
    s_atomic_or s60, s[86:87], 0
    s_waitcnt lgkmcnt(0)
    s_memtime s[90:91]
    s_atomic_or s60, s[86:87], 0x2000
    s_waitcnt lgkmcnt(0)
    s_sub_u32 s63, s90, s88
    s_memtime s[88:89]
    s_min_u32 s61, s61, s63
    s_waitcnt lgkmcnt(0)
    s_sub_u32 s63, s88, s90
    s_min_u32 s62, s62, s63
    s_memtime s[88:89]
    s_atomic_or s60, s[86:87], 0
    s_waitcnt lgkmcnt(0)
    s_memtime s[90:91]
    s_atomic_or s60, s[86:87], 0x2000
    s_waitcnt lgkmcnt(0)
    s_sub_u32 s63, s90, s88
    s_memtime s[88:89]
    s_min_u32 s61, s61, s63
    s_waitcnt lgkmcnt(0)
    s_sub_u32 s63, s88, s90
    s_min_u32 s62, s62, s63
    s_cmp_lt_u32 s62, s61
    s_cselect_b32 s60, 1, 0x101
    s_atomic_add s60, s[98:99], 4
    s_waitcnt lgkmcnt(0)
L_cal_54:
    s_waitcnt vmcnt(25)
    v_lshlrev_b32 v192, 16, v192
    v_lshlrev_b32 v200, 16, v200
    v_lshlrev_b32 v208, 16, v208
    v_lshlrev_b32 v216, 16, v216
    v_lshlrev_b32 v193, 16, v193
    v_lshlrev_b32 v201, 16, v201
    v_lshlrev_b32 v209, 16, v209
    v_lshlrev_b32 v217, 16, v217
    v_lshlrev_b32 v194, 16, v194
    v_lshlrev_b32 v202, 16, v202
    v_lshlrev_b32 v210, 16, v210
    v_lshlrev_b32 v218, 16, v218
    v_mul_f32 v194, 0x3fb8aa3b, v194
    v_mul_f32 v202, 0x3fb8aa3b, v202
    v_mul_f32 v210, 0x3fb8aa3b, v210
    v_mul_f32 v218, 0x3fb8aa3b, v218
    v_exp_f32 v194, v194
    v_exp_f32 v202, v202
    v_exp_f32 v210, v210
    v_exp_f32 v218, v218
    v_cvt_pk_bf16_f32 v194, 0, v194
    v_cvt_pk_bf16_f32 v202, 0, v202
    v_cvt_pk_bf16_f32 v210, 0, v210
    v_cvt_pk_bf16_f32 v218, 0, v218
    v_mul_f32 v195, v194, v192
    v_mul_f32 v203, v202, v200
    v_mul_f32 v211, v210, v208
    v_mul_f32 v219, v218, v216
    v_mul_f32 v196, v194, v193
    v_mul_f32 v204, v202, v201
    v_mul_f32 v212, v210, v209
    v_mul_f32 v220, v218, v217
    v_mul_f32 v195, 0x3fb8aa3b, v195
    v_mul_f32 v203, 0x3fb8aa3b, v203
    v_mul_f32 v211, 0x3fb8aa3b, v211
    v_mul_f32 v219, 0x3fb8aa3b, v219
    v_exp_f32 v195, v195
    v_exp_f32 v203, v203
    v_exp_f32 v211, v211
    v_exp_f32 v219, v219
    v_mul_f32 v196, 0x3e22f983, v196
    v_mul_f32 v204, 0x3e22f983, v204
    v_mul_f32 v212, 0x3e22f983, v212
    v_mul_f32 v220, 0x3e22f983, v220
    v_fract_f32 v196, v196
    v_fract_f32 v204, v204
    v_fract_f32 v212, v212
    v_fract_f32 v220, v220
    v_cos_f32 v197, v196
    v_cos_f32 v205, v204
    v_cos_f32 v213, v212
    v_cos_f32 v221, v220
    v_sin_f32 v198, v196
    v_sin_f32 v206, v204
    v_sin_f32 v214, v212
    v_sin_f32 v222, v220
    v_mul_f32 v88, v195, v197
    v_mul_f32 v90, v203, v205
    v_mul_f32 v92, v211, v213
    v_mul_f32 v94, v219, v221
    v_mul_f32 v89, v195, v198
    v_mul_f32 v91, v203, v206
    v_mul_f32 v93, v211, v214
    v_mul_f32 v95, v219, v222
    v_add_f32 v197, -1.0, v88
    v_add_f32 v205, -1.0, v90
    v_add_f32 v213, -1.0, v92
    v_add_f32 v221, -1.0, v94
    v_mul_f32 v198, v197, v192
    v_mul_f32 v206, v205, v200
    v_mul_f32 v214, v213, v208
    v_mul_f32 v222, v221, v216
    v_fma_f32 v198, v89, v193, v198
    v_fma_f32 v206, v91, v201, v206
    v_fma_f32 v214, v93, v209, v214
    v_fma_f32 v222, v95, v217, v222
    v_mul_f32 v199, v89, v192
    v_mul_f32 v207, v91, v200
    v_mul_f32 v215, v93, v208
    v_mul_f32 v223, v95, v216
    v_fma_f32 v199, -v197, v193, v199
    v_fma_f32 v207, -v205, v201, v207
    v_fma_f32 v215, -v213, v209, v215
    v_fma_f32 v223, -v221, v217, v223
    v_mul_f32 v195, v192, v192
    v_mul_f32 v203, v200, v200
    v_mul_f32 v211, v208, v208
    v_mul_f32 v219, v216, v216
    v_fma_f32 v195, v193, v193, v195
    v_fma_f32 v203, v201, v201, v203
    v_fma_f32 v211, v209, v209, v211
    v_fma_f32 v219, v217, v217, v219
    v_rcp_f32 v195, v195
    v_rcp_f32 v203, v203
    v_rcp_f32 v211, v211
    v_rcp_f32 v219, v219
    v_add_f32 v195, v195, v195
    v_add_f32 v203, v203, v203
    v_add_f32 v211, v211, v211
    v_add_f32 v219, v219, v219
    v_mul_f32 v96, v198, v195
    v_mul_f32 v98, v206, v203
    v_mul_f32 v100, v214, v211
    v_mul_f32 v102, v222, v219
    v_mul_f32 v97, v199, v195
    v_mul_f32 v99, v207, v203
    v_mul_f32 v101, v215, v211
    v_mul_f32 v103, v223, v219
    v_pk_mul_f32 v[192:193], v[88:89], v[88:89] op_sel:[0,0] op_sel_hi:[0,1]
    v_pk_mul_f32 v[200:201], v[90:91], v[90:91] op_sel:[0,0] op_sel_hi:[0,1]
    v_pk_mul_f32 v[208:209], v[92:93], v[92:93] op_sel:[0,0] op_sel_hi:[0,1]
    v_pk_mul_f32 v[216:217], v[94:95], v[94:95] op_sel:[0,0] op_sel_hi:[0,1]
    v_pk_fma_f32 v[104:105], v[88:89], v[88:89], v[192:193] op_sel:[1,1,0] op_sel_hi:[1,0,1] neg_lo:[1,0,0]
    v_pk_fma_f32 v[106:107], v[90:91], v[90:91], v[200:201] op_sel:[1,1,0] op_sel_hi:[1,0,1] neg_lo:[1,0,0]
    v_pk_fma_f32 v[108:109], v[92:93], v[92:93], v[208:209] op_sel:[1,1,0] op_sel_hi:[1,0,1] neg_lo:[1,0,0]
    v_pk_fma_f32 v[110:111], v[94:95], v[94:95], v[216:217] op_sel:[1,1,0] op_sel_hi:[1,0,1] neg_lo:[1,0,0]
    v_pk_mul_f32 v[192:193], v[104:105], v[104:105] op_sel:[0,0] op_sel_hi:[0,1]
    v_pk_mul_f32 v[200:201], v[106:107], v[106:107] op_sel:[0,0] op_sel_hi:[0,1]
    v_pk_mul_f32 v[208:209], v[108:109], v[108:109] op_sel:[0,0] op_sel_hi:[0,1]
    v_pk_mul_f32 v[216:217], v[110:111], v[110:111] op_sel:[0,0] op_sel_hi:[0,1]
    v_pk_fma_f32 v[104:105], v[104:105], v[104:105], v[192:193] op_sel:[1,1,0] op_sel_hi:[1,0,1] neg_lo:[1,0,0]
    v_pk_fma_f32 v[106:107], v[106:107], v[106:107], v[200:201] op_sel:[1,1,0] op_sel_hi:[1,0,1] neg_lo:[1,0,0]
    v_pk_fma_f32 v[108:109], v[108:109], v[108:109], v[208:209] op_sel:[1,1,0] op_sel_hi:[1,0,1] neg_lo:[1,0,0]
    v_pk_fma_f32 v[110:111], v[110:111], v[110:111], v[216:217] op_sel:[1,1,0] op_sel_hi:[1,0,1] neg_lo:[1,0,0]
    v_pk_mul_f32 v[192:193], v[104:105], v[104:105] op_sel:[0,0] op_sel_hi:[0,1]
    v_pk_mul_f32 v[200:201], v[106:107], v[106:107] op_sel:[0,0] op_sel_hi:[0,1]
    v_pk_mul_f32 v[208:209], v[108:109], v[108:109] op_sel:[0,0] op_sel_hi:[0,1]
    v_pk_mul_f32 v[216:217], v[110:111], v[110:111] op_sel:[0,0] op_sel_hi:[0,1]
    v_pk_fma_f32 v[104:105], v[104:105], v[104:105], v[192:193] op_sel:[1,1,0] op_sel_hi:[1,0,1] neg_lo:[1,0,0]
    v_pk_fma_f32 v[106:107], v[106:107], v[106:107], v[200:201] op_sel:[1,1,0] op_sel_hi:[1,0,1] neg_lo:[1,0,0]
    v_pk_fma_f32 v[108:109], v[108:109], v[108:109], v[208:209] op_sel:[1,1,0] op_sel_hi:[1,0,1] neg_lo:[1,0,0]
    v_pk_fma_f32 v[110:111], v[110:111], v[110:111], v[216:217] op_sel:[1,1,0] op_sel_hi:[1,0,1] neg_lo:[1,0,0]
    v_pk_mul_f32 v[192:193], v[104:105], v[104:105] op_sel:[0,0] op_sel_hi:[0,1]
    v_pk_mul_f32 v[200:201], v[106:107], v[106:107] op_sel:[0,0] op_sel_hi:[0,1]
    v_pk_mul_f32 v[208:209], v[108:109], v[108:109] op_sel:[0,0] op_sel_hi:[0,1]
    v_pk_mul_f32 v[216:217], v[110:111], v[110:111] op_sel:[0,0] op_sel_hi:[0,1]
    v_pk_fma_f32 v[104:105], v[104:105], v[104:105], v[192:193] op_sel:[1,1,0] op_sel_hi:[1,0,1] neg_lo:[1,0,0]
    v_pk_fma_f32 v[106:107], v[106:107], v[106:107], v[200:201] op_sel:[1,1,0] op_sel_hi:[1,0,1] neg_lo:[1,0,0]
    v_pk_fma_f32 v[108:109], v[108:109], v[108:109], v[208:209] op_sel:[1,1,0] op_sel_hi:[1,0,1] neg_lo:[1,0,0]
    v_pk_fma_f32 v[110:111], v[110:111], v[110:111], v[216:217] op_sel:[1,1,0] op_sel_hi:[1,0,1] neg_lo:[1,0,0]
    v_pk_mul_f32 v[192:193], v[104:105], v[104:105] op_sel:[0,0] op_sel_hi:[0,1]
    v_pk_mul_f32 v[200:201], v[106:107], v[106:107] op_sel:[0,0] op_sel_hi:[0,1]
    v_pk_mul_f32 v[208:209], v[108:109], v[108:109] op_sel:[0,0] op_sel_hi:[0,1]
    v_pk_mul_f32 v[216:217], v[110:111], v[110:111] op_sel:[0,0] op_sel_hi:[0,1]
    v_pk_fma_f32 v[104:105], v[104:105], v[104:105], v[192:193] op_sel:[1,1,0] op_sel_hi:[1,0,1] neg_lo:[1,0,0]
    v_pk_fma_f32 v[106:107], v[106:107], v[106:107], v[200:201] op_sel:[1,1,0] op_sel_hi:[1,0,1] neg_lo:[1,0,0]
    v_pk_fma_f32 v[108:109], v[108:109], v[108:109], v[208:209] op_sel:[1,1,0] op_sel_hi:[1,0,1] neg_lo:[1,0,0]
    v_pk_fma_f32 v[110:111], v[110:111], v[110:111], v[216:217] op_sel:[1,1,0] op_sel_hi:[1,0,1] neg_lo:[1,0,0]
    v_pk_mul_f32 v[192:193], v[104:105], v[104:105] op_sel:[0,0] op_sel_hi:[0,1]
    v_pk_mul_f32 v[200:201], v[106:107], v[106:107] op_sel:[0,0] op_sel_hi:[0,1]
    v_pk_mul_f32 v[208:209], v[108:109], v[108:109] op_sel:[0,0] op_sel_hi:[0,1]
    v_pk_mul_f32 v[216:217], v[110:111], v[110:111] op_sel:[0,0] op_sel_hi:[0,1]
    v_pk_fma_f32 v[112:113], v[104:105], v[104:105], v[192:193] op_sel:[1,1,0] op_sel_hi:[1,0,1] neg_lo:[1,0,0]
    v_pk_fma_f32 v[114:115], v[106:107], v[106:107], v[200:201] op_sel:[1,1,0] op_sel_hi:[1,0,1] neg_lo:[1,0,0]
    v_pk_fma_f32 v[116:117], v[108:109], v[108:109], v[208:209] op_sel:[1,1,0] op_sel_hi:[1,0,1] neg_lo:[1,0,0]
    v_pk_fma_f32 v[118:119], v[110:111], v[110:111], v[216:217] op_sel:[1,1,0] op_sel_hi:[1,0,1] neg_lo:[1,0,0]
    v_pk_mul_f32 v[192:193], v[112:113], v[112:113] op_sel:[0,0] op_sel_hi:[0,1]
    v_pk_mul_f32 v[200:201], v[114:115], v[114:115] op_sel:[0,0] op_sel_hi:[0,1]
    v_pk_mul_f32 v[208:209], v[116:117], v[116:117] op_sel:[0,0] op_sel_hi:[0,1]
    v_pk_mul_f32 v[216:217], v[118:119], v[118:119] op_sel:[0,0] op_sel_hi:[0,1]
    v_pk_fma_f32 v[196:197], v[112:113], v[112:113], v[192:193] op_sel:[1,1,0] op_sel_hi:[1,0,1] neg_lo:[1,0,0]
    v_pk_fma_f32 v[204:205], v[114:115], v[114:115], v[200:201] op_sel:[1,1,0] op_sel_hi:[1,0,1] neg_lo:[1,0,0]
    v_pk_fma_f32 v[212:213], v[116:117], v[116:117], v[208:209] op_sel:[1,1,0] op_sel_hi:[1,0,1] neg_lo:[1,0,0]
    v_pk_fma_f32 v[220:221], v[118:119], v[118:119], v[216:217] op_sel:[1,1,0] op_sel_hi:[1,0,1] neg_lo:[1,0,0]
    s_mov_b32 exec_lo, 0xffffffff
    s_mov_b32 exec_hi, 0xffffffff
    v_mov_b32 v120, v196
    v_mov_b32 v121, v197
    s_mov_b32 exec_lo, 0xffff0000
    s_mov_b32 exec_hi, 0xffffffff
    v_mov_b32 v120, v204
    v_mov_b32 v121, v205
    s_mov_b32 exec_lo, 0x0
    s_mov_b32 exec_hi, 0xffffffff
    v_mov_b32 v120, v212
    v_mov_b32 v121, v213
    s_mov_b32 exec_lo, 0x0
    s_mov_b32 exec_hi, 0xffff0000
    v_mov_b32 v120, v220
    v_mov_b32 v121, v221
    s_mov_b64 exec, -1
    s_cmp_eq_u32 s58, 0
    s_cselect_b32 s1, 20, 0
    s_mov_b32 s4, 0
    s_mov_b32 s3, 20
    s_mov_b32 s2, 32
    s_mov_b32 s50, 0
    s_mov_b32 s5, 0
    s_mov_b32 s51, 0
    s_mov_b32 s52, 0
    s_waitcnt vmcnt(9)
    s_barrier
    s_call_b64 s[54:55], t_g1
    v_mov_b32 v125, 0
    s_mov_b32 s62, 0
L_pp_55:
    v_readfirstlane_b32 s59, v125
    s_and_b32 s60, s59, 0xff
    s_cmp_ge_u32 s60, 15
    s_cbranch_scc1 L_pok_56
    v_mov_b32 v24, 4
    global_load_dword v125, v24, s[98:99] sc1
    s_add_u32 s62, s62, 1
    s_cmp_gt_u32 s62, 0x200000
    s_cbranch_scc1 chain_kernel_wabort
    s_waitcnt vmcnt(0)
    s_branch L_pp_55
L_pok_56:
    s_cmp_ge_u32 s59, 0x800
    s_cselect_b32 s59, 0x2000, 0
    s_call_b64 s[54:55], t_scan
    s_add_u32 s82, s82, 4
    v_and_b32 v24, 15, v0
    v_bfe_u32 v25, v0, 7, 1
    v_lshl_add_u32 v24, v25, 6, v24
    v_lshlrev_b32 v24, 1, v24
    s_lshl_b32 s53, s82, 8
    s_mov_b32 s60, s66
    s_and_b32 s61, s67, 0xffff
    s_mov_b32 s62, 0x800
    s_mov_b32 s63, 0x00020000
    buffer_load_ushort v40, v24, s[60:63], s53 offen offset:0
    buffer_load_ushort v48, v24, s[60:63], s53 offen offset:32
    buffer_load_ushort v56, v24, s[60:63], s53 offen offset:64
    buffer_load_ushort v64, v24, s[60:63], s53 offen offset:96
    s_mov_b32 s60, s68
    s_and_b32 s61, s69, 0xffff
    s_mov_b32 s62, 0x800
    s_mov_b32 s63, 0x00020000
    buffer_load_ushort v41, v24, s[60:63], s53 offen offset:0
    buffer_load_ushort v49, v24, s[60:63], s53 offen offset:32
    buffer_load_ushort v57, v24, s[60:63], s53 offen offset:64
    buffer_load_ushort v65, v24, s[60:63], s53 offen offset:96
    s_mov_b32 s60, s78
    s_and_b32 s61, s79, 0xffff
    s_mov_b32 s62, 0x800
    s_mov_b32 s63, 0x00020000
    buffer_load_ushort v42, v24, s[60:63], s53 offen offset:0
    buffer_load_ushort v50, v24, s[60:63], s53 offen offset:32
    buffer_load_ushort v58, v24, s[60:63], s53 offen offset:64
    buffer_load_ushort v66, v24, s[60:63], s53 offen offset:96
    s_and_b32 s62, s57, 7
    s_lshr_b32 s63, s57, 3
    s_lshl_b32 s60, s63, 19
    s_add_u32 s60, s60, 0
    s_mov_b32 s30, s74
    s_and_b32 s31, s75, 0xffff
    s_mov_b32 s32, 0x200000
    s_mov_b32 s33, s60
    s_mov_b32 s34, 0x8000
    s_mov_b32 s35, 0x40000
    s_lshl_b32 s61, s62, 13
    s_andn2_b32 s61, 0x2000, s61
    s_xor_b32 s61, s61, s59
    s_lshl_b32 s60, s62, 21
    s_add_u32 s60, s60, s61
    s_add_u32 s60, s60, 0x0
    s_add_u32 s36, s100, 0xa000000
    s_addc_u32 s37, s101, 0
    s_and_b32 s37, s37, 0xffff
    s_mov_b32 s38, 0x1000000
    s_mov_b32 s39, s60
    s_mov_b32 s40, 0x800
    s_mov_b32 s41, 0x8000
    s_mov_b32 s42, 0x10000
    s_mov_b32 s84, s62
    s_lshl_b32 s94, s63, 0
    v_bfe_u32 v24, v0, 4, 2
    v_and_b32 v25, 7, v0
    v_xor_b32 v24, v24, v25
    v_lshlrev_b32 v8, 4, v24
    v_bfe_u32 v24, v0, 3, 3
    v_lshl_add_u32 v8, v24, 11, v8
    v_bfe_u32 v24, v0, 6, 2
    v_lshl_add_u32 v8, v24, 16, v8
    v_xor_b32 v9, 64, v8
    v_add_u32 v9, 0x4000, v9
    s_lshr_b32 s61, s58, 1
    s_lshl_b32 s61, s61, 14
    v_add_u32 v10, s61, v1
    s_and_b32 s61, s58, 1
    s_lshl_b32 s61, s61, 12
    v_add_u32 v10, s61, v10
    v_add_u32 v11, 1024, v10
    s_mov_b32 s18, 0xc000000
    s_mov_b32 s4, 12
    s_mov_b32 s3, 12
    s_waitcnt vmcnt(0)
    v_lshlrev_b32 v40, 16, v40
    v_lshlrev_b32 v48, 16, v48
    v_lshlrev_b32 v56, 16, v56
    v_lshlrev_b32 v64, 16, v64
    v_lshlrev_b32 v41, 16, v41
    v_lshlrev_b32 v49, 16, v49
    v_lshlrev_b32 v57, 16, v57
    v_lshlrev_b32 v65, 16, v65
    v_lshlrev_b32 v42, 16, v42
    v_lshlrev_b32 v50, 16, v50
    v_lshlrev_b32 v58, 16, v58
    v_lshlrev_b32 v66, 16, v66
    v_mul_f32 v42, 0x3fb8aa3b, v42
    v_mul_f32 v50, 0x3fb8aa3b, v50
    v_mul_f32 v58, 0x3fb8aa3b, v58
    v_mul_f32 v66, 0x3fb8aa3b, v66
    v_exp_f32 v42, v42
    v_exp_f32 v50, v50
    v_exp_f32 v58, v58
    v_exp_f32 v66, v66
    v_cvt_pk_bf16_f32 v42, 0, v42
    v_cvt_pk_bf16_f32 v50, 0, v50
    v_cvt_pk_bf16_f32 v58, 0, v58
    v_cvt_pk_bf16_f32 v66, 0, v66
    v_mul_f32 v43, v42, v40
    v_mul_f32 v51, v50, v48
    v_mul_f32 v59, v58, v56
    v_mul_f32 v67, v66, v64
    v_mul_f32 v44, v42, v41
    v_mul_f32 v52, v50, v49
    v_mul_f32 v60, v58, v57
    v_mul_f32 v68, v66, v65
    v_mul_f32 v43, 0x3fb8aa3b, v43
    v_mul_f32 v51, 0x3fb8aa3b, v51
    v_mul_f32 v59, 0x3fb8aa3b, v59
    v_mul_f32 v67, 0x3fb8aa3b, v67
    v_exp_f32 v43, v43
    v_exp_f32 v51, v51
    v_exp_f32 v59, v59
    v_exp_f32 v67, v67
    v_mul_f32 v44, 0x3e22f983, v44
    v_mul_f32 v52, 0x3e22f983, v52
    v_mul_f32 v60, 0x3e22f983, v60
    v_mul_f32 v68, 0x3e22f983, v68
    v_fract_f32 v44, v44
    v_fract_f32 v52, v52
    v_fract_f32 v60, v60
    v_fract_f32 v68, v68
    v_cos_f32 v45, v44
    v_cos_f32 v53, v52
    v_cos_f32 v61, v60
    v_cos_f32 v69, v68
    v_sin_f32 v46, v44
    v_sin_f32 v54, v52
    v_sin_f32 v62, v60
    v_sin_f32 v70, v68
    v_mul_f32 v88, v43, v45
    v_mul_f32 v90, v51, v53
    v_mul_f32 v92, v59, v61
    v_mul_f32 v94, v67, v69
    v_mul_f32 v89, v43, v46
    v_mul_f32 v91, v51, v54
    v_mul_f32 v93, v59, v62
    v_mul_f32 v95, v67, v70
    v_add_f32 v45, -1.0, v88
    v_add_f32 v53, -1.0, v90
    v_add_f32 v61, -1.0, v92
    v_add_f32 v69, -1.0, v94
    v_mul_f32 v46, v45, v40
    v_mul_f32 v54, v53, v48
    v_mul_f32 v62, v61, v56
    v_mul_f32 v70, v69, v64
    v_fma_f32 v46, v89, v41, v46
    v_fma_f32 v54, v91, v49, v54
    v_fma_f32 v62, v93, v57, v62
    v_fma_f32 v70, v95, v65, v70
    v_mul_f32 v47, v89, v40
    v_mul_f32 v55, v91, v48
    v_mul_f32 v63, v93, v56
    v_mul_f32 v71, v95, v64
    v_fma_f32 v47, -v45, v41, v47
    v_fma_f32 v55, -v53, v49, v55
    v_fma_f32 v63, -v61, v57, v63
    v_fma_f32 v71, -v69, v65, v71
    v_mul_f32 v43, v40, v40
    v_mul_f32 v51, v48, v48
    v_mul_f32 v59, v56, v56
    v_mul_f32 v67, v64, v64
    v_fma_f32 v43, v41, v41, v43
    v_fma_f32 v51, v49, v49, v51
    v_fma_f32 v59, v57, v57, v59
    v_fma_f32 v67, v65, v65, v67
    v_rcp_f32 v43, v43
    v_rcp_f32 v51, v51
    v_rcp_f32 v59, v59
    v_rcp_f32 v67, v67
    v_add_f32 v43, v43, v43
    v_add_f32 v51, v51, v51
    v_add_f32 v59, v59, v59
    v_add_f32 v67, v67, v67
    v_mul_f32 v96, v46, v43
    v_mul_f32 v98, v54, v51
    v_mul_f32 v100, v62, v59
    v_mul_f32 v102, v70, v67
    v_mul_f32 v97, v47, v43
    v_mul_f32 v99, v55, v51
    v_mul_f32 v101, v63, v59
    v_mul_f32 v103, v71, v67
    v_pk_mul_f32 v[40:41], v[88:89], v[88:89] op_sel:[0,0] op_sel_hi:[0,1]
    v_pk_mul_f32 v[48:49], v[90:91], v[90:91] op_sel:[0,0] op_sel_hi:[0,1]
    v_pk_mul_f32 v[56:57], v[92:93], v[92:93] op_sel:[0,0] op_sel_hi:[0,1]
    v_pk_mul_f32 v[64:65], v[94:95], v[94:95] op_sel:[0,0] op_sel_hi:[0,1]
    v_pk_fma_f32 v[104:105], v[88:89], v[88:89], v[40:41] op_sel:[1,1,0] op_sel_hi:[1,0,1] neg_lo:[1,0,0]
    v_pk_fma_f32 v[106:107], v[90:91], v[90:91], v[48:49] op_sel:[1,1,0] op_sel_hi:[1,0,1] neg_lo:[1,0,0]
    v_pk_fma_f32 v[108:109], v[92:93], v[92:93], v[56:57] op_sel:[1,1,0] op_sel_hi:[1,0,1] neg_lo:[1,0,0]
    v_pk_fma_f32 v[110:111], v[94:95], v[94:95], v[64:65] op_sel:[1,1,0] op_sel_hi:[1,0,1] neg_lo:[1,0,0]
    v_pk_mul_f32 v[40:41], v[104:105], v[104:105] op_sel:[0,0] op_sel_hi:[0,1]
    v_pk_mul_f32 v[48:49], v[106:107], v[106:107] op_sel:[0,0] op_sel_hi:[0,1]
    v_pk_mul_f32 v[56:57], v[108:109], v[108:109] op_sel:[0,0] op_sel_hi:[0,1]
    v_pk_mul_f32 v[64:65], v[110:111], v[110:111] op_sel:[0,0] op_sel_hi:[0,1]
    v_pk_fma_f32 v[104:105], v[104:105], v[104:105], v[40:41] op_sel:[1,1,0] op_sel_hi:[1,0,1] neg_lo:[1,0,0]
    v_pk_fma_f32 v[106:107], v[106:107], v[106:107], v[48:49] op_sel:[1,1,0] op_sel_hi:[1,0,1] neg_lo:[1,0,0]
    v_pk_fma_f32 v[108:109], v[108:109], v[108:109], v[56:57] op_sel:[1,1,0] op_sel_hi:[1,0,1] neg_lo:[1,0,0]
    v_pk_fma_f32 v[110:111], v[110:111], v[110:111], v[64:65] op_sel:[1,1,0] op_sel_hi:[1,0,1] neg_lo:[1,0,0]
    v_pk_mul_f32 v[40:41], v[104:105], v[104:105] op_sel:[0,0] op_sel_hi:[0,1]
    v_pk_mul_f32 v[48:49], v[106:107], v[106:107] op_sel:[0,0] op_sel_hi:[0,1]
    v_pk_mul_f32 v[56:57], v[108:109], v[108:109] op_sel:[0,0] op_sel_hi:[0,1]
    v_pk_mul_f32 v[64:65], v[110:111], v[110:111] op_sel:[0,0] op_sel_hi:[0,1]
    v_pk_fma_f32 v[104:105], v[104:105], v[104:105], v[40:41] op_sel:[1,1,0] op_sel_hi:[1,0,1] neg_lo:[1,0,0]
    v_pk_fma_f32 v[106:107], v[106:107], v[106:107], v[48:49] op_sel:[1,1,0] op_sel_hi:[1,0,1] neg_lo:[1,0,0]
    v_pk_fma_f32 v[108:109], v[108:109], v[108:109], v[56:57] op_sel:[1,1,0] op_sel_hi:[1,0,1] neg_lo:[1,0,0]
    v_pk_fma_f32 v[110:111], v[110:111], v[110:111], v[64:65] op_sel:[1,1,0] op_sel_hi:[1,0,1] neg_lo:[1,0,0]
    v_pk_mul_f32 v[40:41], v[104:105], v[104:105] op_sel:[0,0] op_sel_hi:[0,1]
    v_pk_mul_f32 v[48:49], v[106:107], v[106:107] op_sel:[0,0] op_sel_hi:[0,1]
    v_pk_mul_f32 v[56:57], v[108:109], v[108:109] op_sel:[0,0] op_sel_hi:[0,1]
    v_pk_mul_f32 v[64:65], v[110:111], v[110:111] op_sel:[0,0] op_sel_hi:[0,1]
    v_pk_fma_f32 v[104:105], v[104:105], v[104:105], v[40:41] op_sel:[1,1,0] op_sel_hi:[1,0,1] neg_lo:[1,0,0]
    v_pk_fma_f32 v[106:107], v[106:107], v[106:107], v[48:49] op_sel:[1,1,0] op_sel_hi:[1,0,1] neg_lo:[1,0,0]
    v_pk_fma_f32 v[108:109], v[108:109], v[108:109], v[56:57] op_sel:[1,1,0] op_sel_hi:[1,0,1] neg_lo:[1,0,0]
    v_pk_fma_f32 v[110:111], v[110:111], v[110:111], v[64:65] op_sel:[1,1,0] op_sel_hi:[1,0,1] neg_lo:[1,0,0]
    v_pk_mul_f32 v[40:41], v[104:105], v[104:105] op_sel:[0,0] op_sel_hi:[0,1]
    v_pk_mul_f32 v[48:49], v[106:107], v[106:107] op_sel:[0,0] op_sel_hi:[0,1]
    v_pk_mul_f32 v[56:57], v[108:109], v[108:109] op_sel:[0,0] op_sel_hi:[0,1]
    v_pk_mul_f32 v[64:65], v[110:111], v[110:111] op_sel:[0,0] op_sel_hi:[0,1]
    v_pk_fma_f32 v[104:105], v[104:105], v[104:105], v[40:41] op_sel:[1,1,0] op_sel_hi:[1,0,1] neg_lo:[1,0,0]
    v_pk_fma_f32 v[106:107], v[106:107], v[106:107], v[48:49] op_sel:[1,1,0] op_sel_hi:[1,0,1] neg_lo:[1,0,0]
    v_pk_fma_f32 v[108:109], v[108:109], v[108:109], v[56:57] op_sel:[1,1,0] op_sel_hi:[1,0,1] neg_lo:[1,0,0]
    v_pk_fma_f32 v[110:111], v[110:111], v[110:111], v[64:65] op_sel:[1,1,0] op_sel_hi:[1,0,1] neg_lo:[1,0,0]
    v_pk_mul_f32 v[40:41], v[104:105], v[104:105] op_sel:[0,0] op_sel_hi:[0,1]
    v_pk_mul_f32 v[48:49], v[106:107], v[106:107] op_sel:[0,0] op_sel_hi:[0,1]
    v_pk_mul_f32 v[56:57], v[108:109], v[108:109] op_sel:[0,0] op_sel_hi:[0,1]
    v_pk_mul_f32 v[64:65], v[110:111], v[110:111] op_sel:[0,0] op_sel_hi:[0,1]
    v_pk_fma_f32 v[112:113], v[104:105], v[104:105], v[40:41] op_sel:[1,1,0] op_sel_hi:[1,0,1] neg_lo:[1,0,0]
    v_pk_fma_f32 v[114:115], v[106:107], v[106:107], v[48:49] op_sel:[1,1,0] op_sel_hi:[1,0,1] neg_lo:[1,0,0]
    v_pk_fma_f32 v[116:117], v[108:109], v[108:109], v[56:57] op_sel:[1,1,0] op_sel_hi:[1,0,1] neg_lo:[1,0,0]
    v_pk_fma_f32 v[118:119], v[110:111], v[110:111], v[64:65] op_sel:[1,1,0] op_sel_hi:[1,0,1] neg_lo:[1,0,0]
    v_pk_mul_f32 v[40:41], v[112:113], v[112:113] op_sel:[0,0] op_sel_hi:[0,1]
    v_pk_mul_f32 v[48:49], v[114:115], v[114:115] op_sel:[0,0] op_sel_hi:[0,1]
    v_pk_mul_f32 v[56:57], v[116:117], v[116:117] op_sel:[0,0] op_sel_hi:[0,1]
    v_pk_mul_f32 v[64:65], v[118:119], v[118:119] op_sel:[0,0] op_sel_hi:[0,1]
    v_pk_fma_f32 v[44:45], v[112:113], v[112:113], v[40:41] op_sel:[1,1,0] op_sel_hi:[1,0,1] neg_lo:[1,0,0]
    v_pk_fma_f32 v[52:53], v[114:115], v[114:115], v[48:49] op_sel:[1,1,0] op_sel_hi:[1,0,1] neg_lo:[1,0,0]
    v_pk_fma_f32 v[60:61], v[116:117], v[116:117], v[56:57] op_sel:[1,1,0] op_sel_hi:[1,0,1] neg_lo:[1,0,0]
    v_pk_fma_f32 v[68:69], v[118:119], v[118:119], v[64:65] op_sel:[1,1,0] op_sel_hi:[1,0,1] neg_lo:[1,0,0]
    s_mov_b32 exec_lo, 0xffffffff
    s_mov_b32 exec_hi, 0xffffffff
    v_mov_b32 v120, v44
    v_mov_b32 v121, v45
    s_mov_b32 exec_lo, 0xffff0000
    s_mov_b32 exec_hi, 0xffffffff
    v_mov_b32 v120, v52
    v_mov_b32 v121, v53
    s_mov_b32 exec_lo, 0x0
    s_mov_b32 exec_hi, 0xffffffff
    v_mov_b32 v120, v60
    v_mov_b32 v121, v61
    s_mov_b32 exec_lo, 0x0
    s_mov_b32 exec_hi, 0xffff0000
    v_mov_b32 v120, v68
    v_mov_b32 v121, v69
    s_mov_b64 exec, -1
    s_call_b64 s[54:55], t_g1
    s_call_b64 s[54:55], t_scan
    s_and_b32 s62, s57, 7
    s_lshr_b32 s63, s57, 3
    s_lshl_b32 s60, s63, 19
    s_add_u32 s60, s60, 0
    s_mov_b32 s30, s76
    s_and_b32 s31, s77, 0xffff
    s_mov_b32 s32, 0x200000
    s_mov_b32 s33, s60
    s_mov_b32 s34, 0x8000
    s_mov_b32 s35, 0x40000
    s_lshl_b32 s61, s62, 13
    s_andn2_b32 s61, 0x2000, s61
    s_xor_b32 s61, s61, s59
    s_lshl_b32 s60, s62, 21
    s_add_u32 s60, s60, s61
    s_add_u32 s60, s60, 0x80000
    s_add_u32 s36, s100, 0xa000000
    s_addc_u32 s37, s101, 0
    s_and_b32 s37, s37, 0xffff
    s_mov_b32 s38, 0x1000000
    s_mov_b32 s39, s60
    s_mov_b32 s40, 0x800
    s_mov_b32 s41, 0x8000
    s_mov_b32 s42, 0x10000
    s_mov_b32 s84, s62
    s_lshl_b32 s94, s63, 0
    s_mov_b32 s3, 0
    s_call_b64 s[54:55], t_g2
    s_and_b32 s62, s57, 7
    s_lshr_b32 s63, s57, 3
    s_lshl_b32 s60, s63, 19
    s_add_u32 s60, s60, 1024
    s_mov_b32 s30, s74
    s_and_b32 s31, s75, 0xffff
    s_mov_b32 s32, 0x200000
    s_mov_b32 s33, s60
    s_mov_b32 s34, 0x8000
    s_mov_b32 s35, 0x40000
    s_lshl_b32 s61, s62, 13
    s_andn2_b32 s61, 0x2000, s61
    s_xor_b32 s61, s61, s59
    s_lshl_b32 s60, s62, 21
    s_add_u32 s60, s60, s61
    s_add_u32 s60, s60, 0x100000
    s_add_u32 s36, s100, 0xa000000
    s_addc_u32 s37, s101, 0
    s_and_b32 s37, s37, 0xffff
    s_mov_b32 s38, 0x1000000
    s_mov_b32 s39, s60
    s_mov_b32 s40, 0x800
    s_mov_b32 s41, 0x8000
    s_mov_b32 s42, 0x10000
    s_mov_b32 s84, s62
    s_lshl_b32 s94, s63, 0
    s_mov_b32 s18, 0
    s_cmp_eq_u32 s58, 0
    s_cselect_b32 s1, 16, 0
    s_mov_b32 s3, 16
    s_call_b64 s[54:55], t_g2_c
    s_and_b32 s62, s57, 7
    s_lshr_b32 s63, s57, 3
    s_lshl_b32 s60, s63, 19
    s_add_u32 s60, s60, 1024
    s_mov_b32 s30, s76
    s_and_b32 s31, s77, 0xffff
    s_mov_b32 s32, 0x200000
    s_mov_b32 s33, s60
    s_mov_b32 s34, 0x8000
    s_mov_b32 s35, 0x40000
    s_lshl_b32 s61, s62, 13
    s_andn2_b32 s61, 0x2000, s61
    s_xor_b32 s61, s61, s59
    s_lshl_b32 s60, s62, 21
    s_add_u32 s60, s60, s61
    s_add_u32 s60, s60, 0x180000
    s_add_u32 s36, s100, 0xa000000
    s_addc_u32 s37, s101, 0
    s_and_b32 s37, s37, 0xffff
    s_mov_b32 s38, 0x1000000
    s_mov_b32 s39, s60
    s_mov_b32 s40, 0x800
    s_mov_b32 s41, 0x8000
    s_mov_b32 s42, 0x10000
    s_mov_b32 s84, s62
    s_lshl_b32 s94, s63, 0
    s_mov_b32 s3, 0
    s_call_b64 s[54:55], t_g2_c
    s_mov_b32 s32, 0
    s_mov_b32 s38, 0
    s_call_b64 s[54:55], t_g2_c
    s_and_b32 s85, s57, 7
    s_lshr_b32 s82, s57, 3
    s_waitcnt vmcnt(0)
    s_barrier
    v_and_b32 v26, 31, v0
    v_bfe_u32 v25, v0, 6, 1
    v_lshl_add_u32 v27, v25, 5, v26
    v_bfe_u32 v28, v0, 5, 1
    v_bfe_u32 v24, v0, 7, 1
    v_lshl_add_u32 v24, v24, 7, v28
    v_lshlrev_b32 v25, 13, v24
    v_lshl_add_u32 v25, v27, 4, v25
    v_lshlrev_b32 v24, 11, v24
    v_lshl_add_u32 v24, v27, 3, v24
    v_lshlrev_b32 v27, 3, v27
    s_mov_b32 s60, s80
    s_and_b32 s61, s81, 0xffff
    s_mov_b32 s62, 0x800
    s_mov_b32 s63, 0x00020000
    s_lshl_b32 s53, s82, 9
    buffer_load_dwordx2 v[44:45], v27, s[60:63], s53 offen
    s_mov_b32 s8, s64
    s_and_b32 s9, s65, 0xffff
    s_mov_b32 s10, 0x400000
    s_mov_b32 s11, 0x00020000
    s_mov_b32 s12, s96
    s_and_b32 s13, s97, 0xffff
    s_mov_b32 s14, 0x1000000
    s_mov_b32 s15, 0x00020000
    s_lshl_b32 s50, s85, 19
    s_add_u32 s50, s50, s53
    s_add_u32 s53, s50, 0x0
    buffer_load_dwordx2 v[128:129], v24, s[8:11], s53 offen
    s_add_u32 s53, s50, 0x1000
    buffer_load_dwordx2 v[130:131], v24, s[8:11], s53 offen
    s_add_u32 s53, s50, 0x2000
    buffer_load_dwordx2 v[132:133], v24, s[8:11], s53 offen
    s_add_u32 s53, s50, 0x3000
    buffer_load_dwordx2 v[134:135], v24, s[8:11], s53 offen
    s_add_u32 s53, s50, 0x10000
    buffer_load_dwordx2 v[136:137], v24, s[8:11], s53 offen
    s_add_u32 s53, s50, 0x11000
    buffer_load_dwordx2 v[138:139], v24, s[8:11], s53 offen
    s_add_u32 s53, s50, 0x12000
    buffer_load_dwordx2 v[140:141], v24, s[8:11], s53 offen
    s_add_u32 s53, s50, 0x13000
    buffer_load_dwordx2 v[142:143], v24, s[8:11], s53 offen
    s_add_u32 s53, s50, 0x20000
    buffer_load_dwordx2 v[144:145], v24, s[8:11], s53 offen
    s_add_u32 s53, s50, 0x21000
    buffer_load_dwordx2 v[146:147], v24, s[8:11], s53 offen
    s_add_u32 s53, s50, 0x22000
    buffer_load_dwordx2 v[148:149], v24, s[8:11], s53 offen
    s_add_u32 s53, s50, 0x23000
    buffer_load_dwordx2 v[150:151], v24, s[8:11], s53 offen
    s_add_u32 s53, s50, 0x30000
    buffer_load_dwordx2 v[152:153], v24, s[8:11], s53 offen
    s_add_u32 s53, s50, 0x31000
    buffer_load_dwordx2 v[154:155], v24, s[8:11], s53 offen
    s_add_u32 s53, s50, 0x32000
    buffer_load_dwordx2 v[156:157], v24, s[8:11], s53 offen
    s_add_u32 s53, s50, 0x33000
    buffer_load_dwordx2 v[158:159], v24, s[8:11], s53 offen
    s_add_u32 s53, s50, 0x4000
    buffer_load_dwordx2 v[160:161], v24, s[8:11], s53 offen
    s_add_u32 s53, s50, 0x5000
    buffer_load_dwordx2 v[162:163], v24, s[8:11], s53 offen
    s_add_u32 s53, s50, 0x6000
    buffer_load_dwordx2 v[164:165], v24, s[8:11], s53 offen
    s_add_u32 s53, s50, 0x7000
    buffer_load_dwordx2 v[166:167], v24, s[8:11], s53 offen
    s_add_u32 s53, s50, 0x14000
    buffer_load_dwordx2 v[168:169], v24, s[8:11], s53 offen
    s_add_u32 s53, s50, 0x15000
    buffer_load_dwordx2 v[170:171], v24, s[8:11], s53 offen
    s_add_u32 s53, s50, 0x16000
    buffer_load_dwordx2 v[172:173], v24, s[8:11], s53 offen
    s_add_u32 s53, s50, 0x17000
    buffer_load_dwordx2 v[174:175], v24, s[8:11], s53 offen
    s_add_u32 s53, s50, 0x24000
    buffer_load_dwordx2 v[176:177], v24, s[8:11], s53 offen
    s_add_u32 s53, s50, 0x25000
    buffer_load_dwordx2 v[178:179], v24, s[8:11], s53 offen
    s_add_u32 s53, s50, 0x26000
    buffer_load_dwordx2 v[180:181], v24, s[8:11], s53 offen
    s_add_u32 s53, s50, 0x27000
    buffer_load_dwordx2 v[182:183], v24, s[8:11], s53 offen
    s_add_u32 s53, s50, 0x34000
    buffer_load_dwordx2 v[184:185], v24, s[8:11], s53 offen
    s_add_u32 s53, s50, 0x35000
    buffer_load_dwordx2 v[186:187], v24, s[8:11], s53 offen
    s_add_u32 s53, s50, 0x36000
    buffer_load_dwordx2 v[188:189], v24, s[8:11], s53 offen
    s_add_u32 s53, s50, 0x37000
    buffer_load_dwordx2 v[190:191], v24, s[8:11], s53 offen
    s_mul_i32 s60, s58, 33792
    v_mul_u32_u24 v28, 528, v28
    v_lshl_add_u32 v28, v26, 4, v28
    v_add_u32 v28, s60, v28
    v_and_b32 v27, 15, v0
    v_mul_u32_u24 v27, 528, v27
    v_bfe_u32 v26, v0, 4, 2
    v_lshl_add_u32 v27, v26, 4, v27
    v_add_u32 v27, s60, v27
    s_lshl_b32 s51, s85, 21
    s_lshl_b32 s52, s82, 10
    s_add_u32 s51, s51, s52
    ds_write_b128 v27, a[0:3] offset:0
    ds_write_b128 v27, a[32:35] offset:64
    ds_write_b128 v27, a[64:67] offset:128
    ds_write_b128 v27, a[96:99] offset:192
    ds_write_b128 v27, a[128:131] offset:256
    ds_write_b128 v27, a[160:163] offset:320
    ds_write_b128 v27, a[192:195] offset:384
    ds_write_b128 v27, a[224:227] offset:448
    ds_read_b128 v[48:51], v28 offset:0
    ds_read_b128 v[52:55], v28 offset:1056
    ds_read_b128 v[56:59], v28 offset:2112
    ds_read_b128 v[60:63], v28 offset:3168
    ds_read_b128 v[64:67], v28 offset:4224
    ds_read_b128 v[68:71], v28 offset:5280
    ds_read_b128 v[72:75], v28 offset:6336
    ds_read_b128 v[76:79], v28 offset:7392
    ds_write_b128 v27, a[4:7] offset:8448
    ds_write_b128 v27, a[36:39] offset:8512
    ds_write_b128 v27, a[68:71] offset:8576
    ds_write_b128 v27, a[100:103] offset:8640
    ds_write_b128 v27, a[132:135] offset:8704
    ds_write_b128 v27, a[164:167] offset:8768
    ds_write_b128 v27, a[196:199] offset:8832
    ds_write_b128 v27, a[228:231] offset:8896
    s_waitcnt vmcnt(32)
    v_lshlrev_b32 v40, 16, v44
    v_and_b32 v41, 0xffff0000, v44
    v_lshlrev_b32 v42, 16, v45
    v_and_b32 v43, 0xffff0000, v45
    s_waitcnt vmcnt(24) lgkmcnt(8)
    ds_read_b128 v[80:83], v28 offset:8448
    ds_read_b128 v[84:87], v28 offset:9504
    ds_read_b128 v[88:91], v28 offset:10560
    ds_read_b128 v[92:95], v28 offset:11616
    ds_read_b128 v[96:99], v28 offset:12672
    ds_read_b128 v[100:103], v28 offset:13728
    ds_read_b128 v[104:107], v28 offset:14784
    ds_read_b128 v[108:111], v28 offset:15840
    ds_write_b128 v27, a[8:11] offset:16896
    ds_write_b128 v27, a[40:43] offset:16960
    ds_write_b128 v27, a[72:75] offset:17024
    ds_write_b128 v27, a[104:107] offset:17088
    ds_write_b128 v27, a[136:139] offset:17152
    ds_write_b128 v27, a[168:171] offset:17216
    ds_write_b128 v27, a[200:203] offset:17280
    ds_write_b128 v27, a[232:235] offset:17344
    v_lshlrev_b32 v112, 16, v128
    v_and_b32 v113, 0xffff0000, v128
    v_lshlrev_b32 v114, 16, v129
    v_and_b32 v115, 0xffff0000, v129
    v_pk_mul_f32 v[112:113], v[112:113], v[40:41]
    v_pk_mul_f32 v[114:115], v[114:115], v[42:43]
    s_add_u32 s52, s51, 0x0
    v_cvt_pk_bf16_f32 v112, 0, v112
    v_cvt_pk_bf16_f32 v113, 0, v113
    v_cvt_pk_bf16_f32 v114, 0, v114
    v_cvt_pk_bf16_f32 v115, 0, v115
    v_pk_add_f32 v[48:49], v[48:49], v[112:113]
    v_pk_add_f32 v[50:51], v[50:51], v[114:115]
    buffer_store_dwordx4 v[48:51], v25, s[12:15], s52 offen
    v_lshlrev_b32 v116, 16, v130
    v_and_b32 v117, 0xffff0000, v130
    v_lshlrev_b32 v118, 16, v131
    v_and_b32 v119, 0xffff0000, v131
    v_pk_mul_f32 v[116:117], v[116:117], v[40:41]
    v_pk_mul_f32 v[118:119], v[118:119], v[42:43]
    s_add_u32 s52, s51, 0x4000
    v_cvt_pk_bf16_f32 v116, 0, v116
    v_cvt_pk_bf16_f32 v117, 0, v117
    v_cvt_pk_bf16_f32 v118, 0, v118
    v_cvt_pk_bf16_f32 v119, 0, v119
    v_pk_add_f32 v[52:53], v[52:53], v[116:117]
    v_pk_add_f32 v[54:55], v[54:55], v[118:119]
    buffer_store_dwordx4 v[52:55], v25, s[12:15], s52 offen
    v_lshlrev_b32 v112, 16, v132
    v_and_b32 v113, 0xffff0000, v132
    v_lshlrev_b32 v114, 16, v133
    v_and_b32 v115, 0xffff0000, v133
    v_pk_mul_f32 v[112:113], v[112:113], v[40:41]
    v_pk_mul_f32 v[114:115], v[114:115], v[42:43]
    s_add_u32 s52, s51, 0x8000
    v_cvt_pk_bf16_f32 v112, 0, v112
    v_cvt_pk_bf16_f32 v113, 0, v113
    v_cvt_pk_bf16_f32 v114, 0, v114
    v_cvt_pk_bf16_f32 v115, 0, v115
    v_pk_add_f32 v[56:57], v[56:57], v[112:113]
    v_pk_add_f32 v[58:59], v[58:59], v[114:115]
    buffer_store_dwordx4 v[56:59], v25, s[12:15], s52 offen
    v_lshlrev_b32 v116, 16, v134
    v_and_b32 v117, 0xffff0000, v134
    v_lshlrev_b32 v118, 16, v135
    v_and_b32 v119, 0xffff0000, v135
    v_pk_mul_f32 v[116:117], v[116:117], v[40:41]
    v_pk_mul_f32 v[118:119], v[118:119], v[42:43]
    s_add_u32 s52, s51, 0xc000
    v_cvt_pk_bf16_f32 v116, 0, v116
    v_cvt_pk_bf16_f32 v117, 0, v117
    v_cvt_pk_bf16_f32 v118, 0, v118
    v_cvt_pk_bf16_f32 v119, 0, v119
    v_pk_add_f32 v[60:61], v[60:61], v[116:117]
    v_pk_add_f32 v[62:63], v[62:63], v[118:119]
    buffer_store_dwordx4 v[60:63], v25, s[12:15], s52 offen
    v_lshlrev_b32 v112, 16, v136
    v_and_b32 v113, 0xffff0000, v136
    v_lshlrev_b32 v114, 16, v137
    v_and_b32 v115, 0xffff0000, v137
    v_pk_mul_f32 v[112:113], v[112:113], v[40:41]
    v_pk_mul_f32 v[114:115], v[114:115], v[42:43]
    s_add_u32 s52, s51, 0x40000
    v_cvt_pk_bf16_f32 v112, 0, v112
    v_cvt_pk_bf16_f32 v113, 0, v113
    v_cvt_pk_bf16_f32 v114, 0, v114
    v_cvt_pk_bf16_f32 v115, 0, v115
    v_pk_add_f32 v[64:65], v[64:65], v[112:113]
    v_pk_add_f32 v[66:67], v[66:67], v[114:115]
    buffer_store_dwordx4 v[64:67], v25, s[12:15], s52 offen
    v_lshlrev_b32 v116, 16, v138
    v_and_b32 v117, 0xffff0000, v138
    v_lshlrev_b32 v118, 16, v139
    v_and_b32 v119, 0xffff0000, v139
    v_pk_mul_f32 v[116:117], v[116:117], v[40:41]
    v_pk_mul_f32 v[118:119], v[118:119], v[42:43]
    s_add_u32 s52, s51, 0x44000
    v_cvt_pk_bf16_f32 v116, 0, v116
    v_cvt_pk_bf16_f32 v117, 0, v117
    v_cvt_pk_bf16_f32 v118, 0, v118
    v_cvt_pk_bf16_f32 v119, 0, v119
    v_pk_add_f32 v[68:69], v[68:69], v[116:117]
    v_pk_add_f32 v[70:71], v[70:71], v[118:119]
    buffer_store_dwordx4 v[68:71], v25, s[12:15], s52 offen
    v_lshlrev_b32 v112, 16, v140
    v_and_b32 v113, 0xffff0000, v140
    v_lshlrev_b32 v114, 16, v141
    v_and_b32 v115, 0xffff0000, v141
    v_pk_mul_f32 v[112:113], v[112:113], v[40:41]
    v_pk_mul_f32 v[114:115], v[114:115], v[42:43]
    s_add_u32 s52, s51, 0x48000
    v_cvt_pk_bf16_f32 v112, 0, v112
    v_cvt_pk_bf16_f32 v113, 0, v113
    v_cvt_pk_bf16_f32 v114, 0, v114
    v_cvt_pk_bf16_f32 v115, 0, v115
    v_pk_add_f32 v[72:73], v[72:73], v[112:113]
    v_pk_add_f32 v[74:75], v[74:75], v[114:115]
    buffer_store_dwordx4 v[72:75], v25, s[12:15], s52 offen
    v_lshlrev_b32 v116, 16, v142
    v_and_b32 v117, 0xffff0000, v142
    v_lshlrev_b32 v118, 16, v143
    v_and_b32 v119, 0xffff0000, v143
    v_pk_mul_f32 v[116:117], v[116:117], v[40:41]
    v_pk_mul_f32 v[118:119], v[118:119], v[42:43]
    s_add_u32 s52, s51, 0x4c000
    v_cvt_pk_bf16_f32 v116, 0, v116
    v_cvt_pk_bf16_f32 v117, 0, v117
    v_cvt_pk_bf16_f32 v118, 0, v118
    v_cvt_pk_bf16_f32 v119, 0, v119
    v_pk_add_f32 v[76:77], v[76:77], v[116:117]
    v_pk_add_f32 v[78:79], v[78:79], v[118:119]
    buffer_store_dwordx4 v[76:79], v25, s[12:15], s52 offen
    s_add_u32 s53, s50, 0x8000
    buffer_load_dwordx2 v[192:193], v24, s[8:11], s53 offen
    s_add_u32 s53, s50, 0x9000
    buffer_load_dwordx2 v[194:195], v24, s[8:11], s53 offen
    s_add_u32 s53, s50, 0xa000
    buffer_load_dwordx2 v[196:197], v24, s[8:11], s53 offen
    s_add_u32 s53, s50, 0xb000
    buffer_load_dwordx2 v[198:199], v24, s[8:11], s53 offen
    s_add_u32 s53, s50, 0x18000
    buffer_load_dwordx2 v[200:201], v24, s[8:11], s53 offen
    s_add_u32 s53, s50, 0x19000
    buffer_load_dwordx2 v[202:203], v24, s[8:11], s53 offen
    s_add_u32 s53, s50, 0x1a000
    buffer_load_dwordx2 v[204:205], v24, s[8:11], s53 offen
    s_add_u32 s53, s50, 0x1b000
    buffer_load_dwordx2 v[206:207], v24, s[8:11], s53 offen
    s_waitcnt vmcnt(32) lgkmcnt(8)
    ds_read_b128 v[48:51], v28 offset:16896
    ds_read_b128 v[52:55], v28 offset:17952
    ds_read_b128 v[56:59], v28 offset:19008
    ds_read_b128 v[60:63], v28 offset:20064
    ds_read_b128 v[64:67], v28 offset:21120
    ds_read_b128 v[68:71], v28 offset:22176
    ds_read_b128 v[72:75], v28 offset:23232
    ds_read_b128 v[76:79], v28 offset:24288
    ds_write_b128 v27, a[12:15] offset:25344
    ds_write_b128 v27, a[44:47] offset:25408
    ds_write_b128 v27, a[76:79] offset:25472
    ds_write_b128 v27, a[108:111] offset:25536
    ds_write_b128 v27, a[140:143] offset:25600
    ds_write_b128 v27, a[172:175] offset:25664
    ds_write_b128 v27, a[204:207] offset:25728
    ds_write_b128 v27, a[236:239] offset:25792
    v_lshlrev_b32 v112, 16, v144
    v_and_b32 v113, 0xffff0000, v144
    v_lshlrev_b32 v114, 16, v145
    v_and_b32 v115, 0xffff0000, v145
    v_pk_mul_f32 v[112:113], v[112:113], v[40:41]
    v_pk_mul_f32 v[114:115], v[114:115], v[42:43]
    s_add_u32 s52, s51, 0x80000
    v_cvt_pk_bf16_f32 v112, 0, v112
    v_cvt_pk_bf16_f32 v113, 0, v113
    v_cvt_pk_bf16_f32 v114, 0, v114
    v_cvt_pk_bf16_f32 v115, 0, v115
    v_pk_add_f32 v[80:81], v[80:81], v[112:113]
    v_pk_add_f32 v[82:83], v[82:83], v[114:115]
    buffer_store_dwordx4 v[80:83], v25, s[12:15], s52 offen
    v_lshlrev_b32 v116, 16, v146
    v_and_b32 v117, 0xffff0000, v146
    v_lshlrev_b32 v118, 16, v147
    v_and_b32 v119, 0xffff0000, v147
    v_pk_mul_f32 v[116:117], v[116:117], v[40:41]
    v_pk_mul_f32 v[118:119], v[118:119], v[42:43]
    s_add_u32 s52, s51, 0x84000
    v_cvt_pk_bf16_f32 v116, 0, v116
    v_cvt_pk_bf16_f32 v117, 0, v117
    v_cvt_pk_bf16_f32 v118, 0, v118
    v_cvt_pk_bf16_f32 v119, 0, v119
    v_pk_add_f32 v[84:85], v[84:85], v[116:117]
    v_pk_add_f32 v[86:87], v[86:87], v[118:119]
    buffer_store_dwordx4 v[84:87], v25, s[12:15], s52 offen
    v_lshlrev_b32 v112, 16, v148
    v_and_b32 v113, 0xffff0000, v148
    v_lshlrev_b32 v114, 16, v149
    v_and_b32 v115, 0xffff0000, v149
    v_pk_mul_f32 v[112:113], v[112:113], v[40:41]
    v_pk_mul_f32 v[114:115], v[114:115], v[42:43]
    s_add_u32 s52, s51, 0x88000
    v_cvt_pk_bf16_f32 v112, 0, v112
    v_cvt_pk_bf16_f32 v113, 0, v113
    v_cvt_pk_bf16_f32 v114, 0, v114
    v_cvt_pk_bf16_f32 v115, 0, v115
    v_pk_add_f32 v[88:89], v[88:89], v[112:113]
    v_pk_add_f32 v[90:91], v[90:91], v[114:115]
    buffer_store_dwordx4 v[88:91], v25, s[12:15], s52 offen
    v_lshlrev_b32 v116, 16, v150
    v_and_b32 v117, 0xffff0000, v150
    v_lshlrev_b32 v118, 16, v151
    v_and_b32 v119, 0xffff0000, v151
    v_pk_mul_f32 v[116:117], v[116:117], v[40:41]
    v_pk_mul_f32 v[118:119], v[118:119], v[42:43]
    s_add_u32 s52, s51, 0x8c000
    v_cvt_pk_bf16_f32 v116, 0, v116
    v_cvt_pk_bf16_f32 v117, 0, v117
    v_cvt_pk_bf16_f32 v118, 0, v118
    v_cvt_pk_bf16_f32 v119, 0, v119
    v_pk_add_f32 v[92:93], v[92:93], v[116:117]
    v_pk_add_f32 v[94:95], v[94:95], v[118:119]
    buffer_store_dwordx4 v[92:95], v25, s[12:15], s52 offen
    v_lshlrev_b32 v112, 16, v152
    v_and_b32 v113, 0xffff0000, v152
    v_lshlrev_b32 v114, 16, v153
    v_and_b32 v115, 0xffff0000, v153
    v_pk_mul_f32 v[112:113], v[112:113], v[40:41]
    v_pk_mul_f32 v[114:115], v[114:115], v[42:43]
    s_add_u32 s52, s51, 0xc0000
    v_cvt_pk_bf16_f32 v112, 0, v112
    v_cvt_pk_bf16_f32 v113, 0, v113
    v_cvt_pk_bf16_f32 v114, 0, v114
    v_cvt_pk_bf16_f32 v115, 0, v115
    v_pk_add_f32 v[96:97], v[96:97], v[112:113]
    v_pk_add_f32 v[98:99], v[98:99], v[114:115]
    buffer_store_dwordx4 v[96:99], v25, s[12:15], s52 offen
    v_lshlrev_b32 v116, 16, v154
    v_and_b32 v117, 0xffff0000, v154
    v_lshlrev_b32 v118, 16, v155
    v_and_b32 v119, 0xffff0000, v155
    v_pk_mul_f32 v[116:117], v[116:117], v[40:41]
    v_pk_mul_f32 v[118:119], v[118:119], v[42:43]
    s_add_u32 s52, s51, 0xc4000
    v_cvt_pk_bf16_f32 v116, 0, v116
    v_cvt_pk_bf16_f32 v117, 0, v117
    v_cvt_pk_bf16_f32 v118, 0, v118
    v_cvt_pk_bf16_f32 v119, 0, v119
    v_pk_add_f32 v[100:101], v[100:101], v[116:117]
    v_pk_add_f32 v[102:103], v[102:103], v[118:119]
    buffer_store_dwordx4 v[100:103], v25, s[12:15], s52 offen
    v_lshlrev_b32 v112, 16, v156
    v_and_b32 v113, 0xffff0000, v156
    v_lshlrev_b32 v114, 16, v157
    v_and_b32 v115, 0xffff0000, v157
    v_pk_mul_f32 v[112:113], v[112:113], v[40:41]
    v_pk_mul_f32 v[114:115], v[114:115], v[42:43]
    s_add_u32 s52, s51, 0xc8000
    v_cvt_pk_bf16_f32 v112, 0, v112
    v_cvt_pk_bf16_f32 v113, 0, v113
    v_cvt_pk_bf16_f32 v114, 0, v114
    v_cvt_pk_bf16_f32 v115, 0, v115
    v_pk_add_f32 v[104:105], v[104:105], v[112:113]
    v_pk_add_f32 v[106:107], v[106:107], v[114:115]
    buffer_store_dwordx4 v[104:107], v25, s[12:15], s52 offen
    v_lshlrev_b32 v116, 16, v158
    v_and_b32 v117, 0xffff0000, v158
    v_lshlrev_b32 v118, 16, v159
    v_and_b32 v119, 0xffff0000, v159
    v_pk_mul_f32 v[116:117], v[116:117], v[40:41]
    v_pk_mul_f32 v[118:119], v[118:119], v[42:43]
    s_add_u32 s52, s51, 0xcc000
    v_cvt_pk_bf16_f32 v116, 0, v116
    v_cvt_pk_bf16_f32 v117, 0, v117
    v_cvt_pk_bf16_f32 v118, 0, v118
    v_cvt_pk_bf16_f32 v119, 0, v119
    v_pk_add_f32 v[108:109], v[108:109], v[116:117]
    v_pk_add_f32 v[110:111], v[110:111], v[118:119]
    buffer_store_dwordx4 v[108:111], v25, s[12:15], s52 offen
    s_add_u32 s53, s50, 0x28000
    buffer_load_dwordx2 v[208:209], v24, s[8:11], s53 offen
    s_add_u32 s53, s50, 0x29000
    buffer_load_dwordx2 v[210:211], v24, s[8:11], s53 offen
    s_add_u32 s53, s50, 0x2a000
    buffer_load_dwordx2 v[212:213], v24, s[8:11], s53 offen
    s_add_u32 s53, s50, 0x2b000
    buffer_load_dwordx2 v[214:215], v24, s[8:11], s53 offen
    s_add_u32 s53, s50, 0x38000
    buffer_load_dwordx2 v[216:217], v24, s[8:11], s53 offen
    s_add_u32 s53, s50, 0x39000
    buffer_load_dwordx2 v[218:219], v24, s[8:11], s53 offen
    s_add_u32 s53, s50, 0x3a000
    buffer_load_dwordx2 v[220:221], v24, s[8:11], s53 offen
    s_add_u32 s53, s50, 0x3b000
    buffer_load_dwordx2 v[222:223], v24, s[8:11], s53 offen
    s_waitcnt vmcnt(40) lgkmcnt(8)
    ds_read_b128 v[80:83], v28 offset:25344
    ds_read_b128 v[84:87], v28 offset:26400
    ds_read_b128 v[88:91], v28 offset:27456
    ds_read_b128 v[92:95], v28 offset:28512
    ds_read_b128 v[96:99], v28 offset:29568
    ds_read_b128 v[100:103], v28 offset:30624
    ds_read_b128 v[104:107], v28 offset:31680
    ds_read_b128 v[108:111], v28 offset:32736
    ds_write_b128 v27, a[16:19] offset:0
    ds_write_b128 v27, a[48:51] offset:64
    ds_write_b128 v27, a[80:83] offset:128
    ds_write_b128 v27, a[112:115] offset:192
    ds_write_b128 v27, a[144:147] offset:256
    ds_write_b128 v27, a[176:179] offset:320
    ds_write_b128 v27, a[208:211] offset:384
    ds_write_b128 v27, a[240:243] offset:448
    v_lshlrev_b32 v112, 16, v160
    v_and_b32 v113, 0xffff0000, v160
    v_lshlrev_b32 v114, 16, v161
    v_and_b32 v115, 0xffff0000, v161
    v_pk_mul_f32 v[112:113], v[112:113], v[40:41]
    v_pk_mul_f32 v[114:115], v[114:115], v[42:43]
    s_add_u32 s52, s51, 0x10000
    v_cvt_pk_bf16_f32 v112, 0, v112
    v_cvt_pk_bf16_f32 v113, 0, v113
    v_cvt_pk_bf16_f32 v114, 0, v114
    v_cvt_pk_bf16_f32 v115, 0, v115
    v_pk_add_f32 v[48:49], v[48:49], v[112:113]
    v_pk_add_f32 v[50:51], v[50:51], v[114:115]
    buffer_store_dwordx4 v[48:51], v25, s[12:15], s52 offen
    v_lshlrev_b32 v116, 16, v162
    v_and_b32 v117, 0xffff0000, v162
    v_lshlrev_b32 v118, 16, v163
    v_and_b32 v119, 0xffff0000, v163
    v_pk_mul_f32 v[116:117], v[116:117], v[40:41]
    v_pk_mul_f32 v[118:119], v[118:119], v[42:43]
    s_add_u32 s52, s51, 0x14000
    v_cvt_pk_bf16_f32 v116, 0, v116
    v_cvt_pk_bf16_f32 v117, 0, v117
    v_cvt_pk_bf16_f32 v118, 0, v118
    v_cvt_pk_bf16_f32 v119, 0, v119
    v_pk_add_f32 v[52:53], v[52:53], v[116:117]
    v_pk_add_f32 v[54:55], v[54:55], v[118:119]
    buffer_store_dwordx4 v[52:55], v25, s[12:15], s52 offen
    v_lshlrev_b32 v112, 16, v164
    v_and_b32 v113, 0xffff0000, v164
    v_lshlrev_b32 v114, 16, v165
    v_and_b32 v115, 0xffff0000, v165
    v_pk_mul_f32 v[112:113], v[112:113], v[40:41]
    v_pk_mul_f32 v[114:115], v[114:115], v[42:43]
    s_add_u32 s52, s51, 0x18000
    v_cvt_pk_bf16_f32 v112, 0, v112
    v_cvt_pk_bf16_f32 v113, 0, v113
    v_cvt_pk_bf16_f32 v114, 0, v114
    v_cvt_pk_bf16_f32 v115, 0, v115
    v_pk_add_f32 v[56:57], v[56:57], v[112:113]
    v_pk_add_f32 v[58:59], v[58:59], v[114:115]
    buffer_store_dwordx4 v[56:59], v25, s[12:15], s52 offen
    v_lshlrev_b32 v116, 16, v166
    v_and_b32 v117, 0xffff0000, v166
    v_lshlrev_b32 v118, 16, v167
    v_and_b32 v119, 0xffff0000, v167
    v_pk_mul_f32 v[116:117], v[116:117], v[40:41]
    v_pk_mul_f32 v[118:119], v[118:119], v[42:43]
    s_add_u32 s52, s51, 0x1c000
    v_cvt_pk_bf16_f32 v116, 0, v116
    v_cvt_pk_bf16_f32 v117, 0, v117
    v_cvt_pk_bf16_f32 v118, 0, v118
    v_cvt_pk_bf16_f32 v119, 0, v119
    v_pk_add_f32 v[60:61], v[60:61], v[116:117]
    v_pk_add_f32 v[62:63], v[62:63], v[118:119]
    buffer_store_dwordx4 v[60:63], v25, s[12:15], s52 offen
    v_lshlrev_b32 v112, 16, v168
    v_and_b32 v113, 0xffff0000, v168
    v_lshlrev_b32 v114, 16, v169
    v_and_b32 v115, 0xffff0000, v169
    v_pk_mul_f32 v[112:113], v[112:113], v[40:41]
    v_pk_mul_f32 v[114:115], v[114:115], v[42:43]
    s_add_u32 s52, s51, 0x50000
    v_cvt_pk_bf16_f32 v112, 0, v112
    v_cvt_pk_bf16_f32 v113, 0, v113
    v_cvt_pk_bf16_f32 v114, 0, v114
    v_cvt_pk_bf16_f32 v115, 0, v115
    v_pk_add_f32 v[64:65], v[64:65], v[112:113]
    v_pk_add_f32 v[66:67], v[66:67], v[114:115]
    buffer_store_dwordx4 v[64:67], v25, s[12:15], s52 offen
    v_lshlrev_b32 v116, 16, v170
    v_and_b32 v117, 0xffff0000, v170
    v_lshlrev_b32 v118, 16, v171
    v_and_b32 v119, 0xffff0000, v171
    v_pk_mul_f32 v[116:117], v[116:117], v[40:41]
    v_pk_mul_f32 v[118:119], v[118:119], v[42:43]
    s_add_u32 s52, s51, 0x54000
    v_cvt_pk_bf16_f32 v116, 0, v116
    v_cvt_pk_bf16_f32 v117, 0, v117
    v_cvt_pk_bf16_f32 v118, 0, v118
    v_cvt_pk_bf16_f32 v119, 0, v119
    v_pk_add_f32 v[68:69], v[68:69], v[116:117]
    v_pk_add_f32 v[70:71], v[70:71], v[118:119]
    buffer_store_dwordx4 v[68:71], v25, s[12:15], s52 offen
    v_lshlrev_b32 v112, 16, v172
    v_and_b32 v113, 0xffff0000, v172
    v_lshlrev_b32 v114, 16, v173
    v_and_b32 v115, 0xffff0000, v173
    v_pk_mul_f32 v[112:113], v[112:113], v[40:41]
    v_pk_mul_f32 v[114:115], v[114:115], v[42:43]
    s_add_u32 s52, s51, 0x58000
    v_cvt_pk_bf16_f32 v112, 0, v112
    v_cvt_pk_bf16_f32 v113, 0, v113
    v_cvt_pk_bf16_f32 v114, 0, v114
    v_cvt_pk_bf16_f32 v115, 0, v115
    v_pk_add_f32 v[72:73], v[72:73], v[112:113]
    v_pk_add_f32 v[74:75], v[74:75], v[114:115]
    buffer_store_dwordx4 v[72:75], v25, s[12:15], s52 offen
    v_lshlrev_b32 v116, 16, v174
    v_and_b32 v117, 0xffff0000, v174
    v_lshlrev_b32 v118, 16, v175
    v_and_b32 v119, 0xffff0000, v175
    v_pk_mul_f32 v[116:117], v[116:117], v[40:41]
    v_pk_mul_f32 v[118:119], v[118:119], v[42:43]
    s_add_u32 s52, s51, 0x5c000
    v_cvt_pk_bf16_f32 v116, 0, v116
    v_cvt_pk_bf16_f32 v117, 0, v117
    v_cvt_pk_bf16_f32 v118, 0, v118
    v_cvt_pk_bf16_f32 v119, 0, v119
    v_pk_add_f32 v[76:77], v[76:77], v[116:117]
    v_pk_add_f32 v[78:79], v[78:79], v[118:119]
    buffer_store_dwordx4 v[76:79], v25, s[12:15], s52 offen
    s_add_u32 s53, s50, 0xc000
    buffer_load_dwordx2 v[224:225], v24, s[8:11], s53 offen
    s_add_u32 s53, s50, 0xd000
    buffer_load_dwordx2 v[226:227], v24, s[8:11], s53 offen
    s_add_u32 s53, s50, 0xe000
    buffer_load_dwordx2 v[228:229], v24, s[8:11], s53 offen
    s_add_u32 s53, s50, 0xf000
    buffer_load_dwordx2 v[230:231], v24, s[8:11], s53 offen
    s_add_u32 s53, s50, 0x1c000
    buffer_load_dwordx2 v[232:233], v24, s[8:11], s53 offen
    s_add_u32 s53, s50, 0x1d000
    buffer_load_dwordx2 v[234:235], v24, s[8:11], s53 offen
    s_add_u32 s53, s50, 0x1e000
    buffer_load_dwordx2 v[236:237], v24, s[8:11], s53 offen
    s_add_u32 s53, s50, 0x1f000
    buffer_load_dwordx2 v[238:239], v24, s[8:11], s53 offen
    s_waitcnt vmcnt(48) lgkmcnt(8)
    ds_read_b128 v[48:51], v28 offset:0
    ds_read_b128 v[52:55], v28 offset:1056
    ds_read_b128 v[56:59], v28 offset:2112
    ds_read_b128 v[60:63], v28 offset:3168
    ds_read_b128 v[64:67], v28 offset:4224
    ds_read_b128 v[68:71], v28 offset:5280
    ds_read_b128 v[72:75], v28 offset:6336
    ds_read_b128 v[76:79], v28 offset:7392
    ds_write_b128 v27, a[20:23] offset:8448
    ds_write_b128 v27, a[52:55] offset:8512
    ds_write_b128 v27, a[84:87] offset:8576
    ds_write_b128 v27, a[116:119] offset:8640
    ds_write_b128 v27, a[148:151] offset:8704
    ds_write_b128 v27, a[180:183] offset:8768
    ds_write_b128 v27, a[212:215] offset:8832
    ds_write_b128 v27, a[244:247] offset:8896
    v_lshlrev_b32 v112, 16, v176
    v_and_b32 v113, 0xffff0000, v176
    v_lshlrev_b32 v114, 16, v177
    v_and_b32 v115, 0xffff0000, v177
    v_pk_mul_f32 v[112:113], v[112:113], v[40:41]
    v_pk_mul_f32 v[114:115], v[114:115], v[42:43]
    s_add_u32 s52, s51, 0x90000
    v_cvt_pk_bf16_f32 v112, 0, v112
    v_cvt_pk_bf16_f32 v113, 0, v113
    v_cvt_pk_bf16_f32 v114, 0, v114
    v_cvt_pk_bf16_f32 v115, 0, v115
    v_pk_add_f32 v[80:81], v[80:81], v[112:113]
    v_pk_add_f32 v[82:83], v[82:83], v[114:115]
    buffer_store_dwordx4 v[80:83], v25, s[12:15], s52 offen
    v_lshlrev_b32 v116, 16, v178
    v_and_b32 v117, 0xffff0000, v178
    v_lshlrev_b32 v118, 16, v179
    v_and_b32 v119, 0xffff0000, v179
    v_pk_mul_f32 v[116:117], v[116:117], v[40:41]
    v_pk_mul_f32 v[118:119], v[118:119], v[42:43]
    s_add_u32 s52, s51, 0x94000
    v_cvt_pk_bf16_f32 v116, 0, v116
    v_cvt_pk_bf16_f32 v117, 0, v117
    v_cvt_pk_bf16_f32 v118, 0, v118
    v_cvt_pk_bf16_f32 v119, 0, v119
    v_pk_add_f32 v[84:85], v[84:85], v[116:117]
    v_pk_add_f32 v[86:87], v[86:87], v[118:119]
    buffer_store_dwordx4 v[84:87], v25, s[12:15], s52 offen
    v_lshlrev_b32 v112, 16, v180
    v_and_b32 v113, 0xffff0000, v180
    v_lshlrev_b32 v114, 16, v181
    v_and_b32 v115, 0xffff0000, v181
    v_pk_mul_f32 v[112:113], v[112:113], v[40:41]
    v_pk_mul_f32 v[114:115], v[114:115], v[42:43]
    s_add_u32 s52, s51, 0x98000
    v_cvt_pk_bf16_f32 v112, 0, v112
    v_cvt_pk_bf16_f32 v113, 0, v113
    v_cvt_pk_bf16_f32 v114, 0, v114
    v_cvt_pk_bf16_f32 v115, 0, v115
    v_pk_add_f32 v[88:89], v[88:89], v[112:113]
    v_pk_add_f32 v[90:91], v[90:91], v[114:115]
    buffer_store_dwordx4 v[88:91], v25, s[12:15], s52 offen
    v_lshlrev_b32 v116, 16, v182
    v_and_b32 v117, 0xffff0000, v182
    v_lshlrev_b32 v118, 16, v183
    v_and_b32 v119, 0xffff0000, v183
    v_pk_mul_f32 v[116:117], v[116:117], v[40:41]
    v_pk_mul_f32 v[118:119], v[118:119], v[42:43]
    s_add_u32 s52, s51, 0x9c000
    v_cvt_pk_bf16_f32 v116, 0, v116
    v_cvt_pk_bf16_f32 v117, 0, v117
    v_cvt_pk_bf16_f32 v118, 0, v118
    v_cvt_pk_bf16_f32 v119, 0, v119
    v_pk_add_f32 v[92:93], v[92:93], v[116:117]
    v_pk_add_f32 v[94:95], v[94:95], v[118:119]
    buffer_store_dwordx4 v[92:95], v25, s[12:15], s52 offen
    v_lshlrev_b32 v112, 16, v184
    v_and_b32 v113, 0xffff0000, v184
    v_lshlrev_b32 v114, 16, v185
    v_and_b32 v115, 0xffff0000, v185
    v_pk_mul_f32 v[112:113], v[112:113], v[40:41]
    v_pk_mul_f32 v[114:115], v[114:115], v[42:43]
    s_add_u32 s52, s51, 0xd0000
    v_cvt_pk_bf16_f32 v112, 0, v112
    v_cvt_pk_bf16_f32 v113, 0, v113
    v_cvt_pk_bf16_f32 v114, 0, v114
    v_cvt_pk_bf16_f32 v115, 0, v115
    v_pk_add_f32 v[96:97], v[96:97], v[112:113]
    v_pk_add_f32 v[98:99], v[98:99], v[114:115]
    buffer_store_dwordx4 v[96:99], v25, s[12:15], s52 offen
    v_lshlrev_b32 v116, 16, v186
    v_and_b32 v117, 0xffff0000, v186
    v_lshlrev_b32 v118, 16, v187
    v_and_b32 v119, 0xffff0000, v187
    v_pk_mul_f32 v[116:117], v[116:117], v[40:41]
    v_pk_mul_f32 v[118:119], v[118:119], v[42:43]
    s_add_u32 s52, s51, 0xd4000
    v_cvt_pk_bf16_f32 v116, 0, v116
    v_cvt_pk_bf16_f32 v117, 0, v117
    v_cvt_pk_bf16_f32 v118, 0, v118
    v_cvt_pk_bf16_f32 v119, 0, v119
    v_pk_add_f32 v[100:101], v[100:101], v[116:117]
    v_pk_add_f32 v[102:103], v[102:103], v[118:119]
    buffer_store_dwordx4 v[100:103], v25, s[12:15], s52 offen
    v_lshlrev_b32 v112, 16, v188
    v_and_b32 v113, 0xffff0000, v188
    v_lshlrev_b32 v114, 16, v189
    v_and_b32 v115, 0xffff0000, v189
    v_pk_mul_f32 v[112:113], v[112:113], v[40:41]
    v_pk_mul_f32 v[114:115], v[114:115], v[42:43]
    s_add_u32 s52, s51, 0xd8000
    v_cvt_pk_bf16_f32 v112, 0, v112
    v_cvt_pk_bf16_f32 v113, 0, v113
    v_cvt_pk_bf16_f32 v114, 0, v114
    v_cvt_pk_bf16_f32 v115, 0, v115
    v_pk_add_f32 v[104:105], v[104:105], v[112:113]
    v_pk_add_f32 v[106:107], v[106:107], v[114:115]
    buffer_store_dwordx4 v[104:107], v25, s[12:15], s52 offen
    v_lshlrev_b32 v116, 16, v190
    v_and_b32 v117, 0xffff0000, v190
    v_lshlrev_b32 v118, 16, v191
    v_and_b32 v119, 0xffff0000, v191
    v_pk_mul_f32 v[116:117], v[116:117], v[40:41]
    v_pk_mul_f32 v[118:119], v[118:119], v[42:43]
    s_add_u32 s52, s51, 0xdc000
    v_cvt_pk_bf16_f32 v116, 0, v116
    v_cvt_pk_bf16_f32 v117, 0, v117
    v_cvt_pk_bf16_f32 v118, 0, v118
    v_cvt_pk_bf16_f32 v119, 0, v119
    v_pk_add_f32 v[108:109], v[108:109], v[116:117]
    v_pk_add_f32 v[110:111], v[110:111], v[118:119]
    buffer_store_dwordx4 v[108:111], v25, s[12:15], s52 offen
    s_add_u32 s53, s50, 0x2c000
    buffer_load_dwordx2 v[240:241], v24, s[8:11], s53 offen
    s_add_u32 s53, s50, 0x2d000
    buffer_load_dwordx2 v[242:243], v24, s[8:11], s53 offen
    s_add_u32 s53, s50, 0x2e000
    buffer_load_dwordx2 v[244:245], v24, s[8:11], s53 offen
    s_add_u32 s53, s50, 0x2f000
    buffer_load_dwordx2 v[246:247], v24, s[8:11], s53 offen
    s_add_u32 s53, s50, 0x3c000
    buffer_load_dwordx2 v[248:249], v24, s[8:11], s53 offen
    s_add_u32 s53, s50, 0x3d000
    buffer_load_dwordx2 v[250:251], v24, s[8:11], s53 offen
    s_add_u32 s53, s50, 0x3e000
    buffer_load_dwordx2 v[252:253], v24, s[8:11], s53 offen
    s_add_u32 s53, s50, 0x3f000
    buffer_load_dwordx2 v[254:255], v24, s[8:11], s53 offen
    s_waitcnt vmcnt(48) lgkmcnt(8)
    ds_read_b128 v[80:83], v28 offset:8448
    ds_read_b128 v[84:87], v28 offset:9504
    ds_read_b128 v[88:91], v28 offset:10560
    ds_read_b128 v[92:95], v28 offset:11616
    ds_read_b128 v[96:99], v28 offset:12672
    ds_read_b128 v[100:103], v28 offset:13728
    ds_read_b128 v[104:107], v28 offset:14784
    ds_read_b128 v[108:111], v28 offset:15840
    ds_write_b128 v27, a[24:27] offset:16896
    ds_write_b128 v27, a[56:59] offset:16960
    ds_write_b128 v27, a[88:91] offset:17024
    ds_write_b128 v27, a[120:123] offset:17088
    ds_write_b128 v27, a[152:155] offset:17152
    ds_write_b128 v27, a[184:187] offset:17216
    ds_write_b128 v27, a[216:219] offset:17280
    ds_write_b128 v27, a[248:251] offset:17344
    v_lshlrev_b32 v112, 16, v192
    v_and_b32 v113, 0xffff0000, v192
    v_lshlrev_b32 v114, 16, v193
    v_and_b32 v115, 0xffff0000, v193
    v_pk_mul_f32 v[112:113], v[112:113], v[40:41]
    v_pk_mul_f32 v[114:115], v[114:115], v[42:43]
    s_add_u32 s52, s51, 0x20000
    v_cvt_pk_bf16_f32 v112, 0, v112
    v_cvt_pk_bf16_f32 v113, 0, v113
    v_cvt_pk_bf16_f32 v114, 0, v114
    v_cvt_pk_bf16_f32 v115, 0, v115
    v_pk_add_f32 v[48:49], v[48:49], v[112:113]
    v_pk_add_f32 v[50:51], v[50:51], v[114:115]
    buffer_store_dwordx4 v[48:51], v25, s[12:15], s52 offen
    v_lshlrev_b32 v116, 16, v194
    v_and_b32 v117, 0xffff0000, v194
    v_lshlrev_b32 v118, 16, v195
    v_and_b32 v119, 0xffff0000, v195
    v_pk_mul_f32 v[116:117], v[116:117], v[40:41]
    v_pk_mul_f32 v[118:119], v[118:119], v[42:43]
    s_add_u32 s52, s51, 0x24000
    v_cvt_pk_bf16_f32 v116, 0, v116
    v_cvt_pk_bf16_f32 v117, 0, v117
    v_cvt_pk_bf16_f32 v118, 0, v118
    v_cvt_pk_bf16_f32 v119, 0, v119
    v_pk_add_f32 v[52:53], v[52:53], v[116:117]
    v_pk_add_f32 v[54:55], v[54:55], v[118:119]
    buffer_store_dwordx4 v[52:55], v25, s[12:15], s52 offen
    v_lshlrev_b32 v112, 16, v196
    v_and_b32 v113, 0xffff0000, v196
    v_lshlrev_b32 v114, 16, v197
    v_and_b32 v115, 0xffff0000, v197
    v_pk_mul_f32 v[112:113], v[112:113], v[40:41]
    v_pk_mul_f32 v[114:115], v[114:115], v[42:43]
    s_add_u32 s52, s51, 0x28000
    v_cvt_pk_bf16_f32 v112, 0, v112
    v_cvt_pk_bf16_f32 v113, 0, v113
    v_cvt_pk_bf16_f32 v114, 0, v114
    v_cvt_pk_bf16_f32 v115, 0, v115
    v_pk_add_f32 v[56:57], v[56:57], v[112:113]
    v_pk_add_f32 v[58:59], v[58:59], v[114:115]
    buffer_store_dwordx4 v[56:59], v25, s[12:15], s52 offen
    v_lshlrev_b32 v116, 16, v198
    v_and_b32 v117, 0xffff0000, v198
    v_lshlrev_b32 v118, 16, v199
    v_and_b32 v119, 0xffff0000, v199
    v_pk_mul_f32 v[116:117], v[116:117], v[40:41]
    v_pk_mul_f32 v[118:119], v[118:119], v[42:43]
    s_add_u32 s52, s51, 0x2c000
    v_cvt_pk_bf16_f32 v116, 0, v116
    v_cvt_pk_bf16_f32 v117, 0, v117
    v_cvt_pk_bf16_f32 v118, 0, v118
    v_cvt_pk_bf16_f32 v119, 0, v119
    v_pk_add_f32 v[60:61], v[60:61], v[116:117]
    v_pk_add_f32 v[62:63], v[62:63], v[118:119]
    buffer_store_dwordx4 v[60:63], v25, s[12:15], s52 offen
    v_lshlrev_b32 v112, 16, v200
    v_and_b32 v113, 0xffff0000, v200
    v_lshlrev_b32 v114, 16, v201
    v_and_b32 v115, 0xffff0000, v201
    v_pk_mul_f32 v[112:113], v[112:113], v[40:41]
    v_pk_mul_f32 v[114:115], v[114:115], v[42:43]
    s_add_u32 s52, s51, 0x60000
    v_cvt_pk_bf16_f32 v112, 0, v112
    v_cvt_pk_bf16_f32 v113, 0, v113
    v_cvt_pk_bf16_f32 v114, 0, v114
    v_cvt_pk_bf16_f32 v115, 0, v115
    v_pk_add_f32 v[64:65], v[64:65], v[112:113]
    v_pk_add_f32 v[66:67], v[66:67], v[114:115]
    buffer_store_dwordx4 v[64:67], v25, s[12:15], s52 offen
    v_lshlrev_b32 v116, 16, v202
    v_and_b32 v117, 0xffff0000, v202
    v_lshlrev_b32 v118, 16, v203
    v_and_b32 v119, 0xffff0000, v203
    v_pk_mul_f32 v[116:117], v[116:117], v[40:41]
    v_pk_mul_f32 v[118:119], v[118:119], v[42:43]
    s_add_u32 s52, s51, 0x64000
    v_cvt_pk_bf16_f32 v116, 0, v116
    v_cvt_pk_bf16_f32 v117, 0, v117
    v_cvt_pk_bf16_f32 v118, 0, v118
    v_cvt_pk_bf16_f32 v119, 0, v119
    v_pk_add_f32 v[68:69], v[68:69], v[116:117]
    v_pk_add_f32 v[70:71], v[70:71], v[118:119]
    buffer_store_dwordx4 v[68:71], v25, s[12:15], s52 offen
    v_lshlrev_b32 v112, 16, v204
    v_and_b32 v113, 0xffff0000, v204
    v_lshlrev_b32 v114, 16, v205
    v_and_b32 v115, 0xffff0000, v205
    v_pk_mul_f32 v[112:113], v[112:113], v[40:41]
    v_pk_mul_f32 v[114:115], v[114:115], v[42:43]
    s_add_u32 s52, s51, 0x68000
    v_cvt_pk_bf16_f32 v112, 0, v112
    v_cvt_pk_bf16_f32 v113, 0, v113
    v_cvt_pk_bf16_f32 v114, 0, v114
    v_cvt_pk_bf16_f32 v115, 0, v115
    v_pk_add_f32 v[72:73], v[72:73], v[112:113]
    v_pk_add_f32 v[74:75], v[74:75], v[114:115]
    buffer_store_dwordx4 v[72:75], v25, s[12:15], s52 offen
    v_lshlrev_b32 v116, 16, v206
    v_and_b32 v117, 0xffff0000, v206
    v_lshlrev_b32 v118, 16, v207
    v_and_b32 v119, 0xffff0000, v207
    v_pk_mul_f32 v[116:117], v[116:117], v[40:41]
    v_pk_mul_f32 v[118:119], v[118:119], v[42:43]
    s_add_u32 s52, s51, 0x6c000
    v_cvt_pk_bf16_f32 v116, 0, v116
    v_cvt_pk_bf16_f32 v117, 0, v117
    v_cvt_pk_bf16_f32 v118, 0, v118
    v_cvt_pk_bf16_f32 v119, 0, v119
    v_pk_add_f32 v[76:77], v[76:77], v[116:117]
    v_pk_add_f32 v[78:79], v[78:79], v[118:119]
    buffer_store_dwordx4 v[76:79], v25, s[12:15], s52 offen
    s_waitcnt vmcnt(40) lgkmcnt(8)
    ds_read_b128 v[48:51], v28 offset:16896
    ds_read_b128 v[52:55], v28 offset:17952
    ds_read_b128 v[56:59], v28 offset:19008
    ds_read_b128 v[60:63], v28 offset:20064
    ds_read_b128 v[64:67], v28 offset:21120
    ds_read_b128 v[68:71], v28 offset:22176
    ds_read_b128 v[72:75], v28 offset:23232
    ds_read_b128 v[76:79], v28 offset:24288
    ds_write_b128 v27, a[28:31] offset:25344
    ds_write_b128 v27, a[60:63] offset:25408
    ds_write_b128 v27, a[92:95] offset:25472
    ds_write_b128 v27, a[124:127] offset:25536
    ds_write_b128 v27, a[156:159] offset:25600
    ds_write_b128 v27, a[188:191] offset:25664
    ds_write_b128 v27, a[220:223] offset:25728
    ds_write_b128 v27, a[252:255] offset:25792
    v_lshlrev_b32 v112, 16, v208
    v_and_b32 v113, 0xffff0000, v208
    v_lshlrev_b32 v114, 16, v209
    v_and_b32 v115, 0xffff0000, v209
    v_pk_mul_f32 v[112:113], v[112:113], v[40:41]
    v_pk_mul_f32 v[114:115], v[114:115], v[42:43]
    s_add_u32 s52, s51, 0xa0000
    v_cvt_pk_bf16_f32 v112, 0, v112
    v_cvt_pk_bf16_f32 v113, 0, v113
    v_cvt_pk_bf16_f32 v114, 0, v114
    v_cvt_pk_bf16_f32 v115, 0, v115
    v_pk_add_f32 v[80:81], v[80:81], v[112:113]
    v_pk_add_f32 v[82:83], v[82:83], v[114:115]
    buffer_store_dwordx4 v[80:83], v25, s[12:15], s52 offen
    v_lshlrev_b32 v116, 16, v210
    v_and_b32 v117, 0xffff0000, v210
    v_lshlrev_b32 v118, 16, v211
    v_and_b32 v119, 0xffff0000, v211
    v_pk_mul_f32 v[116:117], v[116:117], v[40:41]
    v_pk_mul_f32 v[118:119], v[118:119], v[42:43]
    s_add_u32 s52, s51, 0xa4000
    v_cvt_pk_bf16_f32 v116, 0, v116
    v_cvt_pk_bf16_f32 v117, 0, v117
    v_cvt_pk_bf16_f32 v118, 0, v118
    v_cvt_pk_bf16_f32 v119, 0, v119
    v_pk_add_f32 v[84:85], v[84:85], v[116:117]
    v_pk_add_f32 v[86:87], v[86:87], v[118:119]
    buffer_store_dwordx4 v[84:87], v25, s[12:15], s52 offen
    v_lshlrev_b32 v112, 16, v212
    v_and_b32 v113, 0xffff0000, v212
    v_lshlrev_b32 v114, 16, v213
    v_and_b32 v115, 0xffff0000, v213
    v_pk_mul_f32 v[112:113], v[112:113], v[40:41]
    v_pk_mul_f32 v[114:115], v[114:115], v[42:43]
    s_add_u32 s52, s51, 0xa8000
    v_cvt_pk_bf16_f32 v112, 0, v112
    v_cvt_pk_bf16_f32 v113, 0, v113
    v_cvt_pk_bf16_f32 v114, 0, v114
    v_cvt_pk_bf16_f32 v115, 0, v115
    v_pk_add_f32 v[88:89], v[88:89], v[112:113]
    v_pk_add_f32 v[90:91], v[90:91], v[114:115]
    buffer_store_dwordx4 v[88:91], v25, s[12:15], s52 offen
    v_lshlrev_b32 v116, 16, v214
    v_and_b32 v117, 0xffff0000, v214
    v_lshlrev_b32 v118, 16, v215
    v_and_b32 v119, 0xffff0000, v215
    v_pk_mul_f32 v[116:117], v[116:117], v[40:41]
    v_pk_mul_f32 v[118:119], v[118:119], v[42:43]
    s_add_u32 s52, s51, 0xac000
    v_cvt_pk_bf16_f32 v116, 0, v116
    v_cvt_pk_bf16_f32 v117, 0, v117
    v_cvt_pk_bf16_f32 v118, 0, v118
    v_cvt_pk_bf16_f32 v119, 0, v119
    v_pk_add_f32 v[92:93], v[92:93], v[116:117]
    v_pk_add_f32 v[94:95], v[94:95], v[118:119]
    buffer_store_dwordx4 v[92:95], v25, s[12:15], s52 offen
    v_lshlrev_b32 v112, 16, v216
    v_and_b32 v113, 0xffff0000, v216
    v_lshlrev_b32 v114, 16, v217
    v_and_b32 v115, 0xffff0000, v217
    v_pk_mul_f32 v[112:113], v[112:113], v[40:41]
    v_pk_mul_f32 v[114:115], v[114:115], v[42:43]
    s_add_u32 s52, s51, 0xe0000
    v_cvt_pk_bf16_f32 v112, 0, v112
    v_cvt_pk_bf16_f32 v113, 0, v113
    v_cvt_pk_bf16_f32 v114, 0, v114
    v_cvt_pk_bf16_f32 v115, 0, v115
    v_pk_add_f32 v[96:97], v[96:97], v[112:113]
    v_pk_add_f32 v[98:99], v[98:99], v[114:115]
    buffer_store_dwordx4 v[96:99], v25, s[12:15], s52 offen
    v_lshlrev_b32 v116, 16, v218
    v_and_b32 v117, 0xffff0000, v218
    v_lshlrev_b32 v118, 16, v219
    v_and_b32 v119, 0xffff0000, v219
    v_pk_mul_f32 v[116:117], v[116:117], v[40:41]
    v_pk_mul_f32 v[118:119], v[118:119], v[42:43]
    s_add_u32 s52, s51, 0xe4000
    v_cvt_pk_bf16_f32 v116, 0, v116
    v_cvt_pk_bf16_f32 v117, 0, v117
    v_cvt_pk_bf16_f32 v118, 0, v118
    v_cvt_pk_bf16_f32 v119, 0, v119
    v_pk_add_f32 v[100:101], v[100:101], v[116:117]
    v_pk_add_f32 v[102:103], v[102:103], v[118:119]
    buffer_store_dwordx4 v[100:103], v25, s[12:15], s52 offen
    v_lshlrev_b32 v112, 16, v220
    v_and_b32 v113, 0xffff0000, v220
    v_lshlrev_b32 v114, 16, v221
    v_and_b32 v115, 0xffff0000, v221
    v_pk_mul_f32 v[112:113], v[112:113], v[40:41]
    v_pk_mul_f32 v[114:115], v[114:115], v[42:43]
    s_add_u32 s52, s51, 0xe8000
    v_cvt_pk_bf16_f32 v112, 0, v112
    v_cvt_pk_bf16_f32 v113, 0, v113
    v_cvt_pk_bf16_f32 v114, 0, v114
    v_cvt_pk_bf16_f32 v115, 0, v115
    v_pk_add_f32 v[104:105], v[104:105], v[112:113]
    v_pk_add_f32 v[106:107], v[106:107], v[114:115]
    buffer_store_dwordx4 v[104:107], v25, s[12:15], s52 offen
    v_lshlrev_b32 v116, 16, v222
    v_and_b32 v117, 0xffff0000, v222
    v_lshlrev_b32 v118, 16, v223
    v_and_b32 v119, 0xffff0000, v223
    v_pk_mul_f32 v[116:117], v[116:117], v[40:41]
    v_pk_mul_f32 v[118:119], v[118:119], v[42:43]
    s_add_u32 s52, s51, 0xec000
    v_cvt_pk_bf16_f32 v116, 0, v116
    v_cvt_pk_bf16_f32 v117, 0, v117
    v_cvt_pk_bf16_f32 v118, 0, v118
    v_cvt_pk_bf16_f32 v119, 0, v119
    v_pk_add_f32 v[108:109], v[108:109], v[116:117]
    v_pk_add_f32 v[110:111], v[110:111], v[118:119]
    buffer_store_dwordx4 v[108:111], v25, s[12:15], s52 offen
    s_waitcnt vmcnt(32) lgkmcnt(8)
    ds_read_b128 v[80:83], v28 offset:25344
    ds_read_b128 v[84:87], v28 offset:26400
    ds_read_b128 v[88:91], v28 offset:27456
    ds_read_b128 v[92:95], v28 offset:28512
    ds_read_b128 v[96:99], v28 offset:29568
    ds_read_b128 v[100:103], v28 offset:30624
    ds_read_b128 v[104:107], v28 offset:31680
    ds_read_b128 v[108:111], v28 offset:32736
    v_lshlrev_b32 v112, 16, v224
    v_and_b32 v113, 0xffff0000, v224
    v_lshlrev_b32 v114, 16, v225
    v_and_b32 v115, 0xffff0000, v225
    v_pk_mul_f32 v[112:113], v[112:113], v[40:41]
    v_pk_mul_f32 v[114:115], v[114:115], v[42:43]
    s_add_u32 s52, s51, 0x30000
    v_cvt_pk_bf16_f32 v112, 0, v112
    v_cvt_pk_bf16_f32 v113, 0, v113
    v_cvt_pk_bf16_f32 v114, 0, v114
    v_cvt_pk_bf16_f32 v115, 0, v115
    v_pk_add_f32 v[48:49], v[48:49], v[112:113]
    v_pk_add_f32 v[50:51], v[50:51], v[114:115]
    buffer_store_dwordx4 v[48:51], v25, s[12:15], s52 offen
    v_lshlrev_b32 v116, 16, v226
    v_and_b32 v117, 0xffff0000, v226
    v_lshlrev_b32 v118, 16, v227
    v_and_b32 v119, 0xffff0000, v227
    v_pk_mul_f32 v[116:117], v[116:117], v[40:41]
    v_pk_mul_f32 v[118:119], v[118:119], v[42:43]
    s_add_u32 s52, s51, 0x34000
    v_cvt_pk_bf16_f32 v116, 0, v116
    v_cvt_pk_bf16_f32 v117, 0, v117
    v_cvt_pk_bf16_f32 v118, 0, v118
    v_cvt_pk_bf16_f32 v119, 0, v119
    v_pk_add_f32 v[52:53], v[52:53], v[116:117]
    v_pk_add_f32 v[54:55], v[54:55], v[118:119]
    buffer_store_dwordx4 v[52:55], v25, s[12:15], s52 offen
    v_lshlrev_b32 v112, 16, v228
    v_and_b32 v113, 0xffff0000, v228
    v_lshlrev_b32 v114, 16, v229
    v_and_b32 v115, 0xffff0000, v229
    v_pk_mul_f32 v[112:113], v[112:113], v[40:41]
    v_pk_mul_f32 v[114:115], v[114:115], v[42:43]
    s_add_u32 s52, s51, 0x38000
    v_cvt_pk_bf16_f32 v112, 0, v112
    v_cvt_pk_bf16_f32 v113, 0, v113
    v_cvt_pk_bf16_f32 v114, 0, v114
    v_cvt_pk_bf16_f32 v115, 0, v115
    v_pk_add_f32 v[56:57], v[56:57], v[112:113]
    v_pk_add_f32 v[58:59], v[58:59], v[114:115]
    buffer_store_dwordx4 v[56:59], v25, s[12:15], s52 offen
    v_lshlrev_b32 v116, 16, v230
    v_and_b32 v117, 0xffff0000, v230
    v_lshlrev_b32 v118, 16, v231
    v_and_b32 v119, 0xffff0000, v231
    v_pk_mul_f32 v[116:117], v[116:117], v[40:41]
    v_pk_mul_f32 v[118:119], v[118:119], v[42:43]
    s_add_u32 s52, s51, 0x3c000
    v_cvt_pk_bf16_f32 v116, 0, v116
    v_cvt_pk_bf16_f32 v117, 0, v117
    v_cvt_pk_bf16_f32 v118, 0, v118
    v_cvt_pk_bf16_f32 v119, 0, v119
    v_pk_add_f32 v[60:61], v[60:61], v[116:117]
    v_pk_add_f32 v[62:63], v[62:63], v[118:119]
    buffer_store_dwordx4 v[60:63], v25, s[12:15], s52 offen
    v_lshlrev_b32 v112, 16, v232
    v_and_b32 v113, 0xffff0000, v232
    v_lshlrev_b32 v114, 16, v233
    v_and_b32 v115, 0xffff0000, v233
    v_pk_mul_f32 v[112:113], v[112:113], v[40:41]
    v_pk_mul_f32 v[114:115], v[114:115], v[42:43]
    s_add_u32 s52, s51, 0x70000
    v_cvt_pk_bf16_f32 v112, 0, v112
    v_cvt_pk_bf16_f32 v113, 0, v113
    v_cvt_pk_bf16_f32 v114, 0, v114
    v_cvt_pk_bf16_f32 v115, 0, v115
    v_pk_add_f32 v[64:65], v[64:65], v[112:113]
    v_pk_add_f32 v[66:67], v[66:67], v[114:115]
    buffer_store_dwordx4 v[64:67], v25, s[12:15], s52 offen
    v_lshlrev_b32 v116, 16, v234
    v_and_b32 v117, 0xffff0000, v234
    v_lshlrev_b32 v118, 16, v235
    v_and_b32 v119, 0xffff0000, v235
    v_pk_mul_f32 v[116:117], v[116:117], v[40:41]
    v_pk_mul_f32 v[118:119], v[118:119], v[42:43]
    s_add_u32 s52, s51, 0x74000
    v_cvt_pk_bf16_f32 v116, 0, v116
    v_cvt_pk_bf16_f32 v117, 0, v117
    v_cvt_pk_bf16_f32 v118, 0, v118
    v_cvt_pk_bf16_f32 v119, 0, v119
    v_pk_add_f32 v[68:69], v[68:69], v[116:117]
    v_pk_add_f32 v[70:71], v[70:71], v[118:119]
    buffer_store_dwordx4 v[68:71], v25, s[12:15], s52 offen
    v_lshlrev_b32 v112, 16, v236
    v_and_b32 v113, 0xffff0000, v236
    v_lshlrev_b32 v114, 16, v237
    v_and_b32 v115, 0xffff0000, v237
    v_pk_mul_f32 v[112:113], v[112:113], v[40:41]
    v_pk_mul_f32 v[114:115], v[114:115], v[42:43]
    s_add_u32 s52, s51, 0x78000
    v_cvt_pk_bf16_f32 v112, 0, v112
    v_cvt_pk_bf16_f32 v113, 0, v113
    v_cvt_pk_bf16_f32 v114, 0, v114
    v_cvt_pk_bf16_f32 v115, 0, v115
    v_pk_add_f32 v[72:73], v[72:73], v[112:113]
    v_pk_add_f32 v[74:75], v[74:75], v[114:115]
    buffer_store_dwordx4 v[72:75], v25, s[12:15], s52 offen
    v_lshlrev_b32 v116, 16, v238
    v_and_b32 v117, 0xffff0000, v238
    v_lshlrev_b32 v118, 16, v239
    v_and_b32 v119, 0xffff0000, v239
    v_pk_mul_f32 v[116:117], v[116:117], v[40:41]
    v_pk_mul_f32 v[118:119], v[118:119], v[42:43]
    s_add_u32 s52, s51, 0x7c000
    v_cvt_pk_bf16_f32 v116, 0, v116
    v_cvt_pk_bf16_f32 v117, 0, v117
    v_cvt_pk_bf16_f32 v118, 0, v118
    v_cvt_pk_bf16_f32 v119, 0, v119
    v_pk_add_f32 v[76:77], v[76:77], v[116:117]
    v_pk_add_f32 v[78:79], v[78:79], v[118:119]
    buffer_store_dwordx4 v[76:79], v25, s[12:15], s52 offen
    s_waitcnt vmcnt(24) lgkmcnt(0)
    v_lshlrev_b32 v112, 16, v240
    v_and_b32 v113, 0xffff0000, v240
    v_lshlrev_b32 v114, 16, v241
    v_and_b32 v115, 0xffff0000, v241
    v_pk_mul_f32 v[112:113], v[112:113], v[40:41]
    v_pk_mul_f32 v[114:115], v[114:115], v[42:43]
    s_add_u32 s52, s51, 0xb0000
    v_cvt_pk_bf16_f32 v112, 0, v112
    v_cvt_pk_bf16_f32 v113, 0, v113
    v_cvt_pk_bf16_f32 v114, 0, v114
    v_cvt_pk_bf16_f32 v115, 0, v115
    v_pk_add_f32 v[80:81], v[80:81], v[112:113]
    v_pk_add_f32 v[82:83], v[82:83], v[114:115]
    buffer_store_dwordx4 v[80:83], v25, s[12:15], s52 offen
    v_lshlrev_b32 v116, 16, v242
    v_and_b32 v117, 0xffff0000, v242
    v_lshlrev_b32 v118, 16, v243
    v_and_b32 v119, 0xffff0000, v243
    v_pk_mul_f32 v[116:117], v[116:117], v[40:41]
    v_pk_mul_f32 v[118:119], v[118:119], v[42:43]
    s_add_u32 s52, s51, 0xb4000
    v_cvt_pk_bf16_f32 v116, 0, v116
    v_cvt_pk_bf16_f32 v117, 0, v117
    v_cvt_pk_bf16_f32 v118, 0, v118
    v_cvt_pk_bf16_f32 v119, 0, v119
    v_pk_add_f32 v[84:85], v[84:85], v[116:117]
    v_pk_add_f32 v[86:87], v[86:87], v[118:119]
    buffer_store_dwordx4 v[84:87], v25, s[12:15], s52 offen
    v_lshlrev_b32 v112, 16, v244
    v_and_b32 v113, 0xffff0000, v244
    v_lshlrev_b32 v114, 16, v245
    v_and_b32 v115, 0xffff0000, v245
    v_pk_mul_f32 v[112:113], v[112:113], v[40:41]
    v_pk_mul_f32 v[114:115], v[114:115], v[42:43]
    s_add_u32 s52, s51, 0xb8000
    v_cvt_pk_bf16_f32 v112, 0, v112
    v_cvt_pk_bf16_f32 v113, 0, v113
    v_cvt_pk_bf16_f32 v114, 0, v114
    v_cvt_pk_bf16_f32 v115, 0, v115
    v_pk_add_f32 v[88:89], v[88:89], v[112:113]
    v_pk_add_f32 v[90:91], v[90:91], v[114:115]
    buffer_store_dwordx4 v[88:91], v25, s[12:15], s52 offen
    v_lshlrev_b32 v116, 16, v246
    v_and_b32 v117, 0xffff0000, v246
    v_lshlrev_b32 v118, 16, v247
    v_and_b32 v119, 0xffff0000, v247
    v_pk_mul_f32 v[116:117], v[116:117], v[40:41]
    v_pk_mul_f32 v[118:119], v[118:119], v[42:43]
    s_add_u32 s52, s51, 0xbc000
    v_cvt_pk_bf16_f32 v116, 0, v116
    v_cvt_pk_bf16_f32 v117, 0, v117
    v_cvt_pk_bf16_f32 v118, 0, v118
    v_cvt_pk_bf16_f32 v119, 0, v119
    v_pk_add_f32 v[92:93], v[92:93], v[116:117]
    v_pk_add_f32 v[94:95], v[94:95], v[118:119]
    buffer_store_dwordx4 v[92:95], v25, s[12:15], s52 offen
    v_lshlrev_b32 v112, 16, v248
    v_and_b32 v113, 0xffff0000, v248
    v_lshlrev_b32 v114, 16, v249
    v_and_b32 v115, 0xffff0000, v249
    v_pk_mul_f32 v[112:113], v[112:113], v[40:41]
    v_pk_mul_f32 v[114:115], v[114:115], v[42:43]
    s_add_u32 s52, s51, 0xf0000
    v_cvt_pk_bf16_f32 v112, 0, v112
    v_cvt_pk_bf16_f32 v113, 0, v113
    v_cvt_pk_bf16_f32 v114, 0, v114
    v_cvt_pk_bf16_f32 v115, 0, v115
    v_pk_add_f32 v[96:97], v[96:97], v[112:113]
    v_pk_add_f32 v[98:99], v[98:99], v[114:115]
    buffer_store_dwordx4 v[96:99], v25, s[12:15], s52 offen
    v_lshlrev_b32 v116, 16, v250
    v_and_b32 v117, 0xffff0000, v250
    v_lshlrev_b32 v118, 16, v251
    v_and_b32 v119, 0xffff0000, v251
    v_pk_mul_f32 v[116:117], v[116:117], v[40:41]
    v_pk_mul_f32 v[118:119], v[118:119], v[42:43]
    s_add_u32 s52, s51, 0xf4000
    v_cvt_pk_bf16_f32 v116, 0, v116
    v_cvt_pk_bf16_f32 v117, 0, v117
    v_cvt_pk_bf16_f32 v118, 0, v118
    v_cvt_pk_bf16_f32 v119, 0, v119
    v_pk_add_f32 v[100:101], v[100:101], v[116:117]
    v_pk_add_f32 v[102:103], v[102:103], v[118:119]
    buffer_store_dwordx4 v[100:103], v25, s[12:15], s52 offen
    v_lshlrev_b32 v112, 16, v252
    v_and_b32 v113, 0xffff0000, v252
    v_lshlrev_b32 v114, 16, v253
    v_and_b32 v115, 0xffff0000, v253
    v_pk_mul_f32 v[112:113], v[112:113], v[40:41]
    v_pk_mul_f32 v[114:115], v[114:115], v[42:43]
    s_add_u32 s52, s51, 0xf8000
    v_cvt_pk_bf16_f32 v112, 0, v112
    v_cvt_pk_bf16_f32 v113, 0, v113
    v_cvt_pk_bf16_f32 v114, 0, v114
    v_cvt_pk_bf16_f32 v115, 0, v115
    v_pk_add_f32 v[104:105], v[104:105], v[112:113]
    v_pk_add_f32 v[106:107], v[106:107], v[114:115]
    buffer_store_dwordx4 v[104:107], v25, s[12:15], s52 offen
    v_lshlrev_b32 v116, 16, v254
    v_and_b32 v117, 0xffff0000, v254
    v_lshlrev_b32 v118, 16, v255
    v_and_b32 v119, 0xffff0000, v255
    v_pk_mul_f32 v[116:117], v[116:117], v[40:41]
    v_pk_mul_f32 v[118:119], v[118:119], v[42:43]
    s_add_u32 s52, s51, 0xfc000
    v_cvt_pk_bf16_f32 v116, 0, v116
    v_cvt_pk_bf16_f32 v117, 0, v117
    v_cvt_pk_bf16_f32 v118, 0, v118
    v_cvt_pk_bf16_f32 v119, 0, v119
    v_pk_add_f32 v[108:109], v[108:109], v[116:117]
    v_pk_add_f32 v[110:111], v[110:111], v[118:119]
    buffer_store_dwordx4 v[108:111], v25, s[12:15], s52 offen
chain_kernel_seg:
    s_waitcnt vmcnt(0) lgkmcnt(0)
    s_barrier
    s_mov_b32 s12, s92
    s_and_b32 s13, s93, 0xffff
    s_mov_b32 s14, 0x800000
    s_mov_b32 s15, 0x00020000
    s_lshr_b32 s60, s57, 3
    s_lshl_b32 s28, s60, 21
    s_and_b32 s60, s57, 7
    s_lshl_b32 s60, s60, 8
    s_add_u32 s28, s28, s60
    v_bfe_u32 v24, v0, 4, 3
    v_lshlrev_b32 v24, 1, v24
    v_and_b32 v25, 15, v0
    v_xor_b32 v24, v24, v25
    v_lshlrev_b32 v6, 4, v24
    v_bfe_u32 v24, v0, 4, 2
    v_lshl_add_u32 v6, v24, 11, v6
    v_bfe_u32 v24, v0, 6, 1
    v_lshl_add_u32 v6, v24, 13, v6
    v_bfe_u32 v24, v0, 7, 1
    v_lshl_add_u32 v6, v24, 15, v6
    s_and_b32 s60, s58, 1
    s_lshl_b32 s61, s60, 11
    s_lshr_b32 s60, s58, 1
    s_lshl_b32 s60, s60, 10
    s_add_u32 s32, s60, s61
    s_add_u32 m0, s32, 0
    s_add_u32 s61, s28, 0x0
    buffer_load_dwordx4 v6, s[12:15], s61 offen nt lds
    s_add_u32 m0, s32, 4096
    s_add_u32 s61, s28, 0x4000
    buffer_load_dwordx4 v6, s[12:15], s61 offen nt lds
    s_add_u32 m0, s32, 8192
    s_add_u32 s61, s28, 0x10000
    buffer_load_dwordx4 v6, s[12:15], s61 offen nt lds
    s_add_u32 m0, s32, 12288
    s_add_u32 s61, s28, 0x14000
    buffer_load_dwordx4 v6, s[12:15], s61 offen nt lds
    s_add_u32 m0, s32, 16384
    s_add_u32 s61, s28, 0x20000
    buffer_load_dwordx4 v6, s[12:15], s61 offen nt lds
    s_add_u32 m0, s32, 20480
    s_add_u32 s61, s28, 0x24000
    buffer_load_dwordx4 v6, s[12:15], s61 offen nt lds
    s_add_u32 m0, s32, 24576
    s_add_u32 s61, s28, 0x30000
    buffer_load_dwordx4 v6, s[12:15], s61 offen nt lds
    s_add_u32 m0, s32, 28672
    s_add_u32 s61, s28, 0x34000
    buffer_load_dwordx4 v6, s[12:15], s61 offen nt lds
    s_mov_b32 s8, s100
    s_and_b32 s9, s101, 0xffff
    s_mov_b32 s10, 0xc000000
    s_mov_b32 s11, 0x00020000
    s_mov_b32 s16, s96
    s_and_b32 s17, s97, 0xffff
    s_mov_b32 s18, 0x1000000
    s_mov_b32 s19, 0x00020000
    v_and_b32 v24, 63, v0
    v_lshlrev_b32 v1, 4, v24
    v_add_u32 v2, 4096, v1
    v_lshlrev_b32 v10, 7, v24
    v_mov_b32 v11, 0
    s_lshl_b32 s60, s56, 8
    s_add_u32 s60, s60, 0xb200400
    s_lshl2_add_u32 s27, s57, s60
    s_and_b32 s38, s57, 7
    s_lshl_b32 s38, s38, 16
    s_cmp_eq_u32 s58, 0
    s_cselect_b32 s27, s27, 0xc000000
    s_cselect_b32 s38, s38, 0xc000000
    s_add_u32 s60, s60, s100
    s_addc_u32 s61, s101, 0
    v_and_b32 v25, 31, v0
    v_lshlrev_b32 v25, 2, v25
    v_add_u32 v16, s60, v25
    v_mov_b32 v17, s61
    s_add_u32 s60, s98, 208
    s_addc_u32 s61, s99, 0
    v_writelane_b32 v16, s60, 32
    v_writelane_b32 v17, s61, 32
    s_mov_b32 s26, 0
    s_mov_b32 s30, 0
    s_mov_b32 s40, 0
    s_mov_b32 s29, 32768
    v_and_b32 v24, 15, v0
    v_lshlrev_b32 v15, 13, v24
    v_bfe_u32 v24, v0, 4, 2
    v_lshl_add_u32 v15, v24, 4, v15
    s_lshr_b32 s60, s57, 4
    s_lshl_b32 s60, s60, 17
    s_and_b32 s61, s57, 7
    s_lshl_b32 s61, s61, 9
    s_add_u32 s60, s60, s61
    s_lshl_b32 s61, s58, 7
    s_add_u32 s60, s60, s61
    s_and_b32 s61, s57, 8
    s_lshl_b32 s61, s61, 3
    s_add_u32 s60, s60, s61
    s_add_u32 s60, s60, 4096
    v_add_u32 v15, s60, v15
    s_lshl_b32 s61, s58, 12
    s_xor_b32 s60, s57, 24
    s_lshl_b32 s60, s60, 14
    s_add_u32 s60, s60, s61
    s_add_u32 s60, s60, 0
    v_add_u32 v20, s60, v1
    s_xor_b32 s60, s57, 16
    s_lshl_b32 s60, s60, 14
    s_add_u32 s60, s60, s61
    s_add_u32 s60, s60, 1024
    v_add_u32 v21, s60, v1
    s_xor_b32 s60, s57, 8
    s_lshl_b32 s60, s60, 14
    s_add_u32 s60, s60, s61
    s_add_u32 s60, s60, 2048
    v_add_u32 v22, s60, v1
    s_xor_b32 s60, s57, 0
    s_lshl_b32 s60, s60, 14
    s_add_u32 s60, s60, s61
    s_add_u32 s60, s60, 0
    v_add_u32 v23, s60, v1
    s_lshl_b32 s24, s56, 20
    s_add_u32 s24, s24, 0xb800000
    s_and_b32 s60, s57, 24
    s_add_u32 s60, s60, s58
    s_lshl_b32 s31, s60, 16
    s_add_u32 s31, s31, 0xc000
    s_add_u32 s31, s31, s59
    s_mul_i32 s33, s56, 8
    s_lshr_b32 s33, 0x2010000, s33
    s_and_b32 s33, s33, 255
    s_mul_i32 s39, s56, 8
    s_lshr_b32 s39, 0x13131400, s39
    s_and_b32 s39, s39, 255
    s_cmp_eq_u32 s56, 0
    s_cmov_b32 s36, 0x3f3b
    s_cmp_eq_u32 s56, 1
    s_cmov_b32 s36, 0x3c
    s_cmp_eq_u32 s56, 2
    s_cmov_b32 s36, 0x3d3a
    s_cmp_eq_u32 s56, 3
    s_cmov_b32 s36, 0x3e
    s_add_u32 m0, s32, 32768
    s_add_u32 s61, s28, 0x40000
    buffer_load_dwordx4 v6, s[12:15], s61 offen nt lds
    s_add_u32 m0, s32, 36864
    s_add_u32 s61, s28, 0x44000
    buffer_load_dwordx4 v6, s[12:15], s61 offen nt lds
    s_add_u32 m0, s32, 40960
    s_add_u32 s61, s28, 0x50000
    buffer_load_dwordx4 v6, s[12:15], s61 offen nt lds
    s_add_u32 m0, s32, 45056
    s_add_u32 s61, s28, 0x54000
    buffer_load_dwordx4 v6, s[12:15], s61 offen nt lds
    s_add_u32 m0, s32, 49152
    s_add_u32 s61, s28, 0x60000
    buffer_load_dwordx4 v6, s[12:15], s61 offen nt lds
    s_add_u32 m0, s32, 53248
    s_add_u32 s61, s28, 0x64000
    buffer_load_dwordx4 v6, s[12:15], s61 offen nt lds
    s_add_u32 m0, s32, 57344
    s_add_u32 s61, s28, 0x70000
    buffer_load_dwordx4 v6, s[12:15], s61 offen nt lds
    s_add_u32 m0, s32, 61440
    s_add_u32 s61, s28, 0x74000
    buffer_load_dwordx4 v6, s[12:15], s61 offen nt lds
    s_add_u32 m0, s32, 65536
    s_add_u32 s61, s28, 0x80000
    buffer_load_dwordx4 v6, s[12:15], s61 offen nt lds
    s_add_u32 m0, s32, 69632
    s_add_u32 s61, s28, 0x84000
    buffer_load_dwordx4 v6, s[12:15], s61 offen nt lds
    s_add_u32 m0, s32, 73728
    s_add_u32 s61, s28, 0x90000
    buffer_load_dwordx4 v6, s[12:15], s61 offen nt lds
    s_add_u32 m0, s32, 77824
    s_add_u32 s61, s28, 0x94000
    buffer_load_dwordx4 v6, s[12:15], s61 offen nt lds
    s_add_u32 m0, s32, 81920
    s_add_u32 s61, s28, 0xa0000
    buffer_load_dwordx4 v6, s[12:15], s61 offen nt lds
    s_add_u32 m0, s32, 86016
    s_add_u32 s61, s28, 0xa4000
    buffer_load_dwordx4 v6, s[12:15], s61 offen nt lds
    s_add_u32 m0, s32, 90112
    s_add_u32 s61, s28, 0xb0000
    buffer_load_dwordx4 v6, s[12:15], s61 offen nt lds
    s_add_u32 m0, s32, 94208
    s_add_u32 s61, s28, 0xb4000
    buffer_load_dwordx4 v6, s[12:15], s61 offen nt lds
    s_add_u32 m0, s32, 98304
    s_add_u32 s61, s28, 0xc0000
    buffer_load_dwordx4 v6, s[12:15], s61 offen nt lds
    s_add_u32 m0, s32, 102400
    s_add_u32 s61, s28, 0xc4000
    buffer_load_dwordx4 v6, s[12:15], s61 offen nt lds
    s_add_u32 m0, s32, 106496
    s_add_u32 s61, s28, 0xd0000
    buffer_load_dwordx4 v6, s[12:15], s61 offen nt lds
    s_add_u32 m0, s32, 110592
    s_add_u32 s61, s28, 0xd4000
    buffer_load_dwordx4 v6, s[12:15], s61 offen nt lds
    s_add_u32 m0, s32, 114688
    s_add_u32 s61, s28, 0xe0000
    buffer_load_dwordx4 v6, s[12:15], s61 offen nt lds
    s_add_u32 m0, s32, 118784
    s_add_u32 s61, s28, 0xe4000
    buffer_load_dwordx4 v6, s[12:15], s61 offen nt lds
    s_add_u32 m0, s32, 122880
    s_add_u32 s61, s28, 0xf0000
    buffer_load_dwordx4 v6, s[12:15], s61 offen nt lds
    s_add_u32 m0, s32, 126976
    s_add_u32 s61, s28, 0xf4000
    buffer_load_dwordx4 v6, s[12:15], s61 offen nt lds
    s_add_u32 m0, s32, 131072
    s_add_u32 s61, s28, 0x100000
    buffer_load_dwordx4 v6, s[12:15], s61 offen nt lds
    s_add_u32 m0, s32, 135168
    s_add_u32 s61, s28, 0x104000
    buffer_load_dwordx4 v6, s[12:15], s61 offen nt lds
    s_add_u32 m0, s32, 139264
    s_add_u32 s61, s28, 0x110000
    buffer_load_dwordx4 v6, s[12:15], s61 offen nt lds
    s_add_u32 m0, s32, 143360
    s_add_u32 s61, s28, 0x114000
    buffer_load_dwordx4 v6, s[12:15], s61 offen nt lds
    s_add_u32 m0, s32, 147456
    s_add_u32 s61, s28, 0x120000
    buffer_load_dwordx4 v6, s[12:15], s61 offen nt lds
    s_add_u32 m0, s32, 151552
    s_add_u32 s61, s28, 0x124000
    buffer_load_dwordx4 v6, s[12:15], s61 offen nt lds
    s_add_u32 m0, s32, 155648
    s_add_u32 s61, s28, 0x130000
    buffer_load_dwordx4 v6, s[12:15], s61 offen nt lds
    s_add_u32 m0, s32, 159744
    s_add_u32 s61, s28, 0x134000
    buffer_load_dwordx4 v6, s[12:15], s61 offen nt lds
    s_andn2_b32 s60, 8, s57
    s_lshl_b32 s60, s60, 2
    v_bfe_u32 v24, v0, 2, 3
    v_lshrrev_b32 v25, 6, v0
    v_lshlrev_b32 v25, 1, v25
    v_xor_b32 v24, v24, v25
    v_lshlrev_b32 v8, 5, v24
    v_bfe_u32 v24, v0, 0, 2
    v_lshl_add_u32 v8, v24, 3, v8
    v_bfe_u32 v24, v0, 2, 2
    v_lshl_add_u32 v8, v24, 8, v8
    v_bfe_u32 v24, v0, 4, 2
    v_lshl_add_u32 v8, v24, 11, v8
    v_xor_b32 v8, s60, v8
    v_xor_b32 v9, 32, v8
    s_waitcnt vmcnt(32)
    s_barrier
    ds_read_b64_tr_b16 a[0:1], v8 offset:0
    ds_read_b64_tr_b16 a[2:3], v8 offset:1024
    ds_read_b64_tr_b16 a[4:5], v9 offset:0
    ds_read_b64_tr_b16 a[6:7], v9 offset:1024
    ds_read_b64_tr_b16 a[8:9], v8 offset:8192
    ds_read_b64_tr_b16 a[10:11], v8 offset:9216
    ds_read_b64_tr_b16 a[12:13], v9 offset:8192
    ds_read_b64_tr_b16 a[14:15], v9 offset:9216
    s_waitcnt lgkmcnt(0)
    ds_read_b64_tr_b16 a[16:17], v8 offset:16384
    ds_read_b64_tr_b16 a[18:19], v8 offset:17408
    ds_read_b64_tr_b16 a[20:21], v9 offset:16384
    ds_read_b64_tr_b16 a[22:23], v9 offset:17408
    ds_read_b64_tr_b16 a[24:25], v8 offset:24576
    ds_read_b64_tr_b16 a[26:27], v8 offset:25600
    ds_read_b64_tr_b16 a[28:29], v9 offset:24576
    ds_read_b64_tr_b16 a[30:31], v9 offset:25600
    s_waitcnt lgkmcnt(0)
    s_waitcnt vmcnt(24)
    s_barrier
    s_add_u32 m0, s32, 0
    s_add_u32 s61, s28, 0x140000
    buffer_load_dwordx4 v6, s[12:15], s61 offen nt lds
    s_add_u32 m0, s32, 4096
    s_add_u32 s61, s28, 0x144000
    buffer_load_dwordx4 v6, s[12:15], s61 offen nt lds
    s_add_u32 m0, s32, 8192
    s_add_u32 s61, s28, 0x150000
    buffer_load_dwordx4 v6, s[12:15], s61 offen nt lds
    s_add_u32 m0, s32, 12288
    s_add_u32 s61, s28, 0x154000
    buffer_load_dwordx4 v6, s[12:15], s61 offen nt lds
    s_add_u32 m0, s32, 16384
    s_add_u32 s61, s28, 0x160000
    buffer_load_dwordx4 v6, s[12:15], s61 offen nt lds
    s_add_u32 m0, s32, 20480
    s_add_u32 s61, s28, 0x164000
    buffer_load_dwordx4 v6, s[12:15], s61 offen nt lds
    s_add_u32 m0, s32, 24576
    s_add_u32 s61, s28, 0x170000
    buffer_load_dwordx4 v6, s[12:15], s61 offen nt lds
    s_add_u32 m0, s32, 28672
    s_add_u32 s61, s28, 0x174000
    buffer_load_dwordx4 v6, s[12:15], s61 offen nt lds
    ds_read_b64_tr_b16 a[32:33], v8 offset:32768
    ds_read_b64_tr_b16 a[34:35], v8 offset:33792
    ds_read_b64_tr_b16 a[36:37], v9 offset:32768
    ds_read_b64_tr_b16 a[38:39], v9 offset:33792
    ds_read_b64_tr_b16 a[40:41], v8 offset:40960
    ds_read_b64_tr_b16 a[42:43], v8 offset:41984
    ds_read_b64_tr_b16 a[44:45], v9 offset:40960
    ds_read_b64_tr_b16 a[46:47], v9 offset:41984
    s_waitcnt lgkmcnt(0)
    ds_read_b64_tr_b16 a[48:49], v8 offset:49152
    ds_read_b64_tr_b16 a[50:51], v8 offset:50176
    ds_read_b64_tr_b16 a[52:53], v9 offset:49152
    ds_read_b64_tr_b16 a[54:55], v9 offset:50176
    ds_read_b64_tr_b16 a[56:57], v8 offset:57344
    ds_read_b64_tr_b16 a[58:59], v8 offset:58368
    ds_read_b64_tr_b16 a[60:61], v9 offset:57344
    ds_read_b64_tr_b16 a[62:63], v9 offset:58368
    s_waitcnt lgkmcnt(0)
    s_waitcnt vmcnt(24)
    s_barrier
    s_add_u32 m0, s32, 32768
    s_add_u32 s61, s28, 0x180000
    buffer_load_dwordx4 v6, s[12:15], s61 offen nt lds
    s_add_u32 m0, s32, 36864
    s_add_u32 s61, s28, 0x184000
    buffer_load_dwordx4 v6, s[12:15], s61 offen nt lds
    s_add_u32 m0, s32, 40960
    s_add_u32 s61, s28, 0x190000
    buffer_load_dwordx4 v6, s[12:15], s61 offen nt lds
    s_add_u32 m0, s32, 45056
    s_add_u32 s61, s28, 0x194000
    buffer_load_dwordx4 v6, s[12:15], s61 offen nt lds
    s_add_u32 m0, s32, 49152
    s_add_u32 s61, s28, 0x1a0000
    buffer_load_dwordx4 v6, s[12:15], s61 offen nt lds
    s_add_u32 m0, s32, 53248
    s_add_u32 s61, s28, 0x1a4000
    buffer_load_dwordx4 v6, s[12:15], s61 offen nt lds
    s_add_u32 m0, s32, 57344
    s_add_u32 s61, s28, 0x1b0000
    buffer_load_dwordx4 v6, s[12:15], s61 offen nt lds
    s_add_u32 m0, s32, 61440
    s_add_u32 s61, s28, 0x1b4000
    buffer_load_dwordx4 v6, s[12:15], s61 offen nt lds
    v_add_u32 v8, 0x10000, v8
    v_add_u32 v9, 0x10000, v9
    ds_read_b64_tr_b16 a[64:65], v8 offset:0
    ds_read_b64_tr_b16 a[66:67], v8 offset:1024
    ds_read_b64_tr_b16 a[68:69], v9 offset:0
    ds_read_b64_tr_b16 a[70:71], v9 offset:1024
    ds_read_b64_tr_b16 a[72:73], v8 offset:8192
    ds_read_b64_tr_b16 a[74:75], v8 offset:9216
    ds_read_b64_tr_b16 a[76:77], v9 offset:8192
    ds_read_b64_tr_b16 a[78:79], v9 offset:9216
    s_waitcnt lgkmcnt(0)
    ds_read_b64_tr_b16 a[80:81], v8 offset:16384
    ds_read_b64_tr_b16 a[82:83], v8 offset:17408
    ds_read_b64_tr_b16 a[84:85], v9 offset:16384
    ds_read_b64_tr_b16 a[86:87], v9 offset:17408
    ds_read_b64_tr_b16 a[88:89], v8 offset:24576
    ds_read_b64_tr_b16 a[90:91], v8 offset:25600
    ds_read_b64_tr_b16 a[92:93], v9 offset:24576
    ds_read_b64_tr_b16 a[94:95], v9 offset:25600
    s_waitcnt lgkmcnt(0)
    s_waitcnt vmcnt(24)
    s_barrier
    s_add_u32 m0, s32, 65536
    s_add_u32 s61, s28, 0x1c0000
    buffer_load_dwordx4 v6, s[12:15], s61 offen nt lds
    s_add_u32 m0, s32, 69632
    s_add_u32 s61, s28, 0x1c4000
    buffer_load_dwordx4 v6, s[12:15], s61 offen nt lds
    s_add_u32 m0, s32, 73728
    s_add_u32 s61, s28, 0x1d0000
    buffer_load_dwordx4 v6, s[12:15], s61 offen nt lds
    s_add_u32 m0, s32, 77824
    s_add_u32 s61, s28, 0x1d4000
    buffer_load_dwordx4 v6, s[12:15], s61 offen nt lds
    s_add_u32 m0, s32, 81920
    s_add_u32 s61, s28, 0x1e0000
    buffer_load_dwordx4 v6, s[12:15], s61 offen nt lds
    s_add_u32 m0, s32, 86016
    s_add_u32 s61, s28, 0x1e4000
    buffer_load_dwordx4 v6, s[12:15], s61 offen nt lds
    s_add_u32 m0, s32, 90112
    s_add_u32 s61, s28, 0x1f0000
    buffer_load_dwordx4 v6, s[12:15], s61 offen nt lds
    s_add_u32 m0, s32, 94208
    s_add_u32 s61, s28, 0x1f4000
    buffer_load_dwordx4 v6, s[12:15], s61 offen nt lds
    ds_read_b64_tr_b16 a[96:97], v8 offset:32768
    ds_read_b64_tr_b16 a[98:99], v8 offset:33792
    ds_read_b64_tr_b16 a[100:101], v9 offset:32768
    ds_read_b64_tr_b16 a[102:103], v9 offset:33792
    ds_read_b64_tr_b16 a[104:105], v8 offset:40960
    ds_read_b64_tr_b16 a[106:107], v8 offset:41984
    ds_read_b64_tr_b16 a[108:109], v9 offset:40960
    ds_read_b64_tr_b16 a[110:111], v9 offset:41984
    s_waitcnt lgkmcnt(0)
    ds_read_b64_tr_b16 a[112:113], v8 offset:49152
    ds_read_b64_tr_b16 a[114:115], v8 offset:50176
    ds_read_b64_tr_b16 a[116:117], v9 offset:49152
    ds_read_b64_tr_b16 a[118:119], v9 offset:50176
    ds_read_b64_tr_b16 a[120:121], v8 offset:57344
    ds_read_b64_tr_b16 a[122:123], v8 offset:58368
    ds_read_b64_tr_b16 a[124:125], v9 offset:57344
    ds_read_b64_tr_b16 a[126:127], v9 offset:58368
    s_waitcnt lgkmcnt(0)
    s_waitcnt vmcnt(24)
    s_barrier
    v_add_u32 v8, 0x10000, v8
    v_add_u32 v9, 0x10000, v9
    ds_read_b64_tr_b16 a[128:129], v8 offset:0
    ds_read_b64_tr_b16 a[130:131], v8 offset:1024
    ds_read_b64_tr_b16 a[132:133], v9 offset:0
    ds_read_b64_tr_b16 a[134:135], v9 offset:1024
    ds_read_b64_tr_b16 a[136:137], v8 offset:8192
    ds_read_b64_tr_b16 a[138:139], v8 offset:9216
    ds_read_b64_tr_b16 a[140:141], v9 offset:8192
    ds_read_b64_tr_b16 a[142:143], v9 offset:9216
    s_waitcnt lgkmcnt(0)
    ds_read_b64_tr_b16 a[144:145], v8 offset:16384
    ds_read_b64_tr_b16 a[146:147], v8 offset:17408
    ds_read_b64_tr_b16 a[148:149], v9 offset:16384
    ds_read_b64_tr_b16 a[150:151], v9 offset:17408
    ds_read_b64_tr_b16 a[152:153], v8 offset:24576
    ds_read_b64_tr_b16 a[154:155], v8 offset:25600
    ds_read_b64_tr_b16 a[156:157], v9 offset:24576
    ds_read_b64_tr_b16 a[158:159], v9 offset:25600
    s_waitcnt lgkmcnt(0)
    s_waitcnt vmcnt(16)
    s_barrier
    v_add_u32 v8, 0xfffe0000, v8
    v_add_u32 v9, 0xfffe0000, v9
    ds_read_b64_tr_b16 a[160:161], v8 offset:0
    ds_read_b64_tr_b16 a[162:163], v8 offset:1024
    ds_read_b64_tr_b16 a[164:165], v9 offset:0
    ds_read_b64_tr_b16 a[166:167], v9 offset:1024
    ds_read_b64_tr_b16 a[168:169], v8 offset:8192
    ds_read_b64_tr_b16 a[170:171], v8 offset:9216
    ds_read_b64_tr_b16 a[172:173], v9 offset:8192
    ds_read_b64_tr_b16 a[174:175], v9 offset:9216
    s_waitcnt lgkmcnt(0)
    ds_read_b64_tr_b16 a[176:177], v8 offset:16384
    ds_read_b64_tr_b16 a[178:179], v8 offset:17408
    ds_read_b64_tr_b16 a[180:181], v9 offset:16384
    ds_read_b64_tr_b16 a[182:183], v9 offset:17408
    ds_read_b64_tr_b16 a[184:185], v8 offset:24576
    ds_read_b64_tr_b16 a[186:187], v8 offset:25600
    ds_read_b64_tr_b16 a[188:189], v9 offset:24576
    ds_read_b64_tr_b16 a[190:191], v9 offset:25600
    s_waitcnt lgkmcnt(0)
    s_waitcnt vmcnt(8)
    s_barrier
    ds_read_b64_tr_b16 a[192:193], v8 offset:32768
    ds_read_b64_tr_b16 a[194:195], v8 offset:33792
    ds_read_b64_tr_b16 a[196:197], v9 offset:32768
    ds_read_b64_tr_b16 a[198:199], v9 offset:33792
    ds_read_b64_tr_b16 a[200:201], v8 offset:40960
    ds_read_b64_tr_b16 a[202:203], v8 offset:41984
    ds_read_b64_tr_b16 a[204:205], v9 offset:40960
    ds_read_b64_tr_b16 a[206:207], v9 offset:41984
    s_waitcnt lgkmcnt(0)
    ds_read_b64_tr_b16 a[208:209], v8 offset:49152
    ds_read_b64_tr_b16 a[210:211], v8 offset:50176
    ds_read_b64_tr_b16 a[212:213], v9 offset:49152
    ds_read_b64_tr_b16 a[214:215], v9 offset:50176
    ds_read_b64_tr_b16 a[216:217], v8 offset:57344
    ds_read_b64_tr_b16 a[218:219], v8 offset:58368
    ds_read_b64_tr_b16 a[220:221], v9 offset:57344
    ds_read_b64_tr_b16 a[222:223], v9 offset:58368
    s_waitcnt lgkmcnt(0)
    s_waitcnt vmcnt(0)
    s_barrier
    v_add_u32 v8, 0x10000, v8
    v_add_u32 v9, 0x10000, v9
    ds_read_b64_tr_b16 a[224:225], v8 offset:0
    ds_read_b64_tr_b16 a[226:227], v8 offset:1024
    ds_read_b64_tr_b16 a[228:229], v9 offset:0
    ds_read_b64_tr_b16 a[230:231], v9 offset:1024
    ds_read_b64_tr_b16 a[232:233], v8 offset:8192
    ds_read_b64_tr_b16 a[234:235], v8 offset:9216
    ds_read_b64_tr_b16 a[236:237], v9 offset:8192
    ds_read_b64_tr_b16 a[238:239], v9 offset:9216
    s_waitcnt lgkmcnt(0)
    ds_read_b64_tr_b16 a[240:241], v8 offset:16384
    ds_read_b64_tr_b16 a[242:243], v8 offset:17408
    ds_read_b64_tr_b16 a[244:245], v9 offset:16384
    ds_read_b64_tr_b16 a[246:247], v9 offset:17408
    ds_read_b64_tr_b16 a[248:249], v8 offset:24576
    ds_read_b64_tr_b16 a[250:251], v8 offset:25600
    ds_read_b64_tr_b16 a[252:253], v9 offset:24576
    ds_read_b64_tr_b16 a[254:255], v9 offset:25600
    s_waitcnt lgkmcnt(0)
    s_barrier
    s_cmp_eq_u32 s39, 0
    s_cbranch_scc1 seg_t0
    s_lshl_b32 s20, s58, 13
    s_mov_b32 s21, 0
    s_lshr_b32 s60, s57, 4
    s_lshl_b32 s60, s60, 12
    v_add_u32 v5, s60, v1
    v_xor_b32 v4, 4096, v5
    s_sub_u32 s60, s39, 1
    s_mul_i32 s60, s60, 3
    s_add_u32 s35, s33, s60
    s_add_u32 s34, s33, 9
    s_lshl_b32 s25, s33, 18
    s_sub_u32 s25, s25, 0x180000
    s_mov_b32 s18, 0
    v_mov_b32 v18, s26
    v_writelane_b32 v18, s34, 32
    v_writelane_b32 v18, s40, 33
L_sp_57:
    global_load_dword v19, v[16:17], off sc1
    s_add_u32 s30, s30, 1
    s_cmp_gt_u32 s30, 0x200000
    s_cbranch_scc1 chain_kernel_wabort
    s_waitcnt vmcnt(0)
    v_cmp_lt_u32 vcc, v19, v18
    s_cbranch_vccz L_spok_58
    s_sleep 4
    s_branch L_sp_57
L_spok_58:
    s_lshl_b32 s61, s33, 13
    s_and_b32 s61, s61, 0x2000
    s_xor_b32 s61, s61, s31
    s_lshl_b32 s23, s33, 21
    s_add_u32 s23, s23, s61
    s_cmp_gt_u32 s33, s35
    s_cselect_b32 s23, 0xc000000, s23
    s_add_u32 m0, s20, 0
    s_nop 0
    buffer_load_dwordx4 v1, s[8:11], s23 offen offset:0 lds
    buffer_load_dwordx4 v1, s[8:11], s23 offen offset:1024 lds
    buffer_load_dwordx4 v1, s[8:11], s23 offen offset:2048 lds
    buffer_load_dwordx4 v1, s[8:11], s23 offen offset:3072 lds
    s_add_u32 m0, s20, 4096
    s_nop 0
    buffer_load_dwordx4 v2, s[8:11], s23 offen offset:0 lds
    buffer_load_dwordx4 v2, s[8:11], s23 offen offset:1024 lds
    buffer_load_dwordx4 v2, s[8:11], s23 offen offset:2048 lds
    buffer_load_dwordx4 v2, s[8:11], s23 offen offset:3072 lds
    s_add_u32 s20, s20, 32768
    s_cmp_ge_u32 s20, 163840
    s_cselect_b32 s60, 163840, 0
    s_sub_u32 s20, s20, s60
    s_add_u32 s23, s23, 0x40000
    s_add_u32 m0, s20, 0
    s_nop 0
    buffer_load_dwordx4 v1, s[8:11], s23 offen offset:0 lds
    buffer_load_dwordx4 v1, s[8:11], s23 offen offset:1024 lds
    buffer_load_dwordx4 v1, s[8:11], s23 offen offset:2048 lds
    buffer_load_dwordx4 v1, s[8:11], s23 offen offset:3072 lds
    s_add_u32 m0, s20, 4096
    s_nop 0
    buffer_load_dwordx4 v2, s[8:11], s23 offen offset:0 lds
    buffer_load_dwordx4 v2, s[8:11], s23 offen offset:1024 lds
    buffer_load_dwordx4 v2, s[8:11], s23 offen offset:2048 lds
    buffer_load_dwordx4 v2, s[8:11], s23 offen offset:3072 lds
    s_add_u32 s20, s20, 32768
    s_cmp_ge_u32 s20, 163840
    s_cselect_b32 s60, 163840, 0
    s_sub_u32 s20, s20, s60
    s_add_u32 s33, s33, 3
    s_lshl_b32 s61, s33, 13
    s_and_b32 s61, s61, 0x2000
    s_xor_b32 s61, s61, s31
    s_lshl_b32 s23, s33, 21
    s_add_u32 s23, s23, s61
    s_cmp_gt_u32 s33, s35
    s_cselect_b32 s23, 0xc000000, s23
    s_add_u32 m0, s20, 0
    s_nop 0
    buffer_load_dwordx4 v1, s[8:11], s23 offen offset:0 lds
    buffer_load_dwordx4 v1, s[8:11], s23 offen offset:1024 lds
    buffer_load_dwordx4 v1, s[8:11], s23 offen offset:2048 lds
    buffer_load_dwordx4 v1, s[8:11], s23 offen offset:3072 lds
    s_add_u32 m0, s20, 4096
    s_nop 0
    buffer_load_dwordx4 v2, s[8:11], s23 offen offset:0 lds
    buffer_load_dwordx4 v2, s[8:11], s23 offen offset:1024 lds
    buffer_load_dwordx4 v2, s[8:11], s23 offen offset:2048 lds
    buffer_load_dwordx4 v2, s[8:11], s23 offen offset:3072 lds
    s_add_u32 s20, s20, 32768
    s_cmp_ge_u32 s20, 163840
    s_cselect_b32 s60, 163840, 0
    s_sub_u32 s20, s20, s60
    s_add_u32 s23, s23, 0x40000
    s_mov_b32 s37, 0xc000000
    s_waitcnt vmcnt(8)
    s_barrier
    ds_read_b128 v[72:75], v4 offset:0
    ds_read_b128 v[76:79], v5 offset:0
    ds_read_b128 v[80:83], v4 offset:1024
    ds_read_b128 v[84:87], v5 offset:1024
    ds_read_b128 v[88:91], v4 offset:2048
    ds_read_b128 v[92:95], v5 offset:2048
seg_p:
    s_waitcnt lgkmcnt(4)
    v_mfma_f32_16x16x32_bf16 v[32:35], a[0:3], v[72:75], 0
    ds_read_b128 v[96:99], v4 offset:3072
    s_waitcnt vmcnt(0)
    v_mfma_f32_16x16x32_bf16 v[36:39], a[4:7], v[72:75], 0
    ds_read_b128 v[100:103], v5 offset:3072
    v_pk_add_f32 v[104:105], v[104:105], v[64:65]
    v_mfma_f32_16x16x32_bf16 v[44:47], a[4:7], v[76:79], 0
    v_pk_add_f32 v[106:107], v[106:107], v[66:67]
    s_xor_b32 s24, s24, 0x80000
    v_mfma_f32_16x16x32_bf16 v[40:43], a[0:3], v[76:79], 0
    buffer_store_dwordx4 v[48:51], v20, s[8:11], s24 offen
    s_waitcnt lgkmcnt(4)
    v_mfma_f32_16x16x32_bf16 v[32:35], a[8:11], v[80:83], v[32:35]
    ds_read_b128 v[72:75], v4 offset:8192
    v_mfma_f32_16x16x32_bf16 v[36:39], a[12:15], v[80:83], v[36:39]
    ds_read_b128 v[76:79], v5 offset:8192
    buffer_store_dwordx4 v[52:55], v21, s[8:11], s24 offen
    v_mfma_f32_16x16x32_bf16 v[44:47], a[12:15], v[84:87], v[44:47]
    v_mfma_f32_16x16x32_bf16 v[40:43], a[8:11], v[84:87], v[40:43]
    buffer_store_dwordx4 v[56:59], v22, s[8:11], s24 offen
    s_waitcnt lgkmcnt(4)
    v_mfma_f32_16x16x32_bf16 v[32:35], a[16:19], v[88:91], v[32:35]
    ds_read_b128 v[80:83], v4 offset:9216
    buffer_load_dword v13, v10, s[8:11], s37 offen
    v_mfma_f32_16x16x32_bf16 v[36:39], a[20:23], v[88:91], v[36:39]
    ds_read_b128 v[84:87], v5 offset:9216
    v_mov_b32 v64, v60
    v_mfma_f32_16x16x32_bf16 v[44:47], a[20:23], v[92:95], v[44:47]
    v_mov_b32 v65, v61
    v_mov_b32 v66, v62
    v_mfma_f32_16x16x32_bf16 v[40:43], a[16:19], v[92:95], v[40:43]
    v_mov_b32 v67, v63
    s_waitcnt lgkmcnt(4)
    v_mfma_f32_16x16x32_bf16 v[32:35], a[24:27], v[96:99], v[32:35]
    ds_read_b128 v[88:91], v4 offset:10240
    v_pk_add_f32 v[108:109], v[108:109], v[112:113]
    v_mfma_f32_16x16x32_bf16 v[36:39], a[28:31], v[96:99], v[36:39]
    ds_read_b128 v[92:95], v5 offset:10240
    v_pk_add_f32 v[110:111], v[110:111], v[114:115]
    v_mfma_f32_16x16x32_bf16 v[44:47], a[28:31], v[100:103], v[44:47]
    v_pk_add_f32 v[104:105], v[104:105], v[108:109]
    v_pk_add_f32 v[106:107], v[106:107], v[110:111]
    v_mfma_f32_16x16x32_bf16 v[40:43], a[24:27], v[100:103], v[40:43]
    v_cvt_pk_bf16_f32 v104, 0, v104
    s_waitcnt lgkmcnt(4)
    v_mfma_f32_16x16x32_bf16 v[32:35], a[32:35], v[72:75], v[32:35]
    ds_read_b128 v[96:99], v4 offset:11264
    v_cvt_pk_bf16_f32 v105, 0, v105
    v_mfma_f32_16x16x32_bf16 v[36:39], a[36:39], v[72:75], v[36:39]
    ds_read_b128 v[100:103], v5 offset:11264
    v_cvt_pk_bf16_f32 v106, 0, v106
    v_mfma_f32_16x16x32_bf16 v[44:47], a[36:39], v[76:79], v[44:47]
    v_cvt_pk_bf16_f32 v107, 0, v107
    buffer_store_dwordx4 v[104:107], v15, s[16:19], s25 offen
    v_mfma_f32_16x16x32_bf16 v[40:43], a[32:35], v[76:79], v[40:43]
    s_waitcnt lgkmcnt(4)
    v_mfma_f32_16x16x32_bf16 v[32:35], a[40:43], v[80:83], v[32:35]
    ds_read_b128 v[72:75], v4 offset:16384
    v_mfma_f32_16x16x32_bf16 v[36:39], a[44:47], v[80:83], v[36:39]
    ds_read_b128 v[76:79], v5 offset:16384
    v_mfma_f32_16x16x32_bf16 v[44:47], a[44:47], v[84:87], v[44:47]
    v_mfma_f32_16x16x32_bf16 v[40:43], a[40:43], v[84:87], v[40:43]
    s_waitcnt lgkmcnt(4)
    v_mfma_f32_16x16x32_bf16 v[32:35], a[48:51], v[88:91], v[32:35]
    ds_read_b128 v[80:83], v4 offset:17408
    s_add_u32 m0, s20, 0
    v_mfma_f32_16x16x32_bf16 v[36:39], a[52:55], v[88:91], v[36:39]
    ds_read_b128 v[84:87], v5 offset:17408
    v_mfma_f32_16x16x32_bf16 v[44:47], a[52:55], v[92:95], v[44:47]
    buffer_load_dwordx4 v1, s[8:11], s23 offen offset:0 lds
    v_mfma_f32_16x16x32_bf16 v[40:43], a[48:51], v[92:95], v[40:43]
    s_waitcnt lgkmcnt(4)
    v_mfma_f32_16x16x32_bf16 v[32:35], a[56:59], v[96:99], v[32:35]
    ds_read_b128 v[88:91], v4 offset:18432
    buffer_load_dwordx4 v1, s[8:11], s23 offen offset:1024 lds
    v_mfma_f32_16x16x32_bf16 v[36:39], a[60:63], v[96:99], v[36:39]
    ds_read_b128 v[92:95], v5 offset:18432
    v_mfma_f32_16x16x32_bf16 v[44:47], a[60:63], v[100:103], v[44:47]
    buffer_load_dwordx4 v1, s[8:11], s23 offen offset:2048 lds
    v_mfma_f32_16x16x32_bf16 v[40:43], a[56:59], v[100:103], v[40:43]
    s_waitcnt lgkmcnt(4)
    v_mfma_f32_16x16x32_bf16 v[32:35], a[64:67], v[72:75], v[32:35]
    ds_read_b128 v[96:99], v4 offset:19456
    buffer_load_dwordx4 v1, s[8:11], s23 offen offset:3072 lds
    v_mfma_f32_16x16x32_bf16 v[36:39], a[68:71], v[72:75], v[36:39]
    ds_read_b128 v[100:103], v5 offset:19456
    v_mfma_f32_16x16x32_bf16 v[44:47], a[68:71], v[76:79], v[44:47]
    s_add_u32 m0, s20, 4096
    v_mfma_f32_16x16x32_bf16 v[40:43], a[64:67], v[76:79], v[40:43]
    s_waitcnt lgkmcnt(4)
    v_mfma_f32_16x16x32_bf16 v[32:35], a[72:75], v[80:83], v[32:35]
    ds_read_b128 v[72:75], v4 offset:24576
    buffer_load_dwordx4 v2, s[8:11], s23 offen offset:0 lds
    v_mfma_f32_16x16x32_bf16 v[36:39], a[76:79], v[80:83], v[36:39]
    ds_read_b128 v[76:79], v5 offset:24576
    v_mfma_f32_16x16x32_bf16 v[44:47], a[76:79], v[84:87], v[44:47]
    buffer_load_dwordx4 v2, s[8:11], s23 offen offset:1024 lds
    v_mfma_f32_16x16x32_bf16 v[40:43], a[72:75], v[84:87], v[40:43]
    s_waitcnt lgkmcnt(4)
    v_mfma_f32_16x16x32_bf16 v[32:35], a[80:83], v[88:91], v[32:35]
    ds_read_b128 v[80:83], v4 offset:25600
    buffer_load_dwordx4 v2, s[8:11], s23 offen offset:2048 lds
    v_mfma_f32_16x16x32_bf16 v[36:39], a[84:87], v[88:91], v[36:39]
    ds_read_b128 v[84:87], v5 offset:25600
    v_mfma_f32_16x16x32_bf16 v[44:47], a[84:87], v[92:95], v[44:47]
    buffer_load_dwordx4 v2, s[8:11], s23 offen offset:3072 lds
    v_mfma_f32_16x16x32_bf16 v[40:43], a[80:83], v[92:95], v[40:43]
    s_cmp_ge_u32 s21, 131072
    s_waitcnt lgkmcnt(4)
    v_mfma_f32_16x16x32_bf16 v[32:35], a[88:91], v[96:99], v[32:35]
    ds_read_b128 v[88:91], v4 offset:26624
    s_cselect_b32 s22, 0xfffe0000, s29
    v_mfma_f32_16x16x32_bf16 v[36:39], a[92:95], v[96:99], v[36:39]
    ds_read_b128 v[92:95], v5 offset:26624
    s_add_u32 s21, s21, s22
    v_mfma_f32_16x16x32_bf16 v[44:47], a[92:95], v[100:103], v[44:47]
    v_mfma_f32_16x16x32_bf16 v[40:43], a[88:91], v[100:103], v[40:43]
    s_waitcnt lgkmcnt(4)
    v_mfma_f32_16x16x32_bf16 v[32:35], a[96:99], v[72:75], v[32:35]
    ds_read_b128 v[96:99], v4 offset:27648
    v_mfma_f32_16x16x32_bf16 v[36:39], a[100:103], v[72:75], v[36:39]
    ds_read_b128 v[100:103], v5 offset:27648
    v_mfma_f32_16x16x32_bf16 v[44:47], a[100:103], v[76:79], v[44:47]
    v_add_u32 v4, s22, v4
    v_add_u32 v5, s22, v5
    v_mfma_f32_16x16x32_bf16 v[40:43], a[96:99], v[76:79], v[40:43]
    s_waitcnt vmcnt(10)
    s_barrier
    s_waitcnt lgkmcnt(4)
    v_mfma_f32_16x16x32_bf16 v[32:35], a[104:107], v[80:83], v[32:35]
    ds_read_b128 v[72:75], v4 offset:0
    s_add_u32 s26, s26, 1
    v_mfma_f32_16x16x32_bf16 v[36:39], a[108:111], v[80:83], v[36:39]
    ds_read_b128 v[76:79], v5 offset:0
    v_mov_b32 v12, s26
    v_mfma_f32_16x16x32_bf16 v[44:47], a[108:111], v[84:87], v[44:47]
    buffer_store_dword v12, v11, s[8:11], s27 offen
    v_mfma_f32_16x16x32_bf16 v[40:43], a[104:107], v[84:87], v[40:43]
    s_add_u32 s20, s20, 32768
    s_waitcnt lgkmcnt(4)
    v_mfma_f32_16x16x32_bf16 v[32:35], a[112:115], v[88:91], v[32:35]
    ds_read_b128 v[80:83], v4 offset:1024
    s_cmp_ge_u32 s20, 163840
    v_mfma_f32_16x16x32_bf16 v[36:39], a[116:119], v[88:91], v[36:39]
    ds_read_b128 v[84:87], v5 offset:1024
    s_cselect_b32 s60, 163840, 0
    v_mfma_f32_16x16x32_bf16 v[44:47], a[116:119], v[92:95], v[44:47]
    s_sub_u32 s20, s20, s60
    s_add_u32 s33, s33, 3
    v_mfma_f32_16x16x32_bf16 v[40:43], a[112:115], v[92:95], v[40:43]
    s_lshl_b32 s61, s33, 13
    s_waitcnt lgkmcnt(4)
    v_mfma_f32_16x16x32_bf16 v[32:35], a[120:123], v[96:99], v[32:35]
    ds_read_b128 v[88:91], v4 offset:2048
    s_and_b32 s61, s61, 0x2000
    v_mfma_f32_16x16x32_bf16 v[36:39], a[124:127], v[96:99], v[36:39]
    ds_read_b128 v[92:95], v5 offset:2048
    s_xor_b32 s61, s61, s31
    v_mfma_f32_16x16x32_bf16 v[44:47], a[124:127], v[100:103], v[44:47]
    s_lshl_b32 s23, s33, 21
    s_add_u32 s23, s23, s61
    v_mfma_f32_16x16x32_bf16 v[40:43], a[120:123], v[100:103], v[40:43]
    s_cmp_gt_u32 s33, s35
    s_waitcnt lgkmcnt(4)
    v_mfma_f32_16x16x32_bf16 v[32:35], a[128:131], v[72:75], v[32:35]
    ds_read_b128 v[96:99], v4 offset:3072
    s_cselect_b32 s23, 0xc000000, s23
    v_mfma_f32_16x16x32_bf16 v[36:39], a[132:135], v[72:75], v[36:39]
    ds_read_b128 v[100:103], v5 offset:3072
    s_add_u32 s34, s34, 3
    v_mfma_f32_16x16x32_bf16 v[44:47], a[132:135], v[76:79], v[44:47]
    s_add_u32 s62, s35, 3
    s_min_u32 s34, s34, s62
    v_mfma_f32_16x16x32_bf16 v[40:43], a[128:131], v[76:79], v[40:43]
    v_mov_b32 v18, s26
    s_waitcnt lgkmcnt(4)
    v_mfma_f32_16x16x32_bf16 v[32:35], a[136:139], v[80:83], v[32:35]
    ds_read_b128 v[72:75], v4 offset:8192
    v_writelane_b32 v18, s34, 32
    v_mfma_f32_16x16x32_bf16 v[36:39], a[140:143], v[80:83], v[36:39]
    ds_read_b128 v[76:79], v5 offset:8192
    v_writelane_b32 v18, s40, 33
    v_mfma_f32_16x16x32_bf16 v[44:47], a[140:143], v[84:87], v[44:47]
    v_mfma_f32_16x16x32_bf16 v[40:43], a[136:139], v[84:87], v[40:43]
    s_waitcnt lgkmcnt(4)
    v_mfma_f32_16x16x32_bf16 v[32:35], a[144:147], v[88:91], v[32:35]
    ds_read_b128 v[80:83], v4 offset:9216
    global_load_dword v19, v[16:17], off sc1
    v_mfma_f32_16x16x32_bf16 v[36:39], a[148:151], v[88:91], v[36:39]
    ds_read_b128 v[84:87], v5 offset:9216
    v_mfma_f32_16x16x32_bf16 v[44:47], a[148:151], v[92:95], v[44:47]
    s_add_u32 m0, s20, 0
    v_mfma_f32_16x16x32_bf16 v[40:43], a[144:147], v[92:95], v[40:43]
    s_waitcnt lgkmcnt(4)
    v_mfma_f32_16x16x32_bf16 v[32:35], a[152:155], v[96:99], v[32:35]
    ds_read_b128 v[88:91], v4 offset:10240
    buffer_load_dwordx4 v1, s[8:11], s23 offen offset:0 lds
    v_mfma_f32_16x16x32_bf16 v[36:39], a[156:159], v[96:99], v[36:39]
    ds_read_b128 v[92:95], v5 offset:10240
    v_mfma_f32_16x16x32_bf16 v[44:47], a[156:159], v[100:103], v[44:47]
    buffer_load_dwordx4 v1, s[8:11], s23 offen offset:1024 lds
    v_mfma_f32_16x16x32_bf16 v[40:43], a[152:155], v[100:103], v[40:43]
    s_waitcnt lgkmcnt(4)
    v_mfma_f32_16x16x32_bf16 v[32:35], a[160:163], v[72:75], v[32:35]
    ds_read_b128 v[96:99], v4 offset:11264
    buffer_load_dwordx4 v1, s[8:11], s23 offen offset:2048 lds
    v_mfma_f32_16x16x32_bf16 v[36:39], a[164:167], v[72:75], v[36:39]
    ds_read_b128 v[100:103], v5 offset:11264
    v_mfma_f32_16x16x32_bf16 v[44:47], a[164:167], v[76:79], v[44:47]
    buffer_load_dwordx4 v1, s[8:11], s23 offen offset:3072 lds
    v_mfma_f32_16x16x32_bf16 v[40:43], a[160:163], v[76:79], v[40:43]
    s_waitcnt lgkmcnt(4)
    v_mfma_f32_16x16x32_bf16 v[32:35], a[168:171], v[80:83], v[32:35]
    ds_read_b128 v[72:75], v4 offset:16384
    s_add_u32 m0, s20, 4096
    v_mfma_f32_16x16x32_bf16 v[36:39], a[172:175], v[80:83], v[36:39]
    ds_read_b128 v[76:79], v5 offset:16384
    v_mfma_f32_16x16x32_bf16 v[44:47], a[172:175], v[84:87], v[44:47]
    buffer_load_dwordx4 v2, s[8:11], s23 offen offset:0 lds
    v_mfma_f32_16x16x32_bf16 v[40:43], a[168:171], v[84:87], v[40:43]
    s_waitcnt lgkmcnt(4)
    v_mfma_f32_16x16x32_bf16 v[32:35], a[176:179], v[88:91], v[32:35]
    ds_read_b128 v[80:83], v4 offset:17408
    buffer_load_dwordx4 v2, s[8:11], s23 offen offset:1024 lds
    v_mfma_f32_16x16x32_bf16 v[36:39], a[180:183], v[88:91], v[36:39]
    ds_read_b128 v[84:87], v5 offset:17408
    v_mfma_f32_16x16x32_bf16 v[44:47], a[180:183], v[92:95], v[44:47]
    buffer_load_dwordx4 v2, s[8:11], s23 offen offset:2048 lds
    v_mfma_f32_16x16x32_bf16 v[40:43], a[176:179], v[92:95], v[40:43]
    s_waitcnt lgkmcnt(4)
    v_mfma_f32_16x16x32_bf16 v[32:35], a[184:187], v[96:99], v[32:35]
    ds_read_b128 v[88:91], v4 offset:18432
    buffer_load_dwordx4 v2, s[8:11], s23 offen offset:3072 lds
    v_mfma_f32_16x16x32_bf16 v[36:39], a[188:191], v[96:99], v[36:39]
    ds_read_b128 v[92:95], v5 offset:18432
    s_cmp_ge_u32 s21, 131072
    v_mfma_f32_16x16x32_bf16 v[44:47], a[188:191], v[100:103], v[44:47]
    s_cselect_b32 s22, 0xfffe0000, s29
    s_add_u32 s21, s21, s22
    v_mfma_f32_16x16x32_bf16 v[40:43], a[184:187], v[100:103], v[40:43]
    s_waitcnt lgkmcnt(4)
    v_mfma_f32_16x16x32_bf16 v[32:35], a[192:195], v[72:75], v[32:35]
    ds_read_b128 v[96:99], v4 offset:19456
    v_mfma_f32_16x16x32_bf16 v[36:39], a[196:199], v[72:75], v[36:39]
    ds_read_b128 v[100:103], v5 offset:19456
    v_mfma_f32_16x16x32_bf16 v[44:47], a[196:199], v[76:79], v[44:47]
    v_mfma_f32_16x16x32_bf16 v[40:43], a[192:195], v[76:79], v[40:43]
    s_waitcnt lgkmcnt(4)
    v_mfma_f32_16x16x32_bf16 v[32:35], a[200:203], v[80:83], v[32:35]
    ds_read_b128 v[72:75], v4 offset:24576
    s_waitcnt vmcnt(8)
    v_cmp_lt_u32 vcc, v19, v18
    v_mfma_f32_16x16x32_bf16 v[36:39], a[204:207], v[80:83], v[36:39]
    ds_read_b128 v[76:79], v5 offset:24576
    v_mfma_f32_16x16x32_bf16 v[44:47], a[204:207], v[84:87], v[44:47]
    v_mfma_f32_16x16x32_bf16 v[40:43], a[200:203], v[84:87], v[40:43]
    s_cbranch_vccnz seg_pslow
seg_pok:
    s_waitcnt lgkmcnt(4)
    v_mfma_f32_16x16x32_bf16 v[32:35], a[208:211], v[88:91], v[32:35]
    ds_read_b128 v[80:83], v4 offset:25600
    buffer_load_dwordx4 v[104:107], v23, s[8:11], s24 offen offset:0 sc1
    v_mfma_f32_16x16x32_bf16 v[36:39], a[212:215], v[88:91], v[36:39]
    ds_read_b128 v[84:87], v5 offset:25600
    buffer_load_dwordx4 v[108:111], v23, s[8:11], s24 offen offset:1024 sc1
    v_mfma_f32_16x16x32_bf16 v[44:47], a[212:215], v[92:95], v[44:47]
    buffer_load_dwordx4 v[112:115], v23, s[8:11], s24 offen offset:2048 sc1
    v_mfma_f32_16x16x32_bf16 v[40:43], a[208:211], v[92:95], v[40:43]
    s_waitcnt lgkmcnt(4)
    v_mfma_f32_16x16x32_bf16 v[32:35], a[216:219], v[96:99], v[32:35]
    ds_read_b128 v[88:91], v4 offset:26624
    v_mfma_f32_16x16x32_bf16 v[36:39], a[220:223], v[96:99], v[36:39]
    ds_read_b128 v[92:95], v5 offset:26624
    v_mfma_f32_16x16x32_bf16 v[44:47], a[220:223], v[100:103], v[44:47]
    v_mfma_f32_16x16x32_bf16 v[40:43], a[216:219], v[100:103], v[40:43]
    s_waitcnt lgkmcnt(4)
    v_mfma_f32_16x16x32_bf16 v[32:35], a[224:227], v[72:75], v[32:35]
    ds_read_b128 v[96:99], v4 offset:27648
    v_mfma_f32_16x16x32_bf16 v[36:39], a[228:231], v[72:75], v[36:39]
    ds_read_b128 v[100:103], v5 offset:27648
    v_mfma_f32_16x16x32_bf16 v[44:47], a[228:231], v[76:79], v[44:47]
    v_add_u32 v4, s22, v4
    v_add_u32 v5, s22, v5
    v_mfma_f32_16x16x32_bf16 v[40:43], a[224:227], v[76:79], v[40:43]
    s_waitcnt vmcnt(29)
    s_barrier
    s_waitcnt lgkmcnt(4)
    v_mfma_f32_16x16x32_bf16 v[32:35], a[232:235], v[80:83], v[32:35]
    ds_read_b128 v[72:75], v4 offset:0
    s_add_u32 s20, s20, 32768
    s_cmp_ge_u32 s20, 163840
    v_mfma_f32_16x16x32_bf16 v[36:39], a[236:239], v[80:83], v[36:39]
    ds_read_b128 v[76:79], v5 offset:0
    s_cselect_b32 s60, 163840, 0
    s_sub_u32 s20, s20, s60
    v_mfma_f32_16x16x32_bf16 v[44:47], a[236:239], v[84:87], v[44:47]
    s_add_u32 s37, s23, 0x600000
    s_xor_b32 s37, s37, 0x2000
    v_mfma_f32_16x16x32_bf16 v[40:43], a[232:235], v[84:87], v[40:43]
    s_cmp_ge_u32 s33, s35
    s_cselect_b32 s62, 0xc000000, s38
    s_waitcnt lgkmcnt(4)
    v_mfma_f32_16x16x32_bf16 v[32:35], a[240:243], v[88:91], v[32:35]
    ds_read_b128 v[80:83], v4 offset:1024
    s_add_u32 s37, s37, s62
    s_add_u32 s23, s23, 0x40000
    v_mfma_f32_16x16x32_bf16 v[36:39], a[244:247], v[88:91], v[36:39]
    ds_read_b128 v[84:87], v5 offset:1024
    s_add_u32 s25, s25, 0xc0000
    s_cmp_ge_u32 s26, 2
    v_mfma_f32_16x16x32_bf16 v[44:47], a[244:247], v[92:95], v[44:47]
    s_cselect_b32 s18, 0x1000000, 0
    s_cmp_lt_u32 s26, s39
    v_mfma_f32_16x16x32_bf16 v[40:43], a[240:243], v[92:95], v[40:43]
    s_waitcnt lgkmcnt(4)
    v_mfma_f32_16x16x32_bf16 v[48:51], a[248:251], v[96:99], v[32:35]
    ds_read_b128 v[88:91], v4 offset:2048
    v_mfma_f32_16x16x32_bf16 v[52:55], a[252:255], v[96:99], v[36:39]
    ds_read_b128 v[92:95], v5 offset:2048
    v_mfma_f32_16x16x32_bf16 v[60:63], a[252:255], v[100:103], v[44:47]
    v_mfma_f32_16x16x32_bf16 v[56:59], a[248:251], v[100:103], v[40:43]
    s_cbranch_scc1 seg_p
    s_xor_b32 s24, s24, 0x80000
    s_waitcnt vmcnt(0)
    v_pk_add_f32 v[104:105], v[104:105], v[64:65]
    v_pk_add_f32 v[106:107], v[106:107], v[66:67]
    v_pk_add_f32 v[108:109], v[108:109], v[112:113]
    v_pk_add_f32 v[110:111], v[110:111], v[114:115]
    v_pk_add_f32 v[104:105], v[104:105], v[108:109]
    v_pk_add_f32 v[106:107], v[106:107], v[110:111]
    v_cvt_pk_bf16_f32 v104, 0, v104
    v_cvt_pk_bf16_f32 v105, 0, v105
    v_cvt_pk_bf16_f32 v106, 0, v106
    v_cvt_pk_bf16_f32 v107, 0, v107
    buffer_store_dwordx4 v[104:107], v15, s[16:19], s25 offen
    buffer_store_dwordx4 v[48:51], v20, s[8:11], s24 offen
    buffer_store_dwordx4 v[52:55], v21, s[8:11], s24 offen
    buffer_store_dwordx4 v[56:59], v22, s[8:11], s24 offen
    s_add_u32 s25, s25, 0xc0000
    s_waitcnt vmcnt(0)
    s_barrier
    s_add_u32 s26, s26, 1
    v_mov_b32 v12, s26
    buffer_store_dword v12, v11, s[8:11], s27 offen
    v_mov_b32 v18, s26
    v_writelane_b32 v18, s34, 32
    v_writelane_b32 v18, s40, 33
L_sp_59:
    global_load_dword v19, v[16:17], off sc1
    s_add_u32 s30, s30, 1
    s_cmp_gt_u32 s30, 0x200000
    s_cbranch_scc1 chain_kernel_wabort
    s_waitcnt vmcnt(0)
    v_cmp_lt_u32 vcc, v19, v18
    s_cbranch_vccz L_spok_60
    s_branch L_sp_59
L_spok_60:
    buffer_load_dwordx4 v[104:107], v23, s[8:11], s24 offen offset:0 sc1
    buffer_load_dwordx4 v[108:111], v23, s[8:11], s24 offen offset:1024 sc1
    buffer_load_dwordx4 v[112:115], v23, s[8:11], s24 offen offset:2048 sc1
    s_waitcnt vmcnt(0) lgkmcnt(0)
    v_pk_add_f32 v[104:105], v[104:105], v[60:61]
    v_pk_add_f32 v[106:107], v[106:107], v[62:63]
    v_pk_add_f32 v[108:109], v[108:109], v[112:113]
    v_pk_add_f32 v[110:111], v[110:111], v[114:115]
    v_pk_add_f32 v[104:105], v[104:105], v[108:109]
    v_pk_add_f32 v[106:107], v[106:107], v[110:111]
    v_cvt_pk_bf16_f32 v104, 0, v104
    v_cvt_pk_bf16_f32 v105, 0, v105
    v_cvt_pk_bf16_f32 v106, 0, v106
    v_cvt_pk_bf16_f32 v107, 0, v107
    buffer_store_dwordx4 v[104:107], v15, s[16:19], s25 offen
seg_t0:
    s_mov_b32 s35, 63
    s_lshr_b32 s60, s57, 3
    s_lshl_b32 s60, s60, 8
    s_add_u32 s60, s60, 0xb201000
    s_add_u32 s37, s60, s100
    s_addc_u32 s38, s101, 0
seg_t:
    s_and_b32 s33, s36, 0xff
    s_cbranch_scc0 seg_end
    s_lshr_b32 s36, s36, 8
    s_lshl_b32 s20, s58, 13
    s_mov_b32 s21, 0
    s_lshr_b32 s60, s57, 4
    s_lshl_b32 s60, s60, 12
    v_add_u32 v5, s60, v1
    v_xor_b32 v4, 4096, v5
    s_lshl_b32 s61, s33, 13
    s_and_b32 s61, s61, 0x2000
    s_xor_b32 s61, s61, s31
    s_lshl_b32 s23, s33, 21
    s_add_u32 s23, s23, s61
    s_cmp_gt_u32 s33, s35
    s_cselect_b32 s23, 0xc000000, s23
    s_xor_b32 s24, s24, 0x80000
    s_lshl_b32 s25, s33, 18
    s_add_u32 s34, s33, 3
    s_min_u32 s34, s34, 64
    v_mov_b32 v18, s26
    v_writelane_b32 v18, s34, 32
    v_writelane_b32 v18, s40, 33
L_sp_61:
    global_load_dword v19, v[16:17], off sc1
    s_add_u32 s30, s30, 1
    s_cmp_gt_u32 s30, 0x200000
    s_cbranch_scc1 chain_kernel_wabort
    s_waitcnt vmcnt(0)
    v_cmp_lt_u32 vcc, v19, v18
    s_cbranch_vccz L_spok_62
    s_sleep 2
    s_branch L_sp_61
L_spok_62:
    s_cmp_lt_u32 s33, 62
    s_cbranch_scc1 L_tf_63
    v_writelane_b32 v16, s37, 33
    v_writelane_b32 v17, s38, 33
    s_mov_b32 s40, 32
    v_mov_b32 v18, s26
    v_writelane_b32 v18, s34, 32
    v_writelane_b32 v18, s40, 33
L_sp_64:
    global_load_dword v19, v[16:17], off sc1
    s_add_u32 s30, s30, 1
    s_cmp_gt_u32 s30, 0x200000
    s_cbranch_scc1 chain_kernel_wabort
    s_waitcnt vmcnt(0)
    v_cmp_lt_u32 vcc, v19, v18
    s_cbranch_vccz L_spok_65
    s_branch L_sp_64
L_spok_65:
L_tf_63:
    s_add_u32 m0, s20, 0
    s_nop 0
    buffer_load_dwordx4 v1, s[8:11], s23 offen offset:0 lds
    buffer_load_dwordx4 v1, s[8:11], s23 offen offset:1024 lds
    buffer_load_dwordx4 v1, s[8:11], s23 offen offset:2048 lds
    buffer_load_dwordx4 v1, s[8:11], s23 offen offset:3072 lds
    s_add_u32 m0, s20, 4096
    s_nop 0
    buffer_load_dwordx4 v2, s[8:11], s23 offen offset:0 lds
    buffer_load_dwordx4 v2, s[8:11], s23 offen offset:1024 lds
    buffer_load_dwordx4 v2, s[8:11], s23 offen offset:2048 lds
    buffer_load_dwordx4 v2, s[8:11], s23 offen offset:3072 lds
    s_add_u32 s20, s20, 32768
    s_cmp_ge_u32 s20, 163840
    s_cselect_b32 s60, 163840, 0
    s_sub_u32 s20, s20, s60
    s_add_u32 s23, s23, 0x40000
    s_add_u32 m0, s20, 0
    s_nop 0
    buffer_load_dwordx4 v1, s[8:11], s23 offen offset:0 lds
    buffer_load_dwordx4 v1, s[8:11], s23 offen offset:1024 lds
    buffer_load_dwordx4 v1, s[8:11], s23 offen offset:2048 lds
    buffer_load_dwordx4 v1, s[8:11], s23 offen offset:3072 lds
    s_add_u32 m0, s20, 4096
    s_nop 0
    buffer_load_dwordx4 v2, s[8:11], s23 offen offset:0 lds
    buffer_load_dwordx4 v2, s[8:11], s23 offen offset:1024 lds
    buffer_load_dwordx4 v2, s[8:11], s23 offen offset:2048 lds
    buffer_load_dwordx4 v2, s[8:11], s23 offen offset:3072 lds
    s_waitcnt vmcnt(8)
    s_barrier
    ds_read_b128 v[72:75], v4 offset:0
    ds_read_b128 v[76:79], v5 offset:0
    ds_read_b128 v[80:83], v4 offset:1024
    ds_read_b128 v[84:87], v5 offset:1024
    ds_read_b128 v[88:91], v4 offset:2048
    ds_read_b128 v[92:95], v5 offset:2048
    s_waitcnt lgkmcnt(4)
    v_mfma_f32_16x16x32_bf16 v[32:35], a[0:3], v[72:75], 0
    ds_read_b128 v[96:99], v4 offset:3072
    v_mfma_f32_16x16x32_bf16 v[36:39], a[4:7], v[72:75], 0
    ds_read_b128 v[100:103], v5 offset:3072
    v_mfma_f32_16x16x32_bf16 v[44:47], a[4:7], v[76:79], 0
    v_mfma_f32_16x16x32_bf16 v[40:43], a[0:3], v[76:79], 0
    s_waitcnt lgkmcnt(4)
    v_mfma_f32_16x16x32_bf16 v[32:35], a[8:11], v[80:83], v[32:35]
    ds_read_b128 v[72:75], v4 offset:8192
    v_mfma_f32_16x16x32_bf16 v[36:39], a[12:15], v[80:83], v[36:39]
    ds_read_b128 v[76:79], v5 offset:8192
    v_mfma_f32_16x16x32_bf16 v[44:47], a[12:15], v[84:87], v[44:47]
    v_mfma_f32_16x16x32_bf16 v[40:43], a[8:11], v[84:87], v[40:43]
    s_waitcnt lgkmcnt(4)
    v_mfma_f32_16x16x32_bf16 v[32:35], a[16:19], v[88:91], v[32:35]
    ds_read_b128 v[80:83], v4 offset:9216
    v_mfma_f32_16x16x32_bf16 v[36:39], a[20:23], v[88:91], v[36:39]
    ds_read_b128 v[84:87], v5 offset:9216
    v_mfma_f32_16x16x32_bf16 v[44:47], a[20:23], v[92:95], v[44:47]
    v_mfma_f32_16x16x32_bf16 v[40:43], a[16:19], v[92:95], v[40:43]
    s_waitcnt lgkmcnt(4)
    v_mfma_f32_16x16x32_bf16 v[32:35], a[24:27], v[96:99], v[32:35]
    ds_read_b128 v[88:91], v4 offset:10240
    v_mfma_f32_16x16x32_bf16 v[36:39], a[28:31], v[96:99], v[36:39]
    ds_read_b128 v[92:95], v5 offset:10240
    v_mfma_f32_16x16x32_bf16 v[44:47], a[28:31], v[100:103], v[44:47]
    v_mfma_f32_16x16x32_bf16 v[40:43], a[24:27], v[100:103], v[40:43]
    s_waitcnt lgkmcnt(4)
    v_mfma_f32_16x16x32_bf16 v[32:35], a[32:35], v[72:75], v[32:35]
    ds_read_b128 v[96:99], v4 offset:11264
    v_mfma_f32_16x16x32_bf16 v[36:39], a[36:39], v[72:75], v[36:39]
    ds_read_b128 v[100:103], v5 offset:11264
    v_mfma_f32_16x16x32_bf16 v[44:47], a[36:39], v[76:79], v[44:47]
    v_mfma_f32_16x16x32_bf16 v[40:43], a[32:35], v[76:79], v[40:43]
    s_waitcnt lgkmcnt(4)
    v_mfma_f32_16x16x32_bf16 v[32:35], a[40:43], v[80:83], v[32:35]
    ds_read_b128 v[72:75], v4 offset:16384
    v_mfma_f32_16x16x32_bf16 v[36:39], a[44:47], v[80:83], v[36:39]
    ds_read_b128 v[76:79], v5 offset:16384
    v_mfma_f32_16x16x32_bf16 v[44:47], a[44:47], v[84:87], v[44:47]
    v_mfma_f32_16x16x32_bf16 v[40:43], a[40:43], v[84:87], v[40:43]
    s_waitcnt lgkmcnt(4)
    v_mfma_f32_16x16x32_bf16 v[32:35], a[48:51], v[88:91], v[32:35]
    ds_read_b128 v[80:83], v4 offset:17408
    v_mfma_f32_16x16x32_bf16 v[36:39], a[52:55], v[88:91], v[36:39]
    ds_read_b128 v[84:87], v5 offset:17408
    v_mfma_f32_16x16x32_bf16 v[44:47], a[52:55], v[92:95], v[44:47]
    v_mfma_f32_16x16x32_bf16 v[40:43], a[48:51], v[92:95], v[40:43]
    s_waitcnt lgkmcnt(4)
    v_mfma_f32_16x16x32_bf16 v[32:35], a[56:59], v[96:99], v[32:35]
    ds_read_b128 v[88:91], v4 offset:18432
    v_mfma_f32_16x16x32_bf16 v[36:39], a[60:63], v[96:99], v[36:39]
    ds_read_b128 v[92:95], v5 offset:18432
    v_mfma_f32_16x16x32_bf16 v[44:47], a[60:63], v[100:103], v[44:47]
    v_mfma_f32_16x16x32_bf16 v[40:43], a[56:59], v[100:103], v[40:43]
    s_waitcnt lgkmcnt(4)
    v_mfma_f32_16x16x32_bf16 v[32:35], a[64:67], v[72:75], v[32:35]
    ds_read_b128 v[96:99], v4 offset:19456
    v_mfma_f32_16x16x32_bf16 v[36:39], a[68:71], v[72:75], v[36:39]
    ds_read_b128 v[100:103], v5 offset:19456
    v_mfma_f32_16x16x32_bf16 v[44:47], a[68:71], v[76:79], v[44:47]
    v_mfma_f32_16x16x32_bf16 v[40:43], a[64:67], v[76:79], v[40:43]
    s_waitcnt lgkmcnt(4)
    v_mfma_f32_16x16x32_bf16 v[32:35], a[72:75], v[80:83], v[32:35]
    ds_read_b128 v[72:75], v4 offset:24576
    v_mfma_f32_16x16x32_bf16 v[36:39], a[76:79], v[80:83], v[36:39]
    ds_read_b128 v[76:79], v5 offset:24576
    v_mfma_f32_16x16x32_bf16 v[44:47], a[76:79], v[84:87], v[44:47]
    v_mfma_f32_16x16x32_bf16 v[40:43], a[72:75], v[84:87], v[40:43]
    s_waitcnt lgkmcnt(4)
    v_mfma_f32_16x16x32_bf16 v[32:35], a[80:83], v[88:91], v[32:35]
    ds_read_b128 v[80:83], v4 offset:25600
    v_mfma_f32_16x16x32_bf16 v[36:39], a[84:87], v[88:91], v[36:39]
    ds_read_b128 v[84:87], v5 offset:25600
    v_mfma_f32_16x16x32_bf16 v[44:47], a[84:87], v[92:95], v[44:47]
    v_mfma_f32_16x16x32_bf16 v[40:43], a[80:83], v[92:95], v[40:43]
    s_waitcnt lgkmcnt(4)
    v_mfma_f32_16x16x32_bf16 v[32:35], a[88:91], v[96:99], v[32:35]
    ds_read_b128 v[88:91], v4 offset:26624
    v_mfma_f32_16x16x32_bf16 v[36:39], a[92:95], v[96:99], v[36:39]
    ds_read_b128 v[92:95], v5 offset:26624
    v_mfma_f32_16x16x32_bf16 v[44:47], a[92:95], v[100:103], v[44:47]
    v_mfma_f32_16x16x32_bf16 v[40:43], a[88:91], v[100:103], v[40:43]
    s_waitcnt lgkmcnt(4)
    v_mfma_f32_16x16x32_bf16 v[32:35], a[96:99], v[72:75], v[32:35]
    ds_read_b128 v[96:99], v4 offset:27648
    v_mfma_f32_16x16x32_bf16 v[36:39], a[100:103], v[72:75], v[36:39]
    ds_read_b128 v[100:103], v5 offset:27648
    v_mfma_f32_16x16x32_bf16 v[44:47], a[100:103], v[76:79], v[44:47]
    v_mfma_f32_16x16x32_bf16 v[40:43], a[96:99], v[76:79], v[40:43]
    s_waitcnt vmcnt(0)
    s_barrier
    s_waitcnt lgkmcnt(4)
    v_mfma_f32_16x16x32_bf16 v[32:35], a[104:107], v[80:83], v[32:35]
    ds_read_b128 v[72:75], v4 offset:32768
    v_mfma_f32_16x16x32_bf16 v[36:39], a[108:111], v[80:83], v[36:39]
    ds_read_b128 v[76:79], v5 offset:32768
    v_mfma_f32_16x16x32_bf16 v[44:47], a[108:111], v[84:87], v[44:47]
    v_mfma_f32_16x16x32_bf16 v[40:43], a[104:107], v[84:87], v[40:43]
    s_waitcnt lgkmcnt(4)
    v_mfma_f32_16x16x32_bf16 v[32:35], a[112:115], v[88:91], v[32:35]
    ds_read_b128 v[80:83], v4 offset:33792
    v_mfma_f32_16x16x32_bf16 v[36:39], a[116:119], v[88:91], v[36:39]
    ds_read_b128 v[84:87], v5 offset:33792
    v_mfma_f32_16x16x32_bf16 v[44:47], a[116:119], v[92:95], v[44:47]
    v_mfma_f32_16x16x32_bf16 v[40:43], a[112:115], v[92:95], v[40:43]
    s_waitcnt lgkmcnt(4)
    v_mfma_f32_16x16x32_bf16 v[32:35], a[120:123], v[96:99], v[32:35]
    ds_read_b128 v[88:91], v4 offset:34816
    v_mfma_f32_16x16x32_bf16 v[36:39], a[124:127], v[96:99], v[36:39]
    ds_read_b128 v[92:95], v5 offset:34816
    v_mfma_f32_16x16x32_bf16 v[44:47], a[124:127], v[100:103], v[44:47]
    v_mfma_f32_16x16x32_bf16 v[40:43], a[120:123], v[100:103], v[40:43]
    s_waitcnt lgkmcnt(4)
    v_mfma_f32_16x16x32_bf16 v[32:35], a[128:131], v[72:75], v[32:35]
    ds_read_b128 v[96:99], v4 offset:35840
    v_mfma_f32_16x16x32_bf16 v[36:39], a[132:135], v[72:75], v[36:39]
    ds_read_b128 v[100:103], v5 offset:35840
    v_mfma_f32_16x16x32_bf16 v[44:47], a[132:135], v[76:79], v[44:47]
    v_mfma_f32_16x16x32_bf16 v[40:43], a[128:131], v[76:79], v[40:43]
    s_waitcnt lgkmcnt(4)
    v_mfma_f32_16x16x32_bf16 v[32:35], a[136:139], v[80:83], v[32:35]
    ds_read_b128 v[72:75], v4 offset:40960
    v_mfma_f32_16x16x32_bf16 v[36:39], a[140:143], v[80:83], v[36:39]
    ds_read_b128 v[76:79], v5 offset:40960
    v_mfma_f32_16x16x32_bf16 v[44:47], a[140:143], v[84:87], v[44:47]
    v_mfma_f32_16x16x32_bf16 v[40:43], a[136:139], v[84:87], v[40:43]
    s_waitcnt lgkmcnt(4)
    v_mfma_f32_16x16x32_bf16 v[32:35], a[144:147], v[88:91], v[32:35]
    ds_read_b128 v[80:83], v4 offset:41984
    v_mfma_f32_16x16x32_bf16 v[36:39], a[148:151], v[88:91], v[36:39]
    ds_read_b128 v[84:87], v5 offset:41984
    v_mfma_f32_16x16x32_bf16 v[44:47], a[148:151], v[92:95], v[44:47]
    v_mfma_f32_16x16x32_bf16 v[40:43], a[144:147], v[92:95], v[40:43]
    s_waitcnt lgkmcnt(4)
    v_mfma_f32_16x16x32_bf16 v[32:35], a[152:155], v[96:99], v[32:35]
    ds_read_b128 v[88:91], v4 offset:43008
    v_mfma_f32_16x16x32_bf16 v[36:39], a[156:159], v[96:99], v[36:39]
    ds_read_b128 v[92:95], v5 offset:43008
    v_mfma_f32_16x16x32_bf16 v[44:47], a[156:159], v[100:103], v[44:47]
    v_mfma_f32_16x16x32_bf16 v[40:43], a[152:155], v[100:103], v[40:43]
    s_waitcnt lgkmcnt(4)
    v_mfma_f32_16x16x32_bf16 v[32:35], a[160:163], v[72:75], v[32:35]
    ds_read_b128 v[96:99], v4 offset:44032
    v_mfma_f32_16x16x32_bf16 v[36:39], a[164:167], v[72:75], v[36:39]
    ds_read_b128 v[100:103], v5 offset:44032
    v_mfma_f32_16x16x32_bf16 v[44:47], a[164:167], v[76:79], v[44:47]
    v_mfma_f32_16x16x32_bf16 v[40:43], a[160:163], v[76:79], v[40:43]
    s_waitcnt lgkmcnt(4)
    v_mfma_f32_16x16x32_bf16 v[32:35], a[168:171], v[80:83], v[32:35]
    ds_read_b128 v[72:75], v4 offset:49152
    v_mfma_f32_16x16x32_bf16 v[36:39], a[172:175], v[80:83], v[36:39]
    ds_read_b128 v[76:79], v5 offset:49152
    v_mfma_f32_16x16x32_bf16 v[44:47], a[172:175], v[84:87], v[44:47]
    v_mfma_f32_16x16x32_bf16 v[40:43], a[168:171], v[84:87], v[40:43]
    s_waitcnt lgkmcnt(4)
    v_mfma_f32_16x16x32_bf16 v[32:35], a[176:179], v[88:91], v[32:35]
    ds_read_b128 v[80:83], v4 offset:50176
    v_mfma_f32_16x16x32_bf16 v[36:39], a[180:183], v[88:91], v[36:39]
    ds_read_b128 v[84:87], v5 offset:50176
    v_mfma_f32_16x16x32_bf16 v[44:47], a[180:183], v[92:95], v[44:47]
    v_mfma_f32_16x16x32_bf16 v[40:43], a[176:179], v[92:95], v[40:43]
    s_waitcnt lgkmcnt(4)
    v_mfma_f32_16x16x32_bf16 v[32:35], a[184:187], v[96:99], v[32:35]
    ds_read_b128 v[88:91], v4 offset:51200
    v_mfma_f32_16x16x32_bf16 v[36:39], a[188:191], v[96:99], v[36:39]
    ds_read_b128 v[92:95], v5 offset:51200
    v_mfma_f32_16x16x32_bf16 v[44:47], a[188:191], v[100:103], v[44:47]
    v_mfma_f32_16x16x32_bf16 v[40:43], a[184:187], v[100:103], v[40:43]
    s_waitcnt lgkmcnt(4)
    v_mfma_f32_16x16x32_bf16 v[32:35], a[192:195], v[72:75], v[32:35]
    ds_read_b128 v[96:99], v4 offset:52224
    v_mfma_f32_16x16x32_bf16 v[36:39], a[196:199], v[72:75], v[36:39]
    ds_read_b128 v[100:103], v5 offset:52224
    v_mfma_f32_16x16x32_bf16 v[44:47], a[196:199], v[76:79], v[44:47]
    v_mfma_f32_16x16x32_bf16 v[40:43], a[192:195], v[76:79], v[40:43]
    s_waitcnt lgkmcnt(4)
    v_mfma_f32_16x16x32_bf16 v[32:35], a[200:203], v[80:83], v[32:35]
    ds_read_b128 v[72:75], v4 offset:57344
    v_mfma_f32_16x16x32_bf16 v[36:39], a[204:207], v[80:83], v[36:39]
    ds_read_b128 v[76:79], v5 offset:57344
    v_mfma_f32_16x16x32_bf16 v[44:47], a[204:207], v[84:87], v[44:47]
    v_mfma_f32_16x16x32_bf16 v[40:43], a[200:203], v[84:87], v[40:43]
    s_waitcnt lgkmcnt(4)
    v_mfma_f32_16x16x32_bf16 v[32:35], a[208:211], v[88:91], v[32:35]
    ds_read_b128 v[80:83], v4 offset:58368
    v_mfma_f32_16x16x32_bf16 v[36:39], a[212:215], v[88:91], v[36:39]
    ds_read_b128 v[84:87], v5 offset:58368
    v_mfma_f32_16x16x32_bf16 v[44:47], a[212:215], v[92:95], v[44:47]
    v_mfma_f32_16x16x32_bf16 v[40:43], a[208:211], v[92:95], v[40:43]
    s_waitcnt lgkmcnt(4)
    v_mfma_f32_16x16x32_bf16 v[32:35], a[216:219], v[96:99], v[32:35]
    ds_read_b128 v[88:91], v4 offset:59392
    v_mfma_f32_16x16x32_bf16 v[36:39], a[220:223], v[96:99], v[36:39]
    ds_read_b128 v[92:95], v5 offset:59392
    v_mfma_f32_16x16x32_bf16 v[44:47], a[220:223], v[100:103], v[44:47]
    v_mfma_f32_16x16x32_bf16 v[40:43], a[216:219], v[100:103], v[40:43]
    s_waitcnt lgkmcnt(4)
    v_mfma_f32_16x16x32_bf16 v[32:35], a[224:227], v[72:75], v[32:35]
    ds_read_b128 v[96:99], v4 offset:60416
    v_mfma_f32_16x16x32_bf16 v[36:39], a[228:231], v[72:75], v[36:39]
    ds_read_b128 v[100:103], v5 offset:60416
    v_mfma_f32_16x16x32_bf16 v[44:47], a[228:231], v[76:79], v[44:47]
    v_mfma_f32_16x16x32_bf16 v[40:43], a[224:227], v[76:79], v[40:43]
    s_waitcnt lgkmcnt(4)
    v_mfma_f32_16x16x32_bf16 v[32:35], a[232:235], v[80:83], v[32:35]
    v_mfma_f32_16x16x32_bf16 v[36:39], a[236:239], v[80:83], v[36:39]
    v_mfma_f32_16x16x32_bf16 v[44:47], a[236:239], v[84:87], v[44:47]
    v_mfma_f32_16x16x32_bf16 v[40:43], a[232:235], v[84:87], v[40:43]
    s_waitcnt lgkmcnt(2)
    v_mfma_f32_16x16x32_bf16 v[32:35], a[240:243], v[88:91], v[32:35]
    v_mfma_f32_16x16x32_bf16 v[36:39], a[244:247], v[88:91], v[36:39]
    v_mfma_f32_16x16x32_bf16 v[44:47], a[244:247], v[92:95], v[44:47]
    v_mfma_f32_16x16x32_bf16 v[40:43], a[240:243], v[92:95], v[40:43]
    s_waitcnt lgkmcnt(0)
    v_mfma_f32_16x16x32_bf16 v[48:51], a[248:251], v[96:99], v[32:35]
    v_mfma_f32_16x16x32_bf16 v[52:55], a[252:255], v[96:99], v[36:39]
    v_mfma_f32_16x16x32_bf16 v[60:63], a[252:255], v[100:103], v[44:47]
    v_mfma_f32_16x16x32_bf16 v[56:59], a[248:251], v[100:103], v[40:43]
    s_nop 7
    buffer_store_dwordx4 v[48:51], v20, s[8:11], s24 offen
    buffer_store_dwordx4 v[52:55], v21, s[8:11], s24 offen
    buffer_store_dwordx4 v[56:59], v22, s[8:11], s24 offen
    s_waitcnt vmcnt(0)
    s_barrier
    s_add_u32 s26, s26, 1
    v_mov_b32 v12, s26
    buffer_store_dword v12, v11, s[8:11], s27 offen
    v_mov_b32 v18, s26
    v_writelane_b32 v18, s34, 32
    v_writelane_b32 v18, s40, 33
L_sp_66:
    global_load_dword v19, v[16:17], off sc1
    s_add_u32 s30, s30, 1
    s_cmp_gt_u32 s30, 0x200000
    s_cbranch_scc1 chain_kernel_wabort
    s_waitcnt vmcnt(0)
    v_cmp_lt_u32 vcc, v19, v18
    s_cbranch_vccz L_spok_67
    s_branch L_sp_66
L_spok_67:
    buffer_load_dwordx4 v[104:107], v23, s[8:11], s24 offen offset:0 sc1
    buffer_load_dwordx4 v[108:111], v23, s[8:11], s24 offen offset:1024 sc1
    buffer_load_dwordx4 v[112:115], v23, s[8:11], s24 offen offset:2048 sc1
    s_waitcnt vmcnt(0)
    v_pk_add_f32 v[104:105], v[104:105], v[60:61]
    v_pk_add_f32 v[106:107], v[106:107], v[62:63]
    v_pk_add_f32 v[108:109], v[108:109], v[112:113]
    v_pk_add_f32 v[110:111], v[110:111], v[114:115]
    v_pk_add_f32 v[104:105], v[104:105], v[108:109]
    v_pk_add_f32 v[106:107], v[106:107], v[110:111]
    v_cvt_pk_bf16_f32 v104, 0, v104
    v_cvt_pk_bf16_f32 v105, 0, v105
    v_cvt_pk_bf16_f32 v106, 0, v106
    v_cvt_pk_bf16_f32 v107, 0, v107
    buffer_store_dwordx4 v[104:107], v15, s[16:19], s25 offen
    s_branch seg_t
seg_end:
    s_endpgm
seg_pslow:
L_sp_68:
    global_load_dword v19, v[16:17], off sc1
    s_add_u32 s30, s30, 1
    s_cmp_gt_u32 s30, 0x200000
    s_cbranch_scc1 chain_kernel_wabort
    s_waitcnt vmcnt(0)
    v_cmp_lt_u32 vcc, v19, v18
    s_cbranch_vccz L_spok_69
    s_sleep 2
    s_branch L_sp_68
L_spok_69:
    s_branch seg_pok
    s_endpgm
chain_kernel_wabort:
    s_mov_b64 exec, 1
    v_mov_b32 v1, 0xdeadbeef
    v_mov_b32 v2, 120
    global_store_dword v2, v1, s[98:99]
    s_endpgm
t_g2_c:
    s_mov_b32 s43, 0
    v_bfe_u32 v16, v0, 5, 1
    v_lshlrev_b32 v23, 13, v16
    v_bfe_u32 v16, v0, 7, 1
    v_lshl_add_u32 v23, v16, 12, v23
    v_bfe_u32 v16, v0, 1, 1
    v_lshl_add_u32 v23, v16, 8, v23
    v_bfe_u32 v16, v0, 1, 1
    v_lshl_add_u32 v23, v16, 6, v23
    v_bfe_u32 v16, v0, 4, 1
    v_lshl_add_u32 v23, v16, 7, v23
    v_bfe_u32 v16, v0, 2, 2
    v_lshl_add_u32 v23, v16, 4, v23
    v_bfe_u32 v16, v0, 0, 1
    v_lshl_add_u32 v23, v16, 3, v23
    v_add_u32 v14, s49, v23
    v_xor_b32 v15, 64, v14
    ds_read_b64_tr_b16 v[72:73], v14 offset:0
    ds_read_b64_tr_b16 v[74:75], v15 offset:0
    ds_read_b128 v[44:47], v12 offset:2048
    ds_read_b128 v[40:43], v12 offset:0
    ds_read_b64_tr_b16 v[76:77], v14 offset:512
    ds_read_b64_tr_b16 v[78:79], v15 offset:512
    ds_read_b128 v[52:55], v12 offset:6144
    ds_read_b128 v[48:51], v12 offset:4096
    ds_read_b128 v[60:63], v12 offset:10240
    ds_read_b128 v[56:59], v12 offset:8192
    ds_read_b128 v[68:71], v12 offset:14336
    ds_read_b128 v[64:67], v12 offset:12288
    s_branch t_g2_as
t_g2:
    s_mov_b32 s43, 0
    v_bfe_u32 v16, v0, 5, 1
    v_lshlrev_b32 v23, 13, v16
    v_bfe_u32 v16, v0, 7, 1
    v_lshl_add_u32 v23, v16, 12, v23
    v_bfe_u32 v16, v0, 1, 1
    v_lshl_add_u32 v23, v16, 8, v23
    v_bfe_u32 v16, v0, 1, 1
    v_lshl_add_u32 v23, v16, 6, v23
    v_bfe_u32 v16, v0, 4, 1
    v_lshl_add_u32 v23, v16, 7, v23
    v_bfe_u32 v16, v0, 2, 2
    v_lshl_add_u32 v23, v16, 4, v23
    v_bfe_u32 v16, v0, 0, 1
    v_lshl_add_u32 v23, v16, 3, v23
    v_add_u32 v14, s49, v23
    v_xor_b32 v15, 64, v14
    ds_read_b64_tr_b16 v[72:73], v14 offset:0
    ds_read_b64_tr_b16 v[74:75], v15 offset:0
    ds_read_b128 v[44:47], v12 offset:2048
    ds_read_b128 v[40:43], v12 offset:0
    ds_read_b64_tr_b16 v[76:77], v14 offset:512
    ds_read_b64_tr_b16 v[78:79], v15 offset:512
    ds_read_b128 v[52:55], v12 offset:6144
    ds_read_b128 v[48:51], v12 offset:4096
    ds_read_b128 v[60:63], v12 offset:10240
    ds_read_b128 v[56:59], v12 offset:8192
    ds_read_b128 v[68:71], v12 offset:14336
    ds_read_b128 v[64:67], v12 offset:12288
    s_waitcnt lgkmcnt(8)
    v_mfma_f32_16x16x32_bf16 a[0:3], v[40:43], v[72:75], 0
    s_xor_b32 m0, s44, 0
    v_mfma_f32_16x16x32_bf16 a[32:35], v[44:47], v[72:75], 0
    buffer_load_dwordx4 v4, s[8:11], s20 offen lds
    s_waitcnt lgkmcnt(6)
    v_mfma_f32_16x16x32_bf16 a[36:39], v[44:47], v[76:79], 0
    ds_read_b64_tr_b16 v[80:81], v14 offset:1024
    s_xor_b32 m0, s44, 1024
    v_mfma_f32_16x16x32_bf16 a[4:7], v[40:43], v[76:79], 0
    buffer_load_dwordx4 v5, s[8:11], s20 offen lds
    s_waitcnt lgkmcnt(5)
    v_mfma_f32_16x16x32_bf16 a[64:67], v[48:51], v[72:75], 0
    ds_read_b64_tr_b16 v[82:83], v15 offset:1024
    s_add_u32 s20, s20, 128
    v_mfma_f32_16x16x32_bf16 a[96:99], v[52:55], v[72:75], 0
    s_xor_b32 m0, s45, 0
    v_mfma_f32_16x16x32_bf16 a[100:103], v[52:55], v[76:79], 0
    ds_read_b64_tr_b16 v[84:85], v14 offset:1536
    buffer_load_dwordx4 v6, s[12:15], s24 offen lds
    v_mfma_f32_16x16x32_bf16 a[68:71], v[48:51], v[76:79], 0
    s_xor_b32 m0, s45, 1024
    s_waitcnt lgkmcnt(5)
    v_mfma_f32_16x16x32_bf16 a[128:131], v[56:59], v[72:75], 0
    ds_read_b64_tr_b16 v[86:87], v15 offset:1536
    buffer_load_dwordx4 v7, s[12:15], s24 offen lds
    v_mfma_f32_16x16x32_bf16 a[160:163], v[60:63], v[72:75], 0
    s_add_u32 s24, s24, s28
    s_bitcmp1_b32 s43, 0
    v_mfma_f32_16x16x32_bf16 a[164:167], v[60:63], v[76:79], 0
    s_cselect_b32 s61, s5, 0
    s_lshl1_add_u32 s53, s61, s50
    v_mfma_f32_16x16x32_bf16 a[132:135], v[56:59], v[76:79], 0
    s_bitcmp1_b32 s43, 1
    s_waitcnt lgkmcnt(4)
    v_mfma_f32_16x16x32_bf16 a[192:195], v[64:67], v[72:75], 0
    s_cselect_b32 s61, s51, 0
    s_add_u32 s53, s53, s61
    v_mfma_f32_16x16x32_bf16 a[224:227], v[68:71], v[72:75], 0
    s_bitcmp1_b32 s43, 2
    s_cselect_b32 s61, s52, 0
    v_mfma_f32_16x16x32_bf16 a[228:231], v[68:71], v[76:79], 0
    s_add_u32 s53, s53, s61
    s_lshl_b32 s29, s43, 4
    v_mfma_f32_16x16x32_bf16 a[196:199], v[64:67], v[76:79], 0
    s_waitcnt lgkmcnt(2)
    v_mfma_f32_16x16x32_bf16 a[8:11], v[40:43], v[80:83], 0
    s_set_gpr_idx_on s29, gpr_idx(SRC0)
    v_mov_b32 v24, v128
    v_mov_b32 v25, v129
    v_mov_b32 v26, v130
    v_mov_b32 v27, v131
    s_set_gpr_idx_off
    v_mfma_f32_16x16x32_bf16 a[40:43], v[44:47], v[80:83], 0
    s_waitcnt lgkmcnt(0)
    v_mfma_f32_16x16x32_bf16 a[44:47], v[44:47], v[84:87], 0
    ds_read_b64_tr_b16 v[72:73], v14 offset:2048
    s_set_gpr_idx_on s29, gpr_idx(SRC0)
    v_mov_b32 v28, v132
    v_mov_b32 v29, v133
    v_mov_b32 v30, v134
    v_mov_b32 v31, v135
    s_set_gpr_idx_off
    v_mfma_f32_16x16x32_bf16 a[12:15], v[40:43], v[84:87], 0
    v_mfma_f32_16x16x32_bf16 a[72:75], v[48:51], v[80:83], 0
    ds_read_b64_tr_b16 v[74:75], v15 offset:2048
    s_set_gpr_idx_on s29, gpr_idx(SRC0)
    v_mov_b32 v32, v136
    v_mov_b32 v33, v137
    v_mov_b32 v34, v138
    v_mov_b32 v35, v139
    s_set_gpr_idx_off
    v_mfma_f32_16x16x32_bf16 a[104:107], v[52:55], v[80:83], 0
    v_mfma_f32_16x16x32_bf16 a[108:111], v[52:55], v[84:87], 0
    ds_read_b64_tr_b16 v[76:77], v14 offset:2560
    s_set_gpr_idx_on s29, gpr_idx(SRC0)
    v_mov_b32 v36, v140
    v_mov_b32 v37, v141
    v_mov_b32 v38, v142
    v_mov_b32 v39, v143
    s_set_gpr_idx_off
    v_mfma_f32_16x16x32_bf16 a[76:79], v[48:51], v[84:87], 0
    v_mfma_f32_16x16x32_bf16 a[136:139], v[56:59], v[80:83], 0
    ds_read_b64_tr_b16 v[78:79], v15 offset:2560
    buffer_store_dwordx4 v[24:27], v2, s[16:19], s53 offen sc1
    v_mfma_f32_16x16x32_bf16 a[168:171], v[60:63], v[80:83], 0
    v_mfma_f32_16x16x32_bf16 a[172:175], v[60:63], v[84:87], 0
    buffer_store_dwordx4 v[28:31], v3, s[16:19], s53 offen sc1
    v_mfma_f32_16x16x32_bf16 a[140:143], v[56:59], v[84:87], 0
    s_add_u32 s53, s53, s5
    v_mfma_f32_16x16x32_bf16 a[200:203], v[64:67], v[80:83], 0
    buffer_store_dwordx4 v[32:35], v2, s[16:19], s53 offen sc1
    v_mfma_f32_16x16x32_bf16 a[232:235], v[68:71], v[80:83], 0
    v_mfma_f32_16x16x32_bf16 a[236:239], v[68:71], v[84:87], 0
    buffer_store_dwordx4 v[36:39], v3, s[16:19], s53 offen sc1
    v_mfma_f32_16x16x32_bf16 a[204:207], v[64:67], v[84:87], 0
    s_waitcnt lgkmcnt(2)
    v_mfma_f32_16x16x32_bf16 a[16:19], v[40:43], v[72:75], 0
    v_mfma_f32_16x16x32_bf16 a[48:51], v[44:47], v[72:75], 0
    s_waitcnt lgkmcnt(0)
    v_mfma_f32_16x16x32_bf16 a[52:55], v[44:47], v[76:79], 0
    ds_read_b64_tr_b16 v[80:81], v14 offset:3072
    v_mfma_f32_16x16x32_bf16 a[20:23], v[40:43], v[76:79], 0
    v_mfma_f32_16x16x32_bf16 a[80:83], v[48:51], v[72:75], 0
    ds_read_b64_tr_b16 v[82:83], v15 offset:3072
    v_mfma_f32_16x16x32_bf16 a[112:115], v[52:55], v[72:75], 0
    v_mfma_f32_16x16x32_bf16 a[116:119], v[52:55], v[76:79], 0
    ds_read_b64_tr_b16 v[84:85], v14 offset:3584
    v_mfma_f32_16x16x32_bf16 a[84:87], v[48:51], v[76:79], 0
    v_mfma_f32_16x16x32_bf16 a[144:147], v[56:59], v[72:75], 0
    ds_read_b64_tr_b16 v[86:87], v15 offset:3584
    v_mfma_f32_16x16x32_bf16 a[176:179], v[60:63], v[72:75], 0
    v_mfma_f32_16x16x32_bf16 a[180:183], v[60:63], v[76:79], 0
    v_mfma_f32_16x16x32_bf16 a[148:151], v[56:59], v[76:79], 0
    v_mfma_f32_16x16x32_bf16 a[208:211], v[64:67], v[72:75], 0
    v_mfma_f32_16x16x32_bf16 a[240:243], v[68:71], v[72:75], 0
    v_mfma_f32_16x16x32_bf16 a[244:247], v[68:71], v[76:79], 0
    v_mfma_f32_16x16x32_bf16 a[212:215], v[64:67], v[76:79], 0
    s_waitcnt lgkmcnt(2)
    v_mfma_f32_16x16x32_bf16 a[24:27], v[40:43], v[80:83], 0
    ds_read_b64_tr_b16 v[72:73], v14 offset:16384
    v_mfma_f32_16x16x32_bf16 a[56:59], v[44:47], v[80:83], 0
    ds_read_b64_tr_b16 v[74:75], v15 offset:16384
    s_waitcnt lgkmcnt(2)
    v_mfma_f32_16x16x32_bf16 a[60:63], v[44:47], v[84:87], 0
    ds_read_b128 v[44:47], v13 offset:2048
    v_mfma_f32_16x16x32_bf16 a[28:31], v[40:43], v[84:87], 0
    ds_read_b128 v[40:43], v13 offset:0
    v_mfma_f32_16x16x32_bf16 a[88:91], v[48:51], v[80:83], 0
    ds_read_b64_tr_b16 v[76:77], v14 offset:16896
    v_mfma_f32_16x16x32_bf16 a[120:123], v[52:55], v[80:83], 0
    ds_read_b64_tr_b16 v[78:79], v15 offset:16896
    v_mfma_f32_16x16x32_bf16 a[124:127], v[52:55], v[84:87], 0
    ds_read_b128 v[52:55], v13 offset:6144
    v_mfma_f32_16x16x32_bf16 a[92:95], v[48:51], v[84:87], 0
    ds_read_b128 v[48:51], v13 offset:4096
    v_mfma_f32_16x16x32_bf16 a[152:155], v[56:59], v[80:83], 0
    s_xor_b32 m0, s44, 2048
    v_mfma_f32_16x16x32_bf16 a[184:187], v[60:63], v[80:83], 0
    buffer_load_dwordx4 v4, s[8:11], s21 offen lds
    v_mfma_f32_16x16x32_bf16 a[188:191], v[60:63], v[84:87], 0
    ds_read_b128 v[60:63], v13 offset:10240
    v_mfma_f32_16x16x32_bf16 a[156:159], v[56:59], v[84:87], 0
    ds_read_b128 v[56:59], v13 offset:8192
    v_mfma_f32_16x16x32_bf16 a[216:219], v[64:67], v[80:83], 0
    s_xor_b32 m0, s44, 3072
    v_mfma_f32_16x16x32_bf16 a[248:251], v[68:71], v[80:83], 0
    buffer_load_dwordx4 v5, s[8:11], s21 offen lds
    v_mfma_f32_16x16x32_bf16 a[252:255], v[68:71], v[84:87], 0
    ds_read_b128 v[68:71], v13 offset:14336
    s_add_u32 s21, s21, 128
    v_mfma_f32_16x16x32_bf16 a[220:223], v[64:67], v[84:87], 0
    ds_read_b128 v[64:67], v13 offset:12288
    s_branch t_g2_b
t_g2_hook:
    s_cmp_eq_u32 s43, 1
    s_cbranch_scc1 t_g2_sig0
    s_cmp_eq_u32 s43, 6
    s_cbranch_scc1 t_g2_sws
    s_cmp_eq_u32 s43, 7
    s_cbranch_scc1 t_g2_swp
    s_cmp_lg_u32 s58, 0
    s_cbranch_scc1 t_g2_a
t_g2_wait:
    s_cmp_eq_u32 s3, 0
    s_cbranch_scc1 t_g2_a
    s_mov_b32 s62, 0
L_sw_70:
    s_load_dword s63, s[98:99], s3 glc
    s_add_u32 s62, s62, 1
    s_cmp_gt_u32 s62, 0x200000
    s_cbranch_scc1 chain_kernel_wabort
    s_waitcnt lgkmcnt(0)
    s_cmp_ge_u32 s63, s2
    s_cbranch_scc1 L_swok_71
    s_sleep 16
    s_branch L_sw_70
L_swok_71:
    s_branch t_g2_a
t_g2_sig0:
    s_cmp_eq_u32 s1, 0
    s_cbranch_scc1 t_g2_as
    v_mov_b32 v24, s1
    v_mov_b32 v25, 1
    s_mov_b64 exec, 1
    global_atomic_add v24, v25, s[98:99] sc1
    s_mov_b64 exec, -1
    s_mov_b32 s1, 0
    s_branch t_g2_as
t_g2_sws:
    s_mov_b32 s12, s36
    s_mov_b32 s13, s37
    s_mov_b32 s14, s38
    s_and_b32 s45, s45, 0xffffb7ff
    s_bitcmp1_b32 s94, 1
    s_cselect_b32 s24, s41, 0
    s_cselect_b32 s26, 0, s41
    s_cselect_b32 s60, 0x4000, 0
    s_or_b32 s45, s45, s60
    s_add_u32 s24, s24, s39
    s_add_u32 s26, s26, s39
    s_bitcmp1_b32 s94, 0
    s_cselect_b32 s61, s40, 0
    s_cselect_b32 s62, 0, s40
    s_cselect_b32 s60, 0x800, 0
    s_or_b32 s45, s45, s60
    s_add_u32 s25, s24, s62
    s_add_u32 s24, s24, s61
    s_add_u32 s27, s26, s62
    s_add_u32 s26, s26, s61
    s_mov_b32 s28, s42
    v_mov_b32 v6, v10
    v_mov_b32 v7, v11
    s_branch t_g2_a
t_g2_swp:
    s_mov_b32 s8, s30
    s_mov_b32 s9, s31
    s_mov_b32 s10, s32
    s_and_b32 s44, s44, 0xffffb7ff
    s_bitcmp1_b32 s84, 1
    s_cselect_b32 s20, s35, 0
    s_cselect_b32 s22, 0, s35
    s_cselect_b32 s60, 0x4000, 0
    s_or_b32 s44, s44, s60
    s_add_u32 s20, s20, s33
    s_add_u32 s22, s22, s33
    s_bitcmp1_b32 s84, 0
    s_cselect_b32 s61, s34, 0
    s_cselect_b32 s62, 0, s34
    s_cselect_b32 s60, 0x800, 0
    s_or_b32 s44, s44, s60
    s_add_u32 s21, s20, s62
    s_add_u32 s20, s20, s61
    s_add_u32 s23, s22, s62
    s_add_u32 s22, s22, s61
    v_mov_b32 v4, v8
    v_mov_b32 v5, v9
t_g2_a:
t_g2_as:
    s_waitcnt lgkmcnt(8)
    v_mfma_f32_16x16x32_bf16 a[0:3], v[40:43], v[72:75], a[0:3]
    s_xor_b32 m0, s44, 0
    v_mfma_f32_16x16x32_bf16 a[32:35], v[44:47], v[72:75], a[32:35]
    buffer_load_dwordx4 v4, s[8:11], s20 offen lds
    s_waitcnt lgkmcnt(6)
    v_mfma_f32_16x16x32_bf16 a[36:39], v[44:47], v[76:79], a[36:39]
    ds_read_b64_tr_b16 v[80:81], v14 offset:1024
    s_xor_b32 m0, s44, 1024
    v_mfma_f32_16x16x32_bf16 a[4:7], v[40:43], v[76:79], a[4:7]
    buffer_load_dwordx4 v5, s[8:11], s20 offen lds
    s_waitcnt lgkmcnt(5)
    v_mfma_f32_16x16x32_bf16 a[64:67], v[48:51], v[72:75], a[64:67]
    ds_read_b64_tr_b16 v[82:83], v15 offset:1024
    s_add_u32 s20, s20, 128
    v_mfma_f32_16x16x32_bf16 a[96:99], v[52:55], v[72:75], a[96:99]
    s_xor_b32 m0, s45, 0
    v_mfma_f32_16x16x32_bf16 a[100:103], v[52:55], v[76:79], a[100:103]
    ds_read_b64_tr_b16 v[84:85], v14 offset:1536
    buffer_load_dwordx4 v6, s[12:15], s24 offen lds
    v_mfma_f32_16x16x32_bf16 a[68:71], v[48:51], v[76:79], a[68:71]
    s_xor_b32 m0, s45, 1024
    s_waitcnt lgkmcnt(5)
    v_mfma_f32_16x16x32_bf16 a[128:131], v[56:59], v[72:75], a[128:131]
    ds_read_b64_tr_b16 v[86:87], v15 offset:1536
    buffer_load_dwordx4 v7, s[12:15], s24 offen lds
    v_mfma_f32_16x16x32_bf16 a[160:163], v[60:63], v[72:75], a[160:163]
    s_add_u32 s24, s24, s28
    s_bitcmp1_b32 s43, 0
    v_mfma_f32_16x16x32_bf16 a[164:167], v[60:63], v[76:79], a[164:167]
    s_cselect_b32 s61, s5, 0
    s_lshl1_add_u32 s53, s61, s50
    v_mfma_f32_16x16x32_bf16 a[132:135], v[56:59], v[76:79], a[132:135]
    s_bitcmp1_b32 s43, 1
    s_waitcnt lgkmcnt(4)
    v_mfma_f32_16x16x32_bf16 a[192:195], v[64:67], v[72:75], a[192:195]
    s_cselect_b32 s61, s51, 0
    s_add_u32 s53, s53, s61
    v_mfma_f32_16x16x32_bf16 a[224:227], v[68:71], v[72:75], a[224:227]
    s_bitcmp1_b32 s43, 2
    s_cselect_b32 s61, s52, 0
    v_mfma_f32_16x16x32_bf16 a[228:231], v[68:71], v[76:79], a[228:231]
    s_add_u32 s53, s53, s61
    s_lshl_b32 s29, s43, 4
    v_mfma_f32_16x16x32_bf16 a[196:199], v[64:67], v[76:79], a[196:199]
    s_waitcnt lgkmcnt(2)
    v_mfma_f32_16x16x32_bf16 a[8:11], v[40:43], v[80:83], a[8:11]
    s_set_gpr_idx_on s29, gpr_idx(SRC0)
    v_mov_b32 v24, v128
    v_mov_b32 v25, v129
    v_mov_b32 v26, v130
    v_mov_b32 v27, v131
    s_set_gpr_idx_off
    v_mfma_f32_16x16x32_bf16 a[40:43], v[44:47], v[80:83], a[40:43]
    s_waitcnt lgkmcnt(0)
    v_mfma_f32_16x16x32_bf16 a[44:47], v[44:47], v[84:87], a[44:47]
    ds_read_b64_tr_b16 v[72:73], v14 offset:2048
    s_set_gpr_idx_on s29, gpr_idx(SRC0)
    v_mov_b32 v28, v132
    v_mov_b32 v29, v133
    v_mov_b32 v30, v134
    v_mov_b32 v31, v135
    s_set_gpr_idx_off
    v_mfma_f32_16x16x32_bf16 a[12:15], v[40:43], v[84:87], a[12:15]
    v_mfma_f32_16x16x32_bf16 a[72:75], v[48:51], v[80:83], a[72:75]
    ds_read_b64_tr_b16 v[74:75], v15 offset:2048
    s_set_gpr_idx_on s29, gpr_idx(SRC0)
    v_mov_b32 v32, v136
    v_mov_b32 v33, v137
    v_mov_b32 v34, v138
    v_mov_b32 v35, v139
    s_set_gpr_idx_off
    v_mfma_f32_16x16x32_bf16 a[104:107], v[52:55], v[80:83], a[104:107]
    v_mfma_f32_16x16x32_bf16 a[108:111], v[52:55], v[84:87], a[108:111]
    ds_read_b64_tr_b16 v[76:77], v14 offset:2560
    s_set_gpr_idx_on s29, gpr_idx(SRC0)
    v_mov_b32 v36, v140
    v_mov_b32 v37, v141
    v_mov_b32 v38, v142
    v_mov_b32 v39, v143
    s_set_gpr_idx_off
    v_mfma_f32_16x16x32_bf16 a[76:79], v[48:51], v[84:87], a[76:79]
    v_mfma_f32_16x16x32_bf16 a[136:139], v[56:59], v[80:83], a[136:139]
    ds_read_b64_tr_b16 v[78:79], v15 offset:2560
    buffer_store_dwordx4 v[24:27], v2, s[16:19], s53 offen sc1
    v_mfma_f32_16x16x32_bf16 a[168:171], v[60:63], v[80:83], a[168:171]
    v_mfma_f32_16x16x32_bf16 a[172:175], v[60:63], v[84:87], a[172:175]
    buffer_store_dwordx4 v[28:31], v3, s[16:19], s53 offen sc1
    v_mfma_f32_16x16x32_bf16 a[140:143], v[56:59], v[84:87], a[140:143]
    s_add_u32 s53, s53, s5
    v_mfma_f32_16x16x32_bf16 a[200:203], v[64:67], v[80:83], a[200:203]
    buffer_store_dwordx4 v[32:35], v2, s[16:19], s53 offen sc1
    v_mfma_f32_16x16x32_bf16 a[232:235], v[68:71], v[80:83], a[232:235]
    v_mfma_f32_16x16x32_bf16 a[236:239], v[68:71], v[84:87], a[236:239]
    buffer_store_dwordx4 v[36:39], v3, s[16:19], s53 offen sc1
    v_mfma_f32_16x16x32_bf16 a[204:207], v[64:67], v[84:87], a[204:207]
    s_waitcnt lgkmcnt(2)
    v_mfma_f32_16x16x32_bf16 a[16:19], v[40:43], v[72:75], a[16:19]
    v_mfma_f32_16x16x32_bf16 a[48:51], v[44:47], v[72:75], a[48:51]
    s_waitcnt lgkmcnt(0)
    v_mfma_f32_16x16x32_bf16 a[52:55], v[44:47], v[76:79], a[52:55]
    ds_read_b64_tr_b16 v[80:81], v14 offset:3072
    v_mfma_f32_16x16x32_bf16 a[20:23], v[40:43], v[76:79], a[20:23]
    v_mfma_f32_16x16x32_bf16 a[80:83], v[48:51], v[72:75], a[80:83]
    ds_read_b64_tr_b16 v[82:83], v15 offset:3072
    v_mfma_f32_16x16x32_bf16 a[112:115], v[52:55], v[72:75], a[112:115]
    v_mfma_f32_16x16x32_bf16 a[116:119], v[52:55], v[76:79], a[116:119]
    ds_read_b64_tr_b16 v[84:85], v14 offset:3584
    v_mfma_f32_16x16x32_bf16 a[84:87], v[48:51], v[76:79], a[84:87]
    v_mfma_f32_16x16x32_bf16 a[144:147], v[56:59], v[72:75], a[144:147]
    ds_read_b64_tr_b16 v[86:87], v15 offset:3584
    v_mfma_f32_16x16x32_bf16 a[176:179], v[60:63], v[72:75], a[176:179]
    v_mfma_f32_16x16x32_bf16 a[180:183], v[60:63], v[76:79], a[180:183]
    v_mfma_f32_16x16x32_bf16 a[148:151], v[56:59], v[76:79], a[148:151]
    v_mfma_f32_16x16x32_bf16 a[208:211], v[64:67], v[72:75], a[208:211]
    v_mfma_f32_16x16x32_bf16 a[240:243], v[68:71], v[72:75], a[240:243]
    v_mfma_f32_16x16x32_bf16 a[244:247], v[68:71], v[76:79], a[244:247]
    v_mfma_f32_16x16x32_bf16 a[212:215], v[64:67], v[76:79], a[212:215]
    s_waitcnt lgkmcnt(2)
    v_mfma_f32_16x16x32_bf16 a[24:27], v[40:43], v[80:83], a[24:27]
    ds_read_b64_tr_b16 v[72:73], v14 offset:16384
    v_mfma_f32_16x16x32_bf16 a[56:59], v[44:47], v[80:83], a[56:59]
    ds_read_b64_tr_b16 v[74:75], v15 offset:16384
    s_waitcnt lgkmcnt(2)
    v_mfma_f32_16x16x32_bf16 a[60:63], v[44:47], v[84:87], a[60:63]
    ds_read_b128 v[44:47], v13 offset:2048
    v_mfma_f32_16x16x32_bf16 a[28:31], v[40:43], v[84:87], a[28:31]
    ds_read_b128 v[40:43], v13 offset:0
    v_mfma_f32_16x16x32_bf16 a[88:91], v[48:51], v[80:83], a[88:91]
    ds_read_b64_tr_b16 v[76:77], v14 offset:16896
    v_mfma_f32_16x16x32_bf16 a[120:123], v[52:55], v[80:83], a[120:123]
    ds_read_b64_tr_b16 v[78:79], v15 offset:16896
    v_mfma_f32_16x16x32_bf16 a[124:127], v[52:55], v[84:87], a[124:127]
    ds_read_b128 v[52:55], v13 offset:6144
    v_mfma_f32_16x16x32_bf16 a[92:95], v[48:51], v[84:87], a[92:95]
    ds_read_b128 v[48:51], v13 offset:4096
    v_mfma_f32_16x16x32_bf16 a[152:155], v[56:59], v[80:83], a[152:155]
    s_xor_b32 m0, s44, 2048
    v_mfma_f32_16x16x32_bf16 a[184:187], v[60:63], v[80:83], a[184:187]
    buffer_load_dwordx4 v4, s[8:11], s21 offen lds
    v_mfma_f32_16x16x32_bf16 a[188:191], v[60:63], v[84:87], a[188:191]
    ds_read_b128 v[60:63], v13 offset:10240
    v_mfma_f32_16x16x32_bf16 a[156:159], v[56:59], v[84:87], a[156:159]
    ds_read_b128 v[56:59], v13 offset:8192
    v_mfma_f32_16x16x32_bf16 a[216:219], v[64:67], v[80:83], a[216:219]
    s_xor_b32 m0, s44, 3072
    v_mfma_f32_16x16x32_bf16 a[248:251], v[68:71], v[80:83], a[248:251]
    buffer_load_dwordx4 v5, s[8:11], s21 offen lds
    v_mfma_f32_16x16x32_bf16 a[252:255], v[68:71], v[84:87], a[252:255]
    ds_read_b128 v[68:71], v13 offset:14336
    s_add_u32 s21, s21, 128
    v_mfma_f32_16x16x32_bf16 a[220:223], v[64:67], v[84:87], a[220:223]
    ds_read_b128 v[64:67], v13 offset:12288
t_g2_b:
    s_waitcnt lgkmcnt(8)
    v_mfma_f32_16x16x32_bf16 a[0:3], v[40:43], v[72:75], a[0:3]
    v_mfma_f32_16x16x32_bf16 a[32:35], v[44:47], v[72:75], a[32:35]
    s_xor_b32 m0, s44, 16384
    s_waitcnt lgkmcnt(6)
    v_mfma_f32_16x16x32_bf16 a[36:39], v[44:47], v[76:79], a[36:39]
    ds_read_b64_tr_b16 v[80:81], v14 offset:17408
    buffer_load_dwordx4 v4, s[8:11], s22 offen lds
    v_mfma_f32_16x16x32_bf16 a[4:7], v[40:43], v[76:79], a[4:7]
    s_cmp_ge_u32 s48, 98304
    s_waitcnt lgkmcnt(5)
    v_mfma_f32_16x16x32_bf16 a[64:67], v[48:51], v[72:75], a[64:67]
    ds_read_b64_tr_b16 v[82:83], v15 offset:17408
    s_cselect_b32 s46, s6, s7
    v_mfma_f32_16x16x32_bf16 a[96:99], v[52:55], v[72:75], a[96:99]
    s_add_u32 s48, s48, s46
    s_xor_b32 m0, s44, 17408
    v_mfma_f32_16x16x32_bf16 a[100:103], v[52:55], v[76:79], a[100:103]
    ds_read_b64_tr_b16 v[84:85], v14 offset:17920
    buffer_load_dwordx4 v5, s[8:11], s22 offen lds
    v_mfma_f32_16x16x32_bf16 a[68:71], v[48:51], v[76:79], a[68:71]
    s_add_u32 s22, s22, 128
    s_waitcnt lgkmcnt(5)
    v_mfma_f32_16x16x32_bf16 a[128:131], v[56:59], v[72:75], a[128:131]
    ds_read_b64_tr_b16 v[86:87], v15 offset:17920
    s_cmp_ge_u32 s49, 98304
    v_mfma_f32_16x16x32_bf16 a[160:163], v[60:63], v[72:75], a[160:163]
    s_cselect_b32 s47, s6, s7
    s_add_u32 s49, s49, s47
    v_mfma_f32_16x16x32_bf16 a[164:167], v[60:63], v[76:79], a[164:167]
    s_xor_b32 m0, s44, 18432
    v_mfma_f32_16x16x32_bf16 a[132:135], v[56:59], v[76:79], a[132:135]
    buffer_load_dwordx4 v4, s[8:11], s23 offen lds
    s_waitcnt lgkmcnt(4)
    v_mfma_f32_16x16x32_bf16 a[192:195], v[64:67], v[72:75], a[192:195]
    v_mfma_f32_16x16x32_bf16 a[224:227], v[68:71], v[72:75], a[224:227]
    s_xor_b32 m0, s44, 19456
    v_mfma_f32_16x16x32_bf16 a[228:231], v[68:71], v[76:79], a[228:231]
    buffer_load_dwordx4 v5, s[8:11], s23 offen lds
    v_mfma_f32_16x16x32_bf16 a[196:199], v[64:67], v[76:79], a[196:199]
    s_add_u32 s23, s23, 128
    s_waitcnt lgkmcnt(2)
    v_mfma_f32_16x16x32_bf16 a[8:11], v[40:43], v[80:83], a[8:11]
    s_cmp_ge_u32 s44, 98304
    s_cselect_b32 s60, s6, s7
    v_mfma_f32_16x16x32_bf16 a[40:43], v[44:47], v[80:83], a[40:43]
    s_add_u32 s44, s44, s60
    s_waitcnt lgkmcnt(0)
    v_mfma_f32_16x16x32_bf16 a[44:47], v[44:47], v[84:87], a[44:47]
    ds_read_b64_tr_b16 v[72:73], v14 offset:18432
    v_add_u32 v12, s46, v12
    v_mfma_f32_16x16x32_bf16 a[12:15], v[40:43], v[84:87], a[12:15]
    v_add_u32 v13, s46, v13
    v_mfma_f32_16x16x32_bf16 a[72:75], v[48:51], v[80:83], a[72:75]
    ds_read_b64_tr_b16 v[74:75], v15 offset:18432
    s_xor_b32 m0, s45, 2048
    v_mfma_f32_16x16x32_bf16 a[104:107], v[52:55], v[80:83], a[104:107]
    buffer_load_dwordx4 v6, s[12:15], s25 offen lds
    v_mfma_f32_16x16x32_bf16 a[108:111], v[52:55], v[84:87], a[108:111]
    ds_read_b64_tr_b16 v[76:77], v14 offset:18944
    v_mfma_f32_16x16x32_bf16 a[76:79], v[48:51], v[84:87], a[76:79]
    v_mfma_f32_16x16x32_bf16 a[136:139], v[56:59], v[80:83], a[136:139]
    ds_read_b64_tr_b16 v[78:79], v15 offset:18944
    s_xor_b32 m0, s45, 3072
    v_mfma_f32_16x16x32_bf16 a[168:171], v[60:63], v[80:83], a[168:171]
    buffer_load_dwordx4 v7, s[12:15], s25 offen lds
    v_mfma_f32_16x16x32_bf16 a[172:175], v[60:63], v[84:87], a[172:175]
    s_add_u32 s25, s25, s28
    v_mfma_f32_16x16x32_bf16 a[140:143], v[56:59], v[84:87], a[140:143]
    v_mfma_f32_16x16x32_bf16 a[200:203], v[64:67], v[80:83], a[200:203]
    s_xor_b32 m0, s45, 16384
    v_mfma_f32_16x16x32_bf16 a[232:235], v[68:71], v[80:83], a[232:235]
    buffer_load_dwordx4 v6, s[12:15], s26 offen lds
    v_mfma_f32_16x16x32_bf16 a[236:239], v[68:71], v[84:87], a[236:239]
    v_mfma_f32_16x16x32_bf16 a[204:207], v[64:67], v[84:87], a[204:207]
    s_waitcnt lgkmcnt(2)
    v_mfma_f32_16x16x32_bf16 a[16:19], v[40:43], v[72:75], a[16:19]
    s_xor_b32 m0, s45, 17408
    v_mfma_f32_16x16x32_bf16 a[48:51], v[44:47], v[72:75], a[48:51]
    buffer_load_dwordx4 v7, s[12:15], s26 offen lds
    s_waitcnt lgkmcnt(0)
    v_mfma_f32_16x16x32_bf16 a[52:55], v[44:47], v[76:79], a[52:55]
    ds_read_b64_tr_b16 v[80:81], v14 offset:19456
    s_add_u32 s26, s26, s28
    v_mfma_f32_16x16x32_bf16 a[20:23], v[40:43], v[76:79], a[20:23]
    v_mfma_f32_16x16x32_bf16 a[80:83], v[48:51], v[72:75], a[80:83]
    ds_read_b64_tr_b16 v[82:83], v15 offset:19456
    s_xor_b32 m0, s45, 18432
    v_mfma_f32_16x16x32_bf16 a[112:115], v[52:55], v[72:75], a[112:115]
    buffer_load_dwordx4 v6, s[12:15], s27 offen lds
    v_mfma_f32_16x16x32_bf16 a[116:119], v[52:55], v[76:79], a[116:119]
    ds_read_b64_tr_b16 v[84:85], v14 offset:19968
    v_mfma_f32_16x16x32_bf16 a[84:87], v[48:51], v[76:79], a[84:87]
    s_xor_b32 m0, s45, 19456
    v_mfma_f32_16x16x32_bf16 a[144:147], v[56:59], v[72:75], a[144:147]
    ds_read_b64_tr_b16 v[86:87], v15 offset:19968
    buffer_load_dwordx4 v7, s[12:15], s27 offen lds
    v_mfma_f32_16x16x32_bf16 a[176:179], v[60:63], v[72:75], a[176:179]
    s_add_u32 s27, s27, s28
    s_cmp_ge_u32 s45, 98304
    v_mfma_f32_16x16x32_bf16 a[180:183], v[60:63], v[76:79], a[180:183]
    s_cselect_b32 s60, s6, s7
    s_add_u32 s45, s45, s60
    v_mfma_f32_16x16x32_bf16 a[148:151], v[56:59], v[76:79], a[148:151]
    v_add_u32 v14, s47, v14
    v_add_u32 v15, s47, v15
    v_mfma_f32_16x16x32_bf16 a[208:211], v[64:67], v[72:75], a[208:211]
    s_add_u32 s43, s43, 1
    s_cmp_eq_u32 s43, 8
    v_mfma_f32_16x16x32_bf16 a[240:243], v[68:71], v[72:75], a[240:243]
    v_mfma_f32_16x16x32_bf16 a[244:247], v[68:71], v[76:79], a[244:247]
    v_mfma_f32_16x16x32_bf16 a[212:215], v[64:67], v[76:79], a[212:215]
    s_waitcnt vmcnt(6) lgkmcnt(0)
    s_barrier
    s_cbranch_scc1 t_g2_last
    v_mfma_f32_16x16x32_bf16 a[24:27], v[40:43], v[80:83], a[24:27]
    ds_read_b64_tr_b16 v[72:73], v14 offset:0
    v_mfma_f32_16x16x32_bf16 a[56:59], v[44:47], v[80:83], a[56:59]
    ds_read_b64_tr_b16 v[74:75], v15 offset:0
    v_mfma_f32_16x16x32_bf16 a[60:63], v[44:47], v[84:87], a[60:63]
    ds_read_b128 v[44:47], v12 offset:2048
    v_mfma_f32_16x16x32_bf16 a[28:31], v[40:43], v[84:87], a[28:31]
    ds_read_b128 v[40:43], v12 offset:0
    v_mfma_f32_16x16x32_bf16 a[88:91], v[48:51], v[80:83], a[88:91]
    ds_read_b64_tr_b16 v[76:77], v14 offset:512
    v_mfma_f32_16x16x32_bf16 a[120:123], v[52:55], v[80:83], a[120:123]
    ds_read_b64_tr_b16 v[78:79], v15 offset:512
    v_mfma_f32_16x16x32_bf16 a[124:127], v[52:55], v[84:87], a[124:127]
    ds_read_b128 v[52:55], v12 offset:6144
    v_mfma_f32_16x16x32_bf16 a[92:95], v[48:51], v[84:87], a[92:95]
    ds_read_b128 v[48:51], v12 offset:4096
    v_mfma_f32_16x16x32_bf16 a[152:155], v[56:59], v[80:83], a[152:155]
    v_mfma_f32_16x16x32_bf16 a[184:187], v[60:63], v[80:83], a[184:187]
    v_mfma_f32_16x16x32_bf16 a[188:191], v[60:63], v[84:87], a[188:191]
    ds_read_b128 v[60:63], v12 offset:10240
    v_mfma_f32_16x16x32_bf16 a[156:159], v[56:59], v[84:87], a[156:159]
    ds_read_b128 v[56:59], v12 offset:8192
    v_mfma_f32_16x16x32_bf16 a[216:219], v[64:67], v[80:83], a[216:219]
    s_sub_u32 s61, s43, 2
    s_cmp_lt_u32 s61, 3
    v_mfma_f32_16x16x32_bf16 a[248:251], v[68:71], v[80:83], a[248:251]
    v_mfma_f32_16x16x32_bf16 a[252:255], v[68:71], v[84:87], a[252:255]
    ds_read_b128 v[68:71], v12 offset:14336
    v_mfma_f32_16x16x32_bf16 a[220:223], v[64:67], v[84:87], a[220:223]
    ds_read_b128 v[64:67], v12 offset:12288
    s_cbranch_scc1 t_g2_a
    s_branch t_g2_hook
t_g2_last:
    v_mfma_f32_16x16x32_bf16 a[24:27], v[40:43], v[80:83], a[24:27]
    v_mfma_f32_16x16x32_bf16 a[56:59], v[44:47], v[80:83], a[56:59]
    v_mfma_f32_16x16x32_bf16 a[60:63], v[44:47], v[84:87], a[60:63]
    v_mfma_f32_16x16x32_bf16 a[28:31], v[40:43], v[84:87], a[28:31]
    v_mfma_f32_16x16x32_bf16 a[88:91], v[48:51], v[80:83], a[88:91]
    v_mfma_f32_16x16x32_bf16 a[120:123], v[52:55], v[80:83], a[120:123]
    v_mfma_f32_16x16x32_bf16 a[124:127], v[52:55], v[84:87], a[124:127]
    v_mfma_f32_16x16x32_bf16 a[92:95], v[48:51], v[84:87], a[92:95]
    v_mfma_f32_16x16x32_bf16 a[152:155], v[56:59], v[80:83], a[152:155]
    v_mfma_f32_16x16x32_bf16 a[184:187], v[60:63], v[80:83], a[184:187]
    v_mfma_f32_16x16x32_bf16 a[188:191], v[60:63], v[84:87], a[188:191]
    v_mfma_f32_16x16x32_bf16 a[156:159], v[56:59], v[84:87], a[156:159]
    v_mfma_f32_16x16x32_bf16 a[216:219], v[64:67], v[80:83], a[216:219]
    v_mfma_f32_16x16x32_bf16 a[248:251], v[68:71], v[80:83], a[248:251]
    v_mfma_f32_16x16x32_bf16 a[252:255], v[68:71], v[84:87], a[252:255]
    v_mfma_f32_16x16x32_bf16 a[220:223], v[64:67], v[84:87], a[220:223]
    s_setpc_b64 s[54:55]
t_g1:
    s_mov_b32 s43, 0
    v_add_u32 v14, s49, v23
    v_xor_b32 v15, 64, v14
    ds_read_b128 v[72:75], v14 offset:0
    ds_read_b128 v[76:79], v14 offset:2048
    ds_read_b128 v[44:47], v12 offset:2048
    ds_read_b128 v[40:43], v12 offset:0
    ds_read_b128 v[52:55], v12 offset:6144
    ds_read_b128 v[48:51], v12 offset:4096
    ds_read_b128 v[60:63], v12 offset:10240
    ds_read_b128 v[56:59], v12 offset:8192
    ds_read_b128 v[68:71], v12 offset:14336
    ds_read_b128 v[64:67], v12 offset:12288
    s_waitcnt lgkmcnt(6)
    v_mfma_f32_16x16x32_bf16 a[0:3], v[40:43], v[72:75], 0
    s_xor_b32 m0, s44, 0
    v_mfma_f32_16x16x32_bf16 a[32:35], v[44:47], v[72:75], 0
    buffer_load_dwordx4 v4, s[8:11], s20 offen lds
    v_mfma_f32_16x16x32_bf16 a[36:39], v[44:47], v[76:79], 0
    ds_read_b128 v[80:83], v14 offset:4096
    s_xor_b32 m0, s44, 1024
    v_mfma_f32_16x16x32_bf16 a[4:7], v[40:43], v[76:79], 0
    buffer_load_dwordx4 v5, s[8:11], s20 offen lds
    s_waitcnt lgkmcnt(5)
    v_mfma_f32_16x16x32_bf16 a[64:67], v[48:51], v[72:75], 0
    ds_read_b128 v[84:87], v14 offset:6144
    s_add_u32 s20, s20, 128
    v_mfma_f32_16x16x32_bf16 a[96:99], v[52:55], v[72:75], 0
    s_xor_b32 m0, s45, 0
    v_mfma_f32_16x16x32_bf16 a[100:103], v[52:55], v[76:79], 0
    buffer_load_dwordx4 v6, s[12:15], s24 offen lds
    v_mfma_f32_16x16x32_bf16 a[68:71], v[48:51], v[76:79], 0
    s_xor_b32 m0, s45, 1024
    s_waitcnt lgkmcnt(4)
    v_mfma_f32_16x16x32_bf16 a[128:131], v[56:59], v[72:75], 0
    buffer_load_dwordx4 v7, s[12:15], s24 offen lds
    v_mfma_f32_16x16x32_bf16 a[160:163], v[60:63], v[72:75], 0
    s_add_u32 s24, s24, s28
    s_bitcmp1_b32 s43, 0
    v_mfma_f32_16x16x32_bf16 a[164:167], v[60:63], v[76:79], 0
    s_cselect_b32 s61, s5, 0
    s_lshl1_add_u32 s53, s61, s50
    v_mfma_f32_16x16x32_bf16 a[132:135], v[56:59], v[76:79], 0
    s_bitcmp1_b32 s43, 1
    s_waitcnt lgkmcnt(2)
    v_mfma_f32_16x16x32_bf16 a[192:195], v[64:67], v[72:75], 0
    s_cselect_b32 s61, s51, 0
    s_add_u32 s53, s53, s61
    v_mfma_f32_16x16x32_bf16 a[224:227], v[68:71], v[72:75], 0
    s_bitcmp1_b32 s43, 2
    s_cselect_b32 s61, s52, 0
    v_mfma_f32_16x16x32_bf16 a[228:231], v[68:71], v[76:79], 0
    s_add_u32 s53, s53, s61
    s_lshl_b32 s29, s43, 4
    v_mfma_f32_16x16x32_bf16 a[196:199], v[64:67], v[76:79], 0
    s_waitcnt lgkmcnt(1)
    v_mfma_f32_16x16x32_bf16 a[8:11], v[40:43], v[80:83], 0
    s_set_gpr_idx_on s29, gpr_idx(SRC0)
    v_mov_b32 v24, v128
    v_mov_b32 v25, v129
    v_mov_b32 v26, v130
    v_mov_b32 v27, v131
    s_set_gpr_idx_off
    v_mfma_f32_16x16x32_bf16 a[40:43], v[44:47], v[80:83], 0
    s_waitcnt lgkmcnt(0)
    v_mfma_f32_16x16x32_bf16 a[44:47], v[44:47], v[84:87], 0
    ds_read_b128 v[72:75], v14 offset:8192
    s_set_gpr_idx_on s29, gpr_idx(SRC0)
    v_mov_b32 v28, v132
    v_mov_b32 v29, v133
    v_mov_b32 v30, v134
    v_mov_b32 v31, v135
    s_set_gpr_idx_off
    v_mfma_f32_16x16x32_bf16 a[12:15], v[40:43], v[84:87], 0
    v_mfma_f32_16x16x32_bf16 a[72:75], v[48:51], v[80:83], 0
    ds_read_b128 v[76:79], v14 offset:10240
    s_set_gpr_idx_on s29, gpr_idx(SRC0)
    v_mov_b32 v32, v136
    v_mov_b32 v33, v137
    v_mov_b32 v34, v138
    v_mov_b32 v35, v139
    s_set_gpr_idx_off
    v_mfma_f32_16x16x32_bf16 a[104:107], v[52:55], v[80:83], 0
    v_mfma_f32_16x16x32_bf16 a[108:111], v[52:55], v[84:87], 0
    s_set_gpr_idx_on s29, gpr_idx(SRC0)
    v_mov_b32 v36, v140
    v_mov_b32 v37, v141
    v_mov_b32 v38, v142
    v_mov_b32 v39, v143
    s_set_gpr_idx_off
    v_mfma_f32_16x16x32_bf16 a[76:79], v[48:51], v[84:87], 0
    v_mfma_f32_16x16x32_bf16 a[136:139], v[56:59], v[80:83], 0
    buffer_store_dwordx4 v[24:27], v2, s[16:19], s53 offen sc1
    v_mfma_f32_16x16x32_bf16 a[168:171], v[60:63], v[80:83], 0
    v_mfma_f32_16x16x32_bf16 a[172:175], v[60:63], v[84:87], 0
    buffer_store_dwordx4 v[28:31], v3, s[16:19], s53 offen sc1
    v_mfma_f32_16x16x32_bf16 a[140:143], v[56:59], v[84:87], 0
    s_add_u32 s53, s53, s5
    v_mfma_f32_16x16x32_bf16 a[200:203], v[64:67], v[80:83], 0
    buffer_store_dwordx4 v[32:35], v2, s[16:19], s53 offen sc1
    v_mfma_f32_16x16x32_bf16 a[232:235], v[68:71], v[80:83], 0
    v_mfma_f32_16x16x32_bf16 a[236:239], v[68:71], v[84:87], 0
    buffer_store_dwordx4 v[36:39], v3, s[16:19], s53 offen sc1
    v_mfma_f32_16x16x32_bf16 a[204:207], v[64:67], v[84:87], 0
    s_waitcnt lgkmcnt(1)
    v_mfma_f32_16x16x32_bf16 a[16:19], v[40:43], v[72:75], 0
    v_mfma_f32_16x16x32_bf16 a[48:51], v[44:47], v[72:75], 0
    s_waitcnt lgkmcnt(0)
    v_mfma_f32_16x16x32_bf16 a[52:55], v[44:47], v[76:79], 0
    ds_read_b128 v[80:83], v14 offset:12288
    v_mfma_f32_16x16x32_bf16 a[20:23], v[40:43], v[76:79], 0
    v_mfma_f32_16x16x32_bf16 a[80:83], v[48:51], v[72:75], 0
    ds_read_b128 v[84:87], v14 offset:14336
    v_mfma_f32_16x16x32_bf16 a[112:115], v[52:55], v[72:75], 0
    v_mfma_f32_16x16x32_bf16 a[116:119], v[52:55], v[76:79], 0
    v_mfma_f32_16x16x32_bf16 a[84:87], v[48:51], v[76:79], 0
    v_mfma_f32_16x16x32_bf16 a[144:147], v[56:59], v[72:75], 0
    v_mfma_f32_16x16x32_bf16 a[176:179], v[60:63], v[72:75], 0
    v_mfma_f32_16x16x32_bf16 a[180:183], v[60:63], v[76:79], 0
    v_mfma_f32_16x16x32_bf16 a[148:151], v[56:59], v[76:79], 0
    v_mfma_f32_16x16x32_bf16 a[208:211], v[64:67], v[72:75], 0
    v_mfma_f32_16x16x32_bf16 a[240:243], v[68:71], v[72:75], 0
    v_mfma_f32_16x16x32_bf16 a[244:247], v[68:71], v[76:79], 0
    v_mfma_f32_16x16x32_bf16 a[212:215], v[64:67], v[76:79], 0
    s_waitcnt lgkmcnt(1)
    v_mfma_f32_16x16x32_bf16 a[24:27], v[40:43], v[80:83], 0
    ds_read_b128 v[72:75], v15 offset:0
    v_mfma_f32_16x16x32_bf16 a[56:59], v[44:47], v[80:83], 0
    ds_read_b128 v[76:79], v15 offset:2048
    s_waitcnt lgkmcnt(2)
    v_mfma_f32_16x16x32_bf16 a[60:63], v[44:47], v[84:87], 0
    ds_read_b128 v[44:47], v13 offset:2048
    v_mfma_f32_16x16x32_bf16 a[28:31], v[40:43], v[84:87], 0
    ds_read_b128 v[40:43], v13 offset:0
    v_mfma_f32_16x16x32_bf16 a[88:91], v[48:51], v[80:83], 0
    v_mfma_f32_16x16x32_bf16 a[120:123], v[52:55], v[80:83], 0
    v_mfma_f32_16x16x32_bf16 a[124:127], v[52:55], v[84:87], 0
    ds_read_b128 v[52:55], v13 offset:6144
    v_mfma_f32_16x16x32_bf16 a[92:95], v[48:51], v[84:87], 0
    ds_read_b128 v[48:51], v13 offset:4096
    v_mfma_f32_16x16x32_bf16 a[152:155], v[56:59], v[80:83], 0
    s_xor_b32 m0, s44, 2048
    v_mfma_f32_16x16x32_bf16 a[184:187], v[60:63], v[80:83], 0
    buffer_load_dwordx4 v4, s[8:11], s21 offen lds
    v_mfma_f32_16x16x32_bf16 a[188:191], v[60:63], v[84:87], 0
    ds_read_b128 v[60:63], v13 offset:10240
    v_mfma_f32_16x16x32_bf16 a[156:159], v[56:59], v[84:87], 0
    ds_read_b128 v[56:59], v13 offset:8192
    v_mfma_f32_16x16x32_bf16 a[216:219], v[64:67], v[80:83], 0
    s_xor_b32 m0, s44, 3072
    v_mfma_f32_16x16x32_bf16 a[248:251], v[68:71], v[80:83], 0
    buffer_load_dwordx4 v5, s[8:11], s21 offen lds
    v_mfma_f32_16x16x32_bf16 a[252:255], v[68:71], v[84:87], 0
    ds_read_b128 v[68:71], v13 offset:14336
    s_add_u32 s21, s21, 128
    v_mfma_f32_16x16x32_bf16 a[220:223], v[64:67], v[84:87], 0
    ds_read_b128 v[64:67], v13 offset:12288
    s_branch t_g1_b
t_g1_as:
    s_waitcnt lgkmcnt(6)
    v_mfma_f32_16x16x32_bf16 a[0:3], v[40:43], v[72:75], a[0:3]
    s_xor_b32 m0, s44, 0
    v_mfma_f32_16x16x32_bf16 a[32:35], v[44:47], v[72:75], a[32:35]
    buffer_load_dwordx4 v4, s[8:11], s20 offen lds
    v_mfma_f32_16x16x32_bf16 a[36:39], v[44:47], v[76:79], a[36:39]
    ds_read_b128 v[80:83], v14 offset:4096
    s_xor_b32 m0, s44, 1024
    v_mfma_f32_16x16x32_bf16 a[4:7], v[40:43], v[76:79], a[4:7]
    buffer_load_dwordx4 v5, s[8:11], s20 offen lds
    s_waitcnt lgkmcnt(5)
    v_mfma_f32_16x16x32_bf16 a[64:67], v[48:51], v[72:75], a[64:67]
    ds_read_b128 v[84:87], v14 offset:6144
    s_add_u32 s20, s20, 128
    v_mfma_f32_16x16x32_bf16 a[96:99], v[52:55], v[72:75], a[96:99]
    s_xor_b32 m0, s45, 0
    v_mfma_f32_16x16x32_bf16 a[100:103], v[52:55], v[76:79], a[100:103]
    buffer_load_dwordx4 v6, s[12:15], s24 offen lds
    v_mfma_f32_16x16x32_bf16 a[68:71], v[48:51], v[76:79], a[68:71]
    s_xor_b32 m0, s45, 1024
    s_waitcnt lgkmcnt(4)
    v_mfma_f32_16x16x32_bf16 a[128:131], v[56:59], v[72:75], a[128:131]
    buffer_load_dwordx4 v7, s[12:15], s24 offen lds
    v_mfma_f32_16x16x32_bf16 a[160:163], v[60:63], v[72:75], a[160:163]
    s_add_u32 s24, s24, s28
    s_bitcmp1_b32 s43, 0
    v_mfma_f32_16x16x32_bf16 a[164:167], v[60:63], v[76:79], a[164:167]
    s_cselect_b32 s61, s5, 0
    s_lshl1_add_u32 s53, s61, s50
    v_mfma_f32_16x16x32_bf16 a[132:135], v[56:59], v[76:79], a[132:135]
    s_bitcmp1_b32 s43, 1
    s_waitcnt lgkmcnt(2)
    v_mfma_f32_16x16x32_bf16 a[192:195], v[64:67], v[72:75], a[192:195]
    s_cselect_b32 s61, s51, 0
    s_add_u32 s53, s53, s61
    v_mfma_f32_16x16x32_bf16 a[224:227], v[68:71], v[72:75], a[224:227]
    s_bitcmp1_b32 s43, 2
    s_cselect_b32 s61, s52, 0
    v_mfma_f32_16x16x32_bf16 a[228:231], v[68:71], v[76:79], a[228:231]
    s_add_u32 s53, s53, s61
    s_lshl_b32 s29, s43, 4
    v_mfma_f32_16x16x32_bf16 a[196:199], v[64:67], v[76:79], a[196:199]
    s_waitcnt lgkmcnt(1)
    v_mfma_f32_16x16x32_bf16 a[8:11], v[40:43], v[80:83], a[8:11]
    s_set_gpr_idx_on s29, gpr_idx(SRC0)
    v_mov_b32 v24, v128
    v_mov_b32 v25, v129
    v_mov_b32 v26, v130
    v_mov_b32 v27, v131
    s_set_gpr_idx_off
    v_mfma_f32_16x16x32_bf16 a[40:43], v[44:47], v[80:83], a[40:43]
    s_waitcnt lgkmcnt(0)
    v_mfma_f32_16x16x32_bf16 a[44:47], v[44:47], v[84:87], a[44:47]
    ds_read_b128 v[72:75], v14 offset:8192
    s_set_gpr_idx_on s29, gpr_idx(SRC0)
    v_mov_b32 v28, v132
    v_mov_b32 v29, v133
    v_mov_b32 v30, v134
    v_mov_b32 v31, v135
    s_set_gpr_idx_off
    v_mfma_f32_16x16x32_bf16 a[12:15], v[40:43], v[84:87], a[12:15]
    v_mfma_f32_16x16x32_bf16 a[72:75], v[48:51], v[80:83], a[72:75]
    ds_read_b128 v[76:79], v14 offset:10240
    s_set_gpr_idx_on s29, gpr_idx(SRC0)
    v_mov_b32 v32, v136
    v_mov_b32 v33, v137
    v_mov_b32 v34, v138
    v_mov_b32 v35, v139
    s_set_gpr_idx_off
    v_mfma_f32_16x16x32_bf16 a[104:107], v[52:55], v[80:83], a[104:107]
    v_mfma_f32_16x16x32_bf16 a[108:111], v[52:55], v[84:87], a[108:111]
    s_set_gpr_idx_on s29, gpr_idx(SRC0)
    v_mov_b32 v36, v140
    v_mov_b32 v37, v141
    v_mov_b32 v38, v142
    v_mov_b32 v39, v143
    s_set_gpr_idx_off
    v_mfma_f32_16x16x32_bf16 a[76:79], v[48:51], v[84:87], a[76:79]
    v_mfma_f32_16x16x32_bf16 a[136:139], v[56:59], v[80:83], a[136:139]
    buffer_store_dwordx4 v[24:27], v2, s[16:19], s53 offen sc1
    v_mfma_f32_16x16x32_bf16 a[168:171], v[60:63], v[80:83], a[168:171]
    v_mfma_f32_16x16x32_bf16 a[172:175], v[60:63], v[84:87], a[172:175]
    buffer_store_dwordx4 v[28:31], v3, s[16:19], s53 offen sc1
    v_mfma_f32_16x16x32_bf16 a[140:143], v[56:59], v[84:87], a[140:143]
    s_add_u32 s53, s53, s5
    v_mfma_f32_16x16x32_bf16 a[200:203], v[64:67], v[80:83], a[200:203]
    buffer_store_dwordx4 v[32:35], v2, s[16:19], s53 offen sc1
    v_mfma_f32_16x16x32_bf16 a[232:235], v[68:71], v[80:83], a[232:235]
    v_mfma_f32_16x16x32_bf16 a[236:239], v[68:71], v[84:87], a[236:239]
    buffer_store_dwordx4 v[36:39], v3, s[16:19], s53 offen sc1
    v_mfma_f32_16x16x32_bf16 a[204:207], v[64:67], v[84:87], a[204:207]
    s_waitcnt lgkmcnt(1)
    v_mfma_f32_16x16x32_bf16 a[16:19], v[40:43], v[72:75], a[16:19]
    v_mfma_f32_16x16x32_bf16 a[48:51], v[44:47], v[72:75], a[48:51]
    s_waitcnt lgkmcnt(0)
    v_mfma_f32_16x16x32_bf16 a[52:55], v[44:47], v[76:79], a[52:55]
    ds_read_b128 v[80:83], v14 offset:12288
    v_mfma_f32_16x16x32_bf16 a[20:23], v[40:43], v[76:79], a[20:23]
    v_mfma_f32_16x16x32_bf16 a[80:83], v[48:51], v[72:75], a[80:83]
    ds_read_b128 v[84:87], v14 offset:14336
    v_mfma_f32_16x16x32_bf16 a[112:115], v[52:55], v[72:75], a[112:115]
    v_mfma_f32_16x16x32_bf16 a[116:119], v[52:55], v[76:79], a[116:119]
    v_mfma_f32_16x16x32_bf16 a[84:87], v[48:51], v[76:79], a[84:87]
    v_mfma_f32_16x16x32_bf16 a[144:147], v[56:59], v[72:75], a[144:147]
    v_mfma_f32_16x16x32_bf16 a[176:179], v[60:63], v[72:75], a[176:179]
    v_mfma_f32_16x16x32_bf16 a[180:183], v[60:63], v[76:79], a[180:183]
    v_mfma_f32_16x16x32_bf16 a[148:151], v[56:59], v[76:79], a[148:151]
    v_mfma_f32_16x16x32_bf16 a[208:211], v[64:67], v[72:75], a[208:211]
    v_mfma_f32_16x16x32_bf16 a[240:243], v[68:71], v[72:75], a[240:243]
    v_mfma_f32_16x16x32_bf16 a[244:247], v[68:71], v[76:79], a[244:247]
    v_mfma_f32_16x16x32_bf16 a[212:215], v[64:67], v[76:79], a[212:215]
    s_waitcnt lgkmcnt(1)
    v_mfma_f32_16x16x32_bf16 a[24:27], v[40:43], v[80:83], a[24:27]
    ds_read_b128 v[72:75], v15 offset:0
    v_mfma_f32_16x16x32_bf16 a[56:59], v[44:47], v[80:83], a[56:59]
    ds_read_b128 v[76:79], v15 offset:2048
    s_waitcnt lgkmcnt(2)
    v_mfma_f32_16x16x32_bf16 a[60:63], v[44:47], v[84:87], a[60:63]
    ds_read_b128 v[44:47], v13 offset:2048
    v_mfma_f32_16x16x32_bf16 a[28:31], v[40:43], v[84:87], a[28:31]
    ds_read_b128 v[40:43], v13 offset:0
    v_mfma_f32_16x16x32_bf16 a[88:91], v[48:51], v[80:83], a[88:91]
    v_mfma_f32_16x16x32_bf16 a[120:123], v[52:55], v[80:83], a[120:123]
    v_mfma_f32_16x16x32_bf16 a[124:127], v[52:55], v[84:87], a[124:127]
    ds_read_b128 v[52:55], v13 offset:6144
    v_mfma_f32_16x16x32_bf16 a[92:95], v[48:51], v[84:87], a[92:95]
    ds_read_b128 v[48:51], v13 offset:4096
    v_mfma_f32_16x16x32_bf16 a[152:155], v[56:59], v[80:83], a[152:155]
    s_xor_b32 m0, s44, 2048
    v_mfma_f32_16x16x32_bf16 a[184:187], v[60:63], v[80:83], a[184:187]
    buffer_load_dwordx4 v4, s[8:11], s21 offen lds
    v_mfma_f32_16x16x32_bf16 a[188:191], v[60:63], v[84:87], a[188:191]
    ds_read_b128 v[60:63], v13 offset:10240
    v_mfma_f32_16x16x32_bf16 a[156:159], v[56:59], v[84:87], a[156:159]
    ds_read_b128 v[56:59], v13 offset:8192
    v_mfma_f32_16x16x32_bf16 a[216:219], v[64:67], v[80:83], a[216:219]
    s_xor_b32 m0, s44, 3072
    v_mfma_f32_16x16x32_bf16 a[248:251], v[68:71], v[80:83], a[248:251]
    buffer_load_dwordx4 v5, s[8:11], s21 offen lds
    v_mfma_f32_16x16x32_bf16 a[252:255], v[68:71], v[84:87], a[252:255]
    ds_read_b128 v[68:71], v13 offset:14336
    s_add_u32 s21, s21, 128
    v_mfma_f32_16x16x32_bf16 a[220:223], v[64:67], v[84:87], a[220:223]
    ds_read_b128 v[64:67], v13 offset:12288
    s_branch t_g1_b
t_g1_hook:
    s_cmp_eq_u32 s43, 1
    s_cbranch_scc1 t_g1_sig0
    s_cmp_lt_u32 s43, 8
    s_cbranch_scc1 t_g1_as
    s_cmp_eq_u32 s43, 14
    s_cbranch_scc1 t_g1_sws
    s_cmp_eq_u32 s43, 15
    s_cbranch_scc1 t_g1_swp
    s_cmp_lg_u32 s58, 0
    s_cbranch_scc1 t_g1_a
    s_cmp_eq_u32 s43, 13
    s_cbranch_scc1 t_g1_wait
    s_cmp_lg_u32 s43, 9
    s_cbranch_scc1 t_g1_a
    s_cmp_eq_u32 s4, 0
    s_cbranch_scc1 t_g1_a
    v_mov_b32 v24, s4
    v_mov_b32 v25, 1
    s_mov_b64 exec, 1
    global_atomic_add v24, v25, s[98:99] sc1
    s_mov_b64 exec, -1
    s_branch t_g1_a
t_g1_wait:
    s_cmp_eq_u32 s3, 0
    s_cbranch_scc1 t_g1_a
    s_mov_b32 s62, 0
L_sw_72:
    s_load_dword s63, s[98:99], s3 glc
    s_add_u32 s62, s62, 1
    s_cmp_gt_u32 s62, 0x200000
    s_cbranch_scc1 chain_kernel_wabort
    s_waitcnt lgkmcnt(0)
    s_cmp_ge_u32 s63, s2
    s_cbranch_scc1 L_swok_73
    s_sleep 16
    s_branch L_sw_72
L_swok_73:
    s_branch t_g1_a
t_g1_sig0:
    s_cmp_eq_u32 s1, 0
    s_cbranch_scc1 t_g1_as
    v_mov_b32 v24, s1
    v_mov_b32 v25, 1
    s_mov_b64 exec, 1
    global_atomic_add v24, v25, s[98:99] sc1
    s_mov_b64 exec, -1
    s_mov_b32 s1, 0
    s_branch t_g1_as
t_g1_sws:
    s_mov_b32 s12, s36
    s_mov_b32 s13, s37
    s_mov_b32 s14, s38
    s_and_b32 s45, s45, 0xffffb7ff
    s_bitcmp1_b32 s94, 1
    s_cselect_b32 s24, s41, 0
    s_cselect_b32 s26, 0, s41
    s_cselect_b32 s60, 0x4000, 0
    s_or_b32 s45, s45, s60
    s_add_u32 s24, s24, s39
    s_add_u32 s26, s26, s39
    s_bitcmp1_b32 s94, 0
    s_cselect_b32 s61, s40, 0
    s_cselect_b32 s62, 0, s40
    s_cselect_b32 s60, 0x800, 0
    s_or_b32 s45, s45, s60
    s_add_u32 s25, s24, s62
    s_add_u32 s24, s24, s61
    s_add_u32 s27, s26, s62
    s_add_u32 s26, s26, s61
    s_mov_b32 s28, s42
    v_mov_b32 v6, v10
    v_mov_b32 v7, v11
    s_branch t_g1_a
t_g1_swp:
    s_mov_b32 s8, s30
    s_mov_b32 s9, s31
    s_mov_b32 s10, s32
    s_and_b32 s44, s44, 0xffffb7ff
    s_bitcmp1_b32 s84, 1
    s_cselect_b32 s20, s35, 0
    s_cselect_b32 s22, 0, s35
    s_cselect_b32 s60, 0x4000, 0
    s_or_b32 s44, s44, s60
    s_add_u32 s20, s20, s33
    s_add_u32 s22, s22, s33
    s_bitcmp1_b32 s84, 0
    s_cselect_b32 s61, s34, 0
    s_cselect_b32 s62, 0, s34
    s_cselect_b32 s60, 0x800, 0
    s_or_b32 s44, s44, s60
    s_add_u32 s21, s20, s62
    s_add_u32 s20, s20, s61
    s_add_u32 s23, s22, s62
    s_add_u32 s22, s22, s61
    v_mov_b32 v4, v8
    v_mov_b32 v5, v9
t_g1_a:
    s_waitcnt lgkmcnt(6)
    v_mfma_f32_16x16x32_bf16 a[0:3], v[40:43], v[72:75], a[0:3]
    s_xor_b32 m0, s44, 0
    v_mfma_f32_16x16x32_bf16 a[32:35], v[44:47], v[72:75], a[32:35]
    buffer_load_dwordx4 v4, s[8:11], s20 offen lds
    v_mfma_f32_16x16x32_bf16 a[36:39], v[44:47], v[76:79], a[36:39]
    ds_read_b128 v[80:83], v14 offset:4096
    s_xor_b32 m0, s44, 1024
    v_mfma_f32_16x16x32_bf16 a[4:7], v[40:43], v[76:79], a[4:7]
    buffer_load_dwordx4 v5, s[8:11], s20 offen lds
    s_waitcnt lgkmcnt(5)
    v_mfma_f32_16x16x32_bf16 a[64:67], v[48:51], v[72:75], a[64:67]
    ds_read_b128 v[84:87], v14 offset:6144
    s_add_u32 s20, s20, 128
    v_mfma_f32_16x16x32_bf16 a[96:99], v[52:55], v[72:75], a[96:99]
    s_xor_b32 m0, s45, 0
    v_mfma_f32_16x16x32_bf16 a[100:103], v[52:55], v[76:79], a[100:103]
    buffer_load_dwordx4 v6, s[12:15], s24 offen lds
    v_mfma_f32_16x16x32_bf16 a[68:71], v[48:51], v[76:79], a[68:71]
    s_xor_b32 m0, s45, 1024
    s_waitcnt lgkmcnt(4)
    v_mfma_f32_16x16x32_bf16 a[128:131], v[56:59], v[72:75], a[128:131]
    buffer_load_dwordx4 v7, s[12:15], s24 offen lds
    v_mfma_f32_16x16x32_bf16 a[160:163], v[60:63], v[72:75], a[160:163]
    s_add_u32 s24, s24, s28
    v_mfma_f32_16x16x32_bf16 a[164:167], v[60:63], v[76:79], a[164:167]
    v_mfma_f32_16x16x32_bf16 a[132:135], v[56:59], v[76:79], a[132:135]
    s_waitcnt lgkmcnt(2)
    v_mfma_f32_16x16x32_bf16 a[192:195], v[64:67], v[72:75], a[192:195]
    v_mfma_f32_16x16x32_bf16 a[224:227], v[68:71], v[72:75], a[224:227]
    v_mfma_f32_16x16x32_bf16 a[228:231], v[68:71], v[76:79], a[228:231]
    v_mfma_f32_16x16x32_bf16 a[196:199], v[64:67], v[76:79], a[196:199]
    s_waitcnt lgkmcnt(1)
    v_mfma_f32_16x16x32_bf16 a[8:11], v[40:43], v[80:83], a[8:11]
    v_mfma_f32_16x16x32_bf16 a[40:43], v[44:47], v[80:83], a[40:43]
    s_waitcnt lgkmcnt(0)
    v_mfma_f32_16x16x32_bf16 a[44:47], v[44:47], v[84:87], a[44:47]
    ds_read_b128 v[72:75], v14 offset:8192
    v_mfma_f32_16x16x32_bf16 a[12:15], v[40:43], v[84:87], a[12:15]
    v_mfma_f32_16x16x32_bf16 a[72:75], v[48:51], v[80:83], a[72:75]
    ds_read_b128 v[76:79], v14 offset:10240
    v_mfma_f32_16x16x32_bf16 a[104:107], v[52:55], v[80:83], a[104:107]
    v_mfma_f32_16x16x32_bf16 a[108:111], v[52:55], v[84:87], a[108:111]
    v_mfma_f32_16x16x32_bf16 a[76:79], v[48:51], v[84:87], a[76:79]
    v_mfma_f32_16x16x32_bf16 a[136:139], v[56:59], v[80:83], a[136:139]
    v_mfma_f32_16x16x32_bf16 a[168:171], v[60:63], v[80:83], a[168:171]
    v_mfma_f32_16x16x32_bf16 a[172:175], v[60:63], v[84:87], a[172:175]
    v_mfma_f32_16x16x32_bf16 a[140:143], v[56:59], v[84:87], a[140:143]
    v_mfma_f32_16x16x32_bf16 a[200:203], v[64:67], v[80:83], a[200:203]
    v_mfma_f32_16x16x32_bf16 a[232:235], v[68:71], v[80:83], a[232:235]
    v_mfma_f32_16x16x32_bf16 a[236:239], v[68:71], v[84:87], a[236:239]
    v_mfma_f32_16x16x32_bf16 a[204:207], v[64:67], v[84:87], a[204:207]
    s_waitcnt lgkmcnt(1)
    v_mfma_f32_16x16x32_bf16 a[16:19], v[40:43], v[72:75], a[16:19]
    v_mfma_f32_16x16x32_bf16 a[48:51], v[44:47], v[72:75], a[48:51]
    s_waitcnt lgkmcnt(0)
    v_mfma_f32_16x16x32_bf16 a[52:55], v[44:47], v[76:79], a[52:55]
    ds_read_b128 v[80:83], v14 offset:12288
    v_mfma_f32_16x16x32_bf16 a[20:23], v[40:43], v[76:79], a[20:23]
    v_mfma_f32_16x16x32_bf16 a[80:83], v[48:51], v[72:75], a[80:83]
    ds_read_b128 v[84:87], v14 offset:14336
    v_mfma_f32_16x16x32_bf16 a[112:115], v[52:55], v[72:75], a[112:115]
    v_mfma_f32_16x16x32_bf16 a[116:119], v[52:55], v[76:79], a[116:119]
    v_mfma_f32_16x16x32_bf16 a[84:87], v[48:51], v[76:79], a[84:87]
    v_mfma_f32_16x16x32_bf16 a[144:147], v[56:59], v[72:75], a[144:147]
    v_mfma_f32_16x16x32_bf16 a[176:179], v[60:63], v[72:75], a[176:179]
    v_mfma_f32_16x16x32_bf16 a[180:183], v[60:63], v[76:79], a[180:183]
    v_mfma_f32_16x16x32_bf16 a[148:151], v[56:59], v[76:79], a[148:151]
    v_mfma_f32_16x16x32_bf16 a[208:211], v[64:67], v[72:75], a[208:211]
    v_mfma_f32_16x16x32_bf16 a[240:243], v[68:71], v[72:75], a[240:243]
    v_mfma_f32_16x16x32_bf16 a[244:247], v[68:71], v[76:79], a[244:247]
    v_mfma_f32_16x16x32_bf16 a[212:215], v[64:67], v[76:79], a[212:215]
    s_waitcnt lgkmcnt(1)
    v_mfma_f32_16x16x32_bf16 a[24:27], v[40:43], v[80:83], a[24:27]
    ds_read_b128 v[72:75], v15 offset:0
    v_mfma_f32_16x16x32_bf16 a[56:59], v[44:47], v[80:83], a[56:59]
    ds_read_b128 v[76:79], v15 offset:2048
    s_waitcnt lgkmcnt(2)
    v_mfma_f32_16x16x32_bf16 a[60:63], v[44:47], v[84:87], a[60:63]
    ds_read_b128 v[44:47], v13 offset:2048
    v_mfma_f32_16x16x32_bf16 a[28:31], v[40:43], v[84:87], a[28:31]
    ds_read_b128 v[40:43], v13 offset:0
    v_mfma_f32_16x16x32_bf16 a[88:91], v[48:51], v[80:83], a[88:91]
    v_mfma_f32_16x16x32_bf16 a[120:123], v[52:55], v[80:83], a[120:123]
    v_mfma_f32_16x16x32_bf16 a[124:127], v[52:55], v[84:87], a[124:127]
    ds_read_b128 v[52:55], v13 offset:6144
    v_mfma_f32_16x16x32_bf16 a[92:95], v[48:51], v[84:87], a[92:95]
    ds_read_b128 v[48:51], v13 offset:4096
    v_mfma_f32_16x16x32_bf16 a[152:155], v[56:59], v[80:83], a[152:155]
    s_xor_b32 m0, s44, 2048
    v_mfma_f32_16x16x32_bf16 a[184:187], v[60:63], v[80:83], a[184:187]
    buffer_load_dwordx4 v4, s[8:11], s21 offen lds
    v_mfma_f32_16x16x32_bf16 a[188:191], v[60:63], v[84:87], a[188:191]
    ds_read_b128 v[60:63], v13 offset:10240
    v_mfma_f32_16x16x32_bf16 a[156:159], v[56:59], v[84:87], a[156:159]
    ds_read_b128 v[56:59], v13 offset:8192
    v_mfma_f32_16x16x32_bf16 a[216:219], v[64:67], v[80:83], a[216:219]
    s_xor_b32 m0, s44, 3072
    v_mfma_f32_16x16x32_bf16 a[248:251], v[68:71], v[80:83], a[248:251]
    buffer_load_dwordx4 v5, s[8:11], s21 offen lds
    v_mfma_f32_16x16x32_bf16 a[252:255], v[68:71], v[84:87], a[252:255]
    ds_read_b128 v[68:71], v13 offset:14336
    s_add_u32 s21, s21, 128
    v_mfma_f32_16x16x32_bf16 a[220:223], v[64:67], v[84:87], a[220:223]
    ds_read_b128 v[64:67], v13 offset:12288
t_g1_b:
    s_waitcnt lgkmcnt(6)
    v_mfma_f32_16x16x32_bf16 a[0:3], v[40:43], v[72:75], a[0:3]
    v_mfma_f32_16x16x32_bf16 a[32:35], v[44:47], v[72:75], a[32:35]
    s_xor_b32 m0, s44, 16384
    v_mfma_f32_16x16x32_bf16 a[36:39], v[44:47], v[76:79], a[36:39]
    ds_read_b128 v[80:83], v15 offset:4096
    buffer_load_dwordx4 v4, s[8:11], s22 offen lds
    v_mfma_f32_16x16x32_bf16 a[4:7], v[40:43], v[76:79], a[4:7]
    s_cmp_ge_u32 s48, 98304
    s_waitcnt lgkmcnt(5)
    v_mfma_f32_16x16x32_bf16 a[64:67], v[48:51], v[72:75], a[64:67]
    ds_read_b128 v[84:87], v15 offset:6144
    s_cselect_b32 s46, s6, s7
    v_mfma_f32_16x16x32_bf16 a[96:99], v[52:55], v[72:75], a[96:99]
    s_add_u32 s48, s48, s46
    s_xor_b32 m0, s44, 17408
    v_mfma_f32_16x16x32_bf16 a[100:103], v[52:55], v[76:79], a[100:103]
    buffer_load_dwordx4 v5, s[8:11], s22 offen lds
    v_mfma_f32_16x16x32_bf16 a[68:71], v[48:51], v[76:79], a[68:71]
    s_add_u32 s22, s22, 128
    s_waitcnt lgkmcnt(4)
    v_mfma_f32_16x16x32_bf16 a[128:131], v[56:59], v[72:75], a[128:131]
    s_cmp_ge_u32 s49, 98304
    s_cselect_b32 s47, s6, s7
    v_mfma_f32_16x16x32_bf16 a[160:163], v[60:63], v[72:75], a[160:163]
    s_add_u32 s49, s49, s47
    s_xor_b32 m0, s44, 18432
    v_mfma_f32_16x16x32_bf16 a[164:167], v[60:63], v[76:79], a[164:167]
    buffer_load_dwordx4 v4, s[8:11], s23 offen lds
    v_mfma_f32_16x16x32_bf16 a[132:135], v[56:59], v[76:79], a[132:135]
    s_waitcnt lgkmcnt(2)
    v_mfma_f32_16x16x32_bf16 a[192:195], v[64:67], v[72:75], a[192:195]
    v_mfma_f32_16x16x32_bf16 a[224:227], v[68:71], v[72:75], a[224:227]
    s_xor_b32 m0, s44, 19456
    v_mfma_f32_16x16x32_bf16 a[228:231], v[68:71], v[76:79], a[228:231]
    buffer_load_dwordx4 v5, s[8:11], s23 offen lds
    v_mfma_f32_16x16x32_bf16 a[196:199], v[64:67], v[76:79], a[196:199]
    s_add_u32 s23, s23, 128
    s_waitcnt lgkmcnt(1)
    v_mfma_f32_16x16x32_bf16 a[8:11], v[40:43], v[80:83], a[8:11]
    s_cmp_ge_u32 s44, 98304
    s_cselect_b32 s60, s6, s7
    v_mfma_f32_16x16x32_bf16 a[40:43], v[44:47], v[80:83], a[40:43]
    s_add_u32 s44, s44, s60
    s_waitcnt lgkmcnt(0)
    v_mfma_f32_16x16x32_bf16 a[44:47], v[44:47], v[84:87], a[44:47]
    ds_read_b128 v[72:75], v15 offset:8192
    v_add_u32 v12, s46, v12
    v_mfma_f32_16x16x32_bf16 a[12:15], v[40:43], v[84:87], a[12:15]
    v_add_u32 v13, s46, v13
    v_add_u32 v14, s47, v14
    v_mfma_f32_16x16x32_bf16 a[72:75], v[48:51], v[80:83], a[72:75]
    ds_read_b128 v[76:79], v15 offset:10240
    s_xor_b32 m0, s45, 2048
    v_mfma_f32_16x16x32_bf16 a[104:107], v[52:55], v[80:83], a[104:107]
    buffer_load_dwordx4 v6, s[12:15], s25 offen lds
    v_mfma_f32_16x16x32_bf16 a[108:111], v[52:55], v[84:87], a[108:111]
    v_mfma_f32_16x16x32_bf16 a[76:79], v[48:51], v[84:87], a[76:79]
    v_mfma_f32_16x16x32_bf16 a[136:139], v[56:59], v[80:83], a[136:139]
    s_xor_b32 m0, s45, 3072
    v_mfma_f32_16x16x32_bf16 a[168:171], v[60:63], v[80:83], a[168:171]
    buffer_load_dwordx4 v7, s[12:15], s25 offen lds
    v_mfma_f32_16x16x32_bf16 a[172:175], v[60:63], v[84:87], a[172:175]
    s_add_u32 s25, s25, s28
    v_mfma_f32_16x16x32_bf16 a[140:143], v[56:59], v[84:87], a[140:143]
    v_mfma_f32_16x16x32_bf16 a[200:203], v[64:67], v[80:83], a[200:203]
    s_xor_b32 m0, s45, 16384
    v_mfma_f32_16x16x32_bf16 a[232:235], v[68:71], v[80:83], a[232:235]
    buffer_load_dwordx4 v6, s[12:15], s26 offen lds
    v_mfma_f32_16x16x32_bf16 a[236:239], v[68:71], v[84:87], a[236:239]
    v_mfma_f32_16x16x32_bf16 a[204:207], v[64:67], v[84:87], a[204:207]
    s_waitcnt lgkmcnt(1)
    v_mfma_f32_16x16x32_bf16 a[16:19], v[40:43], v[72:75], a[16:19]
    s_xor_b32 m0, s45, 17408
    v_mfma_f32_16x16x32_bf16 a[48:51], v[44:47], v[72:75], a[48:51]
    buffer_load_dwordx4 v7, s[12:15], s26 offen lds
    s_waitcnt lgkmcnt(0)
    v_mfma_f32_16x16x32_bf16 a[52:55], v[44:47], v[76:79], a[52:55]
    ds_read_b128 v[80:83], v15 offset:12288
    s_add_u32 s26, s26, s28
    v_mfma_f32_16x16x32_bf16 a[20:23], v[40:43], v[76:79], a[20:23]
    v_mfma_f32_16x16x32_bf16 a[80:83], v[48:51], v[72:75], a[80:83]
    ds_read_b128 v[84:87], v15 offset:14336
    s_xor_b32 m0, s45, 18432
    v_mfma_f32_16x16x32_bf16 a[112:115], v[52:55], v[72:75], a[112:115]
    buffer_load_dwordx4 v6, s[12:15], s27 offen lds
    v_mfma_f32_16x16x32_bf16 a[116:119], v[52:55], v[76:79], a[116:119]
    v_mfma_f32_16x16x32_bf16 a[84:87], v[48:51], v[76:79], a[84:87]
    s_xor_b32 m0, s45, 19456
    v_mfma_f32_16x16x32_bf16 a[144:147], v[56:59], v[72:75], a[144:147]
    buffer_load_dwordx4 v7, s[12:15], s27 offen lds
    v_mfma_f32_16x16x32_bf16 a[176:179], v[60:63], v[72:75], a[176:179]
    s_add_u32 s27, s27, s28
    s_cmp_ge_u32 s45, 98304
    v_mfma_f32_16x16x32_bf16 a[180:183], v[60:63], v[76:79], a[180:183]
    s_cselect_b32 s60, s6, s7
    s_add_u32 s45, s45, s60
    v_mfma_f32_16x16x32_bf16 a[148:151], v[56:59], v[76:79], a[148:151]
    v_add_u32 v15, s47, v15
    v_mfma_f32_16x16x32_bf16 a[208:211], v[64:67], v[72:75], a[208:211]
    s_add_u32 s43, s43, 1
    s_cmp_eq_u32 s43, 16
    v_mfma_f32_16x16x32_bf16 a[240:243], v[68:71], v[72:75], a[240:243]
    v_mfma_f32_16x16x32_bf16 a[244:247], v[68:71], v[76:79], a[244:247]
    v_mfma_f32_16x16x32_bf16 a[212:215], v[64:67], v[76:79], a[212:215]
    s_waitcnt vmcnt(6) lgkmcnt(0)
    s_barrier
    s_cbranch_scc1 t_g1_last
    v_mfma_f32_16x16x32_bf16 a[24:27], v[40:43], v[80:83], a[24:27]
    ds_read_b128 v[72:75], v14 offset:0
    v_mfma_f32_16x16x32_bf16 a[56:59], v[44:47], v[80:83], a[56:59]
    ds_read_b128 v[76:79], v14 offset:2048
    v_mfma_f32_16x16x32_bf16 a[60:63], v[44:47], v[84:87], a[60:63]
    ds_read_b128 v[44:47], v12 offset:2048
    v_mfma_f32_16x16x32_bf16 a[28:31], v[40:43], v[84:87], a[28:31]
    ds_read_b128 v[40:43], v12 offset:0
    v_mfma_f32_16x16x32_bf16 a[88:91], v[48:51], v[80:83], a[88:91]
    v_mfma_f32_16x16x32_bf16 a[120:123], v[52:55], v[80:83], a[120:123]
    v_mfma_f32_16x16x32_bf16 a[124:127], v[52:55], v[84:87], a[124:127]
    ds_read_b128 v[52:55], v12 offset:6144
    v_mfma_f32_16x16x32_bf16 a[92:95], v[48:51], v[84:87], a[92:95]
    ds_read_b128 v[48:51], v12 offset:4096
    v_mfma_f32_16x16x32_bf16 a[152:155], v[56:59], v[80:83], a[152:155]
    v_mfma_f32_16x16x32_bf16 a[184:187], v[60:63], v[80:83], a[184:187]
    v_mfma_f32_16x16x32_bf16 a[188:191], v[60:63], v[84:87], a[188:191]
    ds_read_b128 v[60:63], v12 offset:10240
    v_mfma_f32_16x16x32_bf16 a[156:159], v[56:59], v[84:87], a[156:159]
    ds_read_b128 v[56:59], v12 offset:8192
    v_mfma_f32_16x16x32_bf16 a[216:219], v[64:67], v[80:83], a[216:219]
    s_sub_u32 s61, s43, 10
    s_cmp_lt_u32 s61, 3
    v_mfma_f32_16x16x32_bf16 a[248:251], v[68:71], v[80:83], a[248:251]
    v_mfma_f32_16x16x32_bf16 a[252:255], v[68:71], v[84:87], a[252:255]
    ds_read_b128 v[68:71], v12 offset:14336
    v_mfma_f32_16x16x32_bf16 a[220:223], v[64:67], v[84:87], a[220:223]
    ds_read_b128 v[64:67], v12 offset:12288
    s_cbranch_scc1 t_g1_a
    s_branch t_g1_hook
t_g1_last:
    v_mfma_f32_16x16x32_bf16 a[24:27], v[40:43], v[80:83], a[24:27]
    v_mfma_f32_16x16x32_bf16 a[56:59], v[44:47], v[80:83], a[56:59]
    v_mfma_f32_16x16x32_bf16 a[60:63], v[44:47], v[84:87], a[60:63]
    v_mfma_f32_16x16x32_bf16 a[28:31], v[40:43], v[84:87], a[28:31]
    v_mfma_f32_16x16x32_bf16 a[88:91], v[48:51], v[80:83], a[88:91]
    v_mfma_f32_16x16x32_bf16 a[120:123], v[52:55], v[80:83], a[120:123]
    v_mfma_f32_16x16x32_bf16 a[124:127], v[52:55], v[84:87], a[124:127]
    v_mfma_f32_16x16x32_bf16 a[92:95], v[48:51], v[84:87], a[92:95]
    v_mfma_f32_16x16x32_bf16 a[152:155], v[56:59], v[80:83], a[152:155]
    v_mfma_f32_16x16x32_bf16 a[184:187], v[60:63], v[80:83], a[184:187]
    v_mfma_f32_16x16x32_bf16 a[188:191], v[60:63], v[84:87], a[188:191]
    v_mfma_f32_16x16x32_bf16 a[156:159], v[56:59], v[84:87], a[156:159]
    v_mfma_f32_16x16x32_bf16 a[216:219], v[64:67], v[80:83], a[216:219]
    v_mfma_f32_16x16x32_bf16 a[248:251], v[68:71], v[80:83], a[248:251]
    v_mfma_f32_16x16x32_bf16 a[252:255], v[68:71], v[84:87], a[252:255]
    v_mfma_f32_16x16x32_bf16 a[220:223], v[64:67], v[84:87], a[220:223]
    s_setpc_b64 s[54:55]
t_scan:
    s_nop 7
    v_accvgpr_read_b32 v40, a0
    v_accvgpr_read_b32 v42, a4
    v_accvgpr_read_b32 v44, a8
    v_accvgpr_read_b32 v46, a12
    v_accvgpr_read_b32 v41, a16
    v_accvgpr_read_b32 v43, a20
    v_accvgpr_read_b32 v45, a24
    v_accvgpr_read_b32 v47, a28
    v_accvgpr_read_b32 v48, a1
    v_accvgpr_read_b32 v50, a5
    v_accvgpr_read_b32 v52, a9
    v_accvgpr_read_b32 v54, a13
    v_accvgpr_read_b32 v49, a17
    v_accvgpr_read_b32 v51, a21
    v_accvgpr_read_b32 v53, a25
    v_accvgpr_read_b32 v55, a29
    v_pk_fma_f32 v[56:57], v[88:89], v[40:41], v[48:49] op_sel:[0,0,0] op_sel_hi:[0,1,1]
    v_pk_fma_f32 v[58:59], v[90:91], v[42:43], v[50:51] op_sel:[0,0,0] op_sel_hi:[0,1,1]
    v_pk_fma_f32 v[60:61], v[92:93], v[44:45], v[52:53] op_sel:[0,0,0] op_sel_hi:[0,1,1]
    v_pk_fma_f32 v[62:63], v[94:95], v[46:47], v[54:55] op_sel:[0,0,0] op_sel_hi:[0,1,1]
    v_pk_fma_f32 v[40:41], v[88:89], v[40:41], v[56:57] op_sel:[1,1,0] op_sel_hi:[1,0,1] neg_lo:[1,0,0]
    v_pk_fma_f32 v[42:43], v[90:91], v[42:43], v[58:59] op_sel:[1,1,0] op_sel_hi:[1,0,1] neg_lo:[1,0,0]
    v_pk_fma_f32 v[44:45], v[92:93], v[44:45], v[60:61] op_sel:[1,1,0] op_sel_hi:[1,0,1] neg_lo:[1,0,0]
    v_pk_fma_f32 v[46:47], v[94:95], v[46:47], v[62:63] op_sel:[1,1,0] op_sel_hi:[1,0,1] neg_lo:[1,0,0]
    v_accvgpr_read_b32 v64, a2
    v_accvgpr_read_b32 v66, a6
    v_accvgpr_read_b32 v68, a10
    v_accvgpr_read_b32 v70, a14
    v_accvgpr_read_b32 v65, a18
    v_accvgpr_read_b32 v67, a22
    v_accvgpr_read_b32 v69, a26
    v_accvgpr_read_b32 v71, a30
    v_pk_fma_f32 v[56:57], v[88:89], v[40:41], v[64:65] op_sel:[0,0,0] op_sel_hi:[0,1,1]
    v_pk_fma_f32 v[58:59], v[90:91], v[42:43], v[66:67] op_sel:[0,0,0] op_sel_hi:[0,1,1]
    v_pk_fma_f32 v[60:61], v[92:93], v[44:45], v[68:69] op_sel:[0,0,0] op_sel_hi:[0,1,1]
    v_pk_fma_f32 v[62:63], v[94:95], v[46:47], v[70:71] op_sel:[0,0,0] op_sel_hi:[0,1,1]
    v_pk_fma_f32 v[40:41], v[88:89], v[40:41], v[56:57] op_sel:[1,1,0] op_sel_hi:[1,0,1] neg_lo:[1,0,0]
    v_pk_fma_f32 v[42:43], v[90:91], v[42:43], v[58:59] op_sel:[1,1,0] op_sel_hi:[1,0,1] neg_lo:[1,0,0]
    v_pk_fma_f32 v[44:45], v[92:93], v[44:45], v[60:61] op_sel:[1,1,0] op_sel_hi:[1,0,1] neg_lo:[1,0,0]
    v_pk_fma_f32 v[46:47], v[94:95], v[46:47], v[62:63] op_sel:[1,1,0] op_sel_hi:[1,0,1] neg_lo:[1,0,0]
    v_accvgpr_read_b32 v48, a3
    v_accvgpr_read_b32 v50, a7
    v_accvgpr_read_b32 v52, a11
    v_accvgpr_read_b32 v54, a15
    v_accvgpr_read_b32 v49, a19
    v_accvgpr_read_b32 v51, a23
    v_accvgpr_read_b32 v53, a27
    v_accvgpr_read_b32 v55, a31
    v_pk_fma_f32 v[56:57], v[88:89], v[40:41], v[48:49] op_sel:[0,0,0] op_sel_hi:[0,1,1]
    v_pk_fma_f32 v[58:59], v[90:91], v[42:43], v[50:51] op_sel:[0,0,0] op_sel_hi:[0,1,1]
    v_pk_fma_f32 v[60:61], v[92:93], v[44:45], v[52:53] op_sel:[0,0,0] op_sel_hi:[0,1,1]
    v_pk_fma_f32 v[62:63], v[94:95], v[46:47], v[54:55] op_sel:[0,0,0] op_sel_hi:[0,1,1]
    v_pk_fma_f32 v[40:41], v[88:89], v[40:41], v[56:57] op_sel:[1,1,0] op_sel_hi:[1,0,1] neg_lo:[1,0,0]
    v_pk_fma_f32 v[42:43], v[90:91], v[42:43], v[58:59] op_sel:[1,1,0] op_sel_hi:[1,0,1] neg_lo:[1,0,0]
    v_pk_fma_f32 v[44:45], v[92:93], v[44:45], v[60:61] op_sel:[1,1,0] op_sel_hi:[1,0,1] neg_lo:[1,0,0]
    v_pk_fma_f32 v[46:47], v[94:95], v[46:47], v[62:63] op_sel:[1,1,0] op_sel_hi:[1,0,1] neg_lo:[1,0,0]
    v_accvgpr_read_b32 v64, a32
    v_accvgpr_read_b32 v66, a36
    v_accvgpr_read_b32 v68, a40
    v_accvgpr_read_b32 v70, a44
    v_accvgpr_read_b32 v65, a48
    v_accvgpr_read_b32 v67, a52
    v_accvgpr_read_b32 v69, a56
    v_accvgpr_read_b32 v71, a60
    v_pk_fma_f32 v[56:57], v[88:89], v[40:41], v[64:65] op_sel:[0,0,0] op_sel_hi:[0,1,1]
    v_pk_fma_f32 v[58:59], v[90:91], v[42:43], v[66:67] op_sel:[0,0,0] op_sel_hi:[0,1,1]
    v_pk_fma_f32 v[60:61], v[92:93], v[44:45], v[68:69] op_sel:[0,0,0] op_sel_hi:[0,1,1]
    v_pk_fma_f32 v[62:63], v[94:95], v[46:47], v[70:71] op_sel:[0,0,0] op_sel_hi:[0,1,1]
    v_pk_fma_f32 v[40:41], v[88:89], v[40:41], v[56:57] op_sel:[1,1,0] op_sel_hi:[1,0,1] neg_lo:[1,0,0]
    v_pk_fma_f32 v[42:43], v[90:91], v[42:43], v[58:59] op_sel:[1,1,0] op_sel_hi:[1,0,1] neg_lo:[1,0,0]
    v_pk_fma_f32 v[44:45], v[92:93], v[44:45], v[60:61] op_sel:[1,1,0] op_sel_hi:[1,0,1] neg_lo:[1,0,0]
    v_pk_fma_f32 v[46:47], v[94:95], v[46:47], v[62:63] op_sel:[1,1,0] op_sel_hi:[1,0,1] neg_lo:[1,0,0]
    v_accvgpr_read_b32 v48, a33
    v_accvgpr_read_b32 v50, a37
    v_accvgpr_read_b32 v52, a41
    v_accvgpr_read_b32 v54, a45
    v_accvgpr_read_b32 v49, a49
    v_accvgpr_read_b32 v51, a53
    v_accvgpr_read_b32 v53, a57
    v_accvgpr_read_b32 v55, a61
    v_pk_fma_f32 v[56:57], v[88:89], v[40:41], v[48:49] op_sel:[0,0,0] op_sel_hi:[0,1,1]
    v_pk_fma_f32 v[58:59], v[90:91], v[42:43], v[50:51] op_sel:[0,0,0] op_sel_hi:[0,1,1]
    v_pk_fma_f32 v[60:61], v[92:93], v[44:45], v[52:53] op_sel:[0,0,0] op_sel_hi:[0,1,1]
    v_pk_fma_f32 v[62:63], v[94:95], v[46:47], v[54:55] op_sel:[0,0,0] op_sel_hi:[0,1,1]
    v_pk_fma_f32 v[40:41], v[88:89], v[40:41], v[56:57] op_sel:[1,1,0] op_sel_hi:[1,0,1] neg_lo:[1,0,0]
    v_pk_fma_f32 v[42:43], v[90:91], v[42:43], v[58:59] op_sel:[1,1,0] op_sel_hi:[1,0,1] neg_lo:[1,0,0]
    v_pk_fma_f32 v[44:45], v[92:93], v[44:45], v[60:61] op_sel:[1,1,0] op_sel_hi:[1,0,1] neg_lo:[1,0,0]
    v_pk_fma_f32 v[46:47], v[94:95], v[46:47], v[62:63] op_sel:[1,1,0] op_sel_hi:[1,0,1] neg_lo:[1,0,0]
    v_accvgpr_read_b32 v64, a34
    v_accvgpr_read_b32 v66, a38
    v_accvgpr_read_b32 v68, a42
    v_accvgpr_read_b32 v70, a46
    v_accvgpr_read_b32 v65, a50
    v_accvgpr_read_b32 v67, a54
    v_accvgpr_read_b32 v69, a58
    v_accvgpr_read_b32 v71, a62
    v_pk_fma_f32 v[56:57], v[88:89], v[40:41], v[64:65] op_sel:[0,0,0] op_sel_hi:[0,1,1]
    v_pk_fma_f32 v[58:59], v[90:91], v[42:43], v[66:67] op_sel:[0,0,0] op_sel_hi:[0,1,1]
    v_pk_fma_f32 v[60:61], v[92:93], v[44:45], v[68:69] op_sel:[0,0,0] op_sel_hi:[0,1,1]
    v_pk_fma_f32 v[62:63], v[94:95], v[46:47], v[70:71] op_sel:[0,0,0] op_sel_hi:[0,1,1]
    v_pk_fma_f32 v[40:41], v[88:89], v[40:41], v[56:57] op_sel:[1,1,0] op_sel_hi:[1,0,1] neg_lo:[1,0,0]
    v_pk_fma_f32 v[42:43], v[90:91], v[42:43], v[58:59] op_sel:[1,1,0] op_sel_hi:[1,0,1] neg_lo:[1,0,0]
    v_pk_fma_f32 v[44:45], v[92:93], v[44:45], v[60:61] op_sel:[1,1,0] op_sel_hi:[1,0,1] neg_lo:[1,0,0]
    v_pk_fma_f32 v[46:47], v[94:95], v[46:47], v[62:63] op_sel:[1,1,0] op_sel_hi:[1,0,1] neg_lo:[1,0,0]
    v_accvgpr_read_b32 v48, a35
    v_accvgpr_read_b32 v50, a39
    v_accvgpr_read_b32 v52, a43
    v_accvgpr_read_b32 v54, a47
    v_accvgpr_read_b32 v49, a51
    v_accvgpr_read_b32 v51, a55
    v_accvgpr_read_b32 v53, a59
    v_accvgpr_read_b32 v55, a63
    v_pk_fma_f32 v[56:57], v[88:89], v[40:41], v[48:49] op_sel:[0,0,0] op_sel_hi:[0,1,1]
    v_pk_fma_f32 v[58:59], v[90:91], v[42:43], v[50:51] op_sel:[0,0,0] op_sel_hi:[0,1,1]
    v_pk_fma_f32 v[60:61], v[92:93], v[44:45], v[52:53] op_sel:[0,0,0] op_sel_hi:[0,1,1]
    v_pk_fma_f32 v[62:63], v[94:95], v[46:47], v[54:55] op_sel:[0,0,0] op_sel_hi:[0,1,1]
    v_pk_fma_f32 v[40:41], v[88:89], v[40:41], v[56:57] op_sel:[1,1,0] op_sel_hi:[1,0,1] neg_lo:[1,0,0]
    v_pk_fma_f32 v[42:43], v[90:91], v[42:43], v[58:59] op_sel:[1,1,0] op_sel_hi:[1,0,1] neg_lo:[1,0,0]
    v_pk_fma_f32 v[44:45], v[92:93], v[44:45], v[60:61] op_sel:[1,1,0] op_sel_hi:[1,0,1] neg_lo:[1,0,0]
    v_pk_fma_f32 v[46:47], v[94:95], v[46:47], v[62:63] op_sel:[1,1,0] op_sel_hi:[1,0,1] neg_lo:[1,0,0]
    v_accvgpr_read_b32 v64, a64
    v_accvgpr_read_b32 v66, a68
    v_accvgpr_read_b32 v68, a72
    v_accvgpr_read_b32 v70, a76
    v_accvgpr_read_b32 v65, a80
    v_accvgpr_read_b32 v67, a84
    v_accvgpr_read_b32 v69, a88
    v_accvgpr_read_b32 v71, a92
    v_pk_fma_f32 v[56:57], v[88:89], v[40:41], v[64:65] op_sel:[0,0,0] op_sel_hi:[0,1,1]
    v_pk_fma_f32 v[58:59], v[90:91], v[42:43], v[66:67] op_sel:[0,0,0] op_sel_hi:[0,1,1]
    v_pk_fma_f32 v[60:61], v[92:93], v[44:45], v[68:69] op_sel:[0,0,0] op_sel_hi:[0,1,1]
    v_pk_fma_f32 v[62:63], v[94:95], v[46:47], v[70:71] op_sel:[0,0,0] op_sel_hi:[0,1,1]
    v_pk_fma_f32 v[40:41], v[88:89], v[40:41], v[56:57] op_sel:[1,1,0] op_sel_hi:[1,0,1] neg_lo:[1,0,0]
    v_pk_fma_f32 v[42:43], v[90:91], v[42:43], v[58:59] op_sel:[1,1,0] op_sel_hi:[1,0,1] neg_lo:[1,0,0]
    v_pk_fma_f32 v[44:45], v[92:93], v[44:45], v[60:61] op_sel:[1,1,0] op_sel_hi:[1,0,1] neg_lo:[1,0,0]
    v_pk_fma_f32 v[46:47], v[94:95], v[46:47], v[62:63] op_sel:[1,1,0] op_sel_hi:[1,0,1] neg_lo:[1,0,0]
    v_accvgpr_read_b32 v48, a65
    v_accvgpr_read_b32 v50, a69
    v_accvgpr_read_b32 v52, a73
    v_accvgpr_read_b32 v54, a77
    v_accvgpr_read_b32 v49, a81
    v_accvgpr_read_b32 v51, a85
    v_accvgpr_read_b32 v53, a89
    v_accvgpr_read_b32 v55, a93
    v_pk_fma_f32 v[56:57], v[88:89], v[40:41], v[48:49] op_sel:[0,0,0] op_sel_hi:[0,1,1]
    v_pk_fma_f32 v[58:59], v[90:91], v[42:43], v[50:51] op_sel:[0,0,0] op_sel_hi:[0,1,1]
    v_pk_fma_f32 v[60:61], v[92:93], v[44:45], v[52:53] op_sel:[0,0,0] op_sel_hi:[0,1,1]
    v_pk_fma_f32 v[62:63], v[94:95], v[46:47], v[54:55] op_sel:[0,0,0] op_sel_hi:[0,1,1]
    v_pk_fma_f32 v[40:41], v[88:89], v[40:41], v[56:57] op_sel:[1,1,0] op_sel_hi:[1,0,1] neg_lo:[1,0,0]
    v_pk_fma_f32 v[42:43], v[90:91], v[42:43], v[58:59] op_sel:[1,1,0] op_sel_hi:[1,0,1] neg_lo:[1,0,0]
    v_pk_fma_f32 v[44:45], v[92:93], v[44:45], v[60:61] op_sel:[1,1,0] op_sel_hi:[1,0,1] neg_lo:[1,0,0]
    v_pk_fma_f32 v[46:47], v[94:95], v[46:47], v[62:63] op_sel:[1,1,0] op_sel_hi:[1,0,1] neg_lo:[1,0,0]
    v_accvgpr_read_b32 v64, a66
    v_accvgpr_read_b32 v66, a70
    v_accvgpr_read_b32 v68, a74
    v_accvgpr_read_b32 v70, a78
    v_accvgpr_read_b32 v65, a82
    v_accvgpr_read_b32 v67, a86
    v_accvgpr_read_b32 v69, a90
    v_accvgpr_read_b32 v71, a94
    v_pk_fma_f32 v[56:57], v[88:89], v[40:41], v[64:65] op_sel:[0,0,0] op_sel_hi:[0,1,1]
    v_pk_fma_f32 v[58:59], v[90:91], v[42:43], v[66:67] op_sel:[0,0,0] op_sel_hi:[0,1,1]
    v_pk_fma_f32 v[60:61], v[92:93], v[44:45], v[68:69] op_sel:[0,0,0] op_sel_hi:[0,1,1]
    v_pk_fma_f32 v[62:63], v[94:95], v[46:47], v[70:71] op_sel:[0,0,0] op_sel_hi:[0,1,1]
    v_pk_fma_f32 v[40:41], v[88:89], v[40:41], v[56:57] op_sel:[1,1,0] op_sel_hi:[1,0,1] neg_lo:[1,0,0]
    v_pk_fma_f32 v[42:43], v[90:91], v[42:43], v[58:59] op_sel:[1,1,0] op_sel_hi:[1,0,1] neg_lo:[1,0,0]
    v_pk_fma_f32 v[44:45], v[92:93], v[44:45], v[60:61] op_sel:[1,1,0] op_sel_hi:[1,0,1] neg_lo:[1,0,0]
    v_pk_fma_f32 v[46:47], v[94:95], v[46:47], v[62:63] op_sel:[1,1,0] op_sel_hi:[1,0,1] neg_lo:[1,0,0]
    v_accvgpr_read_b32 v48, a67
    v_accvgpr_read_b32 v50, a71
    v_accvgpr_read_b32 v52, a75
    v_accvgpr_read_b32 v54, a79
    v_accvgpr_read_b32 v49, a83
    v_accvgpr_read_b32 v51, a87
    v_accvgpr_read_b32 v53, a91
    v_accvgpr_read_b32 v55, a95
    v_pk_fma_f32 v[56:57], v[88:89], v[40:41], v[48:49] op_sel:[0,0,0] op_sel_hi:[0,1,1]
    v_pk_fma_f32 v[58:59], v[90:91], v[42:43], v[50:51] op_sel:[0,0,0] op_sel_hi:[0,1,1]
    v_pk_fma_f32 v[60:61], v[92:93], v[44:45], v[52:53] op_sel:[0,0,0] op_sel_hi:[0,1,1]
    v_pk_fma_f32 v[62:63], v[94:95], v[46:47], v[54:55] op_sel:[0,0,0] op_sel_hi:[0,1,1]
    v_pk_fma_f32 v[40:41], v[88:89], v[40:41], v[56:57] op_sel:[1,1,0] op_sel_hi:[1,0,1] neg_lo:[1,0,0]
    v_pk_fma_f32 v[42:43], v[90:91], v[42:43], v[58:59] op_sel:[1,1,0] op_sel_hi:[1,0,1] neg_lo:[1,0,0]
    v_pk_fma_f32 v[44:45], v[92:93], v[44:45], v[60:61] op_sel:[1,1,0] op_sel_hi:[1,0,1] neg_lo:[1,0,0]
    v_pk_fma_f32 v[46:47], v[94:95], v[46:47], v[62:63] op_sel:[1,1,0] op_sel_hi:[1,0,1] neg_lo:[1,0,0]
    v_accvgpr_read_b32 v64, a96
    v_accvgpr_read_b32 v66, a100
    v_accvgpr_read_b32 v68, a104
    v_accvgpr_read_b32 v70, a108
    v_accvgpr_read_b32 v65, a112
    v_accvgpr_read_b32 v67, a116
    v_accvgpr_read_b32 v69, a120
    v_accvgpr_read_b32 v71, a124
    v_pk_fma_f32 v[56:57], v[88:89], v[40:41], v[64:65] op_sel:[0,0,0] op_sel_hi:[0,1,1]
    v_pk_fma_f32 v[58:59], v[90:91], v[42:43], v[66:67] op_sel:[0,0,0] op_sel_hi:[0,1,1]
    v_pk_fma_f32 v[60:61], v[92:93], v[44:45], v[68:69] op_sel:[0,0,0] op_sel_hi:[0,1,1]
    v_pk_fma_f32 v[62:63], v[94:95], v[46:47], v[70:71] op_sel:[0,0,0] op_sel_hi:[0,1,1]
    v_pk_fma_f32 v[40:41], v[88:89], v[40:41], v[56:57] op_sel:[1,1,0] op_sel_hi:[1,0,1] neg_lo:[1,0,0]
    v_pk_fma_f32 v[42:43], v[90:91], v[42:43], v[58:59] op_sel:[1,1,0] op_sel_hi:[1,0,1] neg_lo:[1,0,0]
    v_pk_fma_f32 v[44:45], v[92:93], v[44:45], v[60:61] op_sel:[1,1,0] op_sel_hi:[1,0,1] neg_lo:[1,0,0]
    v_pk_fma_f32 v[46:47], v[94:95], v[46:47], v[62:63] op_sel:[1,1,0] op_sel_hi:[1,0,1] neg_lo:[1,0,0]
    v_accvgpr_read_b32 v48, a97
    v_accvgpr_read_b32 v50, a101
    v_accvgpr_read_b32 v52, a105
    v_accvgpr_read_b32 v54, a109
    v_accvgpr_read_b32 v49, a113
    v_accvgpr_read_b32 v51, a117
    v_accvgpr_read_b32 v53, a121
    v_accvgpr_read_b32 v55, a125
    v_pk_fma_f32 v[56:57], v[88:89], v[40:41], v[48:49] op_sel:[0,0,0] op_sel_hi:[0,1,1]
    v_pk_fma_f32 v[58:59], v[90:91], v[42:43], v[50:51] op_sel:[0,0,0] op_sel_hi:[0,1,1]
    v_pk_fma_f32 v[60:61], v[92:93], v[44:45], v[52:53] op_sel:[0,0,0] op_sel_hi:[0,1,1]
    v_pk_fma_f32 v[62:63], v[94:95], v[46:47], v[54:55] op_sel:[0,0,0] op_sel_hi:[0,1,1]
    v_pk_fma_f32 v[40:41], v[88:89], v[40:41], v[56:57] op_sel:[1,1,0] op_sel_hi:[1,0,1] neg_lo:[1,0,0]
    v_pk_fma_f32 v[42:43], v[90:91], v[42:43], v[58:59] op_sel:[1,1,0] op_sel_hi:[1,0,1] neg_lo:[1,0,0]
    v_pk_fma_f32 v[44:45], v[92:93], v[44:45], v[60:61] op_sel:[1,1,0] op_sel_hi:[1,0,1] neg_lo:[1,0,0]
    v_pk_fma_f32 v[46:47], v[94:95], v[46:47], v[62:63] op_sel:[1,1,0] op_sel_hi:[1,0,1] neg_lo:[1,0,0]
    v_accvgpr_read_b32 v64, a98
    v_accvgpr_read_b32 v66, a102
    v_accvgpr_read_b32 v68, a106
    v_accvgpr_read_b32 v70, a110
    v_accvgpr_read_b32 v65, a114
    v_accvgpr_read_b32 v67, a118
    v_accvgpr_read_b32 v69, a122
    v_accvgpr_read_b32 v71, a126
    v_pk_fma_f32 v[56:57], v[88:89], v[40:41], v[64:65] op_sel:[0,0,0] op_sel_hi:[0,1,1]
    v_pk_fma_f32 v[58:59], v[90:91], v[42:43], v[66:67] op_sel:[0,0,0] op_sel_hi:[0,1,1]
    v_pk_fma_f32 v[60:61], v[92:93], v[44:45], v[68:69] op_sel:[0,0,0] op_sel_hi:[0,1,1]
    v_pk_fma_f32 v[62:63], v[94:95], v[46:47], v[70:71] op_sel:[0,0,0] op_sel_hi:[0,1,1]
    v_pk_fma_f32 v[40:41], v[88:89], v[40:41], v[56:57] op_sel:[1,1,0] op_sel_hi:[1,0,1] neg_lo:[1,0,0]
    v_pk_fma_f32 v[42:43], v[90:91], v[42:43], v[58:59] op_sel:[1,1,0] op_sel_hi:[1,0,1] neg_lo:[1,0,0]
    v_pk_fma_f32 v[44:45], v[92:93], v[44:45], v[60:61] op_sel:[1,1,0] op_sel_hi:[1,0,1] neg_lo:[1,0,0]
    v_pk_fma_f32 v[46:47], v[94:95], v[46:47], v[62:63] op_sel:[1,1,0] op_sel_hi:[1,0,1] neg_lo:[1,0,0]
    v_accvgpr_read_b32 v48, a99
    v_accvgpr_read_b32 v50, a103
    v_accvgpr_read_b32 v52, a107
    v_accvgpr_read_b32 v54, a111
    v_accvgpr_read_b32 v49, a115
    v_accvgpr_read_b32 v51, a119
    v_accvgpr_read_b32 v53, a123
    v_accvgpr_read_b32 v55, a127
    v_pk_fma_f32 v[56:57], v[88:89], v[40:41], v[48:49] op_sel:[0,0,0] op_sel_hi:[0,1,1]
    v_pk_fma_f32 v[58:59], v[90:91], v[42:43], v[50:51] op_sel:[0,0,0] op_sel_hi:[0,1,1]
    v_pk_fma_f32 v[60:61], v[92:93], v[44:45], v[52:53] op_sel:[0,0,0] op_sel_hi:[0,1,1]
    v_pk_fma_f32 v[62:63], v[94:95], v[46:47], v[54:55] op_sel:[0,0,0] op_sel_hi:[0,1,1]
    v_pk_fma_f32 v[40:41], v[88:89], v[40:41], v[56:57] op_sel:[1,1,0] op_sel_hi:[1,0,1] neg_lo:[1,0,0]
    v_pk_fma_f32 v[42:43], v[90:91], v[42:43], v[58:59] op_sel:[1,1,0] op_sel_hi:[1,0,1] neg_lo:[1,0,0]
    v_pk_fma_f32 v[44:45], v[92:93], v[44:45], v[60:61] op_sel:[1,1,0] op_sel_hi:[1,0,1] neg_lo:[1,0,0]
    v_pk_fma_f32 v[46:47], v[94:95], v[46:47], v[62:63] op_sel:[1,1,0] op_sel_hi:[1,0,1] neg_lo:[1,0,0]
    v_accvgpr_read_b32 v64, a128
    v_accvgpr_read_b32 v66, a132
    v_accvgpr_read_b32 v68, a136
    v_accvgpr_read_b32 v70, a140
    v_accvgpr_read_b32 v65, a144
    v_accvgpr_read_b32 v67, a148
    v_accvgpr_read_b32 v69, a152
    v_accvgpr_read_b32 v71, a156
    v_pk_fma_f32 v[56:57], v[88:89], v[40:41], v[64:65] op_sel:[0,0,0] op_sel_hi:[0,1,1]
    v_pk_fma_f32 v[58:59], v[90:91], v[42:43], v[66:67] op_sel:[0,0,0] op_sel_hi:[0,1,1]
    v_pk_fma_f32 v[60:61], v[92:93], v[44:45], v[68:69] op_sel:[0,0,0] op_sel_hi:[0,1,1]
    v_pk_fma_f32 v[62:63], v[94:95], v[46:47], v[70:71] op_sel:[0,0,0] op_sel_hi:[0,1,1]
    v_pk_fma_f32 v[40:41], v[88:89], v[40:41], v[56:57] op_sel:[1,1,0] op_sel_hi:[1,0,1] neg_lo:[1,0,0]
    v_pk_fma_f32 v[42:43], v[90:91], v[42:43], v[58:59] op_sel:[1,1,0] op_sel_hi:[1,0,1] neg_lo:[1,0,0]
    v_pk_fma_f32 v[44:45], v[92:93], v[44:45], v[60:61] op_sel:[1,1,0] op_sel_hi:[1,0,1] neg_lo:[1,0,0]
    v_pk_fma_f32 v[46:47], v[94:95], v[46:47], v[62:63] op_sel:[1,1,0] op_sel_hi:[1,0,1] neg_lo:[1,0,0]
    v_accvgpr_read_b32 v48, a129
    v_accvgpr_read_b32 v50, a133
    v_accvgpr_read_b32 v52, a137
    v_accvgpr_read_b32 v54, a141
    v_accvgpr_read_b32 v49, a145
    v_accvgpr_read_b32 v51, a149
    v_accvgpr_read_b32 v53, a153
    v_accvgpr_read_b32 v55, a157
    v_pk_fma_f32 v[56:57], v[88:89], v[40:41], v[48:49] op_sel:[0,0,0] op_sel_hi:[0,1,1]
    v_pk_fma_f32 v[58:59], v[90:91], v[42:43], v[50:51] op_sel:[0,0,0] op_sel_hi:[0,1,1]
    v_pk_fma_f32 v[60:61], v[92:93], v[44:45], v[52:53] op_sel:[0,0,0] op_sel_hi:[0,1,1]
    v_pk_fma_f32 v[62:63], v[94:95], v[46:47], v[54:55] op_sel:[0,0,0] op_sel_hi:[0,1,1]
    v_pk_fma_f32 v[40:41], v[88:89], v[40:41], v[56:57] op_sel:[1,1,0] op_sel_hi:[1,0,1] neg_lo:[1,0,0]
    v_pk_fma_f32 v[42:43], v[90:91], v[42:43], v[58:59] op_sel:[1,1,0] op_sel_hi:[1,0,1] neg_lo:[1,0,0]
    v_pk_fma_f32 v[44:45], v[92:93], v[44:45], v[60:61] op_sel:[1,1,0] op_sel_hi:[1,0,1] neg_lo:[1,0,0]
    v_pk_fma_f32 v[46:47], v[94:95], v[46:47], v[62:63] op_sel:[1,1,0] op_sel_hi:[1,0,1] neg_lo:[1,0,0]
    v_accvgpr_read_b32 v64, a130
    v_accvgpr_read_b32 v66, a134
    v_accvgpr_read_b32 v68, a138
    v_accvgpr_read_b32 v70, a142
    v_accvgpr_read_b32 v65, a146
    v_accvgpr_read_b32 v67, a150
    v_accvgpr_read_b32 v69, a154
    v_accvgpr_read_b32 v71, a158
    v_pk_fma_f32 v[56:57], v[88:89], v[40:41], v[64:65] op_sel:[0,0,0] op_sel_hi:[0,1,1]
    v_pk_fma_f32 v[58:59], v[90:91], v[42:43], v[66:67] op_sel:[0,0,0] op_sel_hi:[0,1,1]
    v_pk_fma_f32 v[60:61], v[92:93], v[44:45], v[68:69] op_sel:[0,0,0] op_sel_hi:[0,1,1]
    v_pk_fma_f32 v[62:63], v[94:95], v[46:47], v[70:71] op_sel:[0,0,0] op_sel_hi:[0,1,1]
    v_pk_fma_f32 v[40:41], v[88:89], v[40:41], v[56:57] op_sel:[1,1,0] op_sel_hi:[1,0,1] neg_lo:[1,0,0]
    v_pk_fma_f32 v[42:43], v[90:91], v[42:43], v[58:59] op_sel:[1,1,0] op_sel_hi:[1,0,1] neg_lo:[1,0,0]
    v_pk_fma_f32 v[44:45], v[92:93], v[44:45], v[60:61] op_sel:[1,1,0] op_sel_hi:[1,0,1] neg_lo:[1,0,0]
    v_pk_fma_f32 v[46:47], v[94:95], v[46:47], v[62:63] op_sel:[1,1,0] op_sel_hi:[1,0,1] neg_lo:[1,0,0]
    v_accvgpr_read_b32 v48, a131
    v_accvgpr_read_b32 v50, a135
    v_accvgpr_read_b32 v52, a139
    v_accvgpr_read_b32 v54, a143
    v_accvgpr_read_b32 v49, a147
    v_accvgpr_read_b32 v51, a151
    v_accvgpr_read_b32 v53, a155
    v_accvgpr_read_b32 v55, a159
    v_pk_fma_f32 v[56:57], v[88:89], v[40:41], v[48:49] op_sel:[0,0,0] op_sel_hi:[0,1,1]
    v_pk_fma_f32 v[58:59], v[90:91], v[42:43], v[50:51] op_sel:[0,0,0] op_sel_hi:[0,1,1]
    v_pk_fma_f32 v[60:61], v[92:93], v[44:45], v[52:53] op_sel:[0,0,0] op_sel_hi:[0,1,1]
    v_pk_fma_f32 v[62:63], v[94:95], v[46:47], v[54:55] op_sel:[0,0,0] op_sel_hi:[0,1,1]
    v_pk_fma_f32 v[40:41], v[88:89], v[40:41], v[56:57] op_sel:[1,1,0] op_sel_hi:[1,0,1] neg_lo:[1,0,0]
    v_pk_fma_f32 v[42:43], v[90:91], v[42:43], v[58:59] op_sel:[1,1,0] op_sel_hi:[1,0,1] neg_lo:[1,0,0]
    v_pk_fma_f32 v[44:45], v[92:93], v[44:45], v[60:61] op_sel:[1,1,0] op_sel_hi:[1,0,1] neg_lo:[1,0,0]
    v_pk_fma_f32 v[46:47], v[94:95], v[46:47], v[62:63] op_sel:[1,1,0] op_sel_hi:[1,0,1] neg_lo:[1,0,0]
    v_accvgpr_read_b32 v64, a160
    v_accvgpr_read_b32 v66, a164
    v_accvgpr_read_b32 v68, a168
    v_accvgpr_read_b32 v70, a172
    v_accvgpr_read_b32 v65, a176
    v_accvgpr_read_b32 v67, a180
    v_accvgpr_read_b32 v69, a184
    v_accvgpr_read_b32 v71, a188
    v_pk_fma_f32 v[56:57], v[88:89], v[40:41], v[64:65] op_sel:[0,0,0] op_sel_hi:[0,1,1]
    v_pk_fma_f32 v[58:59], v[90:91], v[42:43], v[66:67] op_sel:[0,0,0] op_sel_hi:[0,1,1]
    v_pk_fma_f32 v[60:61], v[92:93], v[44:45], v[68:69] op_sel:[0,0,0] op_sel_hi:[0,1,1]
    v_pk_fma_f32 v[62:63], v[94:95], v[46:47], v[70:71] op_sel:[0,0,0] op_sel_hi:[0,1,1]
    v_pk_fma_f32 v[40:41], v[88:89], v[40:41], v[56:57] op_sel:[1,1,0] op_sel_hi:[1,0,1] neg_lo:[1,0,0]
    v_pk_fma_f32 v[42:43], v[90:91], v[42:43], v[58:59] op_sel:[1,1,0] op_sel_hi:[1,0,1] neg_lo:[1,0,0]
    v_pk_fma_f32 v[44:45], v[92:93], v[44:45], v[60:61] op_sel:[1,1,0] op_sel_hi:[1,0,1] neg_lo:[1,0,0]
    v_pk_fma_f32 v[46:47], v[94:95], v[46:47], v[62:63] op_sel:[1,1,0] op_sel_hi:[1,0,1] neg_lo:[1,0,0]
    v_accvgpr_read_b32 v48, a161
    v_accvgpr_read_b32 v50, a165
    v_accvgpr_read_b32 v52, a169
    v_accvgpr_read_b32 v54, a173
    v_accvgpr_read_b32 v49, a177
    v_accvgpr_read_b32 v51, a181
    v_accvgpr_read_b32 v53, a185
    v_accvgpr_read_b32 v55, a189
    v_pk_fma_f32 v[56:57], v[88:89], v[40:41], v[48:49] op_sel:[0,0,0] op_sel_hi:[0,1,1]
    v_pk_fma_f32 v[58:59], v[90:91], v[42:43], v[50:51] op_sel:[0,0,0] op_sel_hi:[0,1,1]
    v_pk_fma_f32 v[60:61], v[92:93], v[44:45], v[52:53] op_sel:[0,0,0] op_sel_hi:[0,1,1]
    v_pk_fma_f32 v[62:63], v[94:95], v[46:47], v[54:55] op_sel:[0,0,0] op_sel_hi:[0,1,1]
    v_pk_fma_f32 v[40:41], v[88:89], v[40:41], v[56:57] op_sel:[1,1,0] op_sel_hi:[1,0,1] neg_lo:[1,0,0]
    v_pk_fma_f32 v[42:43], v[90:91], v[42:43], v[58:59] op_sel:[1,1,0] op_sel_hi:[1,0,1] neg_lo:[1,0,0]
    v_pk_fma_f32 v[44:45], v[92:93], v[44:45], v[60:61] op_sel:[1,1,0] op_sel_hi:[1,0,1] neg_lo:[1,0,0]
    v_pk_fma_f32 v[46:47], v[94:95], v[46:47], v[62:63] op_sel:[1,1,0] op_sel_hi:[1,0,1] neg_lo:[1,0,0]
    v_accvgpr_read_b32 v64, a162
    v_accvgpr_read_b32 v66, a166
    v_accvgpr_read_b32 v68, a170
    v_accvgpr_read_b32 v70, a174
    v_accvgpr_read_b32 v65, a178
    v_accvgpr_read_b32 v67, a182
    v_accvgpr_read_b32 v69, a186
    v_accvgpr_read_b32 v71, a190
    v_pk_fma_f32 v[56:57], v[88:89], v[40:41], v[64:65] op_sel:[0,0,0] op_sel_hi:[0,1,1]
    v_pk_fma_f32 v[58:59], v[90:91], v[42:43], v[66:67] op_sel:[0,0,0] op_sel_hi:[0,1,1]
    v_pk_fma_f32 v[60:61], v[92:93], v[44:45], v[68:69] op_sel:[0,0,0] op_sel_hi:[0,1,1]
    v_pk_fma_f32 v[62:63], v[94:95], v[46:47], v[70:71] op_sel:[0,0,0] op_sel_hi:[0,1,1]
    v_pk_fma_f32 v[40:41], v[88:89], v[40:41], v[56:57] op_sel:[1,1,0] op_sel_hi:[1,0,1] neg_lo:[1,0,0]
    v_pk_fma_f32 v[42:43], v[90:91], v[42:43], v[58:59] op_sel:[1,1,0] op_sel_hi:[1,0,1] neg_lo:[1,0,0]
    v_pk_fma_f32 v[44:45], v[92:93], v[44:45], v[60:61] op_sel:[1,1,0] op_sel_hi:[1,0,1] neg_lo:[1,0,0]
    v_pk_fma_f32 v[46:47], v[94:95], v[46:47], v[62:63] op_sel:[1,1,0] op_sel_hi:[1,0,1] neg_lo:[1,0,0]
    v_accvgpr_read_b32 v48, a163
    v_accvgpr_read_b32 v50, a167
    v_accvgpr_read_b32 v52, a171
    v_accvgpr_read_b32 v54, a175
    v_accvgpr_read_b32 v49, a179
    v_accvgpr_read_b32 v51, a183
    v_accvgpr_read_b32 v53, a187
    v_accvgpr_read_b32 v55, a191
    v_pk_fma_f32 v[56:57], v[88:89], v[40:41], v[48:49] op_sel:[0,0,0] op_sel_hi:[0,1,1]
    v_pk_fma_f32 v[58:59], v[90:91], v[42:43], v[50:51] op_sel:[0,0,0] op_sel_hi:[0,1,1]
    v_pk_fma_f32 v[60:61], v[92:93], v[44:45], v[52:53] op_sel:[0,0,0] op_sel_hi:[0,1,1]
    v_pk_fma_f32 v[62:63], v[94:95], v[46:47], v[54:55] op_sel:[0,0,0] op_sel_hi:[0,1,1]
    v_pk_fma_f32 v[40:41], v[88:89], v[40:41], v[56:57] op_sel:[1,1,0] op_sel_hi:[1,0,1] neg_lo:[1,0,0]
    v_pk_fma_f32 v[42:43], v[90:91], v[42:43], v[58:59] op_sel:[1,1,0] op_sel_hi:[1,0,1] neg_lo:[1,0,0]
    v_pk_fma_f32 v[44:45], v[92:93], v[44:45], v[60:61] op_sel:[1,1,0] op_sel_hi:[1,0,1] neg_lo:[1,0,0]
    v_pk_fma_f32 v[46:47], v[94:95], v[46:47], v[62:63] op_sel:[1,1,0] op_sel_hi:[1,0,1] neg_lo:[1,0,0]
    v_accvgpr_read_b32 v64, a192
    v_accvgpr_read_b32 v66, a196
    v_accvgpr_read_b32 v68, a200
    v_accvgpr_read_b32 v70, a204
    v_accvgpr_read_b32 v65, a208
    v_accvgpr_read_b32 v67, a212
    v_accvgpr_read_b32 v69, a216
    v_accvgpr_read_b32 v71, a220
    v_pk_fma_f32 v[56:57], v[88:89], v[40:41], v[64:65] op_sel:[0,0,0] op_sel_hi:[0,1,1]
    v_pk_fma_f32 v[58:59], v[90:91], v[42:43], v[66:67] op_sel:[0,0,0] op_sel_hi:[0,1,1]
    v_pk_fma_f32 v[60:61], v[92:93], v[44:45], v[68:69] op_sel:[0,0,0] op_sel_hi:[0,1,1]
    v_pk_fma_f32 v[62:63], v[94:95], v[46:47], v[70:71] op_sel:[0,0,0] op_sel_hi:[0,1,1]
    v_pk_fma_f32 v[40:41], v[88:89], v[40:41], v[56:57] op_sel:[1,1,0] op_sel_hi:[1,0,1] neg_lo:[1,0,0]
    v_pk_fma_f32 v[42:43], v[90:91], v[42:43], v[58:59] op_sel:[1,1,0] op_sel_hi:[1,0,1] neg_lo:[1,0,0]
    v_pk_fma_f32 v[44:45], v[92:93], v[44:45], v[60:61] op_sel:[1,1,0] op_sel_hi:[1,0,1] neg_lo:[1,0,0]
    v_pk_fma_f32 v[46:47], v[94:95], v[46:47], v[62:63] op_sel:[1,1,0] op_sel_hi:[1,0,1] neg_lo:[1,0,0]
    v_accvgpr_read_b32 v48, a193
    v_accvgpr_read_b32 v50, a197
    v_accvgpr_read_b32 v52, a201
    v_accvgpr_read_b32 v54, a205
    v_accvgpr_read_b32 v49, a209
    v_accvgpr_read_b32 v51, a213
    v_accvgpr_read_b32 v53, a217
    v_accvgpr_read_b32 v55, a221
    v_pk_fma_f32 v[56:57], v[88:89], v[40:41], v[48:49] op_sel:[0,0,0] op_sel_hi:[0,1,1]
    v_pk_fma_f32 v[58:59], v[90:91], v[42:43], v[50:51] op_sel:[0,0,0] op_sel_hi:[0,1,1]
    v_pk_fma_f32 v[60:61], v[92:93], v[44:45], v[52:53] op_sel:[0,0,0] op_sel_hi:[0,1,1]
    v_pk_fma_f32 v[62:63], v[94:95], v[46:47], v[54:55] op_sel:[0,0,0] op_sel_hi:[0,1,1]
    v_pk_fma_f32 v[40:41], v[88:89], v[40:41], v[56:57] op_sel:[1,1,0] op_sel_hi:[1,0,1] neg_lo:[1,0,0]
    v_pk_fma_f32 v[42:43], v[90:91], v[42:43], v[58:59] op_sel:[1,1,0] op_sel_hi:[1,0,1] neg_lo:[1,0,0]
    v_pk_fma_f32 v[44:45], v[92:93], v[44:45], v[60:61] op_sel:[1,1,0] op_sel_hi:[1,0,1] neg_lo:[1,0,0]
    v_pk_fma_f32 v[46:47], v[94:95], v[46:47], v[62:63] op_sel:[1,1,0] op_sel_hi:[1,0,1] neg_lo:[1,0,0]
    v_accvgpr_read_b32 v64, a194
    v_accvgpr_read_b32 v66, a198
    v_accvgpr_read_b32 v68, a202
    v_accvgpr_read_b32 v70, a206
    v_accvgpr_read_b32 v65, a210
    v_accvgpr_read_b32 v67, a214
    v_accvgpr_read_b32 v69, a218
    v_accvgpr_read_b32 v71, a222
    v_pk_fma_f32 v[56:57], v[88:89], v[40:41], v[64:65] op_sel:[0,0,0] op_sel_hi:[0,1,1]
    v_pk_fma_f32 v[58:59], v[90:91], v[42:43], v[66:67] op_sel:[0,0,0] op_sel_hi:[0,1,1]
    v_pk_fma_f32 v[60:61], v[92:93], v[44:45], v[68:69] op_sel:[0,0,0] op_sel_hi:[0,1,1]
    v_pk_fma_f32 v[62:63], v[94:95], v[46:47], v[70:71] op_sel:[0,0,0] op_sel_hi:[0,1,1]
    v_pk_fma_f32 v[40:41], v[88:89], v[40:41], v[56:57] op_sel:[1,1,0] op_sel_hi:[1,0,1] neg_lo:[1,0,0]
    v_pk_fma_f32 v[42:43], v[90:91], v[42:43], v[58:59] op_sel:[1,1,0] op_sel_hi:[1,0,1] neg_lo:[1,0,0]
    v_pk_fma_f32 v[44:45], v[92:93], v[44:45], v[60:61] op_sel:[1,1,0] op_sel_hi:[1,0,1] neg_lo:[1,0,0]
    v_pk_fma_f32 v[46:47], v[94:95], v[46:47], v[62:63] op_sel:[1,1,0] op_sel_hi:[1,0,1] neg_lo:[1,0,0]
    v_accvgpr_read_b32 v48, a195
    v_accvgpr_read_b32 v50, a199
    v_accvgpr_read_b32 v52, a203
    v_accvgpr_read_b32 v54, a207
    v_accvgpr_read_b32 v49, a211
    v_accvgpr_read_b32 v51, a215
    v_accvgpr_read_b32 v53, a219
    v_accvgpr_read_b32 v55, a223
    v_pk_fma_f32 v[56:57], v[88:89], v[40:41], v[48:49] op_sel:[0,0,0] op_sel_hi:[0,1,1]
    v_pk_fma_f32 v[58:59], v[90:91], v[42:43], v[50:51] op_sel:[0,0,0] op_sel_hi:[0,1,1]
    v_pk_fma_f32 v[60:61], v[92:93], v[44:45], v[52:53] op_sel:[0,0,0] op_sel_hi:[0,1,1]
    v_pk_fma_f32 v[62:63], v[94:95], v[46:47], v[54:55] op_sel:[0,0,0] op_sel_hi:[0,1,1]
    v_pk_fma_f32 v[40:41], v[88:89], v[40:41], v[56:57] op_sel:[1,1,0] op_sel_hi:[1,0,1] neg_lo:[1,0,0]
    v_pk_fma_f32 v[42:43], v[90:91], v[42:43], v[58:59] op_sel:[1,1,0] op_sel_hi:[1,0,1] neg_lo:[1,0,0]
    v_pk_fma_f32 v[44:45], v[92:93], v[44:45], v[60:61] op_sel:[1,1,0] op_sel_hi:[1,0,1] neg_lo:[1,0,0]
    v_pk_fma_f32 v[46:47], v[94:95], v[46:47], v[62:63] op_sel:[1,1,0] op_sel_hi:[1,0,1] neg_lo:[1,0,0]
    v_accvgpr_read_b32 v64, a224
    v_accvgpr_read_b32 v66, a228
    v_accvgpr_read_b32 v68, a232
    v_accvgpr_read_b32 v70, a236
    v_accvgpr_read_b32 v65, a240
    v_accvgpr_read_b32 v67, a244
    v_accvgpr_read_b32 v69, a248
    v_accvgpr_read_b32 v71, a252
    v_pk_fma_f32 v[56:57], v[88:89], v[40:41], v[64:65] op_sel:[0,0,0] op_sel_hi:[0,1,1]
    v_pk_fma_f32 v[58:59], v[90:91], v[42:43], v[66:67] op_sel:[0,0,0] op_sel_hi:[0,1,1]
    v_pk_fma_f32 v[60:61], v[92:93], v[44:45], v[68:69] op_sel:[0,0,0] op_sel_hi:[0,1,1]
    v_pk_fma_f32 v[62:63], v[94:95], v[46:47], v[70:71] op_sel:[0,0,0] op_sel_hi:[0,1,1]
    v_pk_fma_f32 v[40:41], v[88:89], v[40:41], v[56:57] op_sel:[1,1,0] op_sel_hi:[1,0,1] neg_lo:[1,0,0]
    v_pk_fma_f32 v[42:43], v[90:91], v[42:43], v[58:59] op_sel:[1,1,0] op_sel_hi:[1,0,1] neg_lo:[1,0,0]
    v_pk_fma_f32 v[44:45], v[92:93], v[44:45], v[60:61] op_sel:[1,1,0] op_sel_hi:[1,0,1] neg_lo:[1,0,0]
    v_pk_fma_f32 v[46:47], v[94:95], v[46:47], v[62:63] op_sel:[1,1,0] op_sel_hi:[1,0,1] neg_lo:[1,0,0]
    v_accvgpr_read_b32 v48, a225
    v_accvgpr_read_b32 v50, a229
    v_accvgpr_read_b32 v52, a233
    v_accvgpr_read_b32 v54, a237
    v_accvgpr_read_b32 v49, a241
    v_accvgpr_read_b32 v51, a245
    v_accvgpr_read_b32 v53, a249
    v_accvgpr_read_b32 v55, a253
    v_pk_fma_f32 v[56:57], v[88:89], v[40:41], v[48:49] op_sel:[0,0,0] op_sel_hi:[0,1,1]
    v_pk_fma_f32 v[58:59], v[90:91], v[42:43], v[50:51] op_sel:[0,0,0] op_sel_hi:[0,1,1]
    v_pk_fma_f32 v[60:61], v[92:93], v[44:45], v[52:53] op_sel:[0,0,0] op_sel_hi:[0,1,1]
    v_pk_fma_f32 v[62:63], v[94:95], v[46:47], v[54:55] op_sel:[0,0,0] op_sel_hi:[0,1,1]
    v_pk_fma_f32 v[40:41], v[88:89], v[40:41], v[56:57] op_sel:[1,1,0] op_sel_hi:[1,0,1] neg_lo:[1,0,0]
    v_pk_fma_f32 v[42:43], v[90:91], v[42:43], v[58:59] op_sel:[1,1,0] op_sel_hi:[1,0,1] neg_lo:[1,0,0]
    v_pk_fma_f32 v[44:45], v[92:93], v[44:45], v[60:61] op_sel:[1,1,0] op_sel_hi:[1,0,1] neg_lo:[1,0,0]
    v_pk_fma_f32 v[46:47], v[94:95], v[46:47], v[62:63] op_sel:[1,1,0] op_sel_hi:[1,0,1] neg_lo:[1,0,0]
    v_accvgpr_read_b32 v64, a226
    v_accvgpr_read_b32 v66, a230
    v_accvgpr_read_b32 v68, a234
    v_accvgpr_read_b32 v70, a238
    v_accvgpr_read_b32 v65, a242
    v_accvgpr_read_b32 v67, a246
    v_accvgpr_read_b32 v69, a250
    v_accvgpr_read_b32 v71, a254
    v_pk_fma_f32 v[56:57], v[88:89], v[40:41], v[64:65] op_sel:[0,0,0] op_sel_hi:[0,1,1]
    v_pk_fma_f32 v[58:59], v[90:91], v[42:43], v[66:67] op_sel:[0,0,0] op_sel_hi:[0,1,1]
    v_pk_fma_f32 v[60:61], v[92:93], v[44:45], v[68:69] op_sel:[0,0,0] op_sel_hi:[0,1,1]
    v_pk_fma_f32 v[62:63], v[94:95], v[46:47], v[70:71] op_sel:[0,0,0] op_sel_hi:[0,1,1]
    v_pk_fma_f32 v[40:41], v[88:89], v[40:41], v[56:57] op_sel:[1,1,0] op_sel_hi:[1,0,1] neg_lo:[1,0,0]
    v_pk_fma_f32 v[42:43], v[90:91], v[42:43], v[58:59] op_sel:[1,1,0] op_sel_hi:[1,0,1] neg_lo:[1,0,0]
    v_pk_fma_f32 v[44:45], v[92:93], v[44:45], v[60:61] op_sel:[1,1,0] op_sel_hi:[1,0,1] neg_lo:[1,0,0]
    v_pk_fma_f32 v[46:47], v[94:95], v[46:47], v[62:63] op_sel:[1,1,0] op_sel_hi:[1,0,1] neg_lo:[1,0,0]
    v_accvgpr_read_b32 v48, a227
    v_accvgpr_read_b32 v50, a231
    v_accvgpr_read_b32 v52, a235
    v_accvgpr_read_b32 v54, a239
    v_accvgpr_read_b32 v49, a243
    v_accvgpr_read_b32 v51, a247
    v_accvgpr_read_b32 v53, a251
    v_accvgpr_read_b32 v55, a255
    v_pk_fma_f32 v[56:57], v[88:89], v[40:41], v[48:49] op_sel:[0,0,0] op_sel_hi:[0,1,1]
    v_pk_fma_f32 v[58:59], v[90:91], v[42:43], v[50:51] op_sel:[0,0,0] op_sel_hi:[0,1,1]
    v_pk_fma_f32 v[60:61], v[92:93], v[44:45], v[52:53] op_sel:[0,0,0] op_sel_hi:[0,1,1]
    v_pk_fma_f32 v[62:63], v[94:95], v[46:47], v[54:55] op_sel:[0,0,0] op_sel_hi:[0,1,1]
    v_pk_fma_f32 v[40:41], v[88:89], v[40:41], v[56:57] op_sel:[1,1,0] op_sel_hi:[1,0,1] neg_lo:[1,0,0]
    v_pk_fma_f32 v[42:43], v[90:91], v[42:43], v[58:59] op_sel:[1,1,0] op_sel_hi:[1,0,1] neg_lo:[1,0,0]
    v_pk_fma_f32 v[44:45], v[92:93], v[44:45], v[60:61] op_sel:[1,1,0] op_sel_hi:[1,0,1] neg_lo:[1,0,0]
    v_pk_fma_f32 v[46:47], v[94:95], v[46:47], v[62:63] op_sel:[1,1,0] op_sel_hi:[1,0,1] neg_lo:[1,0,0]
    v_mov_b32 v64, v40
    v_mov_b32 v72, v40
    v_mov_b32 v65, v41
    v_mov_b32 v73, v41
    v_mov_b32 v66, v42
    v_mov_b32 v74, v42
    v_mov_b32 v67, v43
    v_mov_b32 v75, v43
    v_mov_b32 v68, v44
    v_mov_b32 v76, v44
    v_mov_b32 v69, v45
    v_mov_b32 v77, v45
    v_mov_b32 v70, v46
    v_mov_b32 v78, v46
    v_mov_b32 v71, v47
    v_mov_b32 v79, v47
    s_nop 1
    v_permlane16_swap_b32 v64, v72
    v_permlane16_swap_b32 v65, v73
    v_permlane16_swap_b32 v66, v74
    v_permlane16_swap_b32 v67, v75
    v_permlane16_swap_b32 v68, v76
    v_permlane16_swap_b32 v69, v77
    v_permlane16_swap_b32 v70, v78
    v_permlane16_swap_b32 v71, v79
    v_pk_fma_f32 v[56:57], v[104:105], v[64:65], v[72:73] op_sel:[0,0,0] op_sel_hi:[0,1,1]
    v_pk_fma_f32 v[58:59], v[106:107], v[66:67], v[74:75] op_sel:[0,0,0] op_sel_hi:[0,1,1]
    v_pk_fma_f32 v[60:61], v[108:109], v[68:69], v[76:77] op_sel:[0,0,0] op_sel_hi:[0,1,1]
    v_pk_fma_f32 v[62:63], v[110:111], v[70:71], v[78:79] op_sel:[0,0,0] op_sel_hi:[0,1,1]
    v_pk_fma_f32 v[80:81], v[104:105], v[64:65], v[56:57] op_sel:[1,1,0] op_sel_hi:[1,0,1] neg_lo:[1,0,0]
    v_pk_fma_f32 v[82:83], v[106:107], v[66:67], v[58:59] op_sel:[1,1,0] op_sel_hi:[1,0,1] neg_lo:[1,0,0]
    v_pk_fma_f32 v[84:85], v[108:109], v[68:69], v[60:61] op_sel:[1,1,0] op_sel_hi:[1,0,1] neg_lo:[1,0,0]
    v_pk_fma_f32 v[86:87], v[110:111], v[70:71], v[62:63] op_sel:[1,1,0] op_sel_hi:[1,0,1] neg_lo:[1,0,0]
    v_mov_b32 v24, v80
    v_mov_b32 v25, v81
    v_mov_b32 v26, v82
    v_mov_b32 v27, v83
    v_mov_b32 v28, v84
    v_mov_b32 v29, v85
    v_mov_b32 v30, v86
    v_mov_b32 v31, v87
    s_nop 1
    v_permlane32_swap_b32 v80, v24
    v_permlane32_swap_b32 v81, v25
    v_permlane32_swap_b32 v82, v26
    v_permlane32_swap_b32 v83, v27
    v_permlane32_swap_b32 v84, v28
    v_permlane32_swap_b32 v85, v29
    v_permlane32_swap_b32 v86, v30
    v_permlane32_swap_b32 v87, v31
    v_pk_fma_f32 v[56:57], v[112:113], v[80:81], v[24:25] op_sel:[0,0,0] op_sel_hi:[0,1,1]
    v_pk_fma_f32 v[58:59], v[114:115], v[82:83], v[26:27] op_sel:[0,0,0] op_sel_hi:[0,1,1]
    v_pk_fma_f32 v[60:61], v[116:117], v[84:85], v[28:29] op_sel:[0,0,0] op_sel_hi:[0,1,1]
    v_pk_fma_f32 v[62:63], v[118:119], v[86:87], v[30:31] op_sel:[0,0,0] op_sel_hi:[0,1,1]
    v_pk_fma_f32 v[40:41], v[112:113], v[80:81], v[56:57] op_sel:[1,1,0] op_sel_hi:[1,0,1] neg_lo:[1,0,0]
    v_pk_fma_f32 v[42:43], v[114:115], v[82:83], v[58:59] op_sel:[1,1,0] op_sel_hi:[1,0,1] neg_lo:[1,0,0]
    v_pk_fma_f32 v[44:45], v[116:117], v[84:85], v[60:61] op_sel:[1,1,0] op_sel_hi:[1,0,1] neg_lo:[1,0,0]
    v_pk_fma_f32 v[46:47], v[118:119], v[86:87], v[62:63] op_sel:[1,1,0] op_sel_hi:[1,0,1] neg_lo:[1,0,0]
    s_mov_b32 exec_lo, 0xffffffff
    s_mov_b32 exec_hi, 0xffffffff
    v_mov_b32 v122, v40
    v_mov_b32 v123, v41
    s_mov_b32 exec_lo, 0xffff0000
    s_mov_b32 exec_hi, 0xffffffff
    v_mov_b32 v122, v42
    v_mov_b32 v123, v43
    s_mov_b32 exec_lo, 0x0
    s_mov_b32 exec_hi, 0xffffffff
    v_mov_b32 v122, v44
    v_mov_b32 v123, v45
    s_mov_b32 exec_lo, 0x0
    s_mov_b32 exec_hi, 0xffff0000
    v_mov_b32 v122, v46
    v_mov_b32 v123, v47
    s_mov_b64 exec, -1
    v_min_u32 v122, 0xfffffffe, v122
    v_min_u32 v123, 0xfffffffe, v123
    s_and_b32 s53, s58, 1
    s_lshl1_add_u32 s53, s85, s53
    s_lshl_b32 s53, s53, 13
    s_lshr_b32 s29, s58, 1
    s_lshl1_add_u32 s29, s82, s29
    s_lshl_b32 s29, s29, 9
    s_add_u32 s53, s53, s29
    v_lshrrev_b32 v124, 1, v1
    v_add_u32 v124, s53, v124
    s_add_u32 s60, s100, 0xb100000
    s_addc_u32 s61, s101, 0
    s_and_b32 s61, s61, 0xffff
    s_mov_b32 s62, 0x20000
    s_mov_b32 s63, 0x00020000
    buffer_store_dwordx2 v[122:123], v124, s[60:63], 0 offen sc1
    v_subrev_u32 v160, 8192, v124
    v_subrev_u32 v161, 16384, v124
    v_subrev_u32 v162, 24576, v124
    v_subrev_u32 v163, 32768, v124
    v_subrev_u32 v164, 40960, v124
    v_subrev_u32 v165, 49152, v124
    v_subrev_u32 v166, 57344, v124
    v_subrev_u32 v167, 65536, v124
    v_subrev_u32 v168, 73728, v124
    v_subrev_u32 v169, 81920, v124
    v_subrev_u32 v170, 90112, v124
    v_subrev_u32 v171, 98304, v124
    v_subrev_u32 v172, 106496, v124
    v_subrev_u32 v173, 114688, v124
    v_subrev_u32 v174, 122880, v124
    s_mov_b32 s53, 0
L_lb_74:
    buffer_load_dwordx2 v[128:129], v160, s[60:63], 0 offen sc1
    buffer_load_dwordx2 v[130:131], v161, s[60:63], 0 offen sc1
    buffer_load_dwordx2 v[132:133], v162, s[60:63], 0 offen sc1
    buffer_load_dwordx2 v[134:135], v163, s[60:63], 0 offen sc1
    buffer_load_dwordx2 v[136:137], v164, s[60:63], 0 offen sc1
    buffer_load_dwordx2 v[138:139], v165, s[60:63], 0 offen sc1
    buffer_load_dwordx2 v[140:141], v166, s[60:63], 0 offen sc1
    buffer_load_dwordx2 v[142:143], v167, s[60:63], 0 offen sc1
    buffer_load_dwordx2 v[144:145], v168, s[60:63], 0 offen sc1
    buffer_load_dwordx2 v[146:147], v169, s[60:63], 0 offen sc1
    buffer_load_dwordx2 v[148:149], v170, s[60:63], 0 offen sc1
    buffer_load_dwordx2 v[150:151], v171, s[60:63], 0 offen sc1
    buffer_load_dwordx2 v[152:153], v172, s[60:63], 0 offen sc1
    buffer_load_dwordx2 v[154:155], v173, s[60:63], 0 offen sc1
    buffer_load_dwordx2 v[156:157], v174, s[60:63], 0 offen sc1
    s_add_u32 s53, s53, 1
    s_cmp_gt_u32 s53, 0x200000
    s_cbranch_scc1 chain_kernel_wabort
    s_waitcnt vmcnt(0)
    v_max_u32 v56, v128, v129
    v_max3_u32 v56, v56, v130, v131
    v_max3_u32 v56, v56, v132, v133
    v_max3_u32 v56, v56, v134, v135
    v_max3_u32 v56, v56, v136, v137
    v_max3_u32 v56, v56, v138, v139
    v_max3_u32 v56, v56, v140, v141
    v_max3_u32 v56, v56, v142, v143
    v_max3_u32 v56, v56, v144, v145
    v_max3_u32 v56, v56, v146, v147
    v_max3_u32 v56, v56, v148, v149
    v_max3_u32 v56, v56, v150, v151
    v_max3_u32 v56, v56, v152, v153
    v_max3_u32 v56, v56, v154, v155
    v_max3_u32 v56, v56, v156, v157
    v_cmp_eq_u32 vcc, -1, v56
    s_cbranch_vccnz L_lb_74
    v_pk_fma_f32 v[56:57], v[120:121], v[156:157], v[154:155] op_sel:[0,0,0] op_sel_hi:[0,1,1]
    v_pk_fma_f32 v[154:155], v[120:121], v[156:157], v[56:57] op_sel:[1,1,0] op_sel_hi:[1,0,1] neg_lo:[1,0,0]
    v_pk_fma_f32 v[56:57], v[120:121], v[154:155], v[152:153] op_sel:[0,0,0] op_sel_hi:[0,1,1]
    v_pk_fma_f32 v[152:153], v[120:121], v[154:155], v[56:57] op_sel:[1,1,0] op_sel_hi:[1,0,1] neg_lo:[1,0,0]
    v_pk_fma_f32 v[56:57], v[120:121], v[152:153], v[150:151] op_sel:[0,0,0] op_sel_hi:[0,1,1]
    v_pk_fma_f32 v[150:151], v[120:121], v[152:153], v[56:57] op_sel:[1,1,0] op_sel_hi:[1,0,1] neg_lo:[1,0,0]
    v_pk_fma_f32 v[56:57], v[120:121], v[150:151], v[148:149] op_sel:[0,0,0] op_sel_hi:[0,1,1]
    v_pk_fma_f32 v[148:149], v[120:121], v[150:151], v[56:57] op_sel:[1,1,0] op_sel_hi:[1,0,1] neg_lo:[1,0,0]
    v_pk_fma_f32 v[56:57], v[120:121], v[148:149], v[146:147] op_sel:[0,0,0] op_sel_hi:[0,1,1]
    v_pk_fma_f32 v[146:147], v[120:121], v[148:149], v[56:57] op_sel:[1,1,0] op_sel_hi:[1,0,1] neg_lo:[1,0,0]
    v_pk_fma_f32 v[56:57], v[120:121], v[146:147], v[144:145] op_sel:[0,0,0] op_sel_hi:[0,1,1]
    v_pk_fma_f32 v[144:145], v[120:121], v[146:147], v[56:57] op_sel:[1,1,0] op_sel_hi:[1,0,1] neg_lo:[1,0,0]
    v_pk_fma_f32 v[56:57], v[120:121], v[144:145], v[142:143] op_sel:[0,0,0] op_sel_hi:[0,1,1]
    v_pk_fma_f32 v[142:143], v[120:121], v[144:145], v[56:57] op_sel:[1,1,0] op_sel_hi:[1,0,1] neg_lo:[1,0,0]
    v_pk_fma_f32 v[56:57], v[120:121], v[142:143], v[140:141] op_sel:[0,0,0] op_sel_hi:[0,1,1]
    v_pk_fma_f32 v[140:141], v[120:121], v[142:143], v[56:57] op_sel:[1,1,0] op_sel_hi:[1,0,1] neg_lo:[1,0,0]
    v_pk_fma_f32 v[56:57], v[120:121], v[140:141], v[138:139] op_sel:[0,0,0] op_sel_hi:[0,1,1]
    v_pk_fma_f32 v[138:139], v[120:121], v[140:141], v[56:57] op_sel:[1,1,0] op_sel_hi:[1,0,1] neg_lo:[1,0,0]
    v_pk_fma_f32 v[56:57], v[120:121], v[138:139], v[136:137] op_sel:[0,0,0] op_sel_hi:[0,1,1]
    v_pk_fma_f32 v[136:137], v[120:121], v[138:139], v[56:57] op_sel:[1,1,0] op_sel_hi:[1,0,1] neg_lo:[1,0,0]
    v_pk_fma_f32 v[56:57], v[120:121], v[136:137], v[134:135] op_sel:[0,0,0] op_sel_hi:[0,1,1]
    v_pk_fma_f32 v[134:135], v[120:121], v[136:137], v[56:57] op_sel:[1,1,0] op_sel_hi:[1,0,1] neg_lo:[1,0,0]
    v_pk_fma_f32 v[56:57], v[120:121], v[134:135], v[132:133] op_sel:[0,0,0] op_sel_hi:[0,1,1]
    v_pk_fma_f32 v[132:133], v[120:121], v[134:135], v[56:57] op_sel:[1,1,0] op_sel_hi:[1,0,1] neg_lo:[1,0,0]
    v_pk_fma_f32 v[56:57], v[120:121], v[132:133], v[130:131] op_sel:[0,0,0] op_sel_hi:[0,1,1]
    v_pk_fma_f32 v[130:131], v[120:121], v[132:133], v[56:57] op_sel:[1,1,0] op_sel_hi:[1,0,1] neg_lo:[1,0,0]
    v_pk_fma_f32 v[56:57], v[120:121], v[130:131], v[128:129] op_sel:[0,0,0] op_sel_hi:[0,1,1]
    v_pk_fma_f32 v[128:129], v[120:121], v[130:131], v[56:57] op_sel:[1,1,0] op_sel_hi:[1,0,1] neg_lo:[1,0,0]
    v_mov_b32 v32, v128
    v_mov_b32 v34, v128
    v_mov_b32 v33, v129
    v_mov_b32 v35, v129
    s_nop 1
    v_permlane16_swap_b32 v32, v34
    v_permlane16_swap_b32 v33, v35
    v_mov_b32 v36, v32
    v_mov_b32 v37, v33
    v_mov_b32 v38, v34
    v_mov_b32 v39, v35
    s_nop 1
    v_permlane32_swap_b32 v32, v36
    v_permlane32_swap_b32 v33, v37
    v_permlane32_swap_b32 v34, v38
    v_permlane32_swap_b32 v35, v39
    s_mov_b32 exec_lo, 0
    v_pk_fma_f32 v[56:57], v[112:113], v[32:33], v[80:81] op_sel:[0,0,0] op_sel_hi:[0,1,1]
    v_pk_fma_f32 v[58:59], v[114:115], v[34:35], v[82:83] op_sel:[0,0,0] op_sel_hi:[0,1,1]
    v_pk_fma_f32 v[60:61], v[116:117], v[36:37], v[84:85] op_sel:[0,0,0] op_sel_hi:[0,1,1]
    v_pk_fma_f32 v[62:63], v[118:119], v[38:39], v[86:87] op_sel:[0,0,0] op_sel_hi:[0,1,1]
    v_pk_fma_f32 v[32:33], v[112:113], v[32:33], v[56:57] op_sel:[1,1,0] op_sel_hi:[1,0,1] neg_lo:[1,0,0]
    v_pk_fma_f32 v[34:35], v[114:115], v[34:35], v[58:59] op_sel:[1,1,0] op_sel_hi:[1,0,1] neg_lo:[1,0,0]
    v_pk_fma_f32 v[36:37], v[116:117], v[36:37], v[60:61] op_sel:[1,1,0] op_sel_hi:[1,0,1] neg_lo:[1,0,0]
    v_pk_fma_f32 v[38:39], v[118:119], v[38:39], v[62:63] op_sel:[1,1,0] op_sel_hi:[1,0,1] neg_lo:[1,0,0]
    s_mov_b32 exec_lo, 0xffff0000
    s_mov_b32 exec_hi, 0xffff0000
    v_pk_fma_f32 v[56:57], v[104:105], v[32:33], v[64:65] op_sel:[0,0,0] op_sel_hi:[0,1,1]
    v_pk_fma_f32 v[58:59], v[106:107], v[34:35], v[66:67] op_sel:[0,0,0] op_sel_hi:[0,1,1]
    v_pk_fma_f32 v[60:61], v[108:109], v[36:37], v[68:69] op_sel:[0,0,0] op_sel_hi:[0,1,1]
    v_pk_fma_f32 v[62:63], v[110:111], v[38:39], v[70:71] op_sel:[0,0,0] op_sel_hi:[0,1,1]
    v_pk_fma_f32 v[32:33], v[104:105], v[32:33], v[56:57] op_sel:[1,1,0] op_sel_hi:[1,0,1] neg_lo:[1,0,0]
    v_pk_fma_f32 v[34:35], v[106:107], v[34:35], v[58:59] op_sel:[1,1,0] op_sel_hi:[1,0,1] neg_lo:[1,0,0]
    v_pk_fma_f32 v[36:37], v[108:109], v[36:37], v[60:61] op_sel:[1,1,0] op_sel_hi:[1,0,1] neg_lo:[1,0,0]
    v_pk_fma_f32 v[38:39], v[110:111], v[38:39], v[62:63] op_sel:[1,1,0] op_sel_hi:[1,0,1] neg_lo:[1,0,0]
    s_mov_b64 exec, -1
    v_accvgpr_read_b32 v64, a0
    v_accvgpr_read_b32 v66, a4
    v_accvgpr_read_b32 v68, a8
    v_accvgpr_read_b32 v70, a12
    v_accvgpr_read_b32 v65, a16
    v_accvgpr_read_b32 v67, a20
    v_accvgpr_read_b32 v69, a24
    v_accvgpr_read_b32 v71, a28
    v_pk_fma_f32 v[56:57], v[88:89], v[32:33], v[64:65] op_sel:[0,0,0] op_sel_hi:[0,1,1]
    v_pk_fma_f32 v[58:59], v[90:91], v[34:35], v[66:67] op_sel:[0,0,0] op_sel_hi:[0,1,1]
    v_pk_fma_f32 v[60:61], v[92:93], v[36:37], v[68:69] op_sel:[0,0,0] op_sel_hi:[0,1,1]
    v_pk_fma_f32 v[62:63], v[94:95], v[38:39], v[70:71] op_sel:[0,0,0] op_sel_hi:[0,1,1]
    v_pk_fma_f32 v[32:33], v[88:89], v[32:33], v[56:57] op_sel:[1,1,0] op_sel_hi:[1,0,1] neg_lo:[1,0,0]
    v_pk_fma_f32 v[34:35], v[90:91], v[34:35], v[58:59] op_sel:[1,1,0] op_sel_hi:[1,0,1] neg_lo:[1,0,0]
    v_pk_fma_f32 v[36:37], v[92:93], v[36:37], v[60:61] op_sel:[1,1,0] op_sel_hi:[1,0,1] neg_lo:[1,0,0]
    v_pk_fma_f32 v[38:39], v[94:95], v[38:39], v[62:63] op_sel:[1,1,0] op_sel_hi:[1,0,1] neg_lo:[1,0,0]
    v_pk_mul_f32 v[40:41], v[96:97], v[32:33] op_sel:[0,0] op_sel_hi:[0,1]
    v_pk_mul_f32 v[42:43], v[98:99], v[34:35] op_sel:[0,0] op_sel_hi:[0,1]
    v_pk_mul_f32 v[44:45], v[100:101], v[36:37] op_sel:[0,0] op_sel_hi:[0,1]
    v_pk_mul_f32 v[46:47], v[102:103], v[38:39] op_sel:[0,0] op_sel_hi:[0,1]
    v_pk_fma_f32 v[72:73], v[96:97], v[32:33], v[40:41] op_sel:[1,1,0] op_sel_hi:[1,0,1] neg_lo:[1,0,0] neg_hi:[1,0,1]
    v_pk_fma_f32 v[74:75], v[98:99], v[34:35], v[42:43] op_sel:[1,1,0] op_sel_hi:[1,0,1] neg_lo:[1,0,0] neg_hi:[1,0,1]
    v_pk_fma_f32 v[76:77], v[100:101], v[36:37], v[44:45] op_sel:[1,1,0] op_sel_hi:[1,0,1] neg_lo:[1,0,0] neg_hi:[1,0,1]
    v_pk_fma_f32 v[78:79], v[102:103], v[38:39], v[46:47] op_sel:[1,1,0] op_sel_hi:[1,0,1] neg_lo:[1,0,0] neg_hi:[1,0,1]
    v_accvgpr_read_b32 v48, a1
    v_accvgpr_read_b32 v50, a5
    v_accvgpr_read_b32 v52, a9
    v_accvgpr_read_b32 v54, a13
    v_accvgpr_read_b32 v49, a17
    v_accvgpr_read_b32 v51, a21
    v_accvgpr_read_b32 v53, a25
    v_accvgpr_read_b32 v55, a29
    v_pk_fma_f32 v[56:57], v[88:89], v[32:33], v[48:49] op_sel:[0,0,0] op_sel_hi:[0,1,1]
    v_pk_fma_f32 v[58:59], v[90:91], v[34:35], v[50:51] op_sel:[0,0,0] op_sel_hi:[0,1,1]
    v_pk_fma_f32 v[60:61], v[92:93], v[36:37], v[52:53] op_sel:[0,0,0] op_sel_hi:[0,1,1]
    v_pk_fma_f32 v[62:63], v[94:95], v[38:39], v[54:55] op_sel:[0,0,0] op_sel_hi:[0,1,1]
    v_pk_fma_f32 v[32:33], v[88:89], v[32:33], v[56:57] op_sel:[1,1,0] op_sel_hi:[1,0,1] neg_lo:[1,0,0]
    v_pk_fma_f32 v[34:35], v[90:91], v[34:35], v[58:59] op_sel:[1,1,0] op_sel_hi:[1,0,1] neg_lo:[1,0,0]
    v_pk_fma_f32 v[36:37], v[92:93], v[36:37], v[60:61] op_sel:[1,1,0] op_sel_hi:[1,0,1] neg_lo:[1,0,0]
    v_pk_fma_f32 v[38:39], v[94:95], v[38:39], v[62:63] op_sel:[1,1,0] op_sel_hi:[1,0,1] neg_lo:[1,0,0]
    v_pk_mul_f32 v[40:41], v[96:97], v[32:33] op_sel:[0,0] op_sel_hi:[0,1]
    v_pk_mul_f32 v[42:43], v[98:99], v[34:35] op_sel:[0,0] op_sel_hi:[0,1]
    v_pk_mul_f32 v[44:45], v[100:101], v[36:37] op_sel:[0,0] op_sel_hi:[0,1]
    v_pk_mul_f32 v[46:47], v[102:103], v[38:39] op_sel:[0,0] op_sel_hi:[0,1]
    v_pk_fma_f32 v[80:81], v[96:97], v[32:33], v[40:41] op_sel:[1,1,0] op_sel_hi:[1,0,1] neg_lo:[1,0,0] neg_hi:[1,0,1]
    v_pk_fma_f32 v[82:83], v[98:99], v[34:35], v[42:43] op_sel:[1,1,0] op_sel_hi:[1,0,1] neg_lo:[1,0,0] neg_hi:[1,0,1]
    v_pk_fma_f32 v[84:85], v[100:101], v[36:37], v[44:45] op_sel:[1,1,0] op_sel_hi:[1,0,1] neg_lo:[1,0,0] neg_hi:[1,0,1]
    v_pk_fma_f32 v[86:87], v[102:103], v[38:39], v[46:47] op_sel:[1,1,0] op_sel_hi:[1,0,1] neg_lo:[1,0,0] neg_hi:[1,0,1]
    v_cvt_pk_bf16_f32 v128, v72, v80
    v_cvt_pk_bf16_f32 v136, v74, v82
    v_cvt_pk_bf16_f32 v144, v76, v84
    v_cvt_pk_bf16_f32 v152, v78, v86
    v_cvt_pk_bf16_f32 v192, v73, v81
    v_cvt_pk_bf16_f32 v200, v75, v83
    v_cvt_pk_bf16_f32 v208, v77, v85
    v_cvt_pk_bf16_f32 v216, v79, v87
    v_accvgpr_read_b32 v64, a2
    v_accvgpr_read_b32 v66, a6
    v_accvgpr_read_b32 v68, a10
    v_accvgpr_read_b32 v70, a14
    v_accvgpr_read_b32 v65, a18
    v_accvgpr_read_b32 v67, a22
    v_accvgpr_read_b32 v69, a26
    v_accvgpr_read_b32 v71, a30
    v_pk_fma_f32 v[56:57], v[88:89], v[32:33], v[64:65] op_sel:[0,0,0] op_sel_hi:[0,1,1]
    v_pk_fma_f32 v[58:59], v[90:91], v[34:35], v[66:67] op_sel:[0,0,0] op_sel_hi:[0,1,1]
    v_pk_fma_f32 v[60:61], v[92:93], v[36:37], v[68:69] op_sel:[0,0,0] op_sel_hi:[0,1,1]
    v_pk_fma_f32 v[62:63], v[94:95], v[38:39], v[70:71] op_sel:[0,0,0] op_sel_hi:[0,1,1]
    v_pk_fma_f32 v[32:33], v[88:89], v[32:33], v[56:57] op_sel:[1,1,0] op_sel_hi:[1,0,1] neg_lo:[1,0,0]
    v_pk_fma_f32 v[34:35], v[90:91], v[34:35], v[58:59] op_sel:[1,1,0] op_sel_hi:[1,0,1] neg_lo:[1,0,0]
    v_pk_fma_f32 v[36:37], v[92:93], v[36:37], v[60:61] op_sel:[1,1,0] op_sel_hi:[1,0,1] neg_lo:[1,0,0]
    v_pk_fma_f32 v[38:39], v[94:95], v[38:39], v[62:63] op_sel:[1,1,0] op_sel_hi:[1,0,1] neg_lo:[1,0,0]
    v_pk_mul_f32 v[40:41], v[96:97], v[32:33] op_sel:[0,0] op_sel_hi:[0,1]
    v_pk_mul_f32 v[42:43], v[98:99], v[34:35] op_sel:[0,0] op_sel_hi:[0,1]
    v_pk_mul_f32 v[44:45], v[100:101], v[36:37] op_sel:[0,0] op_sel_hi:[0,1]
    v_pk_mul_f32 v[46:47], v[102:103], v[38:39] op_sel:[0,0] op_sel_hi:[0,1]
    v_pk_fma_f32 v[72:73], v[96:97], v[32:33], v[40:41] op_sel:[1,1,0] op_sel_hi:[1,0,1] neg_lo:[1,0,0] neg_hi:[1,0,1]
    v_pk_fma_f32 v[74:75], v[98:99], v[34:35], v[42:43] op_sel:[1,1,0] op_sel_hi:[1,0,1] neg_lo:[1,0,0] neg_hi:[1,0,1]
    v_pk_fma_f32 v[76:77], v[100:101], v[36:37], v[44:45] op_sel:[1,1,0] op_sel_hi:[1,0,1] neg_lo:[1,0,0] neg_hi:[1,0,1]
    v_pk_fma_f32 v[78:79], v[102:103], v[38:39], v[46:47] op_sel:[1,1,0] op_sel_hi:[1,0,1] neg_lo:[1,0,0] neg_hi:[1,0,1]
    v_accvgpr_read_b32 v48, a3
    v_accvgpr_read_b32 v50, a7
    v_accvgpr_read_b32 v52, a11
    v_accvgpr_read_b32 v54, a15
    v_accvgpr_read_b32 v49, a19
    v_accvgpr_read_b32 v51, a23
    v_accvgpr_read_b32 v53, a27
    v_accvgpr_read_b32 v55, a31
    v_pk_fma_f32 v[56:57], v[88:89], v[32:33], v[48:49] op_sel:[0,0,0] op_sel_hi:[0,1,1]
    v_pk_fma_f32 v[58:59], v[90:91], v[34:35], v[50:51] op_sel:[0,0,0] op_sel_hi:[0,1,1]
    v_pk_fma_f32 v[60:61], v[92:93], v[36:37], v[52:53] op_sel:[0,0,0] op_sel_hi:[0,1,1]
    v_pk_fma_f32 v[62:63], v[94:95], v[38:39], v[54:55] op_sel:[0,0,0] op_sel_hi:[0,1,1]
    v_pk_fma_f32 v[32:33], v[88:89], v[32:33], v[56:57] op_sel:[1,1,0] op_sel_hi:[1,0,1] neg_lo:[1,0,0]
    v_pk_fma_f32 v[34:35], v[90:91], v[34:35], v[58:59] op_sel:[1,1,0] op_sel_hi:[1,0,1] neg_lo:[1,0,0]
    v_pk_fma_f32 v[36:37], v[92:93], v[36:37], v[60:61] op_sel:[1,1,0] op_sel_hi:[1,0,1] neg_lo:[1,0,0]
    v_pk_fma_f32 v[38:39], v[94:95], v[38:39], v[62:63] op_sel:[1,1,0] op_sel_hi:[1,0,1] neg_lo:[1,0,0]
    v_pk_mul_f32 v[40:41], v[96:97], v[32:33] op_sel:[0,0] op_sel_hi:[0,1]
    v_pk_mul_f32 v[42:43], v[98:99], v[34:35] op_sel:[0,0] op_sel_hi:[0,1]
    v_pk_mul_f32 v[44:45], v[100:101], v[36:37] op_sel:[0,0] op_sel_hi:[0,1]
    v_pk_mul_f32 v[46:47], v[102:103], v[38:39] op_sel:[0,0] op_sel_hi:[0,1]
    v_pk_fma_f32 v[80:81], v[96:97], v[32:33], v[40:41] op_sel:[1,1,0] op_sel_hi:[1,0,1] neg_lo:[1,0,0] neg_hi:[1,0,1]
    v_pk_fma_f32 v[82:83], v[98:99], v[34:35], v[42:43] op_sel:[1,1,0] op_sel_hi:[1,0,1] neg_lo:[1,0,0] neg_hi:[1,0,1]
    v_pk_fma_f32 v[84:85], v[100:101], v[36:37], v[44:45] op_sel:[1,1,0] op_sel_hi:[1,0,1] neg_lo:[1,0,0] neg_hi:[1,0,1]
    v_pk_fma_f32 v[86:87], v[102:103], v[38:39], v[46:47] op_sel:[1,1,0] op_sel_hi:[1,0,1] neg_lo:[1,0,0] neg_hi:[1,0,1]
    v_cvt_pk_bf16_f32 v129, v72, v80
    v_cvt_pk_bf16_f32 v137, v74, v82
    v_cvt_pk_bf16_f32 v145, v76, v84
    v_cvt_pk_bf16_f32 v153, v78, v86
    v_cvt_pk_bf16_f32 v193, v73, v81
    v_cvt_pk_bf16_f32 v201, v75, v83
    v_cvt_pk_bf16_f32 v209, v77, v85
    v_cvt_pk_bf16_f32 v217, v79, v87
    v_accvgpr_read_b32 v64, a32
    v_accvgpr_read_b32 v66, a36
    v_accvgpr_read_b32 v68, a40
    v_accvgpr_read_b32 v70, a44
    v_accvgpr_read_b32 v65, a48
    v_accvgpr_read_b32 v67, a52
    v_accvgpr_read_b32 v69, a56
    v_accvgpr_read_b32 v71, a60
    v_pk_fma_f32 v[56:57], v[88:89], v[32:33], v[64:65] op_sel:[0,0,0] op_sel_hi:[0,1,1]
    v_pk_fma_f32 v[58:59], v[90:91], v[34:35], v[66:67] op_sel:[0,0,0] op_sel_hi:[0,1,1]
    v_pk_fma_f32 v[60:61], v[92:93], v[36:37], v[68:69] op_sel:[0,0,0] op_sel_hi:[0,1,1]
    v_pk_fma_f32 v[62:63], v[94:95], v[38:39], v[70:71] op_sel:[0,0,0] op_sel_hi:[0,1,1]
    v_pk_fma_f32 v[32:33], v[88:89], v[32:33], v[56:57] op_sel:[1,1,0] op_sel_hi:[1,0,1] neg_lo:[1,0,0]
    v_pk_fma_f32 v[34:35], v[90:91], v[34:35], v[58:59] op_sel:[1,1,0] op_sel_hi:[1,0,1] neg_lo:[1,0,0]
    v_pk_fma_f32 v[36:37], v[92:93], v[36:37], v[60:61] op_sel:[1,1,0] op_sel_hi:[1,0,1] neg_lo:[1,0,0]
    v_pk_fma_f32 v[38:39], v[94:95], v[38:39], v[62:63] op_sel:[1,1,0] op_sel_hi:[1,0,1] neg_lo:[1,0,0]
    v_pk_mul_f32 v[40:41], v[96:97], v[32:33] op_sel:[0,0] op_sel_hi:[0,1]
    v_pk_mul_f32 v[42:43], v[98:99], v[34:35] op_sel:[0,0] op_sel_hi:[0,1]
    v_pk_mul_f32 v[44:45], v[100:101], v[36:37] op_sel:[0,0] op_sel_hi:[0,1]
    v_pk_mul_f32 v[46:47], v[102:103], v[38:39] op_sel:[0,0] op_sel_hi:[0,1]
    v_pk_fma_f32 v[72:73], v[96:97], v[32:33], v[40:41] op_sel:[1,1,0] op_sel_hi:[1,0,1] neg_lo:[1,0,0] neg_hi:[1,0,1]
    v_pk_fma_f32 v[74:75], v[98:99], v[34:35], v[42:43] op_sel:[1,1,0] op_sel_hi:[1,0,1] neg_lo:[1,0,0] neg_hi:[1,0,1]
    v_pk_fma_f32 v[76:77], v[100:101], v[36:37], v[44:45] op_sel:[1,1,0] op_sel_hi:[1,0,1] neg_lo:[1,0,0] neg_hi:[1,0,1]
    v_pk_fma_f32 v[78:79], v[102:103], v[38:39], v[46:47] op_sel:[1,1,0] op_sel_hi:[1,0,1] neg_lo:[1,0,0] neg_hi:[1,0,1]
    v_accvgpr_read_b32 v48, a33
    v_accvgpr_read_b32 v50, a37
    v_accvgpr_read_b32 v52, a41
    v_accvgpr_read_b32 v54, a45
    v_accvgpr_read_b32 v49, a49
    v_accvgpr_read_b32 v51, a53
    v_accvgpr_read_b32 v53, a57
    v_accvgpr_read_b32 v55, a61
    v_pk_fma_f32 v[56:57], v[88:89], v[32:33], v[48:49] op_sel:[0,0,0] op_sel_hi:[0,1,1]
    v_pk_fma_f32 v[58:59], v[90:91], v[34:35], v[50:51] op_sel:[0,0,0] op_sel_hi:[0,1,1]
    v_pk_fma_f32 v[60:61], v[92:93], v[36:37], v[52:53] op_sel:[0,0,0] op_sel_hi:[0,1,1]
    v_pk_fma_f32 v[62:63], v[94:95], v[38:39], v[54:55] op_sel:[0,0,0] op_sel_hi:[0,1,1]
    v_pk_fma_f32 v[32:33], v[88:89], v[32:33], v[56:57] op_sel:[1,1,0] op_sel_hi:[1,0,1] neg_lo:[1,0,0]
    v_pk_fma_f32 v[34:35], v[90:91], v[34:35], v[58:59] op_sel:[1,1,0] op_sel_hi:[1,0,1] neg_lo:[1,0,0]
    v_pk_fma_f32 v[36:37], v[92:93], v[36:37], v[60:61] op_sel:[1,1,0] op_sel_hi:[1,0,1] neg_lo:[1,0,0]
    v_pk_fma_f32 v[38:39], v[94:95], v[38:39], v[62:63] op_sel:[1,1,0] op_sel_hi:[1,0,1] neg_lo:[1,0,0]
    v_pk_mul_f32 v[40:41], v[96:97], v[32:33] op_sel:[0,0] op_sel_hi:[0,1]
    v_pk_mul_f32 v[42:43], v[98:99], v[34:35] op_sel:[0,0] op_sel_hi:[0,1]
    v_pk_mul_f32 v[44:45], v[100:101], v[36:37] op_sel:[0,0] op_sel_hi:[0,1]
    v_pk_mul_f32 v[46:47], v[102:103], v[38:39] op_sel:[0,0] op_sel_hi:[0,1]
    v_pk_fma_f32 v[80:81], v[96:97], v[32:33], v[40:41] op_sel:[1,1,0] op_sel_hi:[1,0,1] neg_lo:[1,0,0] neg_hi:[1,0,1]
    v_pk_fma_f32 v[82:83], v[98:99], v[34:35], v[42:43] op_sel:[1,1,0] op_sel_hi:[1,0,1] neg_lo:[1,0,0] neg_hi:[1,0,1]
    v_pk_fma_f32 v[84:85], v[100:101], v[36:37], v[44:45] op_sel:[1,1,0] op_sel_hi:[1,0,1] neg_lo:[1,0,0] neg_hi:[1,0,1]
    v_pk_fma_f32 v[86:87], v[102:103], v[38:39], v[46:47] op_sel:[1,1,0] op_sel_hi:[1,0,1] neg_lo:[1,0,0] neg_hi:[1,0,1]
    v_cvt_pk_bf16_f32 v130, v72, v80
    v_cvt_pk_bf16_f32 v138, v74, v82
    v_cvt_pk_bf16_f32 v146, v76, v84
    v_cvt_pk_bf16_f32 v154, v78, v86
    v_cvt_pk_bf16_f32 v194, v73, v81
    v_cvt_pk_bf16_f32 v202, v75, v83
    v_cvt_pk_bf16_f32 v210, v77, v85
    v_cvt_pk_bf16_f32 v218, v79, v87
    v_accvgpr_read_b32 v64, a34
    v_accvgpr_read_b32 v66, a38
    v_accvgpr_read_b32 v68, a42
    v_accvgpr_read_b32 v70, a46
    v_accvgpr_read_b32 v65, a50
    v_accvgpr_read_b32 v67, a54
    v_accvgpr_read_b32 v69, a58
    v_accvgpr_read_b32 v71, a62
    v_pk_fma_f32 v[56:57], v[88:89], v[32:33], v[64:65] op_sel:[0,0,0] op_sel_hi:[0,1,1]
    v_pk_fma_f32 v[58:59], v[90:91], v[34:35], v[66:67] op_sel:[0,0,0] op_sel_hi:[0,1,1]
    v_pk_fma_f32 v[60:61], v[92:93], v[36:37], v[68:69] op_sel:[0,0,0] op_sel_hi:[0,1,1]
    v_pk_fma_f32 v[62:63], v[94:95], v[38:39], v[70:71] op_sel:[0,0,0] op_sel_hi:[0,1,1]
    v_pk_fma_f32 v[32:33], v[88:89], v[32:33], v[56:57] op_sel:[1,1,0] op_sel_hi:[1,0,1] neg_lo:[1,0,0]
    v_pk_fma_f32 v[34:35], v[90:91], v[34:35], v[58:59] op_sel:[1,1,0] op_sel_hi:[1,0,1] neg_lo:[1,0,0]
    v_pk_fma_f32 v[36:37], v[92:93], v[36:37], v[60:61] op_sel:[1,1,0] op_sel_hi:[1,0,1] neg_lo:[1,0,0]
    v_pk_fma_f32 v[38:39], v[94:95], v[38:39], v[62:63] op_sel:[1,1,0] op_sel_hi:[1,0,1] neg_lo:[1,0,0]
    v_pk_mul_f32 v[40:41], v[96:97], v[32:33] op_sel:[0,0] op_sel_hi:[0,1]
    v_pk_mul_f32 v[42:43], v[98:99], v[34:35] op_sel:[0,0] op_sel_hi:[0,1]
    v_pk_mul_f32 v[44:45], v[100:101], v[36:37] op_sel:[0,0] op_sel_hi:[0,1]
    v_pk_mul_f32 v[46:47], v[102:103], v[38:39] op_sel:[0,0] op_sel_hi:[0,1]
    v_pk_fma_f32 v[72:73], v[96:97], v[32:33], v[40:41] op_sel:[1,1,0] op_sel_hi:[1,0,1] neg_lo:[1,0,0] neg_hi:[1,0,1]
    v_pk_fma_f32 v[74:75], v[98:99], v[34:35], v[42:43] op_sel:[1,1,0] op_sel_hi:[1,0,1] neg_lo:[1,0,0] neg_hi:[1,0,1]
    v_pk_fma_f32 v[76:77], v[100:101], v[36:37], v[44:45] op_sel:[1,1,0] op_sel_hi:[1,0,1] neg_lo:[1,0,0] neg_hi:[1,0,1]
    v_pk_fma_f32 v[78:79], v[102:103], v[38:39], v[46:47] op_sel:[1,1,0] op_sel_hi:[1,0,1] neg_lo:[1,0,0] neg_hi:[1,0,1]
    v_accvgpr_read_b32 v48, a35
    v_accvgpr_read_b32 v50, a39
    v_accvgpr_read_b32 v52, a43
    v_accvgpr_read_b32 v54, a47
    v_accvgpr_read_b32 v49, a51
    v_accvgpr_read_b32 v51, a55
    v_accvgpr_read_b32 v53, a59
    v_accvgpr_read_b32 v55, a63
    v_pk_fma_f32 v[56:57], v[88:89], v[32:33], v[48:49] op_sel:[0,0,0] op_sel_hi:[0,1,1]
    v_pk_fma_f32 v[58:59], v[90:91], v[34:35], v[50:51] op_sel:[0,0,0] op_sel_hi:[0,1,1]
    v_pk_fma_f32 v[60:61], v[92:93], v[36:37], v[52:53] op_sel:[0,0,0] op_sel_hi:[0,1,1]
    v_pk_fma_f32 v[62:63], v[94:95], v[38:39], v[54:55] op_sel:[0,0,0] op_sel_hi:[0,1,1]
    v_pk_fma_f32 v[32:33], v[88:89], v[32:33], v[56:57] op_sel:[1,1,0] op_sel_hi:[1,0,1] neg_lo:[1,0,0]
    v_pk_fma_f32 v[34:35], v[90:91], v[34:35], v[58:59] op_sel:[1,1,0] op_sel_hi:[1,0,1] neg_lo:[1,0,0]
    v_pk_fma_f32 v[36:37], v[92:93], v[36:37], v[60:61] op_sel:[1,1,0] op_sel_hi:[1,0,1] neg_lo:[1,0,0]
    v_pk_fma_f32 v[38:39], v[94:95], v[38:39], v[62:63] op_sel:[1,1,0] op_sel_hi:[1,0,1] neg_lo:[1,0,0]
    v_pk_mul_f32 v[40:41], v[96:97], v[32:33] op_sel:[0,0] op_sel_hi:[0,1]
    v_pk_mul_f32 v[42:43], v[98:99], v[34:35] op_sel:[0,0] op_sel_hi:[0,1]
    v_pk_mul_f32 v[44:45], v[100:101], v[36:37] op_sel:[0,0] op_sel_hi:[0,1]
    v_pk_mul_f32 v[46:47], v[102:103], v[38:39] op_sel:[0,0] op_sel_hi:[0,1]
    v_pk_fma_f32 v[80:81], v[96:97], v[32:33], v[40:41] op_sel:[1,1,0] op_sel_hi:[1,0,1] neg_lo:[1,0,0] neg_hi:[1,0,1]
    v_pk_fma_f32 v[82:83], v[98:99], v[34:35], v[42:43] op_sel:[1,1,0] op_sel_hi:[1,0,1] neg_lo:[1,0,0] neg_hi:[1,0,1]
    v_pk_fma_f32 v[84:85], v[100:101], v[36:37], v[44:45] op_sel:[1,1,0] op_sel_hi:[1,0,1] neg_lo:[1,0,0] neg_hi:[1,0,1]
    v_pk_fma_f32 v[86:87], v[102:103], v[38:39], v[46:47] op_sel:[1,1,0] op_sel_hi:[1,0,1] neg_lo:[1,0,0] neg_hi:[1,0,1]
    v_cvt_pk_bf16_f32 v131, v72, v80
    v_cvt_pk_bf16_f32 v139, v74, v82
    v_cvt_pk_bf16_f32 v147, v76, v84
    v_cvt_pk_bf16_f32 v155, v78, v86
    v_cvt_pk_bf16_f32 v195, v73, v81
    v_cvt_pk_bf16_f32 v203, v75, v83
    v_cvt_pk_bf16_f32 v211, v77, v85
    v_cvt_pk_bf16_f32 v219, v79, v87
    v_accvgpr_read_b32 v64, a64
    v_accvgpr_read_b32 v66, a68
    v_accvgpr_read_b32 v68, a72
    v_accvgpr_read_b32 v70, a76
    v_accvgpr_read_b32 v65, a80
    v_accvgpr_read_b32 v67, a84
    v_accvgpr_read_b32 v69, a88
    v_accvgpr_read_b32 v71, a92
    v_pk_fma_f32 v[56:57], v[88:89], v[32:33], v[64:65] op_sel:[0,0,0] op_sel_hi:[0,1,1]
    v_pk_fma_f32 v[58:59], v[90:91], v[34:35], v[66:67] op_sel:[0,0,0] op_sel_hi:[0,1,1]
    v_pk_fma_f32 v[60:61], v[92:93], v[36:37], v[68:69] op_sel:[0,0,0] op_sel_hi:[0,1,1]
    v_pk_fma_f32 v[62:63], v[94:95], v[38:39], v[70:71] op_sel:[0,0,0] op_sel_hi:[0,1,1]
    v_pk_fma_f32 v[32:33], v[88:89], v[32:33], v[56:57] op_sel:[1,1,0] op_sel_hi:[1,0,1] neg_lo:[1,0,0]
    v_pk_fma_f32 v[34:35], v[90:91], v[34:35], v[58:59] op_sel:[1,1,0] op_sel_hi:[1,0,1] neg_lo:[1,0,0]
    v_pk_fma_f32 v[36:37], v[92:93], v[36:37], v[60:61] op_sel:[1,1,0] op_sel_hi:[1,0,1] neg_lo:[1,0,0]
    v_pk_fma_f32 v[38:39], v[94:95], v[38:39], v[62:63] op_sel:[1,1,0] op_sel_hi:[1,0,1] neg_lo:[1,0,0]
    v_pk_mul_f32 v[40:41], v[96:97], v[32:33] op_sel:[0,0] op_sel_hi:[0,1]
    v_pk_mul_f32 v[42:43], v[98:99], v[34:35] op_sel:[0,0] op_sel_hi:[0,1]
    v_pk_mul_f32 v[44:45], v[100:101], v[36:37] op_sel:[0,0] op_sel_hi:[0,1]
    v_pk_mul_f32 v[46:47], v[102:103], v[38:39] op_sel:[0,0] op_sel_hi:[0,1]
    v_pk_fma_f32 v[72:73], v[96:97], v[32:33], v[40:41] op_sel:[1,1,0] op_sel_hi:[1,0,1] neg_lo:[1,0,0] neg_hi:[1,0,1]
    v_pk_fma_f32 v[74:75], v[98:99], v[34:35], v[42:43] op_sel:[1,1,0] op_sel_hi:[1,0,1] neg_lo:[1,0,0] neg_hi:[1,0,1]
    v_pk_fma_f32 v[76:77], v[100:101], v[36:37], v[44:45] op_sel:[1,1,0] op_sel_hi:[1,0,1] neg_lo:[1,0,0] neg_hi:[1,0,1]
    v_pk_fma_f32 v[78:79], v[102:103], v[38:39], v[46:47] op_sel:[1,1,0] op_sel_hi:[1,0,1] neg_lo:[1,0,0] neg_hi:[1,0,1]
    v_accvgpr_read_b32 v48, a65
    v_accvgpr_read_b32 v50, a69
    v_accvgpr_read_b32 v52, a73
    v_accvgpr_read_b32 v54, a77
    v_accvgpr_read_b32 v49, a81
    v_accvgpr_read_b32 v51, a85
    v_accvgpr_read_b32 v53, a89
    v_accvgpr_read_b32 v55, a93
    v_pk_fma_f32 v[56:57], v[88:89], v[32:33], v[48:49] op_sel:[0,0,0] op_sel_hi:[0,1,1]
    v_pk_fma_f32 v[58:59], v[90:91], v[34:35], v[50:51] op_sel:[0,0,0] op_sel_hi:[0,1,1]
    v_pk_fma_f32 v[60:61], v[92:93], v[36:37], v[52:53] op_sel:[0,0,0] op_sel_hi:[0,1,1]
    v_pk_fma_f32 v[62:63], v[94:95], v[38:39], v[54:55] op_sel:[0,0,0] op_sel_hi:[0,1,1]
    v_pk_fma_f32 v[32:33], v[88:89], v[32:33], v[56:57] op_sel:[1,1,0] op_sel_hi:[1,0,1] neg_lo:[1,0,0]
    v_pk_fma_f32 v[34:35], v[90:91], v[34:35], v[58:59] op_sel:[1,1,0] op_sel_hi:[1,0,1] neg_lo:[1,0,0]
    v_pk_fma_f32 v[36:37], v[92:93], v[36:37], v[60:61] op_sel:[1,1,0] op_sel_hi:[1,0,1] neg_lo:[1,0,0]
    v_pk_fma_f32 v[38:39], v[94:95], v[38:39], v[62:63] op_sel:[1,1,0] op_sel_hi:[1,0,1] neg_lo:[1,0,0]
    v_pk_mul_f32 v[40:41], v[96:97], v[32:33] op_sel:[0,0] op_sel_hi:[0,1]
    v_pk_mul_f32 v[42:43], v[98:99], v[34:35] op_sel:[0,0] op_sel_hi:[0,1]
    v_pk_mul_f32 v[44:45], v[100:101], v[36:37] op_sel:[0,0] op_sel_hi:[0,1]
    v_pk_mul_f32 v[46:47], v[102:103], v[38:39] op_sel:[0,0] op_sel_hi:[0,1]
    v_pk_fma_f32 v[80:81], v[96:97], v[32:33], v[40:41] op_sel:[1,1,0] op_sel_hi:[1,0,1] neg_lo:[1,0,0] neg_hi:[1,0,1]
    v_pk_fma_f32 v[82:83], v[98:99], v[34:35], v[42:43] op_sel:[1,1,0] op_sel_hi:[1,0,1] neg_lo:[1,0,0] neg_hi:[1,0,1]
    v_pk_fma_f32 v[84:85], v[100:101], v[36:37], v[44:45] op_sel:[1,1,0] op_sel_hi:[1,0,1] neg_lo:[1,0,0] neg_hi:[1,0,1]
    v_pk_fma_f32 v[86:87], v[102:103], v[38:39], v[46:47] op_sel:[1,1,0] op_sel_hi:[1,0,1] neg_lo:[1,0,0] neg_hi:[1,0,1]
    v_cvt_pk_bf16_f32 v132, v72, v80
    v_cvt_pk_bf16_f32 v140, v74, v82
    v_cvt_pk_bf16_f32 v148, v76, v84
    v_cvt_pk_bf16_f32 v156, v78, v86
    v_cvt_pk_bf16_f32 v196, v73, v81
    v_cvt_pk_bf16_f32 v204, v75, v83
    v_cvt_pk_bf16_f32 v212, v77, v85
    v_cvt_pk_bf16_f32 v220, v79, v87
    v_accvgpr_read_b32 v64, a66
    v_accvgpr_read_b32 v66, a70
    v_accvgpr_read_b32 v68, a74
    v_accvgpr_read_b32 v70, a78
    v_accvgpr_read_b32 v65, a82
    v_accvgpr_read_b32 v67, a86
    v_accvgpr_read_b32 v69, a90
    v_accvgpr_read_b32 v71, a94
    v_pk_fma_f32 v[56:57], v[88:89], v[32:33], v[64:65] op_sel:[0,0,0] op_sel_hi:[0,1,1]
    v_pk_fma_f32 v[58:59], v[90:91], v[34:35], v[66:67] op_sel:[0,0,0] op_sel_hi:[0,1,1]
    v_pk_fma_f32 v[60:61], v[92:93], v[36:37], v[68:69] op_sel:[0,0,0] op_sel_hi:[0,1,1]
    v_pk_fma_f32 v[62:63], v[94:95], v[38:39], v[70:71] op_sel:[0,0,0] op_sel_hi:[0,1,1]
    v_pk_fma_f32 v[32:33], v[88:89], v[32:33], v[56:57] op_sel:[1,1,0] op_sel_hi:[1,0,1] neg_lo:[1,0,0]
    v_pk_fma_f32 v[34:35], v[90:91], v[34:35], v[58:59] op_sel:[1,1,0] op_sel_hi:[1,0,1] neg_lo:[1,0,0]
    v_pk_fma_f32 v[36:37], v[92:93], v[36:37], v[60:61] op_sel:[1,1,0] op_sel_hi:[1,0,1] neg_lo:[1,0,0]
    v_pk_fma_f32 v[38:39], v[94:95], v[38:39], v[62:63] op_sel:[1,1,0] op_sel_hi:[1,0,1] neg_lo:[1,0,0]
    v_pk_mul_f32 v[40:41], v[96:97], v[32:33] op_sel:[0,0] op_sel_hi:[0,1]
    v_pk_mul_f32 v[42:43], v[98:99], v[34:35] op_sel:[0,0] op_sel_hi:[0,1]
    v_pk_mul_f32 v[44:45], v[100:101], v[36:37] op_sel:[0,0] op_sel_hi:[0,1]
    v_pk_mul_f32 v[46:47], v[102:103], v[38:39] op_sel:[0,0] op_sel_hi:[0,1]
    v_pk_fma_f32 v[72:73], v[96:97], v[32:33], v[40:41] op_sel:[1,1,0] op_sel_hi:[1,0,1] neg_lo:[1,0,0] neg_hi:[1,0,1]
    v_pk_fma_f32 v[74:75], v[98:99], v[34:35], v[42:43] op_sel:[1,1,0] op_sel_hi:[1,0,1] neg_lo:[1,0,0] neg_hi:[1,0,1]
    v_pk_fma_f32 v[76:77], v[100:101], v[36:37], v[44:45] op_sel:[1,1,0] op_sel_hi:[1,0,1] neg_lo:[1,0,0] neg_hi:[1,0,1]
    v_pk_fma_f32 v[78:79], v[102:103], v[38:39], v[46:47] op_sel:[1,1,0] op_sel_hi:[1,0,1] neg_lo:[1,0,0] neg_hi:[1,0,1]
    v_accvgpr_read_b32 v48, a67
    v_accvgpr_read_b32 v50, a71
    v_accvgpr_read_b32 v52, a75
    v_accvgpr_read_b32 v54, a79
    v_accvgpr_read_b32 v49, a83
    v_accvgpr_read_b32 v51, a87
    v_accvgpr_read_b32 v53, a91
    v_accvgpr_read_b32 v55, a95
    v_pk_fma_f32 v[56:57], v[88:89], v[32:33], v[48:49] op_sel:[0,0,0] op_sel_hi:[0,1,1]
    v_pk_fma_f32 v[58:59], v[90:91], v[34:35], v[50:51] op_sel:[0,0,0] op_sel_hi:[0,1,1]
    v_pk_fma_f32 v[60:61], v[92:93], v[36:37], v[52:53] op_sel:[0,0,0] op_sel_hi:[0,1,1]
    v_pk_fma_f32 v[62:63], v[94:95], v[38:39], v[54:55] op_sel:[0,0,0] op_sel_hi:[0,1,1]
    v_pk_fma_f32 v[32:33], v[88:89], v[32:33], v[56:57] op_sel:[1,1,0] op_sel_hi:[1,0,1] neg_lo:[1,0,0]
    v_pk_fma_f32 v[34:35], v[90:91], v[34:35], v[58:59] op_sel:[1,1,0] op_sel_hi:[1,0,1] neg_lo:[1,0,0]
    v_pk_fma_f32 v[36:37], v[92:93], v[36:37], v[60:61] op_sel:[1,1,0] op_sel_hi:[1,0,1] neg_lo:[1,0,0]
    v_pk_fma_f32 v[38:39], v[94:95], v[38:39], v[62:63] op_sel:[1,1,0] op_sel_hi:[1,0,1] neg_lo:[1,0,0]
    v_pk_mul_f32 v[40:41], v[96:97], v[32:33] op_sel:[0,0] op_sel_hi:[0,1]
    v_pk_mul_f32 v[42:43], v[98:99], v[34:35] op_sel:[0,0] op_sel_hi:[0,1]
    v_pk_mul_f32 v[44:45], v[100:101], v[36:37] op_sel:[0,0] op_sel_hi:[0,1]
    v_pk_mul_f32 v[46:47], v[102:103], v[38:39] op_sel:[0,0] op_sel_hi:[0,1]
    v_pk_fma_f32 v[80:81], v[96:97], v[32:33], v[40:41] op_sel:[1,1,0] op_sel_hi:[1,0,1] neg_lo:[1,0,0] neg_hi:[1,0,1]
    v_pk_fma_f32 v[82:83], v[98:99], v[34:35], v[42:43] op_sel:[1,1,0] op_sel_hi:[1,0,1] neg_lo:[1,0,0] neg_hi:[1,0,1]
    v_pk_fma_f32 v[84:85], v[100:101], v[36:37], v[44:45] op_sel:[1,1,0] op_sel_hi:[1,0,1] neg_lo:[1,0,0] neg_hi:[1,0,1]
    v_pk_fma_f32 v[86:87], v[102:103], v[38:39], v[46:47] op_sel:[1,1,0] op_sel_hi:[1,0,1] neg_lo:[1,0,0] neg_hi:[1,0,1]
    v_cvt_pk_bf16_f32 v133, v72, v80
    v_cvt_pk_bf16_f32 v141, v74, v82
    v_cvt_pk_bf16_f32 v149, v76, v84
    v_cvt_pk_bf16_f32 v157, v78, v86
    v_cvt_pk_bf16_f32 v197, v73, v81
    v_cvt_pk_bf16_f32 v205, v75, v83
    v_cvt_pk_bf16_f32 v213, v77, v85
    v_cvt_pk_bf16_f32 v221, v79, v87
    v_accvgpr_read_b32 v64, a96
    v_accvgpr_read_b32 v66, a100
    v_accvgpr_read_b32 v68, a104
    v_accvgpr_read_b32 v70, a108
    v_accvgpr_read_b32 v65, a112
    v_accvgpr_read_b32 v67, a116
    v_accvgpr_read_b32 v69, a120
    v_accvgpr_read_b32 v71, a124
    v_pk_fma_f32 v[56:57], v[88:89], v[32:33], v[64:65] op_sel:[0,0,0] op_sel_hi:[0,1,1]
    v_pk_fma_f32 v[58:59], v[90:91], v[34:35], v[66:67] op_sel:[0,0,0] op_sel_hi:[0,1,1]
    v_pk_fma_f32 v[60:61], v[92:93], v[36:37], v[68:69] op_sel:[0,0,0] op_sel_hi:[0,1,1]
    v_pk_fma_f32 v[62:63], v[94:95], v[38:39], v[70:71] op_sel:[0,0,0] op_sel_hi:[0,1,1]
    v_pk_fma_f32 v[32:33], v[88:89], v[32:33], v[56:57] op_sel:[1,1,0] op_sel_hi:[1,0,1] neg_lo:[1,0,0]
    v_pk_fma_f32 v[34:35], v[90:91], v[34:35], v[58:59] op_sel:[1,1,0] op_sel_hi:[1,0,1] neg_lo:[1,0,0]
    v_pk_fma_f32 v[36:37], v[92:93], v[36:37], v[60:61] op_sel:[1,1,0] op_sel_hi:[1,0,1] neg_lo:[1,0,0]
    v_pk_fma_f32 v[38:39], v[94:95], v[38:39], v[62:63] op_sel:[1,1,0] op_sel_hi:[1,0,1] neg_lo:[1,0,0]
    v_pk_mul_f32 v[40:41], v[96:97], v[32:33] op_sel:[0,0] op_sel_hi:[0,1]
    v_pk_mul_f32 v[42:43], v[98:99], v[34:35] op_sel:[0,0] op_sel_hi:[0,1]
    v_pk_mul_f32 v[44:45], v[100:101], v[36:37] op_sel:[0,0] op_sel_hi:[0,1]
    v_pk_mul_f32 v[46:47], v[102:103], v[38:39] op_sel:[0,0] op_sel_hi:[0,1]
    v_pk_fma_f32 v[72:73], v[96:97], v[32:33], v[40:41] op_sel:[1,1,0] op_sel_hi:[1,0,1] neg_lo:[1,0,0] neg_hi:[1,0,1]
    v_pk_fma_f32 v[74:75], v[98:99], v[34:35], v[42:43] op_sel:[1,1,0] op_sel_hi:[1,0,1] neg_lo:[1,0,0] neg_hi:[1,0,1]
    v_pk_fma_f32 v[76:77], v[100:101], v[36:37], v[44:45] op_sel:[1,1,0] op_sel_hi:[1,0,1] neg_lo:[1,0,0] neg_hi:[1,0,1]
    v_pk_fma_f32 v[78:79], v[102:103], v[38:39], v[46:47] op_sel:[1,1,0] op_sel_hi:[1,0,1] neg_lo:[1,0,0] neg_hi:[1,0,1]
    v_accvgpr_read_b32 v48, a97
    v_accvgpr_read_b32 v50, a101
    v_accvgpr_read_b32 v52, a105
    v_accvgpr_read_b32 v54, a109
    v_accvgpr_read_b32 v49, a113
    v_accvgpr_read_b32 v51, a117
    v_accvgpr_read_b32 v53, a121
    v_accvgpr_read_b32 v55, a125
    v_pk_fma_f32 v[56:57], v[88:89], v[32:33], v[48:49] op_sel:[0,0,0] op_sel_hi:[0,1,1]
    v_pk_fma_f32 v[58:59], v[90:91], v[34:35], v[50:51] op_sel:[0,0,0] op_sel_hi:[0,1,1]
    v_pk_fma_f32 v[60:61], v[92:93], v[36:37], v[52:53] op_sel:[0,0,0] op_sel_hi:[0,1,1]
    v_pk_fma_f32 v[62:63], v[94:95], v[38:39], v[54:55] op_sel:[0,0,0] op_sel_hi:[0,1,1]
    v_pk_fma_f32 v[32:33], v[88:89], v[32:33], v[56:57] op_sel:[1,1,0] op_sel_hi:[1,0,1] neg_lo:[1,0,0]
    v_pk_fma_f32 v[34:35], v[90:91], v[34:35], v[58:59] op_sel:[1,1,0] op_sel_hi:[1,0,1] neg_lo:[1,0,0]
    v_pk_fma_f32 v[36:37], v[92:93], v[36:37], v[60:61] op_sel:[1,1,0] op_sel_hi:[1,0,1] neg_lo:[1,0,0]
    v_pk_fma_f32 v[38:39], v[94:95], v[38:39], v[62:63] op_sel:[1,1,0] op_sel_hi:[1,0,1] neg_lo:[1,0,0]
    v_pk_mul_f32 v[40:41], v[96:97], v[32:33] op_sel:[0,0] op_sel_hi:[0,1]
    v_pk_mul_f32 v[42:43], v[98:99], v[34:35] op_sel:[0,0] op_sel_hi:[0,1]
    v_pk_mul_f32 v[44:45], v[100:101], v[36:37] op_sel:[0,0] op_sel_hi:[0,1]
    v_pk_mul_f32 v[46:47], v[102:103], v[38:39] op_sel:[0,0] op_sel_hi:[0,1]
    v_pk_fma_f32 v[80:81], v[96:97], v[32:33], v[40:41] op_sel:[1,1,0] op_sel_hi:[1,0,1] neg_lo:[1,0,0] neg_hi:[1,0,1]
    v_pk_fma_f32 v[82:83], v[98:99], v[34:35], v[42:43] op_sel:[1,1,0] op_sel_hi:[1,0,1] neg_lo:[1,0,0] neg_hi:[1,0,1]
    v_pk_fma_f32 v[84:85], v[100:101], v[36:37], v[44:45] op_sel:[1,1,0] op_sel_hi:[1,0,1] neg_lo:[1,0,0] neg_hi:[1,0,1]
    v_pk_fma_f32 v[86:87], v[102:103], v[38:39], v[46:47] op_sel:[1,1,0] op_sel_hi:[1,0,1] neg_lo:[1,0,0] neg_hi:[1,0,1]
    v_cvt_pk_bf16_f32 v134, v72, v80
    v_cvt_pk_bf16_f32 v142, v74, v82
    v_cvt_pk_bf16_f32 v150, v76, v84
    v_cvt_pk_bf16_f32 v158, v78, v86
    v_cvt_pk_bf16_f32 v198, v73, v81
    v_cvt_pk_bf16_f32 v206, v75, v83
    v_cvt_pk_bf16_f32 v214, v77, v85
    v_cvt_pk_bf16_f32 v222, v79, v87
    v_accvgpr_read_b32 v64, a98
    v_accvgpr_read_b32 v66, a102
    v_accvgpr_read_b32 v68, a106
    v_accvgpr_read_b32 v70, a110
    v_accvgpr_read_b32 v65, a114
    v_accvgpr_read_b32 v67, a118
    v_accvgpr_read_b32 v69, a122
    v_accvgpr_read_b32 v71, a126
    v_pk_fma_f32 v[56:57], v[88:89], v[32:33], v[64:65] op_sel:[0,0,0] op_sel_hi:[0,1,1]
    v_pk_fma_f32 v[58:59], v[90:91], v[34:35], v[66:67] op_sel:[0,0,0] op_sel_hi:[0,1,1]
    v_pk_fma_f32 v[60:61], v[92:93], v[36:37], v[68:69] op_sel:[0,0,0] op_sel_hi:[0,1,1]
    v_pk_fma_f32 v[62:63], v[94:95], v[38:39], v[70:71] op_sel:[0,0,0] op_sel_hi:[0,1,1]
    v_pk_fma_f32 v[32:33], v[88:89], v[32:33], v[56:57] op_sel:[1,1,0] op_sel_hi:[1,0,1] neg_lo:[1,0,0]
    v_pk_fma_f32 v[34:35], v[90:91], v[34:35], v[58:59] op_sel:[1,1,0] op_sel_hi:[1,0,1] neg_lo:[1,0,0]
    v_pk_fma_f32 v[36:37], v[92:93], v[36:37], v[60:61] op_sel:[1,1,0] op_sel_hi:[1,0,1] neg_lo:[1,0,0]
    v_pk_fma_f32 v[38:39], v[94:95], v[38:39], v[62:63] op_sel:[1,1,0] op_sel_hi:[1,0,1] neg_lo:[1,0,0]
    v_pk_mul_f32 v[40:41], v[96:97], v[32:33] op_sel:[0,0] op_sel_hi:[0,1]
    v_pk_mul_f32 v[42:43], v[98:99], v[34:35] op_sel:[0,0] op_sel_hi:[0,1]
    v_pk_mul_f32 v[44:45], v[100:101], v[36:37] op_sel:[0,0] op_sel_hi:[0,1]
    v_pk_mul_f32 v[46:47], v[102:103], v[38:39] op_sel:[0,0] op_sel_hi:[0,1]
    v_pk_fma_f32 v[72:73], v[96:97], v[32:33], v[40:41] op_sel:[1,1,0] op_sel_hi:[1,0,1] neg_lo:[1,0,0] neg_hi:[1,0,1]
    v_pk_fma_f32 v[74:75], v[98:99], v[34:35], v[42:43] op_sel:[1,1,0] op_sel_hi:[1,0,1] neg_lo:[1,0,0] neg_hi:[1,0,1]
    v_pk_fma_f32 v[76:77], v[100:101], v[36:37], v[44:45] op_sel:[1,1,0] op_sel_hi:[1,0,1] neg_lo:[1,0,0] neg_hi:[1,0,1]
    v_pk_fma_f32 v[78:79], v[102:103], v[38:39], v[46:47] op_sel:[1,1,0] op_sel_hi:[1,0,1] neg_lo:[1,0,0] neg_hi:[1,0,1]
    v_accvgpr_read_b32 v48, a99
    v_accvgpr_read_b32 v50, a103
    v_accvgpr_read_b32 v52, a107
    v_accvgpr_read_b32 v54, a111
    v_accvgpr_read_b32 v49, a115
    v_accvgpr_read_b32 v51, a119
    v_accvgpr_read_b32 v53, a123
    v_accvgpr_read_b32 v55, a127
    v_pk_fma_f32 v[56:57], v[88:89], v[32:33], v[48:49] op_sel:[0,0,0] op_sel_hi:[0,1,1]
    v_pk_fma_f32 v[58:59], v[90:91], v[34:35], v[50:51] op_sel:[0,0,0] op_sel_hi:[0,1,1]
    v_pk_fma_f32 v[60:61], v[92:93], v[36:37], v[52:53] op_sel:[0,0,0] op_sel_hi:[0,1,1]
    v_pk_fma_f32 v[62:63], v[94:95], v[38:39], v[54:55] op_sel:[0,0,0] op_sel_hi:[0,1,1]
    v_pk_fma_f32 v[32:33], v[88:89], v[32:33], v[56:57] op_sel:[1,1,0] op_sel_hi:[1,0,1] neg_lo:[1,0,0]
    v_pk_fma_f32 v[34:35], v[90:91], v[34:35], v[58:59] op_sel:[1,1,0] op_sel_hi:[1,0,1] neg_lo:[1,0,0]
    v_pk_fma_f32 v[36:37], v[92:93], v[36:37], v[60:61] op_sel:[1,1,0] op_sel_hi:[1,0,1] neg_lo:[1,0,0]
    v_pk_fma_f32 v[38:39], v[94:95], v[38:39], v[62:63] op_sel:[1,1,0] op_sel_hi:[1,0,1] neg_lo:[1,0,0]
    v_pk_mul_f32 v[40:41], v[96:97], v[32:33] op_sel:[0,0] op_sel_hi:[0,1]
    v_pk_mul_f32 v[42:43], v[98:99], v[34:35] op_sel:[0,0] op_sel_hi:[0,1]
    v_pk_mul_f32 v[44:45], v[100:101], v[36:37] op_sel:[0,0] op_sel_hi:[0,1]
    v_pk_mul_f32 v[46:47], v[102:103], v[38:39] op_sel:[0,0] op_sel_hi:[0,1]
    v_pk_fma_f32 v[80:81], v[96:97], v[32:33], v[40:41] op_sel:[1,1,0] op_sel_hi:[1,0,1] neg_lo:[1,0,0] neg_hi:[1,0,1]
    v_pk_fma_f32 v[82:83], v[98:99], v[34:35], v[42:43] op_sel:[1,1,0] op_sel_hi:[1,0,1] neg_lo:[1,0,0] neg_hi:[1,0,1]
    v_pk_fma_f32 v[84:85], v[100:101], v[36:37], v[44:45] op_sel:[1,1,0] op_sel_hi:[1,0,1] neg_lo:[1,0,0] neg_hi:[1,0,1]
    v_pk_fma_f32 v[86:87], v[102:103], v[38:39], v[46:47] op_sel:[1,1,0] op_sel_hi:[1,0,1] neg_lo:[1,0,0] neg_hi:[1,0,1]
    v_cvt_pk_bf16_f32 v135, v72, v80
    v_cvt_pk_bf16_f32 v143, v74, v82
    v_cvt_pk_bf16_f32 v151, v76, v84
    v_cvt_pk_bf16_f32 v159, v78, v86
    v_cvt_pk_bf16_f32 v199, v73, v81
    v_cvt_pk_bf16_f32 v207, v75, v83
    v_cvt_pk_bf16_f32 v215, v77, v85
    v_cvt_pk_bf16_f32 v223, v79, v87
    v_accvgpr_read_b32 v64, a128
    v_accvgpr_read_b32 v66, a132
    v_accvgpr_read_b32 v68, a136
    v_accvgpr_read_b32 v70, a140
    v_accvgpr_read_b32 v65, a144
    v_accvgpr_read_b32 v67, a148
    v_accvgpr_read_b32 v69, a152
    v_accvgpr_read_b32 v71, a156
    v_pk_fma_f32 v[56:57], v[88:89], v[32:33], v[64:65] op_sel:[0,0,0] op_sel_hi:[0,1,1]
    v_pk_fma_f32 v[58:59], v[90:91], v[34:35], v[66:67] op_sel:[0,0,0] op_sel_hi:[0,1,1]
    v_pk_fma_f32 v[60:61], v[92:93], v[36:37], v[68:69] op_sel:[0,0,0] op_sel_hi:[0,1,1]
    v_pk_fma_f32 v[62:63], v[94:95], v[38:39], v[70:71] op_sel:[0,0,0] op_sel_hi:[0,1,1]
    v_pk_fma_f32 v[32:33], v[88:89], v[32:33], v[56:57] op_sel:[1,1,0] op_sel_hi:[1,0,1] neg_lo:[1,0,0]
    v_pk_fma_f32 v[34:35], v[90:91], v[34:35], v[58:59] op_sel:[1,1,0] op_sel_hi:[1,0,1] neg_lo:[1,0,0]
    v_pk_fma_f32 v[36:37], v[92:93], v[36:37], v[60:61] op_sel:[1,1,0] op_sel_hi:[1,0,1] neg_lo:[1,0,0]
    v_pk_fma_f32 v[38:39], v[94:95], v[38:39], v[62:63] op_sel:[1,1,0] op_sel_hi:[1,0,1] neg_lo:[1,0,0]
    v_pk_mul_f32 v[40:41], v[96:97], v[32:33] op_sel:[0,0] op_sel_hi:[0,1]
    v_pk_mul_f32 v[42:43], v[98:99], v[34:35] op_sel:[0,0] op_sel_hi:[0,1]
    v_pk_mul_f32 v[44:45], v[100:101], v[36:37] op_sel:[0,0] op_sel_hi:[0,1]
    v_pk_mul_f32 v[46:47], v[102:103], v[38:39] op_sel:[0,0] op_sel_hi:[0,1]
    v_pk_fma_f32 v[72:73], v[96:97], v[32:33], v[40:41] op_sel:[1,1,0] op_sel_hi:[1,0,1] neg_lo:[1,0,0] neg_hi:[1,0,1]
    v_pk_fma_f32 v[74:75], v[98:99], v[34:35], v[42:43] op_sel:[1,1,0] op_sel_hi:[1,0,1] neg_lo:[1,0,0] neg_hi:[1,0,1]
    v_pk_fma_f32 v[76:77], v[100:101], v[36:37], v[44:45] op_sel:[1,1,0] op_sel_hi:[1,0,1] neg_lo:[1,0,0] neg_hi:[1,0,1]
    v_pk_fma_f32 v[78:79], v[102:103], v[38:39], v[46:47] op_sel:[1,1,0] op_sel_hi:[1,0,1] neg_lo:[1,0,0] neg_hi:[1,0,1]
    v_accvgpr_read_b32 v48, a129
    v_accvgpr_read_b32 v50, a133
    v_accvgpr_read_b32 v52, a137
    v_accvgpr_read_b32 v54, a141
    v_accvgpr_read_b32 v49, a145
    v_accvgpr_read_b32 v51, a149
    v_accvgpr_read_b32 v53, a153
    v_accvgpr_read_b32 v55, a157
    v_pk_fma_f32 v[56:57], v[88:89], v[32:33], v[48:49] op_sel:[0,0,0] op_sel_hi:[0,1,1]
    v_pk_fma_f32 v[58:59], v[90:91], v[34:35], v[50:51] op_sel:[0,0,0] op_sel_hi:[0,1,1]
    v_pk_fma_f32 v[60:61], v[92:93], v[36:37], v[52:53] op_sel:[0,0,0] op_sel_hi:[0,1,1]
    v_pk_fma_f32 v[62:63], v[94:95], v[38:39], v[54:55] op_sel:[0,0,0] op_sel_hi:[0,1,1]
    v_pk_fma_f32 v[32:33], v[88:89], v[32:33], v[56:57] op_sel:[1,1,0] op_sel_hi:[1,0,1] neg_lo:[1,0,0]
    v_pk_fma_f32 v[34:35], v[90:91], v[34:35], v[58:59] op_sel:[1,1,0] op_sel_hi:[1,0,1] neg_lo:[1,0,0]
    v_pk_fma_f32 v[36:37], v[92:93], v[36:37], v[60:61] op_sel:[1,1,0] op_sel_hi:[1,0,1] neg_lo:[1,0,0]
    v_pk_fma_f32 v[38:39], v[94:95], v[38:39], v[62:63] op_sel:[1,1,0] op_sel_hi:[1,0,1] neg_lo:[1,0,0]
    v_pk_mul_f32 v[40:41], v[96:97], v[32:33] op_sel:[0,0] op_sel_hi:[0,1]
    v_pk_mul_f32 v[42:43], v[98:99], v[34:35] op_sel:[0,0] op_sel_hi:[0,1]
    v_pk_mul_f32 v[44:45], v[100:101], v[36:37] op_sel:[0,0] op_sel_hi:[0,1]
    v_pk_mul_f32 v[46:47], v[102:103], v[38:39] op_sel:[0,0] op_sel_hi:[0,1]
    v_pk_fma_f32 v[80:81], v[96:97], v[32:33], v[40:41] op_sel:[1,1,0] op_sel_hi:[1,0,1] neg_lo:[1,0,0] neg_hi:[1,0,1]
    v_pk_fma_f32 v[82:83], v[98:99], v[34:35], v[42:43] op_sel:[1,1,0] op_sel_hi:[1,0,1] neg_lo:[1,0,0] neg_hi:[1,0,1]
    v_pk_fma_f32 v[84:85], v[100:101], v[36:37], v[44:45] op_sel:[1,1,0] op_sel_hi:[1,0,1] neg_lo:[1,0,0] neg_hi:[1,0,1]
    v_pk_fma_f32 v[86:87], v[102:103], v[38:39], v[46:47] op_sel:[1,1,0] op_sel_hi:[1,0,1] neg_lo:[1,0,0] neg_hi:[1,0,1]
    v_cvt_pk_bf16_f32 v160, v72, v80
    v_cvt_pk_bf16_f32 v168, v74, v82
    v_cvt_pk_bf16_f32 v176, v76, v84
    v_cvt_pk_bf16_f32 v184, v78, v86
    v_cvt_pk_bf16_f32 v224, v73, v81
    v_cvt_pk_bf16_f32 v232, v75, v83
    v_cvt_pk_bf16_f32 v240, v77, v85
    v_cvt_pk_bf16_f32 v248, v79, v87
    v_accvgpr_read_b32 v64, a130
    v_accvgpr_read_b32 v66, a134
    v_accvgpr_read_b32 v68, a138
    v_accvgpr_read_b32 v70, a142
    v_accvgpr_read_b32 v65, a146
    v_accvgpr_read_b32 v67, a150
    v_accvgpr_read_b32 v69, a154
    v_accvgpr_read_b32 v71, a158
    v_pk_fma_f32 v[56:57], v[88:89], v[32:33], v[64:65] op_sel:[0,0,0] op_sel_hi:[0,1,1]
    v_pk_fma_f32 v[58:59], v[90:91], v[34:35], v[66:67] op_sel:[0,0,0] op_sel_hi:[0,1,1]
    v_pk_fma_f32 v[60:61], v[92:93], v[36:37], v[68:69] op_sel:[0,0,0] op_sel_hi:[0,1,1]
    v_pk_fma_f32 v[62:63], v[94:95], v[38:39], v[70:71] op_sel:[0,0,0] op_sel_hi:[0,1,1]
    v_pk_fma_f32 v[32:33], v[88:89], v[32:33], v[56:57] op_sel:[1,1,0] op_sel_hi:[1,0,1] neg_lo:[1,0,0]
    v_pk_fma_f32 v[34:35], v[90:91], v[34:35], v[58:59] op_sel:[1,1,0] op_sel_hi:[1,0,1] neg_lo:[1,0,0]
    v_pk_fma_f32 v[36:37], v[92:93], v[36:37], v[60:61] op_sel:[1,1,0] op_sel_hi:[1,0,1] neg_lo:[1,0,0]
    v_pk_fma_f32 v[38:39], v[94:95], v[38:39], v[62:63] op_sel:[1,1,0] op_sel_hi:[1,0,1] neg_lo:[1,0,0]
    v_pk_mul_f32 v[40:41], v[96:97], v[32:33] op_sel:[0,0] op_sel_hi:[0,1]
    v_pk_mul_f32 v[42:43], v[98:99], v[34:35] op_sel:[0,0] op_sel_hi:[0,1]
    v_pk_mul_f32 v[44:45], v[100:101], v[36:37] op_sel:[0,0] op_sel_hi:[0,1]
    v_pk_mul_f32 v[46:47], v[102:103], v[38:39] op_sel:[0,0] op_sel_hi:[0,1]
    v_pk_fma_f32 v[72:73], v[96:97], v[32:33], v[40:41] op_sel:[1,1,0] op_sel_hi:[1,0,1] neg_lo:[1,0,0] neg_hi:[1,0,1]
    v_pk_fma_f32 v[74:75], v[98:99], v[34:35], v[42:43] op_sel:[1,1,0] op_sel_hi:[1,0,1] neg_lo:[1,0,0] neg_hi:[1,0,1]
    v_pk_fma_f32 v[76:77], v[100:101], v[36:37], v[44:45] op_sel:[1,1,0] op_sel_hi:[1,0,1] neg_lo:[1,0,0] neg_hi:[1,0,1]
    v_pk_fma_f32 v[78:79], v[102:103], v[38:39], v[46:47] op_sel:[1,1,0] op_sel_hi:[1,0,1] neg_lo:[1,0,0] neg_hi:[1,0,1]
    v_accvgpr_read_b32 v48, a131
    v_accvgpr_read_b32 v50, a135
    v_accvgpr_read_b32 v52, a139
    v_accvgpr_read_b32 v54, a143
    v_accvgpr_read_b32 v49, a147
    v_accvgpr_read_b32 v51, a151
    v_accvgpr_read_b32 v53, a155
    v_accvgpr_read_b32 v55, a159
    v_pk_fma_f32 v[56:57], v[88:89], v[32:33], v[48:49] op_sel:[0,0,0] op_sel_hi:[0,1,1]
    v_pk_fma_f32 v[58:59], v[90:91], v[34:35], v[50:51] op_sel:[0,0,0] op_sel_hi:[0,1,1]
    v_pk_fma_f32 v[60:61], v[92:93], v[36:37], v[52:53] op_sel:[0,0,0] op_sel_hi:[0,1,1]
    v_pk_fma_f32 v[62:63], v[94:95], v[38:39], v[54:55] op_sel:[0,0,0] op_sel_hi:[0,1,1]
    v_pk_fma_f32 v[32:33], v[88:89], v[32:33], v[56:57] op_sel:[1,1,0] op_sel_hi:[1,0,1] neg_lo:[1,0,0]
    v_pk_fma_f32 v[34:35], v[90:91], v[34:35], v[58:59] op_sel:[1,1,0] op_sel_hi:[1,0,1] neg_lo:[1,0,0]
    v_pk_fma_f32 v[36:37], v[92:93], v[36:37], v[60:61] op_sel:[1,1,0] op_sel_hi:[1,0,1] neg_lo:[1,0,0]
    v_pk_fma_f32 v[38:39], v[94:95], v[38:39], v[62:63] op_sel:[1,1,0] op_sel_hi:[1,0,1] neg_lo:[1,0,0]
    v_pk_mul_f32 v[40:41], v[96:97], v[32:33] op_sel:[0,0] op_sel_hi:[0,1]
    v_pk_mul_f32 v[42:43], v[98:99], v[34:35] op_sel:[0,0] op_sel_hi:[0,1]
    v_pk_mul_f32 v[44:45], v[100:101], v[36:37] op_sel:[0,0] op_sel_hi:[0,1]
    v_pk_mul_f32 v[46:47], v[102:103], v[38:39] op_sel:[0,0] op_sel_hi:[0,1]
    v_pk_fma_f32 v[80:81], v[96:97], v[32:33], v[40:41] op_sel:[1,1,0] op_sel_hi:[1,0,1] neg_lo:[1,0,0] neg_hi:[1,0,1]
    v_pk_fma_f32 v[82:83], v[98:99], v[34:35], v[42:43] op_sel:[1,1,0] op_sel_hi:[1,0,1] neg_lo:[1,0,0] neg_hi:[1,0,1]
    v_pk_fma_f32 v[84:85], v[100:101], v[36:37], v[44:45] op_sel:[1,1,0] op_sel_hi:[1,0,1] neg_lo:[1,0,0] neg_hi:[1,0,1]
    v_pk_fma_f32 v[86:87], v[102:103], v[38:39], v[46:47] op_sel:[1,1,0] op_sel_hi:[1,0,1] neg_lo:[1,0,0] neg_hi:[1,0,1]
    v_cvt_pk_bf16_f32 v161, v72, v80
    v_cvt_pk_bf16_f32 v169, v74, v82
    v_cvt_pk_bf16_f32 v177, v76, v84
    v_cvt_pk_bf16_f32 v185, v78, v86
    v_cvt_pk_bf16_f32 v225, v73, v81
    v_cvt_pk_bf16_f32 v233, v75, v83
    v_cvt_pk_bf16_f32 v241, v77, v85
    v_cvt_pk_bf16_f32 v249, v79, v87
    v_accvgpr_read_b32 v64, a160
    v_accvgpr_read_b32 v66, a164
    v_accvgpr_read_b32 v68, a168
    v_accvgpr_read_b32 v70, a172
    v_accvgpr_read_b32 v65, a176
    v_accvgpr_read_b32 v67, a180
    v_accvgpr_read_b32 v69, a184
    v_accvgpr_read_b32 v71, a188
    v_pk_fma_f32 v[56:57], v[88:89], v[32:33], v[64:65] op_sel:[0,0,0] op_sel_hi:[0,1,1]
    v_pk_fma_f32 v[58:59], v[90:91], v[34:35], v[66:67] op_sel:[0,0,0] op_sel_hi:[0,1,1]
    v_pk_fma_f32 v[60:61], v[92:93], v[36:37], v[68:69] op_sel:[0,0,0] op_sel_hi:[0,1,1]
    v_pk_fma_f32 v[62:63], v[94:95], v[38:39], v[70:71] op_sel:[0,0,0] op_sel_hi:[0,1,1]
    v_pk_fma_f32 v[32:33], v[88:89], v[32:33], v[56:57] op_sel:[1,1,0] op_sel_hi:[1,0,1] neg_lo:[1,0,0]
    v_pk_fma_f32 v[34:35], v[90:91], v[34:35], v[58:59] op_sel:[1,1,0] op_sel_hi:[1,0,1] neg_lo:[1,0,0]
    v_pk_fma_f32 v[36:37], v[92:93], v[36:37], v[60:61] op_sel:[1,1,0] op_sel_hi:[1,0,1] neg_lo:[1,0,0]
    v_pk_fma_f32 v[38:39], v[94:95], v[38:39], v[62:63] op_sel:[1,1,0] op_sel_hi:[1,0,1] neg_lo:[1,0,0]
    v_pk_mul_f32 v[40:41], v[96:97], v[32:33] op_sel:[0,0] op_sel_hi:[0,1]
    v_pk_mul_f32 v[42:43], v[98:99], v[34:35] op_sel:[0,0] op_sel_hi:[0,1]
    v_pk_mul_f32 v[44:45], v[100:101], v[36:37] op_sel:[0,0] op_sel_hi:[0,1]
    v_pk_mul_f32 v[46:47], v[102:103], v[38:39] op_sel:[0,0] op_sel_hi:[0,1]
    v_pk_fma_f32 v[72:73], v[96:97], v[32:33], v[40:41] op_sel:[1,1,0] op_sel_hi:[1,0,1] neg_lo:[1,0,0] neg_hi:[1,0,1]
    v_pk_fma_f32 v[74:75], v[98:99], v[34:35], v[42:43] op_sel:[1,1,0] op_sel_hi:[1,0,1] neg_lo:[1,0,0] neg_hi:[1,0,1]
    v_pk_fma_f32 v[76:77], v[100:101], v[36:37], v[44:45] op_sel:[1,1,0] op_sel_hi:[1,0,1] neg_lo:[1,0,0] neg_hi:[1,0,1]
    v_pk_fma_f32 v[78:79], v[102:103], v[38:39], v[46:47] op_sel:[1,1,0] op_sel_hi:[1,0,1] neg_lo:[1,0,0] neg_hi:[1,0,1]
    v_accvgpr_read_b32 v48, a161
    v_accvgpr_read_b32 v50, a165
    v_accvgpr_read_b32 v52, a169
    v_accvgpr_read_b32 v54, a173
    v_accvgpr_read_b32 v49, a177
    v_accvgpr_read_b32 v51, a181
    v_accvgpr_read_b32 v53, a185
    v_accvgpr_read_b32 v55, a189
    v_pk_fma_f32 v[56:57], v[88:89], v[32:33], v[48:49] op_sel:[0,0,0] op_sel_hi:[0,1,1]
    v_pk_fma_f32 v[58:59], v[90:91], v[34:35], v[50:51] op_sel:[0,0,0] op_sel_hi:[0,1,1]
    v_pk_fma_f32 v[60:61], v[92:93], v[36:37], v[52:53] op_sel:[0,0,0] op_sel_hi:[0,1,1]
    v_pk_fma_f32 v[62:63], v[94:95], v[38:39], v[54:55] op_sel:[0,0,0] op_sel_hi:[0,1,1]
    v_pk_fma_f32 v[32:33], v[88:89], v[32:33], v[56:57] op_sel:[1,1,0] op_sel_hi:[1,0,1] neg_lo:[1,0,0]
    v_pk_fma_f32 v[34:35], v[90:91], v[34:35], v[58:59] op_sel:[1,1,0] op_sel_hi:[1,0,1] neg_lo:[1,0,0]
    v_pk_fma_f32 v[36:37], v[92:93], v[36:37], v[60:61] op_sel:[1,1,0] op_sel_hi:[1,0,1] neg_lo:[1,0,0]
    v_pk_fma_f32 v[38:39], v[94:95], v[38:39], v[62:63] op_sel:[1,1,0] op_sel_hi:[1,0,1] neg_lo:[1,0,0]
    v_pk_mul_f32 v[40:41], v[96:97], v[32:33] op_sel:[0,0] op_sel_hi:[0,1]
    v_pk_mul_f32 v[42:43], v[98:99], v[34:35] op_sel:[0,0] op_sel_hi:[0,1]
    v_pk_mul_f32 v[44:45], v[100:101], v[36:37] op_sel:[0,0] op_sel_hi:[0,1]
    v_pk_mul_f32 v[46:47], v[102:103], v[38:39] op_sel:[0,0] op_sel_hi:[0,1]
    v_pk_fma_f32 v[80:81], v[96:97], v[32:33], v[40:41] op_sel:[1,1,0] op_sel_hi:[1,0,1] neg_lo:[1,0,0] neg_hi:[1,0,1]
    v_pk_fma_f32 v[82:83], v[98:99], v[34:35], v[42:43] op_sel:[1,1,0] op_sel_hi:[1,0,1] neg_lo:[1,0,0] neg_hi:[1,0,1]
    v_pk_fma_f32 v[84:85], v[100:101], v[36:37], v[44:45] op_sel:[1,1,0] op_sel_hi:[1,0,1] neg_lo:[1,0,0] neg_hi:[1,0,1]
    v_pk_fma_f32 v[86:87], v[102:103], v[38:39], v[46:47] op_sel:[1,1,0] op_sel_hi:[1,0,1] neg_lo:[1,0,0] neg_hi:[1,0,1]
    v_cvt_pk_bf16_f32 v162, v72, v80
    v_cvt_pk_bf16_f32 v170, v74, v82
    v_cvt_pk_bf16_f32 v178, v76, v84
    v_cvt_pk_bf16_f32 v186, v78, v86
    v_cvt_pk_bf16_f32 v226, v73, v81
    v_cvt_pk_bf16_f32 v234, v75, v83
    v_cvt_pk_bf16_f32 v242, v77, v85
    v_cvt_pk_bf16_f32 v250, v79, v87
    v_accvgpr_read_b32 v64, a162
    v_accvgpr_read_b32 v66, a166
    v_accvgpr_read_b32 v68, a170
    v_accvgpr_read_b32 v70, a174
    v_accvgpr_read_b32 v65, a178
    v_accvgpr_read_b32 v67, a182
    v_accvgpr_read_b32 v69, a186
    v_accvgpr_read_b32 v71, a190
    v_pk_fma_f32 v[56:57], v[88:89], v[32:33], v[64:65] op_sel:[0,0,0] op_sel_hi:[0,1,1]
    v_pk_fma_f32 v[58:59], v[90:91], v[34:35], v[66:67] op_sel:[0,0,0] op_sel_hi:[0,1,1]
    v_pk_fma_f32 v[60:61], v[92:93], v[36:37], v[68:69] op_sel:[0,0,0] op_sel_hi:[0,1,1]
    v_pk_fma_f32 v[62:63], v[94:95], v[38:39], v[70:71] op_sel:[0,0,0] op_sel_hi:[0,1,1]
    v_pk_fma_f32 v[32:33], v[88:89], v[32:33], v[56:57] op_sel:[1,1,0] op_sel_hi:[1,0,1] neg_lo:[1,0,0]
    v_pk_fma_f32 v[34:35], v[90:91], v[34:35], v[58:59] op_sel:[1,1,0] op_sel_hi:[1,0,1] neg_lo:[1,0,0]
    v_pk_fma_f32 v[36:37], v[92:93], v[36:37], v[60:61] op_sel:[1,1,0] op_sel_hi:[1,0,1] neg_lo:[1,0,0]
    v_pk_fma_f32 v[38:39], v[94:95], v[38:39], v[62:63] op_sel:[1,1,0] op_sel_hi:[1,0,1] neg_lo:[1,0,0]
    v_pk_mul_f32 v[40:41], v[96:97], v[32:33] op_sel:[0,0] op_sel_hi:[0,1]
    v_pk_mul_f32 v[42:43], v[98:99], v[34:35] op_sel:[0,0] op_sel_hi:[0,1]
    v_pk_mul_f32 v[44:45], v[100:101], v[36:37] op_sel:[0,0] op_sel_hi:[0,1]
    v_pk_mul_f32 v[46:47], v[102:103], v[38:39] op_sel:[0,0] op_sel_hi:[0,1]
    v_pk_fma_f32 v[72:73], v[96:97], v[32:33], v[40:41] op_sel:[1,1,0] op_sel_hi:[1,0,1] neg_lo:[1,0,0] neg_hi:[1,0,1]
    v_pk_fma_f32 v[74:75], v[98:99], v[34:35], v[42:43] op_sel:[1,1,0] op_sel_hi:[1,0,1] neg_lo:[1,0,0] neg_hi:[1,0,1]
    v_pk_fma_f32 v[76:77], v[100:101], v[36:37], v[44:45] op_sel:[1,1,0] op_sel_hi:[1,0,1] neg_lo:[1,0,0] neg_hi:[1,0,1]
    v_pk_fma_f32 v[78:79], v[102:103], v[38:39], v[46:47] op_sel:[1,1,0] op_sel_hi:[1,0,1] neg_lo:[1,0,0] neg_hi:[1,0,1]
    v_accvgpr_read_b32 v48, a163
    v_accvgpr_read_b32 v50, a167
    v_accvgpr_read_b32 v52, a171
    v_accvgpr_read_b32 v54, a175
    v_accvgpr_read_b32 v49, a179
    v_accvgpr_read_b32 v51, a183
    v_accvgpr_read_b32 v53, a187
    v_accvgpr_read_b32 v55, a191
    v_pk_fma_f32 v[56:57], v[88:89], v[32:33], v[48:49] op_sel:[0,0,0] op_sel_hi:[0,1,1]
    v_pk_fma_f32 v[58:59], v[90:91], v[34:35], v[50:51] op_sel:[0,0,0] op_sel_hi:[0,1,1]
    v_pk_fma_f32 v[60:61], v[92:93], v[36:37], v[52:53] op_sel:[0,0,0] op_sel_hi:[0,1,1]
    v_pk_fma_f32 v[62:63], v[94:95], v[38:39], v[54:55] op_sel:[0,0,0] op_sel_hi:[0,1,1]
    v_pk_fma_f32 v[32:33], v[88:89], v[32:33], v[56:57] op_sel:[1,1,0] op_sel_hi:[1,0,1] neg_lo:[1,0,0]
    v_pk_fma_f32 v[34:35], v[90:91], v[34:35], v[58:59] op_sel:[1,1,0] op_sel_hi:[1,0,1] neg_lo:[1,0,0]
    v_pk_fma_f32 v[36:37], v[92:93], v[36:37], v[60:61] op_sel:[1,1,0] op_sel_hi:[1,0,1] neg_lo:[1,0,0]
    v_pk_fma_f32 v[38:39], v[94:95], v[38:39], v[62:63] op_sel:[1,1,0] op_sel_hi:[1,0,1] neg_lo:[1,0,0]
    v_pk_mul_f32 v[40:41], v[96:97], v[32:33] op_sel:[0,0] op_sel_hi:[0,1]
    v_pk_mul_f32 v[42:43], v[98:99], v[34:35] op_sel:[0,0] op_sel_hi:[0,1]
    v_pk_mul_f32 v[44:45], v[100:101], v[36:37] op_sel:[0,0] op_sel_hi:[0,1]
    v_pk_mul_f32 v[46:47], v[102:103], v[38:39] op_sel:[0,0] op_sel_hi:[0,1]
    v_pk_fma_f32 v[80:81], v[96:97], v[32:33], v[40:41] op_sel:[1,1,0] op_sel_hi:[1,0,1] neg_lo:[1,0,0] neg_hi:[1,0,1]
    v_pk_fma_f32 v[82:83], v[98:99], v[34:35], v[42:43] op_sel:[1,1,0] op_sel_hi:[1,0,1] neg_lo:[1,0,0] neg_hi:[1,0,1]
    v_pk_fma_f32 v[84:85], v[100:101], v[36:37], v[44:45] op_sel:[1,1,0] op_sel_hi:[1,0,1] neg_lo:[1,0,0] neg_hi:[1,0,1]
    v_pk_fma_f32 v[86:87], v[102:103], v[38:39], v[46:47] op_sel:[1,1,0] op_sel_hi:[1,0,1] neg_lo:[1,0,0] neg_hi:[1,0,1]
    v_cvt_pk_bf16_f32 v163, v72, v80
    v_cvt_pk_bf16_f32 v171, v74, v82
    v_cvt_pk_bf16_f32 v179, v76, v84
    v_cvt_pk_bf16_f32 v187, v78, v86
    v_cvt_pk_bf16_f32 v227, v73, v81
    v_cvt_pk_bf16_f32 v235, v75, v83
    v_cvt_pk_bf16_f32 v243, v77, v85
    v_cvt_pk_bf16_f32 v251, v79, v87
    v_accvgpr_read_b32 v64, a192
    v_accvgpr_read_b32 v66, a196
    v_accvgpr_read_b32 v68, a200
    v_accvgpr_read_b32 v70, a204
    v_accvgpr_read_b32 v65, a208
    v_accvgpr_read_b32 v67, a212
    v_accvgpr_read_b32 v69, a216
    v_accvgpr_read_b32 v71, a220
    v_pk_fma_f32 v[56:57], v[88:89], v[32:33], v[64:65] op_sel:[0,0,0] op_sel_hi:[0,1,1]
    v_pk_fma_f32 v[58:59], v[90:91], v[34:35], v[66:67] op_sel:[0,0,0] op_sel_hi:[0,1,1]
    v_pk_fma_f32 v[60:61], v[92:93], v[36:37], v[68:69] op_sel:[0,0,0] op_sel_hi:[0,1,1]
    v_pk_fma_f32 v[62:63], v[94:95], v[38:39], v[70:71] op_sel:[0,0,0] op_sel_hi:[0,1,1]
    v_pk_fma_f32 v[32:33], v[88:89], v[32:33], v[56:57] op_sel:[1,1,0] op_sel_hi:[1,0,1] neg_lo:[1,0,0]
    v_pk_fma_f32 v[34:35], v[90:91], v[34:35], v[58:59] op_sel:[1,1,0] op_sel_hi:[1,0,1] neg_lo:[1,0,0]
    v_pk_fma_f32 v[36:37], v[92:93], v[36:37], v[60:61] op_sel:[1,1,0] op_sel_hi:[1,0,1] neg_lo:[1,0,0]
    v_pk_fma_f32 v[38:39], v[94:95], v[38:39], v[62:63] op_sel:[1,1,0] op_sel_hi:[1,0,1] neg_lo:[1,0,0]
    v_pk_mul_f32 v[40:41], v[96:97], v[32:33] op_sel:[0,0] op_sel_hi:[0,1]
    v_pk_mul_f32 v[42:43], v[98:99], v[34:35] op_sel:[0,0] op_sel_hi:[0,1]
    v_pk_mul_f32 v[44:45], v[100:101], v[36:37] op_sel:[0,0] op_sel_hi:[0,1]
    v_pk_mul_f32 v[46:47], v[102:103], v[38:39] op_sel:[0,0] op_sel_hi:[0,1]
    v_pk_fma_f32 v[72:73], v[96:97], v[32:33], v[40:41] op_sel:[1,1,0] op_sel_hi:[1,0,1] neg_lo:[1,0,0] neg_hi:[1,0,1]
    v_pk_fma_f32 v[74:75], v[98:99], v[34:35], v[42:43] op_sel:[1,1,0] op_sel_hi:[1,0,1] neg_lo:[1,0,0] neg_hi:[1,0,1]
    v_pk_fma_f32 v[76:77], v[100:101], v[36:37], v[44:45] op_sel:[1,1,0] op_sel_hi:[1,0,1] neg_lo:[1,0,0] neg_hi:[1,0,1]
    v_pk_fma_f32 v[78:79], v[102:103], v[38:39], v[46:47] op_sel:[1,1,0] op_sel_hi:[1,0,1] neg_lo:[1,0,0] neg_hi:[1,0,1]
    v_accvgpr_read_b32 v48, a193
    v_accvgpr_read_b32 v50, a197
    v_accvgpr_read_b32 v52, a201
    v_accvgpr_read_b32 v54, a205
    v_accvgpr_read_b32 v49, a209
    v_accvgpr_read_b32 v51, a213
    v_accvgpr_read_b32 v53, a217
    v_accvgpr_read_b32 v55, a221
    v_pk_fma_f32 v[56:57], v[88:89], v[32:33], v[48:49] op_sel:[0,0,0] op_sel_hi:[0,1,1]
    v_pk_fma_f32 v[58:59], v[90:91], v[34:35], v[50:51] op_sel:[0,0,0] op_sel_hi:[0,1,1]
    v_pk_fma_f32 v[60:61], v[92:93], v[36:37], v[52:53] op_sel:[0,0,0] op_sel_hi:[0,1,1]
    v_pk_fma_f32 v[62:63], v[94:95], v[38:39], v[54:55] op_sel:[0,0,0] op_sel_hi:[0,1,1]
    v_pk_fma_f32 v[32:33], v[88:89], v[32:33], v[56:57] op_sel:[1,1,0] op_sel_hi:[1,0,1] neg_lo:[1,0,0]
    v_pk_fma_f32 v[34:35], v[90:91], v[34:35], v[58:59] op_sel:[1,1,0] op_sel_hi:[1,0,1] neg_lo:[1,0,0]
    v_pk_fma_f32 v[36:37], v[92:93], v[36:37], v[60:61] op_sel:[1,1,0] op_sel_hi:[1,0,1] neg_lo:[1,0,0]
    v_pk_fma_f32 v[38:39], v[94:95], v[38:39], v[62:63] op_sel:[1,1,0] op_sel_hi:[1,0,1] neg_lo:[1,0,0]
    v_pk_mul_f32 v[40:41], v[96:97], v[32:33] op_sel:[0,0] op_sel_hi:[0,1]
    v_pk_mul_f32 v[42:43], v[98:99], v[34:35] op_sel:[0,0] op_sel_hi:[0,1]
    v_pk_mul_f32 v[44:45], v[100:101], v[36:37] op_sel:[0,0] op_sel_hi:[0,1]
    v_pk_mul_f32 v[46:47], v[102:103], v[38:39] op_sel:[0,0] op_sel_hi:[0,1]
    v_pk_fma_f32 v[80:81], v[96:97], v[32:33], v[40:41] op_sel:[1,1,0] op_sel_hi:[1,0,1] neg_lo:[1,0,0] neg_hi:[1,0,1]
    v_pk_fma_f32 v[82:83], v[98:99], v[34:35], v[42:43] op_sel:[1,1,0] op_sel_hi:[1,0,1] neg_lo:[1,0,0] neg_hi:[1,0,1]
    v_pk_fma_f32 v[84:85], v[100:101], v[36:37], v[44:45] op_sel:[1,1,0] op_sel_hi:[1,0,1] neg_lo:[1,0,0] neg_hi:[1,0,1]
    v_pk_fma_f32 v[86:87], v[102:103], v[38:39], v[46:47] op_sel:[1,1,0] op_sel_hi:[1,0,1] neg_lo:[1,0,0] neg_hi:[1,0,1]
    v_cvt_pk_bf16_f32 v164, v72, v80
    v_cvt_pk_bf16_f32 v172, v74, v82
    v_cvt_pk_bf16_f32 v180, v76, v84
    v_cvt_pk_bf16_f32 v188, v78, v86
    v_cvt_pk_bf16_f32 v228, v73, v81
    v_cvt_pk_bf16_f32 v236, v75, v83
    v_cvt_pk_bf16_f32 v244, v77, v85
    v_cvt_pk_bf16_f32 v252, v79, v87
    v_accvgpr_read_b32 v64, a194
    v_accvgpr_read_b32 v66, a198
    v_accvgpr_read_b32 v68, a202
    v_accvgpr_read_b32 v70, a206
    v_accvgpr_read_b32 v65, a210
    v_accvgpr_read_b32 v67, a214
    v_accvgpr_read_b32 v69, a218
    v_accvgpr_read_b32 v71, a222
    v_pk_fma_f32 v[56:57], v[88:89], v[32:33], v[64:65] op_sel:[0,0,0] op_sel_hi:[0,1,1]
    v_pk_fma_f32 v[58:59], v[90:91], v[34:35], v[66:67] op_sel:[0,0,0] op_sel_hi:[0,1,1]
    v_pk_fma_f32 v[60:61], v[92:93], v[36:37], v[68:69] op_sel:[0,0,0] op_sel_hi:[0,1,1]
    v_pk_fma_f32 v[62:63], v[94:95], v[38:39], v[70:71] op_sel:[0,0,0] op_sel_hi:[0,1,1]
    v_pk_fma_f32 v[32:33], v[88:89], v[32:33], v[56:57] op_sel:[1,1,0] op_sel_hi:[1,0,1] neg_lo:[1,0,0]
    v_pk_fma_f32 v[34:35], v[90:91], v[34:35], v[58:59] op_sel:[1,1,0] op_sel_hi:[1,0,1] neg_lo:[1,0,0]
    v_pk_fma_f32 v[36:37], v[92:93], v[36:37], v[60:61] op_sel:[1,1,0] op_sel_hi:[1,0,1] neg_lo:[1,0,0]
    v_pk_fma_f32 v[38:39], v[94:95], v[38:39], v[62:63] op_sel:[1,1,0] op_sel_hi:[1,0,1] neg_lo:[1,0,0]
    v_pk_mul_f32 v[40:41], v[96:97], v[32:33] op_sel:[0,0] op_sel_hi:[0,1]
    v_pk_mul_f32 v[42:43], v[98:99], v[34:35] op_sel:[0,0] op_sel_hi:[0,1]
    v_pk_mul_f32 v[44:45], v[100:101], v[36:37] op_sel:[0,0] op_sel_hi:[0,1]
    v_pk_mul_f32 v[46:47], v[102:103], v[38:39] op_sel:[0,0] op_sel_hi:[0,1]
    v_pk_fma_f32 v[72:73], v[96:97], v[32:33], v[40:41] op_sel:[1,1,0] op_sel_hi:[1,0,1] neg_lo:[1,0,0] neg_hi:[1,0,1]
    v_pk_fma_f32 v[74:75], v[98:99], v[34:35], v[42:43] op_sel:[1,1,0] op_sel_hi:[1,0,1] neg_lo:[1,0,0] neg_hi:[1,0,1]
    v_pk_fma_f32 v[76:77], v[100:101], v[36:37], v[44:45] op_sel:[1,1,0] op_sel_hi:[1,0,1] neg_lo:[1,0,0] neg_hi:[1,0,1]
    v_pk_fma_f32 v[78:79], v[102:103], v[38:39], v[46:47] op_sel:[1,1,0] op_sel_hi:[1,0,1] neg_lo:[1,0,0] neg_hi:[1,0,1]
    v_accvgpr_read_b32 v48, a195
    v_accvgpr_read_b32 v50, a199
    v_accvgpr_read_b32 v52, a203
    v_accvgpr_read_b32 v54, a207
    v_accvgpr_read_b32 v49, a211
    v_accvgpr_read_b32 v51, a215
    v_accvgpr_read_b32 v53, a219
    v_accvgpr_read_b32 v55, a223
    v_pk_fma_f32 v[56:57], v[88:89], v[32:33], v[48:49] op_sel:[0,0,0] op_sel_hi:[0,1,1]
    v_pk_fma_f32 v[58:59], v[90:91], v[34:35], v[50:51] op_sel:[0,0,0] op_sel_hi:[0,1,1]
    v_pk_fma_f32 v[60:61], v[92:93], v[36:37], v[52:53] op_sel:[0,0,0] op_sel_hi:[0,1,1]
    v_pk_fma_f32 v[62:63], v[94:95], v[38:39], v[54:55] op_sel:[0,0,0] op_sel_hi:[0,1,1]
    v_pk_fma_f32 v[32:33], v[88:89], v[32:33], v[56:57] op_sel:[1,1,0] op_sel_hi:[1,0,1] neg_lo:[1,0,0]
    v_pk_fma_f32 v[34:35], v[90:91], v[34:35], v[58:59] op_sel:[1,1,0] op_sel_hi:[1,0,1] neg_lo:[1,0,0]
    v_pk_fma_f32 v[36:37], v[92:93], v[36:37], v[60:61] op_sel:[1,1,0] op_sel_hi:[1,0,1] neg_lo:[1,0,0]
    v_pk_fma_f32 v[38:39], v[94:95], v[38:39], v[62:63] op_sel:[1,1,0] op_sel_hi:[1,0,1] neg_lo:[1,0,0]
    v_pk_mul_f32 v[40:41], v[96:97], v[32:33] op_sel:[0,0] op_sel_hi:[0,1]
    v_pk_mul_f32 v[42:43], v[98:99], v[34:35] op_sel:[0,0] op_sel_hi:[0,1]
    v_pk_mul_f32 v[44:45], v[100:101], v[36:37] op_sel:[0,0] op_sel_hi:[0,1]
    v_pk_mul_f32 v[46:47], v[102:103], v[38:39] op_sel:[0,0] op_sel_hi:[0,1]
    v_pk_fma_f32 v[80:81], v[96:97], v[32:33], v[40:41] op_sel:[1,1,0] op_sel_hi:[1,0,1] neg_lo:[1,0,0] neg_hi:[1,0,1]
    v_pk_fma_f32 v[82:83], v[98:99], v[34:35], v[42:43] op_sel:[1,1,0] op_sel_hi:[1,0,1] neg_lo:[1,0,0] neg_hi:[1,0,1]
    v_pk_fma_f32 v[84:85], v[100:101], v[36:37], v[44:45] op_sel:[1,1,0] op_sel_hi:[1,0,1] neg_lo:[1,0,0] neg_hi:[1,0,1]
    v_pk_fma_f32 v[86:87], v[102:103], v[38:39], v[46:47] op_sel:[1,1,0] op_sel_hi:[1,0,1] neg_lo:[1,0,0] neg_hi:[1,0,1]
    v_cvt_pk_bf16_f32 v165, v72, v80
    v_cvt_pk_bf16_f32 v173, v74, v82
    v_cvt_pk_bf16_f32 v181, v76, v84
    v_cvt_pk_bf16_f32 v189, v78, v86
    v_cvt_pk_bf16_f32 v229, v73, v81
    v_cvt_pk_bf16_f32 v237, v75, v83
    v_cvt_pk_bf16_f32 v245, v77, v85
    v_cvt_pk_bf16_f32 v253, v79, v87
    v_accvgpr_read_b32 v64, a224
    v_accvgpr_read_b32 v66, a228
    v_accvgpr_read_b32 v68, a232
    v_accvgpr_read_b32 v70, a236
    v_accvgpr_read_b32 v65, a240
    v_accvgpr_read_b32 v67, a244
    v_accvgpr_read_b32 v69, a248
    v_accvgpr_read_b32 v71, a252
    v_pk_fma_f32 v[56:57], v[88:89], v[32:33], v[64:65] op_sel:[0,0,0] op_sel_hi:[0,1,1]
    v_pk_fma_f32 v[58:59], v[90:91], v[34:35], v[66:67] op_sel:[0,0,0] op_sel_hi:[0,1,1]
    v_pk_fma_f32 v[60:61], v[92:93], v[36:37], v[68:69] op_sel:[0,0,0] op_sel_hi:[0,1,1]
    v_pk_fma_f32 v[62:63], v[94:95], v[38:39], v[70:71] op_sel:[0,0,0] op_sel_hi:[0,1,1]
    v_pk_fma_f32 v[32:33], v[88:89], v[32:33], v[56:57] op_sel:[1,1,0] op_sel_hi:[1,0,1] neg_lo:[1,0,0]
    v_pk_fma_f32 v[34:35], v[90:91], v[34:35], v[58:59] op_sel:[1,1,0] op_sel_hi:[1,0,1] neg_lo:[1,0,0]
    v_pk_fma_f32 v[36:37], v[92:93], v[36:37], v[60:61] op_sel:[1,1,0] op_sel_hi:[1,0,1] neg_lo:[1,0,0]
    v_pk_fma_f32 v[38:39], v[94:95], v[38:39], v[62:63] op_sel:[1,1,0] op_sel_hi:[1,0,1] neg_lo:[1,0,0]
    v_pk_mul_f32 v[40:41], v[96:97], v[32:33] op_sel:[0,0] op_sel_hi:[0,1]
    v_pk_mul_f32 v[42:43], v[98:99], v[34:35] op_sel:[0,0] op_sel_hi:[0,1]
    v_pk_mul_f32 v[44:45], v[100:101], v[36:37] op_sel:[0,0] op_sel_hi:[0,1]
    v_pk_mul_f32 v[46:47], v[102:103], v[38:39] op_sel:[0,0] op_sel_hi:[0,1]
    v_pk_fma_f32 v[72:73], v[96:97], v[32:33], v[40:41] op_sel:[1,1,0] op_sel_hi:[1,0,1] neg_lo:[1,0,0] neg_hi:[1,0,1]
    v_pk_fma_f32 v[74:75], v[98:99], v[34:35], v[42:43] op_sel:[1,1,0] op_sel_hi:[1,0,1] neg_lo:[1,0,0] neg_hi:[1,0,1]
    v_pk_fma_f32 v[76:77], v[100:101], v[36:37], v[44:45] op_sel:[1,1,0] op_sel_hi:[1,0,1] neg_lo:[1,0,0] neg_hi:[1,0,1]
    v_pk_fma_f32 v[78:79], v[102:103], v[38:39], v[46:47] op_sel:[1,1,0] op_sel_hi:[1,0,1] neg_lo:[1,0,0] neg_hi:[1,0,1]
    v_accvgpr_read_b32 v48, a225
    v_accvgpr_read_b32 v50, a229
    v_accvgpr_read_b32 v52, a233
    v_accvgpr_read_b32 v54, a237
    v_accvgpr_read_b32 v49, a241
    v_accvgpr_read_b32 v51, a245
    v_accvgpr_read_b32 v53, a249
    v_accvgpr_read_b32 v55, a253
    v_pk_fma_f32 v[56:57], v[88:89], v[32:33], v[48:49] op_sel:[0,0,0] op_sel_hi:[0,1,1]
    v_pk_fma_f32 v[58:59], v[90:91], v[34:35], v[50:51] op_sel:[0,0,0] op_sel_hi:[0,1,1]
    v_pk_fma_f32 v[60:61], v[92:93], v[36:37], v[52:53] op_sel:[0,0,0] op_sel_hi:[0,1,1]
    v_pk_fma_f32 v[62:63], v[94:95], v[38:39], v[54:55] op_sel:[0,0,0] op_sel_hi:[0,1,1]
    v_pk_fma_f32 v[32:33], v[88:89], v[32:33], v[56:57] op_sel:[1,1,0] op_sel_hi:[1,0,1] neg_lo:[1,0,0]
    v_pk_fma_f32 v[34:35], v[90:91], v[34:35], v[58:59] op_sel:[1,1,0] op_sel_hi:[1,0,1] neg_lo:[1,0,0]
    v_pk_fma_f32 v[36:37], v[92:93], v[36:37], v[60:61] op_sel:[1,1,0] op_sel_hi:[1,0,1] neg_lo:[1,0,0]
    v_pk_fma_f32 v[38:39], v[94:95], v[38:39], v[62:63] op_sel:[1,1,0] op_sel_hi:[1,0,1] neg_lo:[1,0,0]
    v_pk_mul_f32 v[40:41], v[96:97], v[32:33] op_sel:[0,0] op_sel_hi:[0,1]
    v_pk_mul_f32 v[42:43], v[98:99], v[34:35] op_sel:[0,0] op_sel_hi:[0,1]
    v_pk_mul_f32 v[44:45], v[100:101], v[36:37] op_sel:[0,0] op_sel_hi:[0,1]
    v_pk_mul_f32 v[46:47], v[102:103], v[38:39] op_sel:[0,0] op_sel_hi:[0,1]
    v_pk_fma_f32 v[80:81], v[96:97], v[32:33], v[40:41] op_sel:[1,1,0] op_sel_hi:[1,0,1] neg_lo:[1,0,0] neg_hi:[1,0,1]
    v_pk_fma_f32 v[82:83], v[98:99], v[34:35], v[42:43] op_sel:[1,1,0] op_sel_hi:[1,0,1] neg_lo:[1,0,0] neg_hi:[1,0,1]
    v_pk_fma_f32 v[84:85], v[100:101], v[36:37], v[44:45] op_sel:[1,1,0] op_sel_hi:[1,0,1] neg_lo:[1,0,0] neg_hi:[1,0,1]
    v_pk_fma_f32 v[86:87], v[102:103], v[38:39], v[46:47] op_sel:[1,1,0] op_sel_hi:[1,0,1] neg_lo:[1,0,0] neg_hi:[1,0,1]
    v_cvt_pk_bf16_f32 v166, v72, v80
    v_cvt_pk_bf16_f32 v174, v74, v82
    v_cvt_pk_bf16_f32 v182, v76, v84
    v_cvt_pk_bf16_f32 v190, v78, v86
    v_cvt_pk_bf16_f32 v230, v73, v81
    v_cvt_pk_bf16_f32 v238, v75, v83
    v_cvt_pk_bf16_f32 v246, v77, v85
    v_cvt_pk_bf16_f32 v254, v79, v87
    v_accvgpr_read_b32 v64, a226
    v_accvgpr_read_b32 v66, a230
    v_accvgpr_read_b32 v68, a234
    v_accvgpr_read_b32 v70, a238
    v_accvgpr_read_b32 v65, a242
    v_accvgpr_read_b32 v67, a246
    v_accvgpr_read_b32 v69, a250
    v_accvgpr_read_b32 v71, a254
    v_pk_fma_f32 v[56:57], v[88:89], v[32:33], v[64:65] op_sel:[0,0,0] op_sel_hi:[0,1,1]
    v_pk_fma_f32 v[58:59], v[90:91], v[34:35], v[66:67] op_sel:[0,0,0] op_sel_hi:[0,1,1]
    v_pk_fma_f32 v[60:61], v[92:93], v[36:37], v[68:69] op_sel:[0,0,0] op_sel_hi:[0,1,1]
    v_pk_fma_f32 v[62:63], v[94:95], v[38:39], v[70:71] op_sel:[0,0,0] op_sel_hi:[0,1,1]
    v_pk_fma_f32 v[32:33], v[88:89], v[32:33], v[56:57] op_sel:[1,1,0] op_sel_hi:[1,0,1] neg_lo:[1,0,0]
    v_pk_fma_f32 v[34:35], v[90:91], v[34:35], v[58:59] op_sel:[1,1,0] op_sel_hi:[1,0,1] neg_lo:[1,0,0]
    v_pk_fma_f32 v[36:37], v[92:93], v[36:37], v[60:61] op_sel:[1,1,0] op_sel_hi:[1,0,1] neg_lo:[1,0,0]
    v_pk_fma_f32 v[38:39], v[94:95], v[38:39], v[62:63] op_sel:[1,1,0] op_sel_hi:[1,0,1] neg_lo:[1,0,0]
    v_pk_mul_f32 v[40:41], v[96:97], v[32:33] op_sel:[0,0] op_sel_hi:[0,1]
    v_pk_mul_f32 v[42:43], v[98:99], v[34:35] op_sel:[0,0] op_sel_hi:[0,1]
    v_pk_mul_f32 v[44:45], v[100:101], v[36:37] op_sel:[0,0] op_sel_hi:[0,1]
    v_pk_mul_f32 v[46:47], v[102:103], v[38:39] op_sel:[0,0] op_sel_hi:[0,1]
    v_pk_fma_f32 v[72:73], v[96:97], v[32:33], v[40:41] op_sel:[1,1,0] op_sel_hi:[1,0,1] neg_lo:[1,0,0] neg_hi:[1,0,1]
    v_pk_fma_f32 v[74:75], v[98:99], v[34:35], v[42:43] op_sel:[1,1,0] op_sel_hi:[1,0,1] neg_lo:[1,0,0] neg_hi:[1,0,1]
    v_pk_fma_f32 v[76:77], v[100:101], v[36:37], v[44:45] op_sel:[1,1,0] op_sel_hi:[1,0,1] neg_lo:[1,0,0] neg_hi:[1,0,1]
    v_pk_fma_f32 v[78:79], v[102:103], v[38:39], v[46:47] op_sel:[1,1,0] op_sel_hi:[1,0,1] neg_lo:[1,0,0] neg_hi:[1,0,1]
    v_accvgpr_read_b32 v48, a227
    v_accvgpr_read_b32 v50, a231
    v_accvgpr_read_b32 v52, a235
    v_accvgpr_read_b32 v54, a239
    v_accvgpr_read_b32 v49, a243
    v_accvgpr_read_b32 v51, a247
    v_accvgpr_read_b32 v53, a251
    v_accvgpr_read_b32 v55, a255
    v_pk_fma_f32 v[56:57], v[88:89], v[32:33], v[48:49] op_sel:[0,0,0] op_sel_hi:[0,1,1]
    v_pk_fma_f32 v[58:59], v[90:91], v[34:35], v[50:51] op_sel:[0,0,0] op_sel_hi:[0,1,1]
    v_pk_fma_f32 v[60:61], v[92:93], v[36:37], v[52:53] op_sel:[0,0,0] op_sel_hi:[0,1,1]
    v_pk_fma_f32 v[62:63], v[94:95], v[38:39], v[54:55] op_sel:[0,0,0] op_sel_hi:[0,1,1]
    v_pk_fma_f32 v[32:33], v[88:89], v[32:33], v[56:57] op_sel:[1,1,0] op_sel_hi:[1,0,1] neg_lo:[1,0,0]
    v_pk_fma_f32 v[34:35], v[90:91], v[34:35], v[58:59] op_sel:[1,1,0] op_sel_hi:[1,0,1] neg_lo:[1,0,0]
    v_pk_fma_f32 v[36:37], v[92:93], v[36:37], v[60:61] op_sel:[1,1,0] op_sel_hi:[1,0,1] neg_lo:[1,0,0]
    v_pk_fma_f32 v[38:39], v[94:95], v[38:39], v[62:63] op_sel:[1,1,0] op_sel_hi:[1,0,1] neg_lo:[1,0,0]
    v_pk_mul_f32 v[40:41], v[96:97], v[32:33] op_sel:[0,0] op_sel_hi:[0,1]
    v_pk_mul_f32 v[42:43], v[98:99], v[34:35] op_sel:[0,0] op_sel_hi:[0,1]
    v_pk_mul_f32 v[44:45], v[100:101], v[36:37] op_sel:[0,0] op_sel_hi:[0,1]
    v_pk_mul_f32 v[46:47], v[102:103], v[38:39] op_sel:[0,0] op_sel_hi:[0,1]
    v_pk_fma_f32 v[80:81], v[96:97], v[32:33], v[40:41] op_sel:[1,1,0] op_sel_hi:[1,0,1] neg_lo:[1,0,0] neg_hi:[1,0,1]
    v_pk_fma_f32 v[82:83], v[98:99], v[34:35], v[42:43] op_sel:[1,1,0] op_sel_hi:[1,0,1] neg_lo:[1,0,0] neg_hi:[1,0,1]
    v_pk_fma_f32 v[84:85], v[100:101], v[36:37], v[44:45] op_sel:[1,1,0] op_sel_hi:[1,0,1] neg_lo:[1,0,0] neg_hi:[1,0,1]
    v_pk_fma_f32 v[86:87], v[102:103], v[38:39], v[46:47] op_sel:[1,1,0] op_sel_hi:[1,0,1] neg_lo:[1,0,0] neg_hi:[1,0,1]
    v_cvt_pk_bf16_f32 v167, v72, v80
    v_cvt_pk_bf16_f32 v175, v74, v82
    v_cvt_pk_bf16_f32 v183, v76, v84
    v_cvt_pk_bf16_f32 v191, v78, v86
    v_cvt_pk_bf16_f32 v231, v73, v81
    v_cvt_pk_bf16_f32 v239, v75, v83
    v_cvt_pk_bf16_f32 v247, v77, v85
    v_cvt_pk_bf16_f32 v255, v79, v87
    s_lshl_b32 s61, s85, 13
    s_andn2_b32 s61, 0x2000, s61
    s_xor_b32 s61, s61, s59
    s_lshl_b32 s50, s85, 21
    s_add_u32 s50, s50, s61
    s_lshr_b32 s60, s82, 2
    s_lshl_b32 s60, s60, 20
    s_add_u32 s50, s50, s60
    s_lshl_b32 s29, s29, 7
    s_and_b32 s29, s29, 0x7ffff
    s_add_u32 s50, s50, s29
    s_and_b32 s60, s58, 1
    s_lshl_b32 s60, s60, 12
    s_add_u32 s50, s50, s60
    s_add_u32 s50, s50, 0xa000000
    s_mov_b32 s5, 16384
    s_mov_b32 s51, 2048
    s_mov_b32 s52, 0x80000
    v_bfe_u32 v2, v0, 4, 1
    v_lshlrev_b32 v2, 6, v2
    v_xor_b32 v2, v2, v1
    v_add_u32 v3, 1024, v2
    s_setpc_b64 s[54:55]
.section .rodata,"a"
.p2align 6
.amdhsa_kernel chain_kernel
  .amdhsa_next_free_vgpr 512
  .amdhsa_next_free_sgpr 102
  .amdhsa_accum_offset 256
  .amdhsa_group_segment_fixed_size 0
  .amdhsa_kernarg_size 152
  .amdhsa_user_sgpr_count 2
  .amdhsa_user_sgpr_kernarg_segment_ptr 1
  .amdhsa_system_sgpr_workgroup_id_x 1
  .amdhsa_float_denorm_mode_32 3
  .amdhsa_float_denorm_mode_16_64 3
.end_amdhsa_kernel
```

```asm
; @launch kernel=chain_kernel grid=(256,1,1) block=(256,1,1) lds=163840
.amdgcn_target "amdgcn-amd-amdhsa--gfx950"
.text
.globl chain_kernel
.p2align 8
.type chain_kernel,@function
chain_kernel:
    s_cmp_ge_u32 s2, 256
    s_cbranch_scc1 chain_kernel_end
    s_load_dwordx4 s[96:99], s[0:1], 128
    s_load_dwordx2 s[100:101], s[0:1], 144
    s_load_dwordx16 s[64:79], s[0:1], 0
    s_load_dwordx16 s[80:95], s[0:1], 64
    s_getreg_b32 s16, hwreg(HW_REG_XCC_ID)
    s_and_b32 s16, s16, 7
    v_lshrrev_b32 v1, 6, v0
    s_nop 0
    v_readfirstlane_b32 s18, v1
    s_waitcnt lgkmcnt(0)
    s_lshr_b32 s17, s2, 3
    s_mov_b32 s95, 0
    s_cmp_lg_u32 s18, 0
    s_cbranch_scc1 L_role_1
    s_lshl_b32 s12, s16, 8
    s_add_u32 s12, s12, 0xb200000
    v_lshl_add_u32 v1, v0, 2, s12
    v_mov_b32 v2, 0
    global_store_dword v1, v2, s[100:101]
    s_lshl_b32 s12, s16, 3
    s_add_u32 s12, s12, 128
    s_lshl_b32 s0, 1, s17
    s_mov_b32 s1, 0x100
    s_waitcnt vmcnt(0)
    s_atomic_add_x2 s[0:1], s[98:99], s12 glc
L_role_1:
    s_cmp_ge_u32 s16, 4
    s_cbranch_scc1 chain_kernel_worker
chain_start:
    s_mov_b32 s8, s100
    s_and_b32 s9, s101, 0xffff
    s_mov_b32 s10, 0x10000000
    s_mov_b32 s11, 0x00020000
    s_mov_b32 s33, 0
    s_xor_b32 s29, s17, 8
    s_and_b32 s28, s17, 1
    s_bfe_u32 s20, s17, 0x10001
    s_xor_b32 s20, s20, 1
    s_lshl1_add_u32 s28, s28, s20
    s_lshl_b32 s20, s16, 10
    s_lshr_b32 s21, s17, 2
    s_lshl_b32 s21, s21, 7
    s_add_u32 s20, s20, s21
    v_bfe_u32 v160, v0, 5, 1
    v_lshlrev_b32 v162, 1, v160
    v_bfe_u32 v160, v0, 3, 1
    v_add_u32 v162, v162, v160
    v_bfe_u32 v160, v0, 4, 1
    v_lshl_add_u32 v162, v160, 3, v162
    v_lshrrev_b32 v160, 6, v0
    v_lshl_add_u32 v162, v160, 8, v162
    v_and_b32 v161, 7, v0
    v_lshlrev_b32 v163, 13, v162
    v_lshl_add_u32 v163, v161, 4, v163
    s_and_b32 s21, s28, 1
    s_lshl_b32 s21, s21, 6
    s_add_u32 s21, s21, s20
    s_lshl_b32 s21, s21, 1
    v_add_u32 v163, s21, v163
    v_add_u32 v164, 0x8000, v163
    v_bfe_u32 v160, v0, 4, 2
    v_lshlrev_b32 v162, 1, v160
    v_bfe_u32 v160, v0, 2, 1
    v_add_u32 v162, v162, v160
    v_bfe_u32 v160, v0, 3, 1
    v_lshl_add_u32 v162, v160, 3, v162
    v_lshrrev_b32 v160, 6, v0
    v_lshl_add_u32 v162, v160, 8, v162
    v_and_b32 v161, 3, v0
    v_lshlrev_b32 v165, 13, v162
    v_lshl_add_u32 v165, v161, 4, v165
    s_and_b32 s21, s17, 3
    s_lshl_b32 s21, s21, 5
    s_add_u32 s21, s21, s20
    s_lshl_b32 s21, s21, 1
    v_add_u32 v165, s21, v165
    v_bfe_u32 v166, v0, 2, 1
    v_bfe_u32 v160, v0, 4, 1
    v_lshl_add_u32 v166, v160, 1, v166
    v_bfe_u32 v160, v0, 3, 1
    v_lshl_add_u32 v166, v160, 2, v166
    v_bfe_u32 v160, v0, 5, 1
    v_lshl_add_u32 v166, v160, 4, v166
    v_lshrrev_b32 v160, 6, v0
    v_lshl_add_u32 v166, v160, 8, v166
    s_lshl_b32 s21, s16, 10
    v_add_u32 v166, s21, v166
    v_lshlrev_b32 v166, 11, v166
    v_lshl_add_u32 v166, v161, 4, v166
    s_lshl_b32 s21, s29, 6
    v_add_u32 v166, s21, v166
    s_lshl_b32 s72, s18, 15
    s_add_u32 s72, s72, 32768
    s_bitcmp1_b32 s28, 1
    s_cselect_b32 s12, s88, s86
    s_cselect_b32 s13, s89, s87
    s_and_b32 s13, s13, 0xffff
    s_mov_b32 s14, 0x800000
    s_mov_b32 s15, 0x00020000
    s_mov_b32 s4, s90
    s_and_b32 s5, s91, 0xffff
    s_mov_b32 s6, 0x800000
    s_mov_b32 s7, 0x00020000
    s_mov_b32 s40, s92
    s_and_b32 s41, s93, 0xffff
    s_mov_b32 s42, 0x800000
    s_mov_b32 s43, 0x00020000
    s_add_u32 m0, s72, 0
    s_mov_b32 s73, 0
    buffer_load_dwordx4 v163, s[12:15], s73 offen nt lds
    s_add_u32 m0, s72, 1024
    s_mov_b32 s73, 0
    buffer_load_dwordx4 v164, s[12:15], s73 offen nt lds
    s_add_u32 m0, s72, 2048
    s_mov_b32 s73, 131072
    buffer_load_dwordx4 v163, s[12:15], s73 offen nt lds
    s_add_u32 m0, s72, 3072
    s_mov_b32 s73, 131072
    buffer_load_dwordx4 v164, s[12:15], s73 offen nt lds
    s_mov_b32 s73, 0
    buffer_load_dwordx4 v[32:35], v165, s[4:7], s73 offen nt
    s_mov_b32 s73, 0
    buffer_load_dwordx4 v[96:99], v166, s[40:43], s73 offen nt
    s_mov_b32 s73, 131072
    buffer_load_dwordx4 v[36:39], v165, s[4:7], s73 offen nt
    s_mov_b32 s73, 16384
    buffer_load_dwordx4 v[100:103], v166, s[40:43], s73 offen nt
    s_mov_b32 s24, 0x00ff00ff
    s_mov_b32 s25, 0x00ff00ff
    s_mov_b32 s26, 0x55555555
    s_mov_b32 s27, 0x55555555
    s_mov_b32 s56, 0x3fb8aa3b
    s_mov_b32 s57, 0x3fb8aa3b
    s_mov_b32 s58, 0x3db504f3
    s_mov_b32 s59, 0x3db504f3
    s_lshl_b32 s53, s16, 16
    s_add_u32 s53, s53, 0xb000000
    s_lshl_b32 s47, s16, 5
    s_add_u32 s47, s47, s17
    s_mov_b64 s[60:61], s[98:99]
    v_mov_b32 v28, -1
    v_mov_b32 v29, -1
    v_mov_b32 v30, -1
    v_mov_b32 v31, -1
    v_and_b32 v210, 63, v0
    v_and_b32 v208, 15, v0
    v_bfe_u32 v209, v0, 4, 2
    v_lshlrev_b32 v1, 4, v210
    v_lshlrev_b32 v26, 3, v210
    s_lshl_b32 s21, s18, 12
    v_add_u32 v2, s21, v1
    s_xor_b32 s22, s18, 3
    s_lshl_b32 s22, s22, 4
    v_xor_b32 v3, s22, v2
    v_add_u32 v3, 16384, v3
    s_and_b32 s22, s22, 16
    s_lshl_b32 s22, s22, 1
    v_xor_b32 v2, s22, v2
    v_mov_b32 v19, 0xeeeeeeee
    v_mov_b32 v212, 0x44444444
    v_cndmask_b32 v19, v19, v212, s[24:25]
    v_mov_b32 v18, 0x03020706
    v_mov_b32 v212, 0x05040100
    v_cndmask_b32 v18, v18, v212, s[26:27]
    s_lshr_b32 s21, s17, 2
    s_lshl_b32 s21, s21, 12
    s_add_u32 s21, s21, 32768
    v_add_u32 v5, s21, v1
    s_and_b32 s22, s28, 1
    s_lshl_b32 s22, s22, 11
    s_add_u32 s21, s21, s22
    s_bfe_u32 s22, s28, 0x10001
    s_lshl_b32 s22, s22, 7
    s_add_u32 s23, s21, s22
    s_add_u32 m0, s72, 4096
    s_mov_b32 s73, 262144
    buffer_load_dwordx4 v163, s[12:15], s73 offen nt lds
    s_add_u32 m0, s72, 5120
    s_mov_b32 s73, 262144
    buffer_load_dwordx4 v164, s[12:15], s73 offen nt lds
    s_add_u32 m0, s72, 6144
    s_mov_b32 s73, 393216
    buffer_load_dwordx4 v163, s[12:15], s73 offen nt lds
    s_add_u32 m0, s72, 7168
    s_mov_b32 s73, 393216
    buffer_load_dwordx4 v164, s[12:15], s73 offen nt lds
    s_mov_b32 s73, 262144
    buffer_load_dwordx4 v[40:43], v165, s[4:7], s73 offen nt
    s_mov_b32 s73, 65536
    buffer_load_dwordx4 v[104:107], v166, s[40:43], s73 offen nt
    s_mov_b32 s73, 393216
    buffer_load_dwordx4 v[44:47], v165, s[4:7], s73 offen nt
    s_mov_b32 s73, 81920
    buffer_load_dwordx4 v[108:111], v166, s[40:43], s73 offen nt
    v_and_b32 v212, 1, v209
    v_lshlrev_b32 v234, 6, v212
    v_and_b32 v212, 1, v208
    v_lshl_add_u32 v234, v212, 4, v234
    v_bfe_u32 v212, v208, 1, 2
    v_lshl_add_u32 v234, v212, 2, v234
    s_and_b32 s22, s18, 1
    s_lshl_b32 s22, s22, 5
    v_add_u32 v234, s22, v234
    v_lshrrev_b32 v212, 3, v208
    v_and_b32 v213, 2, v209
    v_add_u32 v212, v212, v213
    s_and_b32 s22, s18, 2
    s_lshl_b32 s22, s22, 1
    v_add_u32 v212, s22, v212
    v_lshl_add_u32 v4, v212, 8, v234
    v_lshl_add_u32 v234, v212, 7, v234
    v_add_u32 v4, s23, v4
    v_lshrrev_b32 v212, 3, v210
    v_and_b32 v213, 7, v210
    v_lshlrev_b32 v22, 8, v212
    v_lshl_add_u32 v22, v213, 4, v22
    v_add_u32 v22, s23, v22
    s_lshr_b32 s20, s47, 2
    s_add_u32 m0, s72, 8192
    s_mov_b32 s73, 524288
    buffer_load_dwordx4 v163, s[12:15], s73 offen nt lds
    s_add_u32 m0, s72, 9216
    s_mov_b32 s73, 524288
    buffer_load_dwordx4 v164, s[12:15], s73 offen nt lds
    s_add_u32 m0, s72, 10240
    s_mov_b32 s73, 655360
    buffer_load_dwordx4 v163, s[12:15], s73 offen nt lds
    s_add_u32 m0, s72, 11264
    s_mov_b32 s73, 655360
    buffer_load_dwordx4 v164, s[12:15], s73 offen nt lds
    s_mov_b32 s73, 524288
    buffer_load_dwordx4 v[48:51], v165, s[4:7], s73 offen nt
    s_mov_b32 s73, 131072
    buffer_load_dwordx4 v[112:115], v166, s[40:43], s73 offen nt
    s_mov_b32 s73, 655360
    buffer_load_dwordx4 v[52:55], v165, s[4:7], s73 offen nt
    s_mov_b32 s73, 147456
    buffer_load_dwordx4 v[116:119], v166, s[40:43], s73 offen nt
    s_lshl_b32 s48, s20, 16
    s_and_b32 s21, s17, 3
    s_lshl_b32 s22, s21, 11
    s_add_u32 s22, s22, 0x4000
    v_add_u32 v237, s22, v1
    v_lshlrev_b32 v236, 7, v208
    v_and_b32 v212, 1, v209
    v_lshl_add_u32 v236, v212, 15, v236
    s_lshl_b32 s22, s21, 11
    v_add_u32 v236, s22, v236
    v_mov_b32 v25, v236
    s_cmp_lt_u32 s18, 2
    s_cselect_b32 s38, 0xf0000000, 0
    s_cmp_lg_u32 s18, 1
    s_cselect_b32 s39, 0xf0000000, 0
    s_lshr_b32 s22, s18, 1
    s_mul_i32 s54, s22, 10240
    s_lshl_b32 s22, s22, 15
    s_and_b32 s23, s18, 1
    s_lshl_b32 s23, s23, 12
    s_add_u32 s54, s54, s23
    s_add_u32 s54, s54, 32768
    s_add_u32 s22, s22, s23
    v_add_u32 v235, s22, v1
    s_add_u32 m0, s72, 12288
    s_mov_b32 s73, 786432
    buffer_load_dwordx4 v163, s[12:15], s73 offen nt lds
    s_add_u32 m0, s72, 13312
    s_mov_b32 s73, 786432
    buffer_load_dwordx4 v164, s[12:15], s73 offen nt lds
    s_add_u32 m0, s72, 14336
    s_mov_b32 s73, 917504
    buffer_load_dwordx4 v163, s[12:15], s73 offen nt lds
    s_add_u32 m0, s72, 15360
    s_mov_b32 s73, 917504
    buffer_load_dwordx4 v164, s[12:15], s73 offen nt lds
    s_mov_b32 s73, 786432
    buffer_load_dwordx4 v[56:59], v165, s[4:7], s73 offen nt
    s_mov_b32 s73, 196608
    buffer_load_dwordx4 v[120:123], v166, s[40:43], s73 offen nt
    s_mov_b32 s73, 917504
    buffer_load_dwordx4 v[60:63], v165, s[4:7], s73 offen nt
    s_mov_b32 s73, 212992
    buffer_load_dwordx4 v[124:127], v166, s[40:43], s73 offen nt
    s_lshl_b32 s51, s18, 11
    v_add_u32 v243, s51, v1
    v_add_u32 v244, 0x8000, v243
    v_lshrrev_b32 v212, 3, v210
    v_lshl_add_u32 v24, v212, 7, v5
    v_add_u32 v24, 128, v24
    s_and_b32 s22, s18, 1
    s_lshl_b32 s22, s22, 12
    v_add_u32 v242, s22, v1
    s_lshl_b32 s21, s21, 10
    s_add_u32 s21, s21, 0xc000
    v_add_u32 v23, s21, v242
    v_lshlrev_b32 v241, 7, v209
    v_bfe_u32 v212, v0, 2, 1
    v_lshl_add_u32 v241, v212, 6, v241
    v_bfe_u32 v212, v0, 3, 1
    v_lshl_add_u32 v241, v212, 5, v241
    v_bfe_u32 v212, v0, 0, 1
    v_lshl_add_u32 v241, v212, 4, v241
    v_and_b32 v212, 7, v208
    v_lshlrev_b32 v6, 4, v212
    v_lshl_add_u32 v6, v209, 7, v6
    s_lshl_b32 s21, s17, 9
    s_add_u32 s22, s21, 16384
    s_add_u32 m0, s72, 16384
    s_mov_b32 s73, 1048576
    buffer_load_dwordx4 v163, s[12:15], s73 offen nt lds
    s_add_u32 m0, s72, 17408
    s_mov_b32 s73, 1048576
    buffer_load_dwordx4 v164, s[12:15], s73 offen nt lds
    s_add_u32 m0, s72, 18432
    s_mov_b32 s73, 1179648
    buffer_load_dwordx4 v163, s[12:15], s73 offen nt lds
    s_add_u32 m0, s72, 19456
    s_mov_b32 s73, 1179648
    buffer_load_dwordx4 v164, s[12:15], s73 offen nt lds
    s_mov_b32 s73, 1048576
    buffer_load_dwordx4 v[64:67], v165, s[4:7], s73 offen nt
    s_mov_b32 s73, 262144
    buffer_load_dwordx4 v[128:131], v166, s[40:43], s73 offen nt
    s_mov_b32 s73, 1179648
    buffer_load_dwordx4 v[68:71], v165, s[4:7], s73 offen nt
    s_mov_b32 s73, 278528
    buffer_load_dwordx4 v[132:135], v166, s[40:43], s73 offen nt
    v_add_u32 v6, s22, v6
    v_lshrrev_b32 v212, 3, v208
    v_and_b32 v213, 2, v209
    v_add_u32 v212, v212, v213
    v_lshlrev_b32 v7, 7, v212
    v_and_b32 v212, 1, v209
    v_lshl_add_u32 v7, v212, 6, v7
    v_bfe_u32 v212, v208, 1, 2
    v_lshl_add_u32 v7, v212, 2, v7
    s_lshl_b32 s21, s29, 9
    s_lshl_b32 s22, s18, 4
    s_add_u32 s21, s21, s22
    v_add_u32 v7, s21, v7
    v_bfe_u32 v212, v210, 1, 3
    v_and_b32 v213, 1, v210
    v_lshlrev_b32 v27, 11, v212
    v_lshl_add_u32 v27, v213, 3, v27
    v_lshl_add_u32 v27, v209, 4, v27
    s_lshl_b32 s21, s29, 6
    v_add_u32 v27, s21, v27
    v_lshlrev_b32 v212, 2, v210
    s_xor_b32 s21, s18, 3
    s_mul_i32 s21, s21, 768
    s_add_u32 s21, s21, 0
    s_add_u32 m0, s72, 20480
    s_mov_b32 s73, 1310720
    buffer_load_dwordx4 v163, s[12:15], s73 offen nt lds
    s_add_u32 m0, s72, 21504
    s_mov_b32 s73, 1310720
    buffer_load_dwordx4 v164, s[12:15], s73 offen nt lds
    s_add_u32 m0, s72, 22528
    s_mov_b32 s73, 1441792
    buffer_load_dwordx4 v163, s[12:15], s73 offen nt lds
    s_add_u32 m0, s72, 23552
    s_mov_b32 s73, 1441792
    buffer_load_dwordx4 v164, s[12:15], s73 offen nt lds
    s_mov_b32 s73, 1310720
    buffer_load_dwordx4 v[72:75], v165, s[4:7], s73 offen nt
    s_mov_b32 s73, 327680
    buffer_load_dwordx4 v[136:139], v166, s[40:43], s73 offen nt
    s_mov_b32 s73, 1441792
    buffer_load_dwordx4 v[76:79], v165, s[4:7], s73 offen nt
    s_mov_b32 s73, 344064
    buffer_load_dwordx4 v[140:143], v166, s[40:43], s73 offen nt
    v_add_u32 v238, s21, v212
    v_lshlrev_b32 v12, 1, v238
    s_xor_b32 s21, s18, 2
    s_mul_i32 s21, s21, 768
    s_add_u32 s21, s21, 256
    v_add_u32 v239, s21, v212
    v_lshlrev_b32 v13, 1, v239
    s_xor_b32 s21, s18, 1
    s_mul_i32 s21, s21, 768
    s_add_u32 s21, s21, 512
    v_add_u32 v240, s21, v212
    v_lshlrev_b32 v14, 1, v240
    s_mul_i32 s21, s18, 768
    v_add_u32 v17, s21, v212
    v_lshlrev_b32 v15, 1, v17
    s_lshl_b32 s21, s18, 10
    v_add_u32 v16, s21, v1
    global_load_dwordx2 v[246:247], v27, s[84:85]
    v_and_b32 v208, 15, v0
    v_bfe_u32 v209, v0, 6, 1
    v_lshl_add_u32 v208, v209, 4, v208
    v_bfe_u32 v209, v0, 4, 2
    v_lshlrev_b32 v209, 2, v209
    v_sub_u32 v208, v208, v209
    s_or_b32 s76, s95, s18
    s_cbranch_scc1 L_rw_2
    s_lshl_b32 s78, s16, 3
    s_add_u32 s78, s78, 128
    s_mov_b32 s79, 0
L_rp_3:
    s_load_dwordx2 s[76:77], s[98:99], s78 glc
    s_add_u32 s79, s79, 1
    s_cmp_gt_u32 s79, 0x100000
    s_cbranch_scc1 chain_kernel_abort
    s_waitcnt lgkmcnt(0)
    s_cmp_lt_u32 s77, 0x2000
    s_cbranch_scc1 L_rp_3
    s_lshr_b32 s77, s1, 8
    s_cmp_eq_u32 s76, -1
    s_cselect_b32 s0, -1, s77
L_rw_2:
    s_waitcnt vmcnt(44)
    s_add_u32 m0, s72, 24576
    s_mov_b32 s73, 1572864
    buffer_load_dwordx4 v163, s[12:15], s73 offen nt lds
    s_add_u32 m0, s72, 25600
    s_mov_b32 s73, 1572864
    buffer_load_dwordx4 v164, s[12:15], s73 offen nt lds
    s_add_u32 m0, s72, 26624
    s_mov_b32 s73, 1703936
    buffer_load_dwordx4 v163, s[12:15], s73 offen nt lds
    s_add_u32 m0, s72, 27648
    s_mov_b32 s73, 1703936
    buffer_load_dwordx4 v164, s[12:15], s73 offen nt lds
    s_mov_b32 s73, 1572864
    buffer_load_dwordx4 v[80:83], v165, s[4:7], s73 offen nt
    s_mov_b32 s73, 393216
    buffer_load_dwordx4 v[144:147], v166, s[40:43], s73 offen nt
    s_mov_b32 s73, 1703936
    buffer_load_dwordx4 v[84:87], v165, s[4:7], s73 offen nt
    s_mov_b32 s73, 409600
    buffer_load_dwordx4 v[148:151], v166, s[40:43], s73 offen nt
    v_mov_b32 v209, 0xff800000
    v_cmp_gt_i32 vcc, 0, v208
    s_nop 1
    v_cndmask_b32 v226, 0, v209, vcc
    v_cmp_gt_i32 vcc, 1, v208
    s_nop 1
    v_cndmask_b32 v227, 0, v209, vcc
    v_cmp_gt_i32 vcc, 2, v208
    s_nop 1
    v_cndmask_b32 v228, 0, v209, vcc
    v_cmp_gt_i32 vcc, 3, v208
    s_nop 1
    v_cndmask_b32 v229, 0, v209, vcc
    v_cmp_gt_i32 vcc, 16, v208
    s_nop 1
    v_cndmask_b32 v230, 0, v209, vcc
    v_cmp_gt_i32 vcc, 17, v208
    s_nop 1
    v_cndmask_b32 v231, 0, v209, vcc
    v_cmp_gt_i32 vcc, 18, v208
    s_nop 1
    v_cndmask_b32 v232, 0, v209, vcc
    v_cmp_gt_i32 vcc, 19, v208
    s_nop 1
    v_cndmask_b32 v233, 0, v209, vcc
    s_waitcnt vmcnt(44)
    s_add_u32 m0, s72, 28672
    s_mov_b32 s73, 1835008
    buffer_load_dwordx4 v163, s[12:15], s73 offen nt lds
    s_add_u32 m0, s72, 29696
    s_mov_b32 s73, 1835008
    buffer_load_dwordx4 v164, s[12:15], s73 offen nt lds
    s_add_u32 m0, s72, 30720
    s_mov_b32 s73, 1966080
    buffer_load_dwordx4 v163, s[12:15], s73 offen nt lds
    s_add_u32 m0, s72, 31744
    s_mov_b32 s73, 1966080
    buffer_load_dwordx4 v164, s[12:15], s73 offen nt lds
    s_mov_b32 s73, 1835008
    buffer_load_dwordx4 v[88:91], v165, s[4:7], s73 offen nt
    s_mov_b32 s73, 458752
    buffer_load_dwordx4 v[152:155], v166, s[40:43], s73 offen nt
    s_mov_b32 s73, 1966080
    buffer_load_dwordx4 v[92:95], v165, s[4:7], s73 offen nt
    s_mov_b32 s73, 475136
    buffer_load_dwordx4 v[156:159], v166, s[40:43], s73 offen nt
    s_cmp_lg_u32 s95, 0
    s_cbranch_scc1 L_rok_4
    v_mov_b32 v208, 31744
    s_cmp_lg_u32 s18, 0
    s_cbranch_scc1 L_rw_5
    v_mov_b32 v209, s0
    ds_write_b32 v208, v209
    s_waitcnt lgkmcnt(0)
L_rw_5:
    s_barrier
    ds_read_b32 v209, v208
    s_waitcnt lgkmcnt(0)
    v_readfirstlane_b32 s20, v209
    s_mov_b32 s95, 1
    s_cmp_eq_u32 s20, -1
    s_cbranch_scc1 L_rok_4
    s_mov_b32 s17, s20
    s_waitcnt vmcnt(0)
    s_barrier
    s_cmp_ge_u32 s17, 32
    s_cbranch_scc1 chain_kernel_end
    s_branch chain_start
L_rok_4:
    s_lshl_b32 s42, s18, 18
    s_add_u32 s42, s42, s53
    buffer_store_dwordx4 v[28:31], v22, s[8:11], s42 offen
    s_lshl_b32 s21, s29, 9
    s_add_u32 s21, s21, s42
    buffer_store_dwordx2 v[28:29], v26, s[8:11], s21 offen
    s_xor_b32 s21, s21, 20480
    buffer_store_dwordx2 v[28:29], v26, s[8:11], s21 offen
    s_lshl_b32 s62, s16, 8
    s_add_u32 s62, s62, 0xb200000
    s_cmp_eq_u32 s17, 1
    s_cselect_b32 s21, s62, 0x10000000
    v_mov_b32 v248, 0
    s_add_u32 s21, s21, 4096
    buffer_store_dword v248, v248, s[8:11], s21 offen sc1
    v_mov_b32 v249, 4
    global_load_dword v249, v249, s[60:61] sc1
    v_bfe_u32 v160, v0, 4, 2
    v_lshlrev_b32 v160, 3, v160
    v_bfe_u32 v162, v0, 2, 2
    v_add_u32 v160, v160, v162
    v_and_b32 v161, 3, v0
    v_bfe_u32 v163, v0, 3, 1
    v_lshlrev_b32 v162, 7, v160
    v_and_b32 v164, 1, v0
    v_lshl_add_u32 v162, v164, 5, v162
    v_bfe_u32 v164, v0, 1, 1
    v_lshl_add_u32 v162, v164, 3, v162
    v_lshl_add_u32 v162, v163, 4, v162
    s_lshr_b32 s21, s18, 1
    s_xor_b32 s21, s21, 1
    s_lshl_b32 s21, s21, 6
    s_add_u32 s21, s21, s72
    v_add_u32 v167, s21, v162
    v_xor_b32 v168, 256, v167
    s_lshr_b32 s21, s18, 1
    s_xor_b32 s21, s21, 0
    s_lshl_b32 s21, s21, 6
    s_add_u32 s21, s21, s72
    v_add_u32 v169, s21, v162
    v_xor_b32 v170, 256, v169
    s_waitcnt vmcnt(44)
    ds_read_b64_tr_b16 a[0:1], v167 offset:0
    ds_read_b64_tr_b16 a[2:3], v167 offset:512
    ds_read_b64_tr_b16 a[4:5], v167 offset:4096
    ds_read_b64_tr_b16 a[6:7], v167 offset:4608
    ds_read_b64_tr_b16 a[32:33], v168 offset:0
    ds_read_b64_tr_b16 a[34:35], v168 offset:512
    ds_read_b64_tr_b16 a[36:37], v168 offset:4096
    ds_read_b64_tr_b16 a[38:39], v168 offset:4608
    s_waitcnt lgkmcnt(0)
    ds_read_b64_tr_b16 a[64:65], v169 offset:0
    ds_read_b64_tr_b16 a[66:67], v169 offset:512
    ds_read_b64_tr_b16 a[68:69], v169 offset:4096
    ds_read_b64_tr_b16 a[70:71], v169 offset:4608
    ds_read_b64_tr_b16 a[96:97], v170 offset:0
    ds_read_b64_tr_b16 a[98:99], v170 offset:512
    ds_read_b64_tr_b16 a[100:101], v170 offset:4096
    ds_read_b64_tr_b16 a[102:103], v170 offset:4608
    s_waitcnt lgkmcnt(0)
    s_waitcnt vmcnt(41)
    ds_read_b64_tr_b16 a[8:9], v167 offset:8192
    ds_read_b64_tr_b16 a[10:11], v167 offset:8704
    ds_read_b64_tr_b16 a[12:13], v167 offset:12288
    ds_read_b64_tr_b16 a[14:15], v167 offset:12800
    ds_read_b64_tr_b16 a[40:41], v168 offset:8192
    ds_read_b64_tr_b16 a[42:43], v168 offset:8704
    ds_read_b64_tr_b16 a[44:45], v168 offset:12288
    ds_read_b64_tr_b16 a[46:47], v168 offset:12800
    s_waitcnt lgkmcnt(0)
    ds_read_b64_tr_b16 a[72:73], v169 offset:8192
    ds_read_b64_tr_b16 a[74:75], v169 offset:8704
    ds_read_b64_tr_b16 a[76:77], v169 offset:12288
    ds_read_b64_tr_b16 a[78:79], v169 offset:12800
    ds_read_b64_tr_b16 a[104:105], v170 offset:8192
    ds_read_b64_tr_b16 a[106:107], v170 offset:8704
    ds_read_b64_tr_b16 a[108:109], v170 offset:12288
    ds_read_b64_tr_b16 a[110:111], v170 offset:12800
    s_waitcnt lgkmcnt(0)
    s_waitcnt vmcnt(25)
    ds_read_b64_tr_b16 a[16:17], v167 offset:16384
    ds_read_b64_tr_b16 a[18:19], v167 offset:16896
    ds_read_b64_tr_b16 a[20:21], v167 offset:20480
    ds_read_b64_tr_b16 a[22:23], v167 offset:20992
    ds_read_b64_tr_b16 a[48:49], v168 offset:16384
    ds_read_b64_tr_b16 a[50:51], v168 offset:16896
    ds_read_b64_tr_b16 a[52:53], v168 offset:20480
    ds_read_b64_tr_b16 a[54:55], v168 offset:20992
    s_waitcnt lgkmcnt(0)
    ds_read_b64_tr_b16 a[80:81], v169 offset:16384
    ds_read_b64_tr_b16 a[82:83], v169 offset:16896
    ds_read_b64_tr_b16 a[84:85], v169 offset:20480
    ds_read_b64_tr_b16 a[86:87], v169 offset:20992
    ds_read_b64_tr_b16 a[112:113], v170 offset:16384
    ds_read_b64_tr_b16 a[114:115], v170 offset:16896
    ds_read_b64_tr_b16 a[116:117], v170 offset:20480
    ds_read_b64_tr_b16 a[118:119], v170 offset:20992
    s_waitcnt lgkmcnt(0)
    s_waitcnt vmcnt(9)
    ds_read_b64_tr_b16 a[24:25], v167 offset:24576
    ds_read_b64_tr_b16 a[26:27], v167 offset:25088
    ds_read_b64_tr_b16 a[28:29], v167 offset:28672
    ds_read_b64_tr_b16 a[30:31], v167 offset:29184
    ds_read_b64_tr_b16 a[56:57], v168 offset:24576
    ds_read_b64_tr_b16 a[58:59], v168 offset:25088
    ds_read_b64_tr_b16 a[60:61], v168 offset:28672
    ds_read_b64_tr_b16 a[62:63], v168 offset:29184
    s_waitcnt lgkmcnt(0)
    ds_read_b64_tr_b16 a[88:89], v169 offset:24576
    ds_read_b64_tr_b16 a[90:91], v169 offset:25088
    ds_read_b64_tr_b16 a[92:93], v169 offset:28672
    ds_read_b64_tr_b16 a[94:95], v169 offset:29184
    ds_read_b64_tr_b16 a[120:121], v170 offset:24576
    ds_read_b64_tr_b16 a[122:123], v170 offset:25088
    ds_read_b64_tr_b16 a[124:125], v170 offset:28672
    ds_read_b64_tr_b16 a[126:127], v170 offset:29184
    s_waitcnt lgkmcnt(0)
    v_add_u32 v171, s72, v1
    v_lshlrev_b32 v162, 6, v160
    v_add_u32 v162, s72, v162
    v_lshl_add_u32 v169, v161, 3, v162
    v_lshl_add_u32 v169, v163, 5, v169
    v_xor_b32 v170, 128, v169
    s_waitcnt vmcnt(0)
    s_barrier
    v_and_b32 v208, 15, v0
    v_lshlrev_b32 v208, 7, v208
    s_lshl_b32 s21, s17, 11
    s_add_u32 s21, s21, s42
    buffer_load_dword v250, v208, s[8:11], s21 offen sc1
    s_cmp_lg_u32 s18, 0
    s_cbranch_scc1 L_m0_6
    s_lshl2_add_u32 s21, s17, s62
    buffer_store_dword v28, v248, s[8:11], s21 offen
    s_lshl_b32 s21, s29, 9
    s_add_u32 s21, s21, s53
    v_min_u32 v246, 0xfffffffe, v246
    v_min_u32 v247, 0xfffffffe, v247
    buffer_store_dwordx2 v[246:247], v26, s[8:11], s21 offen
L_m0_6:
    ds_write_b128 v171, v[32:35] offset:0
    ds_write_b128 v171, v[36:39] offset:1024
    ds_write_b128 v171, v[40:43] offset:2048
    ds_write_b128 v171, v[44:47] offset:3072
    ds_write_b128 v171, v[48:51] offset:4096
    ds_write_b128 v171, v[52:55] offset:5120
    ds_write_b128 v171, v[56:59] offset:6144
    ds_write_b128 v171, v[60:63] offset:7168
    ds_write_b128 v171, v[64:67] offset:8192
    ds_write_b128 v171, v[68:71] offset:9216
    ds_write_b128 v171, v[72:75] offset:10240
    ds_write_b128 v171, v[76:79] offset:11264
    ds_write_b128 v171, v[80:83] offset:12288
    ds_write_b128 v171, v[84:87] offset:13312
    ds_write_b128 v171, v[88:91] offset:14336
    ds_write_b128 v171, v[92:95] offset:15360
    s_waitcnt lgkmcnt(0)
    ds_read_b64_tr_b16 a[128:129], v169 offset:0
    ds_read_b64_tr_b16 a[130:131], v169 offset:256
    ds_read_b64_tr_b16 a[132:133], v169 offset:2048
    ds_read_b64_tr_b16 a[134:135], v169 offset:2304
    ds_read_b64_tr_b16 a[160:161], v170 offset:0
    ds_read_b64_tr_b16 a[162:163], v170 offset:256
    ds_read_b64_tr_b16 a[164:165], v170 offset:2048
    ds_read_b64_tr_b16 a[166:167], v170 offset:2304
    s_waitcnt lgkmcnt(0)
    ds_read_b64_tr_b16 a[136:137], v169 offset:4096
    ds_read_b64_tr_b16 a[138:139], v169 offset:4352
    ds_read_b64_tr_b16 a[140:141], v169 offset:6144
    ds_read_b64_tr_b16 a[142:143], v169 offset:6400
    ds_read_b64_tr_b16 a[168:169], v170 offset:4096
    ds_read_b64_tr_b16 a[170:171], v170 offset:4352
    ds_read_b64_tr_b16 a[172:173], v170 offset:6144
    ds_read_b64_tr_b16 a[174:175], v170 offset:6400
    s_waitcnt lgkmcnt(0)
    ds_read_b64_tr_b16 a[144:145], v169 offset:8192
    ds_read_b64_tr_b16 a[146:147], v169 offset:8448
    ds_read_b64_tr_b16 a[148:149], v169 offset:10240
    ds_read_b64_tr_b16 a[150:151], v169 offset:10496
    ds_read_b64_tr_b16 a[176:177], v170 offset:8192
    ds_read_b64_tr_b16 a[178:179], v170 offset:8448
    ds_read_b64_tr_b16 a[180:181], v170 offset:10240
    ds_read_b64_tr_b16 a[182:183], v170 offset:10496
    s_waitcnt lgkmcnt(0)
    ds_read_b64_tr_b16 a[152:153], v169 offset:12288
    ds_read_b64_tr_b16 a[154:155], v169 offset:12544
    ds_read_b64_tr_b16 a[156:157], v169 offset:14336
    ds_read_b64_tr_b16 a[158:159], v169 offset:14592
    ds_read_b64_tr_b16 a[184:185], v170 offset:12288
    ds_read_b64_tr_b16 a[186:187], v170 offset:12544
    ds_read_b64_tr_b16 a[188:189], v170 offset:14336
    ds_read_b64_tr_b16 a[190:191], v170 offset:14592
    s_waitcnt lgkmcnt(0)
    ds_write_b128 v171, v[96:99] offset:16384
    ds_write_b128 v171, v[100:103] offset:17408
    ds_write_b128 v171, v[104:107] offset:18432
    ds_write_b128 v171, v[108:111] offset:19456
    ds_write_b128 v171, v[112:115] offset:20480
    ds_write_b128 v171, v[116:119] offset:21504
    ds_write_b128 v171, v[120:123] offset:22528
    ds_write_b128 v171, v[124:127] offset:23552
    ds_write_b128 v171, v[128:131] offset:24576
    ds_write_b128 v171, v[132:135] offset:25600
    ds_write_b128 v171, v[136:139] offset:26624
    ds_write_b128 v171, v[140:143] offset:27648
    ds_write_b128 v171, v[144:147] offset:28672
    ds_write_b128 v171, v[148:151] offset:29696
    ds_write_b128 v171, v[152:155] offset:30720
    ds_write_b128 v171, v[156:159] offset:31744
    s_waitcnt lgkmcnt(0)
    ds_read_b64_tr_b16 a[192:193], v169 offset:16384
    ds_read_b64_tr_b16 a[194:195], v169 offset:16640
    ds_read_b64_tr_b16 a[196:197], v169 offset:18432
    ds_read_b64_tr_b16 a[198:199], v169 offset:18688
    ds_read_b64_tr_b16 a[224:225], v170 offset:16384
    ds_read_b64_tr_b16 a[226:227], v170 offset:16640
    ds_read_b64_tr_b16 a[228:229], v170 offset:18432
    ds_read_b64_tr_b16 a[230:231], v170 offset:18688
    s_waitcnt lgkmcnt(0)
    ds_read_b64_tr_b16 a[200:201], v169 offset:20480
    ds_read_b64_tr_b16 a[202:203], v169 offset:20736
    ds_read_b64_tr_b16 a[204:205], v169 offset:22528
    ds_read_b64_tr_b16 a[206:207], v169 offset:22784
    ds_read_b64_tr_b16 a[232:233], v170 offset:20480
    ds_read_b64_tr_b16 a[234:235], v170 offset:20736
    ds_read_b64_tr_b16 a[236:237], v170 offset:22528
    ds_read_b64_tr_b16 a[238:239], v170 offset:22784
    s_waitcnt lgkmcnt(0)
    ds_read_b64_tr_b16 a[208:209], v169 offset:24576
    ds_read_b64_tr_b16 a[210:211], v169 offset:24832
    ds_read_b64_tr_b16 a[212:213], v169 offset:26624
    ds_read_b64_tr_b16 a[214:215], v169 offset:26880
    ds_read_b64_tr_b16 a[240:241], v170 offset:24576
    ds_read_b64_tr_b16 a[242:243], v170 offset:24832
    ds_read_b64_tr_b16 a[244:245], v170 offset:26624
    ds_read_b64_tr_b16 a[246:247], v170 offset:26880
    s_waitcnt lgkmcnt(0)
    ds_read_b64_tr_b16 a[216:217], v169 offset:28672
    ds_read_b64_tr_b16 a[218:219], v169 offset:28928
    ds_read_b64_tr_b16 a[220:221], v169 offset:30720
    ds_read_b64_tr_b16 a[222:223], v169 offset:30976
    ds_read_b64_tr_b16 a[248:249], v170 offset:28672
    ds_read_b64_tr_b16 a[250:251], v170 offset:28928
    ds_read_b64_tr_b16 a[252:253], v170 offset:30720
    ds_read_b64_tr_b16 a[254:255], v170 offset:30976
    s_waitcnt lgkmcnt(0)
    s_mov_b32 s19, 0
    s_mov_b32 s55, 0
    s_mov_b32 s30, 0xc0000
    s_mov_b32 s41, s53
    v_mov_b32 v197, 0
    v_mov_b32 v198, 0
    v_mov_b32 v216, 0x3f803f80
    v_mov_b32 v217, 0x3f803f80
    v_mov_b32 v218, 0x3f803f80
    v_mov_b32 v219, 0x3f803f80
    v_mov_b32 v248, 4
    s_branch L_kvw_7_c
L_kvw_7:
    global_load_dword v249, v248, s[60:61] sc1
    s_add_u32 s33, s33, 1
    s_cmp_gt_u32 s33, 0x100000
    s_cbranch_scc1 chain_kernel_abort
    s_waitcnt vmcnt(0)
L_kvw_7_c:
    v_readfirstlane_b32 s20, v249
    s_and_b32 s21, s20, 0xff
    s_cmp_ge_u32 s21, 15
    s_cbranch_scc1 L_kvok_8
    s_sleep 16
    s_branch L_kvw_7
L_kvok_8:
    s_cmp_ge_u32 s20, 0x800
    s_cselect_b32 s50, 0x2000, 0
    s_add_u32 s52, s50, 0x8000000
    s_add_u32 s48, s48, s50
    v_and_b32 v208, 63, v0
    v_lshlrev_b32 v208, 2, v208
    s_lshr_b32 s22, s17, 3
    s_lshl_b32 s22, s22, 14
    s_and_b32 s23, s17, 7
    s_lshl_b32 s23, s23, 10
    s_add_u32 s22, s22, s23
    s_lshl_b32 s23, s18, 8
    s_add_u32 s22, s22, s23
    s_xor_b32 s21, s16, 0
    s_lshl_b32 s21, s21, 16
    s_add_u32 s21, s21, s22
    v_add_u32 v8, s21, v208
    s_xor_b32 s21, s16, 1
    s_lshl_b32 s21, s21, 16
    s_add_u32 s21, s21, s22
    v_add_u32 v9, s21, v208
    s_xor_b32 s21, s16, 2
    s_lshl_b32 s21, s21, 16
    s_add_u32 s21, s21, s22
    v_add_u32 v10, s21, v208
    s_xor_b32 s21, s16, 3
    s_lshl_b32 s21, s21, 16
    s_add_u32 s21, s21, s22
    v_add_u32 v11, s21, v208
    s_barrier
    s_add_u32 s21, s19, 0
    s_min_u32 s21, s21, 63
    s_lshl_b32 s31, s21, 21
    s_lshl_b32 s21, s21, 13
    s_and_b32 s21, s21, 0x2000
    s_xor_b32 s21, s21, s48
    s_add_u32 s31, s31, s21
    s_cmp_lg_u32 s18, 1
    s_cbranch_scc1 L_init0_9
    v_mov_b32 v248, 0
    s_lshl2_add_u32 s20, s17, s18
    s_cmp_lg_u32 s20, 5
    s_cbranch_scc1 L_rlo_11
L_rl_10:
    s_load_dword s20, s[60:61], 64 glc
    s_add_u32 s33, s33, 1
    s_cmp_gt_u32 s33, 0x100000
    s_cbranch_scc1 chain_kernel_abort
    s_waitcnt lgkmcnt(0)
    s_cmp_lt_u32 s20, 96
    s_cbranch_scc1 L_rl_10
    v_mov_b32 v249, 1
    buffer_store_dword v249, v248, s[8:11], s62 offen offset:128
    s_branch L_rlok_12
L_rlo_11:
    buffer_load_dword v249, v248, s[8:11], s62 offen offset:128 sc1
    s_add_u32 s33, s33, 1
    s_cmp_gt_u32 s33, 0x100000
    s_cbranch_scc1 chain_kernel_abort
    s_waitcnt vmcnt(0)
    v_readfirstlane_b32 s20, v249
    s_cmp_ge_u32 s20, 1
    s_cbranch_scc1 L_rlok_12
    s_sleep 1
    s_branch L_rlo_11
L_rlok_12:
    s_mov_b32 m0, 40960
    s_nop 0
    buffer_load_dwordx4 v237, s[8:11], s31 offen offset:0 lds
    buffer_load_dwordx4 v237, s[8:11], s31 offen offset:1024 lds
L_init0_9:
    s_cmp_lg_u32 s18, 2
    s_cbranch_scc1 L_init2_13
    v_and_b32 v248, 31, v0
    v_lshlrev_b32 v248, 2, v248
L_initp_14:
    buffer_load_dword v249, v248, s[8:11], s62 offen sc1
    s_add_u32 s33, s33, 1
    s_cmp_gt_u32 s33, 0x100000
    s_cbranch_scc1 chain_kernel_abort
    s_waitcnt vmcnt(0)
    v_cmp_eq_u32 vcc, 0, v249
    s_cbranch_vccz L_init2_13
    s_sleep 2
    s_branch L_initp_14
L_init2_13:
    s_barrier
    s_mov_b32 m0, s54
    s_nop 0
    buffer_load_dwordx4 v235, s[8:11], s31 offen offset:0 lds
    buffer_load_dwordx4 v235, s[8:11], s31 offen offset:1024 lds
    buffer_load_dwordx4 v235, s[8:11], s31 offen offset:2048 lds
    buffer_load_dwordx4 v235, s[8:11], s31 offen offset:3072 lds
    s_waitcnt vmcnt(0) lgkmcnt(0)
    s_barrier
chain_kernel_loop:
    s_mov_b32 s40, s41
    s_add_u32 s30, s30, 0x40000
    s_and_b32 s30, s30, 0xc0000
    s_xor_b32 s20, s30, 0x80000
    s_add_u32 s42, s53, s20
    s_lshl_b32 s43, s19, 19
    s_lshl_b32 s20, s19, 11
    s_and_b32 s20, s20, 0x2000
    s_xor_b32 s20, s20, s52
    s_add_u32 s43, s43, s20
    s_add_u32 s44, s43, 0x40000
    s_add_u32 s20, s30, 0x40000
    s_and_b32 s20, s20, 0xc0000
    s_add_u32 s41, s53, s20
    v_mov_b32 v64, 0
    v_mov_b32 v65, 0
    v_mov_b32 v66, 0
    v_mov_b32 v67, 0
    v_mov_b32 v68, 0
    v_mov_b32 v69, 0
    v_mov_b32 v70, 0
    v_mov_b32 v71, 0
    v_mov_b32 v72, 0
    v_mov_b32 v73, 0
    v_mov_b32 v74, 0
    v_mov_b32 v75, 0
    v_mov_b32 v76, 0
    v_mov_b32 v77, 0
    v_mov_b32 v78, 0
    v_mov_b32 v79, 0
    s_nop 13
    buffer_load_dwordx4 v[32:35], v2, s[8:11], s40 offen offset:0 sc1
    s_nop 13
    buffer_load_dwordx4 v[36:39], v2, s[8:11], s40 offen offset:1024 sc1
    s_nop 13
    buffer_load_dwordx4 v[40:43], v2, s[8:11], s40 offen offset:2048 sc1
    s_nop 13
    buffer_load_dwordx4 v[44:47], v2, s[8:11], s40 offen offset:3072 sc1
Gq_17_s0123:
    s_waitcnt vmcnt(3)
    v_cmp_eq_u32 vcc, -1, v32
    v_mov_b32_dpp v48, v32 row_ror:8 row_mask:0xf bank_mask:0xf
    v_mov_b32_dpp v49, v33 row_ror:8 row_mask:0xf bank_mask:0xf
    v_mov_b32_dpp v50, v34 row_ror:8 row_mask:0xf bank_mask:0xf
    v_mov_b32_dpp v51, v35 row_ror:8 row_mask:0xf bank_mask:0xf
    s_cbranch_vccnz Gq_17_f0123
    v_smfmac_f32_16x16x64_bf16 v[64:67], v[32:35], a[0:7], v19
    v_smfmac_f32_16x16x64_bf16 v[68:71], v[32:35], a[64:71], v19
Gq_17_s123p0:
    s_waitcnt vmcnt(2)
    v_cmp_eq_u32 vcc, -1, v36
    v_smfmac_f32_16x16x64_bf16 v[64:67], v[48:51], a[32:39], v19
    v_mov_b32_dpp v52, v36 row_ror:8 row_mask:0xf bank_mask:0xf
    v_mov_b32_dpp v53, v37 row_ror:8 row_mask:0xf bank_mask:0xf
    v_smfmac_f32_16x16x64_bf16 v[68:71], v[48:51], a[96:103], v19
    v_mov_b32_dpp v54, v38 row_ror:8 row_mask:0xf bank_mask:0xf
    v_mov_b32_dpp v55, v39 row_ror:8 row_mask:0xf bank_mask:0xf
    s_cbranch_vccnz Gq_17_f123p0
    v_smfmac_f32_16x16x64_bf16 v[64:67], v[36:39], a[8:15], v19
    v_smfmac_f32_16x16x64_bf16 v[68:71], v[36:39], a[72:79], v19
Gq_17_s23p1:
    s_waitcnt vmcnt(1)
    v_cmp_eq_u32 vcc, -1, v40
    v_smfmac_f32_16x16x64_bf16 v[64:67], v[52:55], a[40:47], v19
    v_mov_b32_dpp v56, v40 row_ror:8 row_mask:0xf bank_mask:0xf
    v_mov_b32_dpp v57, v41 row_ror:8 row_mask:0xf bank_mask:0xf
    v_smfmac_f32_16x16x64_bf16 v[68:71], v[52:55], a[104:111], v19
    v_mov_b32_dpp v58, v42 row_ror:8 row_mask:0xf bank_mask:0xf
    v_mov_b32_dpp v59, v43 row_ror:8 row_mask:0xf bank_mask:0xf
    s_cbranch_vccnz Gq_17_f23p1
    v_smfmac_f32_16x16x64_bf16 v[64:67], v[40:43], a[16:23], v19
    v_smfmac_f32_16x16x64_bf16 v[68:71], v[40:43], a[80:87], v19
Gq_17_s3p2:
    s_waitcnt vmcnt(0)
    v_cmp_eq_u32 vcc, -1, v44
    v_smfmac_f32_16x16x64_bf16 v[64:67], v[56:59], a[48:55], v19
    v_mov_b32_dpp v60, v44 row_ror:8 row_mask:0xf bank_mask:0xf
    v_mov_b32_dpp v61, v45 row_ror:8 row_mask:0xf bank_mask:0xf
    v_smfmac_f32_16x16x64_bf16 v[68:71], v[56:59], a[112:119], v19
    v_mov_b32_dpp v62, v46 row_ror:8 row_mask:0xf bank_mask:0xf
    v_mov_b32_dpp v63, v47 row_ror:8 row_mask:0xf bank_mask:0xf
    s_cbranch_vccnz Gq_17_f3p2
    v_smfmac_f32_16x16x64_bf16 v[64:67], v[44:47], a[24:31], v19
    v_smfmac_f32_16x16x64_bf16 v[68:71], v[44:47], a[88:95], v19
    v_smfmac_f32_16x16x64_bf16 v[64:67], v[60:63], a[56:63], v19
    v_smfmac_f32_16x16x64_bf16 v[68:71], v[60:63], a[120:127], v19
Gq_17_done:
    v_max3_u32 v20, v33, v34, v35
    v_max3_u32 v208, v37, v38, v39
    v_max3_u32 v209, v41, v42, v43
    v_max3_u32 v210, v45, v46, v47
    ds_write_b64 v12, v[64:65] offset:0
    ds_write_b64 v13, v[66:67] offset:0
    v_max_u32 v20, v20, v208
    v_max3_u32 v20, v20, v209, v210
    ds_write_b64 v14, v[68:69] offset:0
    s_add_u32 m0, s51, 32768
    v_cmp_eq_u32 vcc, -1, v20
    buffer_load_dwordx4 v243, s[8:11], s31 offen offset:0 lds
    buffer_load_dwordx4 v243, s[8:11], s31 offen offset:1024 lds
    v_smfmac_f32_16x16x64_bf16 v[72:75], v[32:35], a[128:135], v19
    v_smfmac_f32_16x16x64_bf16 v[72:75], v[48:51], a[160:167], v19
    s_cbranch_vccnz Gq_17_redo
    s_waitcnt lgkmcnt(0)
    s_barrier
    ds_read_b64 v[80:81], v15 offset:0
    ds_read_b64 v[82:83], v15 offset:512
    ds_read_b64 v[84:85], v15 offset:1024
    v_smfmac_f32_16x16x64_bf16 v[72:75], v[36:39], a[136:143], v19
    v_smfmac_f32_16x16x64_bf16 v[72:75], v[52:55], a[168:175], v19
    s_waitcnt lgkmcnt(2)
    v_pk_add_f32 v[70:71], v[70:71], v[80:81]
    s_waitcnt lgkmcnt(0)
    v_pk_add_f32 v[82:83], v[82:83], v[84:85]
    v_pk_add_f32 v[70:71], v[70:71], v[82:83]
    v_cvt_pk_bf16_f32 v70, v70, v71
    s_cmp_lg_u32 s18, 0
    s_nop 0
    v_mov_b32_dpp v71, v70 quad_perm:[1,0,3,2] row_mask:0xf bank_mask:0xf
    v_perm_b32 v70, v71, v70, v18
    v_min_u32 v70, 0xfffffffe, v70
    buffer_store_dword v70, v4, s[8:11], s40 offen
    v_smfmac_f32_16x16x64_bf16 v[72:75], v[40:43], a[144:151], v19
    v_smfmac_f32_16x16x64_bf16 v[72:75], v[56:59], a[176:183], v19
    v_smfmac_f32_16x16x64_bf16 v[72:75], v[44:47], a[152:159], v19
    v_smfmac_f32_16x16x64_bf16 v[72:75], v[60:63], a[184:191], v19
    s_nop 7
    ds_write_b128 v16, v[72:75] offset:12288
    s_cbranch_scc1 L_help_15
    s_nop 15
    s_nop 11
    buffer_load_dwordx4 v[148:151], v5, s[8:11], s40 offen offset:0 sc1
    buffer_load_dwordx4 v[152:155], v5, s[8:11], s40 offen offset:1024 sc1
    buffer_load_dwordx4 v[156:159], v5, s[8:11], s40 offen offset:2048 sc1
    buffer_load_dwordx4 v[160:163], v5, s[8:11], s40 offen offset:3072 sc1
    s_waitcnt vmcnt(5) lgkmcnt(0)
    s_barrier
    ds_read_b128 v[104:107], v1 offset:32768
    ds_read_b128 v[108:111], v1 offset:33792
    ds_read_b128 v[112:115], v1 offset:34816
    ds_read_b128 v[116:119], v1 offset:35840
    ds_read_b128 v[120:123], v1 offset:36864
    ds_read_b128 v[124:127], v1 offset:37888
    ds_read_b128 v[128:131], v1 offset:38912
    ds_read_b128 v[132:135], v1 offset:39936
    ds_read_b128 v[136:139], v1 offset:40960
    ds_read_b128 v[140:143], v1 offset:41984
    buffer_load_dwordx4 v[164:167], v5, s[8:11], s40 offen offset:0 sc1
    buffer_load_dwordx4 v[168:171], v5, s[8:11], s40 offen offset:1024 sc1
    buffer_load_dwordx4 v[172:175], v5, s[8:11], s40 offen offset:2048 sc1
    buffer_load_dwordx4 v[176:179], v5, s[8:11], s40 offen offset:3072 sc1
    s_nop 13
    buffer_load_dwordx4 v[32:35], v5, s[8:11], s40 offen offset:0 sc1
    buffer_load_dwordx4 v[36:39], v5, s[8:11], s40 offen offset:1024 sc1
    buffer_load_dwordx4 v[40:43], v5, s[8:11], s40 offen offset:2048 sc1
    buffer_load_dwordx4 v[44:47], v5, s[8:11], s40 offen offset:3072 sc1
    s_waitcnt lgkmcnt(0)
L_sd_18_0_0:
    s_waitcnt vmcnt(11)
    v_max3_u32 v20, v148, v149, v150
    v_mfma_f32_16x16x32_bf16 v[88:91], v[148:151], v[148:151], 0
    v_max_u32 v20, v20, v151
    v_cmp_eq_u32 vcc, -1, v20
    v_mfma_f32_16x16x32_bf16 v[84:87], v[120:123], v[148:151], 0
    v_mfma_f32_16x16x32_bf16 v[80:83], v[104:107], v[148:151], 0
    s_cbranch_vccnz L_sd_18_1_0
L_sd_18_0_1:
    s_waitcnt vmcnt(10)
    v_max3_u32 v20, v152, v153, v154
    v_mfma_f32_16x16x32_bf16 v[100:103], v[152:155], v[152:155], v[88:91]
    v_max_u32 v20, v20, v155
    v_cmp_eq_u32 vcc, -1, v20
    v_mfma_f32_16x16x32_bf16 v[96:99], v[124:127], v[152:155], v[84:87]
    v_mfma_f32_16x16x32_bf16 v[92:95], v[108:111], v[152:155], v[80:83]
    s_cbranch_vccnz L_sd_18_1_1
L_sd_18_0_2:
    s_waitcnt vmcnt(9)
    v_max3_u32 v20, v156, v157, v158
    v_mfma_f32_16x16x32_bf16 v[228:231], v[156:159], v[156:159], v[100:103]
    v_max_u32 v20, v20, v159
    v_cmp_eq_u32 vcc, -1, v20
    v_mfma_f32_16x16x32_bf16 v[224:227], v[128:131], v[156:159], v[96:99]
    v_mfma_f32_16x16x32_bf16 v[220:223], v[112:115], v[156:159], v[92:95]
    s_cbranch_vccnz L_sd_18_1_2
L_sd_18_0_3:
    s_waitcnt vmcnt(8)
    v_max3_u32 v20, v160, v161, v162
    v_mfma_f32_16x16x32_bf16 v[188:191], v[160:163], v[160:163], v[228:231]
    v_max_u32 v20, v20, v163
    v_cmp_eq_u32 vcc, -1, v20
    v_mfma_f32_16x16x32_bf16 v[184:187], v[132:135], v[160:163], v[224:227]
    v_mfma_f32_16x16x32_bf16 v[180:183], v[116:119], v[160:163], v[220:223]
    v_mov_b32_dpp v188, v189 row_ror:8 row_mask:0xf bank_mask:0xc
    v_mov_b32_dpp v190, v191 row_ror:8 row_mask:0xf bank_mask:0xc
    s_cbranch_vccnz L_sd_18_1_3
L_sd_18:
    s_barrier
    v_permlane32_swap_b32 v188, v190
    ds_read_b64 v[144:145], v26 offset:28672
    s_cmp_eq_u32 s19, 63
    s_cbranch_scc1 chain_kernel_fin
    v_mov_b32_dpp v180, v184 row_ror:8 row_mask:0xf bank_mask:0xc
    v_mov_b32_dpp v181, v185 row_ror:8 row_mask:0xf bank_mask:0xc
    v_mov_b32_dpp v182, v186 row_ror:8 row_mask:0xf bank_mask:0xc
    v_mov_b32_dpp v183, v187 row_ror:8 row_mask:0xf bank_mask:0xc
    v_max3_f32 v208, v190, v180, v181
    v_max3_f32 v208, v208, v182, v183
    v_cvt_pk_bf16_f32 v180, 0, v180
    v_cvt_pk_bf16_f32 v181, 0, v181
    v_max_f32_dpp v208, v208, v208 row_ror:8 row_mask:0xf bank_mask:0xf
    v_mov_b32 v209, v208
    v_cvt_pk_bf16_f32 v182, 0, v182
    v_cvt_pk_bf16_f32 v183, 0, v183
    v_permlane16_swap_b32 v208, v209
    v_cvt_pk_bf16_f32 v190, 0, v190
    v_max_f32 v208, v208, v209
    v_mov_b32 v209, v208
    v_pk_mul_f32 v[180:181], v[180:181], s[58:59]
    v_pk_mul_f32 v[182:183], v[182:183], s[58:59]
    v_permlane32_swap_b32 v208, v209
    v_mul_f32 v190, s58, v190
    v_max_f32 v208, v208, v209
    v_cvt_pk_bf16_f32 v190, 0, v190
    v_cvt_pk_bf16_f32 v208, 0, v208
    v_cvt_pk_bf16_f32 v180, 0, v180
    v_mul_f32 v208, s58, v208
    v_cvt_pk_bf16_f32 v181, 0, v181
    v_cvt_pk_bf16_f32 v208, 0, v208
    v_cvt_pk_bf16_f32 v182, 0, v182
    v_mul_f32 v208, s56, v208
    v_cvt_pk_bf16_f32 v183, 0, v183
    v_fma_f32 v190, v190, s56, -v208
    v_pk_fma_f32 v[180:181], v[180:181], s[56:57], v[208:209] op_sel_hi:[1,1,0] neg_lo:[0,0,1] neg_hi:[0,0,1]
    v_exp_f32 v190, v190
    v_pk_fma_f32 v[182:183], v[182:183], s[56:57], v[208:209] op_sel_hi:[1,1,0] neg_lo:[0,0,1] neg_hi:[0,0,1]
    v_exp_f32 v180, v180
    v_mov_b32_dpp v209, v190 row_ror:8 row_mask:0xf bank_mask:0xf
    v_exp_f32 v181, v181
    v_cvt_pk_bf16_f32 v196, v190, v209
    v_cvt_pk_bf16_f32 v199, v190, v209
    v_exp_f32 v182, v182
    v_mfma_f32_16x16x16_bf16 v[184:187], v[216:217], v[196:197], 0
    v_exp_f32 v183, v183
    s_waitcnt lgkmcnt(0)
    v_mfma_f32_16x16x16_bf16 v[200:203], v[144:145], v[196:197], 0
    v_cvt_pk_bf16_f32 v192, v180, v181
    v_cvt_pk_bf16_f32 v193, v182, v183
    v_mfma_f32_16x16x16_bf16 v[204:207], v[144:145], v[198:199], 0
    v_mov_b32_dpp v194, v192 row_ror:8 row_mask:0xf bank_mask:0xf
    v_mov_b32_dpp v195, v193 row_ror:8 row_mask:0xf bank_mask:0xf
    s_mov_b64 exec, s[24:25]
    s_nop 0
    v_mfma_f32_16x16x32_bf16 v[184:187], v[216:219], v[192:195], v[184:187]
    v_mfma_f32_16x16x32_bf16 v[200:203], v[136:139], v[192:195], v[200:203]
    v_mfma_f32_16x16x32_bf16 v[204:207], v[140:143], v[192:195], v[204:207]
    s_nop 0
    v_rcp_f32 v184, v184
    s_nop 1
    v_pk_mul_f32 v[200:201], v[200:201], v[184:185] op_sel_hi:[1,0]
    v_pk_mul_f32 v[202:203], v[202:203], v[184:185] op_sel_hi:[1,0]
    v_cvt_pk_bf16_f32 v200, v200, v201
    v_cvt_pk_bf16_f32 v201, v202, v203
    v_pk_mul_f32 v[204:205], v[204:205], v[184:185] op_sel_hi:[1,0]
    v_pk_mul_f32 v[206:207], v[206:207], v[184:185] op_sel_hi:[1,0]
    v_cvt_pk_bf16_f32 v202, v204, v205
    v_cvt_pk_bf16_f32 v203, v206, v207
    v_min_u32 v200, 0xfffffffe, v200
    v_min_u32 v201, 0xfffffffe, v201
    v_min_u32 v202, 0xfffffffe, v202
    v_min_u32 v203, 0xfffffffe, v203
    buffer_store_dwordx4 v[200:203], v6, s[8:11], s40 offen
    s_mov_b64 exec, -1
L_b4_16:
    s_barrier
    s_add_u32 s21, s19, 1
    s_min_u32 s21, s21, 63
    s_lshl_b32 s31, s21, 21
    s_lshl_b32 s21, s21, 13
    s_and_b32 s21, s21, 0x2000
    s_xor_b32 s21, s21, s48
    s_add_u32 s31, s31, s21
    s_add_u32 s19, s19, 1
    s_nop 15
    s_nop 11
    buffer_load_dwordx4 v[32:35], v3, s[8:11], s40 offen offset:0 sc1
    s_nop 13
    buffer_load_dwordx4 v[36:39], v3, s[8:11], s40 offen offset:1024 sc1
    s_nop 13
    buffer_load_dwordx4 v[40:43], v3, s[8:11], s40 offen offset:2048 sc1
    s_nop 13
    buffer_load_dwordx4 v[44:47], v3, s[8:11], s40 offen offset:3072 sc1
Go_19_s0123:
    s_waitcnt vmcnt(3)
    v_cmp_eq_u32 vcc, -1, v32
    v_mov_b32_dpp v48, v32 row_ror:8 row_mask:0xf bank_mask:0xf
    v_mov_b32_dpp v49, v33 row_ror:8 row_mask:0xf bank_mask:0xf
    v_mov_b32_dpp v50, v34 row_ror:8 row_mask:0xf bank_mask:0xf
    v_mov_b32_dpp v51, v35 row_ror:8 row_mask:0xf bank_mask:0xf
    s_cbranch_vccnz Go_19_f0123
    v_smfmac_f32_16x16x64_bf16 v[76:79], v[32:35], a[192:199], v19
    v_smfmac_f32_16x16x64_bf16 v[76:79], v[48:51], a[224:231], v19
Go_19_s123:
    s_waitcnt vmcnt(2)
    v_cmp_eq_u32 vcc, -1, v36
    v_mov_b32_dpp v52, v36 row_ror:8 row_mask:0xf bank_mask:0xf
    v_mov_b32_dpp v53, v37 row_ror:8 row_mask:0xf bank_mask:0xf
    v_mov_b32_dpp v54, v38 row_ror:8 row_mask:0xf bank_mask:0xf
    v_mov_b32_dpp v55, v39 row_ror:8 row_mask:0xf bank_mask:0xf
    s_cbranch_vccnz Go_19_f123
    v_smfmac_f32_16x16x64_bf16 v[76:79], v[36:39], a[200:207], v19
    v_smfmac_f32_16x16x64_bf16 v[76:79], v[52:55], a[232:239], v19
Go_19_s23:
    s_waitcnt vmcnt(1)
    v_cmp_eq_u32 vcc, -1, v40
    v_mov_b32_dpp v56, v40 row_ror:8 row_mask:0xf bank_mask:0xf
    v_mov_b32_dpp v57, v41 row_ror:8 row_mask:0xf bank_mask:0xf
    v_mov_b32_dpp v58, v42 row_ror:8 row_mask:0xf bank_mask:0xf
    v_mov_b32_dpp v59, v43 row_ror:8 row_mask:0xf bank_mask:0xf
    s_cbranch_vccnz Go_19_f23
    v_smfmac_f32_16x16x64_bf16 v[76:79], v[40:43], a[208:215], v19
    v_smfmac_f32_16x16x64_bf16 v[76:79], v[56:59], a[240:247], v19
Go_19_s3:
    s_waitcnt vmcnt(0)
    v_cmp_eq_u32 vcc, -1, v44
    v_mov_b32_dpp v60, v44 row_ror:8 row_mask:0xf bank_mask:0xf
    v_mov_b32_dpp v61, v45 row_ror:8 row_mask:0xf bank_mask:0xf
    v_mov_b32_dpp v62, v46 row_ror:8 row_mask:0xf bank_mask:0xf
    v_mov_b32_dpp v63, v47 row_ror:8 row_mask:0xf bank_mask:0xf
    s_cbranch_vccnz Go_19_f3
    v_smfmac_f32_16x16x64_bf16 v[76:79], v[44:47], a[216:223], v19
    v_smfmac_f32_16x16x64_bf16 v[76:79], v[60:63], a[248:255], v19
Go_19_done:
    v_max3_u32 v20, v33, v34, v35
    v_max3_u32 v208, v37, v38, v39
    v_max3_u32 v209, v41, v42, v43
    v_max3_u32 v210, v45, v46, v47
    v_max_u32 v20, v20, v208
    v_max3_u32 v20, v20, v209, v210
    v_cmp_eq_u32 vcc, -1, v20
    s_nop 0
    ds_write_b32 v238, v76 offset:20480
    ds_write_b32 v239, v77 offset:20480
    ds_write_b32 v240, v78 offset:20480
    s_cbranch_vccnz Go_19_redo
    s_waitcnt lgkmcnt(0)
    s_barrier
    ds_read_b32 v80, v17 offset:20480
    ds_read_b32 v81, v17 offset:20736
    ds_read_b32 v82, v17 offset:20992
    s_cmp_lt_u32 s18, 2
    s_waitcnt lgkmcnt(2)
    v_add_f32 v80, v80, v79
    s_waitcnt lgkmcnt(0)
    v_add_f32 v81, v81, v82
    v_add_f32 v80, v80, v81
    v_min_u32 v80, 0xfffffffe, v80
    buffer_store_dword v80, v8, s[8:11], s43 offen sc1
    buffer_store_dword v80, v8, s[8:11], s44 offen sc1
    ds_read_b128 v[164:167], v241 offset:51200
    ds_read_b128 v[168:171], v241 offset:51712
    ds_read_b128 v[172:175], v241 offset:52224
    ds_read_b128 v[176:179], v241 offset:52736
    s_waitcnt lgkmcnt(3)
    v_mfma_f32_16x16x32_bf16 v[188:191], v[164:167], v[148:151], 0
    s_waitcnt lgkmcnt(2)
    v_mfma_f32_16x16x32_bf16 v[188:191], v[168:171], v[152:155], v[188:191]
    s_waitcnt lgkmcnt(1)
    v_mfma_f32_16x16x32_bf16 v[188:191], v[172:175], v[156:159], v[188:191]
    s_waitcnt lgkmcnt(0)
    v_mfma_f32_16x16x32_bf16 v[188:191], v[176:179], v[160:163], v[188:191]
    s_nop 7
    v_cvt_pk_bf16_f32 v188, 0, v188
    v_cvt_pk_bf16_f32 v189, 0, v189
    v_pk_mul_f32 v[188:189], v[188:189], s[58:59]
    v_cvt_pk_bf16_f32 v188, 0, v188
    v_cvt_pk_bf16_f32 v189, 0, v189
    v_max3_f32 v86, v86, v188, v189
    v_mov_b32 v87, v86
    s_nop 1
    v_permlane16_swap_b32 v86, v87
    buffer_load_dword v220, v9, s[8:11], s43 offen sc1
    buffer_load_dword v221, v10, s[8:11], s43 offen sc1
    buffer_load_dword v222, v11, s[8:11], s43 offen sc1
    v_max_f32 v86, v86, v87
    v_mov_b32 v87, v86
    s_nop 1
    v_permlane32_swap_b32 v86, v87
    v_max_f32 v86, v86, v87
    v_mul_f32 v86, s56, v86
    v_pk_fma_f32 v[180:181], v[180:181], s[56:57], v[86:87] op_sel_hi:[1,1,0] neg_lo:[0,0,1] neg_hi:[0,0,1]
    v_pk_fma_f32 v[182:183], v[182:183], s[56:57], v[86:87] op_sel_hi:[1,1,0] neg_lo:[0,0,1] neg_hi:[0,0,1]
    v_pk_fma_f32 v[184:185], v[184:185], s[56:57], v[86:87] op_sel_hi:[1,1,0] neg_lo:[0,0,1] neg_hi:[0,0,1]
    v_pk_fma_f32 v[186:187], v[186:187], s[56:57], v[86:87] op_sel_hi:[1,1,0] neg_lo:[0,0,1] neg_hi:[0,0,1]
    v_pk_fma_f32 v[188:189], v[188:189], s[56:57], v[86:87] op_sel_hi:[1,1,0] neg_lo:[0,0,1] neg_hi:[0,0,1]
    v_exp_f32 v180, v180
    v_exp_f32 v181, v181
    v_exp_f32 v182, v182
    v_exp_f32 v183, v183
    v_exp_f32 v184, v184
    v_exp_f32 v185, v185
    v_exp_f32 v186, v186
    buffer_load_dword v223, v9, s[8:11], s44 offen sc1
    buffer_load_dword v224, v10, s[8:11], s44 offen sc1
    buffer_load_dword v225, v11, s[8:11], s44 offen sc1
    s_add_u32 m0, s51, 43008
    v_exp_f32 v187, v187
    v_exp_f32 v188, v188
    v_exp_f32 v189, v189
    v_pk_add_f32 v[88:89], v[180:181], v[182:183]
    v_pk_add_f32 v[90:91], v[184:185], v[186:187]
    v_pk_add_f32 v[88:89], v[88:89], v[188:189]
    buffer_load_dwordx4 v244, s[8:11], s31 offen offset:0 lds
    v_pk_add_f32 v[88:89], v[88:89], v[90:91]
    v_add_f32 v88, v88, v89
    v_mov_b32 v87, v88
    s_nop 1
    v_permlane16_swap_b32 v88, v87
    v_add_f32 v88, v88, v87
    buffer_load_dwordx4 v244, s[8:11], s31 offen offset:1024 lds
    v_mov_b32 v87, v88
    s_nop 1
    v_permlane32_swap_b32 v88, v87
    v_add_f32 v88, v88, v87
    v_rcp_f32 v88, v88
    s_nop 0
    v_pk_mul_f32 v[180:181], v[180:181], v[88:89] op_sel_hi:[1,0]
    v_pk_mul_f32 v[182:183], v[182:183], v[88:89] op_sel_hi:[1,0]
    v_pk_mul_f32 v[184:185], v[184:185], v[88:89] op_sel_hi:[1,0]
    v_pk_mul_f32 v[186:187], v[186:187], v[88:89] op_sel_hi:[1,0]
    v_pk_mul_f32 v[188:189], v[188:189], v[88:89] op_sel_hi:[1,0]
    v_cvt_pk_bf16_f32 v192, v180, v181
    v_cvt_pk_bf16_f32 v193, v182, v183
    v_cvt_pk_bf16_f32 v194, v184, v185
    v_cvt_pk_bf16_f32 v195, v186, v187
    v_cvt_pk_bf16_f32 v196, v188, v189
    v_cvt_pk_bf16_f32 v199, v188, v189
    v_mfma_f32_16x16x32_bf16 v[200:203], v[136:139], v[192:195], 0
    v_mfma_f32_16x16x32_bf16 v[204:207], v[140:143], v[192:195], 0
    v_mfma_f32_16x16x16_bf16 v[200:203], v[144:145], v[196:197], v[200:203]
    v_mfma_f32_16x16x16_bf16 v[204:207], v[144:145], v[198:199], v[204:207]
L_pj_21:
    s_waitcnt vmcnt(7)
    v_add_f32 v208, v80, v220
    s_waitcnt vmcnt(5)
    v_max3_u32 v20, v220, v221, v222
    v_add_f32 v209, v221, v222
    v_cmp_eq_u32 vcc, -1, v20
    v_add_f32 v208, v208, v209
    s_nop 1
    v_mov_b32_dpp v209, v208 quad_perm:[1,0,3,2] row_mask:0xf bank_mask:0xf
    s_mov_b64 exec, s[26:27]
    v_cvt_pk_bf16_f32 v208, v208, v209
    v_min_u32 v208, 0xfffffffe, v208
    s_cbranch_vccnz L_pf_26
L_pd_25:
    buffer_store_dword v208, v7, s[8:11], s41 offen
    s_mov_b64 exec, -1
    s_branch chain_kernel_loop
L_help_15:
    s_waitcnt vmcnt(1) lgkmcnt(0)
    s_barrier
    s_cmp_ge_u32 s18, 2
    s_cbranch_scc1 L_w2_30
    ds_read_b128 v[80:83], v1 offset:12288
    ds_read_b128 v[84:87], v1 offset:14336
    ds_read_b128 v[88:91], v1 offset:15360
    s_waitcnt lgkmcnt(2)
    v_pk_add_f32 v[72:73], v[72:73], v[82:83]
    v_pk_add_f32 v[74:75], v[74:75], v[80:81]
    s_waitcnt lgkmcnt(1)
    v_pk_add_f32 v[72:73], v[72:73], v[86:87]
    v_pk_add_f32 v[74:75], v[74:75], v[84:85]
    s_waitcnt lgkmcnt(0)
    v_pk_add_f32 v[72:73], v[72:73], v[88:89]
    v_pk_add_f32 v[74:75], v[74:75], v[90:91]
    v_cvt_pk_bf16_f32 v144, v72, v73
    v_cvt_pk_bf16_f32 v145, v74, v75
    s_nop 1
    v_permlane32_swap_b32 v144, v145
    s_nop 1
    ds_write_b64 v26, v[144:145] offset:28672
    s_add_u32 s21, s19, 1
    s_min_u32 s21, s21, 63
    s_lshl_b32 s63, s21, 21
    s_lshl_b32 s21, s21, 13
    s_and_b32 s21, s21, 0x2000
    s_xor_b32 s21, s21, s48
    s_add_u32 s63, s63, s21
    s_nop 15
    s_nop 0
    buffer_load_dword v250, v25, s[8:11], s63 offen sc1
    s_add_u32 s20, s19, 2
    s_min_u32 s20, s20, 63
    s_bfm_b64 s[22:23], s20, 0
    s_and_b32 s22, s22, 0x204225f
    s_and_b32 s23, s23, 0x80004004
    s_bcnt1_i32_b64 s32, s[22:23]
    s_lshl_b32 s32, s32, 2
    s_add_u32 s32, s32, 64
    s_cmp_eq_u32 s47, 1
    s_cselect_b32 s32, s32, s55
    s_add_u32 s21, s19, 1
    s_min_u32 s21, s21, 63
    s_lshl_b32 s31, s21, 21
    s_lshl_b32 s21, s21, 13
    s_and_b32 s21, s21, 0x2000
    s_xor_b32 s21, s21, s48
    s_add_u32 s31, s31, s21
    s_waitcnt lgkmcnt(0)
    s_cmp_eq_u32 s32, s55
    s_cbranch_scc1 L_nog_33
    s_load_dword s22, s[60:61], s32 glc
L_nog_33:
    s_mov_b32 s23, 1
    s_barrier
    s_cmp_lg_u32 s19, 0
    s_cbranch_scc1 L_ns0_36
    v_mov_b32 v248, 0
    s_lshl2_add_u32 s20, s17, s18
    s_cmp_lg_u32 s20, 5
    s_cbranch_scc1 L_rlo_38
L_rl_37:
    s_load_dword s20, s[60:61], 68 glc
    s_add_u32 s33, s33, 1
    s_cmp_gt_u32 s33, 0x100000
    s_cbranch_scc1 chain_kernel_abort
    s_waitcnt lgkmcnt(0)
    s_cmp_lt_u32 s20, 96
    s_cbranch_scc1 L_rl_37
    v_mov_b32 v249, 2
    buffer_store_dword v249, v248, s[8:11], s62 offen offset:128
    s_branch L_rlok_39
L_rlo_38:
    buffer_load_dword v249, v248, s[8:11], s62 offen offset:128 sc1
    s_add_u32 s33, s33, 1
    s_cmp_gt_u32 s33, 0x100000
    s_cbranch_scc1 chain_kernel_abort
    s_waitcnt vmcnt(0)
    v_readfirstlane_b32 s20, v249
    s_cmp_ge_u32 s20, 2
    s_cbranch_scc1 L_rlok_39
    s_sleep 1
    s_branch L_rlo_38
L_rlok_39:
L_ns0_36:
    s_mov_b32 m0, 40960
    s_nop 0
    buffer_load_dwordx4 v237, s[8:11], s31 offen offset:0 lds
    buffer_load_dwordx4 v237, s[8:11], s31 offen offset:1024 lds
    s_cmp_lg_u32 s47, 0
    s_cbranch_scc1 L_nof_35
    s_atomic_add s23, s[60:61], 208
L_nof_35:
    buffer_store_dwordx4 v[28:31], v22, s[8:11], s42 offen
    s_lshl_b32 s21, s29, 9
    s_add_u32 s21, s21, s42
    buffer_store_dwordx2 v[28:29], v26, s[8:11], s21 offen
    s_xor_b32 s21, s21, 20480
    buffer_store_dwordx2 v[28:29], v26, s[8:11], s21 offen
    s_cmp_eq_u32 s32, s55
    s_cbranch_scc1 L_he_32
    s_mov_b32 s55, s32
L_gr_34:
    s_waitcnt lgkmcnt(0)
    s_cmp_ge_u32 s22, 96
    s_cbranch_scc1 L_he_32
    s_add_u32 s33, s33, 1
    s_cmp_gt_u32 s33, 0x100000
    s_cbranch_scc1 chain_kernel_abort
    s_load_dword s22, s[60:61], s32 glc
    s_branch L_gr_34
L_w2_30:
    ds_read_b128 v[148:151], v242 offset:43008
    ds_read_b128 v[104:107], v1 offset:32768
    ds_read_b128 v[108:111], v1 offset:36864
    ds_read_b128 v[152:155], v242 offset:44032
    ds_read_b128 v[112:115], v1 offset:33792
    ds_read_b128 v[116:119], v1 offset:37888
    ds_read_b128 v[156:159], v242 offset:45056
    ds_read_b128 v[120:123], v1 offset:34816
    ds_read_b128 v[124:127], v1 offset:38912
    ds_read_b128 v[160:163], v242 offset:46080
    ds_read_b128 v[128:131], v1 offset:35840
    ds_read_b128 v[132:135], v1 offset:39936
    ds_read_b128 v[136:139], v1 offset:40960
    ds_read_b128 v[140:143], v1 offset:41984
    v_cvt_pk_bf16_f32 v200, v200, v201
    v_cvt_pk_bf16_f32 v201, v202, v203
    v_cvt_pk_bf16_f32 v202, v204, v205
    v_cvt_pk_bf16_f32 v203, v206, v207
    s_add_u32 s21, s19, -1
    s_lshl_b32 s32, s21, 21
    s_lshl_b32 s21, s21, 13
    s_and_b32 s21, s21, 0x2000
    s_xor_b32 s21, s21, s48
    s_add_u32 s32, s32, s21
    s_waitcnt lgkmcnt(11)
    v_mfma_f32_16x16x32_bf16 v[180:183], v[104:107], v[148:151], 0
    v_mfma_f32_16x16x32_bf16 v[184:187], v[108:111], v[148:151], 0
    s_waitcnt lgkmcnt(8)
    v_mfma_f32_16x16x32_bf16 v[180:183], v[112:115], v[152:155], v[180:183]
    v_mfma_f32_16x16x32_bf16 v[184:187], v[116:119], v[152:155], v[184:187]
    buffer_store_dwordx4 v[200:203], v23, s[8:11], s32 offen sc1
    s_waitcnt lgkmcnt(5)
    v_mfma_f32_16x16x32_bf16 v[180:183], v[120:123], v[156:159], v[180:183]
    v_mfma_f32_16x16x32_bf16 v[184:187], v[124:127], v[156:159], v[184:187]
    s_waitcnt lgkmcnt(2)
    v_mfma_f32_16x16x32_bf16 v[180:183], v[128:131], v[160:163], v[180:183]
    v_mfma_f32_16x16x32_bf16 v[184:187], v[132:135], v[160:163], v[184:187]
    s_add_u32 s21, s19, 1
    s_min_u32 s21, s21, 63
    s_lshl_b32 s31, s21, 21
    s_lshl_b32 s21, s21, 13
    s_and_b32 s21, s21, 0x2000
    s_xor_b32 s21, s21, s48
    s_add_u32 s31, s31, s21
    v_cvt_pk_bf16_f32 v180, 0, v180
    v_cvt_pk_bf16_f32 v181, 0, v181
    v_cvt_pk_bf16_f32 v182, 0, v182
    v_cvt_pk_bf16_f32 v183, 0, v183
    v_cvt_pk_bf16_f32 v184, 0, v184
    v_cvt_pk_bf16_f32 v185, 0, v185
    v_cvt_pk_bf16_f32 v186, 0, v186
    v_cvt_pk_bf16_f32 v187, 0, v187
    v_pk_mul_f32 v[180:181], v[180:181], s[58:59]
    v_pk_mul_f32 v[182:183], v[182:183], s[58:59]
    v_pk_mul_f32 v[184:185], v[184:185], s[58:59]
    v_pk_mul_f32 v[186:187], v[186:187], s[58:59]
    v_cvt_pk_bf16_f32 v180, 0, v180
    v_cvt_pk_bf16_f32 v181, 0, v181
    v_cvt_pk_bf16_f32 v182, 0, v182
    v_cvt_pk_bf16_f32 v183, 0, v183
    v_cvt_pk_bf16_f32 v184, 0, v184
    v_cvt_pk_bf16_f32 v185, 0, v185
    v_cvt_pk_bf16_f32 v186, 0, v186
    v_cvt_pk_bf16_f32 v187, 0, v187
    v_pk_add_f32 v[180:181], v[180:181], v[226:227]
    v_pk_add_f32 v[182:183], v[182:183], v[228:229]
    v_pk_add_f32 v[184:185], v[184:185], v[230:231]
    v_pk_add_f32 v[186:187], v[186:187], v[232:233]
    v_max3_f32 v86, v180, v181, v182
    v_max3_f32 v87, v183, v184, v185
    v_max3_f32 v86, v86, v186, v187
    v_max_f32 v86, v86, v87
    s_cmp_eq_u32 s18, 3
    s_waitcnt lgkmcnt(0)
    s_barrier
    ds_read_b64 v[144:145], v26 offset:28672
    s_cbranch_scc0 L_he_32
    s_mov_b32 m0, 51200
    s_nop 0
    buffer_load_dwordx4 v24, s[8:11], s40 offen offset:0 sc1 lds
    s_mov_b32 m0, 50176
    s_nop 0
    buffer_load_dwordx4 v24, s[8:11], s40 offen offset:2048 sc1 lds
L_he_32:
    s_cmp_lg_u32 s19, 63
    s_cbranch_scc1 L_b4_16
chain_kernel_fin:
    s_waitcnt vmcnt(0) lgkmcnt(0)
    s_barrier
    s_cmp_lt_u32 s18, 2
    s_cbranch_scc1 L_f2_40
    ds_read_b128 v[164:167], v241 offset:51200
    ds_read_b128 v[168:171], v241 offset:51712
    ds_read_b128 v[172:175], v241 offset:52224
    ds_read_b128 v[176:179], v241 offset:52736
    s_waitcnt lgkmcnt(3)
    v_mfma_f32_16x16x32_bf16 v[188:191], v[164:167], v[148:151], 0
    s_waitcnt lgkmcnt(2)
    v_mfma_f32_16x16x32_bf16 v[188:191], v[168:171], v[152:155], v[188:191]
    s_waitcnt lgkmcnt(1)
    v_mfma_f32_16x16x32_bf16 v[188:191], v[172:175], v[156:159], v[188:191]
    s_waitcnt lgkmcnt(0)
    v_mfma_f32_16x16x32_bf16 v[188:191], v[176:179], v[160:163], v[188:191]
    s_nop 7
    v_cvt_pk_bf16_f32 v188, 0, v188
    v_cvt_pk_bf16_f32 v189, 0, v189
    v_pk_mul_f32 v[188:189], v[188:189], s[58:59]
    v_cvt_pk_bf16_f32 v188, 0, v188
    v_cvt_pk_bf16_f32 v189, 0, v189
    v_max3_f32 v86, v86, v188, v189
    v_mov_b32 v87, v86
    s_nop 1
    v_permlane16_swap_b32 v86, v87
    v_max_f32 v86, v86, v87
    v_mov_b32 v87, v86
    s_nop 1
    v_permlane32_swap_b32 v86, v87
    v_max_f32 v86, v86, v87
    v_mul_f32 v86, s56, v86
    v_pk_fma_f32 v[180:181], v[180:181], s[56:57], v[86:87] op_sel_hi:[1,1,0] neg_lo:[0,0,1] neg_hi:[0,0,1]
    v_pk_fma_f32 v[182:183], v[182:183], s[56:57], v[86:87] op_sel_hi:[1,1,0] neg_lo:[0,0,1] neg_hi:[0,0,1]
    v_pk_fma_f32 v[184:185], v[184:185], s[56:57], v[86:87] op_sel_hi:[1,1,0] neg_lo:[0,0,1] neg_hi:[0,0,1]
    v_pk_fma_f32 v[186:187], v[186:187], s[56:57], v[86:87] op_sel_hi:[1,1,0] neg_lo:[0,0,1] neg_hi:[0,0,1]
    v_pk_fma_f32 v[188:189], v[188:189], s[56:57], v[86:87] op_sel_hi:[1,1,0] neg_lo:[0,0,1] neg_hi:[0,0,1]
    v_exp_f32 v180, v180
    v_exp_f32 v181, v181
    v_exp_f32 v182, v182
    v_exp_f32 v183, v183
    v_exp_f32 v184, v184
    v_exp_f32 v185, v185
    v_exp_f32 v186, v186
    v_exp_f32 v187, v187
    v_exp_f32 v188, v188
    v_exp_f32 v189, v189
    v_pk_add_f32 v[88:89], v[180:181], v[182:183]
    v_pk_add_f32 v[90:91], v[184:185], v[186:187]
    v_pk_add_f32 v[88:89], v[88:89], v[188:189]
    v_pk_add_f32 v[88:89], v[88:89], v[90:91]
    v_add_f32 v88, v88, v89
    v_mov_b32 v87, v88
    s_nop 1
    v_permlane16_swap_b32 v88, v87
    v_add_f32 v88, v88, v87
    v_mov_b32 v87, v88
    s_nop 1
    v_permlane32_swap_b32 v88, v87
    v_add_f32 v88, v88, v87
    v_rcp_f32 v88, v88
    s_nop 0
    v_pk_mul_f32 v[180:181], v[180:181], v[88:89] op_sel_hi:[1,0]
    v_pk_mul_f32 v[182:183], v[182:183], v[88:89] op_sel_hi:[1,0]
    v_pk_mul_f32 v[184:185], v[184:185], v[88:89] op_sel_hi:[1,0]
    v_pk_mul_f32 v[186:187], v[186:187], v[88:89] op_sel_hi:[1,0]
    v_pk_mul_f32 v[188:189], v[188:189], v[88:89] op_sel_hi:[1,0]
    v_cvt_pk_bf16_f32 v192, v180, v181
    v_cvt_pk_bf16_f32 v193, v182, v183
    v_cvt_pk_bf16_f32 v194, v184, v185
    v_cvt_pk_bf16_f32 v195, v186, v187
    v_cvt_pk_bf16_f32 v196, v188, v189
    v_cvt_pk_bf16_f32 v199, v188, v189
    v_mfma_f32_16x16x32_bf16 v[200:203], v[136:139], v[192:195], 0
    v_mfma_f32_16x16x32_bf16 v[204:207], v[140:143], v[192:195], 0
    v_mfma_f32_16x16x16_bf16 v[200:203], v[144:145], v[196:197], v[200:203]
    v_mfma_f32_16x16x16_bf16 v[204:207], v[144:145], v[198:199], v[204:207]
    s_add_u32 s21, s19, 0
    s_min_u32 s21, s21, 63
    s_lshl_b32 s32, s21, 21
    s_lshl_b32 s21, s21, 13
    s_and_b32 s21, s21, 0x2000
    s_xor_b32 s21, s21, s48
    s_add_u32 s32, s32, s21
    s_nop 1
    v_cvt_pk_bf16_f32 v200, v200, v201
    v_cvt_pk_bf16_f32 v201, v202, v203
    v_cvt_pk_bf16_f32 v202, v204, v205
    v_cvt_pk_bf16_f32 v203, v206, v207
    buffer_store_dwordx4 v[200:203], v23, s[8:11], s32 offen sc1
    s_waitcnt vmcnt(0)
L_f2_40:
    s_barrier
    s_cmp_lg_u32 s18, 0
    s_cbranch_scc1 chain_kernel_done
    s_add_u32 s20, s62, 4096
    s_mov_b32 s21, 1
    s_atomic_add s21, s[100:101], s20
    s_branch chain_kernel_done
Gq_17_f0123:
    buffer_load_dwordx4 v[32:35], v2, s[8:11], s40 offen offset:0 sc1
    s_branch Gq_17_s1230
Gq_17_f123p0:
    buffer_load_dwordx4 v[36:39], v2, s[8:11], s40 offen offset:1024 sc1
    s_add_u32 s33, s33, 1
    s_cmp_gt_u32 s33, 0x100000
    s_cbranch_scc1 chain_kernel_abort
    s_branch Gq_17_s231
Gq_17_f23p1:
    buffer_load_dwordx4 v[40:43], v2, s[8:11], s40 offen offset:2048 sc1
    s_add_u32 s33, s33, 1
    s_cmp_gt_u32 s33, 0x100000
    s_cbranch_scc1 chain_kernel_abort
    s_branch Gq_17_s32
Gq_17_f3p2:
    buffer_load_dwordx4 v[44:47], v2, s[8:11], s40 offen offset:3072 sc1
    s_add_u32 s33, s33, 1
    s_cmp_gt_u32 s33, 0x100000
    s_cbranch_scc1 chain_kernel_abort
    s_branch Gq_17_s3
Gq_17_redo:
    buffer_load_dwordx4 v[32:35], v2, s[8:11], s40 offen offset:0 sc1
    buffer_load_dwordx4 v[36:39], v2, s[8:11], s40 offen offset:1024 sc1
    buffer_load_dwordx4 v[40:43], v2, s[8:11], s40 offen offset:2048 sc1
    buffer_load_dwordx4 v[44:47], v2, s[8:11], s40 offen offset:3072 sc1
    s_add_u32 s33, s33, 1
    s_cmp_gt_u32 s33, 0x100000
    s_cbranch_scc1 chain_kernel_abort
    s_nop 5
    v_mov_b32 v64, 0
    v_mov_b32 v65, 0
    v_mov_b32 v66, 0
    v_mov_b32 v67, 0
    v_mov_b32 v68, 0
    v_mov_b32 v69, 0
    v_mov_b32 v70, 0
    v_mov_b32 v71, 0
    v_mov_b32 v72, 0
    v_mov_b32 v73, 0
    v_mov_b32 v74, 0
    v_mov_b32 v75, 0
    s_branch Gq_17_s0123
Gq_17_s1230:
    s_waitcnt vmcnt(3)
    v_cmp_eq_u32 vcc, -1, v36
    v_mov_b32_dpp v52, v36 row_ror:8 row_mask:0xf bank_mask:0xf
    v_mov_b32_dpp v53, v37 row_ror:8 row_mask:0xf bank_mask:0xf
    v_mov_b32_dpp v54, v38 row_ror:8 row_mask:0xf bank_mask:0xf
    v_mov_b32_dpp v55, v39 row_ror:8 row_mask:0xf bank_mask:0xf
    s_cbranch_vccnz Gq_17_f1230
    v_smfmac_f32_16x16x64_bf16 v[64:67], v[36:39], a[8:15], v19
    v_smfmac_f32_16x16x64_bf16 v[68:71], v[36:39], a[72:79], v19
Gq_17_s230p1:
    s_waitcnt vmcnt(2)
    v_cmp_eq_u32 vcc, -1, v40
    v_smfmac_f32_16x16x64_bf16 v[64:67], v[52:55], a[40:47], v19
    v_mov_b32_dpp v56, v40 row_ror:8 row_mask:0xf bank_mask:0xf
    v_mov_b32_dpp v57, v41 row_ror:8 row_mask:0xf bank_mask:0xf
    v_smfmac_f32_16x16x64_bf16 v[68:71], v[52:55], a[104:111], v19
    v_mov_b32_dpp v58, v42 row_ror:8 row_mask:0xf bank_mask:0xf
    v_mov_b32_dpp v59, v43 row_ror:8 row_mask:0xf bank_mask:0xf
    s_cbranch_vccnz Gq_17_f230p1
    v_smfmac_f32_16x16x64_bf16 v[64:67], v[40:43], a[16:23], v19
    v_smfmac_f32_16x16x64_bf16 v[68:71], v[40:43], a[80:87], v19
Gq_17_s30p2:
    s_waitcnt vmcnt(1)
    v_cmp_eq_u32 vcc, -1, v44
    v_smfmac_f32_16x16x64_bf16 v[64:67], v[56:59], a[48:55], v19
    v_mov_b32_dpp v60, v44 row_ror:8 row_mask:0xf bank_mask:0xf
    v_mov_b32_dpp v61, v45 row_ror:8 row_mask:0xf bank_mask:0xf
    v_smfmac_f32_16x16x64_bf16 v[68:71], v[56:59], a[112:119], v19
    v_mov_b32_dpp v62, v46 row_ror:8 row_mask:0xf bank_mask:0xf
    v_mov_b32_dpp v63, v47 row_ror:8 row_mask:0xf bank_mask:0xf
    s_cbranch_vccnz Gq_17_f30p2
    v_smfmac_f32_16x16x64_bf16 v[64:67], v[44:47], a[24:31], v19
    v_smfmac_f32_16x16x64_bf16 v[68:71], v[44:47], a[88:95], v19
Gq_17_s0p3:
    s_waitcnt vmcnt(0)
    v_cmp_eq_u32 vcc, -1, v32
    v_smfmac_f32_16x16x64_bf16 v[64:67], v[60:63], a[56:63], v19
    v_mov_b32_dpp v48, v32 row_ror:8 row_mask:0xf bank_mask:0xf
    v_mov_b32_dpp v49, v33 row_ror:8 row_mask:0xf bank_mask:0xf
    v_smfmac_f32_16x16x64_bf16 v[68:71], v[60:63], a[120:127], v19
    v_mov_b32_dpp v50, v34 row_ror:8 row_mask:0xf bank_mask:0xf
    v_mov_b32_dpp v51, v35 row_ror:8 row_mask:0xf bank_mask:0xf
    s_cbranch_vccnz Gq_17_f0p3
    v_smfmac_f32_16x16x64_bf16 v[64:67], v[32:35], a[0:7], v19
    v_smfmac_f32_16x16x64_bf16 v[68:71], v[32:35], a[64:71], v19
    v_smfmac_f32_16x16x64_bf16 v[64:67], v[48:51], a[32:39], v19
    v_smfmac_f32_16x16x64_bf16 v[68:71], v[48:51], a[96:103], v19
    s_branch Gq_17_done
Gq_17_f1230:
    buffer_load_dwordx4 v[36:39], v2, s[8:11], s40 offen offset:1024 sc1
    s_add_u32 s33, s33, 1
    s_cmp_gt_u32 s33, 0x100000
    s_cbranch_scc1 chain_kernel_abort
    s_branch Gq_17_s2301
Gq_17_f230p1:
    buffer_load_dwordx4 v[40:43], v2, s[8:11], s40 offen offset:2048 sc1
    s_add_u32 s33, s33, 1
    s_cmp_gt_u32 s33, 0x100000
    s_cbranch_scc1 chain_kernel_abort
    s_branch Gq_17_s302
Gq_17_f30p2:
    buffer_load_dwordx4 v[44:47], v2, s[8:11], s40 offen offset:3072 sc1
    s_add_u32 s33, s33, 1
    s_cmp_gt_u32 s33, 0x100000
    s_cbranch_scc1 chain_kernel_abort
    s_branch Gq_17_s03
Gq_17_f0p3:
    buffer_load_dwordx4 v[32:35], v2, s[8:11], s40 offen offset:0 sc1
    s_add_u32 s33, s33, 1
    s_cmp_gt_u32 s33, 0x100000
    s_cbranch_scc1 chain_kernel_abort
    s_branch Gq_17_s0
Gq_17_s231:
    s_waitcnt vmcnt(2)
    v_cmp_eq_u32 vcc, -1, v40
    v_mov_b32_dpp v56, v40 row_ror:8 row_mask:0xf bank_mask:0xf
    v_mov_b32_dpp v57, v41 row_ror:8 row_mask:0xf bank_mask:0xf
    v_mov_b32_dpp v58, v42 row_ror:8 row_mask:0xf bank_mask:0xf
    v_mov_b32_dpp v59, v43 row_ror:8 row_mask:0xf bank_mask:0xf
    s_cbranch_vccnz Gq_17_f231
    v_smfmac_f32_16x16x64_bf16 v[64:67], v[40:43], a[16:23], v19
    v_smfmac_f32_16x16x64_bf16 v[68:71], v[40:43], a[80:87], v19
Gq_17_s31p2:
    s_waitcnt vmcnt(1)
    v_cmp_eq_u32 vcc, -1, v44
    v_smfmac_f32_16x16x64_bf16 v[64:67], v[56:59], a[48:55], v19
    v_mov_b32_dpp v60, v44 row_ror:8 row_mask:0xf bank_mask:0xf
    v_mov_b32_dpp v61, v45 row_ror:8 row_mask:0xf bank_mask:0xf
    v_smfmac_f32_16x16x64_bf16 v[68:71], v[56:59], a[112:119], v19
    v_mov_b32_dpp v62, v46 row_ror:8 row_mask:0xf bank_mask:0xf
    v_mov_b32_dpp v63, v47 row_ror:8 row_mask:0xf bank_mask:0xf
    s_cbranch_vccnz Gq_17_f31p2
    v_smfmac_f32_16x16x64_bf16 v[64:67], v[44:47], a[24:31], v19
    v_smfmac_f32_16x16x64_bf16 v[68:71], v[44:47], a[88:95], v19
Gq_17_s1p3:
    s_waitcnt vmcnt(0)
    v_cmp_eq_u32 vcc, -1, v36
    v_smfmac_f32_16x16x64_bf16 v[64:67], v[60:63], a[56:63], v19
    v_mov_b32_dpp v52, v36 row_ror:8 row_mask:0xf bank_mask:0xf
    v_mov_b32_dpp v53, v37 row_ror:8 row_mask:0xf bank_mask:0xf
    v_smfmac_f32_16x16x64_bf16 v[68:71], v[60:63], a[120:127], v19
    v_mov_b32_dpp v54, v38 row_ror:8 row_mask:0xf bank_mask:0xf
    v_mov_b32_dpp v55, v39 row_ror:8 row_mask:0xf bank_mask:0xf
    s_cbranch_vccnz Gq_17_f1p3
    v_smfmac_f32_16x16x64_bf16 v[64:67], v[36:39], a[8:15], v19
    v_smfmac_f32_16x16x64_bf16 v[68:71], v[36:39], a[72:79], v19
    v_smfmac_f32_16x16x64_bf16 v[64:67], v[52:55], a[40:47], v19
    v_smfmac_f32_16x16x64_bf16 v[68:71], v[52:55], a[104:111], v19
    s_branch Gq_17_done
Gq_17_f231:
    buffer_load_dwordx4 v[40:43], v2, s[8:11], s40 offen offset:2048 sc1
    s_add_u32 s33, s33, 1
    s_cmp_gt_u32 s33, 0x100000
    s_cbranch_scc1 chain_kernel_abort
    s_branch Gq_17_s312
Gq_17_f31p2:
    buffer_load_dwordx4 v[44:47], v2, s[8:11], s40 offen offset:3072 sc1
    s_add_u32 s33, s33, 1
    s_cmp_gt_u32 s33, 0x100000
    s_cbranch_scc1 chain_kernel_abort
    s_branch Gq_17_s13
Gq_17_f1p3:
    buffer_load_dwordx4 v[36:39], v2, s[8:11], s40 offen offset:1024 sc1
    s_add_u32 s33, s33, 1
    s_cmp_gt_u32 s33, 0x100000
    s_cbranch_scc1 chain_kernel_abort
    s_branch Gq_17_s1
Gq_17_s32:
    s_waitcnt vmcnt(1)
    v_cmp_eq_u32 vcc, -1, v44
    v_mov_b32_dpp v60, v44 row_ror:8 row_mask:0xf bank_mask:0xf
    v_mov_b32_dpp v61, v45 row_ror:8 row_mask:0xf bank_mask:0xf
    v_mov_b32_dpp v62, v46 row_ror:8 row_mask:0xf bank_mask:0xf
    v_mov_b32_dpp v63, v47 row_ror:8 row_mask:0xf bank_mask:0xf
    s_cbranch_vccnz Gq_17_f32
    v_smfmac_f32_16x16x64_bf16 v[64:67], v[44:47], a[24:31], v19
    v_smfmac_f32_16x16x64_bf16 v[68:71], v[44:47], a[88:95], v19
Gq_17_s2p3:
    s_waitcnt vmcnt(0)
    v_cmp_eq_u32 vcc, -1, v40
    v_smfmac_f32_16x16x64_bf16 v[64:67], v[60:63], a[56:63], v19
    v_mov_b32_dpp v56, v40 row_ror:8 row_mask:0xf bank_mask:0xf
    v_mov_b32_dpp v57, v41 row_ror:8 row_mask:0xf bank_mask:0xf
    v_smfmac_f32_16x16x64_bf16 v[68:71], v[60:63], a[120:127], v19
    v_mov_b32_dpp v58, v42 row_ror:8 row_mask:0xf bank_mask:0xf
    v_mov_b32_dpp v59, v43 row_ror:8 row_mask:0xf bank_mask:0xf
    s_cbranch_vccnz Gq_17_f2p3
    v_smfmac_f32_16x16x64_bf16 v[64:67], v[40:43], a[16:23], v19
    v_smfmac_f32_16x16x64_bf16 v[68:71], v[40:43], a[80:87], v19
    v_smfmac_f32_16x16x64_bf16 v[64:67], v[56:59], a[48:55], v19
    v_smfmac_f32_16x16x64_bf16 v[68:71], v[56:59], a[112:119], v19
    s_branch Gq_17_done
Gq_17_f32:
    buffer_load_dwordx4 v[44:47], v2, s[8:11], s40 offen offset:3072 sc1
    s_add_u32 s33, s33, 1
    s_cmp_gt_u32 s33, 0x100000
    s_cbranch_scc1 chain_kernel_abort
    s_branch Gq_17_s23
Gq_17_f2p3:
    buffer_load_dwordx4 v[40:43], v2, s[8:11], s40 offen offset:2048 sc1
    s_add_u32 s33, s33, 1
    s_cmp_gt_u32 s33, 0x100000
    s_cbranch_scc1 chain_kernel_abort
    s_branch Gq_17_s2
Gq_17_s3:
    s_waitcnt vmcnt(0)
    v_cmp_eq_u32 vcc, -1, v44
    v_mov_b32_dpp v60, v44 row_ror:8 row_mask:0xf bank_mask:0xf
    v_mov_b32_dpp v61, v45 row_ror:8 row_mask:0xf bank_mask:0xf
    v_mov_b32_dpp v62, v46 row_ror:8 row_mask:0xf bank_mask:0xf
    v_mov_b32_dpp v63, v47 row_ror:8 row_mask:0xf bank_mask:0xf
    s_cbranch_vccnz Gq_17_f3
    v_smfmac_f32_16x16x64_bf16 v[64:67], v[44:47], a[24:31], v19
    v_smfmac_f32_16x16x64_bf16 v[68:71], v[44:47], a[88:95], v19
    v_smfmac_f32_16x16x64_bf16 v[64:67], v[60:63], a[56:63], v19
    v_smfmac_f32_16x16x64_bf16 v[68:71], v[60:63], a[120:127], v19
    s_branch Gq_17_done
Gq_17_f3:
    buffer_load_dwordx4 v[44:47], v2, s[8:11], s40 offen offset:3072 sc1
    s_add_u32 s33, s33, 1
    s_cmp_gt_u32 s33, 0x100000
    s_cbranch_scc1 chain_kernel_abort
    s_branch Gq_17_s3
Gq_17_s2301:
    s_waitcnt vmcnt(3)
    v_cmp_eq_u32 vcc, -1, v40
    v_mov_b32_dpp v56, v40 row_ror:8 row_mask:0xf bank_mask:0xf
    v_mov_b32_dpp v57, v41 row_ror:8 row_mask:0xf bank_mask:0xf
    v_mov_b32_dpp v58, v42 row_ror:8 row_mask:0xf bank_mask:0xf
    v_mov_b32_dpp v59, v43 row_ror:8 row_mask:0xf bank_mask:0xf
    s_cbranch_vccnz Gq_17_f2301
    v_smfmac_f32_16x16x64_bf16 v[64:67], v[40:43], a[16:23], v19
    v_smfmac_f32_16x16x64_bf16 v[68:71], v[40:43], a[80:87], v19
Gq_17_s301p2:
    s_waitcnt vmcnt(2)
    v_cmp_eq_u32 vcc, -1, v44
    v_smfmac_f32_16x16x64_bf16 v[64:67], v[56:59], a[48:55], v19
    v_mov_b32_dpp v60, v44 row_ror:8 row_mask:0xf bank_mask:0xf
    v_mov_b32_dpp v61, v45 row_ror:8 row_mask:0xf bank_mask:0xf
    v_smfmac_f32_16x16x64_bf16 v[68:71], v[56:59], a[112:119], v19
    v_mov_b32_dpp v62, v46 row_ror:8 row_mask:0xf bank_mask:0xf
    v_mov_b32_dpp v63, v47 row_ror:8 row_mask:0xf bank_mask:0xf
    s_cbranch_vccnz Gq_17_f301p2
    v_smfmac_f32_16x16x64_bf16 v[64:67], v[44:47], a[24:31], v19
    v_smfmac_f32_16x16x64_bf16 v[68:71], v[44:47], a[88:95], v19
Gq_17_s01p3:
    s_waitcnt vmcnt(1)
    v_cmp_eq_u32 vcc, -1, v32
    v_smfmac_f32_16x16x64_bf16 v[64:67], v[60:63], a[56:63], v19
    v_mov_b32_dpp v48, v32 row_ror:8 row_mask:0xf bank_mask:0xf
    v_mov_b32_dpp v49, v33 row_ror:8 row_mask:0xf bank_mask:0xf
    v_smfmac_f32_16x16x64_bf16 v[68:71], v[60:63], a[120:127], v19
    v_mov_b32_dpp v50, v34 row_ror:8 row_mask:0xf bank_mask:0xf
    v_mov_b32_dpp v51, v35 row_ror:8 row_mask:0xf bank_mask:0xf
    s_cbranch_vccnz Gq_17_f01p3
    v_smfmac_f32_16x16x64_bf16 v[64:67], v[32:35], a[0:7], v19
    v_smfmac_f32_16x16x64_bf16 v[68:71], v[32:35], a[64:71], v19
Gq_17_s1p0:
    s_waitcnt vmcnt(0)
    v_cmp_eq_u32 vcc, -1, v36
    v_smfmac_f32_16x16x64_bf16 v[64:67], v[48:51], a[32:39], v19
    v_mov_b32_dpp v52, v36 row_ror:8 row_mask:0xf bank_mask:0xf
    v_mov_b32_dpp v53, v37 row_ror:8 row_mask:0xf bank_mask:0xf
    v_smfmac_f32_16x16x64_bf16 v[68:71], v[48:51], a[96:103], v19
    v_mov_b32_dpp v54, v38 row_ror:8 row_mask:0xf bank_mask:0xf
    v_mov_b32_dpp v55, v39 row_ror:8 row_mask:0xf bank_mask:0xf
    s_cbranch_vccnz Gq_17_f1p0
    v_smfmac_f32_16x16x64_bf16 v[64:67], v[36:39], a[8:15], v19
    v_smfmac_f32_16x16x64_bf16 v[68:71], v[36:39], a[72:79], v19
    v_smfmac_f32_16x16x64_bf16 v[64:67], v[52:55], a[40:47], v19
    v_smfmac_f32_16x16x64_bf16 v[68:71], v[52:55], a[104:111], v19
    s_branch Gq_17_done
Gq_17_f2301:
    buffer_load_dwordx4 v[40:43], v2, s[8:11], s40 offen offset:2048 sc1
    s_add_u32 s33, s33, 1
    s_cmp_gt_u32 s33, 0x100000
    s_cbranch_scc1 chain_kernel_abort
    s_branch Gq_17_s3012
Gq_17_f301p2:
    buffer_load_dwordx4 v[44:47], v2, s[8:11], s40 offen offset:3072 sc1
    s_add_u32 s33, s33, 1
    s_cmp_gt_u32 s33, 0x100000
    s_cbranch_scc1 chain_kernel_abort
    s_branch Gq_17_s013
Gq_17_f01p3:
    buffer_load_dwordx4 v[32:35], v2, s[8:11], s40 offen offset:0 sc1
    s_add_u32 s33, s33, 1
    s_cmp_gt_u32 s33, 0x100000
    s_cbranch_scc1 chain_kernel_abort
    s_branch Gq_17_s10
Gq_17_f1p0:
    buffer_load_dwordx4 v[36:39], v2, s[8:11], s40 offen offset:1024 sc1
    s_add_u32 s33, s33, 1
    s_cmp_gt_u32 s33, 0x100000
    s_cbranch_scc1 chain_kernel_abort
    s_branch Gq_17_s1
Gq_17_s302:
    s_waitcnt vmcnt(2)
    v_cmp_eq_u32 vcc, -1, v44
    v_mov_b32_dpp v60, v44 row_ror:8 row_mask:0xf bank_mask:0xf
    v_mov_b32_dpp v61, v45 row_ror:8 row_mask:0xf bank_mask:0xf
    v_mov_b32_dpp v62, v46 row_ror:8 row_mask:0xf bank_mask:0xf
    v_mov_b32_dpp v63, v47 row_ror:8 row_mask:0xf bank_mask:0xf
    s_cbranch_vccnz Gq_17_f302
    v_smfmac_f32_16x16x64_bf16 v[64:67], v[44:47], a[24:31], v19
    v_smfmac_f32_16x16x64_bf16 v[68:71], v[44:47], a[88:95], v19
Gq_17_s02p3:
    s_waitcnt vmcnt(1)
    v_cmp_eq_u32 vcc, -1, v32
    v_smfmac_f32_16x16x64_bf16 v[64:67], v[60:63], a[56:63], v19
    v_mov_b32_dpp v48, v32 row_ror:8 row_mask:0xf bank_mask:0xf
    v_mov_b32_dpp v49, v33 row_ror:8 row_mask:0xf bank_mask:0xf
    v_smfmac_f32_16x16x64_bf16 v[68:71], v[60:63], a[120:127], v19
    v_mov_b32_dpp v50, v34 row_ror:8 row_mask:0xf bank_mask:0xf
    v_mov_b32_dpp v51, v35 row_ror:8 row_mask:0xf bank_mask:0xf
    s_cbranch_vccnz Gq_17_f02p3
    v_smfmac_f32_16x16x64_bf16 v[64:67], v[32:35], a[0:7], v19
    v_smfmac_f32_16x16x64_bf16 v[68:71], v[32:35], a[64:71], v19
Gq_17_s2p0:
    s_waitcnt vmcnt(0)
    v_cmp_eq_u32 vcc, -1, v40
    v_smfmac_f32_16x16x64_bf16 v[64:67], v[48:51], a[32:39], v19
    v_mov_b32_dpp v56, v40 row_ror:8 row_mask:0xf bank_mask:0xf
    v_mov_b32_dpp v57, v41 row_ror:8 row_mask:0xf bank_mask:0xf
    v_smfmac_f32_16x16x64_bf16 v[68:71], v[48:51], a[96:103], v19
    v_mov_b32_dpp v58, v42 row_ror:8 row_mask:0xf bank_mask:0xf
    v_mov_b32_dpp v59, v43 row_ror:8 row_mask:0xf bank_mask:0xf
    s_cbranch_vccnz Gq_17_f2p0
    v_smfmac_f32_16x16x64_bf16 v[64:67], v[40:43], a[16:23], v19
    v_smfmac_f32_16x16x64_bf16 v[68:71], v[40:43], a[80:87], v19
    v_smfmac_f32_16x16x64_bf16 v[64:67], v[56:59], a[48:55], v19
    v_smfmac_f32_16x16x64_bf16 v[68:71], v[56:59], a[112:119], v19
    s_branch Gq_17_done
Gq_17_f302:
    buffer_load_dwordx4 v[44:47], v2, s[8:11], s40 offen offset:3072 sc1
    s_add_u32 s33, s33, 1
    s_cmp_gt_u32 s33, 0x100000
    s_cbranch_scc1 chain_kernel_abort
    s_branch Gq_17_s023
Gq_17_f02p3:
    buffer_load_dwordx4 v[32:35], v2, s[8:11], s40 offen offset:0 sc1
    s_add_u32 s33, s33, 1
    s_cmp_gt_u32 s33, 0x100000
    s_cbranch_scc1 chain_kernel_abort
    s_branch Gq_17_s20
Gq_17_f2p0:
    buffer_load_dwordx4 v[40:43], v2, s[8:11], s40 offen offset:2048 sc1
    s_add_u32 s33, s33, 1
    s_cmp_gt_u32 s33, 0x100000
    s_cbranch_scc1 chain_kernel_abort
    s_branch Gq_17_s2
Gq_17_s03:
    s_waitcnt vmcnt(1)
    v_cmp_eq_u32 vcc, -1, v32
    v_mov_b32_dpp v48, v32 row_ror:8 row_mask:0xf bank_mask:0xf
    v_mov_b32_dpp v49, v33 row_ror:8 row_mask:0xf bank_mask:0xf
    v_mov_b32_dpp v50, v34 row_ror:8 row_mask:0xf bank_mask:0xf
    v_mov_b32_dpp v51, v35 row_ror:8 row_mask:0xf bank_mask:0xf
    s_cbranch_vccnz Gq_17_f03
    v_smfmac_f32_16x16x64_bf16 v[64:67], v[32:35], a[0:7], v19
    v_smfmac_f32_16x16x64_bf16 v[68:71], v[32:35], a[64:71], v19
Gq_17_s3p0:
    s_waitcnt vmcnt(0)
    v_cmp_eq_u32 vcc, -1, v44
    v_smfmac_f32_16x16x64_bf16 v[64:67], v[48:51], a[32:39], v19
    v_mov_b32_dpp v60, v44 row_ror:8 row_mask:0xf bank_mask:0xf
    v_mov_b32_dpp v61, v45 row_ror:8 row_mask:0xf bank_mask:0xf
    v_smfmac_f32_16x16x64_bf16 v[68:71], v[48:51], a[96:103], v19
    v_mov_b32_dpp v62, v46 row_ror:8 row_mask:0xf bank_mask:0xf
    v_mov_b32_dpp v63, v47 row_ror:8 row_mask:0xf bank_mask:0xf
    s_cbranch_vccnz Gq_17_f3p0
    v_smfmac_f32_16x16x64_bf16 v[64:67], v[44:47], a[24:31], v19
    v_smfmac_f32_16x16x64_bf16 v[68:71], v[44:47], a[88:95], v19
    v_smfmac_f32_16x16x64_bf16 v[64:67], v[60:63], a[56:63], v19
    v_smfmac_f32_16x16x64_bf16 v[68:71], v[60:63], a[120:127], v19
    s_branch Gq_17_done
Gq_17_f03:
    buffer_load_dwordx4 v[32:35], v2, s[8:11], s40 offen offset:0 sc1
    s_add_u32 s33, s33, 1
    s_cmp_gt_u32 s33, 0x100000
    s_cbranch_scc1 chain_kernel_abort
    s_branch Gq_17_s30
Gq_17_f3p0:
    buffer_load_dwordx4 v[44:47], v2, s[8:11], s40 offen offset:3072 sc1
    s_add_u32 s33, s33, 1
    s_cmp_gt_u32 s33, 0x100000
    s_cbranch_scc1 chain_kernel_abort
    s_branch Gq_17_s3
Gq_17_s0:
    s_waitcnt vmcnt(0)
    v_cmp_eq_u32 vcc, -1, v32
    v_mov_b32_dpp v48, v32 row_ror:8 row_mask:0xf bank_mask:0xf
    v_mov_b32_dpp v49, v33 row_ror:8 row_mask:0xf bank_mask:0xf
    v_mov_b32_dpp v50, v34 row_ror:8 row_mask:0xf bank_mask:0xf
    v_mov_b32_dpp v51, v35 row_ror:8 row_mask:0xf bank_mask:0xf
    s_cbranch_vccnz Gq_17_f0
    v_smfmac_f32_16x16x64_bf16 v[64:67], v[32:35], a[0:7], v19
    v_smfmac_f32_16x16x64_bf16 v[68:71], v[32:35], a[64:71], v19
    v_smfmac_f32_16x16x64_bf16 v[64:67], v[48:51], a[32:39], v19
    v_smfmac_f32_16x16x64_bf16 v[68:71], v[48:51], a[96:103], v19
    s_branch Gq_17_done
Gq_17_f0:
    buffer_load_dwordx4 v[32:35], v2, s[8:11], s40 offen offset:0 sc1
    s_add_u32 s33, s33, 1
    s_cmp_gt_u32 s33, 0x100000
    s_cbranch_scc1 chain_kernel_abort
    s_branch Gq_17_s0
Gq_17_s312:
    s_waitcnt vmcnt(2)
    v_cmp_eq_u32 vcc, -1, v44
    v_mov_b32_dpp v60, v44 row_ror:8 row_mask:0xf bank_mask:0xf
    v_mov_b32_dpp v61, v45 row_ror:8 row_mask:0xf bank_mask:0xf
    v_mov_b32_dpp v62, v46 row_ror:8 row_mask:0xf bank_mask:0xf
    v_mov_b32_dpp v63, v47 row_ror:8 row_mask:0xf bank_mask:0xf
    s_cbranch_vccnz Gq_17_f312
    v_smfmac_f32_16x16x64_bf16 v[64:67], v[44:47], a[24:31], v19
    v_smfmac_f32_16x16x64_bf16 v[68:71], v[44:47], a[88:95], v19
Gq_17_s12p3:
    s_waitcnt vmcnt(1)
    v_cmp_eq_u32 vcc, -1, v36
    v_smfmac_f32_16x16x64_bf16 v[64:67], v[60:63], a[56:63], v19
    v_mov_b32_dpp v52, v36 row_ror:8 row_mask:0xf bank_mask:0xf
    v_mov_b32_dpp v53, v37 row_ror:8 row_mask:0xf bank_mask:0xf
    v_smfmac_f32_16x16x64_bf16 v[68:71], v[60:63], a[120:127], v19
    v_mov_b32_dpp v54, v38 row_ror:8 row_mask:0xf bank_mask:0xf
    v_mov_b32_dpp v55, v39 row_ror:8 row_mask:0xf bank_mask:0xf
    s_cbranch_vccnz Gq_17_f12p3
    v_smfmac_f32_16x16x64_bf16 v[64:67], v[36:39], a[8:15], v19
    v_smfmac_f32_16x16x64_bf16 v[68:71], v[36:39], a[72:79], v19
Gq_17_s2p1:
    s_waitcnt vmcnt(0)
    v_cmp_eq_u32 vcc, -1, v40
    v_smfmac_f32_16x16x64_bf16 v[64:67], v[52:55], a[40:47], v19
    v_mov_b32_dpp v56, v40 row_ror:8 row_mask:0xf bank_mask:0xf
    v_mov_b32_dpp v57, v41 row_ror:8 row_mask:0xf bank_mask:0xf
    v_smfmac_f32_16x16x64_bf16 v[68:71], v[52:55], a[104:111], v19
    v_mov_b32_dpp v58, v42 row_ror:8 row_mask:0xf bank_mask:0xf
    v_mov_b32_dpp v59, v43 row_ror:8 row_mask:0xf bank_mask:0xf
    s_cbranch_vccnz Gq_17_f2p1
    v_smfmac_f32_16x16x64_bf16 v[64:67], v[40:43], a[16:23], v19
    v_smfmac_f32_16x16x64_bf16 v[68:71], v[40:43], a[80:87], v19
    v_smfmac_f32_16x16x64_bf16 v[64:67], v[56:59], a[48:55], v19
    v_smfmac_f32_16x16x64_bf16 v[68:71], v[56:59], a[112:119], v19
    s_branch Gq_17_done
Gq_17_f312:
    buffer_load_dwordx4 v[44:47], v2, s[8:11], s40 offen offset:3072 sc1
    s_add_u32 s33, s33, 1
    s_cmp_gt_u32 s33, 0x100000
    s_cbranch_scc1 chain_kernel_abort
    s_branch Gq_17_s123
Gq_17_f12p3:
    buffer_load_dwordx4 v[36:39], v2, s[8:11], s40 offen offset:1024 sc1
    s_add_u32 s33, s33, 1
    s_cmp_gt_u32 s33, 0x100000
    s_cbranch_scc1 chain_kernel_abort
    s_branch Gq_17_s21
Gq_17_f2p1:
    buffer_load_dwordx4 v[40:43], v2, s[8:11], s40 offen offset:2048 sc1
    s_add_u32 s33, s33, 1
    s_cmp_gt_u32 s33, 0x100000
    s_cbranch_scc1 chain_kernel_abort
    s_branch Gq_17_s2
Gq_17_s13:
    s_waitcnt vmcnt(1)
    v_cmp_eq_u32 vcc, -1, v36
    v_mov_b32_dpp v52, v36 row_ror:8 row_mask:0xf bank_mask:0xf
    v_mov_b32_dpp v53, v37 row_ror:8 row_mask:0xf bank_mask:0xf
    v_mov_b32_dpp v54, v38 row_ror:8 row_mask:0xf bank_mask:0xf
    v_mov_b32_dpp v55, v39 row_ror:8 row_mask:0xf bank_mask:0xf
    s_cbranch_vccnz Gq_17_f13
    v_smfmac_f32_16x16x64_bf16 v[64:67], v[36:39], a[8:15], v19
    v_smfmac_f32_16x16x64_bf16 v[68:71], v[36:39], a[72:79], v19
Gq_17_s3p1:
    s_waitcnt vmcnt(0)
    v_cmp_eq_u32 vcc, -1, v44
    v_smfmac_f32_16x16x64_bf16 v[64:67], v[52:55], a[40:47], v19
    v_mov_b32_dpp v60, v44 row_ror:8 row_mask:0xf bank_mask:0xf
    v_mov_b32_dpp v61, v45 row_ror:8 row_mask:0xf bank_mask:0xf
    v_smfmac_f32_16x16x64_bf16 v[68:71], v[52:55], a[104:111], v19
    v_mov_b32_dpp v62, v46 row_ror:8 row_mask:0xf bank_mask:0xf
    v_mov_b32_dpp v63, v47 row_ror:8 row_mask:0xf bank_mask:0xf
    s_cbranch_vccnz Gq_17_f3p1
    v_smfmac_f32_16x16x64_bf16 v[64:67], v[44:47], a[24:31], v19
    v_smfmac_f32_16x16x64_bf16 v[68:71], v[44:47], a[88:95], v19
    v_smfmac_f32_16x16x64_bf16 v[64:67], v[60:63], a[56:63], v19
    v_smfmac_f32_16x16x64_bf16 v[68:71], v[60:63], a[120:127], v19
    s_branch Gq_17_done
Gq_17_f13:
    buffer_load_dwordx4 v[36:39], v2, s[8:11], s40 offen offset:1024 sc1
    s_add_u32 s33, s33, 1
    s_cmp_gt_u32 s33, 0x100000
    s_cbranch_scc1 chain_kernel_abort
    s_branch Gq_17_s31
Gq_17_f3p1:
    buffer_load_dwordx4 v[44:47], v2, s[8:11], s40 offen offset:3072 sc1
    s_add_u32 s33, s33, 1
    s_cmp_gt_u32 s33, 0x100000
    s_cbranch_scc1 chain_kernel_abort
    s_branch Gq_17_s3
Gq_17_s1:
    s_waitcnt vmcnt(0)
    v_cmp_eq_u32 vcc, -1, v36
    v_mov_b32_dpp v52, v36 row_ror:8 row_mask:0xf bank_mask:0xf
    v_mov_b32_dpp v53, v37 row_ror:8 row_mask:0xf bank_mask:0xf
    v_mov_b32_dpp v54, v38 row_ror:8 row_mask:0xf bank_mask:0xf
    v_mov_b32_dpp v55, v39 row_ror:8 row_mask:0xf bank_mask:0xf
    s_cbranch_vccnz Gq_17_f1
    v_smfmac_f32_16x16x64_bf16 v[64:67], v[36:39], a[8:15], v19
    v_smfmac_f32_16x16x64_bf16 v[68:71], v[36:39], a[72:79], v19
    v_smfmac_f32_16x16x64_bf16 v[64:67], v[52:55], a[40:47], v19
    v_smfmac_f32_16x16x64_bf16 v[68:71], v[52:55], a[104:111], v19
    s_branch Gq_17_done
Gq_17_f1:
    buffer_load_dwordx4 v[36:39], v2, s[8:11], s40 offen offset:1024 sc1
    s_add_u32 s33, s33, 1
    s_cmp_gt_u32 s33, 0x100000
    s_cbranch_scc1 chain_kernel_abort
    s_branch Gq_17_s1
Gq_17_s23:
    s_waitcnt vmcnt(1)
    v_cmp_eq_u32 vcc, -1, v40
    v_mov_b32_dpp v56, v40 row_ror:8 row_mask:0xf bank_mask:0xf
    v_mov_b32_dpp v57, v41 row_ror:8 row_mask:0xf bank_mask:0xf
    v_mov_b32_dpp v58, v42 row_ror:8 row_mask:0xf bank_mask:0xf
    v_mov_b32_dpp v59, v43 row_ror:8 row_mask:0xf bank_mask:0xf
    s_cbranch_vccnz Gq_17_f23
    v_smfmac_f32_16x16x64_bf16 v[64:67], v[40:43], a[16:23], v19
    v_smfmac_f32_16x16x64_bf16 v[68:71], v[40:43], a[80:87], v19
    s_branch Gq_17_s3p2
Gq_17_f23:
    buffer_load_dwordx4 v[40:43], v2, s[8:11], s40 offen offset:2048 sc1
    s_add_u32 s33, s33, 1
    s_cmp_gt_u32 s33, 0x100000
    s_cbranch_scc1 chain_kernel_abort
    s_branch Gq_17_s32
Gq_17_s2:
    s_waitcnt vmcnt(0)
    v_cmp_eq_u32 vcc, -1, v40
    v_mov_b32_dpp v56, v40 row_ror:8 row_mask:0xf bank_mask:0xf
    v_mov_b32_dpp v57, v41 row_ror:8 row_mask:0xf bank_mask:0xf
    v_mov_b32_dpp v58, v42 row_ror:8 row_mask:0xf bank_mask:0xf
    v_mov_b32_dpp v59, v43 row_ror:8 row_mask:0xf bank_mask:0xf
    s_cbranch_vccnz Gq_17_f2
    v_smfmac_f32_16x16x64_bf16 v[64:67], v[40:43], a[16:23], v19
    v_smfmac_f32_16x16x64_bf16 v[68:71], v[40:43], a[80:87], v19
    v_smfmac_f32_16x16x64_bf16 v[64:67], v[56:59], a[48:55], v19
    v_smfmac_f32_16x16x64_bf16 v[68:71], v[56:59], a[112:119], v19
    s_branch Gq_17_done
Gq_17_f2:
    buffer_load_dwordx4 v[40:43], v2, s[8:11], s40 offen offset:2048 sc1
    s_add_u32 s33, s33, 1
    s_cmp_gt_u32 s33, 0x100000
    s_cbranch_scc1 chain_kernel_abort
    s_branch Gq_17_s2
Gq_17_s3012:
    s_waitcnt vmcnt(3)
    v_cmp_eq_u32 vcc, -1, v44
    v_mov_b32_dpp v60, v44 row_ror:8 row_mask:0xf bank_mask:0xf
    v_mov_b32_dpp v61, v45 row_ror:8 row_mask:0xf bank_mask:0xf
    v_mov_b32_dpp v62, v46 row_ror:8 row_mask:0xf bank_mask:0xf
    v_mov_b32_dpp v63, v47 row_ror:8 row_mask:0xf bank_mask:0xf
    s_cbranch_vccnz Gq_17_f3012
    v_smfmac_f32_16x16x64_bf16 v[64:67], v[44:47], a[24:31], v19
    v_smfmac_f32_16x16x64_bf16 v[68:71], v[44:47], a[88:95], v19
Gq_17_s012p3:
    s_waitcnt vmcnt(2)
    v_cmp_eq_u32 vcc, -1, v32
    v_smfmac_f32_16x16x64_bf16 v[64:67], v[60:63], a[56:63], v19
    v_mov_b32_dpp v48, v32 row_ror:8 row_mask:0xf bank_mask:0xf
    v_mov_b32_dpp v49, v33 row_ror:8 row_mask:0xf bank_mask:0xf
    v_smfmac_f32_16x16x64_bf16 v[68:71], v[60:63], a[120:127], v19
    v_mov_b32_dpp v50, v34 row_ror:8 row_mask:0xf bank_mask:0xf
    v_mov_b32_dpp v51, v35 row_ror:8 row_mask:0xf bank_mask:0xf
    s_cbranch_vccnz Gq_17_f012p3
    v_smfmac_f32_16x16x64_bf16 v[64:67], v[32:35], a[0:7], v19
    v_smfmac_f32_16x16x64_bf16 v[68:71], v[32:35], a[64:71], v19
Gq_17_s12p0:
    s_waitcnt vmcnt(1)
    v_cmp_eq_u32 vcc, -1, v36
    v_smfmac_f32_16x16x64_bf16 v[64:67], v[48:51], a[32:39], v19
    v_mov_b32_dpp v52, v36 row_ror:8 row_mask:0xf bank_mask:0xf
    v_mov_b32_dpp v53, v37 row_ror:8 row_mask:0xf bank_mask:0xf
    v_smfmac_f32_16x16x64_bf16 v[68:71], v[48:51], a[96:103], v19
    v_mov_b32_dpp v54, v38 row_ror:8 row_mask:0xf bank_mask:0xf
    v_mov_b32_dpp v55, v39 row_ror:8 row_mask:0xf bank_mask:0xf
    s_cbranch_vccnz Gq_17_f12p0
    v_smfmac_f32_16x16x64_bf16 v[64:67], v[36:39], a[8:15], v19
    v_smfmac_f32_16x16x64_bf16 v[68:71], v[36:39], a[72:79], v19
    s_branch Gq_17_s2p1
Gq_17_f3012:
    buffer_load_dwordx4 v[44:47], v2, s[8:11], s40 offen offset:3072 sc1
    s_add_u32 s33, s33, 1
    s_cmp_gt_u32 s33, 0x100000
    s_cbranch_scc1 chain_kernel_abort
    s_branch Gq_17_s0123
Gq_17_f012p3:
    buffer_load_dwordx4 v[32:35], v2, s[8:11], s40 offen offset:0 sc1
    s_add_u32 s33, s33, 1
    s_cmp_gt_u32 s33, 0x100000
    s_cbranch_scc1 chain_kernel_abort
    s_branch Gq_17_s120
Gq_17_f12p0:
    buffer_load_dwordx4 v[36:39], v2, s[8:11], s40 offen offset:1024 sc1
    s_add_u32 s33, s33, 1
    s_cmp_gt_u32 s33, 0x100000
    s_cbranch_scc1 chain_kernel_abort
    s_branch Gq_17_s21
Gq_17_s013:
    s_waitcnt vmcnt(2)
    v_cmp_eq_u32 vcc, -1, v32
    v_mov_b32_dpp v48, v32 row_ror:8 row_mask:0xf bank_mask:0xf
    v_mov_b32_dpp v49, v33 row_ror:8 row_mask:0xf bank_mask:0xf
    v_mov_b32_dpp v50, v34 row_ror:8 row_mask:0xf bank_mask:0xf
    v_mov_b32_dpp v51, v35 row_ror:8 row_mask:0xf bank_mask:0xf
    s_cbranch_vccnz Gq_17_f013
    v_smfmac_f32_16x16x64_bf16 v[64:67], v[32:35], a[0:7], v19
    v_smfmac_f32_16x16x64_bf16 v[68:71], v[32:35], a[64:71], v19
Gq_17_s13p0:
    s_waitcnt vmcnt(1)
    v_cmp_eq_u32 vcc, -1, v36
    v_smfmac_f32_16x16x64_bf16 v[64:67], v[48:51], a[32:39], v19
    v_mov_b32_dpp v52, v36 row_ror:8 row_mask:0xf bank_mask:0xf
    v_mov_b32_dpp v53, v37 row_ror:8 row_mask:0xf bank_mask:0xf
    v_smfmac_f32_16x16x64_bf16 v[68:71], v[48:51], a[96:103], v19
    v_mov_b32_dpp v54, v38 row_ror:8 row_mask:0xf bank_mask:0xf
    v_mov_b32_dpp v55, v39 row_ror:8 row_mask:0xf bank_mask:0xf
    s_cbranch_vccnz Gq_17_f13p0
    v_smfmac_f32_16x16x64_bf16 v[64:67], v[36:39], a[8:15], v19
    v_smfmac_f32_16x16x64_bf16 v[68:71], v[36:39], a[72:79], v19
    s_branch Gq_17_s3p1
Gq_17_f013:
    buffer_load_dwordx4 v[32:35], v2, s[8:11], s40 offen offset:0 sc1
    s_add_u32 s33, s33, 1
    s_cmp_gt_u32 s33, 0x100000
    s_cbranch_scc1 chain_kernel_abort
    s_branch Gq_17_s130
Gq_17_f13p0:
    buffer_load_dwordx4 v[36:39], v2, s[8:11], s40 offen offset:1024 sc1
    s_add_u32 s33, s33, 1
    s_cmp_gt_u32 s33, 0x100000
    s_cbranch_scc1 chain_kernel_abort
    s_branch Gq_17_s31
Gq_17_s10:
    s_waitcnt vmcnt(1)
    v_cmp_eq_u32 vcc, -1, v36
    v_mov_b32_dpp v52, v36 row_ror:8 row_mask:0xf bank_mask:0xf
    v_mov_b32_dpp v53, v37 row_ror:8 row_mask:0xf bank_mask:0xf
    v_mov_b32_dpp v54, v38 row_ror:8 row_mask:0xf bank_mask:0xf
    v_mov_b32_dpp v55, v39 row_ror:8 row_mask:0xf bank_mask:0xf
    s_cbranch_vccnz Gq_17_f10
    v_smfmac_f32_16x16x64_bf16 v[64:67], v[36:39], a[8:15], v19
    v_smfmac_f32_16x16x64_bf16 v[68:71], v[36:39], a[72:79], v19
Gq_17_s0p1:
    s_waitcnt vmcnt(0)
    v_cmp_eq_u32 vcc, -1, v32
    v_smfmac_f32_16x16x64_bf16 v[64:67], v[52:55], a[40:47], v19
    v_mov_b32_dpp v48, v32 row_ror:8 row_mask:0xf bank_mask:0xf
    v_mov_b32_dpp v49, v33 row_ror:8 row_mask:0xf bank_mask:0xf
    v_smfmac_f32_16x16x64_bf16 v[68:71], v[52:55], a[104:111], v19
    v_mov_b32_dpp v50, v34 row_ror:8 row_mask:0xf bank_mask:0xf
    v_mov_b32_dpp v51, v35 row_ror:8 row_mask:0xf bank_mask:0xf
    s_cbranch_vccnz Gq_17_f0p1
    v_smfmac_f32_16x16x64_bf16 v[64:67], v[32:35], a[0:7], v19
    v_smfmac_f32_16x16x64_bf16 v[68:71], v[32:35], a[64:71], v19
    v_smfmac_f32_16x16x64_bf16 v[64:67], v[48:51], a[32:39], v19
    v_smfmac_f32_16x16x64_bf16 v[68:71], v[48:51], a[96:103], v19
    s_branch Gq_17_done
Gq_17_f10:
    buffer_load_dwordx4 v[36:39], v2, s[8:11], s40 offen offset:1024 sc1
    s_add_u32 s33, s33, 1
    s_cmp_gt_u32 s33, 0x100000
    s_cbranch_scc1 chain_kernel_abort
    s_branch Gq_17_s01
Gq_17_f0p1:
    buffer_load_dwordx4 v[32:35], v2, s[8:11], s40 offen offset:0 sc1
    s_add_u32 s33, s33, 1
    s_cmp_gt_u32 s33, 0x100000
    s_cbranch_scc1 chain_kernel_abort
    s_branch Gq_17_s0
Gq_17_s023:
    s_waitcnt vmcnt(2)
    v_cmp_eq_u32 vcc, -1, v32
    v_mov_b32_dpp v48, v32 row_ror:8 row_mask:0xf bank_mask:0xf
    v_mov_b32_dpp v49, v33 row_ror:8 row_mask:0xf bank_mask:0xf
    v_mov_b32_dpp v50, v34 row_ror:8 row_mask:0xf bank_mask:0xf
    v_mov_b32_dpp v51, v35 row_ror:8 row_mask:0xf bank_mask:0xf
    s_cbranch_vccnz Gq_17_f023
    v_smfmac_f32_16x16x64_bf16 v[64:67], v[32:35], a[0:7], v19
    v_smfmac_f32_16x16x64_bf16 v[68:71], v[32:35], a[64:71], v19
Gq_17_s23p0:
    s_waitcnt vmcnt(1)
    v_cmp_eq_u32 vcc, -1, v40
    v_smfmac_f32_16x16x64_bf16 v[64:67], v[48:51], a[32:39], v19
    v_mov_b32_dpp v56, v40 row_ror:8 row_mask:0xf bank_mask:0xf
    v_mov_b32_dpp v57, v41 row_ror:8 row_mask:0xf bank_mask:0xf
    v_smfmac_f32_16x16x64_bf16 v[68:71], v[48:51], a[96:103], v19
    v_mov_b32_dpp v58, v42 row_ror:8 row_mask:0xf bank_mask:0xf
    v_mov_b32_dpp v59, v43 row_ror:8 row_mask:0xf bank_mask:0xf
    s_cbranch_vccnz Gq_17_f23p0
    v_smfmac_f32_16x16x64_bf16 v[64:67], v[40:43], a[16:23], v19
    v_smfmac_f32_16x16x64_bf16 v[68:71], v[40:43], a[80:87], v19
    s_branch Gq_17_s3p2
Gq_17_f023:
    buffer_load_dwordx4 v[32:35], v2, s[8:11], s40 offen offset:0 sc1
    s_add_u32 s33, s33, 1
    s_cmp_gt_u32 s33, 0x100000
    s_cbranch_scc1 chain_kernel_abort
    s_branch Gq_17_s230
Gq_17_f23p0:
    buffer_load_dwordx4 v[40:43], v2, s[8:11], s40 offen offset:2048 sc1
    s_add_u32 s33, s33, 1
    s_cmp_gt_u32 s33, 0x100000
    s_cbranch_scc1 chain_kernel_abort
    s_branch Gq_17_s32
Gq_17_s20:
    s_waitcnt vmcnt(1)
    v_cmp_eq_u32 vcc, -1, v40
    v_mov_b32_dpp v56, v40 row_ror:8 row_mask:0xf bank_mask:0xf
    v_mov_b32_dpp v57, v41 row_ror:8 row_mask:0xf bank_mask:0xf
    v_mov_b32_dpp v58, v42 row_ror:8 row_mask:0xf bank_mask:0xf
    v_mov_b32_dpp v59, v43 row_ror:8 row_mask:0xf bank_mask:0xf
    s_cbranch_vccnz Gq_17_f20
    v_smfmac_f32_16x16x64_bf16 v[64:67], v[40:43], a[16:23], v19
    v_smfmac_f32_16x16x64_bf16 v[68:71], v[40:43], a[80:87], v19
Gq_17_s0p2:
    s_waitcnt vmcnt(0)
    v_cmp_eq_u32 vcc, -1, v32
    v_smfmac_f32_16x16x64_bf16 v[64:67], v[56:59], a[48:55], v19
    v_mov_b32_dpp v48, v32 row_ror:8 row_mask:0xf bank_mask:0xf
    v_mov_b32_dpp v49, v33 row_ror:8 row_mask:0xf bank_mask:0xf
    v_smfmac_f32_16x16x64_bf16 v[68:71], v[56:59], a[112:119], v19
    v_mov_b32_dpp v50, v34 row_ror:8 row_mask:0xf bank_mask:0xf
    v_mov_b32_dpp v51, v35 row_ror:8 row_mask:0xf bank_mask:0xf
    s_cbranch_vccnz Gq_17_f0p2
    v_smfmac_f32_16x16x64_bf16 v[64:67], v[32:35], a[0:7], v19
    v_smfmac_f32_16x16x64_bf16 v[68:71], v[32:35], a[64:71], v19
    v_smfmac_f32_16x16x64_bf16 v[64:67], v[48:51], a[32:39], v19
    v_smfmac_f32_16x16x64_bf16 v[68:71], v[48:51], a[96:103], v19
    s_branch Gq_17_done
Gq_17_f20:
    buffer_load_dwordx4 v[40:43], v2, s[8:11], s40 offen offset:2048 sc1
    s_add_u32 s33, s33, 1
    s_cmp_gt_u32 s33, 0x100000
    s_cbranch_scc1 chain_kernel_abort
    s_branch Gq_17_s02
Gq_17_f0p2:
    buffer_load_dwordx4 v[32:35], v2, s[8:11], s40 offen offset:0 sc1
    s_add_u32 s33, s33, 1
    s_cmp_gt_u32 s33, 0x100000
    s_cbranch_scc1 chain_kernel_abort
    s_branch Gq_17_s0
Gq_17_s30:
    s_waitcnt vmcnt(1)
    v_cmp_eq_u32 vcc, -1, v44
    v_mov_b32_dpp v60, v44 row_ror:8 row_mask:0xf bank_mask:0xf
    v_mov_b32_dpp v61, v45 row_ror:8 row_mask:0xf bank_mask:0xf
    v_mov_b32_dpp v62, v46 row_ror:8 row_mask:0xf bank_mask:0xf
    v_mov_b32_dpp v63, v47 row_ror:8 row_mask:0xf bank_mask:0xf
    s_cbranch_vccnz Gq_17_f30
    v_smfmac_f32_16x16x64_bf16 v[64:67], v[44:47], a[24:31], v19
    v_smfmac_f32_16x16x64_bf16 v[68:71], v[44:47], a[88:95], v19
    s_branch Gq_17_s0p3
Gq_17_f30:
    buffer_load_dwordx4 v[44:47], v2, s[8:11], s40 offen offset:3072 sc1
    s_add_u32 s33, s33, 1
    s_cmp_gt_u32 s33, 0x100000
    s_cbranch_scc1 chain_kernel_abort
    s_branch Gq_17_s03
Gq_17_s123:
    s_waitcnt vmcnt(2)
    v_cmp_eq_u32 vcc, -1, v36
    v_mov_b32_dpp v52, v36 row_ror:8 row_mask:0xf bank_mask:0xf
    v_mov_b32_dpp v53, v37 row_ror:8 row_mask:0xf bank_mask:0xf
    v_mov_b32_dpp v54, v38 row_ror:8 row_mask:0xf bank_mask:0xf
    v_mov_b32_dpp v55, v39 row_ror:8 row_mask:0xf bank_mask:0xf
    s_cbranch_vccnz Gq_17_f123
    v_smfmac_f32_16x16x64_bf16 v[64:67], v[36:39], a[8:15], v19
    v_smfmac_f32_16x16x64_bf16 v[68:71], v[36:39], a[72:79], v19
    s_branch Gq_17_s23p1
Gq_17_f123:
    buffer_load_dwordx4 v[36:39], v2, s[8:11], s40 offen offset:1024 sc1
    s_add_u32 s33, s33, 1
    s_cmp_gt_u32 s33, 0x100000
    s_cbranch_scc1 chain_kernel_abort
    s_branch Gq_17_s231
Gq_17_s21:
    s_waitcnt vmcnt(1)
    v_cmp_eq_u32 vcc, -1, v40
    v_mov_b32_dpp v56, v40 row_ror:8 row_mask:0xf bank_mask:0xf
    v_mov_b32_dpp v57, v41 row_ror:8 row_mask:0xf bank_mask:0xf
    v_mov_b32_dpp v58, v42 row_ror:8 row_mask:0xf bank_mask:0xf
    v_mov_b32_dpp v59, v43 row_ror:8 row_mask:0xf bank_mask:0xf
    s_cbranch_vccnz Gq_17_f21
    v_smfmac_f32_16x16x64_bf16 v[64:67], v[40:43], a[16:23], v19
    v_smfmac_f32_16x16x64_bf16 v[68:71], v[40:43], a[80:87], v19
Gq_17_s1p2:
    s_waitcnt vmcnt(0)
    v_cmp_eq_u32 vcc, -1, v36
    v_smfmac_f32_16x16x64_bf16 v[64:67], v[56:59], a[48:55], v19
    v_mov_b32_dpp v52, v36 row_ror:8 row_mask:0xf bank_mask:0xf
    v_mov_b32_dpp v53, v37 row_ror:8 row_mask:0xf bank_mask:0xf
    v_smfmac_f32_16x16x64_bf16 v[68:71], v[56:59], a[112:119], v19
    v_mov_b32_dpp v54, v38 row_ror:8 row_mask:0xf bank_mask:0xf
    v_mov_b32_dpp v55, v39 row_ror:8 row_mask:0xf bank_mask:0xf
    s_cbranch_vccnz Gq_17_f1p2
    v_smfmac_f32_16x16x64_bf16 v[64:67], v[36:39], a[8:15], v19
    v_smfmac_f32_16x16x64_bf16 v[68:71], v[36:39], a[72:79], v19
    v_smfmac_f32_16x16x64_bf16 v[64:67], v[52:55], a[40:47], v19
    v_smfmac_f32_16x16x64_bf16 v[68:71], v[52:55], a[104:111], v19
    s_branch Gq_17_done
Gq_17_f21:
    buffer_load_dwordx4 v[40:43], v2, s[8:11], s40 offen offset:2048 sc1
    s_add_u32 s33, s33, 1
    s_cmp_gt_u32 s33, 0x100000
    s_cbranch_scc1 chain_kernel_abort
    s_branch Gq_17_s12
Gq_17_f1p2:
    buffer_load_dwordx4 v[36:39], v2, s[8:11], s40 offen offset:1024 sc1
    s_add_u32 s33, s33, 1
    s_cmp_gt_u32 s33, 0x100000
    s_cbranch_scc1 chain_kernel_abort
    s_branch Gq_17_s1
Gq_17_s31:
    s_waitcnt vmcnt(1)
    v_cmp_eq_u32 vcc, -1, v44
    v_mov_b32_dpp v60, v44 row_ror:8 row_mask:0xf bank_mask:0xf
    v_mov_b32_dpp v61, v45 row_ror:8 row_mask:0xf bank_mask:0xf
    v_mov_b32_dpp v62, v46 row_ror:8 row_mask:0xf bank_mask:0xf
    v_mov_b32_dpp v63, v47 row_ror:8 row_mask:0xf bank_mask:0xf
    s_cbranch_vccnz Gq_17_f31
    v_smfmac_f32_16x16x64_bf16 v[64:67], v[44:47], a[24:31], v19
    v_smfmac_f32_16x16x64_bf16 v[68:71], v[44:47], a[88:95], v19
    s_branch Gq_17_s1p3
Gq_17_f31:
    buffer_load_dwordx4 v[44:47], v2, s[8:11], s40 offen offset:3072 sc1
    s_add_u32 s33, s33, 1
    s_cmp_gt_u32 s33, 0x100000
    s_cbranch_scc1 chain_kernel_abort
    s_branch Gq_17_s13
Gq_17_s120:
    s_waitcnt vmcnt(2)
    v_cmp_eq_u32 vcc, -1, v36
    v_mov_b32_dpp v52, v36 row_ror:8 row_mask:0xf bank_mask:0xf
    v_mov_b32_dpp v53, v37 row_ror:8 row_mask:0xf bank_mask:0xf
    v_mov_b32_dpp v54, v38 row_ror:8 row_mask:0xf bank_mask:0xf
    v_mov_b32_dpp v55, v39 row_ror:8 row_mask:0xf bank_mask:0xf
    s_cbranch_vccnz Gq_17_f120
    v_smfmac_f32_16x16x64_bf16 v[64:67], v[36:39], a[8:15], v19
    v_smfmac_f32_16x16x64_bf16 v[68:71], v[36:39], a[72:79], v19
Gq_17_s20p1:
    s_waitcnt vmcnt(1)
    v_cmp_eq_u32 vcc, -1, v40
    v_smfmac_f32_16x16x64_bf16 v[64:67], v[52:55], a[40:47], v19
    v_mov_b32_dpp v56, v40 row_ror:8 row_mask:0xf bank_mask:0xf
    v_mov_b32_dpp v57, v41 row_ror:8 row_mask:0xf bank_mask:0xf
    v_smfmac_f32_16x16x64_bf16 v[68:71], v[52:55], a[104:111], v19
    v_mov_b32_dpp v58, v42 row_ror:8 row_mask:0xf bank_mask:0xf
    v_mov_b32_dpp v59, v43 row_ror:8 row_mask:0xf bank_mask:0xf
    s_cbranch_vccnz Gq_17_f20p1
    v_smfmac_f32_16x16x64_bf16 v[64:67], v[40:43], a[16:23], v19
    v_smfmac_f32_16x16x64_bf16 v[68:71], v[40:43], a[80:87], v19
    s_branch Gq_17_s0p2
Gq_17_f120:
    buffer_load_dwordx4 v[36:39], v2, s[8:11], s40 offen offset:1024 sc1
    s_add_u32 s33, s33, 1
    s_cmp_gt_u32 s33, 0x100000
    s_cbranch_scc1 chain_kernel_abort
    s_branch Gq_17_s201
Gq_17_f20p1:
    buffer_load_dwordx4 v[40:43], v2, s[8:11], s40 offen offset:2048 sc1
    s_add_u32 s33, s33, 1
    s_cmp_gt_u32 s33, 0x100000
    s_cbranch_scc1 chain_kernel_abort
    s_branch Gq_17_s02
Gq_17_s130:
    s_waitcnt vmcnt(2)
    v_cmp_eq_u32 vcc, -1, v36
    v_mov_b32_dpp v52, v36 row_ror:8 row_mask:0xf bank_mask:0xf
    v_mov_b32_dpp v53, v37 row_ror:8 row_mask:0xf bank_mask:0xf
    v_mov_b32_dpp v54, v38 row_ror:8 row_mask:0xf bank_mask:0xf
    v_mov_b32_dpp v55, v39 row_ror:8 row_mask:0xf bank_mask:0xf
    s_cbranch_vccnz Gq_17_f130
    v_smfmac_f32_16x16x64_bf16 v[64:67], v[36:39], a[8:15], v19
    v_smfmac_f32_16x16x64_bf16 v[68:71], v[36:39], a[72:79], v19
Gq_17_s30p1:
    s_waitcnt vmcnt(1)
    v_cmp_eq_u32 vcc, -1, v44
    v_smfmac_f32_16x16x64_bf16 v[64:67], v[52:55], a[40:47], v19
    v_mov_b32_dpp v60, v44 row_ror:8 row_mask:0xf bank_mask:0xf
    v_mov_b32_dpp v61, v45 row_ror:8 row_mask:0xf bank_mask:0xf
    v_smfmac_f32_16x16x64_bf16 v[68:71], v[52:55], a[104:111], v19
    v_mov_b32_dpp v62, v46 row_ror:8 row_mask:0xf bank_mask:0xf
    v_mov_b32_dpp v63, v47 row_ror:8 row_mask:0xf bank_mask:0xf
    s_cbranch_vccnz Gq_17_f30p1
    v_smfmac_f32_16x16x64_bf16 v[64:67], v[44:47], a[24:31], v19
    v_smfmac_f32_16x16x64_bf16 v[68:71], v[44:47], a[88:95], v19
    s_branch Gq_17_s0p3
Gq_17_f130:
    buffer_load_dwordx4 v[36:39], v2, s[8:11], s40 offen offset:1024 sc1
    s_add_u32 s33, s33, 1
    s_cmp_gt_u32 s33, 0x100000
    s_cbranch_scc1 chain_kernel_abort
    s_branch Gq_17_s301
Gq_17_f30p1:
    buffer_load_dwordx4 v[44:47], v2, s[8:11], s40 offen offset:3072 sc1
    s_add_u32 s33, s33, 1
    s_cmp_gt_u32 s33, 0x100000
    s_cbranch_scc1 chain_kernel_abort
    s_branch Gq_17_s03
Gq_17_s01:
    s_waitcnt vmcnt(1)
    v_cmp_eq_u32 vcc, -1, v32
    v_mov_b32_dpp v48, v32 row_ror:8 row_mask:0xf bank_mask:0xf
    v_mov_b32_dpp v49, v33 row_ror:8 row_mask:0xf bank_mask:0xf
    v_mov_b32_dpp v50, v34 row_ror:8 row_mask:0xf bank_mask:0xf
    v_mov_b32_dpp v51, v35 row_ror:8 row_mask:0xf bank_mask:0xf
    s_cbranch_vccnz Gq_17_f01
    v_smfmac_f32_16x16x64_bf16 v[64:67], v[32:35], a[0:7], v19
    v_smfmac_f32_16x16x64_bf16 v[68:71], v[32:35], a[64:71], v19
    s_branch Gq_17_s1p0
Gq_17_f01:
    buffer_load_dwordx4 v[32:35], v2, s[8:11], s40 offen offset:0 sc1
    s_add_u32 s33, s33, 1
    s_cmp_gt_u32 s33, 0x100000
    s_cbranch_scc1 chain_kernel_abort
    s_branch Gq_17_s10
Gq_17_s230:
    s_waitcnt vmcnt(2)
    v_cmp_eq_u32 vcc, -1, v40
    v_mov_b32_dpp v56, v40 row_ror:8 row_mask:0xf bank_mask:0xf
    v_mov_b32_dpp v57, v41 row_ror:8 row_mask:0xf bank_mask:0xf
    v_mov_b32_dpp v58, v42 row_ror:8 row_mask:0xf bank_mask:0xf
    v_mov_b32_dpp v59, v43 row_ror:8 row_mask:0xf bank_mask:0xf
    s_cbranch_vccnz Gq_17_f230
    v_smfmac_f32_16x16x64_bf16 v[64:67], v[40:43], a[16:23], v19
    v_smfmac_f32_16x16x64_bf16 v[68:71], v[40:43], a[80:87], v19
    s_branch Gq_17_s30p2
Gq_17_f230:
    buffer_load_dwordx4 v[40:43], v2, s[8:11], s40 offen offset:2048 sc1
    s_add_u32 s33, s33, 1
    s_cmp_gt_u32 s33, 0x100000
    s_cbranch_scc1 chain_kernel_abort
    s_branch Gq_17_s302
Gq_17_s02:
    s_waitcnt vmcnt(1)
    v_cmp_eq_u32 vcc, -1, v32
    v_mov_b32_dpp v48, v32 row_ror:8 row_mask:0xf bank_mask:0xf
    v_mov_b32_dpp v49, v33 row_ror:8 row_mask:0xf bank_mask:0xf
    v_mov_b32_dpp v50, v34 row_ror:8 row_mask:0xf bank_mask:0xf
    v_mov_b32_dpp v51, v35 row_ror:8 row_mask:0xf bank_mask:0xf
    s_cbranch_vccnz Gq_17_f02
    v_smfmac_f32_16x16x64_bf16 v[64:67], v[32:35], a[0:7], v19
    v_smfmac_f32_16x16x64_bf16 v[68:71], v[32:35], a[64:71], v19
    s_branch Gq_17_s2p0
Gq_17_f02:
    buffer_load_dwordx4 v[32:35], v2, s[8:11], s40 offen offset:0 sc1
    s_add_u32 s33, s33, 1
    s_cmp_gt_u32 s33, 0x100000
    s_cbranch_scc1 chain_kernel_abort
    s_branch Gq_17_s20
Gq_17_s12:
    s_waitcnt vmcnt(1)
    v_cmp_eq_u32 vcc, -1, v36
    v_mov_b32_dpp v52, v36 row_ror:8 row_mask:0xf bank_mask:0xf
    v_mov_b32_dpp v53, v37 row_ror:8 row_mask:0xf bank_mask:0xf
    v_mov_b32_dpp v54, v38 row_ror:8 row_mask:0xf bank_mask:0xf
    v_mov_b32_dpp v55, v39 row_ror:8 row_mask:0xf bank_mask:0xf
    s_cbranch_vccnz Gq_17_f12
    v_smfmac_f32_16x16x64_bf16 v[64:67], v[36:39], a[8:15], v19
    v_smfmac_f32_16x16x64_bf16 v[68:71], v[36:39], a[72:79], v19
    s_branch Gq_17_s2p1
Gq_17_f12:
    buffer_load_dwordx4 v[36:39], v2, s[8:11], s40 offen offset:1024 sc1
    s_add_u32 s33, s33, 1
    s_cmp_gt_u32 s33, 0x100000
    s_cbranch_scc1 chain_kernel_abort
    s_branch Gq_17_s21
Gq_17_s201:
    s_waitcnt vmcnt(2)
    v_cmp_eq_u32 vcc, -1, v40
    v_mov_b32_dpp v56, v40 row_ror:8 row_mask:0xf bank_mask:0xf
    v_mov_b32_dpp v57, v41 row_ror:8 row_mask:0xf bank_mask:0xf
    v_mov_b32_dpp v58, v42 row_ror:8 row_mask:0xf bank_mask:0xf
    v_mov_b32_dpp v59, v43 row_ror:8 row_mask:0xf bank_mask:0xf
    s_cbranch_vccnz Gq_17_f201
    v_smfmac_f32_16x16x64_bf16 v[64:67], v[40:43], a[16:23], v19
    v_smfmac_f32_16x16x64_bf16 v[68:71], v[40:43], a[80:87], v19
Gq_17_s01p2:
    s_waitcnt vmcnt(1)
    v_cmp_eq_u32 vcc, -1, v32
    v_smfmac_f32_16x16x64_bf16 v[64:67], v[56:59], a[48:55], v19
    v_mov_b32_dpp v48, v32 row_ror:8 row_mask:0xf bank_mask:0xf
    v_mov_b32_dpp v49, v33 row_ror:8 row_mask:0xf bank_mask:0xf
    v_smfmac_f32_16x16x64_bf16 v[68:71], v[56:59], a[112:119], v19
    v_mov_b32_dpp v50, v34 row_ror:8 row_mask:0xf bank_mask:0xf
    v_mov_b32_dpp v51, v35 row_ror:8 row_mask:0xf bank_mask:0xf
    s_cbranch_vccnz Gq_17_f01p2
    v_smfmac_f32_16x16x64_bf16 v[64:67], v[32:35], a[0:7], v19
    v_smfmac_f32_16x16x64_bf16 v[68:71], v[32:35], a[64:71], v19
    s_branch Gq_17_s1p0
Gq_17_f201:
    buffer_load_dwordx4 v[40:43], v2, s[8:11], s40 offen offset:2048 sc1
    s_add_u32 s33, s33, 1
    s_cmp_gt_u32 s33, 0x100000
    s_cbranch_scc1 chain_kernel_abort
    s_branch Gq_17_s012
Gq_17_f01p2:
    buffer_load_dwordx4 v[32:35], v2, s[8:11], s40 offen offset:0 sc1
    s_add_u32 s33, s33, 1
    s_cmp_gt_u32 s33, 0x100000
    s_cbranch_scc1 chain_kernel_abort
    s_branch Gq_17_s10
Gq_17_s301:
    s_waitcnt vmcnt(2)
    v_cmp_eq_u32 vcc, -1, v44
    v_mov_b32_dpp v60, v44 row_ror:8 row_mask:0xf bank_mask:0xf
    v_mov_b32_dpp v61, v45 row_ror:8 row_mask:0xf bank_mask:0xf
    v_mov_b32_dpp v62, v46 row_ror:8 row_mask:0xf bank_mask:0xf
    v_mov_b32_dpp v63, v47 row_ror:8 row_mask:0xf bank_mask:0xf
    s_cbranch_vccnz Gq_17_f301
    v_smfmac_f32_16x16x64_bf16 v[64:67], v[44:47], a[24:31], v19
    v_smfmac_f32_16x16x64_bf16 v[68:71], v[44:47], a[88:95], v19
    s_branch Gq_17_s01p3
Gq_17_f301:
    buffer_load_dwordx4 v[44:47], v2, s[8:11], s40 offen offset:3072 sc1
    s_add_u32 s33, s33, 1
    s_cmp_gt_u32 s33, 0x100000
    s_cbranch_scc1 chain_kernel_abort
    s_branch Gq_17_s013
Gq_17_s012:
    s_waitcnt vmcnt(2)
    v_cmp_eq_u32 vcc, -1, v32
    v_mov_b32_dpp v48, v32 row_ror:8 row_mask:0xf bank_mask:0xf
    v_mov_b32_dpp v49, v33 row_ror:8 row_mask:0xf bank_mask:0xf
    v_mov_b32_dpp v50, v34 row_ror:8 row_mask:0xf bank_mask:0xf
    v_mov_b32_dpp v51, v35 row_ror:8 row_mask:0xf bank_mask:0xf
    s_cbranch_vccnz Gq_17_f012
    v_smfmac_f32_16x16x64_bf16 v[64:67], v[32:35], a[0:7], v19
    v_smfmac_f32_16x16x64_bf16 v[68:71], v[32:35], a[64:71], v19
    s_branch Gq_17_s12p0
Gq_17_f012:
    buffer_load_dwordx4 v[32:35], v2, s[8:11], s40 offen offset:0 sc1
    s_add_u32 s33, s33, 1
    s_cmp_gt_u32 s33, 0x100000
    s_cbranch_scc1 chain_kernel_abort
    s_branch Gq_17_s120
L_sd_18_0_0f:
    s_branch L_sd_18_1_0
L_sd_18_0_1f:
    s_branch L_sd_18_1_1
L_sd_18_0_2f:
    s_branch L_sd_18_1_2
L_sd_18_0_3f:
    s_branch L_sd_18_1_3
L_sd_18_1_0:
    s_waitcnt vmcnt(7)
    v_max3_u32 v20, v164, v165, v166
    v_mfma_f32_16x16x32_bf16 v[88:91], v[164:167], v[164:167], 0
    v_max_u32 v20, v20, v167
    v_cmp_eq_u32 vcc, -1, v20
    v_mfma_f32_16x16x32_bf16 v[84:87], v[120:123], v[164:167], 0
    v_mfma_f32_16x16x32_bf16 v[80:83], v[104:107], v[164:167], 0
    s_cbranch_vccnz L_sd_18_2_0
L_sd_18_1_1:
    s_waitcnt vmcnt(6)
    v_max3_u32 v20, v168, v169, v170
    v_mfma_f32_16x16x32_bf16 v[100:103], v[168:171], v[168:171], v[88:91]
    v_max_u32 v20, v20, v171
    v_cmp_eq_u32 vcc, -1, v20
    v_mfma_f32_16x16x32_bf16 v[96:99], v[124:127], v[168:171], v[84:87]
    v_mfma_f32_16x16x32_bf16 v[92:95], v[108:111], v[168:171], v[80:83]
    s_cbranch_vccnz L_sd_18_2_1
L_sd_18_1_2:
    s_waitcnt vmcnt(5)
    v_max3_u32 v20, v172, v173, v174
    v_mfma_f32_16x16x32_bf16 v[228:231], v[172:175], v[172:175], v[100:103]
    v_max_u32 v20, v20, v175
    v_cmp_eq_u32 vcc, -1, v20
    v_mfma_f32_16x16x32_bf16 v[224:227], v[128:131], v[172:175], v[96:99]
    v_mfma_f32_16x16x32_bf16 v[220:223], v[112:115], v[172:175], v[92:95]
    s_cbranch_vccnz L_sd_18_2_2
L_sd_18_1_3:
    s_waitcnt vmcnt(4)
    v_max3_u32 v20, v176, v177, v178
    v_mfma_f32_16x16x32_bf16 v[188:191], v[176:179], v[176:179], v[228:231]
    v_max_u32 v20, v20, v179
    v_cmp_eq_u32 vcc, -1, v20
    v_mfma_f32_16x16x32_bf16 v[184:187], v[132:135], v[176:179], v[224:227]
    v_mfma_f32_16x16x32_bf16 v[180:183], v[116:119], v[176:179], v[220:223]
    v_mov_b32_dpp v188, v189 row_ror:8 row_mask:0xf bank_mask:0xc
    v_mov_b32_dpp v190, v191 row_ror:8 row_mask:0xf bank_mask:0xc
    s_cbranch_vccnz L_sd_18_2_3
    s_branch L_sd_18
L_sd_18_1_0f:
    s_branch L_sd_18_2_0
L_sd_18_1_1f:
    s_branch L_sd_18_2_1
L_sd_18_1_2f:
    s_branch L_sd_18_2_2
L_sd_18_1_3f:
    s_branch L_sd_18_2_3
L_sd_18_2_0:
    s_waitcnt vmcnt(3)
    v_max3_u32 v20, v32, v33, v34
    v_mfma_f32_16x16x32_bf16 v[88:91], v[32:35], v[32:35], 0
    v_max_u32 v20, v20, v35
    v_cmp_eq_u32 vcc, -1, v20
    v_mfma_f32_16x16x32_bf16 v[84:87], v[120:123], v[32:35], 0
    v_mfma_f32_16x16x32_bf16 v[80:83], v[104:107], v[32:35], 0
    s_cbranch_vccnz L_sd_18_2_0f
L_sd_18_2_1:
    s_waitcnt vmcnt(2)
    v_max3_u32 v20, v36, v37, v38
    v_mfma_f32_16x16x32_bf16 v[100:103], v[36:39], v[36:39], v[88:91]
    v_max_u32 v20, v20, v39
    v_cmp_eq_u32 vcc, -1, v20
    v_mfma_f32_16x16x32_bf16 v[96:99], v[124:127], v[36:39], v[84:87]
    v_mfma_f32_16x16x32_bf16 v[92:95], v[108:111], v[36:39], v[80:83]
    s_cbranch_vccnz L_sd_18_2_1f
L_sd_18_2_2:
    s_waitcnt vmcnt(1)
    v_max3_u32 v20, v40, v41, v42
    v_mfma_f32_16x16x32_bf16 v[228:231], v[40:43], v[40:43], v[100:103]
    v_max_u32 v20, v20, v43
    v_cmp_eq_u32 vcc, -1, v20
    v_mfma_f32_16x16x32_bf16 v[224:227], v[128:131], v[40:43], v[96:99]
    v_mfma_f32_16x16x32_bf16 v[220:223], v[112:115], v[40:43], v[92:95]
    s_cbranch_vccnz L_sd_18_2_2f
L_sd_18_2_3:
    s_waitcnt vmcnt(0)
    v_max3_u32 v20, v44, v45, v46
    v_mfma_f32_16x16x32_bf16 v[188:191], v[44:47], v[44:47], v[228:231]
    v_max_u32 v20, v20, v47
    v_cmp_eq_u32 vcc, -1, v20
    v_mfma_f32_16x16x32_bf16 v[184:187], v[132:135], v[44:47], v[224:227]
    v_mfma_f32_16x16x32_bf16 v[180:183], v[116:119], v[44:47], v[220:223]
    v_mov_b32_dpp v188, v189 row_ror:8 row_mask:0xf bank_mask:0xc
    v_mov_b32_dpp v190, v191 row_ror:8 row_mask:0xf bank_mask:0xc
    s_cbranch_vccnz L_sd_18_2_3f
    s_branch L_sd_18
L_sd_18_2_0f:
    buffer_load_dwordx4 v[148:151], v5, s[8:11], s40 offen offset:0 sc1
    buffer_load_dwordx4 v[152:155], v5, s[8:11], s40 offen offset:1024 sc1
    buffer_load_dwordx4 v[156:159], v5, s[8:11], s40 offen offset:2048 sc1
    buffer_load_dwordx4 v[160:163], v5, s[8:11], s40 offen offset:3072 sc1
    s_add_u32 s33, s33, 1
    s_cmp_gt_u32 s33, 0x100000
    s_cbranch_scc1 chain_kernel_abort
    s_branch L_sd_18_3_0
L_sd_18_2_1f:
    buffer_load_dwordx4 v[152:155], v5, s[8:11], s40 offen offset:1024 sc1
    buffer_load_dwordx4 v[156:159], v5, s[8:11], s40 offen offset:2048 sc1
    buffer_load_dwordx4 v[160:163], v5, s[8:11], s40 offen offset:3072 sc1
    s_add_u32 s33, s33, 1
    s_cmp_gt_u32 s33, 0x100000
    s_cbranch_scc1 chain_kernel_abort
    s_branch L_sd_18_3_1
L_sd_18_2_2f:
    buffer_load_dwordx4 v[156:159], v5, s[8:11], s40 offen offset:2048 sc1
    buffer_load_dwordx4 v[160:163], v5, s[8:11], s40 offen offset:3072 sc1
    s_add_u32 s33, s33, 1
    s_cmp_gt_u32 s33, 0x100000
    s_cbranch_scc1 chain_kernel_abort
    s_branch L_sd_18_3_2
L_sd_18_2_3f:
    buffer_load_dwordx4 v[160:163], v5, s[8:11], s40 offen offset:3072 sc1
    s_add_u32 s33, s33, 1
    s_cmp_gt_u32 s33, 0x100000
    s_cbranch_scc1 chain_kernel_abort
    s_branch L_sd_18_3_3
L_sd_18_3_0:
    s_waitcnt vmcnt(3)
    v_max3_u32 v20, v148, v149, v150
    v_mfma_f32_16x16x32_bf16 v[88:91], v[148:151], v[148:151], 0
    v_max_u32 v20, v20, v151
    v_cmp_eq_u32 vcc, -1, v20
    v_mfma_f32_16x16x32_bf16 v[84:87], v[120:123], v[148:151], 0
    v_mfma_f32_16x16x32_bf16 v[80:83], v[104:107], v[148:151], 0
    s_cbranch_vccnz L_sd_18_3_0f
L_sd_18_3_1:
    s_waitcnt vmcnt(2)
    v_max3_u32 v20, v152, v153, v154
    v_mfma_f32_16x16x32_bf16 v[100:103], v[152:155], v[152:155], v[88:91]
    v_max_u32 v20, v20, v155
    v_cmp_eq_u32 vcc, -1, v20
    v_mfma_f32_16x16x32_bf16 v[96:99], v[124:127], v[152:155], v[84:87]
    v_mfma_f32_16x16x32_bf16 v[92:95], v[108:111], v[152:155], v[80:83]
    s_cbranch_vccnz L_sd_18_3_1f
L_sd_18_3_2:
    s_waitcnt vmcnt(1)
    v_max3_u32 v20, v156, v157, v158
    v_mfma_f32_16x16x32_bf16 v[228:231], v[156:159], v[156:159], v[100:103]
    v_max_u32 v20, v20, v159
    v_cmp_eq_u32 vcc, -1, v20
    v_mfma_f32_16x16x32_bf16 v[224:227], v[128:131], v[156:159], v[96:99]
    v_mfma_f32_16x16x32_bf16 v[220:223], v[112:115], v[156:159], v[92:95]
    s_cbranch_vccnz L_sd_18_3_2f
L_sd_18_3_3:
    s_waitcnt vmcnt(0)
    v_max3_u32 v20, v160, v161, v162
    v_mfma_f32_16x16x32_bf16 v[188:191], v[160:163], v[160:163], v[228:231]
    v_max_u32 v20, v20, v163
    v_cmp_eq_u32 vcc, -1, v20
    v_mfma_f32_16x16x32_bf16 v[184:187], v[132:135], v[160:163], v[224:227]
    v_mfma_f32_16x16x32_bf16 v[180:183], v[116:119], v[160:163], v[220:223]
    v_mov_b32_dpp v188, v189 row_ror:8 row_mask:0xf bank_mask:0xc
    v_mov_b32_dpp v190, v191 row_ror:8 row_mask:0xf bank_mask:0xc
    s_cbranch_vccnz L_sd_18_3_3f
    s_branch L_sd_18
L_sd_18_3_0f:
    buffer_load_dwordx4 v[148:151], v5, s[8:11], s40 offen offset:0 sc1
    buffer_load_dwordx4 v[152:155], v5, s[8:11], s40 offen offset:1024 sc1
    buffer_load_dwordx4 v[156:159], v5, s[8:11], s40 offen offset:2048 sc1
    buffer_load_dwordx4 v[160:163], v5, s[8:11], s40 offen offset:3072 sc1
    s_add_u32 s33, s33, 1
    s_cmp_gt_u32 s33, 0x100000
    s_cbranch_scc1 chain_kernel_abort
    s_branch L_sd_18_3_0
L_sd_18_3_1f:
    buffer_load_dwordx4 v[152:155], v5, s[8:11], s40 offen offset:1024 sc1
    buffer_load_dwordx4 v[156:159], v5, s[8:11], s40 offen offset:2048 sc1
    buffer_load_dwordx4 v[160:163], v5, s[8:11], s40 offen offset:3072 sc1
    s_add_u32 s33, s33, 1
    s_cmp_gt_u32 s33, 0x100000
    s_cbranch_scc1 chain_kernel_abort
    s_branch L_sd_18_3_1
L_sd_18_3_2f:
    buffer_load_dwordx4 v[156:159], v5, s[8:11], s40 offen offset:2048 sc1
    buffer_load_dwordx4 v[160:163], v5, s[8:11], s40 offen offset:3072 sc1
    s_add_u32 s33, s33, 1
    s_cmp_gt_u32 s33, 0x100000
    s_cbranch_scc1 chain_kernel_abort
    s_branch L_sd_18_3_2
L_sd_18_3_3f:
    buffer_load_dwordx4 v[160:163], v5, s[8:11], s40 offen offset:3072 sc1
    s_add_u32 s33, s33, 1
    s_cmp_gt_u32 s33, 0x100000
    s_cbranch_scc1 chain_kernel_abort
    s_branch L_sd_18_3_3
Go_19_f0123:
    buffer_load_dwordx4 v[32:35], v3, s[8:11], s40 offen offset:0 sc1
    s_branch Go_19_s1230
Go_19_f123:
    buffer_load_dwordx4 v[36:39], v3, s[8:11], s40 offen offset:1024 sc1
    s_add_u32 s33, s33, 1
    s_cmp_gt_u32 s33, 0x100000
    s_cbranch_scc1 chain_kernel_abort
    s_branch Go_19_s231
Go_19_f23:
    buffer_load_dwordx4 v[40:43], v3, s[8:11], s40 offen offset:2048 sc1
    s_add_u32 s33, s33, 1
    s_cmp_gt_u32 s33, 0x100000
    s_cbranch_scc1 chain_kernel_abort
    s_branch Go_19_s32
Go_19_f3:
    buffer_load_dwordx4 v[44:47], v3, s[8:11], s40 offen offset:3072 sc1
    s_add_u32 s33, s33, 1
    s_cmp_gt_u32 s33, 0x100000
    s_cbranch_scc1 chain_kernel_abort
    s_branch Go_19_s3
Go_19_redo:
    buffer_load_dwordx4 v[32:35], v3, s[8:11], s40 offen offset:0 sc1
    buffer_load_dwordx4 v[36:39], v3, s[8:11], s40 offen offset:1024 sc1
    buffer_load_dwordx4 v[40:43], v3, s[8:11], s40 offen offset:2048 sc1
    buffer_load_dwordx4 v[44:47], v3, s[8:11], s40 offen offset:3072 sc1
    s_add_u32 s33, s33, 1
    s_cmp_gt_u32 s33, 0x100000
    s_cbranch_scc1 chain_kernel_abort
    s_nop 5
    v_mov_b32 v76, 0
    v_mov_b32 v77, 0
    v_mov_b32 v78, 0
    v_mov_b32 v79, 0
    s_branch Go_19_s0123
Go_19_s1230:
    s_waitcnt vmcnt(3)
    v_cmp_eq_u32 vcc, -1, v36
    v_mov_b32_dpp v52, v36 row_ror:8 row_mask:0xf bank_mask:0xf
    v_mov_b32_dpp v53, v37 row_ror:8 row_mask:0xf bank_mask:0xf
    v_mov_b32_dpp v54, v38 row_ror:8 row_mask:0xf bank_mask:0xf
    v_mov_b32_dpp v55, v39 row_ror:8 row_mask:0xf bank_mask:0xf
    s_cbranch_vccnz Go_19_f1230
    v_smfmac_f32_16x16x64_bf16 v[76:79], v[36:39], a[200:207], v19
    v_smfmac_f32_16x16x64_bf16 v[76:79], v[52:55], a[232:239], v19
Go_19_s230:
    s_waitcnt vmcnt(2)
    v_cmp_eq_u32 vcc, -1, v40
    v_mov_b32_dpp v56, v40 row_ror:8 row_mask:0xf bank_mask:0xf
    v_mov_b32_dpp v57, v41 row_ror:8 row_mask:0xf bank_mask:0xf
    v_mov_b32_dpp v58, v42 row_ror:8 row_mask:0xf bank_mask:0xf
    v_mov_b32_dpp v59, v43 row_ror:8 row_mask:0xf bank_mask:0xf
    s_cbranch_vccnz Go_19_f230
    v_smfmac_f32_16x16x64_bf16 v[76:79], v[40:43], a[208:215], v19
    v_smfmac_f32_16x16x64_bf16 v[76:79], v[56:59], a[240:247], v19
Go_19_s30:
    s_waitcnt vmcnt(1)
    v_cmp_eq_u32 vcc, -1, v44
    v_mov_b32_dpp v60, v44 row_ror:8 row_mask:0xf bank_mask:0xf
    v_mov_b32_dpp v61, v45 row_ror:8 row_mask:0xf bank_mask:0xf
    v_mov_b32_dpp v62, v46 row_ror:8 row_mask:0xf bank_mask:0xf
    v_mov_b32_dpp v63, v47 row_ror:8 row_mask:0xf bank_mask:0xf
    s_cbranch_vccnz Go_19_f30
    v_smfmac_f32_16x16x64_bf16 v[76:79], v[44:47], a[216:223], v19
    v_smfmac_f32_16x16x64_bf16 v[76:79], v[60:63], a[248:255], v19
Go_19_s0:
    s_waitcnt vmcnt(0)
    v_cmp_eq_u32 vcc, -1, v32
    v_mov_b32_dpp v48, v32 row_ror:8 row_mask:0xf bank_mask:0xf
    v_mov_b32_dpp v49, v33 row_ror:8 row_mask:0xf bank_mask:0xf
    v_mov_b32_dpp v50, v34 row_ror:8 row_mask:0xf bank_mask:0xf
    v_mov_b32_dpp v51, v35 row_ror:8 row_mask:0xf bank_mask:0xf
    s_cbranch_vccnz Go_19_f0
    v_smfmac_f32_16x16x64_bf16 v[76:79], v[32:35], a[192:199], v19
    v_smfmac_f32_16x16x64_bf16 v[76:79], v[48:51], a[224:231], v19
    s_branch Go_19_done
Go_19_f1230:
    buffer_load_dwordx4 v[36:39], v3, s[8:11], s40 offen offset:1024 sc1
    s_add_u32 s33, s33, 1
    s_cmp_gt_u32 s33, 0x100000
    s_cbranch_scc1 chain_kernel_abort
    s_branch Go_19_s2301
Go_19_f230:
    buffer_load_dwordx4 v[40:43], v3, s[8:11], s40 offen offset:2048 sc1
    s_add_u32 s33, s33, 1
    s_cmp_gt_u32 s33, 0x100000
    s_cbranch_scc1 chain_kernel_abort
    s_branch Go_19_s302
Go_19_f30:
    buffer_load_dwordx4 v[44:47], v3, s[8:11], s40 offen offset:3072 sc1
    s_add_u32 s33, s33, 1
    s_cmp_gt_u32 s33, 0x100000
    s_cbranch_scc1 chain_kernel_abort
    s_branch Go_19_s03
Go_19_f0:
    buffer_load_dwordx4 v[32:35], v3, s[8:11], s40 offen offset:0 sc1
    s_add_u32 s33, s33, 1
    s_cmp_gt_u32 s33, 0x100000
    s_cbranch_scc1 chain_kernel_abort
    s_branch Go_19_s0
Go_19_s231:
    s_waitcnt vmcnt(2)
    v_cmp_eq_u32 vcc, -1, v40
    v_mov_b32_dpp v56, v40 row_ror:8 row_mask:0xf bank_mask:0xf
    v_mov_b32_dpp v57, v41 row_ror:8 row_mask:0xf bank_mask:0xf
    v_mov_b32_dpp v58, v42 row_ror:8 row_mask:0xf bank_mask:0xf
    v_mov_b32_dpp v59, v43 row_ror:8 row_mask:0xf bank_mask:0xf
    s_cbranch_vccnz Go_19_f231
    v_smfmac_f32_16x16x64_bf16 v[76:79], v[40:43], a[208:215], v19
    v_smfmac_f32_16x16x64_bf16 v[76:79], v[56:59], a[240:247], v19
Go_19_s31:
    s_waitcnt vmcnt(1)
    v_cmp_eq_u32 vcc, -1, v44
    v_mov_b32_dpp v60, v44 row_ror:8 row_mask:0xf bank_mask:0xf
    v_mov_b32_dpp v61, v45 row_ror:8 row_mask:0xf bank_mask:0xf
    v_mov_b32_dpp v62, v46 row_ror:8 row_mask:0xf bank_mask:0xf
    v_mov_b32_dpp v63, v47 row_ror:8 row_mask:0xf bank_mask:0xf
    s_cbranch_vccnz Go_19_f31
    v_smfmac_f32_16x16x64_bf16 v[76:79], v[44:47], a[216:223], v19
    v_smfmac_f32_16x16x64_bf16 v[76:79], v[60:63], a[248:255], v19
Go_19_s1:
    s_waitcnt vmcnt(0)
    v_cmp_eq_u32 vcc, -1, v36
    v_mov_b32_dpp v52, v36 row_ror:8 row_mask:0xf bank_mask:0xf
    v_mov_b32_dpp v53, v37 row_ror:8 row_mask:0xf bank_mask:0xf
    v_mov_b32_dpp v54, v38 row_ror:8 row_mask:0xf bank_mask:0xf
    v_mov_b32_dpp v55, v39 row_ror:8 row_mask:0xf bank_mask:0xf
    s_cbranch_vccnz Go_19_f1
    v_smfmac_f32_16x16x64_bf16 v[76:79], v[36:39], a[200:207], v19
    v_smfmac_f32_16x16x64_bf16 v[76:79], v[52:55], a[232:239], v19
    s_branch Go_19_done
Go_19_f231:
    buffer_load_dwordx4 v[40:43], v3, s[8:11], s40 offen offset:2048 sc1
    s_add_u32 s33, s33, 1
    s_cmp_gt_u32 s33, 0x100000
    s_cbranch_scc1 chain_kernel_abort
    s_branch Go_19_s312
Go_19_f31:
    buffer_load_dwordx4 v[44:47], v3, s[8:11], s40 offen offset:3072 sc1
    s_add_u32 s33, s33, 1
    s_cmp_gt_u32 s33, 0x100000
    s_cbranch_scc1 chain_kernel_abort
    s_branch Go_19_s13
Go_19_f1:
    buffer_load_dwordx4 v[36:39], v3, s[8:11], s40 offen offset:1024 sc1
    s_add_u32 s33, s33, 1
    s_cmp_gt_u32 s33, 0x100000
    s_cbranch_scc1 chain_kernel_abort
    s_branch Go_19_s1
Go_19_s32:
    s_waitcnt vmcnt(1)
    v_cmp_eq_u32 vcc, -1, v44
    v_mov_b32_dpp v60, v44 row_ror:8 row_mask:0xf bank_mask:0xf
    v_mov_b32_dpp v61, v45 row_ror:8 row_mask:0xf bank_mask:0xf
    v_mov_b32_dpp v62, v46 row_ror:8 row_mask:0xf bank_mask:0xf
    v_mov_b32_dpp v63, v47 row_ror:8 row_mask:0xf bank_mask:0xf
    s_cbranch_vccnz Go_19_f32
    v_smfmac_f32_16x16x64_bf16 v[76:79], v[44:47], a[216:223], v19
    v_smfmac_f32_16x16x64_bf16 v[76:79], v[60:63], a[248:255], v19
Go_19_s2:
    s_waitcnt vmcnt(0)
    v_cmp_eq_u32 vcc, -1, v40
    v_mov_b32_dpp v56, v40 row_ror:8 row_mask:0xf bank_mask:0xf
    v_mov_b32_dpp v57, v41 row_ror:8 row_mask:0xf bank_mask:0xf
    v_mov_b32_dpp v58, v42 row_ror:8 row_mask:0xf bank_mask:0xf
    v_mov_b32_dpp v59, v43 row_ror:8 row_mask:0xf bank_mask:0xf
    s_cbranch_vccnz Go_19_f2
    v_smfmac_f32_16x16x64_bf16 v[76:79], v[40:43], a[208:215], v19
    v_smfmac_f32_16x16x64_bf16 v[76:79], v[56:59], a[240:247], v19
    s_branch Go_19_done
Go_19_f32:
    buffer_load_dwordx4 v[44:47], v3, s[8:11], s40 offen offset:3072 sc1
    s_add_u32 s33, s33, 1
    s_cmp_gt_u32 s33, 0x100000
    s_cbranch_scc1 chain_kernel_abort
    s_branch Go_19_s23
Go_19_f2:
    buffer_load_dwordx4 v[40:43], v3, s[8:11], s40 offen offset:2048 sc1
    s_add_u32 s33, s33, 1
    s_cmp_gt_u32 s33, 0x100000
    s_cbranch_scc1 chain_kernel_abort
    s_branch Go_19_s2
Go_19_s2301:
    s_waitcnt vmcnt(3)
    v_cmp_eq_u32 vcc, -1, v40
    v_mov_b32_dpp v56, v40 row_ror:8 row_mask:0xf bank_mask:0xf
    v_mov_b32_dpp v57, v41 row_ror:8 row_mask:0xf bank_mask:0xf
    v_mov_b32_dpp v58, v42 row_ror:8 row_mask:0xf bank_mask:0xf
    v_mov_b32_dpp v59, v43 row_ror:8 row_mask:0xf bank_mask:0xf
    s_cbranch_vccnz Go_19_f2301
    v_smfmac_f32_16x16x64_bf16 v[76:79], v[40:43], a[208:215], v19
    v_smfmac_f32_16x16x64_bf16 v[76:79], v[56:59], a[240:247], v19
Go_19_s301:
    s_waitcnt vmcnt(2)
    v_cmp_eq_u32 vcc, -1, v44
    v_mov_b32_dpp v60, v44 row_ror:8 row_mask:0xf bank_mask:0xf
    v_mov_b32_dpp v61, v45 row_ror:8 row_mask:0xf bank_mask:0xf
    v_mov_b32_dpp v62, v46 row_ror:8 row_mask:0xf bank_mask:0xf
    v_mov_b32_dpp v63, v47 row_ror:8 row_mask:0xf bank_mask:0xf
    s_cbranch_vccnz Go_19_f301
    v_smfmac_f32_16x16x64_bf16 v[76:79], v[44:47], a[216:223], v19
    v_smfmac_f32_16x16x64_bf16 v[76:79], v[60:63], a[248:255], v19
Go_19_s01:
    s_waitcnt vmcnt(1)
    v_cmp_eq_u32 vcc, -1, v32
    v_mov_b32_dpp v48, v32 row_ror:8 row_mask:0xf bank_mask:0xf
    v_mov_b32_dpp v49, v33 row_ror:8 row_mask:0xf bank_mask:0xf
    v_mov_b32_dpp v50, v34 row_ror:8 row_mask:0xf bank_mask:0xf
    v_mov_b32_dpp v51, v35 row_ror:8 row_mask:0xf bank_mask:0xf
    s_cbranch_vccnz Go_19_f01
    v_smfmac_f32_16x16x64_bf16 v[76:79], v[32:35], a[192:199], v19
    v_smfmac_f32_16x16x64_bf16 v[76:79], v[48:51], a[224:231], v19
    s_branch Go_19_s1
Go_19_f2301:
    buffer_load_dwordx4 v[40:43], v3, s[8:11], s40 offen offset:2048 sc1
    s_add_u32 s33, s33, 1
    s_cmp_gt_u32 s33, 0x100000
    s_cbranch_scc1 chain_kernel_abort
    s_branch Go_19_s3012
Go_19_f301:
    buffer_load_dwordx4 v[44:47], v3, s[8:11], s40 offen offset:3072 sc1
    s_add_u32 s33, s33, 1
    s_cmp_gt_u32 s33, 0x100000
    s_cbranch_scc1 chain_kernel_abort
    s_branch Go_19_s013
Go_19_f01:
    buffer_load_dwordx4 v[32:35], v3, s[8:11], s40 offen offset:0 sc1
    s_add_u32 s33, s33, 1
    s_cmp_gt_u32 s33, 0x100000
    s_cbranch_scc1 chain_kernel_abort
    s_branch Go_19_s10
Go_19_s302:
    s_waitcnt vmcnt(2)
    v_cmp_eq_u32 vcc, -1, v44
    v_mov_b32_dpp v60, v44 row_ror:8 row_mask:0xf bank_mask:0xf
    v_mov_b32_dpp v61, v45 row_ror:8 row_mask:0xf bank_mask:0xf
    v_mov_b32_dpp v62, v46 row_ror:8 row_mask:0xf bank_mask:0xf
    v_mov_b32_dpp v63, v47 row_ror:8 row_mask:0xf bank_mask:0xf
    s_cbranch_vccnz Go_19_f302
    v_smfmac_f32_16x16x64_bf16 v[76:79], v[44:47], a[216:223], v19
    v_smfmac_f32_16x16x64_bf16 v[76:79], v[60:63], a[248:255], v19
Go_19_s02:
    s_waitcnt vmcnt(1)
    v_cmp_eq_u32 vcc, -1, v32
    v_mov_b32_dpp v48, v32 row_ror:8 row_mask:0xf bank_mask:0xf
    v_mov_b32_dpp v49, v33 row_ror:8 row_mask:0xf bank_mask:0xf
    v_mov_b32_dpp v50, v34 row_ror:8 row_mask:0xf bank_mask:0xf
    v_mov_b32_dpp v51, v35 row_ror:8 row_mask:0xf bank_mask:0xf
    s_cbranch_vccnz Go_19_f02
    v_smfmac_f32_16x16x64_bf16 v[76:79], v[32:35], a[192:199], v19
    v_smfmac_f32_16x16x64_bf16 v[76:79], v[48:51], a[224:231], v19
    s_branch Go_19_s2
Go_19_f302:
    buffer_load_dwordx4 v[44:47], v3, s[8:11], s40 offen offset:3072 sc1
    s_add_u32 s33, s33, 1
    s_cmp_gt_u32 s33, 0x100000
    s_cbranch_scc1 chain_kernel_abort
    s_branch Go_19_s023
Go_19_f02:
    buffer_load_dwordx4 v[32:35], v3, s[8:11], s40 offen offset:0 sc1
    s_add_u32 s33, s33, 1
    s_cmp_gt_u32 s33, 0x100000
    s_cbranch_scc1 chain_kernel_abort
    s_branch Go_19_s20
Go_19_s03:
    s_waitcnt vmcnt(1)
    v_cmp_eq_u32 vcc, -1, v32
    v_mov_b32_dpp v48, v32 row_ror:8 row_mask:0xf bank_mask:0xf
    v_mov_b32_dpp v49, v33 row_ror:8 row_mask:0xf bank_mask:0xf
    v_mov_b32_dpp v50, v34 row_ror:8 row_mask:0xf bank_mask:0xf
    v_mov_b32_dpp v51, v35 row_ror:8 row_mask:0xf bank_mask:0xf
    s_cbranch_vccnz Go_19_f03
    v_smfmac_f32_16x16x64_bf16 v[76:79], v[32:35], a[192:199], v19
    v_smfmac_f32_16x16x64_bf16 v[76:79], v[48:51], a[224:231], v19
    s_branch Go_19_s3
Go_19_f03:
    buffer_load_dwordx4 v[32:35], v3, s[8:11], s40 offen offset:0 sc1
    s_add_u32 s33, s33, 1
    s_cmp_gt_u32 s33, 0x100000
    s_cbranch_scc1 chain_kernel_abort
    s_branch Go_19_s30
Go_19_s312:
    s_waitcnt vmcnt(2)
    v_cmp_eq_u32 vcc, -1, v44
    v_mov_b32_dpp v60, v44 row_ror:8 row_mask:0xf bank_mask:0xf
    v_mov_b32_dpp v61, v45 row_ror:8 row_mask:0xf bank_mask:0xf
    v_mov_b32_dpp v62, v46 row_ror:8 row_mask:0xf bank_mask:0xf
    v_mov_b32_dpp v63, v47 row_ror:8 row_mask:0xf bank_mask:0xf
    s_cbranch_vccnz Go_19_f312
    v_smfmac_f32_16x16x64_bf16 v[76:79], v[44:47], a[216:223], v19
    v_smfmac_f32_16x16x64_bf16 v[76:79], v[60:63], a[248:255], v19
Go_19_s12:
    s_waitcnt vmcnt(1)
    v_cmp_eq_u32 vcc, -1, v36
    v_mov_b32_dpp v52, v36 row_ror:8 row_mask:0xf bank_mask:0xf
    v_mov_b32_dpp v53, v37 row_ror:8 row_mask:0xf bank_mask:0xf
    v_mov_b32_dpp v54, v38 row_ror:8 row_mask:0xf bank_mask:0xf
    v_mov_b32_dpp v55, v39 row_ror:8 row_mask:0xf bank_mask:0xf
    s_cbranch_vccnz Go_19_f12
    v_smfmac_f32_16x16x64_bf16 v[76:79], v[36:39], a[200:207], v19
    v_smfmac_f32_16x16x64_bf16 v[76:79], v[52:55], a[232:239], v19
    s_branch Go_19_s2
Go_19_f312:
    buffer_load_dwordx4 v[44:47], v3, s[8:11], s40 offen offset:3072 sc1
    s_add_u32 s33, s33, 1
    s_cmp_gt_u32 s33, 0x100000
    s_cbranch_scc1 chain_kernel_abort
    s_branch Go_19_s123
Go_19_f12:
    buffer_load_dwordx4 v[36:39], v3, s[8:11], s40 offen offset:1024 sc1
    s_add_u32 s33, s33, 1
    s_cmp_gt_u32 s33, 0x100000
    s_cbranch_scc1 chain_kernel_abort
    s_branch Go_19_s21
Go_19_s13:
    s_waitcnt vmcnt(1)
    v_cmp_eq_u32 vcc, -1, v36
    v_mov_b32_dpp v52, v36 row_ror:8 row_mask:0xf bank_mask:0xf
    v_mov_b32_dpp v53, v37 row_ror:8 row_mask:0xf bank_mask:0xf
    v_mov_b32_dpp v54, v38 row_ror:8 row_mask:0xf bank_mask:0xf
    v_mov_b32_dpp v55, v39 row_ror:8 row_mask:0xf bank_mask:0xf
    s_cbranch_vccnz Go_19_f13
    v_smfmac_f32_16x16x64_bf16 v[76:79], v[36:39], a[200:207], v19
    v_smfmac_f32_16x16x64_bf16 v[76:79], v[52:55], a[232:239], v19
    s_branch Go_19_s3
Go_19_f13:
    buffer_load_dwordx4 v[36:39], v3, s[8:11], s40 offen offset:1024 sc1
    s_add_u32 s33, s33, 1
    s_cmp_gt_u32 s33, 0x100000
    s_cbranch_scc1 chain_kernel_abort
    s_branch Go_19_s31
Go_19_s3012:
    s_waitcnt vmcnt(3)
    v_cmp_eq_u32 vcc, -1, v44
    v_mov_b32_dpp v60, v44 row_ror:8 row_mask:0xf bank_mask:0xf
    v_mov_b32_dpp v61, v45 row_ror:8 row_mask:0xf bank_mask:0xf
    v_mov_b32_dpp v62, v46 row_ror:8 row_mask:0xf bank_mask:0xf
    v_mov_b32_dpp v63, v47 row_ror:8 row_mask:0xf bank_mask:0xf
    s_cbranch_vccnz Go_19_f3012
    v_smfmac_f32_16x16x64_bf16 v[76:79], v[44:47], a[216:223], v19
    v_smfmac_f32_16x16x64_bf16 v[76:79], v[60:63], a[248:255], v19
Go_19_s012:
    s_waitcnt vmcnt(2)
    v_cmp_eq_u32 vcc, -1, v32
    v_mov_b32_dpp v48, v32 row_ror:8 row_mask:0xf bank_mask:0xf
    v_mov_b32_dpp v49, v33 row_ror:8 row_mask:0xf bank_mask:0xf
    v_mov_b32_dpp v50, v34 row_ror:8 row_mask:0xf bank_mask:0xf
    v_mov_b32_dpp v51, v35 row_ror:8 row_mask:0xf bank_mask:0xf
    s_cbranch_vccnz Go_19_f012
    v_smfmac_f32_16x16x64_bf16 v[76:79], v[32:35], a[192:199], v19
    v_smfmac_f32_16x16x64_bf16 v[76:79], v[48:51], a[224:231], v19
    s_branch Go_19_s12
Go_19_f3012:
    buffer_load_dwordx4 v[44:47], v3, s[8:11], s40 offen offset:3072 sc1
    s_add_u32 s33, s33, 1
    s_cmp_gt_u32 s33, 0x100000
    s_cbranch_scc1 chain_kernel_abort
    s_branch Go_19_s0123
Go_19_f012:
    buffer_load_dwordx4 v[32:35], v3, s[8:11], s40 offen offset:0 sc1
    s_add_u32 s33, s33, 1
    s_cmp_gt_u32 s33, 0x100000
    s_cbranch_scc1 chain_kernel_abort
    s_branch Go_19_s120
Go_19_s013:
    s_waitcnt vmcnt(2)
    v_cmp_eq_u32 vcc, -1, v32
    v_mov_b32_dpp v48, v32 row_ror:8 row_mask:0xf bank_mask:0xf
    v_mov_b32_dpp v49, v33 row_ror:8 row_mask:0xf bank_mask:0xf
    v_mov_b32_dpp v50, v34 row_ror:8 row_mask:0xf bank_mask:0xf
    v_mov_b32_dpp v51, v35 row_ror:8 row_mask:0xf bank_mask:0xf
    s_cbranch_vccnz Go_19_f013
    v_smfmac_f32_16x16x64_bf16 v[76:79], v[32:35], a[192:199], v19
    v_smfmac_f32_16x16x64_bf16 v[76:79], v[48:51], a[224:231], v19
    s_branch Go_19_s13
Go_19_f013:
    buffer_load_dwordx4 v[32:35], v3, s[8:11], s40 offen offset:0 sc1
    s_add_u32 s33, s33, 1
    s_cmp_gt_u32 s33, 0x100000
    s_cbranch_scc1 chain_kernel_abort
    s_branch Go_19_s130
Go_19_s10:
    s_waitcnt vmcnt(1)
    v_cmp_eq_u32 vcc, -1, v36
    v_mov_b32_dpp v52, v36 row_ror:8 row_mask:0xf bank_mask:0xf
    v_mov_b32_dpp v53, v37 row_ror:8 row_mask:0xf bank_mask:0xf
    v_mov_b32_dpp v54, v38 row_ror:8 row_mask:0xf bank_mask:0xf
    v_mov_b32_dpp v55, v39 row_ror:8 row_mask:0xf bank_mask:0xf
    s_cbranch_vccnz Go_19_f10
    v_smfmac_f32_16x16x64_bf16 v[76:79], v[36:39], a[200:207], v19
    v_smfmac_f32_16x16x64_bf16 v[76:79], v[52:55], a[232:239], v19
    s_branch Go_19_s0
Go_19_f10:
    buffer_load_dwordx4 v[36:39], v3, s[8:11], s40 offen offset:1024 sc1
    s_add_u32 s33, s33, 1
    s_cmp_gt_u32 s33, 0x100000
    s_cbranch_scc1 chain_kernel_abort
    s_branch Go_19_s01
Go_19_s023:
    s_waitcnt vmcnt(2)
    v_cmp_eq_u32 vcc, -1, v32
    v_mov_b32_dpp v48, v32 row_ror:8 row_mask:0xf bank_mask:0xf
    v_mov_b32_dpp v49, v33 row_ror:8 row_mask:0xf bank_mask:0xf
    v_mov_b32_dpp v50, v34 row_ror:8 row_mask:0xf bank_mask:0xf
    v_mov_b32_dpp v51, v35 row_ror:8 row_mask:0xf bank_mask:0xf
    s_cbranch_vccnz Go_19_f023
    v_smfmac_f32_16x16x64_bf16 v[76:79], v[32:35], a[192:199], v19
    v_smfmac_f32_16x16x64_bf16 v[76:79], v[48:51], a[224:231], v19
    s_branch Go_19_s23
Go_19_f023:
    buffer_load_dwordx4 v[32:35], v3, s[8:11], s40 offen offset:0 sc1
    s_add_u32 s33, s33, 1
    s_cmp_gt_u32 s33, 0x100000
    s_cbranch_scc1 chain_kernel_abort
    s_branch Go_19_s230
Go_19_s20:
    s_waitcnt vmcnt(1)
    v_cmp_eq_u32 vcc, -1, v40
    v_mov_b32_dpp v56, v40 row_ror:8 row_mask:0xf bank_mask:0xf
    v_mov_b32_dpp v57, v41 row_ror:8 row_mask:0xf bank_mask:0xf
    v_mov_b32_dpp v58, v42 row_ror:8 row_mask:0xf bank_mask:0xf
    v_mov_b32_dpp v59, v43 row_ror:8 row_mask:0xf bank_mask:0xf
    s_cbranch_vccnz Go_19_f20
    v_smfmac_f32_16x16x64_bf16 v[76:79], v[40:43], a[208:215], v19
    v_smfmac_f32_16x16x64_bf16 v[76:79], v[56:59], a[240:247], v19
    s_branch Go_19_s0
Go_19_f20:
    buffer_load_dwordx4 v[40:43], v3, s[8:11], s40 offen offset:2048 sc1
    s_add_u32 s33, s33, 1
    s_cmp_gt_u32 s33, 0x100000
    s_cbranch_scc1 chain_kernel_abort
    s_branch Go_19_s02
Go_19_s21:
    s_waitcnt vmcnt(1)
    v_cmp_eq_u32 vcc, -1, v40
    v_mov_b32_dpp v56, v40 row_ror:8 row_mask:0xf bank_mask:0xf
    v_mov_b32_dpp v57, v41 row_ror:8 row_mask:0xf bank_mask:0xf
    v_mov_b32_dpp v58, v42 row_ror:8 row_mask:0xf bank_mask:0xf
    v_mov_b32_dpp v59, v43 row_ror:8 row_mask:0xf bank_mask:0xf
    s_cbranch_vccnz Go_19_f21
    v_smfmac_f32_16x16x64_bf16 v[76:79], v[40:43], a[208:215], v19
    v_smfmac_f32_16x16x64_bf16 v[76:79], v[56:59], a[240:247], v19
    s_branch Go_19_s1
Go_19_f21:
    buffer_load_dwordx4 v[40:43], v3, s[8:11], s40 offen offset:2048 sc1
    s_add_u32 s33, s33, 1
    s_cmp_gt_u32 s33, 0x100000
    s_cbranch_scc1 chain_kernel_abort
    s_branch Go_19_s12
Go_19_s120:
    s_waitcnt vmcnt(2)
    v_cmp_eq_u32 vcc, -1, v36
    v_mov_b32_dpp v52, v36 row_ror:8 row_mask:0xf bank_mask:0xf
    v_mov_b32_dpp v53, v37 row_ror:8 row_mask:0xf bank_mask:0xf
    v_mov_b32_dpp v54, v38 row_ror:8 row_mask:0xf bank_mask:0xf
    v_mov_b32_dpp v55, v39 row_ror:8 row_mask:0xf bank_mask:0xf
    s_cbranch_vccnz Go_19_f120
    v_smfmac_f32_16x16x64_bf16 v[76:79], v[36:39], a[200:207], v19
    v_smfmac_f32_16x16x64_bf16 v[76:79], v[52:55], a[232:239], v19
    s_branch Go_19_s20
Go_19_f120:
    buffer_load_dwordx4 v[36:39], v3, s[8:11], s40 offen offset:1024 sc1
    s_add_u32 s33, s33, 1
    s_cmp_gt_u32 s33, 0x100000
    s_cbranch_scc1 chain_kernel_abort
    s_branch Go_19_s201
Go_19_s130:
    s_waitcnt vmcnt(2)
    v_cmp_eq_u32 vcc, -1, v36
    v_mov_b32_dpp v52, v36 row_ror:8 row_mask:0xf bank_mask:0xf
    v_mov_b32_dpp v53, v37 row_ror:8 row_mask:0xf bank_mask:0xf
    v_mov_b32_dpp v54, v38 row_ror:8 row_mask:0xf bank_mask:0xf
    v_mov_b32_dpp v55, v39 row_ror:8 row_mask:0xf bank_mask:0xf
    s_cbranch_vccnz Go_19_f130
    v_smfmac_f32_16x16x64_bf16 v[76:79], v[36:39], a[200:207], v19
    v_smfmac_f32_16x16x64_bf16 v[76:79], v[52:55], a[232:239], v19
    s_branch Go_19_s30
Go_19_f130:
    buffer_load_dwordx4 v[36:39], v3, s[8:11], s40 offen offset:1024 sc1
    s_add_u32 s33, s33, 1
    s_cmp_gt_u32 s33, 0x100000
    s_cbranch_scc1 chain_kernel_abort
    s_branch Go_19_s301
Go_19_s201:
    s_waitcnt vmcnt(2)
    v_cmp_eq_u32 vcc, -1, v40
    v_mov_b32_dpp v56, v40 row_ror:8 row_mask:0xf bank_mask:0xf
    v_mov_b32_dpp v57, v41 row_ror:8 row_mask:0xf bank_mask:0xf
    v_mov_b32_dpp v58, v42 row_ror:8 row_mask:0xf bank_mask:0xf
    v_mov_b32_dpp v59, v43 row_ror:8 row_mask:0xf bank_mask:0xf
    s_cbranch_vccnz Go_19_f201
    v_smfmac_f32_16x16x64_bf16 v[76:79], v[40:43], a[208:215], v19
    v_smfmac_f32_16x16x64_bf16 v[76:79], v[56:59], a[240:247], v19
    s_branch Go_19_s01
Go_19_f201:
    buffer_load_dwordx4 v[40:43], v3, s[8:11], s40 offen offset:2048 sc1
    s_add_u32 s33, s33, 1
    s_cmp_gt_u32 s33, 0x100000
    s_cbranch_scc1 chain_kernel_abort
    s_branch Go_19_s012
L_pf_26:
    s_mov_b64 exec, -1
    buffer_load_dword v220, v9, s[8:11], s43 offen sc1
    buffer_load_dword v221, v10, s[8:11], s43 offen sc1
    buffer_load_dword v222, v11, s[8:11], s43 offen sc1
    s_add_u32 s33, s33, 1
    s_cmp_gt_u32 s33, 0x100000
    s_cbranch_scc1 chain_kernel_abort
    s_branch L_pb1_24
L_pb1_24:
    s_waitcnt vmcnt(7)
    v_add_f32 v208, v80, v223
    s_waitcnt vmcnt(5)
    v_max3_u32 v20, v223, v224, v225
    v_add_f32 v209, v224, v225
    v_cmp_eq_u32 vcc, -1, v20
    v_add_f32 v208, v208, v209
    s_nop 1
    v_mov_b32_dpp v209, v208 quad_perm:[1,0,3,2] row_mask:0xf bank_mask:0xf
    s_mov_b64 exec, s[26:27]
    v_cvt_pk_bf16_f32 v208, v208, v209
    v_min_u32 v208, 0xfffffffe, v208
    s_cbranch_vccnz L_pf_27
    s_branch L_pd_25
L_pf_27:
    s_mov_b64 exec, -1
    buffer_load_dword v223, v9, s[8:11], s44 offen sc1
    buffer_load_dword v224, v10, s[8:11], s44 offen sc1
    buffer_load_dword v225, v11, s[8:11], s44 offen sc1
    s_add_u32 s33, s33, 1
    s_cmp_gt_u32 s33, 0x100000
    s_cbranch_scc1 chain_kernel_abort
    s_branch L_pa_22
L_pa_22:
    s_waitcnt vmcnt(5)
    v_add_f32 v208, v80, v220
    s_waitcnt vmcnt(3)
    v_max3_u32 v20, v220, v221, v222
    v_add_f32 v209, v221, v222
    v_cmp_eq_u32 vcc, -1, v20
    v_add_f32 v208, v208, v209
    s_nop 1
    v_mov_b32_dpp v209, v208 quad_perm:[1,0,3,2] row_mask:0xf bank_mask:0xf
    s_mov_b64 exec, s[26:27]
    v_cvt_pk_bf16_f32 v208, v208, v209
    v_min_u32 v208, 0xfffffffe, v208
    s_cbranch_vccnz L_pf_28
    s_branch L_pd_25
L_pf_28:
    s_mov_b64 exec, -1
    buffer_load_dword v220, v9, s[8:11], s43 offen sc1
    buffer_load_dword v221, v10, s[8:11], s43 offen sc1
    buffer_load_dword v222, v11, s[8:11], s43 offen sc1
    s_add_u32 s33, s33, 1
    s_cmp_gt_u32 s33, 0x100000
    s_cbranch_scc1 chain_kernel_abort
    s_branch L_pb_23
L_pb_23:
    s_waitcnt vmcnt(5)
    v_add_f32 v208, v80, v223
    s_waitcnt vmcnt(3)
    v_max3_u32 v20, v223, v224, v225
    v_add_f32 v209, v224, v225
    v_cmp_eq_u32 vcc, -1, v20
    v_add_f32 v208, v208, v209
    s_nop 1
    v_mov_b32_dpp v209, v208 quad_perm:[1,0,3,2] row_mask:0xf bank_mask:0xf
    s_mov_b64 exec, s[26:27]
    v_cvt_pk_bf16_f32 v208, v208, v209
    v_min_u32 v208, 0xfffffffe, v208
    s_cbranch_vccnz L_pf_29
    s_branch L_pd_25
L_pf_29:
    s_mov_b64 exec, -1
    buffer_load_dword v223, v9, s[8:11], s44 offen sc1
    buffer_load_dword v224, v10, s[8:11], s44 offen sc1
    buffer_load_dword v225, v11, s[8:11], s44 offen sc1
    s_add_u32 s33, s33, 1
    s_cmp_gt_u32 s33, 0x100000
    s_cbranch_scc1 chain_kernel_abort
    s_branch L_pa_22
chain_kernel_abort:
    s_mov_b32 s12, s98
    s_and_b32 s13, s99, 0xffff
    s_mov_b32 s14, 0x100
    s_mov_b32 s15, 0x00020000
    s_mov_b64 exec, 1
    v_mov_b32 v1, s19
    v_or_b32 v1, 0xdead0000, v1
    v_mov_b32 v2, 124
    buffer_store_dword v1, v2, s[12:15], 0 offen
chain_kernel_done:
    s_endpgm
chain_kernel_end:
    s_endpgm
chain_kernel_worker:
    s_sub_u32 s56, s16, 4
    s_mov_b32 s57, s17
    s_mov_b32 s58, s18
    s_cmp_eq_u32 s56, 0
    s_cbranch_scc1 L_big_41
kvs_start:
    s_cmp_eq_u32 s56, 3
    s_cselect_b64 s[12:13], s[90:91], s[88:89]
    s_cmp_eq_u32 s56, 1
    s_cselect_b64 s[12:13], s[86:87], s[12:13]
    s_and_b32 s13, s13, 0xffff
    s_mov_b32 s14, 0x800000
    s_mov_b32 s15, 0x00020000
    s_lshl_b32 s28, s57, 8
    v_bfe_u32 v24, v0, 4, 3
    v_lshlrev_b32 v24, 1, v24
    v_and_b32 v25, 15, v0
    v_xor_b32 v24, v24, v25
    v_lshlrev_b32 v6, 4, v24
    v_bfe_u32 v24, v0, 4, 2
    v_lshl_add_u32 v6, v24, 13, v6
    v_bfe_u32 v24, v0, 6, 1
    v_lshl_add_u32 v6, v24, 16, v6
    v_bfe_u32 v24, v0, 7, 1
    v_lshl_add_u32 v6, v24, 15, v6
    s_and_b32 s60, s58, 1
    s_lshl_b32 s61, s60, 11
    s_lshr_b32 s60, s58, 1
    s_lshl_b32 s60, s60, 10
    s_add_u32 s32, s60, s61
    s_add_u32 m0, s32, 0
    s_add_u32 s61, s28, 0x0
    buffer_load_dwordx4 v6, s[12:15], s61 offen nt lds
    s_add_u32 m0, s32, 4096
    s_add_u32 s61, s28, 0x20000
    buffer_load_dwordx4 v6, s[12:15], s61 offen nt lds
    s_add_u32 m0, s32, 8192
    s_add_u32 s61, s28, 0x40000
    buffer_load_dwordx4 v6, s[12:15], s61 offen nt lds
    s_add_u32 m0, s32, 12288
    s_add_u32 s61, s28, 0x60000
    buffer_load_dwordx4 v6, s[12:15], s61 offen nt lds
    s_add_u32 m0, s32, 16384
    s_add_u32 s61, s28, 0x80000
    buffer_load_dwordx4 v6, s[12:15], s61 offen nt lds
    s_add_u32 m0, s32, 20480
    s_add_u32 s61, s28, 0xa0000
    buffer_load_dwordx4 v6, s[12:15], s61 offen nt lds
    s_add_u32 m0, s32, 24576
    s_add_u32 s61, s28, 0xc0000
    buffer_load_dwordx4 v6, s[12:15], s61 offen nt lds
    s_add_u32 m0, s32, 28672
    s_add_u32 s61, s28, 0xe0000
    buffer_load_dwordx4 v6, s[12:15], s61 offen nt lds
    s_mov_b32 s8, s82
    s_and_b32 s9, s83, 0xffff
    s_mov_b32 s10, 0x400000
    s_mov_b32 s11, 0x00020000
    s_mov_b32 s16, s100
    s_and_b32 s17, s101, 0xffff
    s_mov_b32 s18, 0xa000000
    s_mov_b32 s19, 0x00020000
    v_and_b32 v24, 63, v0
    v_lshlrev_b32 v1, 4, v24
    v_add_u32 v12, 4096, v1
    v_lshlrev_b32 v10, 7, v24
    s_lshl_b32 s27, s57, 13
    s_and_b32 s60, s58, 1
    s_lshl_b32 s60, s60, 18
    s_add_u32 s60, s60, s27
    buffer_load_dword v13, v10, s[8:11], s60 offen
    s_add_u32 s27, s27, 0x80000
    s_add_u32 m0, s32, 32768
    s_add_u32 s61, s28, 0x100000
    buffer_load_dwordx4 v6, s[12:15], s61 offen nt lds
    s_add_u32 m0, s32, 36864
    s_add_u32 s61, s28, 0x120000
    buffer_load_dwordx4 v6, s[12:15], s61 offen nt lds
    s_add_u32 m0, s32, 40960
    s_add_u32 s61, s28, 0x140000
    buffer_load_dwordx4 v6, s[12:15], s61 offen nt lds
    s_add_u32 m0, s32, 45056
    s_add_u32 s61, s28, 0x160000
    buffer_load_dwordx4 v6, s[12:15], s61 offen nt lds
    s_add_u32 m0, s32, 49152
    s_add_u32 s61, s28, 0x180000
    buffer_load_dwordx4 v6, s[12:15], s61 offen nt lds
    s_add_u32 m0, s32, 53248
    s_add_u32 s61, s28, 0x1a0000
    buffer_load_dwordx4 v6, s[12:15], s61 offen nt lds
    s_add_u32 m0, s32, 57344
    s_add_u32 s61, s28, 0x1c0000
    buffer_load_dwordx4 v6, s[12:15], s61 offen nt lds
    s_add_u32 m0, s32, 61440
    s_add_u32 s61, s28, 0x1e0000
    buffer_load_dwordx4 v6, s[12:15], s61 offen nt lds
    v_bfe_u32 v24, v0, 4, 3
    v_and_b32 v25, 7, v0
    v_xor_b32 v24, v24, v25
    v_lshlrev_b32 v2, 4, v24
    v_lshrrev_b32 v24, 3, v0
    v_lshl_add_u32 v2, v24, 11, v2
    v_bfe_u32 v24, v0, 1, 3
    v_bfe_u32 v25, v0, 4, 2
    v_xor_b32 v24, v24, v25
    v_lshlrev_b32 v4, 4, v24
    v_and_b32 v25, 15, v0
    v_lshl_add_u32 v4, v25, 7, v4
    v_add_u32 v4, 98304, v4
    v_xor_b32 v5, 64, v4
    s_add_u32 m0, s32, 65536
    s_add_u32 s61, s28, 0x200000
    buffer_load_dwordx4 v6, s[12:15], s61 offen nt lds
    s_add_u32 m0, s32, 69632
    s_add_u32 s61, s28, 0x220000
    buffer_load_dwordx4 v6, s[12:15], s61 offen nt lds
    s_add_u32 m0, s32, 73728
    s_add_u32 s61, s28, 0x240000
    buffer_load_dwordx4 v6, s[12:15], s61 offen nt lds
    s_add_u32 m0, s32, 77824
    s_add_u32 s61, s28, 0x260000
    buffer_load_dwordx4 v6, s[12:15], s61 offen nt lds
    s_add_u32 m0, s32, 81920
    s_add_u32 s61, s28, 0x280000
    buffer_load_dwordx4 v6, s[12:15], s61 offen nt lds
    s_add_u32 m0, s32, 86016
    s_add_u32 s61, s28, 0x2a0000
    buffer_load_dwordx4 v6, s[12:15], s61 offen nt lds
    s_add_u32 m0, s32, 90112
    s_add_u32 s61, s28, 0x2c0000
    buffer_load_dwordx4 v6, s[12:15], s61 offen nt lds
    s_add_u32 m0, s32, 94208
    s_add_u32 s61, s28, 0x2e0000
    buffer_load_dwordx4 v6, s[12:15], s61 offen nt lds
    v_bfe_u32 v24, v0, 2, 3
    v_lshrrev_b32 v25, 6, v0
    v_lshlrev_b32 v25, 1, v25
    v_xor_b32 v24, v24, v25
    v_lshlrev_b32 v8, 5, v24
    v_bfe_u32 v24, v0, 0, 2
    v_lshl_add_u32 v8, v24, 3, v8
    v_bfe_u32 v24, v0, 2, 2
    v_lshl_add_u32 v8, v24, 8, v8
    v_bfe_u32 v24, v0, 4, 2
    v_lshl_add_u32 v8, v24, 11, v8
    v_xor_b32 v9, 32, v8
    v_mov_b32 v28, -1
    v_mov_b32 v29, -1
    v_mov_b32 v30, -1
    v_mov_b32 v31, -1
    s_lshl_b32 s20, s58, 10
    s_add_u32 s20, s20, 98304
    s_mov_b32 s21, 98304
    s_mov_b32 s23, 0
    s_mov_b32 s29, 32768
    s_add_u32 m0, s32, 98304
    s_add_u32 s61, s28, 0x300000
    buffer_load_dwordx4 v6, s[12:15], s61 offen nt lds
    s_add_u32 m0, s32, 102400
    s_add_u32 s61, s28, 0x320000
    buffer_load_dwordx4 v6, s[12:15], s61 offen nt lds
    s_add_u32 m0, s32, 106496
    s_add_u32 s61, s28, 0x340000
    buffer_load_dwordx4 v6, s[12:15], s61 offen nt lds
    s_add_u32 m0, s32, 110592
    s_add_u32 s61, s28, 0x360000
    buffer_load_dwordx4 v6, s[12:15], s61 offen nt lds
    s_add_u32 m0, s32, 114688
    s_add_u32 s61, s28, 0x380000
    buffer_load_dwordx4 v6, s[12:15], s61 offen nt lds
    s_add_u32 m0, s32, 118784
    s_add_u32 s61, s28, 0x3a0000
    buffer_load_dwordx4 v6, s[12:15], s61 offen nt lds
    s_add_u32 m0, s32, 122880
    s_add_u32 s61, s28, 0x3c0000
    buffer_load_dwordx4 v6, s[12:15], s61 offen nt lds
    s_add_u32 m0, s32, 126976
    s_add_u32 s61, s28, 0x3e0000
    buffer_load_dwordx4 v6, s[12:15], s61 offen nt lds
    s_lshl_b32 s30, s57, 16
    s_cmp_eq_u32 s56, 3
    s_cselect_b32 s60, 11, 10
    s_cselect_b32 s61, 0x4000, 0
    s_lshl_b32 s60, s58, s60
    s_add_u32 s30, s30, s60
    s_add_u32 s30, s30, s61
    s_lshl_b32 s31, s57, 14
    s_lshr_b32 s61, s61, 2
    s_add_u32 s31, s31, s61
    s_lshl_b32 s60, s58, 10
    s_add_u32 s31, s31, s60
    s_add_u32 s31, s31, 0x8000000
    s_cmp_eq_u32 s56, 1
    s_cselect_b32 s31, 0xa000000, s31
    s_cselect_b32 s60, 0x8000, 0
    s_add_u32 s30, s30, s60
    s_add_u32 m0, s32, 131072
    s_add_u32 s61, s28, 0x400000
    buffer_load_dwordx4 v6, s[12:15], s61 offen nt lds
    s_add_u32 m0, s32, 135168
    s_add_u32 s61, s28, 0x420000
    buffer_load_dwordx4 v6, s[12:15], s61 offen nt lds
    s_add_u32 m0, s32, 139264
    s_add_u32 s61, s28, 0x440000
    buffer_load_dwordx4 v6, s[12:15], s61 offen nt lds
    s_add_u32 m0, s32, 143360
    s_add_u32 s61, s28, 0x460000
    buffer_load_dwordx4 v6, s[12:15], s61 offen nt lds
    s_add_u32 m0, s32, 147456
    s_add_u32 s61, s28, 0x480000
    buffer_load_dwordx4 v6, s[12:15], s61 offen nt lds
    s_add_u32 m0, s32, 151552
    s_add_u32 s61, s28, 0x4a0000
    buffer_load_dwordx4 v6, s[12:15], s61 offen nt lds
    s_add_u32 m0, s32, 155648
    s_add_u32 s61, s28, 0x4c0000
    buffer_load_dwordx4 v6, s[12:15], s61 offen nt lds
    s_add_u32 m0, s32, 159744
    s_add_u32 s61, s28, 0x4e0000
    buffer_load_dwordx4 v6, s[12:15], s61 offen nt lds
    s_waitcnt vmcnt(33)
    s_barrier
    ds_read_b64_tr_b16 a[0:1], v8 offset:0
    ds_read_b64_tr_b16 a[2:3], v8 offset:1024
    ds_read_b64_tr_b16 a[4:5], v9 offset:0
    ds_read_b64_tr_b16 a[6:7], v9 offset:1024
    ds_read_b64_tr_b16 a[8:9], v8 offset:8192
    ds_read_b64_tr_b16 a[10:11], v8 offset:9216
    ds_read_b64_tr_b16 a[12:13], v9 offset:8192
    ds_read_b64_tr_b16 a[14:15], v9 offset:9216
    s_waitcnt lgkmcnt(0)
    ds_read_b64_tr_b16 a[16:17], v8 offset:16384
    ds_read_b64_tr_b16 a[18:19], v8 offset:17408
    ds_read_b64_tr_b16 a[20:21], v9 offset:16384
    ds_read_b64_tr_b16 a[22:23], v9 offset:17408
    ds_read_b64_tr_b16 a[24:25], v8 offset:24576
    ds_read_b64_tr_b16 a[26:27], v8 offset:25600
    ds_read_b64_tr_b16 a[28:29], v9 offset:24576
    ds_read_b64_tr_b16 a[30:31], v9 offset:25600
    s_waitcnt lgkmcnt(0)
    s_waitcnt vmcnt(24)
    s_barrier
    s_add_u32 m0, s32, 0
    s_add_u32 s61, s28, 0x500000
    buffer_load_dwordx4 v6, s[12:15], s61 offen nt lds
    s_add_u32 m0, s32, 4096
    s_add_u32 s61, s28, 0x520000
    buffer_load_dwordx4 v6, s[12:15], s61 offen nt lds
    s_add_u32 m0, s32, 8192
    s_add_u32 s61, s28, 0x540000
    buffer_load_dwordx4 v6, s[12:15], s61 offen nt lds
    s_add_u32 m0, s32, 12288
    s_add_u32 s61, s28, 0x560000
    buffer_load_dwordx4 v6, s[12:15], s61 offen nt lds
    s_add_u32 m0, s32, 16384
    s_add_u32 s61, s28, 0x580000
    buffer_load_dwordx4 v6, s[12:15], s61 offen nt lds
    s_add_u32 m0, s32, 20480
    s_add_u32 s61, s28, 0x5a0000
    buffer_load_dwordx4 v6, s[12:15], s61 offen nt lds
    s_add_u32 m0, s32, 24576
    s_add_u32 s61, s28, 0x5c0000
    buffer_load_dwordx4 v6, s[12:15], s61 offen nt lds
    s_add_u32 m0, s32, 28672
    s_add_u32 s61, s28, 0x5e0000
    buffer_load_dwordx4 v6, s[12:15], s61 offen nt lds
    ds_read_b64_tr_b16 a[32:33], v8 offset:32768
    ds_read_b64_tr_b16 a[34:35], v8 offset:33792
    ds_read_b64_tr_b16 a[36:37], v9 offset:32768
    ds_read_b64_tr_b16 a[38:39], v9 offset:33792
    ds_read_b64_tr_b16 a[40:41], v8 offset:40960
    ds_read_b64_tr_b16 a[42:43], v8 offset:41984
    ds_read_b64_tr_b16 a[44:45], v9 offset:40960
    ds_read_b64_tr_b16 a[46:47], v9 offset:41984
    s_waitcnt lgkmcnt(0)
    ds_read_b64_tr_b16 a[48:49], v8 offset:49152
    ds_read_b64_tr_b16 a[50:51], v8 offset:50176
    ds_read_b64_tr_b16 a[52:53], v9 offset:49152
    ds_read_b64_tr_b16 a[54:55], v9 offset:50176
    ds_read_b64_tr_b16 a[56:57], v8 offset:57344
    ds_read_b64_tr_b16 a[58:59], v8 offset:58368
    ds_read_b64_tr_b16 a[60:61], v9 offset:57344
    ds_read_b64_tr_b16 a[62:63], v9 offset:58368
    s_waitcnt lgkmcnt(0)
    s_waitcnt vmcnt(24)
    s_barrier
    s_add_u32 m0, s32, 32768
    s_add_u32 s61, s28, 0x600000
    buffer_load_dwordx4 v6, s[12:15], s61 offen nt lds
    s_add_u32 m0, s32, 36864
    s_add_u32 s61, s28, 0x620000
    buffer_load_dwordx4 v6, s[12:15], s61 offen nt lds
    s_add_u32 m0, s32, 40960
    s_add_u32 s61, s28, 0x640000
    buffer_load_dwordx4 v6, s[12:15], s61 offen nt lds
    s_add_u32 m0, s32, 45056
    s_add_u32 s61, s28, 0x660000
    buffer_load_dwordx4 v6, s[12:15], s61 offen nt lds
    s_add_u32 m0, s32, 49152
    s_add_u32 s61, s28, 0x680000
    buffer_load_dwordx4 v6, s[12:15], s61 offen nt lds
    s_add_u32 m0, s32, 53248
    s_add_u32 s61, s28, 0x6a0000
    buffer_load_dwordx4 v6, s[12:15], s61 offen nt lds
    s_add_u32 m0, s32, 57344
    s_add_u32 s61, s28, 0x6c0000
    buffer_load_dwordx4 v6, s[12:15], s61 offen nt lds
    s_add_u32 m0, s32, 61440
    s_add_u32 s61, s28, 0x6e0000
    buffer_load_dwordx4 v6, s[12:15], s61 offen nt lds
    v_add_u32 v8, 0x10000, v8
    v_add_u32 v9, 0x10000, v9
    ds_read_b64_tr_b16 a[64:65], v8 offset:0
    ds_read_b64_tr_b16 a[66:67], v8 offset:1024
    ds_read_b64_tr_b16 a[68:69], v9 offset:0
    ds_read_b64_tr_b16 a[70:71], v9 offset:1024
    ds_read_b64_tr_b16 a[72:73], v8 offset:8192
    ds_read_b64_tr_b16 a[74:75], v8 offset:9216
    ds_read_b64_tr_b16 a[76:77], v9 offset:8192
    ds_read_b64_tr_b16 a[78:79], v9 offset:9216
    s_waitcnt lgkmcnt(0)
    ds_read_b64_tr_b16 a[80:81], v8 offset:16384
    ds_read_b64_tr_b16 a[82:83], v8 offset:17408
    ds_read_b64_tr_b16 a[84:85], v9 offset:16384
    ds_read_b64_tr_b16 a[86:87], v9 offset:17408
    ds_read_b64_tr_b16 a[88:89], v8 offset:24576
    ds_read_b64_tr_b16 a[90:91], v8 offset:25600
    ds_read_b64_tr_b16 a[92:93], v9 offset:24576
    ds_read_b64_tr_b16 a[94:95], v9 offset:25600
    s_waitcnt lgkmcnt(0)
    s_waitcnt vmcnt(24)
    s_barrier
    s_add_u32 m0, s32, 65536
    s_add_u32 s61, s28, 0x700000
    buffer_load_dwordx4 v6, s[12:15], s61 offen nt lds
    s_add_u32 m0, s32, 69632
    s_add_u32 s61, s28, 0x720000
    buffer_load_dwordx4 v6, s[12:15], s61 offen nt lds
    s_add_u32 m0, s32, 73728
    s_add_u32 s61, s28, 0x740000
    buffer_load_dwordx4 v6, s[12:15], s61 offen nt lds
    s_add_u32 m0, s32, 77824
    s_add_u32 s61, s28, 0x760000
    buffer_load_dwordx4 v6, s[12:15], s61 offen nt lds
    s_add_u32 m0, s32, 81920
    s_add_u32 s61, s28, 0x780000
    buffer_load_dwordx4 v6, s[12:15], s61 offen nt lds
    s_add_u32 m0, s32, 86016
    s_add_u32 s61, s28, 0x7a0000
    buffer_load_dwordx4 v6, s[12:15], s61 offen nt lds
    s_add_u32 m0, s32, 90112
    s_add_u32 s61, s28, 0x7c0000
    buffer_load_dwordx4 v6, s[12:15], s61 offen nt lds
    s_add_u32 m0, s32, 94208
    s_add_u32 s61, s28, 0x7e0000
    buffer_load_dwordx4 v6, s[12:15], s61 offen nt lds
    v_mov_b32 v24, 4
    global_load_dword v11, v24, s[98:99] sc1
    s_or_b32 s60, s95, s58
    s_cbranch_scc1 L_rw_42
    s_lshl_b32 s62, s56, 3
    s_add_u32 s62, s62, 160
    s_mov_b32 s63, 0
L_rp_43:
    s_load_dwordx2 s[60:61], s[98:99], s62 glc
    s_add_u32 s63, s63, 1
    s_cmp_gt_u32 s63, 0x100000
    s_cbranch_scc1 chain_kernel_wabort
    s_waitcnt lgkmcnt(0)
    s_cmp_lt_u32 s61, 0x2000
    s_cbranch_scc1 L_rp_43
    s_lshr_b32 s61, s1, 8
    s_cmp_eq_u32 s60, -1
    s_cselect_b32 s0, -1, s61
L_rw_42:
    ds_read_b64_tr_b16 a[96:97], v8 offset:32768
    ds_read_b64_tr_b16 a[98:99], v8 offset:33792
    ds_read_b64_tr_b16 a[100:101], v9 offset:32768
    ds_read_b64_tr_b16 a[102:103], v9 offset:33792
    ds_read_b64_tr_b16 a[104:105], v8 offset:40960
    ds_read_b64_tr_b16 a[106:107], v8 offset:41984
    ds_read_b64_tr_b16 a[108:109], v9 offset:40960
    ds_read_b64_tr_b16 a[110:111], v9 offset:41984
    s_waitcnt lgkmcnt(0)
    ds_read_b64_tr_b16 a[112:113], v8 offset:49152
    ds_read_b64_tr_b16 a[114:115], v8 offset:50176
    ds_read_b64_tr_b16 a[116:117], v9 offset:49152
    ds_read_b64_tr_b16 a[118:119], v9 offset:50176
    ds_read_b64_tr_b16 a[120:121], v8 offset:57344
    ds_read_b64_tr_b16 a[122:123], v8 offset:58368
    ds_read_b64_tr_b16 a[124:125], v9 offset:57344
    ds_read_b64_tr_b16 a[126:127], v9 offset:58368
    s_waitcnt lgkmcnt(0)
    s_waitcnt vmcnt(24)
    s_barrier
    s_add_u32 m0, s20, 0
    s_nop 0
    buffer_load_dwordx4 v2, s[8:11], s23 offen offset:0 lds
    s_add_u32 m0, s20, 3968
    s_nop 0
    buffer_load_dwordx4 v2, s[8:11], s23 offen offset:128 lds
    s_add_u32 m0, s20, 7936
    s_nop 0
    buffer_load_dwordx4 v2, s[8:11], s23 offen offset:256 lds
    s_add_u32 m0, s20, 11904
    s_nop 0
    buffer_load_dwordx4 v2, s[8:11], s23 offen offset:384 lds
    s_add_u32 m0, s20, 15872
    s_nop 0
    buffer_load_dwordx4 v2, s[8:11], s23 offen offset:512 lds
    s_add_u32 m0, s20, 19840
    s_nop 0
    buffer_load_dwordx4 v2, s[8:11], s23 offen offset:640 lds
    s_add_u32 m0, s20, 23808
    s_nop 0
    buffer_load_dwordx4 v2, s[8:11], s23 offen offset:768 lds
    s_add_u32 m0, s20, 27776
    s_nop 0
    buffer_load_dwordx4 v2, s[8:11], s23 offen offset:896 lds
    s_add_u32 s23, s23, 1024
    s_bitcmp1_b32 s23, 11
    s_cselect_b32 s60, 0xf800, 0
    s_add_u32 s23, s23, s60
    s_add_u32 s20, s20, 32768
    s_cmp_ge_u32 s20, 163840
    s_cselect_b32 s60, 163840, 0
    s_sub_u32 s20, s20, s60
    v_add_u32 v8, 0x10000, v8
    v_add_u32 v9, 0x10000, v9
    ds_read_b64_tr_b16 a[128:129], v8 offset:0
    ds_read_b64_tr_b16 a[130:131], v8 offset:1024
    ds_read_b64_tr_b16 a[132:133], v9 offset:0
    ds_read_b64_tr_b16 a[134:135], v9 offset:1024
    ds_read_b64_tr_b16 a[136:137], v8 offset:8192
    ds_read_b64_tr_b16 a[138:139], v8 offset:9216
    ds_read_b64_tr_b16 a[140:141], v9 offset:8192
    ds_read_b64_tr_b16 a[142:143], v9 offset:9216
    s_waitcnt lgkmcnt(0)
    ds_read_b64_tr_b16 a[144:145], v8 offset:16384
    ds_read_b64_tr_b16 a[146:147], v8 offset:17408
    ds_read_b64_tr_b16 a[148:149], v9 offset:16384
    ds_read_b64_tr_b16 a[150:151], v9 offset:17408
    ds_read_b64_tr_b16 a[152:153], v8 offset:24576
    ds_read_b64_tr_b16 a[154:155], v8 offset:25600
    ds_read_b64_tr_b16 a[156:157], v9 offset:24576
    ds_read_b64_tr_b16 a[158:159], v9 offset:25600
    s_waitcnt lgkmcnt(0)
    s_waitcnt vmcnt(24)
    s_barrier
    s_add_u32 m0, s20, 0
    s_nop 0
    buffer_load_dwordx4 v2, s[8:11], s23 offen offset:0 lds
    s_add_u32 m0, s20, 3968
    s_nop 0
    buffer_load_dwordx4 v2, s[8:11], s23 offen offset:128 lds
    s_add_u32 m0, s20, 7936
    s_nop 0
    buffer_load_dwordx4 v2, s[8:11], s23 offen offset:256 lds
    s_add_u32 m0, s20, 11904
    s_nop 0
    buffer_load_dwordx4 v2, s[8:11], s23 offen offset:384 lds
    s_add_u32 m0, s20, 15872
    s_nop 0
    buffer_load_dwordx4 v2, s[8:11], s23 offen offset:512 lds
    s_add_u32 m0, s20, 19840
    s_nop 0
    buffer_load_dwordx4 v2, s[8:11], s23 offen offset:640 lds
    s_add_u32 m0, s20, 23808
    s_nop 0
    buffer_load_dwordx4 v2, s[8:11], s23 offen offset:768 lds
    s_add_u32 m0, s20, 27776
    s_nop 0
    buffer_load_dwordx4 v2, s[8:11], s23 offen offset:896 lds
    s_add_u32 s23, s23, 1024
    s_bitcmp1_b32 s23, 11
    s_cselect_b32 s60, 0xf800, 0
    s_add_u32 s23, s23, s60
    s_add_u32 s20, s20, 32768
    s_cmp_ge_u32 s20, 163840
    s_cselect_b32 s60, 163840, 0
    s_sub_u32 s20, s20, s60
    v_add_u32 v8, 0xfffe0000, v8
    v_add_u32 v9, 0xfffe0000, v9
    ds_read_b64_tr_b16 a[160:161], v8 offset:0
    ds_read_b64_tr_b16 a[162:163], v8 offset:1024
    ds_read_b64_tr_b16 a[164:165], v9 offset:0
    ds_read_b64_tr_b16 a[166:167], v9 offset:1024
    ds_read_b64_tr_b16 a[168:169], v8 offset:8192
    ds_read_b64_tr_b16 a[170:171], v8 offset:9216
    ds_read_b64_tr_b16 a[172:173], v9 offset:8192
    ds_read_b64_tr_b16 a[174:175], v9 offset:9216
    s_waitcnt lgkmcnt(0)
    ds_read_b64_tr_b16 a[176:177], v8 offset:16384
    ds_read_b64_tr_b16 a[178:179], v8 offset:17408
    ds_read_b64_tr_b16 a[180:181], v9 offset:16384
    ds_read_b64_tr_b16 a[182:183], v9 offset:17408
    ds_read_b64_tr_b16 a[184:185], v8 offset:24576
    ds_read_b64_tr_b16 a[186:187], v8 offset:25600
    ds_read_b64_tr_b16 a[188:189], v9 offset:24576
    ds_read_b64_tr_b16 a[190:191], v9 offset:25600
    s_waitcnt lgkmcnt(0)
    s_waitcnt vmcnt(24)
    s_barrier
    s_add_u32 m0, s20, 0
    s_nop 0
    buffer_load_dwordx4 v2, s[8:11], s23 offen offset:0 lds
    s_add_u32 m0, s20, 3968
    s_nop 0
    buffer_load_dwordx4 v2, s[8:11], s23 offen offset:128 lds
    s_add_u32 m0, s20, 7936
    s_nop 0
    buffer_load_dwordx4 v2, s[8:11], s23 offen offset:256 lds
    s_add_u32 m0, s20, 11904
    s_nop 0
    buffer_load_dwordx4 v2, s[8:11], s23 offen offset:384 lds
    s_add_u32 m0, s20, 15872
    s_nop 0
    buffer_load_dwordx4 v2, s[8:11], s23 offen offset:512 lds
    s_add_u32 m0, s20, 19840
    s_nop 0
    buffer_load_dwordx4 v2, s[8:11], s23 offen offset:640 lds
    s_add_u32 m0, s20, 23808
    s_nop 0
    buffer_load_dwordx4 v2, s[8:11], s23 offen offset:768 lds
    s_add_u32 m0, s20, 27776
    s_nop 0
    buffer_load_dwordx4 v2, s[8:11], s23 offen offset:896 lds
    s_add_u32 s23, s23, 1024
    s_bitcmp1_b32 s23, 11
    s_cselect_b32 s60, 0xf800, 0
    s_add_u32 s23, s23, s60
    s_add_u32 s20, s20, 32768
    s_cmp_ge_u32 s20, 163840
    s_cselect_b32 s60, 163840, 0
    s_sub_u32 s20, s20, s60
    ds_read_b64_tr_b16 a[192:193], v8 offset:32768
    ds_read_b64_tr_b16 a[194:195], v8 offset:33792
    ds_read_b64_tr_b16 a[196:197], v9 offset:32768
    ds_read_b64_tr_b16 a[198:199], v9 offset:33792
    ds_read_b64_tr_b16 a[200:201], v8 offset:40960
    ds_read_b64_tr_b16 a[202:203], v8 offset:41984
    ds_read_b64_tr_b16 a[204:205], v9 offset:40960
    ds_read_b64_tr_b16 a[206:207], v9 offset:41984
    s_waitcnt lgkmcnt(0)
    ds_read_b64_tr_b16 a[208:209], v8 offset:49152
    ds_read_b64_tr_b16 a[210:211], v8 offset:50176
    ds_read_b64_tr_b16 a[212:213], v9 offset:49152
    ds_read_b64_tr_b16 a[214:215], v9 offset:50176
    ds_read_b64_tr_b16 a[216:217], v8 offset:57344
    ds_read_b64_tr_b16 a[218:219], v8 offset:58368
    ds_read_b64_tr_b16 a[220:221], v9 offset:57344
    ds_read_b64_tr_b16 a[222:223], v9 offset:58368
    s_waitcnt lgkmcnt(0)
    s_waitcnt vmcnt(24)
    s_barrier
    s_cmp_lg_u32 s95, 0
    s_cbranch_scc1 L_rok_44
    v_mov_b32 v24, 32768
    s_cmp_lg_u32 s58, 0
    s_cbranch_scc1 L_rw_45
    v_mov_b32 v25, s0
    ds_write_b32 v24, v25
    s_waitcnt lgkmcnt(0)
L_rw_45:
    s_barrier
    ds_read_b32 v25, v24
    s_waitcnt lgkmcnt(0)
    v_readfirstlane_b32 s60, v25
    s_mov_b32 s95, 1
    s_cmp_eq_u32 s60, -1
    s_cbranch_scc1 L_rok_44
    s_mov_b32 s57, s60
    s_waitcnt vmcnt(0)
    s_barrier
    s_cmp_ge_u32 s57, 32
    s_cbranch_scc1 chain_kernel_end
    s_branch kvs_start
L_rok_44:
    v_add_u32 v8, 0x10000, v8
    v_add_u32 v9, 0x10000, v9
    ds_read_b64_tr_b16 a[224:225], v8 offset:0
    ds_read_b64_tr_b16 a[226:227], v8 offset:1024
    ds_read_b64_tr_b16 a[228:229], v9 offset:0
    ds_read_b64_tr_b16 a[230:231], v9 offset:1024
    ds_read_b64_tr_b16 a[232:233], v8 offset:8192
    ds_read_b64_tr_b16 a[234:235], v8 offset:9216
    ds_read_b64_tr_b16 a[236:237], v9 offset:8192
    ds_read_b64_tr_b16 a[238:239], v9 offset:9216
    s_waitcnt lgkmcnt(0)
    ds_read_b64_tr_b16 a[240:241], v8 offset:16384
    ds_read_b64_tr_b16 a[242:243], v8 offset:17408
    ds_read_b64_tr_b16 a[244:245], v9 offset:16384
    ds_read_b64_tr_b16 a[246:247], v9 offset:17408
    ds_read_b64_tr_b16 a[248:249], v8 offset:24576
    ds_read_b64_tr_b16 a[250:251], v8 offset:25600
    ds_read_b64_tr_b16 a[252:253], v9 offset:24576
    ds_read_b64_tr_b16 a[254:255], v9 offset:25600
    s_waitcnt lgkmcnt(0)
    s_waitcnt vmcnt(16)
    s_barrier
    s_mov_b32 s62, 0
L_pp_46:
    v_readfirstlane_b32 s59, v11
    s_and_b32 s60, s59, 0xff
    s_cmp_ge_u32 s60, 15
    s_cbranch_scc1 L_pok_47
    v_mov_b32 v24, 4
    global_load_dword v11, v24, s[98:99] sc1
    s_add_u32 s62, s62, 1
    s_cmp_gt_u32 s62, 0x200000
    s_cbranch_scc1 chain_kernel_wabort
    s_waitcnt vmcnt(0)
    s_branch L_pp_46
L_pok_47:
    s_cmp_ge_u32 s59, 0x800
    s_cselect_b32 s59, 0x2000, 0
    s_xor_b32 s31, s31, s59
    s_xor_b32 s30, s30, s59
    s_mov_b32 s24, 0
    s_mov_b32 s18, 0
    s_cmp_eq_u32 s56, 3
    s_cbranch_scc1 L_kvv_48
    ds_read_b128 v[72:75], v4 offset:0
    ds_read_b128 v[76:79], v4 offset:2048
    ds_read_b128 v[80:83], v5 offset:0
    ds_read_b128 v[84:87], v5 offset:2048
    ds_read_b128 v[88:91], v4 offset:4096
    ds_read_b128 v[92:95], v4 offset:6144
    s_mov_b32 s34, 0x2042258
    s_mov_b32 s35, 0x40004004
    s_cmp_eq_u32 s58, 0
    s_cselect_b32 s33, s27, 0x400000
    s_mov_b32 s25, 0
    s_mov_b32 s26, 0
kvsk:
    s_waitcnt lgkmcnt(4)
    v_mfma_f32_16x16x32_bf16 v[32:35], a[0:3], v[72:75], 0
    ds_read_b128 v[96:99], v5 offset:4096
    v_mfma_f32_16x16x32_bf16 v[36:39], a[4:7], v[72:75], 0
    ds_read_b128 v[100:103], v5 offset:6144
    v_mfma_f32_16x16x32_bf16 v[44:47], a[4:7], v[76:79], 0
    v_mfma_f32_16x16x32_bf16 v[40:43], a[0:3], v[76:79], 0
    v_cvt_pk_bf16_f32 v64, v48, v49
    s_waitcnt lgkmcnt(4)
    v_mfma_f32_16x16x32_bf16 v[32:35], a[8:11], v[80:83], v[32:35]
    ds_read_b128 v[72:75], v4 offset:8192
    v_cvt_pk_bf16_f32 v65, v50, v51
    v_mfma_f32_16x16x32_bf16 v[36:39], a[12:15], v[80:83], v[36:39]
    ds_read_b128 v[76:79], v4 offset:10240
    v_cvt_pk_bf16_f32 v66, v52, v53
    v_mfma_f32_16x16x32_bf16 v[44:47], a[12:15], v[84:87], v[44:47]
    v_cvt_pk_bf16_f32 v67, v54, v55
    v_cvt_pk_bf16_f32 v68, v56, v57
    v_mfma_f32_16x16x32_bf16 v[40:43], a[8:11], v[84:87], v[40:43]
    v_cvt_pk_bf16_f32 v69, v58, v59
    s_waitcnt lgkmcnt(4)
    v_mfma_f32_16x16x32_bf16 v[32:35], a[16:19], v[88:91], v[32:35]
    ds_read_b128 v[80:83], v5 offset:8192
    v_cvt_pk_bf16_f32 v70, v60, v61
    v_mfma_f32_16x16x32_bf16 v[36:39], a[20:23], v[88:91], v[36:39]
    ds_read_b128 v[84:87], v5 offset:10240
    v_cvt_pk_bf16_f32 v71, v62, v63
    v_mfma_f32_16x16x32_bf16 v[44:47], a[20:23], v[92:95], v[44:47]
    buffer_store_dwordx4 v[64:67], v1, s[16:19], s25 offen sc1
    v_mfma_f32_16x16x32_bf16 v[40:43], a[16:19], v[92:95], v[40:43]
    buffer_store_dwordx4 v[68:71], v12, s[16:19], s25 offen sc1
    s_waitcnt lgkmcnt(4)
    v_mfma_f32_16x16x32_bf16 v[32:35], a[24:27], v[96:99], v[32:35]
    ds_read_b128 v[88:91], v4 offset:12288
    buffer_store_dwordx4 v[28:31], v1, s[16:19], s26 offen sc1
    v_mfma_f32_16x16x32_bf16 v[36:39], a[28:31], v[96:99], v[36:39]
    ds_read_b128 v[92:95], v4 offset:14336
    v_mfma_f32_16x16x32_bf16 v[44:47], a[28:31], v[100:103], v[44:47]
    v_mfma_f32_16x16x32_bf16 v[40:43], a[24:27], v[100:103], v[40:43]
    buffer_load_dword v13, v10, s[8:11], s33 offen nt
    s_waitcnt lgkmcnt(4)
    v_mfma_f32_16x16x32_bf16 v[32:35], a[32:35], v[72:75], v[32:35]
    ds_read_b128 v[96:99], v5 offset:12288
    v_mfma_f32_16x16x32_bf16 v[36:39], a[36:39], v[72:75], v[36:39]
    ds_read_b128 v[100:103], v5 offset:14336
    v_mfma_f32_16x16x32_bf16 v[44:47], a[36:39], v[76:79], v[44:47]
    s_mov_b32 s18, 0xa000000
    s_lshl_b32 s25, s24, 21
    v_mfma_f32_16x16x32_bf16 v[40:43], a[32:35], v[76:79], v[40:43]
    s_lshl_b32 s62, s24, 13
    s_waitcnt lgkmcnt(4)
    v_mfma_f32_16x16x32_bf16 v[32:35], a[40:43], v[80:83], v[32:35]
    ds_read_b128 v[72:75], v4 offset:16384
    s_and_b32 s62, s62, 0x2000
    v_mfma_f32_16x16x32_bf16 v[36:39], a[44:47], v[80:83], v[36:39]
    ds_read_b128 v[76:79], v4 offset:18432
    s_xor_b32 s62, s62, s30
    v_mfma_f32_16x16x32_bf16 v[44:47], a[44:47], v[84:87], v[44:47]
    s_add_u32 s25, s25, s62
    s_lshl_b32 s26, s24, 19
    v_mfma_f32_16x16x32_bf16 v[40:43], a[40:43], v[84:87], v[40:43]
    s_lshl_b32 s62, s24, 11
    s_waitcnt lgkmcnt(4)
    v_mfma_f32_16x16x32_bf16 v[32:35], a[48:51], v[88:91], v[32:35]
    ds_read_b128 v[80:83], v5 offset:16384
    s_and_b32 s62, s62, 0x2000
    v_mfma_f32_16x16x32_bf16 v[36:39], a[52:55], v[88:91], v[36:39]
    ds_read_b128 v[84:87], v5 offset:18432
    s_xor_b32 s62, s62, s31
    v_mfma_f32_16x16x32_bf16 v[44:47], a[52:55], v[92:95], v[44:47]
    s_add_u32 s26, s26, s62
    s_cmp_ge_u32 s21, 131072
    v_mfma_f32_16x16x32_bf16 v[40:43], a[48:51], v[92:95], v[40:43]
    s_cselect_b32 s22, 0xfffe0000, s29
    s_waitcnt lgkmcnt(4)
    v_mfma_f32_16x16x32_bf16 v[32:35], a[56:59], v[96:99], v[32:35]
    ds_read_b128 v[88:91], v4 offset:20480
    s_add_u32 s21, s21, s22
    v_mfma_f32_16x16x32_bf16 v[36:39], a[60:63], v[96:99], v[36:39]
    ds_read_b128 v[92:95], v4 offset:22528
    s_add_u32 s27, s27, 0x10000
    v_mfma_f32_16x16x32_bf16 v[44:47], a[60:63], v[100:103], v[44:47]
    s_andn2_b32 s61, 3, s24
    s_or_b32 s61, s61, s58
    v_mfma_f32_16x16x32_bf16 v[40:43], a[56:59], v[100:103], v[40:43]
    s_cselect_b32 s33, 0x400000, s27
    s_waitcnt lgkmcnt(4)
    v_mfma_f32_16x16x32_bf16 v[32:35], a[64:67], v[72:75], v[32:35]
    ds_read_b128 v[96:99], v5 offset:20480
    s_cmp_lt_u32 s24, 4
    v_mfma_f32_16x16x32_bf16 v[36:39], a[68:71], v[72:75], v[36:39]
    ds_read_b128 v[100:103], v5 offset:22528
    s_cselect_b64 vcc, -1, 0
    v_mfma_f32_16x16x32_bf16 v[44:47], a[68:71], v[76:79], v[44:47]
    v_mfma_f32_16x16x32_bf16 v[40:43], a[64:67], v[76:79], v[40:43]
    s_waitcnt lgkmcnt(4)
    v_mfma_f32_16x16x32_bf16 v[32:35], a[72:75], v[80:83], v[32:35]
    ds_read_b128 v[72:75], v4 offset:24576
    v_mfma_f32_16x16x32_bf16 v[36:39], a[76:79], v[80:83], v[36:39]
    ds_read_b128 v[76:79], v4 offset:26624
    v_mfma_f32_16x16x32_bf16 v[44:47], a[76:79], v[84:87], v[44:47]
    v_mfma_f32_16x16x32_bf16 v[40:43], a[72:75], v[84:87], v[40:43]
    s_waitcnt lgkmcnt(4)
    v_mfma_f32_16x16x32_bf16 v[32:35], a[80:83], v[88:91], v[32:35]
    ds_read_b128 v[80:83], v5 offset:24576
    s_add_u32 m0, s20, 0
    v_mfma_f32_16x16x32_bf16 v[36:39], a[84:87], v[88:91], v[36:39]
    ds_read_b128 v[84:87], v5 offset:26624
    buffer_load_dwordx4 v2, s[8:11], s23 offen offset:0 lds
    v_mfma_f32_16x16x32_bf16 v[44:47], a[84:87], v[92:95], v[44:47]
    v_mfma_f32_16x16x32_bf16 v[40:43], a[80:83], v[92:95], v[40:43]
    s_waitcnt lgkmcnt(4)
    v_mfma_f32_16x16x32_bf16 v[32:35], a[88:91], v[96:99], v[32:35]
    ds_read_b128 v[88:91], v4 offset:28672
    v_mfma_f32_16x16x32_bf16 v[36:39], a[92:95], v[96:99], v[36:39]
    ds_read_b128 v[92:95], v4 offset:30720
    s_add_u32 m0, s20, 3968
    v_mfma_f32_16x16x32_bf16 v[44:47], a[92:95], v[100:103], v[44:47]
    buffer_load_dwordx4 v2, s[8:11], s23 offen offset:128 lds
    v_mfma_f32_16x16x32_bf16 v[40:43], a[88:91], v[100:103], v[40:43]
    v_add_u32 v4, s22, v4
    s_waitcnt lgkmcnt(4)
    v_mfma_f32_16x16x32_bf16 v[32:35], a[96:99], v[72:75], v[32:35]
    ds_read_b128 v[96:99], v5 offset:28672
    v_mfma_f32_16x16x32_bf16 v[36:39], a[100:103], v[72:75], v[36:39]
    ds_read_b128 v[100:103], v5 offset:30720
    v_mfma_f32_16x16x32_bf16 v[44:47], a[100:103], v[76:79], v[44:47]
    v_add_u32 v5, s22, v5
    s_add_u32 m0, s20, 7936
    v_mfma_f32_16x16x32_bf16 v[40:43], a[96:99], v[76:79], v[40:43]
    buffer_load_dwordx4 v2, s[8:11], s23 offen offset:256 lds
    s_waitcnt vmcnt(15)
    s_cbranch_vccnz kvsk_early
    s_barrier
kvsk_mid:
    s_waitcnt lgkmcnt(4)
    v_mfma_f32_16x16x32_bf16 v[32:35], a[104:107], v[80:83], v[32:35]
    ds_read_b128 v[72:75], v4 offset:0
    v_mfma_f32_16x16x32_bf16 v[36:39], a[108:111], v[80:83], v[36:39]
    ds_read_b128 v[76:79], v4 offset:2048
    v_mfma_f32_16x16x32_bf16 v[44:47], a[108:111], v[84:87], v[44:47]
    v_mfma_f32_16x16x32_bf16 v[40:43], a[104:107], v[84:87], v[40:43]
    s_add_u32 m0, s20, 11904
    s_waitcnt lgkmcnt(4)
    v_mfma_f32_16x16x32_bf16 v[32:35], a[112:115], v[88:91], v[32:35]
    ds_read_b128 v[80:83], v5 offset:0
    buffer_load_dwordx4 v2, s[8:11], s23 offen offset:384 lds
    v_mfma_f32_16x16x32_bf16 v[36:39], a[116:119], v[88:91], v[36:39]
    ds_read_b128 v[84:87], v5 offset:2048
    v_mfma_f32_16x16x32_bf16 v[44:47], a[116:119], v[92:95], v[44:47]
    v_mfma_f32_16x16x32_bf16 v[40:43], a[112:115], v[92:95], v[40:43]
    s_waitcnt lgkmcnt(4)
    v_mfma_f32_16x16x32_bf16 v[32:35], a[120:123], v[96:99], v[32:35]
    ds_read_b128 v[88:91], v4 offset:4096
    s_add_u32 m0, s20, 15872
    v_mfma_f32_16x16x32_bf16 v[36:39], a[124:127], v[96:99], v[36:39]
    ds_read_b128 v[92:95], v4 offset:6144
    buffer_load_dwordx4 v2, s[8:11], s23 offen offset:512 lds
    v_mfma_f32_16x16x32_bf16 v[44:47], a[124:127], v[100:103], v[44:47]
    s_cmp_ge_u32 s21, 131072
    s_cselect_b32 s22, 0xfffe0000, s29
    v_mfma_f32_16x16x32_bf16 v[40:43], a[120:123], v[100:103], v[40:43]
    s_add_u32 s21, s21, s22
    s_waitcnt lgkmcnt(4)
    v_mfma_f32_16x16x32_bf16 v[32:35], a[128:131], v[72:75], v[32:35]
    ds_read_b128 v[96:99], v5 offset:4096
    v_mfma_f32_16x16x32_bf16 v[36:39], a[132:135], v[72:75], v[36:39]
    ds_read_b128 v[100:103], v5 offset:6144
    s_add_u32 m0, s20, 19840
    v_mfma_f32_16x16x32_bf16 v[44:47], a[132:135], v[76:79], v[44:47]
    buffer_load_dwordx4 v2, s[8:11], s23 offen offset:640 lds
    v_mfma_f32_16x16x32_bf16 v[40:43], a[128:131], v[76:79], v[40:43]
    s_waitcnt lgkmcnt(4)
    v_mfma_f32_16x16x32_bf16 v[32:35], a[136:139], v[80:83], v[32:35]
    ds_read_b128 v[72:75], v4 offset:8192
    v_mfma_f32_16x16x32_bf16 v[36:39], a[140:143], v[80:83], v[36:39]
    ds_read_b128 v[76:79], v4 offset:10240
    v_mfma_f32_16x16x32_bf16 v[44:47], a[140:143], v[84:87], v[44:47]
    s_add_u32 m0, s20, 23808
    v_mfma_f32_16x16x32_bf16 v[40:43], a[136:139], v[84:87], v[40:43]
    buffer_load_dwordx4 v2, s[8:11], s23 offen offset:768 lds
    s_waitcnt lgkmcnt(4)
    v_mfma_f32_16x16x32_bf16 v[32:35], a[144:147], v[88:91], v[32:35]
    ds_read_b128 v[80:83], v5 offset:8192
    v_mfma_f32_16x16x32_bf16 v[36:39], a[148:151], v[88:91], v[36:39]
    ds_read_b128 v[84:87], v5 offset:10240
    v_mfma_f32_16x16x32_bf16 v[44:47], a[148:151], v[92:95], v[44:47]
    v_mfma_f32_16x16x32_bf16 v[40:43], a[144:147], v[92:95], v[40:43]
    s_add_u32 m0, s20, 27776
    s_waitcnt lgkmcnt(4)
    v_mfma_f32_16x16x32_bf16 v[32:35], a[152:155], v[96:99], v[32:35]
    ds_read_b128 v[88:91], v4 offset:12288
    buffer_load_dwordx4 v2, s[8:11], s23 offen offset:896 lds
    v_mfma_f32_16x16x32_bf16 v[36:39], a[156:159], v[96:99], v[36:39]
    ds_read_b128 v[92:95], v4 offset:14336
    s_add_u32 s23, s23, 1024
    v_mfma_f32_16x16x32_bf16 v[44:47], a[156:159], v[100:103], v[44:47]
    s_bitcmp1_b32 s23, 11
    s_cselect_b32 s60, 0xf800, 0
    v_mfma_f32_16x16x32_bf16 v[40:43], a[152:155], v[100:103], v[40:43]
    s_add_u32 s23, s23, s60
    s_waitcnt lgkmcnt(4)
    v_mfma_f32_16x16x32_bf16 v[32:35], a[160:163], v[72:75], v[32:35]
    ds_read_b128 v[96:99], v5 offset:12288
    s_add_u32 s20, s20, 32768
    v_mfma_f32_16x16x32_bf16 v[36:39], a[164:167], v[72:75], v[36:39]
    ds_read_b128 v[100:103], v5 offset:14336
    s_cmp_ge_u32 s20, 163840
    v_mfma_f32_16x16x32_bf16 v[44:47], a[164:167], v[76:79], v[44:47]
    s_cselect_b32 s60, 163840, 0
    s_sub_u32 s20, s20, s60
    v_mfma_f32_16x16x32_bf16 v[40:43], a[160:163], v[76:79], v[40:43]
    s_add_u32 m0, s20, 0
    s_waitcnt lgkmcnt(4)
    v_mfma_f32_16x16x32_bf16 v[32:35], a[168:171], v[80:83], v[32:35]
    ds_read_b128 v[72:75], v4 offset:16384
    buffer_load_dwordx4 v2, s[8:11], s23 offen offset:0 lds
    v_mfma_f32_16x16x32_bf16 v[36:39], a[172:175], v[80:83], v[36:39]
    ds_read_b128 v[76:79], v4 offset:18432
    s_add_u32 m0, s20, 3968
    v_mfma_f32_16x16x32_bf16 v[44:47], a[172:175], v[84:87], v[44:47]
    buffer_load_dwordx4 v2, s[8:11], s23 offen offset:128 lds
    v_mfma_f32_16x16x32_bf16 v[40:43], a[168:171], v[84:87], v[40:43]
    s_waitcnt lgkmcnt(4)
    v_mfma_f32_16x16x32_bf16 v[32:35], a[176:179], v[88:91], v[32:35]
    ds_read_b128 v[80:83], v5 offset:16384
    v_mfma_f32_16x16x32_bf16 v[36:39], a[180:183], v[88:91], v[36:39]
    ds_read_b128 v[84:87], v5 offset:18432
    v_mfma_f32_16x16x32_bf16 v[44:47], a[180:183], v[92:95], v[44:47]
    s_add_u32 m0, s20, 7936
    v_mfma_f32_16x16x32_bf16 v[40:43], a[176:179], v[92:95], v[40:43]
    buffer_load_dwordx4 v2, s[8:11], s23 offen offset:256 lds
    s_waitcnt lgkmcnt(4)
    v_mfma_f32_16x16x32_bf16 v[32:35], a[184:187], v[96:99], v[32:35]
    ds_read_b128 v[88:91], v4 offset:20480
    v_mfma_f32_16x16x32_bf16 v[36:39], a[188:191], v[96:99], v[36:39]
    ds_read_b128 v[92:95], v4 offset:22528
    v_mfma_f32_16x16x32_bf16 v[44:47], a[188:191], v[100:103], v[44:47]
    v_mfma_f32_16x16x32_bf16 v[40:43], a[184:187], v[100:103], v[40:43]
    s_add_u32 m0, s20, 11904
    s_waitcnt lgkmcnt(4)
    v_mfma_f32_16x16x32_bf16 v[32:35], a[192:195], v[72:75], v[32:35]
    ds_read_b128 v[96:99], v5 offset:20480
    buffer_load_dwordx4 v2, s[8:11], s23 offen offset:384 lds
    v_mfma_f32_16x16x32_bf16 v[36:39], a[196:199], v[72:75], v[36:39]
    ds_read_b128 v[100:103], v5 offset:22528
    v_mfma_f32_16x16x32_bf16 v[44:47], a[196:199], v[76:79], v[44:47]
    v_mfma_f32_16x16x32_bf16 v[40:43], a[192:195], v[76:79], v[40:43]
    s_waitcnt lgkmcnt(4)
    v_mfma_f32_16x16x32_bf16 v[32:35], a[200:203], v[80:83], v[32:35]
    ds_read_b128 v[72:75], v4 offset:24576
    s_add_u32 m0, s20, 15872
    v_mfma_f32_16x16x32_bf16 v[36:39], a[204:207], v[80:83], v[36:39]
    ds_read_b128 v[76:79], v4 offset:26624
    buffer_load_dwordx4 v2, s[8:11], s23 offen offset:512 lds
    v_mfma_f32_16x16x32_bf16 v[44:47], a[204:207], v[84:87], v[44:47]
    v_mfma_f32_16x16x32_bf16 v[40:43], a[200:203], v[84:87], v[40:43]
    s_waitcnt lgkmcnt(4)
    v_mfma_f32_16x16x32_bf16 v[32:35], a[208:211], v[88:91], v[32:35]
    ds_read_b128 v[80:83], v5 offset:24576
    v_mfma_f32_16x16x32_bf16 v[36:39], a[212:215], v[88:91], v[36:39]
    ds_read_b128 v[84:87], v5 offset:26624
    s_add_u32 m0, s20, 19840
    v_mfma_f32_16x16x32_bf16 v[44:47], a[212:215], v[92:95], v[44:47]
    buffer_load_dwordx4 v2, s[8:11], s23 offen offset:640 lds
    v_mfma_f32_16x16x32_bf16 v[40:43], a[208:211], v[92:95], v[40:43]
    s_waitcnt lgkmcnt(4)
    v_mfma_f32_16x16x32_bf16 v[32:35], a[216:219], v[96:99], v[32:35]
    ds_read_b128 v[88:91], v4 offset:28672
    v_mfma_f32_16x16x32_bf16 v[36:39], a[220:223], v[96:99], v[36:39]
    ds_read_b128 v[92:95], v4 offset:30720
    v_mfma_f32_16x16x32_bf16 v[44:47], a[220:223], v[100:103], v[44:47]
    v_add_u32 v4, s22, v4
    s_add_u32 m0, s20, 23808
    v_mfma_f32_16x16x32_bf16 v[40:43], a[216:219], v[100:103], v[40:43]
    buffer_load_dwordx4 v2, s[8:11], s23 offen offset:768 lds
    s_waitcnt lgkmcnt(4)
    v_mfma_f32_16x16x32_bf16 v[32:35], a[224:227], v[72:75], v[32:35]
    ds_read_b128 v[96:99], v5 offset:28672
    v_mfma_f32_16x16x32_bf16 v[36:39], a[228:231], v[72:75], v[36:39]
    ds_read_b128 v[100:103], v5 offset:30720
    v_mfma_f32_16x16x32_bf16 v[44:47], a[228:231], v[76:79], v[44:47]
    v_add_u32 v5, s22, v5
    v_mfma_f32_16x16x32_bf16 v[40:43], a[224:227], v[76:79], v[40:43]
    s_add_u32 m0, s20, 27776
    s_waitcnt vmcnt(16)
    s_barrier
    s_waitcnt lgkmcnt(4)
    v_mfma_f32_16x16x32_bf16 v[32:35], a[232:235], v[80:83], v[32:35]
    ds_read_b128 v[72:75], v4 offset:0
    buffer_load_dwordx4 v2, s[8:11], s23 offen offset:896 lds
    v_mfma_f32_16x16x32_bf16 v[36:39], a[236:239], v[80:83], v[36:39]
    ds_read_b128 v[76:79], v4 offset:2048
    s_add_u32 s23, s23, 1024
    v_mfma_f32_16x16x32_bf16 v[44:47], a[236:239], v[84:87], v[44:47]
    s_bitcmp1_b32 s23, 11
    s_cselect_b32 s60, 0xf800, 0
    v_mfma_f32_16x16x32_bf16 v[40:43], a[232:235], v[84:87], v[40:43]
    s_add_u32 s23, s23, s60
    s_waitcnt lgkmcnt(4)
    v_mfma_f32_16x16x32_bf16 v[32:35], a[240:243], v[88:91], v[32:35]
    ds_read_b128 v[80:83], v5 offset:0
    s_add_u32 s20, s20, 32768
    s_cmp_ge_u32 s20, 163840
    v_mfma_f32_16x16x32_bf16 v[36:39], a[244:247], v[88:91], v[36:39]
    ds_read_b128 v[84:87], v5 offset:2048
    s_cselect_b32 s60, 163840, 0
    s_sub_u32 s20, s20, s60
    v_mfma_f32_16x16x32_bf16 v[44:47], a[244:247], v[92:95], v[44:47]
    v_mfma_f32_16x16x32_bf16 v[40:43], a[240:243], v[92:95], v[40:43]
    s_waitcnt lgkmcnt(4)
    v_mfma_f32_16x16x32_bf16 v[48:51], a[248:251], v[96:99], v[32:35]
    ds_read_b128 v[88:91], v4 offset:4096
    s_add_u32 s24, s24, 1
    s_sub_u32 s61, s24, 2
    v_mfma_f32_16x16x32_bf16 v[52:55], a[252:255], v[96:99], v[36:39]
    ds_read_b128 v[92:95], v4 offset:6144
    s_bitcmp1_b64 s[34:35], s61
    v_mfma_f32_16x16x32_bf16 v[60:63], a[252:255], v[100:103], v[44:47]
    v_mfma_f32_16x16x32_bf16 v[56:59], a[248:251], v[100:103], v[40:43]
    s_cbranch_scc0 kvsk
    s_cmp_eq_u32 s24, 64
    s_cbranch_scc1 kvsk_fin
    s_cmp_lg_u32 s58, 0
    s_cbranch_scc1 kvsk
    s_bfm_b64 s[62:63], s61, 0
    s_and_b32 s62, s62, 0x204225f
    s_and_b32 s63, s63, 0x80004004
    s_bcnt1_i32_b64 s60, s[62:63]
    s_lshl_b32 s60, s60, 2
    s_add_u32 s60, s60, 64
    v_mov_b32 v24, s60
    v_mov_b32 v25, 1
    s_mov_b64 exec, 1
    global_atomic_add v24, v25, s[98:99] sc1
    s_mov_b64 exec, -1
    s_branch kvsk
kvsk_early:
    s_waitcnt vmcnt(4)
    s_barrier
    s_cmp_eq_u32 s24, 0
    s_cbranch_scc1 kvsk_mid
    s_cmp_lg_u32 s58, 0
    s_cbranch_scc1 kvsk_mid
    s_lshl_b32 s60, s24, 2
    s_add_u32 s60, s60, 60
    v_mov_b32 v24, s60
    v_mov_b32 v25, 1
    s_mov_b64 exec, 1
    global_atomic_add v24, v25, s[98:99] sc1
    s_mov_b64 exec, -1
    s_branch kvsk_mid
kvsk_fin:
    s_nop 7
    v_cvt_pk_bf16_f32 v64, v48, v49
    v_cvt_pk_bf16_f32 v65, v50, v51
    v_cvt_pk_bf16_f32 v66, v52, v53
    v_cvt_pk_bf16_f32 v67, v54, v55
    v_cvt_pk_bf16_f32 v68, v56, v57
    v_cvt_pk_bf16_f32 v69, v58, v59
    v_cvt_pk_bf16_f32 v70, v60, v61
    v_cvt_pk_bf16_f32 v71, v62, v63
    buffer_store_dwordx4 v[64:67], v1, s[16:19], s25 offen sc1
    buffer_store_dwordx4 v[68:71], v12, s[16:19], s25 offen sc1
    buffer_store_dwordx4 v[28:31], v1, s[16:19], s26 offen sc1
    s_waitcnt vmcnt(0) lgkmcnt(0)
    s_barrier
    s_cmp_lg_u32 s58, 0
    s_cbranch_scc1 L_kve_49
    s_mov_b32 s60, 112
    v_mov_b32 v24, s60
    v_mov_b32 v25, 1
    s_mov_b64 exec, 1
    global_atomic_add v24, v25, s[98:99] sc1
    s_mov_b64 exec, -1
    s_branch L_kve_49
L_kvv_48:
    ds_read_b128 v[72:75], v4 offset:0
    ds_read_b128 v[76:79], v4 offset:2048
    ds_read_b128 v[80:83], v5 offset:0
    ds_read_b128 v[84:87], v5 offset:2048
    ds_read_b128 v[88:91], v4 offset:4096
    ds_read_b128 v[92:95], v4 offset:6144
    s_mov_b32 s34, 0x2042258
    s_mov_b32 s35, 0x40004004
    s_cmp_eq_u32 s58, 0
    s_cselect_b32 s33, s27, 0x400000
    s_mov_b32 s25, 0
    s_mov_b32 s26, 0
kvsv:
    s_waitcnt lgkmcnt(4)
    v_mfma_f32_16x16x32_bf16 v[32:35], v[72:75], a[0:3], 0
    ds_read_b128 v[96:99], v5 offset:4096
    v_mfma_f32_16x16x32_bf16 v[40:43], v[72:75], a[4:7], 0
    ds_read_b128 v[100:103], v5 offset:6144
    v_mfma_f32_16x16x32_bf16 v[44:47], v[76:79], a[4:7], 0
    v_mfma_f32_16x16x32_bf16 v[36:39], v[76:79], a[0:3], 0
    v_cvt_pk_bf16_f32 v64, v48, v49
    s_waitcnt lgkmcnt(4)
    v_mfma_f32_16x16x32_bf16 v[32:35], v[80:83], a[8:11], v[32:35]
    ds_read_b128 v[72:75], v4 offset:8192
    v_cvt_pk_bf16_f32 v65, v50, v51
    v_mfma_f32_16x16x32_bf16 v[40:43], v[80:83], a[12:15], v[40:43]
    ds_read_b128 v[76:79], v4 offset:10240
    v_cvt_pk_bf16_f32 v66, v52, v53
    v_mfma_f32_16x16x32_bf16 v[44:47], v[84:87], a[12:15], v[44:47]
    v_cvt_pk_bf16_f32 v67, v54, v55
    v_cvt_pk_bf16_f32 v68, v56, v57
    v_mfma_f32_16x16x32_bf16 v[36:39], v[84:87], a[8:11], v[36:39]
    v_cvt_pk_bf16_f32 v69, v58, v59
    s_waitcnt lgkmcnt(4)
    v_mfma_f32_16x16x32_bf16 v[32:35], v[88:91], a[16:19], v[32:35]
    ds_read_b128 v[80:83], v5 offset:8192
    v_cvt_pk_bf16_f32 v70, v60, v61
    v_mfma_f32_16x16x32_bf16 v[40:43], v[88:91], a[20:23], v[40:43]
    ds_read_b128 v[84:87], v5 offset:10240
    v_cvt_pk_bf16_f32 v71, v62, v63
    v_mfma_f32_16x16x32_bf16 v[44:47], v[92:95], a[20:23], v[44:47]
    buffer_store_dwordx4 v[64:67], v1, s[16:19], s25 offen sc1
    v_mfma_f32_16x16x32_bf16 v[36:39], v[92:95], a[16:19], v[36:39]
    buffer_store_dwordx4 v[68:71], v1, s[16:19], s25 offen offset:1024 sc1
    s_waitcnt lgkmcnt(4)
    v_mfma_f32_16x16x32_bf16 v[32:35], v[96:99], a[24:27], v[32:35]
    ds_read_b128 v[88:91], v4 offset:12288
    buffer_store_dwordx4 v[28:31], v1, s[16:19], s26 offen sc1
    v_mfma_f32_16x16x32_bf16 v[40:43], v[96:99], a[28:31], v[40:43]
    ds_read_b128 v[92:95], v4 offset:14336
    v_mfma_f32_16x16x32_bf16 v[44:47], v[100:103], a[28:31], v[44:47]
    v_mfma_f32_16x16x32_bf16 v[36:39], v[100:103], a[24:27], v[36:39]
    buffer_load_dword v13, v10, s[8:11], s33 offen nt
    s_waitcnt lgkmcnt(4)
    v_mfma_f32_16x16x32_bf16 v[32:35], v[72:75], a[32:35], v[32:35]
    ds_read_b128 v[96:99], v5 offset:12288
    v_mfma_f32_16x16x32_bf16 v[40:43], v[72:75], a[36:39], v[40:43]
    ds_read_b128 v[100:103], v5 offset:14336
    v_mfma_f32_16x16x32_bf16 v[44:47], v[76:79], a[36:39], v[44:47]
    s_mov_b32 s18, 0xa000000
    s_lshl_b32 s25, s24, 21
    v_mfma_f32_16x16x32_bf16 v[36:39], v[76:79], a[32:35], v[36:39]
    s_lshl_b32 s62, s24, 13
    s_waitcnt lgkmcnt(4)
    v_mfma_f32_16x16x32_bf16 v[32:35], v[80:83], a[40:43], v[32:35]
    ds_read_b128 v[72:75], v4 offset:16384
    s_and_b32 s62, s62, 0x2000
    v_mfma_f32_16x16x32_bf16 v[40:43], v[80:83], a[44:47], v[40:43]
    ds_read_b128 v[76:79], v4 offset:18432
    s_xor_b32 s62, s62, s30
    v_mfma_f32_16x16x32_bf16 v[44:47], v[84:87], a[44:47], v[44:47]
    s_add_u32 s25, s25, s62
    s_lshl_b32 s26, s24, 19
    v_mfma_f32_16x16x32_bf16 v[36:39], v[84:87], a[40:43], v[36:39]
    s_lshl_b32 s62, s24, 11
    s_waitcnt lgkmcnt(4)
    v_mfma_f32_16x16x32_bf16 v[32:35], v[88:91], a[48:51], v[32:35]
    ds_read_b128 v[80:83], v5 offset:16384
    s_and_b32 s62, s62, 0x2000
    v_mfma_f32_16x16x32_bf16 v[40:43], v[88:91], a[52:55], v[40:43]
    ds_read_b128 v[84:87], v5 offset:18432
    s_xor_b32 s62, s62, s31
    v_mfma_f32_16x16x32_bf16 v[44:47], v[92:95], a[52:55], v[44:47]
    s_add_u32 s26, s26, s62
    s_cmp_ge_u32 s21, 131072
    v_mfma_f32_16x16x32_bf16 v[36:39], v[92:95], a[48:51], v[36:39]
    s_cselect_b32 s22, 0xfffe0000, s29
    s_waitcnt lgkmcnt(4)
    v_mfma_f32_16x16x32_bf16 v[32:35], v[96:99], a[56:59], v[32:35]
    ds_read_b128 v[88:91], v4 offset:20480
    s_add_u32 s21, s21, s22
    v_mfma_f32_16x16x32_bf16 v[40:43], v[96:99], a[60:63], v[40:43]
    ds_read_b128 v[92:95], v4 offset:22528
    s_add_u32 s27, s27, 0x10000
    v_mfma_f32_16x16x32_bf16 v[44:47], v[100:103], a[60:63], v[44:47]
    s_andn2_b32 s61, 3, s24
    s_or_b32 s61, s61, s58
    v_mfma_f32_16x16x32_bf16 v[36:39], v[100:103], a[56:59], v[36:39]
    s_cselect_b32 s33, 0x400000, s27
    s_waitcnt lgkmcnt(4)
    v_mfma_f32_16x16x32_bf16 v[32:35], v[72:75], a[64:67], v[32:35]
    ds_read_b128 v[96:99], v5 offset:20480
    s_cmp_lt_u32 s24, 4
    v_mfma_f32_16x16x32_bf16 v[40:43], v[72:75], a[68:71], v[40:43]
    ds_read_b128 v[100:103], v5 offset:22528
    s_cselect_b64 vcc, -1, 0
    v_mfma_f32_16x16x32_bf16 v[44:47], v[76:79], a[68:71], v[44:47]
    v_mfma_f32_16x16x32_bf16 v[36:39], v[76:79], a[64:67], v[36:39]
    s_waitcnt lgkmcnt(4)
    v_mfma_f32_16x16x32_bf16 v[32:35], v[80:83], a[72:75], v[32:35]
    ds_read_b128 v[72:75], v4 offset:24576
    v_mfma_f32_16x16x32_bf16 v[40:43], v[80:83], a[76:79], v[40:43]
    ds_read_b128 v[76:79], v4 offset:26624
    v_mfma_f32_16x16x32_bf16 v[44:47], v[84:87], a[76:79], v[44:47]
    v_mfma_f32_16x16x32_bf16 v[36:39], v[84:87], a[72:75], v[36:39]
    s_waitcnt lgkmcnt(4)
    v_mfma_f32_16x16x32_bf16 v[32:35], v[88:91], a[80:83], v[32:35]
    ds_read_b128 v[80:83], v5 offset:24576
    s_add_u32 m0, s20, 0
    v_mfma_f32_16x16x32_bf16 v[40:43], v[88:91], a[84:87], v[40:43]
    ds_read_b128 v[84:87], v5 offset:26624
    buffer_load_dwordx4 v2, s[8:11], s23 offen offset:0 lds
    v_mfma_f32_16x16x32_bf16 v[44:47], v[92:95], a[84:87], v[44:47]
    v_mfma_f32_16x16x32_bf16 v[36:39], v[92:95], a[80:83], v[36:39]
    s_waitcnt lgkmcnt(4)
    v_mfma_f32_16x16x32_bf16 v[32:35], v[96:99], a[88:91], v[32:35]
    ds_read_b128 v[88:91], v4 offset:28672
    v_mfma_f32_16x16x32_bf16 v[40:43], v[96:99], a[92:95], v[40:43]
    ds_read_b128 v[92:95], v4 offset:30720
    s_add_u32 m0, s20, 3968
    v_mfma_f32_16x16x32_bf16 v[44:47], v[100:103], a[92:95], v[44:47]
    buffer_load_dwordx4 v2, s[8:11], s23 offen offset:128 lds
    v_mfma_f32_16x16x32_bf16 v[36:39], v[100:103], a[88:91], v[36:39]
    v_add_u32 v4, s22, v4
    s_waitcnt lgkmcnt(4)
    v_mfma_f32_16x16x32_bf16 v[32:35], v[72:75], a[96:99], v[32:35]
    ds_read_b128 v[96:99], v5 offset:28672
    v_mfma_f32_16x16x32_bf16 v[40:43], v[72:75], a[100:103], v[40:43]
    ds_read_b128 v[100:103], v5 offset:30720
    v_mfma_f32_16x16x32_bf16 v[44:47], v[76:79], a[100:103], v[44:47]
    v_add_u32 v5, s22, v5
    s_add_u32 m0, s20, 7936
    v_mfma_f32_16x16x32_bf16 v[36:39], v[76:79], a[96:99], v[36:39]
    buffer_load_dwordx4 v2, s[8:11], s23 offen offset:256 lds
    s_waitcnt vmcnt(15)
    s_cbranch_vccnz kvsv_early
    s_barrier
kvsv_mid:
    s_waitcnt lgkmcnt(4)
    v_mfma_f32_16x16x32_bf16 v[32:35], v[80:83], a[104:107], v[32:35]
    ds_read_b128 v[72:75], v4 offset:0
    v_mfma_f32_16x16x32_bf16 v[40:43], v[80:83], a[108:111], v[40:43]
    ds_read_b128 v[76:79], v4 offset:2048
    v_mfma_f32_16x16x32_bf16 v[44:47], v[84:87], a[108:111], v[44:47]
    v_mfma_f32_16x16x32_bf16 v[36:39], v[84:87], a[104:107], v[36:39]
    s_add_u32 m0, s20, 11904
    s_waitcnt lgkmcnt(4)
    v_mfma_f32_16x16x32_bf16 v[32:35], v[88:91], a[112:115], v[32:35]
    ds_read_b128 v[80:83], v5 offset:0
    buffer_load_dwordx4 v2, s[8:11], s23 offen offset:384 lds
    v_mfma_f32_16x16x32_bf16 v[40:43], v[88:91], a[116:119], v[40:43]
    ds_read_b128 v[84:87], v5 offset:2048
    v_mfma_f32_16x16x32_bf16 v[44:47], v[92:95], a[116:119], v[44:47]
    v_mfma_f32_16x16x32_bf16 v[36:39], v[92:95], a[112:115], v[36:39]
    s_waitcnt lgkmcnt(4)
    v_mfma_f32_16x16x32_bf16 v[32:35], v[96:99], a[120:123], v[32:35]
    ds_read_b128 v[88:91], v4 offset:4096
    s_add_u32 m0, s20, 15872
    v_mfma_f32_16x16x32_bf16 v[40:43], v[96:99], a[124:127], v[40:43]
    ds_read_b128 v[92:95], v4 offset:6144
    buffer_load_dwordx4 v2, s[8:11], s23 offen offset:512 lds
    v_mfma_f32_16x16x32_bf16 v[44:47], v[100:103], a[124:127], v[44:47]
    s_cmp_ge_u32 s21, 131072
    s_cselect_b32 s22, 0xfffe0000, s29
    v_mfma_f32_16x16x32_bf16 v[36:39], v[100:103], a[120:123], v[36:39]
    s_add_u32 s21, s21, s22
    s_waitcnt lgkmcnt(4)
    v_mfma_f32_16x16x32_bf16 v[32:35], v[72:75], a[128:131], v[32:35]
    ds_read_b128 v[96:99], v5 offset:4096
    v_mfma_f32_16x16x32_bf16 v[40:43], v[72:75], a[132:135], v[40:43]
    ds_read_b128 v[100:103], v5 offset:6144
    s_add_u32 m0, s20, 19840
    v_mfma_f32_16x16x32_bf16 v[44:47], v[76:79], a[132:135], v[44:47]
    buffer_load_dwordx4 v2, s[8:11], s23 offen offset:640 lds
    v_mfma_f32_16x16x32_bf16 v[36:39], v[76:79], a[128:131], v[36:39]
    s_waitcnt lgkmcnt(4)
    v_mfma_f32_16x16x32_bf16 v[32:35], v[80:83], a[136:139], v[32:35]
    ds_read_b128 v[72:75], v4 offset:8192
    v_mfma_f32_16x16x32_bf16 v[40:43], v[80:83], a[140:143], v[40:43]
    ds_read_b128 v[76:79], v4 offset:10240
    v_mfma_f32_16x16x32_bf16 v[44:47], v[84:87], a[140:143], v[44:47]
    s_add_u32 m0, s20, 23808
    v_mfma_f32_16x16x32_bf16 v[36:39], v[84:87], a[136:139], v[36:39]
    buffer_load_dwordx4 v2, s[8:11], s23 offen offset:768 lds
    s_waitcnt lgkmcnt(4)
    v_mfma_f32_16x16x32_bf16 v[32:35], v[88:91], a[144:147], v[32:35]
    ds_read_b128 v[80:83], v5 offset:8192
    v_mfma_f32_16x16x32_bf16 v[40:43], v[88:91], a[148:151], v[40:43]
    ds_read_b128 v[84:87], v5 offset:10240
    v_mfma_f32_16x16x32_bf16 v[44:47], v[92:95], a[148:151], v[44:47]
    v_mfma_f32_16x16x32_bf16 v[36:39], v[92:95], a[144:147], v[36:39]
    s_add_u32 m0, s20, 27776
    s_waitcnt lgkmcnt(4)
    v_mfma_f32_16x16x32_bf16 v[32:35], v[96:99], a[152:155], v[32:35]
    ds_read_b128 v[88:91], v4 offset:12288
    buffer_load_dwordx4 v2, s[8:11], s23 offen offset:896 lds
    v_mfma_f32_16x16x32_bf16 v[40:43], v[96:99], a[156:159], v[40:43]
    ds_read_b128 v[92:95], v4 offset:14336
    s_add_u32 s23, s23, 1024
    v_mfma_f32_16x16x32_bf16 v[44:47], v[100:103], a[156:159], v[44:47]
    s_bitcmp1_b32 s23, 11
    s_cselect_b32 s60, 0xf800, 0
    v_mfma_f32_16x16x32_bf16 v[36:39], v[100:103], a[152:155], v[36:39]
    s_add_u32 s23, s23, s60
    s_waitcnt lgkmcnt(4)
    v_mfma_f32_16x16x32_bf16 v[32:35], v[72:75], a[160:163], v[32:35]
    ds_read_b128 v[96:99], v5 offset:12288
    s_add_u32 s20, s20, 32768
    v_mfma_f32_16x16x32_bf16 v[40:43], v[72:75], a[164:167], v[40:43]
    ds_read_b128 v[100:103], v5 offset:14336
    s_cmp_ge_u32 s20, 163840
    v_mfma_f32_16x16x32_bf16 v[44:47], v[76:79], a[164:167], v[44:47]
    s_cselect_b32 s60, 163840, 0
    s_sub_u32 s20, s20, s60
    v_mfma_f32_16x16x32_bf16 v[36:39], v[76:79], a[160:163], v[36:39]
    s_add_u32 m0, s20, 0
    s_waitcnt lgkmcnt(4)
    v_mfma_f32_16x16x32_bf16 v[32:35], v[80:83], a[168:171], v[32:35]
    ds_read_b128 v[72:75], v4 offset:16384
    buffer_load_dwordx4 v2, s[8:11], s23 offen offset:0 lds
    v_mfma_f32_16x16x32_bf16 v[40:43], v[80:83], a[172:175], v[40:43]
    ds_read_b128 v[76:79], v4 offset:18432
    s_add_u32 m0, s20, 3968
    v_mfma_f32_16x16x32_bf16 v[44:47], v[84:87], a[172:175], v[44:47]
    buffer_load_dwordx4 v2, s[8:11], s23 offen offset:128 lds
    v_mfma_f32_16x16x32_bf16 v[36:39], v[84:87], a[168:171], v[36:39]
    s_waitcnt lgkmcnt(4)
    v_mfma_f32_16x16x32_bf16 v[32:35], v[88:91], a[176:179], v[32:35]
    ds_read_b128 v[80:83], v5 offset:16384
    v_mfma_f32_16x16x32_bf16 v[40:43], v[88:91], a[180:183], v[40:43]
    ds_read_b128 v[84:87], v5 offset:18432
    v_mfma_f32_16x16x32_bf16 v[44:47], v[92:95], a[180:183], v[44:47]
    s_add_u32 m0, s20, 7936
    v_mfma_f32_16x16x32_bf16 v[36:39], v[92:95], a[176:179], v[36:39]
    buffer_load_dwordx4 v2, s[8:11], s23 offen offset:256 lds
    s_waitcnt lgkmcnt(4)
    v_mfma_f32_16x16x32_bf16 v[32:35], v[96:99], a[184:187], v[32:35]
    ds_read_b128 v[88:91], v4 offset:20480
    v_mfma_f32_16x16x32_bf16 v[40:43], v[96:99], a[188:191], v[40:43]
    ds_read_b128 v[92:95], v4 offset:22528
    v_mfma_f32_16x16x32_bf16 v[44:47], v[100:103], a[188:191], v[44:47]
    v_mfma_f32_16x16x32_bf16 v[36:39], v[100:103], a[184:187], v[36:39]
    s_add_u32 m0, s20, 11904
    s_waitcnt lgkmcnt(4)
    v_mfma_f32_16x16x32_bf16 v[32:35], v[72:75], a[192:195], v[32:35]
    ds_read_b128 v[96:99], v5 offset:20480
    buffer_load_dwordx4 v2, s[8:11], s23 offen offset:384 lds
    v_mfma_f32_16x16x32_bf16 v[40:43], v[72:75], a[196:199], v[40:43]
    ds_read_b128 v[100:103], v5 offset:22528
    v_mfma_f32_16x16x32_bf16 v[44:47], v[76:79], a[196:199], v[44:47]
    v_mfma_f32_16x16x32_bf16 v[36:39], v[76:79], a[192:195], v[36:39]
    s_waitcnt lgkmcnt(4)
    v_mfma_f32_16x16x32_bf16 v[32:35], v[80:83], a[200:203], v[32:35]
    ds_read_b128 v[72:75], v4 offset:24576
    s_add_u32 m0, s20, 15872
    v_mfma_f32_16x16x32_bf16 v[40:43], v[80:83], a[204:207], v[40:43]
    ds_read_b128 v[76:79], v4 offset:26624
    buffer_load_dwordx4 v2, s[8:11], s23 offen offset:512 lds
    v_mfma_f32_16x16x32_bf16 v[44:47], v[84:87], a[204:207], v[44:47]
    v_mfma_f32_16x16x32_bf16 v[36:39], v[84:87], a[200:203], v[36:39]
    s_waitcnt lgkmcnt(4)
    v_mfma_f32_16x16x32_bf16 v[32:35], v[88:91], a[208:211], v[32:35]
    ds_read_b128 v[80:83], v5 offset:24576
    v_mfma_f32_16x16x32_bf16 v[40:43], v[88:91], a[212:215], v[40:43]
    ds_read_b128 v[84:87], v5 offset:26624
    s_add_u32 m0, s20, 19840
    v_mfma_f32_16x16x32_bf16 v[44:47], v[92:95], a[212:215], v[44:47]
    buffer_load_dwordx4 v2, s[8:11], s23 offen offset:640 lds
    v_mfma_f32_16x16x32_bf16 v[36:39], v[92:95], a[208:211], v[36:39]
    s_waitcnt lgkmcnt(4)
    v_mfma_f32_16x16x32_bf16 v[32:35], v[96:99], a[216:219], v[32:35]
    ds_read_b128 v[88:91], v4 offset:28672
    v_mfma_f32_16x16x32_bf16 v[40:43], v[96:99], a[220:223], v[40:43]
    ds_read_b128 v[92:95], v4 offset:30720
    v_mfma_f32_16x16x32_bf16 v[44:47], v[100:103], a[220:223], v[44:47]
    v_add_u32 v4, s22, v4
    s_add_u32 m0, s20, 23808
    v_mfma_f32_16x16x32_bf16 v[36:39], v[100:103], a[216:219], v[36:39]
    buffer_load_dwordx4 v2, s[8:11], s23 offen offset:768 lds
    s_waitcnt lgkmcnt(4)
    v_mfma_f32_16x16x32_bf16 v[32:35], v[72:75], a[224:227], v[32:35]
    ds_read_b128 v[96:99], v5 offset:28672
    v_mfma_f32_16x16x32_bf16 v[40:43], v[72:75], a[228:231], v[40:43]
    ds_read_b128 v[100:103], v5 offset:30720
    v_mfma_f32_16x16x32_bf16 v[44:47], v[76:79], a[228:231], v[44:47]
    v_add_u32 v5, s22, v5
    v_mfma_f32_16x16x32_bf16 v[36:39], v[76:79], a[224:227], v[36:39]
    s_add_u32 m0, s20, 27776
    s_waitcnt vmcnt(16)
    s_barrier
    s_waitcnt lgkmcnt(4)
    v_mfma_f32_16x16x32_bf16 v[32:35], v[80:83], a[232:235], v[32:35]
    ds_read_b128 v[72:75], v4 offset:0
    buffer_load_dwordx4 v2, s[8:11], s23 offen offset:896 lds
    v_mfma_f32_16x16x32_bf16 v[40:43], v[80:83], a[236:239], v[40:43]
    ds_read_b128 v[76:79], v4 offset:2048
    s_add_u32 s23, s23, 1024
    v_mfma_f32_16x16x32_bf16 v[44:47], v[84:87], a[236:239], v[44:47]
    s_bitcmp1_b32 s23, 11
    s_cselect_b32 s60, 0xf800, 0
    v_mfma_f32_16x16x32_bf16 v[36:39], v[84:87], a[232:235], v[36:39]
    s_add_u32 s23, s23, s60
    s_waitcnt lgkmcnt(4)
    v_mfma_f32_16x16x32_bf16 v[32:35], v[88:91], a[240:243], v[32:35]
    ds_read_b128 v[80:83], v5 offset:0
    s_add_u32 s20, s20, 32768
    s_cmp_ge_u32 s20, 163840
    v_mfma_f32_16x16x32_bf16 v[40:43], v[88:91], a[244:247], v[40:43]
    ds_read_b128 v[84:87], v5 offset:2048
    s_cselect_b32 s60, 163840, 0
    s_sub_u32 s20, s20, s60
    v_mfma_f32_16x16x32_bf16 v[44:47], v[92:95], a[244:247], v[44:47]
    v_mfma_f32_16x16x32_bf16 v[36:39], v[92:95], a[240:243], v[36:39]
    s_waitcnt lgkmcnt(4)
    v_mfma_f32_16x16x32_bf16 v[48:51], v[96:99], a[248:251], v[32:35]
    ds_read_b128 v[88:91], v4 offset:4096
    s_add_u32 s24, s24, 1
    s_sub_u32 s61, s24, 2
    v_mfma_f32_16x16x32_bf16 v[56:59], v[96:99], a[252:255], v[40:43]
    ds_read_b128 v[92:95], v4 offset:6144
    s_bitcmp1_b64 s[34:35], s61
    v_mfma_f32_16x16x32_bf16 v[60:63], v[100:103], a[252:255], v[44:47]
    v_mfma_f32_16x16x32_bf16 v[52:55], v[100:103], a[248:251], v[36:39]
    s_cbranch_scc0 kvsv
    s_cmp_eq_u32 s24, 64
    s_cbranch_scc1 kvsv_fin
    s_cmp_lg_u32 s58, 0
    s_cbranch_scc1 kvsv
    s_bfm_b64 s[62:63], s61, 0
    s_and_b32 s62, s62, 0x204225f
    s_and_b32 s63, s63, 0x80004004
    s_bcnt1_i32_b64 s60, s[62:63]
    s_lshl_b32 s60, s60, 2
    s_add_u32 s60, s60, 64
    v_mov_b32 v24, s60
    v_mov_b32 v25, 1
    s_mov_b64 exec, 1
    global_atomic_add v24, v25, s[98:99] sc1
    s_mov_b64 exec, -1
    s_branch kvsv
kvsv_early:
    s_waitcnt vmcnt(4)
    s_barrier
    s_cmp_eq_u32 s24, 0
    s_cbranch_scc1 kvsv_mid
    s_cmp_lg_u32 s58, 0
    s_cbranch_scc1 kvsv_mid
    s_lshl_b32 s60, s24, 2
    s_add_u32 s60, s60, 60
    v_mov_b32 v24, s60
    v_mov_b32 v25, 1
    s_mov_b64 exec, 1
    global_atomic_add v24, v25, s[98:99] sc1
    s_mov_b64 exec, -1
    s_branch kvsv_mid
kvsv_fin:
    s_nop 7
    v_cvt_pk_bf16_f32 v64, v48, v49
    v_cvt_pk_bf16_f32 v65, v50, v51
    v_cvt_pk_bf16_f32 v66, v52, v53
    v_cvt_pk_bf16_f32 v67, v54, v55
    v_cvt_pk_bf16_f32 v68, v56, v57
    v_cvt_pk_bf16_f32 v69, v58, v59
    v_cvt_pk_bf16_f32 v70, v60, v61
    v_cvt_pk_bf16_f32 v71, v62, v63
    buffer_store_dwordx4 v[64:67], v1, s[16:19], s25 offen sc1
    buffer_store_dwordx4 v[68:71], v1, s[16:19], s25 offen offset:1024 sc1
    buffer_store_dwordx4 v[28:31], v1, s[16:19], s26 offen sc1
    s_waitcnt vmcnt(0) lgkmcnt(0)
    s_barrier
    s_cmp_lg_u32 s58, 0
    s_cbranch_scc1 L_kve_49
    s_mov_b32 s60, 112
    v_mov_b32 v24, s60
    v_mov_b32 v25, 1
    s_mov_b64 exec, 1
    global_atomic_add v24, v25, s[98:99] sc1
    s_mov_b64 exec, -1
    s_branch L_kve_49
L_kve_49:
    s_branch chain_kernel_seg
L_big_41:
    v_and_b32 v24, 63, v0
    v_lshlrev_b32 v1, 4, v24
    v_mov_b32 v2, v1
    v_add_u32 v3, 1024, v1
    v_bfe_u32 v24, v0, 1, 3
    v_bfe_u32 v25, v0, 4, 2
    v_xor_b32 v24, v24, v25
    v_lshlrev_b32 v24, 4, v24
    v_and_b32 v25, 15, v0
    v_lshl_add_u32 v24, v25, 7, v24
    s_lshr_b32 s60, s58, 1
    s_lshl_b32 s60, s60, 14
    v_add_u32 v23, s60, v24
    s_and_b32 s60, s58, 1
    s_lshl_b32 s60, s60, 14
    s_add_u32 s60, s60, 32768
    v_add_u32 v12, s60, v24
    v_xor_b32 v13, 64, v12
    v_bfe_u32 v24, v0, 2, 3
    v_lshlrev_b32 v22, 5, v24
    v_and_b32 v24, 3, v0
    v_lshl_add_u32 v22, v24, 3, v22
    v_bfe_u32 v24, v0, 2, 2
    v_lshl_add_u32 v22, v24, 9, v22
    v_bfe_u32 v24, v0, 4, 2
    v_lshl_add_u32 v22, v24, 12, v22
    v_bfe_u32 v24, v0, 7, 1
    v_lshl_add_u32 v22, v24, 8, v22
    s_mov_b32 s49, 0
    s_mov_b32 s48, 32768
    s_lshl_b32 s45, s58, 12
    s_add_u32 s44, s45, 32768
    s_mov_b32 s11, 0x00020000
    s_mov_b32 s15, 0x00020000
    s_mov_b32 s19, 0x00020000
    s_and_b32 s82, s57, 3
    s_lshr_b32 s85, s57, 2
    s_mov_b32 s84, s82
    s_lshl_b32 s94, s85, 0
    s_lshl_b32 s60, s85, 19
    s_mov_b32 s30, s64
    s_and_b32 s31, s65, 0xffff
    s_mov_b32 s32, 0x400000
    s_mov_b32 s33, s60
    s_mov_b32 s34, 0x2000
    s_mov_b32 s35, 0x40000
    s_lshl_b32 s60, s82, 18
    s_mov_b32 s36, s70
    s_and_b32 s37, s71, 0xffff
    s_mov_b32 s38, 0x200000
    s_mov_b32 s39, s60
    s_mov_b32 s40, 0x8000
    s_mov_b32 s41, 0x20000
    s_mov_b32 s42, 0x80
    s_cmp_ge_u32 s58, 2
    s_cselect_b32 s36, s72, s70
    s_cselect_b32 s37, s73, s71
    s_and_b32 s37, s37, 0xffff
    v_bfe_u32 v24, v0, 4, 2
    v_and_b32 v25, 7, v0
    v_xor_b32 v24, v24, v25
    v_lshlrev_b32 v8, 4, v24
    v_bfe_u32 v24, v0, 3, 2
    v_lshl_add_u32 v8, v24, 11, v8
    v_bfe_u32 v24, v0, 5, 1
    v_lshl_add_u32 v8, v24, 16, v8
    v_lshrrev_b32 v24, 6, v0
    v_lshl_add_u32 v8, v24, 14, v8
    v_xor_b32 v9, 64, v8
    v_add_u32 v9, 0x20000, v9
    v_bfe_u32 v24, v0, 4, 2
    v_and_b32 v25, 7, v0
    v_xor_b32 v24, v24, v25
    v_lshlrev_b32 v10, 4, v24
    v_bfe_u32 v24, v0, 3, 3
    v_lshl_add_u32 v10, v24, 11, v10
    v_bfe_u32 v24, v0, 6, 1
    v_lshl_add_u32 v10, v24, 16, v10
    v_xor_b32 v11, 64, v10
    v_add_u32 v11, 0x4000, v11
    v_and_b32 v24, 15, v0
    v_bfe_u32 v25, v0, 7, 1
    v_lshl_add_u32 v24, v25, 6, v24
    v_lshlrev_b32 v24, 1, v24
    s_lshl_b32 s53, s82, 8
    s_mov_b32 s60, s66
    s_and_b32 s61, s67, 0xffff
    s_mov_b32 s62, 0x800
    s_mov_b32 s63, 0x00020000
    buffer_load_ushort v192, v24, s[60:63], s53 offen offset:0
    buffer_load_ushort v200, v24, s[60:63], s53 offen offset:32
    buffer_load_ushort v208, v24, s[60:63], s53 offen offset:64
    buffer_load_ushort v216, v24, s[60:63], s53 offen offset:96
    s_mov_b32 s60, s68
    s_and_b32 s61, s69, 0xffff
    s_mov_b32 s62, 0x800
    s_mov_b32 s63, 0x00020000
    buffer_load_ushort v193, v24, s[60:63], s53 offen offset:0
    buffer_load_ushort v201, v24, s[60:63], s53 offen offset:32
    buffer_load_ushort v209, v24, s[60:63], s53 offen offset:64
    buffer_load_ushort v217, v24, s[60:63], s53 offen offset:96
    s_mov_b32 s60, s78
    s_and_b32 s61, s79, 0xffff
    s_mov_b32 s62, 0x800
    s_mov_b32 s63, 0x00020000
    buffer_load_ushort v194, v24, s[60:63], s53 offen offset:0
    buffer_load_ushort v202, v24, s[60:63], s53 offen offset:32
    buffer_load_ushort v210, v24, s[60:63], s53 offen offset:64
    buffer_load_ushort v218, v24, s[60:63], s53 offen offset:96
    s_mov_b32 s6, 0xfffe8000
    s_mov_b32 s7, 65536
    s_mov_b32 s12, s36
    s_mov_b32 s13, s37
    s_mov_b32 s14, s38
    s_and_b32 s45, s45, 0xffffb7ff
    s_bitcmp1_b32 s94, 1
    s_cselect_b32 s24, s41, 0
    s_cselect_b32 s26, 0, s41
    s_cselect_b32 s60, 0x4000, 0
    s_or_b32 s45, s45, s60
    s_add_u32 s24, s24, s39
    s_add_u32 s26, s26, s39
    s_bitcmp1_b32 s94, 0
    s_cselect_b32 s61, s40, 0
    s_cselect_b32 s62, 0, s40
    s_cselect_b32 s60, 0x800, 0
    s_or_b32 s45, s45, s60
    s_add_u32 s25, s24, s62
    s_add_u32 s24, s24, s61
    s_add_u32 s27, s26, s62
    s_add_u32 s26, s26, s61
    s_mov_b32 s28, s42
    v_mov_b32 v6, v10
    v_mov_b32 v7, v11
    s_mov_b32 s8, s30
    s_mov_b32 s9, s31
    s_mov_b32 s10, s32
    s_and_b32 s44, s44, 0xffffb7ff
    s_bitcmp1_b32 s84, 1
    s_cselect_b32 s20, s35, 0
    s_cselect_b32 s22, 0, s35
    s_cselect_b32 s60, 0x4000, 0
    s_or_b32 s44, s44, s60
    s_add_u32 s20, s20, s33
    s_add_u32 s22, s22, s33
    s_bitcmp1_b32 s84, 0
    s_cselect_b32 s61, s34, 0
    s_cselect_b32 s62, 0, s34
    s_cselect_b32 s60, 0x800, 0
    s_or_b32 s44, s44, s60
    s_add_u32 s21, s20, s62
    s_add_u32 s20, s20, s61
    s_add_u32 s23, s22, s62
    s_add_u32 s22, s22, s61
    v_mov_b32 v4, v8
    v_mov_b32 v5, v9
    s_xor_b32 m0, s45, 0
    s_nop 0
    buffer_load_dwordx4 v6, s[12:15], s24 offen lds
    s_xor_b32 m0, s45, 1024
    s_nop 0
    buffer_load_dwordx4 v7, s[12:15], s24 offen lds
    s_xor_b32 m0, s45, 2048
    s_nop 0
    buffer_load_dwordx4 v6, s[12:15], s25 offen lds
    s_xor_b32 m0, s45, 3072
    s_nop 0
    buffer_load_dwordx4 v7, s[12:15], s25 offen lds
    s_xor_b32 m0, s45, 16384
    s_nop 0
    buffer_load_dwordx4 v6, s[12:15], s26 offen lds
    s_xor_b32 m0, s45, 17408
    s_nop 0
    buffer_load_dwordx4 v7, s[12:15], s26 offen lds
    s_xor_b32 m0, s45, 18432
    s_nop 0
    buffer_load_dwordx4 v6, s[12:15], s27 offen lds
    s_xor_b32 m0, s45, 19456
    s_nop 0
    buffer_load_dwordx4 v7, s[12:15], s27 offen lds
    s_add_u32 s24, s24, s28
    s_add_u32 s25, s25, s28
    s_add_u32 s26, s26, s28
    s_add_u32 s27, s27, s28
    s_cmp_ge_u32 s45, 98304
    s_cselect_b32 s60, s6, s7
    s_add_u32 s45, s45, s60
    s_xor_b32 m0, s44, 0
    s_nop 0
    buffer_load_dwordx4 v4, s[8:11], s20 offen lds
    s_xor_b32 m0, s44, 1024
    s_nop 0
    buffer_load_dwordx4 v5, s[8:11], s20 offen lds
    s_xor_b32 m0, s44, 2048
    s_nop 0
    buffer_load_dwordx4 v4, s[8:11], s21 offen lds
    s_xor_b32 m0, s44, 3072
    s_nop 0
    buffer_load_dwordx4 v5, s[8:11], s21 offen lds
    s_xor_b32 m0, s44, 16384
    s_nop 0
    buffer_load_dwordx4 v4, s[8:11], s22 offen lds
    s_xor_b32 m0, s44, 17408
    s_nop 0
    buffer_load_dwordx4 v5, s[8:11], s22 offen lds
    s_xor_b32 m0, s44, 18432
    s_nop 0
    buffer_load_dwordx4 v4, s[8:11], s23 offen lds
    s_xor_b32 m0, s44, 19456
    s_nop 0
    buffer_load_dwordx4 v5, s[8:11], s23 offen lds
    s_add_u32 s20, s20, 128
    s_add_u32 s21, s21, 128
    s_add_u32 s22, s22, 128
    s_add_u32 s23, s23, 128
    s_cmp_ge_u32 s44, 98304
    s_cselect_b32 s60, s6, s7
    s_add_u32 s44, s44, s60
    s_xor_b32 m0, s45, 0
    s_nop 0
    buffer_load_dwordx4 v6, s[12:15], s24 offen lds
    s_xor_b32 m0, s45, 1024
    s_nop 0
    buffer_load_dwordx4 v7, s[12:15], s24 offen lds
    s_xor_b32 m0, s45, 2048
    s_nop 0
    buffer_load_dwordx4 v6, s[12:15], s25 offen lds
    s_xor_b32 m0, s45, 3072
    s_nop 0
    buffer_load_dwordx4 v7, s[12:15], s25 offen lds
    s_xor_b32 m0, s45, 16384
    s_nop 0
    buffer_load_dwordx4 v6, s[12:15], s26 offen lds
    s_xor_b32 m0, s45, 17408
    s_nop 0
    buffer_load_dwordx4 v7, s[12:15], s26 offen lds
    s_xor_b32 m0, s45, 18432
    s_nop 0
    buffer_load_dwordx4 v6, s[12:15], s27 offen lds
    s_xor_b32 m0, s45, 19456
    s_nop 0
    buffer_load_dwordx4 v7, s[12:15], s27 offen lds
    s_add_u32 s24, s24, s28
    s_add_u32 s25, s25, s28
    s_add_u32 s26, s26, s28
    s_add_u32 s27, s27, s28
    s_cmp_ge_u32 s45, 98304
    s_cselect_b32 s60, s6, s7
    s_add_u32 s45, s45, s60
    s_or_b32 s60, s95, s58
    s_cbranch_scc1 L_rw_50
    s_lshl_b32 s62, s56, 3
    s_add_u32 s62, s62, 160
    s_mov_b32 s63, 0
L_rp_51:
    s_load_dwordx2 s[60:61], s[98:99], s62 glc
    s_add_u32 s63, s63, 1
    s_cmp_gt_u32 s63, 0x100000
    s_cbranch_scc1 chain_kernel_wabort
    s_waitcnt lgkmcnt(0)
    s_cmp_lt_u32 s61, 0x2000
    s_cbranch_scc1 L_rp_51
    s_lshr_b32 s61, s1, 8
    s_cmp_eq_u32 s60, -1
    s_cselect_b32 s0, -1, s61
L_rw_50:
    s_cmp_lg_u32 s95, 0
    s_cbranch_scc1 L_rok_52
    v_mov_b32 v24, 131072
    s_cmp_lg_u32 s58, 0
    s_cbranch_scc1 L_rw_53
    v_mov_b32 v25, s0
    ds_write_b32 v24, v25
    s_waitcnt lgkmcnt(0)
L_rw_53:
    s_barrier
    ds_read_b32 v25, v24
    s_waitcnt lgkmcnt(0)
    v_readfirstlane_b32 s60, v25
    s_mov_b32 s95, 1
    s_cmp_eq_u32 s60, -1
    s_cbranch_scc1 L_rok_52
    s_mov_b32 s57, s60
    s_waitcnt vmcnt(0)
    s_barrier
    s_cmp_ge_u32 s57, 32
    s_cbranch_scc1 chain_kernel_end
    s_branch L_big_41
L_rok_52:
    s_add_u32 s39, s39, 0x100000
    s_mov_b32 s16, s100
    s_and_b32 s17, s101, 0xffff
    s_mov_b32 s18, 0xc000000
    s_mov_b32 s19, 0x00020000
    v_mov_b32 v32, -1
    v_mov_b32 v33, -1
    v_mov_b32 v34, -1
    v_mov_b32 v35, -1
    v_lshlrev_b32 v26, 4, v0
    s_lshl_b32 s60, s57, 12
    s_add_u32 s60, s60, 0xb100000
    buffer_store_dwordx4 v[32:35], v26, s[16:19], s60 offen sc1
    s_mov_b32 s18, 0
    s_cmp_lg_u32 s58, 3
    s_cbranch_scc1 L_cal_54
    s_cmp_ge_u32 s57, 15
    s_cbranch_scc1 L_cal_54
    s_lshl_b32 s60, s57, 14
    s_add_u32 s60, s60, 0xb400000
    s_add_u32 s86, s100, s60
    s_addc_u32 s87, s101, 0
    s_mov_b32 s60, 0
    s_atomic_or s60, s[86:87], 0
    s_atomic_or s60, s[86:87], 0x2000
    s_waitcnt lgkmcnt(0)
    s_mov_b32 s61, -1
    s_mov_b32 s62, -1
    s_memtime s[88:89]
    s_atomic_or s60, s[86:87], 0
    s_waitcnt lgkmcnt(0)
    s_memtime s[90:91]
    s_atomic_or s60, s[86:87], 0x2000
    s_waitcnt lgkmcnt(0)
    s_sub_u32 s63, s90, s88
    s_memtime s[88:89]
    s_min_u32 s61, s61, s63
    s_waitcnt lgkmcnt(0)
    s_sub_u32 s63, s88, s90
    s_min_u32 s62, s62, s63
    s_memtime s[88:89]
    s_atomic_or s60, s[86:87], 0
    s_waitcnt lgkmcnt(0)
    s_memtime s[90:91]
    s_atomic_or s60, s[86:87], 0x2000
    s_waitcnt lgkmcnt(0)
    s_sub_u32 s63, s90, s88
    s_memtime s[88:89]
    s_min_u32 s61, s61, s63
    s_waitcnt lgkmcnt(0)
    s_sub_u32 s63, s88, s90
    s_min_u32 s62, s62, s63
    s_memtime s[88:89]
    s_atomic_or s60, s[86:87], 0
    s_waitcnt lgkmcnt(0)
    s_memtime s[90:91]
    s_atomic_or s60, s[86:87], 0x2000
    s_waitcnt lgkmcnt(0)
    s_sub_u32 s63, s90, s88
    s_memtime s[88:89]
    s_min_u32 s61, s61, s63
    s_waitcnt lgkmcnt(0)
    s_sub_u32 s63, s88, s90
    s_min_u32 s62, s62, s63
    s_memtime s[88:89]
    s_atomic_or s60, s[86:87], 0
    s_waitcnt lgkmcnt(0)
    s_memtime s[90:91]
    s_atomic_or s60, s[86:87], 0x2000
    s_waitcnt lgkmcnt(0)
    s_sub_u32 s63, s90, s88
    s_memtime s[88:89]
    s_min_u32 s61, s61, s63
    s_waitcnt lgkmcnt(0)
    s_sub_u32 s63, s88, s90
    s_min_u32 s62, s62, s63
    s_cmp_lt_u32 s62, s61
    s_cselect_b32 s60, 1, 0x101
    s_atomic_add s60, s[98:99], 4
    s_waitcnt lgkmcnt(0)
L_cal_54:
    s_waitcnt vmcnt(25)
    v_lshlrev_b32 v192, 16, v192
    v_lshlrev_b32 v200, 16, v200
    v_lshlrev_b32 v208, 16, v208
    v_lshlrev_b32 v216, 16, v216
    v_lshlrev_b32 v193, 16, v193
    v_lshlrev_b32 v201, 16, v201
    v_lshlrev_b32 v209, 16, v209
    v_lshlrev_b32 v217, 16, v217
    v_lshlrev_b32 v194, 16, v194
    v_lshlrev_b32 v202, 16, v202
    v_lshlrev_b32 v210, 16, v210
    v_lshlrev_b32 v218, 16, v218
    v_mul_f32 v194, 0x3fb8aa3b, v194
    v_mul_f32 v202, 0x3fb8aa3b, v202
    v_mul_f32 v210, 0x3fb8aa3b, v210
    v_mul_f32 v218, 0x3fb8aa3b, v218
    v_exp_f32 v194, v194
    v_exp_f32 v202, v202
    v_exp_f32 v210, v210
    v_exp_f32 v218, v218
    v_cvt_pk_bf16_f32 v194, 0, v194
    v_cvt_pk_bf16_f32 v202, 0, v202
    v_cvt_pk_bf16_f32 v210, 0, v210
    v_cvt_pk_bf16_f32 v218, 0, v218
    v_mul_f32 v195, v194, v192
    v_mul_f32 v203, v202, v200
    v_mul_f32 v211, v210, v208
    v_mul_f32 v219, v218, v216
    v_mul_f32 v196, v194, v193
    v_mul_f32 v204, v202, v201
    v_mul_f32 v212, v210, v209
    v_mul_f32 v220, v218, v217
    v_mul_f32 v195, 0x3fb8aa3b, v195
    v_mul_f32 v203, 0x3fb8aa3b, v203
    v_mul_f32 v211, 0x3fb8aa3b, v211
    v_mul_f32 v219, 0x3fb8aa3b, v219
    v_exp_f32 v195, v195
    v_exp_f32 v203, v203
    v_exp_f32 v211, v211
    v_exp_f32 v219, v219
    v_mul_f32 v196, 0x3e22f983, v196
    v_mul_f32 v204, 0x3e22f983, v204
    v_mul_f32 v212, 0x3e22f983, v212
    v_mul_f32 v220, 0x3e22f983, v220
    v_fract_f32 v196, v196
    v_fract_f32 v204, v204
    v_fract_f32 v212, v212
    v_fract_f32 v220, v220
    v_cos_f32 v197, v196
    v_cos_f32 v205, v204
    v_cos_f32 v213, v212
    v_cos_f32 v221, v220
    v_sin_f32 v198, v196
    v_sin_f32 v206, v204
    v_sin_f32 v214, v212
    v_sin_f32 v222, v220
    v_mul_f32 v88, v195, v197
    v_mul_f32 v90, v203, v205
    v_mul_f32 v92, v211, v213
    v_mul_f32 v94, v219, v221
    v_mul_f32 v89, v195, v198
    v_mul_f32 v91, v203, v206
    v_mul_f32 v93, v211, v214
    v_mul_f32 v95, v219, v222
    v_add_f32 v197, -1.0, v88
    v_add_f32 v205, -1.0, v90
    v_add_f32 v213, -1.0, v92
    v_add_f32 v221, -1.0, v94
    v_mul_f32 v198, v197, v192
    v_mul_f32 v206, v205, v200
    v_mul_f32 v214, v213, v208
    v_mul_f32 v222, v221, v216
    v_fma_f32 v198, v89, v193, v198
    v_fma_f32 v206, v91, v201, v206
    v_fma_f32 v214, v93, v209, v214
    v_fma_f32 v222, v95, v217, v222
    v_mul_f32 v199, v89, v192
    v_mul_f32 v207, v91, v200
    v_mul_f32 v215, v93, v208
    v_mul_f32 v223, v95, v216
    v_fma_f32 v199, -v197, v193, v199
    v_fma_f32 v207, -v205, v201, v207
    v_fma_f32 v215, -v213, v209, v215
    v_fma_f32 v223, -v221, v217, v223
    v_mul_f32 v195, v192, v192
    v_mul_f32 v203, v200, v200
    v_mul_f32 v211, v208, v208
    v_mul_f32 v219, v216, v216
    v_fma_f32 v195, v193, v193, v195
    v_fma_f32 v203, v201, v201, v203
    v_fma_f32 v211, v209, v209, v211
    v_fma_f32 v219, v217, v217, v219
    v_rcp_f32 v195, v195
    v_rcp_f32 v203, v203
    v_rcp_f32 v211, v211
    v_rcp_f32 v219, v219
    v_add_f32 v195, v195, v195
    v_add_f32 v203, v203, v203
    v_add_f32 v211, v211, v211
    v_add_f32 v219, v219, v219
    v_mul_f32 v96, v198, v195
    v_mul_f32 v98, v206, v203
    v_mul_f32 v100, v214, v211
    v_mul_f32 v102, v222, v219
    v_mul_f32 v97, v199, v195
    v_mul_f32 v99, v207, v203
    v_mul_f32 v101, v215, v211
    v_mul_f32 v103, v223, v219
    v_pk_mul_f32 v[192:193], v[88:89], v[88:89] op_sel:[0,0] op_sel_hi:[0,1]
    v_pk_mul_f32 v[200:201], v[90:91], v[90:91] op_sel:[0,0] op_sel_hi:[0,1]
    v_pk_mul_f32 v[208:209], v[92:93], v[92:93] op_sel:[0,0] op_sel_hi:[0,1]
    v_pk_mul_f32 v[216:217], v[94:95], v[94:95] op_sel:[0,0] op_sel_hi:[0,1]
    v_pk_fma_f32 v[104:105], v[88:89], v[88:89], v[192:193] op_sel:[1,1,0] op_sel_hi:[1,0,1] neg_lo:[1,0,0]
    v_pk_fma_f32 v[106:107], v[90:91], v[90:91], v[200:201] op_sel:[1,1,0] op_sel_hi:[1,0,1] neg_lo:[1,0,0]
    v_pk_fma_f32 v[108:109], v[92:93], v[92:93], v[208:209] op_sel:[1,1,0] op_sel_hi:[1,0,1] neg_lo:[1,0,0]
    v_pk_fma_f32 v[110:111], v[94:95], v[94:95], v[216:217] op_sel:[1,1,0] op_sel_hi:[1,0,1] neg_lo:[1,0,0]
    v_pk_mul_f32 v[192:193], v[104:105], v[104:105] op_sel:[0,0] op_sel_hi:[0,1]
    v_pk_mul_f32 v[200:201], v[106:107], v[106:107] op_sel:[0,0] op_sel_hi:[0,1]
    v_pk_mul_f32 v[208:209], v[108:109], v[108:109] op_sel:[0,0] op_sel_hi:[0,1]
    v_pk_mul_f32 v[216:217], v[110:111], v[110:111] op_sel:[0,0] op_sel_hi:[0,1]
    v_pk_fma_f32 v[104:105], v[104:105], v[104:105], v[192:193] op_sel:[1,1,0] op_sel_hi:[1,0,1] neg_lo:[1,0,0]
    v_pk_fma_f32 v[106:107], v[106:107], v[106:107], v[200:201] op_sel:[1,1,0] op_sel_hi:[1,0,1] neg_lo:[1,0,0]
    v_pk_fma_f32 v[108:109], v[108:109], v[108:109], v[208:209] op_sel:[1,1,0] op_sel_hi:[1,0,1] neg_lo:[1,0,0]
    v_pk_fma_f32 v[110:111], v[110:111], v[110:111], v[216:217] op_sel:[1,1,0] op_sel_hi:[1,0,1] neg_lo:[1,0,0]
    v_pk_mul_f32 v[192:193], v[104:105], v[104:105] op_sel:[0,0] op_sel_hi:[0,1]
    v_pk_mul_f32 v[200:201], v[106:107], v[106:107] op_sel:[0,0] op_sel_hi:[0,1]
    v_pk_mul_f32 v[208:209], v[108:109], v[108:109] op_sel:[0,0] op_sel_hi:[0,1]
    v_pk_mul_f32 v[216:217], v[110:111], v[110:111] op_sel:[0,0] op_sel_hi:[0,1]
    v_pk_fma_f32 v[104:105], v[104:105], v[104:105], v[192:193] op_sel:[1,1,0] op_sel_hi:[1,0,1] neg_lo:[1,0,0]
    v_pk_fma_f32 v[106:107], v[106:107], v[106:107], v[200:201] op_sel:[1,1,0] op_sel_hi:[1,0,1] neg_lo:[1,0,0]
    v_pk_fma_f32 v[108:109], v[108:109], v[108:109], v[208:209] op_sel:[1,1,0] op_sel_hi:[1,0,1] neg_lo:[1,0,0]
    v_pk_fma_f32 v[110:111], v[110:111], v[110:111], v[216:217] op_sel:[1,1,0] op_sel_hi:[1,0,1] neg_lo:[1,0,0]
    v_pk_mul_f32 v[192:193], v[104:105], v[104:105] op_sel:[0,0] op_sel_hi:[0,1]
    v_pk_mul_f32 v[200:201], v[106:107], v[106:107] op_sel:[0,0] op_sel_hi:[0,1]
    v_pk_mul_f32 v[208:209], v[108:109], v[108:109] op_sel:[0,0] op_sel_hi:[0,1]
    v_pk_mul_f32 v[216:217], v[110:111], v[110:111] op_sel:[0,0] op_sel_hi:[0,1]
    v_pk_fma_f32 v[104:105], v[104:105], v[104:105], v[192:193] op_sel:[1,1,0] op_sel_hi:[1,0,1] neg_lo:[1,0,0]
    v_pk_fma_f32 v[106:107], v[106:107], v[106:107], v[200:201] op_sel:[1,1,0] op_sel_hi:[1,0,1] neg_lo:[1,0,0]
    v_pk_fma_f32 v[108:109], v[108:109], v[108:109], v[208:209] op_sel:[1,1,0] op_sel_hi:[1,0,1] neg_lo:[1,0,0]
    v_pk_fma_f32 v[110:111], v[110:111], v[110:111], v[216:217] op_sel:[1,1,0] op_sel_hi:[1,0,1] neg_lo:[1,0,0]
    v_pk_mul_f32 v[192:193], v[104:105], v[104:105] op_sel:[0,0] op_sel_hi:[0,1]
    v_pk_mul_f32 v[200:201], v[106:107], v[106:107] op_sel:[0,0] op_sel_hi:[0,1]
    v_pk_mul_f32 v[208:209], v[108:109], v[108:109] op_sel:[0,0] op_sel_hi:[0,1]
    v_pk_mul_f32 v[216:217], v[110:111], v[110:111] op_sel:[0,0] op_sel_hi:[0,1]
    v_pk_fma_f32 v[104:105], v[104:105], v[104:105], v[192:193] op_sel:[1,1,0] op_sel_hi:[1,0,1] neg_lo:[1,0,0]
    v_pk_fma_f32 v[106:107], v[106:107], v[106:107], v[200:201] op_sel:[1,1,0] op_sel_hi:[1,0,1] neg_lo:[1,0,0]
    v_pk_fma_f32 v[108:109], v[108:109], v[108:109], v[208:209] op_sel:[1,1,0] op_sel_hi:[1,0,1] neg_lo:[1,0,0]
    v_pk_fma_f32 v[110:111], v[110:111], v[110:111], v[216:217] op_sel:[1,1,0] op_sel_hi:[1,0,1] neg_lo:[1,0,0]
    v_pk_mul_f32 v[192:193], v[104:105], v[104:105] op_sel:[0,0] op_sel_hi:[0,1]
    v_pk_mul_f32 v[200:201], v[106:107], v[106:107] op_sel:[0,0] op_sel_hi:[0,1]
    v_pk_mul_f32 v[208:209], v[108:109], v[108:109] op_sel:[0,0] op_sel_hi:[0,1]
    v_pk_mul_f32 v[216:217], v[110:111], v[110:111] op_sel:[0,0] op_sel_hi:[0,1]
    v_pk_fma_f32 v[112:113], v[104:105], v[104:105], v[192:193] op_sel:[1,1,0] op_sel_hi:[1,0,1] neg_lo:[1,0,0]
    v_pk_fma_f32 v[114:115], v[106:107], v[106:107], v[200:201] op_sel:[1,1,0] op_sel_hi:[1,0,1] neg_lo:[1,0,0]
    v_pk_fma_f32 v[116:117], v[108:109], v[108:109], v[208:209] op_sel:[1,1,0] op_sel_hi:[1,0,1] neg_lo:[1,0,0]
    v_pk_fma_f32 v[118:119], v[110:111], v[110:111], v[216:217] op_sel:[1,1,0] op_sel_hi:[1,0,1] neg_lo:[1,0,0]
    v_pk_mul_f32 v[192:193], v[112:113], v[112:113] op_sel:[0,0] op_sel_hi:[0,1]
    v_pk_mul_f32 v[200:201], v[114:115], v[114:115] op_sel:[0,0] op_sel_hi:[0,1]
    v_pk_mul_f32 v[208:209], v[116:117], v[116:117] op_sel:[0,0] op_sel_hi:[0,1]
    v_pk_mul_f32 v[216:217], v[118:119], v[118:119] op_sel:[0,0] op_sel_hi:[0,1]
    v_pk_fma_f32 v[196:197], v[112:113], v[112:113], v[192:193] op_sel:[1,1,0] op_sel_hi:[1,0,1] neg_lo:[1,0,0]
    v_pk_fma_f32 v[204:205], v[114:115], v[114:115], v[200:201] op_sel:[1,1,0] op_sel_hi:[1,0,1] neg_lo:[1,0,0]
    v_pk_fma_f32 v[212:213], v[116:117], v[116:117], v[208:209] op_sel:[1,1,0] op_sel_hi:[1,0,1] neg_lo:[1,0,0]
    v_pk_fma_f32 v[220:221], v[118:119], v[118:119], v[216:217] op_sel:[1,1,0] op_sel_hi:[1,0,1] neg_lo:[1,0,0]
    s_mov_b32 exec_lo, 0xffffffff
    s_mov_b32 exec_hi, 0xffffffff
    v_mov_b32 v120, v196
    v_mov_b32 v121, v197
    s_mov_b32 exec_lo, 0xffff0000
    s_mov_b32 exec_hi, 0xffffffff
    v_mov_b32 v120, v204
    v_mov_b32 v121, v205
    s_mov_b32 exec_lo, 0x0
    s_mov_b32 exec_hi, 0xffffffff
    v_mov_b32 v120, v212
    v_mov_b32 v121, v213
    s_mov_b32 exec_lo, 0x0
    s_mov_b32 exec_hi, 0xffff0000
    v_mov_b32 v120, v220
    v_mov_b32 v121, v221
    s_mov_b64 exec, -1
    s_cmp_eq_u32 s58, 0
    s_cselect_b32 s1, 20, 0
    s_mov_b32 s4, 0
    s_mov_b32 s3, 20
    s_mov_b32 s2, 32
    s_mov_b32 s50, 0
    s_mov_b32 s5, 0
    s_mov_b32 s51, 0
    s_mov_b32 s52, 0
    s_waitcnt vmcnt(9)
    s_barrier
    s_call_b64 s[54:55], t_g1
    v_mov_b32 v125, 0
    s_mov_b32 s62, 0
L_pp_55:
    v_readfirstlane_b32 s59, v125
    s_and_b32 s60, s59, 0xff
    s_cmp_ge_u32 s60, 15
    s_cbranch_scc1 L_pok_56
    v_mov_b32 v24, 4
    global_load_dword v125, v24, s[98:99] sc1
    s_add_u32 s62, s62, 1
    s_cmp_gt_u32 s62, 0x200000
    s_cbranch_scc1 chain_kernel_wabort
    s_waitcnt vmcnt(0)
    s_branch L_pp_55
L_pok_56:
    s_cmp_ge_u32 s59, 0x800
    s_cselect_b32 s59, 0x2000, 0
    s_call_b64 s[54:55], t_scan
    s_add_u32 s82, s82, 4
    v_and_b32 v24, 15, v0
    v_bfe_u32 v25, v0, 7, 1
    v_lshl_add_u32 v24, v25, 6, v24
    v_lshlrev_b32 v24, 1, v24
    s_lshl_b32 s53, s82, 8
    s_mov_b32 s60, s66
    s_and_b32 s61, s67, 0xffff
    s_mov_b32 s62, 0x800
    s_mov_b32 s63, 0x00020000
    buffer_load_ushort v40, v24, s[60:63], s53 offen offset:0
    buffer_load_ushort v48, v24, s[60:63], s53 offen offset:32
    buffer_load_ushort v56, v24, s[60:63], s53 offen offset:64
    buffer_load_ushort v64, v24, s[60:63], s53 offen offset:96
    s_mov_b32 s60, s68
    s_and_b32 s61, s69, 0xffff
    s_mov_b32 s62, 0x800
    s_mov_b32 s63, 0x00020000
    buffer_load_ushort v41, v24, s[60:63], s53 offen offset:0
    buffer_load_ushort v49, v24, s[60:63], s53 offen offset:32
    buffer_load_ushort v57, v24, s[60:63], s53 offen offset:64
    buffer_load_ushort v65, v24, s[60:63], s53 offen offset:96
    s_mov_b32 s60, s78
    s_and_b32 s61, s79, 0xffff
    s_mov_b32 s62, 0x800
    s_mov_b32 s63, 0x00020000
    buffer_load_ushort v42, v24, s[60:63], s53 offen offset:0
    buffer_load_ushort v50, v24, s[60:63], s53 offen offset:32
    buffer_load_ushort v58, v24, s[60:63], s53 offen offset:64
    buffer_load_ushort v66, v24, s[60:63], s53 offen offset:96
    s_and_b32 s62, s57, 7
    s_lshr_b32 s63, s57, 3
    s_lshl_b32 s60, s63, 19
    s_add_u32 s60, s60, 0
    s_mov_b32 s30, s74
    s_and_b32 s31, s75, 0xffff
    s_mov_b32 s32, 0x200000
    s_mov_b32 s33, s60
    s_mov_b32 s34, 0x8000
    s_mov_b32 s35, 0x40000
    s_lshl_b32 s61, s62, 13
    s_andn2_b32 s61, 0x2000, s61
    s_xor_b32 s61, s61, s59
    s_lshl_b32 s60, s62, 21
    s_add_u32 s60, s60, s61
    s_add_u32 s60, s60, 0x0
    s_add_u32 s36, s100, 0xa000000
    s_addc_u32 s37, s101, 0
    s_and_b32 s37, s37, 0xffff
    s_mov_b32 s38, 0x1000000
    s_mov_b32 s39, s60
    s_mov_b32 s40, 0x800
    s_mov_b32 s41, 0x8000
    s_mov_b32 s42, 0x10000
    s_mov_b32 s84, s62
    s_lshl_b32 s94, s63, 0
    v_bfe_u32 v24, v0, 4, 2
    v_and_b32 v25, 7, v0
    v_xor_b32 v24, v24, v25
    v_lshlrev_b32 v8, 4, v24
    v_bfe_u32 v24, v0, 3, 3
    v_lshl_add_u32 v8, v24, 11, v8
    v_bfe_u32 v24, v0, 6, 2
    v_lshl_add_u32 v8, v24, 16, v8
    v_xor_b32 v9, 64, v8
    v_add_u32 v9, 0x4000, v9
    s_lshr_b32 s61, s58, 1
    s_lshl_b32 s61, s61, 14
    v_add_u32 v10, s61, v1
    s_and_b32 s61, s58, 1
    s_lshl_b32 s61, s61, 12
    v_add_u32 v10, s61, v10
    v_add_u32 v11, 1024, v10
    s_mov_b32 s18, 0xc000000
    s_mov_b32 s4, 12
    s_mov_b32 s3, 12
    s_waitcnt vmcnt(0)
    v_lshlrev_b32 v40, 16, v40
    v_lshlrev_b32 v48, 16, v48
    v_lshlrev_b32 v56, 16, v56
    v_lshlrev_b32 v64, 16, v64
    v_lshlrev_b32 v41, 16, v41
    v_lshlrev_b32 v49, 16, v49
    v_lshlrev_b32 v57, 16, v57
    v_lshlrev_b32 v65, 16, v65
    v_lshlrev_b32 v42, 16, v42
    v_lshlrev_b32 v50, 16, v50
    v_lshlrev_b32 v58, 16, v58
    v_lshlrev_b32 v66, 16, v66
    v_mul_f32 v42, 0x3fb8aa3b, v42
    v_mul_f32 v50, 0x3fb8aa3b, v50
    v_mul_f32 v58, 0x3fb8aa3b, v58
    v_mul_f32 v66, 0x3fb8aa3b, v66
    v_exp_f32 v42, v42
    v_exp_f32 v50, v50
    v_exp_f32 v58, v58
    v_exp_f32 v66, v66
    v_cvt_pk_bf16_f32 v42, 0, v42
    v_cvt_pk_bf16_f32 v50, 0, v50
    v_cvt_pk_bf16_f32 v58, 0, v58
    v_cvt_pk_bf16_f32 v66, 0, v66
    v_mul_f32 v43, v42, v40
    v_mul_f32 v51, v50, v48
    v_mul_f32 v59, v58, v56
    v_mul_f32 v67, v66, v64
    v_mul_f32 v44, v42, v41
    v_mul_f32 v52, v50, v49
    v_mul_f32 v60, v58, v57
    v_mul_f32 v68, v66, v65
    v_mul_f32 v43, 0x3fb8aa3b, v43
    v_mul_f32 v51, 0x3fb8aa3b, v51
    v_mul_f32 v59, 0x3fb8aa3b, v59
    v_mul_f32 v67, 0x3fb8aa3b, v67
    v_exp_f32 v43, v43
    v_exp_f32 v51, v51
    v_exp_f32 v59, v59
    v_exp_f32 v67, v67
    v_mul_f32 v44, 0x3e22f983, v44
    v_mul_f32 v52, 0x3e22f983, v52
    v_mul_f32 v60, 0x3e22f983, v60
    v_mul_f32 v68, 0x3e22f983, v68
    v_fract_f32 v44, v44
    v_fract_f32 v52, v52
    v_fract_f32 v60, v60
    v_fract_f32 v68, v68
    v_cos_f32 v45, v44
    v_cos_f32 v53, v52
    v_cos_f32 v61, v60
    v_cos_f32 v69, v68
    v_sin_f32 v46, v44
    v_sin_f32 v54, v52
    v_sin_f32 v62, v60
    v_sin_f32 v70, v68
    v_mul_f32 v88, v43, v45
    v_mul_f32 v90, v51, v53
    v_mul_f32 v92, v59, v61
    v_mul_f32 v94, v67, v69
    v_mul_f32 v89, v43, v46
    v_mul_f32 v91, v51, v54
    v_mul_f32 v93, v59, v62
    v_mul_f32 v95, v67, v70
    v_add_f32 v45, -1.0, v88
    v_add_f32 v53, -1.0, v90
    v_add_f32 v61, -1.0, v92
    v_add_f32 v69, -1.0, v94
    v_mul_f32 v46, v45, v40
    v_mul_f32 v54, v53, v48
    v_mul_f32 v62, v61, v56
    v_mul_f32 v70, v69, v64
    v_fma_f32 v46, v89, v41, v46
    v_fma_f32 v54, v91, v49, v54
    v_fma_f32 v62, v93, v57, v62
    v_fma_f32 v70, v95, v65, v70
    v_mul_f32 v47, v89, v40
    v_mul_f32 v55, v91, v48
    v_mul_f32 v63, v93, v56
    v_mul_f32 v71, v95, v64
    v_fma_f32 v47, -v45, v41, v47
    v_fma_f32 v55, -v53, v49, v55
    v_fma_f32 v63, -v61, v57, v63
    v_fma_f32 v71, -v69, v65, v71
    v_mul_f32 v43, v40, v40
    v_mul_f32 v51, v48, v48
    v_mul_f32 v59, v56, v56
    v_mul_f32 v67, v64, v64
    v_fma_f32 v43, v41, v41, v43
    v_fma_f32 v51, v49, v49, v51
    v_fma_f32 v59, v57, v57, v59
    v_fma_f32 v67, v65, v65, v67
    v_rcp_f32 v43, v43
    v_rcp_f32 v51, v51
    v_rcp_f32 v59, v59
    v_rcp_f32 v67, v67
    v_add_f32 v43, v43, v43
    v_add_f32 v51, v51, v51
    v_add_f32 v59, v59, v59
    v_add_f32 v67, v67, v67
    v_mul_f32 v96, v46, v43
    v_mul_f32 v98, v54, v51
    v_mul_f32 v100, v62, v59
    v_mul_f32 v102, v70, v67
    v_mul_f32 v97, v47, v43
    v_mul_f32 v99, v55, v51
    v_mul_f32 v101, v63, v59
    v_mul_f32 v103, v71, v67
    v_pk_mul_f32 v[40:41], v[88:89], v[88:89] op_sel:[0,0] op_sel_hi:[0,1]
    v_pk_mul_f32 v[48:49], v[90:91], v[90:91] op_sel:[0,0] op_sel_hi:[0,1]
    v_pk_mul_f32 v[56:57], v[92:93], v[92:93] op_sel:[0,0] op_sel_hi:[0,1]
    v_pk_mul_f32 v[64:65], v[94:95], v[94:95] op_sel:[0,0] op_sel_hi:[0,1]
    v_pk_fma_f32 v[104:105], v[88:89], v[88:89], v[40:41] op_sel:[1,1,0] op_sel_hi:[1,0,1] neg_lo:[1,0,0]
    v_pk_fma_f32 v[106:107], v[90:91], v[90:91], v[48:49] op_sel:[1,1,0] op_sel_hi:[1,0,1] neg_lo:[1,0,0]
    v_pk_fma_f32 v[108:109], v[92:93], v[92:93], v[56:57] op_sel:[1,1,0] op_sel_hi:[1,0,1] neg_lo:[1,0,0]
    v_pk_fma_f32 v[110:111], v[94:95], v[94:95], v[64:65] op_sel:[1,1,0] op_sel_hi:[1,0,1] neg_lo:[1,0,0]
    v_pk_mul_f32 v[40:41], v[104:105], v[104:105] op_sel:[0,0] op_sel_hi:[0,1]
    v_pk_mul_f32 v[48:49], v[106:107], v[106:107] op_sel:[0,0] op_sel_hi:[0,1]
    v_pk_mul_f32 v[56:57], v[108:109], v[108:109] op_sel:[0,0] op_sel_hi:[0,1]
    v_pk_mul_f32 v[64:65], v[110:111], v[110:111] op_sel:[0,0] op_sel_hi:[0,1]
    v_pk_fma_f32 v[104:105], v[104:105], v[104:105], v[40:41] op_sel:[1,1,0] op_sel_hi:[1,0,1] neg_lo:[1,0,0]
    v_pk_fma_f32 v[106:107], v[106:107], v[106:107], v[48:49] op_sel:[1,1,0] op_sel_hi:[1,0,1] neg_lo:[1,0,0]
    v_pk_fma_f32 v[108:109], v[108:109], v[108:109], v[56:57] op_sel:[1,1,0] op_sel_hi:[1,0,1] neg_lo:[1,0,0]
    v_pk_fma_f32 v[110:111], v[110:111], v[110:111], v[64:65] op_sel:[1,1,0] op_sel_hi:[1,0,1] neg_lo:[1,0,0]
    v_pk_mul_f32 v[40:41], v[104:105], v[104:105] op_sel:[0,0] op_sel_hi:[0,1]
    v_pk_mul_f32 v[48:49], v[106:107], v[106:107] op_sel:[0,0] op_sel_hi:[0,1]
    v_pk_mul_f32 v[56:57], v[108:109], v[108:109] op_sel:[0,0] op_sel_hi:[0,1]
    v_pk_mul_f32 v[64:65], v[110:111], v[110:111] op_sel:[0,0] op_sel_hi:[0,1]
    v_pk_fma_f32 v[104:105], v[104:105], v[104:105], v[40:41] op_sel:[1,1,0] op_sel_hi:[1,0,1] neg_lo:[1,0,0]
    v_pk_fma_f32 v[106:107], v[106:107], v[106:107], v[48:49] op_sel:[1,1,0] op_sel_hi:[1,0,1] neg_lo:[1,0,0]
    v_pk_fma_f32 v[108:109], v[108:109], v[108:109], v[56:57] op_sel:[1,1,0] op_sel_hi:[1,0,1] neg_lo:[1,0,0]
    v_pk_fma_f32 v[110:111], v[110:111], v[110:111], v[64:65] op_sel:[1,1,0] op_sel_hi:[1,0,1] neg_lo:[1,0,0]
    v_pk_mul_f32 v[40:41], v[104:105], v[104:105] op_sel:[0,0] op_sel_hi:[0,1]
    v_pk_mul_f32 v[48:49], v[106:107], v[106:107] op_sel:[0,0] op_sel_hi:[0,1]
    v_pk_mul_f32 v[56:57], v[108:109], v[108:109] op_sel:[0,0] op_sel_hi:[0,1]
    v_pk_mul_f32 v[64:65], v[110:111], v[110:111] op_sel:[0,0] op_sel_hi:[0,1]
    v_pk_fma_f32 v[104:105], v[104:105], v[104:105], v[40:41] op_sel:[1,1,0] op_sel_hi:[1,0,1] neg_lo:[1,0,0]
    v_pk_fma_f32 v[106:107], v[106:107], v[106:107], v[48:49] op_sel:[1,1,0] op_sel_hi:[1,0,1] neg_lo:[1,0,0]
    v_pk_fma_f32 v[108:109], v[108:109], v[108:109], v[56:57] op_sel:[1,1,0] op_sel_hi:[1,0,1] neg_lo:[1,0,0]
    v_pk_fma_f32 v[110:111], v[110:111], v[110:111], v[64:65] op_sel:[1,1,0] op_sel_hi:[1,0,1] neg_lo:[1,0,0]
    v_pk_mul_f32 v[40:41], v[104:105], v[104:105] op_sel:[0,0] op_sel_hi:[0,1]
    v_pk_mul_f32 v[48:49], v[106:107], v[106:107] op_sel:[0,0] op_sel_hi:[0,1]
    v_pk_mul_f32 v[56:57], v[108:109], v[108:109] op_sel:[0,0] op_sel_hi:[0,1]
    v_pk_mul_f32 v[64:65], v[110:111], v[110:111] op_sel:[0,0] op_sel_hi:[0,1]
    v_pk_fma_f32 v[104:105], v[104:105], v[104:105], v[40:41] op_sel:[1,1,0] op_sel_hi:[1,0,1] neg_lo:[1,0,0]
    v_pk_fma_f32 v[106:107], v[106:107], v[106:107], v[48:49] op_sel:[1,1,0] op_sel_hi:[1,0,1] neg_lo:[1,0,0]
    v_pk_fma_f32 v[108:109], v[108:109], v[108:109], v[56:57] op_sel:[1,1,0] op_sel_hi:[1,0,1] neg_lo:[1,0,0]
    v_pk_fma_f32 v[110:111], v[110:111], v[110:111], v[64:65] op_sel:[1,1,0] op_sel_hi:[1,0,1] neg_lo:[1,0,0]
    v_pk_mul_f32 v[40:41], v[104:105], v[104:105] op_sel:[0,0] op_sel_hi:[0,1]
    v_pk_mul_f32 v[48:49], v[106:107], v[106:107] op_sel:[0,0] op_sel_hi:[0,1]
    v_pk_mul_f32 v[56:57], v[108:109], v[108:109] op_sel:[0,0] op_sel_hi:[0,1]
    v_pk_mul_f32 v[64:65], v[110:111], v[110:111] op_sel:[0,0] op_sel_hi:[0,1]
    v_pk_fma_f32 v[112:113], v[104:105], v[104:105], v[40:41] op_sel:[1,1,0] op_sel_hi:[1,0,1] neg_lo:[1,0,0]
    v_pk_fma_f32 v[114:115], v[106:107], v[106:107], v[48:49] op_sel:[1,1,0] op_sel_hi:[1,0,1] neg_lo:[1,0,0]
    v_pk_fma_f32 v[116:117], v[108:109], v[108:109], v[56:57] op_sel:[1,1,0] op_sel_hi:[1,0,1] neg_lo:[1,0,0]
    v_pk_fma_f32 v[118:119], v[110:111], v[110:111], v[64:65] op_sel:[1,1,0] op_sel_hi:[1,0,1] neg_lo:[1,0,0]
    v_pk_mul_f32 v[40:41], v[112:113], v[112:113] op_sel:[0,0] op_sel_hi:[0,1]
    v_pk_mul_f32 v[48:49], v[114:115], v[114:115] op_sel:[0,0] op_sel_hi:[0,1]
    v_pk_mul_f32 v[56:57], v[116:117], v[116:117] op_sel:[0,0] op_sel_hi:[0,1]
    v_pk_mul_f32 v[64:65], v[118:119], v[118:119] op_sel:[0,0] op_sel_hi:[0,1]
    v_pk_fma_f32 v[44:45], v[112:113], v[112:113], v[40:41] op_sel:[1,1,0] op_sel_hi:[1,0,1] neg_lo:[1,0,0]
    v_pk_fma_f32 v[52:53], v[114:115], v[114:115], v[48:49] op_sel:[1,1,0] op_sel_hi:[1,0,1] neg_lo:[1,0,0]
    v_pk_fma_f32 v[60:61], v[116:117], v[116:117], v[56:57] op_sel:[1,1,0] op_sel_hi:[1,0,1] neg_lo:[1,0,0]
    v_pk_fma_f32 v[68:69], v[118:119], v[118:119], v[64:65] op_sel:[1,1,0] op_sel_hi:[1,0,1] neg_lo:[1,0,0]
    s_mov_b32 exec_lo, 0xffffffff
    s_mov_b32 exec_hi, 0xffffffff
    v_mov_b32 v120, v44
    v_mov_b32 v121, v45
    s_mov_b32 exec_lo, 0xffff0000
    s_mov_b32 exec_hi, 0xffffffff
    v_mov_b32 v120, v52
    v_mov_b32 v121, v53
    s_mov_b32 exec_lo, 0x0
    s_mov_b32 exec_hi, 0xffffffff
    v_mov_b32 v120, v60
    v_mov_b32 v121, v61
    s_mov_b32 exec_lo, 0x0
    s_mov_b32 exec_hi, 0xffff0000
    v_mov_b32 v120, v68
    v_mov_b32 v121, v69
    s_mov_b64 exec, -1
    s_call_b64 s[54:55], t_g1
    s_call_b64 s[54:55], t_scan
    s_and_b32 s62, s57, 7
    s_lshr_b32 s63, s57, 3
    s_lshl_b32 s60, s63, 19
    s_add_u32 s60, s60, 0
    s_mov_b32 s30, s76
    s_and_b32 s31, s77, 0xffff
    s_mov_b32 s32, 0x200000
    s_mov_b32 s33, s60
    s_mov_b32 s34, 0x8000
    s_mov_b32 s35, 0x40000
    s_lshl_b32 s61, s62, 13
    s_andn2_b32 s61, 0x2000, s61
    s_xor_b32 s61, s61, s59
    s_lshl_b32 s60, s62, 21
    s_add_u32 s60, s60, s61
    s_add_u32 s60, s60, 0x80000
    s_add_u32 s36, s100, 0xa000000
    s_addc_u32 s37, s101, 0
    s_and_b32 s37, s37, 0xffff
    s_mov_b32 s38, 0x1000000
    s_mov_b32 s39, s60
    s_mov_b32 s40, 0x800
    s_mov_b32 s41, 0x8000
    s_mov_b32 s42, 0x10000
    s_mov_b32 s84, s62
    s_lshl_b32 s94, s63, 0
    s_mov_b32 s3, 0
    s_call_b64 s[54:55], t_g2
    s_and_b32 s62, s57, 7
    s_lshr_b32 s63, s57, 3
    s_lshl_b32 s60, s63, 19
    s_add_u32 s60, s60, 1024
    s_mov_b32 s30, s74
    s_and_b32 s31, s75, 0xffff
    s_mov_b32 s32, 0x200000
    s_mov_b32 s33, s60
    s_mov_b32 s34, 0x8000
    s_mov_b32 s35, 0x40000
    s_lshl_b32 s61, s62, 13
    s_andn2_b32 s61, 0x2000, s61
    s_xor_b32 s61, s61, s59
    s_lshl_b32 s60, s62, 21
    s_add_u32 s60, s60, s61
    s_add_u32 s60, s60, 0x100000
    s_add_u32 s36, s100, 0xa000000
    s_addc_u32 s37, s101, 0
    s_and_b32 s37, s37, 0xffff
    s_mov_b32 s38, 0x1000000
    s_mov_b32 s39, s60
    s_mov_b32 s40, 0x800
    s_mov_b32 s41, 0x8000
    s_mov_b32 s42, 0x10000
    s_mov_b32 s84, s62
    s_lshl_b32 s94, s63, 0
    s_mov_b32 s18, 0
    s_cmp_eq_u32 s58, 0
    s_cselect_b32 s1, 16, 0
    s_mov_b32 s3, 16
    s_call_b64 s[54:55], t_g2_c
    s_and_b32 s62, s57, 7
    s_lshr_b32 s63, s57, 3
    s_lshl_b32 s60, s63, 19
    s_add_u32 s60, s60, 1024
    s_mov_b32 s30, s76
    s_and_b32 s31, s77, 0xffff
    s_mov_b32 s32, 0x200000
    s_mov_b32 s33, s60
    s_mov_b32 s34, 0x8000
    s_mov_b32 s35, 0x40000
    s_lshl_b32 s61, s62, 13
    s_andn2_b32 s61, 0x2000, s61
    s_xor_b32 s61, s61, s59
    s_lshl_b32 s60, s62, 21
    s_add_u32 s60, s60, s61
    s_add_u32 s60, s60, 0x180000
    s_add_u32 s36, s100, 0xa000000
    s_addc_u32 s37, s101, 0
    s_and_b32 s37, s37, 0xffff
    s_mov_b32 s38, 0x1000000
    s_mov_b32 s39, s60
    s_mov_b32 s40, 0x800
    s_mov_b32 s41, 0x8000
    s_mov_b32 s42, 0x10000
    s_mov_b32 s84, s62
    s_lshl_b32 s94, s63, 0
    s_mov_b32 s3, 0
    s_call_b64 s[54:55], t_g2_c
    s_mov_b32 s32, 0
    s_mov_b32 s38, 0
    s_call_b64 s[54:55], t_g2_c
    s_and_b32 s85, s57, 7
    s_lshr_b32 s82, s57, 3
    s_waitcnt vmcnt(0)
    s_barrier
    v_and_b32 v26, 31, v0
    v_bfe_u32 v25, v0, 6, 1
    v_lshl_add_u32 v27, v25, 5, v26
    v_bfe_u32 v28, v0, 5, 1
    v_bfe_u32 v24, v0, 7, 1
    v_lshl_add_u32 v24, v24, 7, v28
    v_lshlrev_b32 v25, 13, v24
    v_lshl_add_u32 v25, v27, 4, v25
    v_lshlrev_b32 v24, 11, v24
    v_lshl_add_u32 v24, v27, 3, v24
    v_lshlrev_b32 v27, 3, v27
    s_mov_b32 s60, s80
    s_and_b32 s61, s81, 0xffff
    s_mov_b32 s62, 0x800
    s_mov_b32 s63, 0x00020000
    s_lshl_b32 s53, s82, 9
    buffer_load_dwordx2 v[44:45], v27, s[60:63], s53 offen
    s_mov_b32 s8, s64
    s_and_b32 s9, s65, 0xffff
    s_mov_b32 s10, 0x400000
    s_mov_b32 s11, 0x00020000
    s_mov_b32 s12, s96
    s_and_b32 s13, s97, 0xffff
    s_mov_b32 s14, 0x1000000
    s_mov_b32 s15, 0x00020000
    s_lshl_b32 s50, s85, 19
    s_add_u32 s50, s50, s53
    s_add_u32 s53, s50, 0x0
    buffer_load_dwordx2 v[128:129], v24, s[8:11], s53 offen
    s_add_u32 s53, s50, 0x1000
    buffer_load_dwordx2 v[130:131], v24, s[8:11], s53 offen
    s_add_u32 s53, s50, 0x2000
    buffer_load_dwordx2 v[132:133], v24, s[8:11], s53 offen
    s_add_u32 s53, s50, 0x3000
    buffer_load_dwordx2 v[134:135], v24, s[8:11], s53 offen
    s_add_u32 s53, s50, 0x10000
    buffer_load_dwordx2 v[136:137], v24, s[8:11], s53 offen
    s_add_u32 s53, s50, 0x11000
    buffer_load_dwordx2 v[138:139], v24, s[8:11], s53 offen
    s_add_u32 s53, s50, 0x12000
    buffer_load_dwordx2 v[140:141], v24, s[8:11], s53 offen
    s_add_u32 s53, s50, 0x13000
    buffer_load_dwordx2 v[142:143], v24, s[8:11], s53 offen
    s_add_u32 s53, s50, 0x20000
    buffer_load_dwordx2 v[144:145], v24, s[8:11], s53 offen
    s_add_u32 s53, s50, 0x21000
    buffer_load_dwordx2 v[146:147], v24, s[8:11], s53 offen
    s_add_u32 s53, s50, 0x22000
    buffer_load_dwordx2 v[148:149], v24, s[8:11], s53 offen
    s_add_u32 s53, s50, 0x23000
    buffer_load_dwordx2 v[150:151], v24, s[8:11], s53 offen
    s_add_u32 s53, s50, 0x30000
    buffer_load_dwordx2 v[152:153], v24, s[8:11], s53 offen
    s_add_u32 s53, s50, 0x31000
    buffer_load_dwordx2 v[154:155], v24, s[8:11], s53 offen
    s_add_u32 s53, s50, 0x32000
    buffer_load_dwordx2 v[156:157], v24, s[8:11], s53 offen
    s_add_u32 s53, s50, 0x33000
    buffer_load_dwordx2 v[158:159], v24, s[8:11], s53 offen
    s_add_u32 s53, s50, 0x4000
    buffer_load_dwordx2 v[160:161], v24, s[8:11], s53 offen
    s_add_u32 s53, s50, 0x5000
    buffer_load_dwordx2 v[162:163], v24, s[8:11], s53 offen
    s_add_u32 s53, s50, 0x6000
    buffer_load_dwordx2 v[164:165], v24, s[8:11], s53 offen
    s_add_u32 s53, s50, 0x7000
    buffer_load_dwordx2 v[166:167], v24, s[8:11], s53 offen
    s_add_u32 s53, s50, 0x14000
    buffer_load_dwordx2 v[168:169], v24, s[8:11], s53 offen
    s_add_u32 s53, s50, 0x15000
    buffer_load_dwordx2 v[170:171], v24, s[8:11], s53 offen
    s_add_u32 s53, s50, 0x16000
    buffer_load_dwordx2 v[172:173], v24, s[8:11], s53 offen
    s_add_u32 s53, s50, 0x17000
    buffer_load_dwordx2 v[174:175], v24, s[8:11], s53 offen
    s_add_u32 s53, s50, 0x24000
    buffer_load_dwordx2 v[176:177], v24, s[8:11], s53 offen
    s_add_u32 s53, s50, 0x25000
    buffer_load_dwordx2 v[178:179], v24, s[8:11], s53 offen
    s_add_u32 s53, s50, 0x26000
    buffer_load_dwordx2 v[180:181], v24, s[8:11], s53 offen
    s_add_u32 s53, s50, 0x27000
    buffer_load_dwordx2 v[182:183], v24, s[8:11], s53 offen
    s_add_u32 s53, s50, 0x34000
    buffer_load_dwordx2 v[184:185], v24, s[8:11], s53 offen
    s_add_u32 s53, s50, 0x35000
    buffer_load_dwordx2 v[186:187], v24, s[8:11], s53 offen
    s_add_u32 s53, s50, 0x36000
    buffer_load_dwordx2 v[188:189], v24, s[8:11], s53 offen
    s_add_u32 s53, s50, 0x37000
    buffer_load_dwordx2 v[190:191], v24, s[8:11], s53 offen
    s_mul_i32 s60, s58, 33792
    v_mul_u32_u24 v28, 528, v28
    v_lshl_add_u32 v28, v26, 4, v28
    v_add_u32 v28, s60, v28
    v_and_b32 v27, 15, v0
    v_mul_u32_u24 v27, 528, v27
    v_bfe_u32 v26, v0, 4, 2
    v_lshl_add_u32 v27, v26, 4, v27
    v_add_u32 v27, s60, v27
    s_lshl_b32 s51, s85, 21
    s_lshl_b32 s52, s82, 10
    s_add_u32 s51, s51, s52
    ds_write_b128 v27, a[0:3] offset:0
    ds_write_b128 v27, a[32:35] offset:64
    ds_write_b128 v27, a[64:67] offset:128
    ds_write_b128 v27, a[96:99] offset:192
    ds_write_b128 v27, a[128:131] offset:256
    ds_write_b128 v27, a[160:163] offset:320
    ds_write_b128 v27, a[192:195] offset:384
    ds_write_b128 v27, a[224:227] offset:448
    ds_read_b128 v[48:51], v28 offset:0
    ds_read_b128 v[52:55], v28 offset:1056
    ds_read_b128 v[56:59], v28 offset:2112
    ds_read_b128 v[60:63], v28 offset:3168
    ds_read_b128 v[64:67], v28 offset:4224
    ds_read_b128 v[68:71], v28 offset:5280
    ds_read_b128 v[72:75], v28 offset:6336
    ds_read_b128 v[76:79], v28 offset:7392
    ds_write_b128 v27, a[4:7] offset:8448
    ds_write_b128 v27, a[36:39] offset:8512
    ds_write_b128 v27, a[68:71] offset:8576
    ds_write_b128 v27, a[100:103] offset:8640
    ds_write_b128 v27, a[132:135] offset:8704
    ds_write_b128 v27, a[164:167] offset:8768
    ds_write_b128 v27, a[196:199] offset:8832
    ds_write_b128 v27, a[228:231] offset:8896
    s_waitcnt vmcnt(32)
    v_lshlrev_b32 v40, 16, v44
    v_and_b32 v41, 0xffff0000, v44
    v_lshlrev_b32 v42, 16, v45
    v_and_b32 v43, 0xffff0000, v45
    s_waitcnt vmcnt(24) lgkmcnt(8)
    ds_read_b128 v[80:83], v28 offset:8448
    ds_read_b128 v[84:87], v28 offset:9504
    ds_read_b128 v[88:91], v28 offset:10560
    ds_read_b128 v[92:95], v28 offset:11616
    ds_read_b128 v[96:99], v28 offset:12672
    ds_read_b128 v[100:103], v28 offset:13728
    ds_read_b128 v[104:107], v28 offset:14784
    ds_read_b128 v[108:111], v28 offset:15840
    ds_write_b128 v27, a[8:11] offset:16896
    ds_write_b128 v27, a[40:43] offset:16960
    ds_write_b128 v27, a[72:75] offset:17024
    ds_write_b128 v27, a[104:107] offset:17088
    ds_write_b128 v27, a[136:139] offset:17152
    ds_write_b128 v27, a[168:171] offset:17216
    ds_write_b128 v27, a[200:203] offset:17280
    ds_write_b128 v27, a[232:235] offset:17344
    v_lshlrev_b32 v112, 16, v128
    v_and_b32 v113, 0xffff0000, v128
    v_lshlrev_b32 v114, 16, v129
    v_and_b32 v115, 0xffff0000, v129
    v_pk_mul_f32 v[112:113], v[112:113], v[40:41]
    v_pk_mul_f32 v[114:115], v[114:115], v[42:43]
    s_add_u32 s52, s51, 0x0
    v_cvt_pk_bf16_f32 v112, 0, v112
    v_cvt_pk_bf16_f32 v113, 0, v113
    v_cvt_pk_bf16_f32 v114, 0, v114
    v_cvt_pk_bf16_f32 v115, 0, v115
    v_pk_add_f32 v[48:49], v[48:49], v[112:113]
    v_pk_add_f32 v[50:51], v[50:51], v[114:115]
    buffer_store_dwordx4 v[48:51], v25, s[12:15], s52 offen
    v_lshlrev_b32 v116, 16, v130
    v_and_b32 v117, 0xffff0000, v130
    v_lshlrev_b32 v118, 16, v131
    v_and_b32 v119, 0xffff0000, v131
    v_pk_mul_f32 v[116:117], v[116:117], v[40:41]
    v_pk_mul_f32 v[118:119], v[118:119], v[42:43]
    s_add_u32 s52, s51, 0x4000
    v_cvt_pk_bf16_f32 v116, 0, v116
    v_cvt_pk_bf16_f32 v117, 0, v117
    v_cvt_pk_bf16_f32 v118, 0, v118
    v_cvt_pk_bf16_f32 v119, 0, v119
    v_pk_add_f32 v[52:53], v[52:53], v[116:117]
    v_pk_add_f32 v[54:55], v[54:55], v[118:119]
    buffer_store_dwordx4 v[52:55], v25, s[12:15], s52 offen
    v_lshlrev_b32 v112, 16, v132
    v_and_b32 v113, 0xffff0000, v132
    v_lshlrev_b32 v114, 16, v133
    v_and_b32 v115, 0xffff0000, v133
    v_pk_mul_f32 v[112:113], v[112:113], v[40:41]
    v_pk_mul_f32 v[114:115], v[114:115], v[42:43]
    s_add_u32 s52, s51, 0x8000
    v_cvt_pk_bf16_f32 v112, 0, v112
    v_cvt_pk_bf16_f32 v113, 0, v113
    v_cvt_pk_bf16_f32 v114, 0, v114
    v_cvt_pk_bf16_f32 v115, 0, v115
    v_pk_add_f32 v[56:57], v[56:57], v[112:113]
    v_pk_add_f32 v[58:59], v[58:59], v[114:115]
    buffer_store_dwordx4 v[56:59], v25, s[12:15], s52 offen
    v_lshlrev_b32 v116, 16, v134
    v_and_b32 v117, 0xffff0000, v134
    v_lshlrev_b32 v118, 16, v135
    v_and_b32 v119, 0xffff0000, v135
    v_pk_mul_f32 v[116:117], v[116:117], v[40:41]
    v_pk_mul_f32 v[118:119], v[118:119], v[42:43]
    s_add_u32 s52, s51, 0xc000
    v_cvt_pk_bf16_f32 v116, 0, v116
    v_cvt_pk_bf16_f32 v117, 0, v117
    v_cvt_pk_bf16_f32 v118, 0, v118
    v_cvt_pk_bf16_f32 v119, 0, v119
    v_pk_add_f32 v[60:61], v[60:61], v[116:117]
    v_pk_add_f32 v[62:63], v[62:63], v[118:119]
    buffer_store_dwordx4 v[60:63], v25, s[12:15], s52 offen
    v_lshlrev_b32 v112, 16, v136
    v_and_b32 v113, 0xffff0000, v136
    v_lshlrev_b32 v114, 16, v137
    v_and_b32 v115, 0xffff0000, v137
    v_pk_mul_f32 v[112:113], v[112:113], v[40:41]
    v_pk_mul_f32 v[114:115], v[114:115], v[42:43]
    s_add_u32 s52, s51, 0x40000
    v_cvt_pk_bf16_f32 v112, 0, v112
    v_cvt_pk_bf16_f32 v113, 0, v113
    v_cvt_pk_bf16_f32 v114, 0, v114
    v_cvt_pk_bf16_f32 v115, 0, v115
    v_pk_add_f32 v[64:65], v[64:65], v[112:113]
    v_pk_add_f32 v[66:67], v[66:67], v[114:115]
    buffer_store_dwordx4 v[64:67], v25, s[12:15], s52 offen
    v_lshlrev_b32 v116, 16, v138
    v_and_b32 v117, 0xffff0000, v138
    v_lshlrev_b32 v118, 16, v139
    v_and_b32 v119, 0xffff0000, v139
    v_pk_mul_f32 v[116:117], v[116:117], v[40:41]
    v_pk_mul_f32 v[118:119], v[118:119], v[42:43]
    s_add_u32 s52, s51, 0x44000
    v_cvt_pk_bf16_f32 v116, 0, v116
    v_cvt_pk_bf16_f32 v117, 0, v117
    v_cvt_pk_bf16_f32 v118, 0, v118
    v_cvt_pk_bf16_f32 v119, 0, v119
    v_pk_add_f32 v[68:69], v[68:69], v[116:117]
    v_pk_add_f32 v[70:71], v[70:71], v[118:119]
    buffer_store_dwordx4 v[68:71], v25, s[12:15], s52 offen
    v_lshlrev_b32 v112, 16, v140
    v_and_b32 v113, 0xffff0000, v140
    v_lshlrev_b32 v114, 16, v141
    v_and_b32 v115, 0xffff0000, v141
    v_pk_mul_f32 v[112:113], v[112:113], v[40:41]
    v_pk_mul_f32 v[114:115], v[114:115], v[42:43]
    s_add_u32 s52, s51, 0x48000
    v_cvt_pk_bf16_f32 v112, 0, v112
    v_cvt_pk_bf16_f32 v113, 0, v113
    v_cvt_pk_bf16_f32 v114, 0, v114
    v_cvt_pk_bf16_f32 v115, 0, v115
    v_pk_add_f32 v[72:73], v[72:73], v[112:113]
    v_pk_add_f32 v[74:75], v[74:75], v[114:115]
    buffer_store_dwordx4 v[72:75], v25, s[12:15], s52 offen
    v_lshlrev_b32 v116, 16, v142
    v_and_b32 v117, 0xffff0000, v142
    v_lshlrev_b32 v118, 16, v143
    v_and_b32 v119, 0xffff0000, v143
    v_pk_mul_f32 v[116:117], v[116:117], v[40:41]
    v_pk_mul_f32 v[118:119], v[118:119], v[42:43]
    s_add_u32 s52, s51, 0x4c000
    v_cvt_pk_bf16_f32 v116, 0, v116
    v_cvt_pk_bf16_f32 v117, 0, v117
    v_cvt_pk_bf16_f32 v118, 0, v118
    v_cvt_pk_bf16_f32 v119, 0, v119
    v_pk_add_f32 v[76:77], v[76:77], v[116:117]
    v_pk_add_f32 v[78:79], v[78:79], v[118:119]
    buffer_store_dwordx4 v[76:79], v25, s[12:15], s52 offen
    s_add_u32 s53, s50, 0x8000
    buffer_load_dwordx2 v[192:193], v24, s[8:11], s53 offen
    s_add_u32 s53, s50, 0x9000
    buffer_load_dwordx2 v[194:195], v24, s[8:11], s53 offen
    s_add_u32 s53, s50, 0xa000
    buffer_load_dwordx2 v[196:197], v24, s[8:11], s53 offen
    s_add_u32 s53, s50, 0xb000
    buffer_load_dwordx2 v[198:199], v24, s[8:11], s53 offen
    s_add_u32 s53, s50, 0x18000
    buffer_load_dwordx2 v[200:201], v24, s[8:11], s53 offen
    s_add_u32 s53, s50, 0x19000
    buffer_load_dwordx2 v[202:203], v24, s[8:11], s53 offen
    s_add_u32 s53, s50, 0x1a000
    buffer_load_dwordx2 v[204:205], v24, s[8:11], s53 offen
    s_add_u32 s53, s50, 0x1b000
    buffer_load_dwordx2 v[206:207], v24, s[8:11], s53 offen
    s_waitcnt vmcnt(32) lgkmcnt(8)
    ds_read_b128 v[48:51], v28 offset:16896
    ds_read_b128 v[52:55], v28 offset:17952
    ds_read_b128 v[56:59], v28 offset:19008
    ds_read_b128 v[60:63], v28 offset:20064
    ds_read_b128 v[64:67], v28 offset:21120
    ds_read_b128 v[68:71], v28 offset:22176
    ds_read_b128 v[72:75], v28 offset:23232
    ds_read_b128 v[76:79], v28 offset:24288
    ds_write_b128 v27, a[12:15] offset:25344
    ds_write_b128 v27, a[44:47] offset:25408
    ds_write_b128 v27, a[76:79] offset:25472
    ds_write_b128 v27, a[108:111] offset:25536
    ds_write_b128 v27, a[140:143] offset:25600
    ds_write_b128 v27, a[172:175] offset:25664
    ds_write_b128 v27, a[204:207] offset:25728
    ds_write_b128 v27, a[236:239] offset:25792
    v_lshlrev_b32 v112, 16, v144
    v_and_b32 v113, 0xffff0000, v144
    v_lshlrev_b32 v114, 16, v145
    v_and_b32 v115, 0xffff0000, v145
    v_pk_mul_f32 v[112:113], v[112:113], v[40:41]
    v_pk_mul_f32 v[114:115], v[114:115], v[42:43]
    s_add_u32 s52, s51, 0x80000
    v_cvt_pk_bf16_f32 v112, 0, v112
    v_cvt_pk_bf16_f32 v113, 0, v113
    v_cvt_pk_bf16_f32 v114, 0, v114
    v_cvt_pk_bf16_f32 v115, 0, v115
    v_pk_add_f32 v[80:81], v[80:81], v[112:113]
    v_pk_add_f32 v[82:83], v[82:83], v[114:115]
    buffer_store_dwordx4 v[80:83], v25, s[12:15], s52 offen
    v_lshlrev_b32 v116, 16, v146
    v_and_b32 v117, 0xffff0000, v146
    v_lshlrev_b32 v118, 16, v147
    v_and_b32 v119, 0xffff0000, v147
    v_pk_mul_f32 v[116:117], v[116:117], v[40:41]
    v_pk_mul_f32 v[118:119], v[118:119], v[42:43]
    s_add_u32 s52, s51, 0x84000
    v_cvt_pk_bf16_f32 v116, 0, v116
    v_cvt_pk_bf16_f32 v117, 0, v117
    v_cvt_pk_bf16_f32 v118, 0, v118
    v_cvt_pk_bf16_f32 v119, 0, v119
    v_pk_add_f32 v[84:85], v[84:85], v[116:117]
    v_pk_add_f32 v[86:87], v[86:87], v[118:119]
    buffer_store_dwordx4 v[84:87], v25, s[12:15], s52 offen
    v_lshlrev_b32 v112, 16, v148
    v_and_b32 v113, 0xffff0000, v148
    v_lshlrev_b32 v114, 16, v149
    v_and_b32 v115, 0xffff0000, v149
    v_pk_mul_f32 v[112:113], v[112:113], v[40:41]
    v_pk_mul_f32 v[114:115], v[114:115], v[42:43]
    s_add_u32 s52, s51, 0x88000
    v_cvt_pk_bf16_f32 v112, 0, v112
    v_cvt_pk_bf16_f32 v113, 0, v113
    v_cvt_pk_bf16_f32 v114, 0, v114
    v_cvt_pk_bf16_f32 v115, 0, v115
    v_pk_add_f32 v[88:89], v[88:89], v[112:113]
    v_pk_add_f32 v[90:91], v[90:91], v[114:115]
    buffer_store_dwordx4 v[88:91], v25, s[12:15], s52 offen
    v_lshlrev_b32 v116, 16, v150
    v_and_b32 v117, 0xffff0000, v150
    v_lshlrev_b32 v118, 16, v151
    v_and_b32 v119, 0xffff0000, v151
    v_pk_mul_f32 v[116:117], v[116:117], v[40:41]
    v_pk_mul_f32 v[118:119], v[118:119], v[42:43]
    s_add_u32 s52, s51, 0x8c000
    v_cvt_pk_bf16_f32 v116, 0, v116
    v_cvt_pk_bf16_f32 v117, 0, v117
    v_cvt_pk_bf16_f32 v118, 0, v118
    v_cvt_pk_bf16_f32 v119, 0, v119
    v_pk_add_f32 v[92:93], v[92:93], v[116:117]
    v_pk_add_f32 v[94:95], v[94:95], v[118:119]
    buffer_store_dwordx4 v[92:95], v25, s[12:15], s52 offen
    v_lshlrev_b32 v112, 16, v152
    v_and_b32 v113, 0xffff0000, v152
    v_lshlrev_b32 v114, 16, v153
    v_and_b32 v115, 0xffff0000, v153
    v_pk_mul_f32 v[112:113], v[112:113], v[40:41]
    v_pk_mul_f32 v[114:115], v[114:115], v[42:43]
    s_add_u32 s52, s51, 0xc0000
    v_cvt_pk_bf16_f32 v112, 0, v112
    v_cvt_pk_bf16_f32 v113, 0, v113
    v_cvt_pk_bf16_f32 v114, 0, v114
    v_cvt_pk_bf16_f32 v115, 0, v115
    v_pk_add_f32 v[96:97], v[96:97], v[112:113]
    v_pk_add_f32 v[98:99], v[98:99], v[114:115]
    buffer_store_dwordx4 v[96:99], v25, s[12:15], s52 offen
    v_lshlrev_b32 v116, 16, v154
    v_and_b32 v117, 0xffff0000, v154
    v_lshlrev_b32 v118, 16, v155
    v_and_b32 v119, 0xffff0000, v155
    v_pk_mul_f32 v[116:117], v[116:117], v[40:41]
    v_pk_mul_f32 v[118:119], v[118:119], v[42:43]
    s_add_u32 s52, s51, 0xc4000
    v_cvt_pk_bf16_f32 v116, 0, v116
    v_cvt_pk_bf16_f32 v117, 0, v117
    v_cvt_pk_bf16_f32 v118, 0, v118
    v_cvt_pk_bf16_f32 v119, 0, v119
    v_pk_add_f32 v[100:101], v[100:101], v[116:117]
    v_pk_add_f32 v[102:103], v[102:103], v[118:119]
    buffer_store_dwordx4 v[100:103], v25, s[12:15], s52 offen
    v_lshlrev_b32 v112, 16, v156
    v_and_b32 v113, 0xffff0000, v156
    v_lshlrev_b32 v114, 16, v157
    v_and_b32 v115, 0xffff0000, v157
    v_pk_mul_f32 v[112:113], v[112:113], v[40:41]
    v_pk_mul_f32 v[114:115], v[114:115], v[42:43]
    s_add_u32 s52, s51, 0xc8000
    v_cvt_pk_bf16_f32 v112, 0, v112
    v_cvt_pk_bf16_f32 v113, 0, v113
    v_cvt_pk_bf16_f32 v114, 0, v114
    v_cvt_pk_bf16_f32 v115, 0, v115
    v_pk_add_f32 v[104:105], v[104:105], v[112:113]
    v_pk_add_f32 v[106:107], v[106:107], v[114:115]
    buffer_store_dwordx4 v[104:107], v25, s[12:15], s52 offen
    v_lshlrev_b32 v116, 16, v158
    v_and_b32 v117, 0xffff0000, v158
    v_lshlrev_b32 v118, 16, v159
    v_and_b32 v119, 0xffff0000, v159
    v_pk_mul_f32 v[116:117], v[116:117], v[40:41]
    v_pk_mul_f32 v[118:119], v[118:119], v[42:43]
    s_add_u32 s52, s51, 0xcc000
    v_cvt_pk_bf16_f32 v116, 0, v116
    v_cvt_pk_bf16_f32 v117, 0, v117
    v_cvt_pk_bf16_f32 v118, 0, v118
    v_cvt_pk_bf16_f32 v119, 0, v119
    v_pk_add_f32 v[108:109], v[108:109], v[116:117]
    v_pk_add_f32 v[110:111], v[110:111], v[118:119]
    buffer_store_dwordx4 v[108:111], v25, s[12:15], s52 offen
    s_add_u32 s53, s50, 0x28000
    buffer_load_dwordx2 v[208:209], v24, s[8:11], s53 offen
    s_add_u32 s53, s50, 0x29000
    buffer_load_dwordx2 v[210:211], v24, s[8:11], s53 offen
    s_add_u32 s53, s50, 0x2a000
    buffer_load_dwordx2 v[212:213], v24, s[8:11], s53 offen
    s_add_u32 s53, s50, 0x2b000
    buffer_load_dwordx2 v[214:215], v24, s[8:11], s53 offen
    s_add_u32 s53, s50, 0x38000
    buffer_load_dwordx2 v[216:217], v24, s[8:11], s53 offen
    s_add_u32 s53, s50, 0x39000
    buffer_load_dwordx2 v[218:219], v24, s[8:11], s53 offen
    s_add_u32 s53, s50, 0x3a000
    buffer_load_dwordx2 v[220:221], v24, s[8:11], s53 offen
    s_add_u32 s53, s50, 0x3b000
    buffer_load_dwordx2 v[222:223], v24, s[8:11], s53 offen
    s_waitcnt vmcnt(40) lgkmcnt(8)
    ds_read_b128 v[80:83], v28 offset:25344
    ds_read_b128 v[84:87], v28 offset:26400
    ds_read_b128 v[88:91], v28 offset:27456
    ds_read_b128 v[92:95], v28 offset:28512
    ds_read_b128 v[96:99], v28 offset:29568
    ds_read_b128 v[100:103], v28 offset:30624
    ds_read_b128 v[104:107], v28 offset:31680
    ds_read_b128 v[108:111], v28 offset:32736
    ds_write_b128 v27, a[16:19] offset:0
    ds_write_b128 v27, a[48:51] offset:64
    ds_write_b128 v27, a[80:83] offset:128
    ds_write_b128 v27, a[112:115] offset:192
    ds_write_b128 v27, a[144:147] offset:256
    ds_write_b128 v27, a[176:179] offset:320
    ds_write_b128 v27, a[208:211] offset:384
    ds_write_b128 v27, a[240:243] offset:448
    v_lshlrev_b32 v112, 16, v160
    v_and_b32 v113, 0xffff0000, v160
    v_lshlrev_b32 v114, 16, v161
    v_and_b32 v115, 0xffff0000, v161
    v_pk_mul_f32 v[112:113], v[112:113], v[40:41]
    v_pk_mul_f32 v[114:115], v[114:115], v[42:43]
    s_add_u32 s52, s51, 0x10000
    v_cvt_pk_bf16_f32 v112, 0, v112
    v_cvt_pk_bf16_f32 v113, 0, v113
    v_cvt_pk_bf16_f32 v114, 0, v114
    v_cvt_pk_bf16_f32 v115, 0, v115
    v_pk_add_f32 v[48:49], v[48:49], v[112:113]
    v_pk_add_f32 v[50:51], v[50:51], v[114:115]
    buffer_store_dwordx4 v[48:51], v25, s[12:15], s52 offen
    v_lshlrev_b32 v116, 16, v162
    v_and_b32 v117, 0xffff0000, v162
    v_lshlrev_b32 v118, 16, v163
    v_and_b32 v119, 0xffff0000, v163
    v_pk_mul_f32 v[116:117], v[116:117], v[40:41]
    v_pk_mul_f32 v[118:119], v[118:119], v[42:43]
    s_add_u32 s52, s51, 0x14000
    v_cvt_pk_bf16_f32 v116, 0, v116
    v_cvt_pk_bf16_f32 v117, 0, v117
    v_cvt_pk_bf16_f32 v118, 0, v118
    v_cvt_pk_bf16_f32 v119, 0, v119
    v_pk_add_f32 v[52:53], v[52:53], v[116:117]
    v_pk_add_f32 v[54:55], v[54:55], v[118:119]
    buffer_store_dwordx4 v[52:55], v25, s[12:15], s52 offen
    v_lshlrev_b32 v112, 16, v164
    v_and_b32 v113, 0xffff0000, v164
    v_lshlrev_b32 v114, 16, v165
    v_and_b32 v115, 0xffff0000, v165
    v_pk_mul_f32 v[112:113], v[112:113], v[40:41]
    v_pk_mul_f32 v[114:115], v[114:115], v[42:43]
    s_add_u32 s52, s51, 0x18000
    v_cvt_pk_bf16_f32 v112, 0, v112
    v_cvt_pk_bf16_f32 v113, 0, v113
    v_cvt_pk_bf16_f32 v114, 0, v114
    v_cvt_pk_bf16_f32 v115, 0, v115
    v_pk_add_f32 v[56:57], v[56:57], v[112:113]
    v_pk_add_f32 v[58:59], v[58:59], v[114:115]
    buffer_store_dwordx4 v[56:59], v25, s[12:15], s52 offen
    v_lshlrev_b32 v116, 16, v166
    v_and_b32 v117, 0xffff0000, v166
    v_lshlrev_b32 v118, 16, v167
    v_and_b32 v119, 0xffff0000, v167
    v_pk_mul_f32 v[116:117], v[116:117], v[40:41]
    v_pk_mul_f32 v[118:119], v[118:119], v[42:43]
    s_add_u32 s52, s51, 0x1c000
    v_cvt_pk_bf16_f32 v116, 0, v116
    v_cvt_pk_bf16_f32 v117, 0, v117
    v_cvt_pk_bf16_f32 v118, 0, v118
    v_cvt_pk_bf16_f32 v119, 0, v119
    v_pk_add_f32 v[60:61], v[60:61], v[116:117]
    v_pk_add_f32 v[62:63], v[62:63], v[118:119]
    buffer_store_dwordx4 v[60:63], v25, s[12:15], s52 offen
    v_lshlrev_b32 v112, 16, v168
    v_and_b32 v113, 0xffff0000, v168
    v_lshlrev_b32 v114, 16, v169
    v_and_b32 v115, 0xffff0000, v169
    v_pk_mul_f32 v[112:113], v[112:113], v[40:41]
    v_pk_mul_f32 v[114:115], v[114:115], v[42:43]
    s_add_u32 s52, s51, 0x50000
    v_cvt_pk_bf16_f32 v112, 0, v112
    v_cvt_pk_bf16_f32 v113, 0, v113
    v_cvt_pk_bf16_f32 v114, 0, v114
    v_cvt_pk_bf16_f32 v115, 0, v115
    v_pk_add_f32 v[64:65], v[64:65], v[112:113]
    v_pk_add_f32 v[66:67], v[66:67], v[114:115]
    buffer_store_dwordx4 v[64:67], v25, s[12:15], s52 offen
    v_lshlrev_b32 v116, 16, v170
    v_and_b32 v117, 0xffff0000, v170
    v_lshlrev_b32 v118, 16, v171
    v_and_b32 v119, 0xffff0000, v171
    v_pk_mul_f32 v[116:117], v[116:117], v[40:41]
    v_pk_mul_f32 v[118:119], v[118:119], v[42:43]
    s_add_u32 s52, s51, 0x54000
    v_cvt_pk_bf16_f32 v116, 0, v116
    v_cvt_pk_bf16_f32 v117, 0, v117
    v_cvt_pk_bf16_f32 v118, 0, v118
    v_cvt_pk_bf16_f32 v119, 0, v119
    v_pk_add_f32 v[68:69], v[68:69], v[116:117]
    v_pk_add_f32 v[70:71], v[70:71], v[118:119]
    buffer_store_dwordx4 v[68:71], v25, s[12:15], s52 offen
    v_lshlrev_b32 v112, 16, v172
    v_and_b32 v113, 0xffff0000, v172
    v_lshlrev_b32 v114, 16, v173
    v_and_b32 v115, 0xffff0000, v173
    v_pk_mul_f32 v[112:113], v[112:113], v[40:41]
    v_pk_mul_f32 v[114:115], v[114:115], v[42:43]
    s_add_u32 s52, s51, 0x58000
    v_cvt_pk_bf16_f32 v112, 0, v112
    v_cvt_pk_bf16_f32 v113, 0, v113
    v_cvt_pk_bf16_f32 v114, 0, v114
    v_cvt_pk_bf16_f32 v115, 0, v115
    v_pk_add_f32 v[72:73], v[72:73], v[112:113]
    v_pk_add_f32 v[74:75], v[74:75], v[114:115]
    buffer_store_dwordx4 v[72:75], v25, s[12:15], s52 offen
    v_lshlrev_b32 v116, 16, v174
    v_and_b32 v117, 0xffff0000, v174
    v_lshlrev_b32 v118, 16, v175
    v_and_b32 v119, 0xffff0000, v175
    v_pk_mul_f32 v[116:117], v[116:117], v[40:41]
    v_pk_mul_f32 v[118:119], v[118:119], v[42:43]
    s_add_u32 s52, s51, 0x5c000
    v_cvt_pk_bf16_f32 v116, 0, v116
    v_cvt_pk_bf16_f32 v117, 0, v117
    v_cvt_pk_bf16_f32 v118, 0, v118
    v_cvt_pk_bf16_f32 v119, 0, v119
    v_pk_add_f32 v[76:77], v[76:77], v[116:117]
    v_pk_add_f32 v[78:79], v[78:79], v[118:119]
    buffer_store_dwordx4 v[76:79], v25, s[12:15], s52 offen
    s_add_u32 s53, s50, 0xc000
    buffer_load_dwordx2 v[224:225], v24, s[8:11], s53 offen
    s_add_u32 s53, s50, 0xd000
    buffer_load_dwordx2 v[226:227], v24, s[8:11], s53 offen
    s_add_u32 s53, s50, 0xe000
    buffer_load_dwordx2 v[228:229], v24, s[8:11], s53 offen
    s_add_u32 s53, s50, 0xf000
    buffer_load_dwordx2 v[230:231], v24, s[8:11], s53 offen
    s_add_u32 s53, s50, 0x1c000
    buffer_load_dwordx2 v[232:233], v24, s[8:11], s53 offen
    s_add_u32 s53, s50, 0x1d000
    buffer_load_dwordx2 v[234:235], v24, s[8:11], s53 offen
    s_add_u32 s53, s50, 0x1e000
    buffer_load_dwordx2 v[236:237], v24, s[8:11], s53 offen
    s_add_u32 s53, s50, 0x1f000
    buffer_load_dwordx2 v[238:239], v24, s[8:11], s53 offen
    s_waitcnt vmcnt(48) lgkmcnt(8)
    ds_read_b128 v[48:51], v28 offset:0
    ds_read_b128 v[52:55], v28 offset:1056
    ds_read_b128 v[56:59], v28 offset:2112
    ds_read_b128 v[60:63], v28 offset:3168
    ds_read_b128 v[64:67], v28 offset:4224
    ds_read_b128 v[68:71], v28 offset:5280
    ds_read_b128 v[72:75], v28 offset:6336
    ds_read_b128 v[76:79], v28 offset:7392
    ds_write_b128 v27, a[20:23] offset:8448
    ds_write_b128 v27, a[52:55] offset:8512
    ds_write_b128 v27, a[84:87] offset:8576
    ds_write_b128 v27, a[116:119] offset:8640
    ds_write_b128 v27, a[148:151] offset:8704
    ds_write_b128 v27, a[180:183] offset:8768
    ds_write_b128 v27, a[212:215] offset:8832
    ds_write_b128 v27, a[244:247] offset:8896
    v_lshlrev_b32 v112, 16, v176
    v_and_b32 v113, 0xffff0000, v176
    v_lshlrev_b32 v114, 16, v177
    v_and_b32 v115, 0xffff0000, v177
    v_pk_mul_f32 v[112:113], v[112:113], v[40:41]
    v_pk_mul_f32 v[114:115], v[114:115], v[42:43]
    s_add_u32 s52, s51, 0x90000
    v_cvt_pk_bf16_f32 v112, 0, v112
    v_cvt_pk_bf16_f32 v113, 0, v113
    v_cvt_pk_bf16_f32 v114, 0, v114
    v_cvt_pk_bf16_f32 v115, 0, v115
    v_pk_add_f32 v[80:81], v[80:81], v[112:113]
    v_pk_add_f32 v[82:83], v[82:83], v[114:115]
    buffer_store_dwordx4 v[80:83], v25, s[12:15], s52 offen
    v_lshlrev_b32 v116, 16, v178
    v_and_b32 v117, 0xffff0000, v178
    v_lshlrev_b32 v118, 16, v179
    v_and_b32 v119, 0xffff0000, v179
    v_pk_mul_f32 v[116:117], v[116:117], v[40:41]
    v_pk_mul_f32 v[118:119], v[118:119], v[42:43]
    s_add_u32 s52, s51, 0x94000
    v_cvt_pk_bf16_f32 v116, 0, v116
    v_cvt_pk_bf16_f32 v117, 0, v117
    v_cvt_pk_bf16_f32 v118, 0, v118
    v_cvt_pk_bf16_f32 v119, 0, v119
    v_pk_add_f32 v[84:85], v[84:85], v[116:117]
    v_pk_add_f32 v[86:87], v[86:87], v[118:119]
    buffer_store_dwordx4 v[84:87], v25, s[12:15], s52 offen
    v_lshlrev_b32 v112, 16, v180
    v_and_b32 v113, 0xffff0000, v180
    v_lshlrev_b32 v114, 16, v181
    v_and_b32 v115, 0xffff0000, v181
    v_pk_mul_f32 v[112:113], v[112:113], v[40:41]
    v_pk_mul_f32 v[114:115], v[114:115], v[42:43]
    s_add_u32 s52, s51, 0x98000
    v_cvt_pk_bf16_f32 v112, 0, v112
    v_cvt_pk_bf16_f32 v113, 0, v113
    v_cvt_pk_bf16_f32 v114, 0, v114
    v_cvt_pk_bf16_f32 v115, 0, v115
    v_pk_add_f32 v[88:89], v[88:89], v[112:113]
    v_pk_add_f32 v[90:91], v[90:91], v[114:115]
    buffer_store_dwordx4 v[88:91], v25, s[12:15], s52 offen
    v_lshlrev_b32 v116, 16, v182
    v_and_b32 v117, 0xffff0000, v182
    v_lshlrev_b32 v118, 16, v183
    v_and_b32 v119, 0xffff0000, v183
    v_pk_mul_f32 v[116:117], v[116:117], v[40:41]
    v_pk_mul_f32 v[118:119], v[118:119], v[42:43]
    s_add_u32 s52, s51, 0x9c000
    v_cvt_pk_bf16_f32 v116, 0, v116
    v_cvt_pk_bf16_f32 v117, 0, v117
    v_cvt_pk_bf16_f32 v118, 0, v118
    v_cvt_pk_bf16_f32 v119, 0, v119
    v_pk_add_f32 v[92:93], v[92:93], v[116:117]
    v_pk_add_f32 v[94:95], v[94:95], v[118:119]
    buffer_store_dwordx4 v[92:95], v25, s[12:15], s52 offen
    v_lshlrev_b32 v112, 16, v184
    v_and_b32 v113, 0xffff0000, v184
    v_lshlrev_b32 v114, 16, v185
    v_and_b32 v115, 0xffff0000, v185
    v_pk_mul_f32 v[112:113], v[112:113], v[40:41]
    v_pk_mul_f32 v[114:115], v[114:115], v[42:43]
    s_add_u32 s52, s51, 0xd0000
    v_cvt_pk_bf16_f32 v112, 0, v112
    v_cvt_pk_bf16_f32 v113, 0, v113
    v_cvt_pk_bf16_f32 v114, 0, v114
    v_cvt_pk_bf16_f32 v115, 0, v115
    v_pk_add_f32 v[96:97], v[96:97], v[112:113]
    v_pk_add_f32 v[98:99], v[98:99], v[114:115]
    buffer_store_dwordx4 v[96:99], v25, s[12:15], s52 offen
    v_lshlrev_b32 v116, 16, v186
    v_and_b32 v117, 0xffff0000, v186
    v_lshlrev_b32 v118, 16, v187
    v_and_b32 v119, 0xffff0000, v187
    v_pk_mul_f32 v[116:117], v[116:117], v[40:41]
    v_pk_mul_f32 v[118:119], v[118:119], v[42:43]
    s_add_u32 s52, s51, 0xd4000
    v_cvt_pk_bf16_f32 v116, 0, v116
    v_cvt_pk_bf16_f32 v117, 0, v117
    v_cvt_pk_bf16_f32 v118, 0, v118
    v_cvt_pk_bf16_f32 v119, 0, v119
    v_pk_add_f32 v[100:101], v[100:101], v[116:117]
    v_pk_add_f32 v[102:103], v[102:103], v[118:119]
    buffer_store_dwordx4 v[100:103], v25, s[12:15], s52 offen
    v_lshlrev_b32 v112, 16, v188
    v_and_b32 v113, 0xffff0000, v188
    v_lshlrev_b32 v114, 16, v189
    v_and_b32 v115, 0xffff0000, v189
    v_pk_mul_f32 v[112:113], v[112:113], v[40:41]
    v_pk_mul_f32 v[114:115], v[114:115], v[42:43]
    s_add_u32 s52, s51, 0xd8000
    v_cvt_pk_bf16_f32 v112, 0, v112
    v_cvt_pk_bf16_f32 v113, 0, v113
    v_cvt_pk_bf16_f32 v114, 0, v114
    v_cvt_pk_bf16_f32 v115, 0, v115
    v_pk_add_f32 v[104:105], v[104:105], v[112:113]
    v_pk_add_f32 v[106:107], v[106:107], v[114:115]
    buffer_store_dwordx4 v[104:107], v25, s[12:15], s52 offen
    v_lshlrev_b32 v116, 16, v190
    v_and_b32 v117, 0xffff0000, v190
    v_lshlrev_b32 v118, 16, v191
    v_and_b32 v119, 0xffff0000, v191
    v_pk_mul_f32 v[116:117], v[116:117], v[40:41]
    v_pk_mul_f32 v[118:119], v[118:119], v[42:43]
    s_add_u32 s52, s51, 0xdc000
    v_cvt_pk_bf16_f32 v116, 0, v116
    v_cvt_pk_bf16_f32 v117, 0, v117
    v_cvt_pk_bf16_f32 v118, 0, v118
    v_cvt_pk_bf16_f32 v119, 0, v119
    v_pk_add_f32 v[108:109], v[108:109], v[116:117]
    v_pk_add_f32 v[110:111], v[110:111], v[118:119]
    buffer_store_dwordx4 v[108:111], v25, s[12:15], s52 offen
    s_add_u32 s53, s50, 0x2c000
    buffer_load_dwordx2 v[240:241], v24, s[8:11], s53 offen
    s_add_u32 s53, s50, 0x2d000
    buffer_load_dwordx2 v[242:243], v24, s[8:11], s53 offen
    s_add_u32 s53, s50, 0x2e000
    buffer_load_dwordx2 v[244:245], v24, s[8:11], s53 offen
    s_add_u32 s53, s50, 0x2f000
    buffer_load_dwordx2 v[246:247], v24, s[8:11], s53 offen
    s_add_u32 s53, s50, 0x3c000
    buffer_load_dwordx2 v[248:249], v24, s[8:11], s53 offen
    s_add_u32 s53, s50, 0x3d000
    buffer_load_dwordx2 v[250:251], v24, s[8:11], s53 offen
    s_add_u32 s53, s50, 0x3e000
    buffer_load_dwordx2 v[252:253], v24, s[8:11], s53 offen
    s_add_u32 s53, s50, 0x3f000
    buffer_load_dwordx2 v[254:255], v24, s[8:11], s53 offen
    s_waitcnt vmcnt(48) lgkmcnt(8)
    ds_read_b128 v[80:83], v28 offset:8448
    ds_read_b128 v[84:87], v28 offset:9504
    ds_read_b128 v[88:91], v28 offset:10560
    ds_read_b128 v[92:95], v28 offset:11616
    ds_read_b128 v[96:99], v28 offset:12672
    ds_read_b128 v[100:103], v28 offset:13728
    ds_read_b128 v[104:107], v28 offset:14784
    ds_read_b128 v[108:111], v28 offset:15840
    ds_write_b128 v27, a[24:27] offset:16896
    ds_write_b128 v27, a[56:59] offset:16960
    ds_write_b128 v27, a[88:91] offset:17024
    ds_write_b128 v27, a[120:123] offset:17088
    ds_write_b128 v27, a[152:155] offset:17152
    ds_write_b128 v27, a[184:187] offset:17216
    ds_write_b128 v27, a[216:219] offset:17280
    ds_write_b128 v27, a[248:251] offset:17344
    v_lshlrev_b32 v112, 16, v192
    v_and_b32 v113, 0xffff0000, v192
    v_lshlrev_b32 v114, 16, v193
    v_and_b32 v115, 0xffff0000, v193
    v_pk_mul_f32 v[112:113], v[112:113], v[40:41]
    v_pk_mul_f32 v[114:115], v[114:115], v[42:43]
    s_add_u32 s52, s51, 0x20000
    v_cvt_pk_bf16_f32 v112, 0, v112
    v_cvt_pk_bf16_f32 v113, 0, v113
    v_cvt_pk_bf16_f32 v114, 0, v114
    v_cvt_pk_bf16_f32 v115, 0, v115
    v_pk_add_f32 v[48:49], v[48:49], v[112:113]
    v_pk_add_f32 v[50:51], v[50:51], v[114:115]
    buffer_store_dwordx4 v[48:51], v25, s[12:15], s52 offen
    v_lshlrev_b32 v116, 16, v194
    v_and_b32 v117, 0xffff0000, v194
    v_lshlrev_b32 v118, 16, v195
    v_and_b32 v119, 0xffff0000, v195
    v_pk_mul_f32 v[116:117], v[116:117], v[40:41]
    v_pk_mul_f32 v[118:119], v[118:119], v[42:43]
    s_add_u32 s52, s51, 0x24000
    v_cvt_pk_bf16_f32 v116, 0, v116
    v_cvt_pk_bf16_f32 v117, 0, v117
    v_cvt_pk_bf16_f32 v118, 0, v118
    v_cvt_pk_bf16_f32 v119, 0, v119
    v_pk_add_f32 v[52:53], v[52:53], v[116:117]
    v_pk_add_f32 v[54:55], v[54:55], v[118:119]
    buffer_store_dwordx4 v[52:55], v25, s[12:15], s52 offen
    v_lshlrev_b32 v112, 16, v196
    v_and_b32 v113, 0xffff0000, v196
    v_lshlrev_b32 v114, 16, v197
    v_and_b32 v115, 0xffff0000, v197
    v_pk_mul_f32 v[112:113], v[112:113], v[40:41]
    v_pk_mul_f32 v[114:115], v[114:115], v[42:43]
    s_add_u32 s52, s51, 0x28000
    v_cvt_pk_bf16_f32 v112, 0, v112
    v_cvt_pk_bf16_f32 v113, 0, v113
    v_cvt_pk_bf16_f32 v114, 0, v114
    v_cvt_pk_bf16_f32 v115, 0, v115
    v_pk_add_f32 v[56:57], v[56:57], v[112:113]
    v_pk_add_f32 v[58:59], v[58:59], v[114:115]
    buffer_store_dwordx4 v[56:59], v25, s[12:15], s52 offen
    v_lshlrev_b32 v116, 16, v198
    v_and_b32 v117, 0xffff0000, v198
    v_lshlrev_b32 v118, 16, v199
    v_and_b32 v119, 0xffff0000, v199
    v_pk_mul_f32 v[116:117], v[116:117], v[40:41]
    v_pk_mul_f32 v[118:119], v[118:119], v[42:43]
    s_add_u32 s52, s51, 0x2c000
    v_cvt_pk_bf16_f32 v116, 0, v116
    v_cvt_pk_bf16_f32 v117, 0, v117
    v_cvt_pk_bf16_f32 v118, 0, v118
    v_cvt_pk_bf16_f32 v119, 0, v119
    v_pk_add_f32 v[60:61], v[60:61], v[116:117]
    v_pk_add_f32 v[62:63], v[62:63], v[118:119]
    buffer_store_dwordx4 v[60:63], v25, s[12:15], s52 offen
    v_lshlrev_b32 v112, 16, v200
    v_and_b32 v113, 0xffff0000, v200
    v_lshlrev_b32 v114, 16, v201
    v_and_b32 v115, 0xffff0000, v201
    v_pk_mul_f32 v[112:113], v[112:113], v[40:41]
    v_pk_mul_f32 v[114:115], v[114:115], v[42:43]
    s_add_u32 s52, s51, 0x60000
    v_cvt_pk_bf16_f32 v112, 0, v112
    v_cvt_pk_bf16_f32 v113, 0, v113
    v_cvt_pk_bf16_f32 v114, 0, v114
    v_cvt_pk_bf16_f32 v115, 0, v115
    v_pk_add_f32 v[64:65], v[64:65], v[112:113]
    v_pk_add_f32 v[66:67], v[66:67], v[114:115]
    buffer_store_dwordx4 v[64:67], v25, s[12:15], s52 offen
    v_lshlrev_b32 v116, 16, v202
    v_and_b32 v117, 0xffff0000, v202
    v_lshlrev_b32 v118, 16, v203
    v_and_b32 v119, 0xffff0000, v203
    v_pk_mul_f32 v[116:117], v[116:117], v[40:41]
    v_pk_mul_f32 v[118:119], v[118:119], v[42:43]
    s_add_u32 s52, s51, 0x64000
    v_cvt_pk_bf16_f32 v116, 0, v116
    v_cvt_pk_bf16_f32 v117, 0, v117
    v_cvt_pk_bf16_f32 v118, 0, v118
    v_cvt_pk_bf16_f32 v119, 0, v119
    v_pk_add_f32 v[68:69], v[68:69], v[116:117]
    v_pk_add_f32 v[70:71], v[70:71], v[118:119]
    buffer_store_dwordx4 v[68:71], v25, s[12:15], s52 offen
    v_lshlrev_b32 v112, 16, v204
    v_and_b32 v113, 0xffff0000, v204
    v_lshlrev_b32 v114, 16, v205
    v_and_b32 v115, 0xffff0000, v205
    v_pk_mul_f32 v[112:113], v[112:113], v[40:41]
    v_pk_mul_f32 v[114:115], v[114:115], v[42:43]
    s_add_u32 s52, s51, 0x68000
    v_cvt_pk_bf16_f32 v112, 0, v112
    v_cvt_pk_bf16_f32 v113, 0, v113
    v_cvt_pk_bf16_f32 v114, 0, v114
    v_cvt_pk_bf16_f32 v115, 0, v115
    v_pk_add_f32 v[72:73], v[72:73], v[112:113]
    v_pk_add_f32 v[74:75], v[74:75], v[114:115]
    buffer_store_dwordx4 v[72:75], v25, s[12:15], s52 offen
    v_lshlrev_b32 v116, 16, v206
    v_and_b32 v117, 0xffff0000, v206
    v_lshlrev_b32 v118, 16, v207
    v_and_b32 v119, 0xffff0000, v207
    v_pk_mul_f32 v[116:117], v[116:117], v[40:41]
    v_pk_mul_f32 v[118:119], v[118:119], v[42:43]
    s_add_u32 s52, s51, 0x6c000
    v_cvt_pk_bf16_f32 v116, 0, v116
    v_cvt_pk_bf16_f32 v117, 0, v117
    v_cvt_pk_bf16_f32 v118, 0, v118
    v_cvt_pk_bf16_f32 v119, 0, v119
    v_pk_add_f32 v[76:77], v[76:77], v[116:117]
    v_pk_add_f32 v[78:79], v[78:79], v[118:119]
    buffer_store_dwordx4 v[76:79], v25, s[12:15], s52 offen
    s_waitcnt vmcnt(40) lgkmcnt(8)
    ds_read_b128 v[48:51], v28 offset:16896
    ds_read_b128 v[52:55], v28 offset:17952
    ds_read_b128 v[56:59], v28 offset:19008
    ds_read_b128 v[60:63], v28 offset:20064
    ds_read_b128 v[64:67], v28 offset:21120
    ds_read_b128 v[68:71], v28 offset:22176
    ds_read_b128 v[72:75], v28 offset:23232
    ds_read_b128 v[76:79], v28 offset:24288
    ds_write_b128 v27, a[28:31] offset:25344
    ds_write_b128 v27, a[60:63] offset:25408
    ds_write_b128 v27, a[92:95] offset:25472
    ds_write_b128 v27, a[124:127] offset:25536
    ds_write_b128 v27, a[156:159] offset:25600
    ds_write_b128 v27, a[188:191] offset:25664
    ds_write_b128 v27, a[220:223] offset:25728
    ds_write_b128 v27, a[252:255] offset:25792
    v_lshlrev_b32 v112, 16, v208
    v_and_b32 v113, 0xffff0000, v208
    v_lshlrev_b32 v114, 16, v209
    v_and_b32 v115, 0xffff0000, v209
    v_pk_mul_f32 v[112:113], v[112:113], v[40:41]
    v_pk_mul_f32 v[114:115], v[114:115], v[42:43]
    s_add_u32 s52, s51, 0xa0000
    v_cvt_pk_bf16_f32 v112, 0, v112
    v_cvt_pk_bf16_f32 v113, 0, v113
    v_cvt_pk_bf16_f32 v114, 0, v114
    v_cvt_pk_bf16_f32 v115, 0, v115
    v_pk_add_f32 v[80:81], v[80:81], v[112:113]
    v_pk_add_f32 v[82:83], v[82:83], v[114:115]
    buffer_store_dwordx4 v[80:83], v25, s[12:15], s52 offen
    v_lshlrev_b32 v116, 16, v210
    v_and_b32 v117, 0xffff0000, v210
    v_lshlrev_b32 v118, 16, v211
    v_and_b32 v119, 0xffff0000, v211
    v_pk_mul_f32 v[116:117], v[116:117], v[40:41]
    v_pk_mul_f32 v[118:119], v[118:119], v[42:43]
    s_add_u32 s52, s51, 0xa4000
    v_cvt_pk_bf16_f32 v116, 0, v116
    v_cvt_pk_bf16_f32 v117, 0, v117
    v_cvt_pk_bf16_f32 v118, 0, v118
    v_cvt_pk_bf16_f32 v119, 0, v119
    v_pk_add_f32 v[84:85], v[84:85], v[116:117]
    v_pk_add_f32 v[86:87], v[86:87], v[118:119]
    buffer_store_dwordx4 v[84:87], v25, s[12:15], s52 offen
    v_lshlrev_b32 v112, 16, v212
    v_and_b32 v113, 0xffff0000, v212
    v_lshlrev_b32 v114, 16, v213
    v_and_b32 v115, 0xffff0000, v213
    v_pk_mul_f32 v[112:113], v[112:113], v[40:41]
    v_pk_mul_f32 v[114:115], v[114:115], v[42:43]
    s_add_u32 s52, s51, 0xa8000
    v_cvt_pk_bf16_f32 v112, 0, v112
    v_cvt_pk_bf16_f32 v113, 0, v113
    v_cvt_pk_bf16_f32 v114, 0, v114
    v_cvt_pk_bf16_f32 v115, 0, v115
    v_pk_add_f32 v[88:89], v[88:89], v[112:113]
    v_pk_add_f32 v[90:91], v[90:91], v[114:115]
    buffer_store_dwordx4 v[88:91], v25, s[12:15], s52 offen
    v_lshlrev_b32 v116, 16, v214
    v_and_b32 v117, 0xffff0000, v214
    v_lshlrev_b32 v118, 16, v215
    v_and_b32 v119, 0xffff0000, v215
    v_pk_mul_f32 v[116:117], v[116:117], v[40:41]
    v_pk_mul_f32 v[118:119], v[118:119], v[42:43]
    s_add_u32 s52, s51, 0xac000
    v_cvt_pk_bf16_f32 v116, 0, v116
    v_cvt_pk_bf16_f32 v117, 0, v117
    v_cvt_pk_bf16_f32 v118, 0, v118
    v_cvt_pk_bf16_f32 v119, 0, v119
    v_pk_add_f32 v[92:93], v[92:93], v[116:117]
    v_pk_add_f32 v[94:95], v[94:95], v[118:119]
    buffer_store_dwordx4 v[92:95], v25, s[12:15], s52 offen
    v_lshlrev_b32 v112, 16, v216
    v_and_b32 v113, 0xffff0000, v216
    v_lshlrev_b32 v114, 16, v217
    v_and_b32 v115, 0xffff0000, v217
    v_pk_mul_f32 v[112:113], v[112:113], v[40:41]
    v_pk_mul_f32 v[114:115], v[114:115], v[42:43]
    s_add_u32 s52, s51, 0xe0000
    v_cvt_pk_bf16_f32 v112, 0, v112
    v_cvt_pk_bf16_f32 v113, 0, v113
    v_cvt_pk_bf16_f32 v114, 0, v114
    v_cvt_pk_bf16_f32 v115, 0, v115
    v_pk_add_f32 v[96:97], v[96:97], v[112:113]
    v_pk_add_f32 v[98:99], v[98:99], v[114:115]
    buffer_store_dwordx4 v[96:99], v25, s[12:15], s52 offen
    v_lshlrev_b32 v116, 16, v218
    v_and_b32 v117, 0xffff0000, v218
    v_lshlrev_b32 v118, 16, v219
    v_and_b32 v119, 0xffff0000, v219
    v_pk_mul_f32 v[116:117], v[116:117], v[40:41]
    v_pk_mul_f32 v[118:119], v[118:119], v[42:43]
    s_add_u32 s52, s51, 0xe4000
    v_cvt_pk_bf16_f32 v116, 0, v116
    v_cvt_pk_bf16_f32 v117, 0, v117
    v_cvt_pk_bf16_f32 v118, 0, v118
    v_cvt_pk_bf16_f32 v119, 0, v119
    v_pk_add_f32 v[100:101], v[100:101], v[116:117]
    v_pk_add_f32 v[102:103], v[102:103], v[118:119]
    buffer_store_dwordx4 v[100:103], v25, s[12:15], s52 offen
    v_lshlrev_b32 v112, 16, v220
    v_and_b32 v113, 0xffff0000, v220
    v_lshlrev_b32 v114, 16, v221
    v_and_b32 v115, 0xffff0000, v221
    v_pk_mul_f32 v[112:113], v[112:113], v[40:41]
    v_pk_mul_f32 v[114:115], v[114:115], v[42:43]
    s_add_u32 s52, s51, 0xe8000
    v_cvt_pk_bf16_f32 v112, 0, v112
    v_cvt_pk_bf16_f32 v113, 0, v113
    v_cvt_pk_bf16_f32 v114, 0, v114
    v_cvt_pk_bf16_f32 v115, 0, v115
    v_pk_add_f32 v[104:105], v[104:105], v[112:113]
    v_pk_add_f32 v[106:107], v[106:107], v[114:115]
    buffer_store_dwordx4 v[104:107], v25, s[12:15], s52 offen
    v_lshlrev_b32 v116, 16, v222
    v_and_b32 v117, 0xffff0000, v222
    v_lshlrev_b32 v118, 16, v223
    v_and_b32 v119, 0xffff0000, v223
    v_pk_mul_f32 v[116:117], v[116:117], v[40:41]
    v_pk_mul_f32 v[118:119], v[118:119], v[42:43]
    s_add_u32 s52, s51, 0xec000
    v_cvt_pk_bf16_f32 v116, 0, v116
    v_cvt_pk_bf16_f32 v117, 0, v117
    v_cvt_pk_bf16_f32 v118, 0, v118
    v_cvt_pk_bf16_f32 v119, 0, v119
    v_pk_add_f32 v[108:109], v[108:109], v[116:117]
    v_pk_add_f32 v[110:111], v[110:111], v[118:119]
    buffer_store_dwordx4 v[108:111], v25, s[12:15], s52 offen
    s_waitcnt vmcnt(32) lgkmcnt(8)
    ds_read_b128 v[80:83], v28 offset:25344
    ds_read_b128 v[84:87], v28 offset:26400
    ds_read_b128 v[88:91], v28 offset:27456
    ds_read_b128 v[92:95], v28 offset:28512
    ds_read_b128 v[96:99], v28 offset:29568
    ds_read_b128 v[100:103], v28 offset:30624
    ds_read_b128 v[104:107], v28 offset:31680
    ds_read_b128 v[108:111], v28 offset:32736
    v_lshlrev_b32 v112, 16, v224
    v_and_b32 v113, 0xffff0000, v224
    v_lshlrev_b32 v114, 16, v225
    v_and_b32 v115, 0xffff0000, v225
    v_pk_mul_f32 v[112:113], v[112:113], v[40:41]
    v_pk_mul_f32 v[114:115], v[114:115], v[42:43]
    s_add_u32 s52, s51, 0x30000
    v_cvt_pk_bf16_f32 v112, 0, v112
    v_cvt_pk_bf16_f32 v113, 0, v113
    v_cvt_pk_bf16_f32 v114, 0, v114
    v_cvt_pk_bf16_f32 v115, 0, v115
    v_pk_add_f32 v[48:49], v[48:49], v[112:113]
    v_pk_add_f32 v[50:51], v[50:51], v[114:115]
    buffer_store_dwordx4 v[48:51], v25, s[12:15], s52 offen
    v_lshlrev_b32 v116, 16, v226
    v_and_b32 v117, 0xffff0000, v226
    v_lshlrev_b32 v118, 16, v227
    v_and_b32 v119, 0xffff0000, v227
    v_pk_mul_f32 v[116:117], v[116:117], v[40:41]
    v_pk_mul_f32 v[118:119], v[118:119], v[42:43]
    s_add_u32 s52, s51, 0x34000
    v_cvt_pk_bf16_f32 v116, 0, v116
    v_cvt_pk_bf16_f32 v117, 0, v117
    v_cvt_pk_bf16_f32 v118, 0, v118
    v_cvt_pk_bf16_f32 v119, 0, v119
    v_pk_add_f32 v[52:53], v[52:53], v[116:117]
    v_pk_add_f32 v[54:55], v[54:55], v[118:119]
    buffer_store_dwordx4 v[52:55], v25, s[12:15], s52 offen
    v_lshlrev_b32 v112, 16, v228
    v_and_b32 v113, 0xffff0000, v228
    v_lshlrev_b32 v114, 16, v229
    v_and_b32 v115, 0xffff0000, v229
    v_pk_mul_f32 v[112:113], v[112:113], v[40:41]
    v_pk_mul_f32 v[114:115], v[114:115], v[42:43]
    s_add_u32 s52, s51, 0x38000
    v_cvt_pk_bf16_f32 v112, 0, v112
    v_cvt_pk_bf16_f32 v113, 0, v113
    v_cvt_pk_bf16_f32 v114, 0, v114
    v_cvt_pk_bf16_f32 v115, 0, v115
    v_pk_add_f32 v[56:57], v[56:57], v[112:113]
    v_pk_add_f32 v[58:59], v[58:59], v[114:115]
    buffer_store_dwordx4 v[56:59], v25, s[12:15], s52 offen
    v_lshlrev_b32 v116, 16, v230
    v_and_b32 v117, 0xffff0000, v230
    v_lshlrev_b32 v118, 16, v231
    v_and_b32 v119, 0xffff0000, v231
    v_pk_mul_f32 v[116:117], v[116:117], v[40:41]
    v_pk_mul_f32 v[118:119], v[118:119], v[42:43]
    s_add_u32 s52, s51, 0x3c000
    v_cvt_pk_bf16_f32 v116, 0, v116
    v_cvt_pk_bf16_f32 v117, 0, v117
    v_cvt_pk_bf16_f32 v118, 0, v118
    v_cvt_pk_bf16_f32 v119, 0, v119
    v_pk_add_f32 v[60:61], v[60:61], v[116:117]
    v_pk_add_f32 v[62:63], v[62:63], v[118:119]
    buffer_store_dwordx4 v[60:63], v25, s[12:15], s52 offen
    v_lshlrev_b32 v112, 16, v232
    v_and_b32 v113, 0xffff0000, v232
    v_lshlrev_b32 v114, 16, v233
    v_and_b32 v115, 0xffff0000, v233
    v_pk_mul_f32 v[112:113], v[112:113], v[40:41]
    v_pk_mul_f32 v[114:115], v[114:115], v[42:43]
    s_add_u32 s52, s51, 0x70000
    v_cvt_pk_bf16_f32 v112, 0, v112
    v_cvt_pk_bf16_f32 v113, 0, v113
    v_cvt_pk_bf16_f32 v114, 0, v114
    v_cvt_pk_bf16_f32 v115, 0, v115
    v_pk_add_f32 v[64:65], v[64:65], v[112:113]
    v_pk_add_f32 v[66:67], v[66:67], v[114:115]
    buffer_store_dwordx4 v[64:67], v25, s[12:15], s52 offen
    v_lshlrev_b32 v116, 16, v234
    v_and_b32 v117, 0xffff0000, v234
    v_lshlrev_b32 v118, 16, v235
    v_and_b32 v119, 0xffff0000, v235
    v_pk_mul_f32 v[116:117], v[116:117], v[40:41]
    v_pk_mul_f32 v[118:119], v[118:119], v[42:43]
    s_add_u32 s52, s51, 0x74000
    v_cvt_pk_bf16_f32 v116, 0, v116
    v_cvt_pk_bf16_f32 v117, 0, v117
    v_cvt_pk_bf16_f32 v118, 0, v118
    v_cvt_pk_bf16_f32 v119, 0, v119
    v_pk_add_f32 v[68:69], v[68:69], v[116:117]
    v_pk_add_f32 v[70:71], v[70:71], v[118:119]
    buffer_store_dwordx4 v[68:71], v25, s[12:15], s52 offen
    v_lshlrev_b32 v112, 16, v236
    v_and_b32 v113, 0xffff0000, v236
    v_lshlrev_b32 v114, 16, v237
    v_and_b32 v115, 0xffff0000, v237
    v_pk_mul_f32 v[112:113], v[112:113], v[40:41]
    v_pk_mul_f32 v[114:115], v[114:115], v[42:43]
    s_add_u32 s52, s51, 0x78000
    v_cvt_pk_bf16_f32 v112, 0, v112
    v_cvt_pk_bf16_f32 v113, 0, v113
    v_cvt_pk_bf16_f32 v114, 0, v114
    v_cvt_pk_bf16_f32 v115, 0, v115
    v_pk_add_f32 v[72:73], v[72:73], v[112:113]
    v_pk_add_f32 v[74:75], v[74:75], v[114:115]
    buffer_store_dwordx4 v[72:75], v25, s[12:15], s52 offen
    v_lshlrev_b32 v116, 16, v238
    v_and_b32 v117, 0xffff0000, v238
    v_lshlrev_b32 v118, 16, v239
    v_and_b32 v119, 0xffff0000, v239
    v_pk_mul_f32 v[116:117], v[116:117], v[40:41]
    v_pk_mul_f32 v[118:119], v[118:119], v[42:43]
    s_add_u32 s52, s51, 0x7c000
    v_cvt_pk_bf16_f32 v116, 0, v116
    v_cvt_pk_bf16_f32 v117, 0, v117
    v_cvt_pk_bf16_f32 v118, 0, v118
    v_cvt_pk_bf16_f32 v119, 0, v119
    v_pk_add_f32 v[76:77], v[76:77], v[116:117]
    v_pk_add_f32 v[78:79], v[78:79], v[118:119]
    buffer_store_dwordx4 v[76:79], v25, s[12:15], s52 offen
    s_waitcnt vmcnt(24) lgkmcnt(0)
    v_lshlrev_b32 v112, 16, v240
    v_and_b32 v113, 0xffff0000, v240
    v_lshlrev_b32 v114, 16, v241
    v_and_b32 v115, 0xffff0000, v241
    v_pk_mul_f32 v[112:113], v[112:113], v[40:41]
    v_pk_mul_f32 v[114:115], v[114:115], v[42:43]
    s_add_u32 s52, s51, 0xb0000
    v_cvt_pk_bf16_f32 v112, 0, v112
    v_cvt_pk_bf16_f32 v113, 0, v113
    v_cvt_pk_bf16_f32 v114, 0, v114
    v_cvt_pk_bf16_f32 v115, 0, v115
    v_pk_add_f32 v[80:81], v[80:81], v[112:113]
    v_pk_add_f32 v[82:83], v[82:83], v[114:115]
    buffer_store_dwordx4 v[80:83], v25, s[12:15], s52 offen
    v_lshlrev_b32 v116, 16, v242
    v_and_b32 v117, 0xffff0000, v242
    v_lshlrev_b32 v118, 16, v243
    v_and_b32 v119, 0xffff0000, v243
    v_pk_mul_f32 v[116:117], v[116:117], v[40:41]
    v_pk_mul_f32 v[118:119], v[118:119], v[42:43]
    s_add_u32 s52, s51, 0xb4000
    v_cvt_pk_bf16_f32 v116, 0, v116
    v_cvt_pk_bf16_f32 v117, 0, v117
    v_cvt_pk_bf16_f32 v118, 0, v118
    v_cvt_pk_bf16_f32 v119, 0, v119
    v_pk_add_f32 v[84:85], v[84:85], v[116:117]
    v_pk_add_f32 v[86:87], v[86:87], v[118:119]
    buffer_store_dwordx4 v[84:87], v25, s[12:15], s52 offen
    v_lshlrev_b32 v112, 16, v244
    v_and_b32 v113, 0xffff0000, v244
    v_lshlrev_b32 v114, 16, v245
    v_and_b32 v115, 0xffff0000, v245
    v_pk_mul_f32 v[112:113], v[112:113], v[40:41]
    v_pk_mul_f32 v[114:115], v[114:115], v[42:43]
    s_add_u32 s52, s51, 0xb8000
    v_cvt_pk_bf16_f32 v112, 0, v112
    v_cvt_pk_bf16_f32 v113, 0, v113
    v_cvt_pk_bf16_f32 v114, 0, v114
    v_cvt_pk_bf16_f32 v115, 0, v115
    v_pk_add_f32 v[88:89], v[88:89], v[112:113]
    v_pk_add_f32 v[90:91], v[90:91], v[114:115]
    buffer_store_dwordx4 v[88:91], v25, s[12:15], s52 offen
    v_lshlrev_b32 v116, 16, v246
    v_and_b32 v117, 0xffff0000, v246
    v_lshlrev_b32 v118, 16, v247
    v_and_b32 v119, 0xffff0000, v247
    v_pk_mul_f32 v[116:117], v[116:117], v[40:41]
    v_pk_mul_f32 v[118:119], v[118:119], v[42:43]
    s_add_u32 s52, s51, 0xbc000
    v_cvt_pk_bf16_f32 v116, 0, v116
    v_cvt_pk_bf16_f32 v117, 0, v117
    v_cvt_pk_bf16_f32 v118, 0, v118
    v_cvt_pk_bf16_f32 v119, 0, v119
    v_pk_add_f32 v[92:93], v[92:93], v[116:117]
    v_pk_add_f32 v[94:95], v[94:95], v[118:119]
    buffer_store_dwordx4 v[92:95], v25, s[12:15], s52 offen
    v_lshlrev_b32 v112, 16, v248
    v_and_b32 v113, 0xffff0000, v248
    v_lshlrev_b32 v114, 16, v249
    v_and_b32 v115, 0xffff0000, v249
    v_pk_mul_f32 v[112:113], v[112:113], v[40:41]
    v_pk_mul_f32 v[114:115], v[114:115], v[42:43]
    s_add_u32 s52, s51, 0xf0000
    v_cvt_pk_bf16_f32 v112, 0, v112
    v_cvt_pk_bf16_f32 v113, 0, v113
    v_cvt_pk_bf16_f32 v114, 0, v114
    v_cvt_pk_bf16_f32 v115, 0, v115
    v_pk_add_f32 v[96:97], v[96:97], v[112:113]
    v_pk_add_f32 v[98:99], v[98:99], v[114:115]
    buffer_store_dwordx4 v[96:99], v25, s[12:15], s52 offen
    v_lshlrev_b32 v116, 16, v250
    v_and_b32 v117, 0xffff0000, v250
    v_lshlrev_b32 v118, 16, v251
    v_and_b32 v119, 0xffff0000, v251
    v_pk_mul_f32 v[116:117], v[116:117], v[40:41]
    v_pk_mul_f32 v[118:119], v[118:119], v[42:43]
    s_add_u32 s52, s51, 0xf4000
    v_cvt_pk_bf16_f32 v116, 0, v116
    v_cvt_pk_bf16_f32 v117, 0, v117
    v_cvt_pk_bf16_f32 v118, 0, v118
    v_cvt_pk_bf16_f32 v119, 0, v119
    v_pk_add_f32 v[100:101], v[100:101], v[116:117]
    v_pk_add_f32 v[102:103], v[102:103], v[118:119]
    buffer_store_dwordx4 v[100:103], v25, s[12:15], s52 offen
    v_lshlrev_b32 v112, 16, v252
    v_and_b32 v113, 0xffff0000, v252
    v_lshlrev_b32 v114, 16, v253
    v_and_b32 v115, 0xffff0000, v253
    v_pk_mul_f32 v[112:113], v[112:113], v[40:41]
    v_pk_mul_f32 v[114:115], v[114:115], v[42:43]
    s_add_u32 s52, s51, 0xf8000
    v_cvt_pk_bf16_f32 v112, 0, v112
    v_cvt_pk_bf16_f32 v113, 0, v113
    v_cvt_pk_bf16_f32 v114, 0, v114
    v_cvt_pk_bf16_f32 v115, 0, v115
    v_pk_add_f32 v[104:105], v[104:105], v[112:113]
    v_pk_add_f32 v[106:107], v[106:107], v[114:115]
    buffer_store_dwordx4 v[104:107], v25, s[12:15], s52 offen
    v_lshlrev_b32 v116, 16, v254
    v_and_b32 v117, 0xffff0000, v254
    v_lshlrev_b32 v118, 16, v255
    v_and_b32 v119, 0xffff0000, v255
    v_pk_mul_f32 v[116:117], v[116:117], v[40:41]
    v_pk_mul_f32 v[118:119], v[118:119], v[42:43]
    s_add_u32 s52, s51, 0xfc000
    v_cvt_pk_bf16_f32 v116, 0, v116
    v_cvt_pk_bf16_f32 v117, 0, v117
    v_cvt_pk_bf16_f32 v118, 0, v118
    v_cvt_pk_bf16_f32 v119, 0, v119
    v_pk_add_f32 v[108:109], v[108:109], v[116:117]
    v_pk_add_f32 v[110:111], v[110:111], v[118:119]
    buffer_store_dwordx4 v[108:111], v25, s[12:15], s52 offen
chain_kernel_seg:
    s_xor_b32 s57, s57, 2
    s_cmp_eq_u32 s56, 0
    s_cbranch_scc1 seg_end
    s_waitcnt vmcnt(0) lgkmcnt(0)
    s_barrier
    s_mov_b32 s12, s92
    s_and_b32 s13, s93, 0xffff
    s_mov_b32 s14, 0x800000
    s_mov_b32 s15, 0x00020000
    s_lshr_b32 s60, s57, 3
    s_lshl_b32 s28, s60, 21
    s_and_b32 s60, s57, 7
    s_lshl_b32 s60, s60, 8
    s_add_u32 s28, s28, s60
    v_bfe_u32 v24, v0, 4, 3
    v_lshlrev_b32 v24, 1, v24
    v_and_b32 v25, 15, v0
    v_xor_b32 v24, v24, v25
    v_lshlrev_b32 v6, 4, v24
    v_bfe_u32 v24, v0, 4, 2
    v_lshl_add_u32 v6, v24, 11, v6
    v_bfe_u32 v24, v0, 6, 1
    v_lshl_add_u32 v6, v24, 13, v6
    v_bfe_u32 v24, v0, 7, 1
    v_lshl_add_u32 v6, v24, 15, v6
    s_and_b32 s60, s58, 1
    s_lshl_b32 s61, s60, 11
    s_lshr_b32 s60, s58, 1
    s_lshl_b32 s60, s60, 10
    s_add_u32 s32, s60, s61
    s_add_u32 m0, s32, 0
    s_add_u32 s61, s28, 0x0
    buffer_load_dwordx4 v6, s[12:15], s61 offen nt lds
    s_add_u32 m0, s32, 4096
    s_add_u32 s61, s28, 0x4000
    buffer_load_dwordx4 v6, s[12:15], s61 offen nt lds
    s_add_u32 m0, s32, 8192
    s_add_u32 s61, s28, 0x10000
    buffer_load_dwordx4 v6, s[12:15], s61 offen nt lds
    s_add_u32 m0, s32, 12288
    s_add_u32 s61, s28, 0x14000
    buffer_load_dwordx4 v6, s[12:15], s61 offen nt lds
    s_add_u32 m0, s32, 16384
    s_add_u32 s61, s28, 0x20000
    buffer_load_dwordx4 v6, s[12:15], s61 offen nt lds
    s_add_u32 m0, s32, 20480
    s_add_u32 s61, s28, 0x24000
    buffer_load_dwordx4 v6, s[12:15], s61 offen nt lds
    s_add_u32 m0, s32, 24576
    s_add_u32 s61, s28, 0x30000
    buffer_load_dwordx4 v6, s[12:15], s61 offen nt lds
    s_add_u32 m0, s32, 28672
    s_add_u32 s61, s28, 0x34000
    buffer_load_dwordx4 v6, s[12:15], s61 offen nt lds
    s_mov_b32 s8, s100
    s_and_b32 s9, s101, 0xffff
    s_mov_b32 s10, 0xc000000
    s_mov_b32 s11, 0x00020000
    s_mov_b32 s16, s96
    s_and_b32 s17, s97, 0xffff
    s_mov_b32 s18, 0x1000000
    s_mov_b32 s19, 0x00020000
    v_and_b32 v24, 63, v0
    v_lshlrev_b32 v1, 4, v24
    v_add_u32 v2, 4096, v1
    v_lshlrev_b32 v10, 7, v24
    v_mov_b32 v11, 0
    s_lshl_b32 s60, s56, 8
    s_add_u32 s60, s60, 0xb200400
    s_lshl2_add_u32 s27, s57, s60
    s_and_b32 s38, s57, 7
    s_lshl_b32 s38, s38, 16
    s_cmp_eq_u32 s58, 0
    s_cselect_b32 s27, s27, 0xc000000
    s_cselect_b32 s38, s38, 0xc000000
    s_add_u32 s60, s60, s100
    s_addc_u32 s61, s101, 0
    v_and_b32 v25, 31, v0
    v_lshlrev_b32 v25, 2, v25
    v_add_u32 v16, s60, v25
    v_mov_b32 v17, s61
    s_add_u32 s60, s98, 208
    s_addc_u32 s61, s99, 0
    v_writelane_b32 v16, s60, 32
    v_writelane_b32 v17, s61, 32
    s_mov_b32 s26, 0
    s_mov_b32 s30, 0
    s_mov_b32 s40, 0
    s_mov_b32 s29, 32768
    v_and_b32 v24, 15, v0
    v_lshlrev_b32 v15, 13, v24
    v_bfe_u32 v24, v0, 4, 2
    v_lshl_add_u32 v15, v24, 4, v15
    s_lshr_b32 s60, s57, 4
    s_lshl_b32 s60, s60, 17
    s_and_b32 s61, s57, 7
    s_lshl_b32 s61, s61, 9
    s_add_u32 s60, s60, s61
    s_lshl_b32 s61, s58, 7
    s_add_u32 s60, s60, s61
    s_and_b32 s61, s57, 8
    s_lshl_b32 s61, s61, 3
    s_add_u32 s60, s60, s61
    s_add_u32 s60, s60, 4096
    v_add_u32 v15, s60, v15
    s_lshl_b32 s61, s58, 12
    s_xor_b32 s60, s57, 24
    s_lshl_b32 s60, s60, 14
    s_add_u32 s60, s60, s61
    s_add_u32 s60, s60, 0
    v_add_u32 v20, s60, v1
    s_xor_b32 s60, s57, 16
    s_lshl_b32 s60, s60, 14
    s_add_u32 s60, s60, s61
    s_add_u32 s60, s60, 1024
    v_add_u32 v21, s60, v1
    s_xor_b32 s60, s57, 8
    s_lshl_b32 s60, s60, 14
    s_add_u32 s60, s60, s61
    s_add_u32 s60, s60, 2048
    v_add_u32 v22, s60, v1
    s_xor_b32 s60, s57, 0
    s_lshl_b32 s60, s60, 14
    s_add_u32 s60, s60, s61
    s_add_u32 s60, s60, 0
    v_add_u32 v23, s60, v1
    s_lshl_b32 s24, s56, 20
    s_add_u32 s24, s24, 0xb800000
    s_and_b32 s60, s57, 24
    s_add_u32 s60, s60, s58
    s_lshl_b32 s31, s60, 16
    s_add_u32 s31, s31, 0xc000
    s_add_u32 s31, s31, s59
    s_mul_i32 s33, s56, 8
    s_lshr_b32 s33, 0x2010000, s33
    s_and_b32 s33, s33, 255
    s_mul_i32 s39, s56, 8
    s_lshr_b32 s39, 0x13131300, s39
    s_and_b32 s39, s39, 255
    s_cmp_eq_u32 s56, 0
    s_cmov_b32 s36, 0x0
    s_cmp_eq_u32 s56, 1
    s_cmov_b32 s36, 0x3f3c39
    s_cmp_eq_u32 s56, 2
    s_cmov_b32 s36, 0x3d3a
    s_cmp_eq_u32 s56, 3
    s_cmov_b32 s36, 0x3e3b
    s_add_u32 m0, s32, 32768
    s_add_u32 s61, s28, 0x40000
    buffer_load_dwordx4 v6, s[12:15], s61 offen nt lds
    s_add_u32 m0, s32, 36864
    s_add_u32 s61, s28, 0x44000
    buffer_load_dwordx4 v6, s[12:15], s61 offen nt lds
    s_add_u32 m0, s32, 40960
    s_add_u32 s61, s28, 0x50000
    buffer_load_dwordx4 v6, s[12:15], s61 offen nt lds
    s_add_u32 m0, s32, 45056
    s_add_u32 s61, s28, 0x54000
    buffer_load_dwordx4 v6, s[12:15], s61 offen nt lds
    s_add_u32 m0, s32, 49152
    s_add_u32 s61, s28, 0x60000
    buffer_load_dwordx4 v6, s[12:15], s61 offen nt lds
    s_add_u32 m0, s32, 53248
    s_add_u32 s61, s28, 0x64000
    buffer_load_dwordx4 v6, s[12:15], s61 offen nt lds
    s_add_u32 m0, s32, 57344
    s_add_u32 s61, s28, 0x70000
    buffer_load_dwordx4 v6, s[12:15], s61 offen nt lds
    s_add_u32 m0, s32, 61440
    s_add_u32 s61, s28, 0x74000
    buffer_load_dwordx4 v6, s[12:15], s61 offen nt lds
    s_add_u32 m0, s32, 65536
    s_add_u32 s61, s28, 0x80000
    buffer_load_dwordx4 v6, s[12:15], s61 offen nt lds
    s_add_u32 m0, s32, 69632
    s_add_u32 s61, s28, 0x84000
    buffer_load_dwordx4 v6, s[12:15], s61 offen nt lds
    s_add_u32 m0, s32, 73728
    s_add_u32 s61, s28, 0x90000
    buffer_load_dwordx4 v6, s[12:15], s61 offen nt lds
    s_add_u32 m0, s32, 77824
    s_add_u32 s61, s28, 0x94000
    buffer_load_dwordx4 v6, s[12:15], s61 offen nt lds
    s_add_u32 m0, s32, 81920
    s_add_u32 s61, s28, 0xa0000
    buffer_load_dwordx4 v6, s[12:15], s61 offen nt lds
    s_add_u32 m0, s32, 86016
    s_add_u32 s61, s28, 0xa4000
    buffer_load_dwordx4 v6, s[12:15], s61 offen nt lds
    s_add_u32 m0, s32, 90112
    s_add_u32 s61, s28, 0xb0000
    buffer_load_dwordx4 v6, s[12:15], s61 offen nt lds
    s_add_u32 m0, s32, 94208
    s_add_u32 s61, s28, 0xb4000
    buffer_load_dwordx4 v6, s[12:15], s61 offen nt lds
    s_add_u32 m0, s32, 98304
    s_add_u32 s61, s28, 0xc0000
    buffer_load_dwordx4 v6, s[12:15], s61 offen nt lds
    s_add_u32 m0, s32, 102400
    s_add_u32 s61, s28, 0xc4000
    buffer_load_dwordx4 v6, s[12:15], s61 offen nt lds
    s_add_u32 m0, s32, 106496
    s_add_u32 s61, s28, 0xd0000
    buffer_load_dwordx4 v6, s[12:15], s61 offen nt lds
    s_add_u32 m0, s32, 110592
    s_add_u32 s61, s28, 0xd4000
    buffer_load_dwordx4 v6, s[12:15], s61 offen nt lds
    s_add_u32 m0, s32, 114688
    s_add_u32 s61, s28, 0xe0000
    buffer_load_dwordx4 v6, s[12:15], s61 offen nt lds
    s_add_u32 m0, s32, 118784
    s_add_u32 s61, s28, 0xe4000
    buffer_load_dwordx4 v6, s[12:15], s61 offen nt lds
    s_add_u32 m0, s32, 122880
    s_add_u32 s61, s28, 0xf0000
    buffer_load_dwordx4 v6, s[12:15], s61 offen nt lds
    s_add_u32 m0, s32, 126976
    s_add_u32 s61, s28, 0xf4000
    buffer_load_dwordx4 v6, s[12:15], s61 offen nt lds
    s_add_u32 m0, s32, 131072
    s_add_u32 s61, s28, 0x100000
    buffer_load_dwordx4 v6, s[12:15], s61 offen nt lds
    s_add_u32 m0, s32, 135168
    s_add_u32 s61, s28, 0x104000
    buffer_load_dwordx4 v6, s[12:15], s61 offen nt lds
    s_add_u32 m0, s32, 139264
    s_add_u32 s61, s28, 0x110000
    buffer_load_dwordx4 v6, s[12:15], s61 offen nt lds
    s_add_u32 m0, s32, 143360
    s_add_u32 s61, s28, 0x114000
    buffer_load_dwordx4 v6, s[12:15], s61 offen nt lds
    s_add_u32 m0, s32, 147456
    s_add_u32 s61, s28, 0x120000
    buffer_load_dwordx4 v6, s[12:15], s61 offen nt lds
    s_add_u32 m0, s32, 151552
    s_add_u32 s61, s28, 0x124000
    buffer_load_dwordx4 v6, s[12:15], s61 offen nt lds
    s_add_u32 m0, s32, 155648
    s_add_u32 s61, s28, 0x130000
    buffer_load_dwordx4 v6, s[12:15], s61 offen nt lds
    s_add_u32 m0, s32, 159744
    s_add_u32 s61, s28, 0x134000
    buffer_load_dwordx4 v6, s[12:15], s61 offen nt lds
    s_andn2_b32 s60, 8, s57
    s_lshl_b32 s60, s60, 2
    v_bfe_u32 v24, v0, 2, 3
    v_lshrrev_b32 v25, 6, v0
    v_lshlrev_b32 v25, 1, v25
    v_xor_b32 v24, v24, v25
    v_lshlrev_b32 v8, 5, v24
    v_bfe_u32 v24, v0, 0, 2
    v_lshl_add_u32 v8, v24, 3, v8
    v_bfe_u32 v24, v0, 2, 2
    v_lshl_add_u32 v8, v24, 8, v8
    v_bfe_u32 v24, v0, 4, 2
    v_lshl_add_u32 v8, v24, 11, v8
    v_xor_b32 v8, s60, v8
    v_xor_b32 v9, 32, v8
    s_waitcnt vmcnt(32)
    s_barrier
    ds_read_b64_tr_b16 a[0:1], v8 offset:0
    ds_read_b64_tr_b16 a[2:3], v8 offset:1024
    ds_read_b64_tr_b16 a[4:5], v9 offset:0
    ds_read_b64_tr_b16 a[6:7], v9 offset:1024
    ds_read_b64_tr_b16 a[8:9], v8 offset:8192
    ds_read_b64_tr_b16 a[10:11], v8 offset:9216
    ds_read_b64_tr_b16 a[12:13], v9 offset:8192
    ds_read_b64_tr_b16 a[14:15], v9 offset:9216
    s_waitcnt lgkmcnt(0)
    ds_read_b64_tr_b16 a[16:17], v8 offset:16384
    ds_read_b64_tr_b16 a[18:19], v8 offset:17408
    ds_read_b64_tr_b16 a[20:21], v9 offset:16384
    ds_read_b64_tr_b16 a[22:23], v9 offset:17408
    ds_read_b64_tr_b16 a[24:25], v8 offset:24576
    ds_read_b64_tr_b16 a[26:27], v8 offset:25600
    ds_read_b64_tr_b16 a[28:29], v9 offset:24576
    ds_read_b64_tr_b16 a[30:31], v9 offset:25600
    s_waitcnt lgkmcnt(0)
    s_waitcnt vmcnt(24)
    s_barrier
    s_add_u32 m0, s32, 0
    s_add_u32 s61, s28, 0x140000
    buffer_load_dwordx4 v6, s[12:15], s61 offen nt lds
    s_add_u32 m0, s32, 4096
    s_add_u32 s61, s28, 0x144000
    buffer_load_dwordx4 v6, s[12:15], s61 offen nt lds
    s_add_u32 m0, s32, 8192
    s_add_u32 s61, s28, 0x150000
    buffer_load_dwordx4 v6, s[12:15], s61 offen nt lds
    s_add_u32 m0, s32, 12288
    s_add_u32 s61, s28, 0x154000
    buffer_load_dwordx4 v6, s[12:15], s61 offen nt lds
    s_add_u32 m0, s32, 16384
    s_add_u32 s61, s28, 0x160000
    buffer_load_dwordx4 v6, s[12:15], s61 offen nt lds
    s_add_u32 m0, s32, 20480
    s_add_u32 s61, s28, 0x164000
    buffer_load_dwordx4 v6, s[12:15], s61 offen nt lds
    s_add_u32 m0, s32, 24576
    s_add_u32 s61, s28, 0x170000
    buffer_load_dwordx4 v6, s[12:15], s61 offen nt lds
    s_add_u32 m0, s32, 28672
    s_add_u32 s61, s28, 0x174000
    buffer_load_dwordx4 v6, s[12:15], s61 offen nt lds
    ds_read_b64_tr_b16 a[32:33], v8 offset:32768
    ds_read_b64_tr_b16 a[34:35], v8 offset:33792
    ds_read_b64_tr_b16 a[36:37], v9 offset:32768
    ds_read_b64_tr_b16 a[38:39], v9 offset:33792
    ds_read_b64_tr_b16 a[40:41], v8 offset:40960
    ds_read_b64_tr_b16 a[42:43], v8 offset:41984
    ds_read_b64_tr_b16 a[44:45], v9 offset:40960
    ds_read_b64_tr_b16 a[46:47], v9 offset:41984
    s_waitcnt lgkmcnt(0)
    ds_read_b64_tr_b16 a[48:49], v8 offset:49152
    ds_read_b64_tr_b16 a[50:51], v8 offset:50176
    ds_read_b64_tr_b16 a[52:53], v9 offset:49152
    ds_read_b64_tr_b16 a[54:55], v9 offset:50176
    ds_read_b64_tr_b16 a[56:57], v8 offset:57344
    ds_read_b64_tr_b16 a[58:59], v8 offset:58368
    ds_read_b64_tr_b16 a[60:61], v9 offset:57344
    ds_read_b64_tr_b16 a[62:63], v9 offset:58368
    s_waitcnt lgkmcnt(0)
    s_waitcnt vmcnt(24)
    s_barrier
    s_add_u32 m0, s32, 32768
    s_add_u32 s61, s28, 0x180000
    buffer_load_dwordx4 v6, s[12:15], s61 offen nt lds
    s_add_u32 m0, s32, 36864
    s_add_u32 s61, s28, 0x184000
    buffer_load_dwordx4 v6, s[12:15], s61 offen nt lds
    s_add_u32 m0, s32, 40960
    s_add_u32 s61, s28, 0x190000
    buffer_load_dwordx4 v6, s[12:15], s61 offen nt lds
    s_add_u32 m0, s32, 45056
    s_add_u32 s61, s28, 0x194000
    buffer_load_dwordx4 v6, s[12:15], s61 offen nt lds
    s_add_u32 m0, s32, 49152
    s_add_u32 s61, s28, 0x1a0000
    buffer_load_dwordx4 v6, s[12:15], s61 offen nt lds
    s_add_u32 m0, s32, 53248
    s_add_u32 s61, s28, 0x1a4000
    buffer_load_dwordx4 v6, s[12:15], s61 offen nt lds
    s_add_u32 m0, s32, 57344
    s_add_u32 s61, s28, 0x1b0000
    buffer_load_dwordx4 v6, s[12:15], s61 offen nt lds
    s_add_u32 m0, s32, 61440
    s_add_u32 s61, s28, 0x1b4000
    buffer_load_dwordx4 v6, s[12:15], s61 offen nt lds
    v_add_u32 v8, 0x10000, v8
    v_add_u32 v9, 0x10000, v9
    ds_read_b64_tr_b16 a[64:65], v8 offset:0
    ds_read_b64_tr_b16 a[66:67], v8 offset:1024
    ds_read_b64_tr_b16 a[68:69], v9 offset:0
    ds_read_b64_tr_b16 a[70:71], v9 offset:1024
    ds_read_b64_tr_b16 a[72:73], v8 offset:8192
    ds_read_b64_tr_b16 a[74:75], v8 offset:9216
    ds_read_b64_tr_b16 a[76:77], v9 offset:8192
    ds_read_b64_tr_b16 a[78:79], v9 offset:9216
    s_waitcnt lgkmcnt(0)
    ds_read_b64_tr_b16 a[80:81], v8 offset:16384
    ds_read_b64_tr_b16 a[82:83], v8 offset:17408
    ds_read_b64_tr_b16 a[84:85], v9 offset:16384
    ds_read_b64_tr_b16 a[86:87], v9 offset:17408
    ds_read_b64_tr_b16 a[88:89], v8 offset:24576
    ds_read_b64_tr_b16 a[90:91], v8 offset:25600
    ds_read_b64_tr_b16 a[92:93], v9 offset:24576
    ds_read_b64_tr_b16 a[94:95], v9 offset:25600
    s_waitcnt lgkmcnt(0)
    s_waitcnt vmcnt(24)
    s_barrier
    s_add_u32 m0, s32, 65536
    s_add_u32 s61, s28, 0x1c0000
    buffer_load_dwordx4 v6, s[12:15], s61 offen nt lds
    s_add_u32 m0, s32, 69632
    s_add_u32 s61, s28, 0x1c4000
    buffer_load_dwordx4 v6, s[12:15], s61 offen nt lds
    s_add_u32 m0, s32, 73728
    s_add_u32 s61, s28, 0x1d0000
    buffer_load_dwordx4 v6, s[12:15], s61 offen nt lds
    s_add_u32 m0, s32, 77824
    s_add_u32 s61, s28, 0x1d4000
    buffer_load_dwordx4 v6, s[12:15], s61 offen nt lds
    s_add_u32 m0, s32, 81920
    s_add_u32 s61, s28, 0x1e0000
    buffer_load_dwordx4 v6, s[12:15], s61 offen nt lds
    s_add_u32 m0, s32, 86016
    s_add_u32 s61, s28, 0x1e4000
    buffer_load_dwordx4 v6, s[12:15], s61 offen nt lds
    s_add_u32 m0, s32, 90112
    s_add_u32 s61, s28, 0x1f0000
    buffer_load_dwordx4 v6, s[12:15], s61 offen nt lds
    s_add_u32 m0, s32, 94208
    s_add_u32 s61, s28, 0x1f4000
    buffer_load_dwordx4 v6, s[12:15], s61 offen nt lds
    ds_read_b64_tr_b16 a[96:97], v8 offset:32768
    ds_read_b64_tr_b16 a[98:99], v8 offset:33792
    ds_read_b64_tr_b16 a[100:101], v9 offset:32768
    ds_read_b64_tr_b16 a[102:103], v9 offset:33792
    ds_read_b64_tr_b16 a[104:105], v8 offset:40960
    ds_read_b64_tr_b16 a[106:107], v8 offset:41984
    ds_read_b64_tr_b16 a[108:109], v9 offset:40960
    ds_read_b64_tr_b16 a[110:111], v9 offset:41984
    s_waitcnt lgkmcnt(0)
    ds_read_b64_tr_b16 a[112:113], v8 offset:49152
    ds_read_b64_tr_b16 a[114:115], v8 offset:50176
    ds_read_b64_tr_b16 a[116:117], v9 offset:49152
    ds_read_b64_tr_b16 a[118:119], v9 offset:50176
    ds_read_b64_tr_b16 a[120:121], v8 offset:57344
    ds_read_b64_tr_b16 a[122:123], v8 offset:58368
    ds_read_b64_tr_b16 a[124:125], v9 offset:57344
    ds_read_b64_tr_b16 a[126:127], v9 offset:58368
    s_waitcnt lgkmcnt(0)
    s_waitcnt vmcnt(24)
    s_barrier
    v_add_u32 v8, 0x10000, v8
    v_add_u32 v9, 0x10000, v9
    ds_read_b64_tr_b16 a[128:129], v8 offset:0
    ds_read_b64_tr_b16 a[130:131], v8 offset:1024
    ds_read_b64_tr_b16 a[132:133], v9 offset:0
    ds_read_b64_tr_b16 a[134:135], v9 offset:1024
    ds_read_b64_tr_b16 a[136:137], v8 offset:8192
    ds_read_b64_tr_b16 a[138:139], v8 offset:9216
    ds_read_b64_tr_b16 a[140:141], v9 offset:8192
    ds_read_b64_tr_b16 a[142:143], v9 offset:9216
    s_waitcnt lgkmcnt(0)
    ds_read_b64_tr_b16 a[144:145], v8 offset:16384
    ds_read_b64_tr_b16 a[146:147], v8 offset:17408
    ds_read_b64_tr_b16 a[148:149], v9 offset:16384
    ds_read_b64_tr_b16 a[150:151], v9 offset:17408
    ds_read_b64_tr_b16 a[152:153], v8 offset:24576
    ds_read_b64_tr_b16 a[154:155], v8 offset:25600
    ds_read_b64_tr_b16 a[156:157], v9 offset:24576
    ds_read_b64_tr_b16 a[158:159], v9 offset:25600
    s_waitcnt lgkmcnt(0)
    s_waitcnt vmcnt(16)
    s_barrier
    v_add_u32 v8, 0xfffe0000, v8
    v_add_u32 v9, 0xfffe0000, v9
    ds_read_b64_tr_b16 a[160:161], v8 offset:0
    ds_read_b64_tr_b16 a[162:163], v8 offset:1024
    ds_read_b64_tr_b16 a[164:165], v9 offset:0
    ds_read_b64_tr_b16 a[166:167], v9 offset:1024
    ds_read_b64_tr_b16 a[168:169], v8 offset:8192
    ds_read_b64_tr_b16 a[170:171], v8 offset:9216
    ds_read_b64_tr_b16 a[172:173], v9 offset:8192
    ds_read_b64_tr_b16 a[174:175], v9 offset:9216
    s_waitcnt lgkmcnt(0)
    ds_read_b64_tr_b16 a[176:177], v8 offset:16384
    ds_read_b64_tr_b16 a[178:179], v8 offset:17408
    ds_read_b64_tr_b16 a[180:181], v9 offset:16384
    ds_read_b64_tr_b16 a[182:183], v9 offset:17408
    ds_read_b64_tr_b16 a[184:185], v8 offset:24576
    ds_read_b64_tr_b16 a[186:187], v8 offset:25600
    ds_read_b64_tr_b16 a[188:189], v9 offset:24576
    ds_read_b64_tr_b16 a[190:191], v9 offset:25600
    s_waitcnt lgkmcnt(0)
    s_waitcnt vmcnt(8)
    s_barrier
    ds_read_b64_tr_b16 a[192:193], v8 offset:32768
    ds_read_b64_tr_b16 a[194:195], v8 offset:33792
    ds_read_b64_tr_b16 a[196:197], v9 offset:32768
    ds_read_b64_tr_b16 a[198:199], v9 offset:33792
    ds_read_b64_tr_b16 a[200:201], v8 offset:40960
    ds_read_b64_tr_b16 a[202:203], v8 offset:41984
    ds_read_b64_tr_b16 a[204:205], v9 offset:40960
    ds_read_b64_tr_b16 a[206:207], v9 offset:41984
    s_waitcnt lgkmcnt(0)
    ds_read_b64_tr_b16 a[208:209], v8 offset:49152
    ds_read_b64_tr_b16 a[210:211], v8 offset:50176
    ds_read_b64_tr_b16 a[212:213], v9 offset:49152
    ds_read_b64_tr_b16 a[214:215], v9 offset:50176
    ds_read_b64_tr_b16 a[216:217], v8 offset:57344
    ds_read_b64_tr_b16 a[218:219], v8 offset:58368
    ds_read_b64_tr_b16 a[220:221], v9 offset:57344
    ds_read_b64_tr_b16 a[222:223], v9 offset:58368
    s_waitcnt lgkmcnt(0)
    s_waitcnt vmcnt(0)
    s_barrier
    v_add_u32 v8, 0x10000, v8
    v_add_u32 v9, 0x10000, v9
    ds_read_b64_tr_b16 a[224:225], v8 offset:0
    ds_read_b64_tr_b16 a[226:227], v8 offset:1024
    ds_read_b64_tr_b16 a[228:229], v9 offset:0
    ds_read_b64_tr_b16 a[230:231], v9 offset:1024
    ds_read_b64_tr_b16 a[232:233], v8 offset:8192
    ds_read_b64_tr_b16 a[234:235], v8 offset:9216
    ds_read_b64_tr_b16 a[236:237], v9 offset:8192
    ds_read_b64_tr_b16 a[238:239], v9 offset:9216
    s_waitcnt lgkmcnt(0)
    ds_read_b64_tr_b16 a[240:241], v8 offset:16384
    ds_read_b64_tr_b16 a[242:243], v8 offset:17408
    ds_read_b64_tr_b16 a[244:245], v9 offset:16384
    ds_read_b64_tr_b16 a[246:247], v9 offset:17408
    ds_read_b64_tr_b16 a[248:249], v8 offset:24576
    ds_read_b64_tr_b16 a[250:251], v8 offset:25600
    ds_read_b64_tr_b16 a[252:253], v9 offset:24576
    ds_read_b64_tr_b16 a[254:255], v9 offset:25600
    s_waitcnt lgkmcnt(0)
    s_barrier
    s_cmp_eq_u32 s39, 0
    s_cbranch_scc1 seg_t0
    s_lshl_b32 s20, s58, 13
    s_mov_b32 s21, 0
    s_lshr_b32 s60, s57, 4
    s_lshl_b32 s60, s60, 12
    v_add_u32 v5, s60, v1
    v_xor_b32 v4, 4096, v5
    s_sub_u32 s60, s39, 1
    s_mul_i32 s60, s60, 3
    s_add_u32 s35, s33, s60
    s_add_u32 s34, s33, 9
    s_lshl_b32 s25, s33, 18
    s_sub_u32 s25, s25, 0x180000
    s_mov_b32 s18, 0
    v_mov_b32 v18, s26
    v_writelane_b32 v18, s34, 32
    v_writelane_b32 v18, s40, 33
L_sp_57:
    global_load_dword v19, v[16:17], off sc1
    s_add_u32 s30, s30, 1
    s_cmp_gt_u32 s30, 0x200000
    s_cbranch_scc1 chain_kernel_wabort
    s_waitcnt vmcnt(0)
    v_cmp_lt_u32 vcc, v19, v18
    s_cbranch_vccz L_spok_58
    s_sleep 4
    s_branch L_sp_57
L_spok_58:
    s_lshl_b32 s61, s33, 13
    s_and_b32 s61, s61, 0x2000
    s_xor_b32 s61, s61, s31
    s_lshl_b32 s23, s33, 21
    s_add_u32 s23, s23, s61
    s_cmp_gt_u32 s33, s35
    s_cselect_b32 s23, 0xc000000, s23
    s_add_u32 m0, s20, 0
    s_nop 0
    buffer_load_dwordx4 v1, s[8:11], s23 offen offset:0 lds
    buffer_load_dwordx4 v1, s[8:11], s23 offen offset:1024 lds
    buffer_load_dwordx4 v1, s[8:11], s23 offen offset:2048 lds
    buffer_load_dwordx4 v1, s[8:11], s23 offen offset:3072 lds
    s_add_u32 m0, s20, 4096
    s_nop 0
    buffer_load_dwordx4 v2, s[8:11], s23 offen offset:0 lds
    buffer_load_dwordx4 v2, s[8:11], s23 offen offset:1024 lds
    buffer_load_dwordx4 v2, s[8:11], s23 offen offset:2048 lds
    buffer_load_dwordx4 v2, s[8:11], s23 offen offset:3072 lds
    s_add_u32 s20, s20, 32768
    s_cmp_ge_u32 s20, 163840
    s_cselect_b32 s60, 163840, 0
    s_sub_u32 s20, s20, s60
    s_add_u32 s23, s23, 0x40000
    s_add_u32 m0, s20, 0
    s_nop 0
    buffer_load_dwordx4 v1, s[8:11], s23 offen offset:0 lds
    buffer_load_dwordx4 v1, s[8:11], s23 offen offset:1024 lds
    buffer_load_dwordx4 v1, s[8:11], s23 offen offset:2048 lds
    buffer_load_dwordx4 v1, s[8:11], s23 offen offset:3072 lds
    s_add_u32 m0, s20, 4096
    s_nop 0
    buffer_load_dwordx4 v2, s[8:11], s23 offen offset:0 lds
    buffer_load_dwordx4 v2, s[8:11], s23 offen offset:1024 lds
    buffer_load_dwordx4 v2, s[8:11], s23 offen offset:2048 lds
    buffer_load_dwordx4 v2, s[8:11], s23 offen offset:3072 lds
    s_add_u32 s20, s20, 32768
    s_cmp_ge_u32 s20, 163840
    s_cselect_b32 s60, 163840, 0
    s_sub_u32 s20, s20, s60
    s_add_u32 s33, s33, 3
    s_lshl_b32 s61, s33, 13
    s_and_b32 s61, s61, 0x2000
    s_xor_b32 s61, s61, s31
    s_lshl_b32 s23, s33, 21
    s_add_u32 s23, s23, s61
    s_cmp_gt_u32 s33, s35
    s_cselect_b32 s23, 0xc000000, s23
    s_add_u32 m0, s20, 0
    s_nop 0
    buffer_load_dwordx4 v1, s[8:11], s23 offen offset:0 lds
    buffer_load_dwordx4 v1, s[8:11], s23 offen offset:1024 lds
    buffer_load_dwordx4 v1, s[8:11], s23 offen offset:2048 lds
    buffer_load_dwordx4 v1, s[8:11], s23 offen offset:3072 lds
    s_add_u32 m0, s20, 4096
    s_nop 0
    buffer_load_dwordx4 v2, s[8:11], s23 offen offset:0 lds
    buffer_load_dwordx4 v2, s[8:11], s23 offen offset:1024 lds
    buffer_load_dwordx4 v2, s[8:11], s23 offen offset:2048 lds
    buffer_load_dwordx4 v2, s[8:11], s23 offen offset:3072 lds
    s_add_u32 s20, s20, 32768
    s_cmp_ge_u32 s20, 163840
    s_cselect_b32 s60, 163840, 0
    s_sub_u32 s20, s20, s60
    s_add_u32 s23, s23, 0x40000
    s_mov_b32 s37, 0xc000000
    s_waitcnt vmcnt(8)
    s_barrier
    ds_read_b128 v[72:75], v4 offset:0
    ds_read_b128 v[76:79], v5 offset:0
    ds_read_b128 v[80:83], v4 offset:1024
    ds_read_b128 v[84:87], v5 offset:1024
    ds_read_b128 v[88:91], v4 offset:2048
    ds_read_b128 v[92:95], v5 offset:2048
seg_p:
    s_waitcnt lgkmcnt(4)
    v_mfma_f32_16x16x32_bf16 v[32:35], a[0:3], v[72:75], 0
    ds_read_b128 v[96:99], v4 offset:3072
    s_waitcnt vmcnt(4)
    v_mfma_f32_16x16x32_bf16 v[36:39], a[4:7], v[72:75], 0
    ds_read_b128 v[100:103], v5 offset:3072
    v_pk_add_f32 v[104:105], v[104:105], v[64:65]
    v_mfma_f32_16x16x32_bf16 v[44:47], a[4:7], v[76:79], 0
    v_pk_add_f32 v[106:107], v[106:107], v[66:67]
    s_xor_b32 s24, s24, 0x80000
    v_mfma_f32_16x16x32_bf16 v[40:43], a[0:3], v[76:79], 0
    buffer_store_dwordx4 v[48:51], v20, s[8:11], s24 offen
    s_waitcnt lgkmcnt(4)
    v_mfma_f32_16x16x32_bf16 v[32:35], a[8:11], v[80:83], v[32:35]
    ds_read_b128 v[72:75], v4 offset:8192
    v_mfma_f32_16x16x32_bf16 v[36:39], a[12:15], v[80:83], v[36:39]
    ds_read_b128 v[76:79], v5 offset:8192
    buffer_store_dwordx4 v[52:55], v21, s[8:11], s24 offen
    v_mfma_f32_16x16x32_bf16 v[44:47], a[12:15], v[84:87], v[44:47]
    v_mfma_f32_16x16x32_bf16 v[40:43], a[8:11], v[84:87], v[40:43]
    buffer_store_dwordx4 v[56:59], v22, s[8:11], s24 offen
    s_waitcnt lgkmcnt(4)
    v_mfma_f32_16x16x32_bf16 v[32:35], a[16:19], v[88:91], v[32:35]
    ds_read_b128 v[80:83], v4 offset:9216
    buffer_load_dword v13, v10, s[8:11], s37 offen
    v_mfma_f32_16x16x32_bf16 v[36:39], a[20:23], v[88:91], v[36:39]
    ds_read_b128 v[84:87], v5 offset:9216
    v_pk_add_f32 v[108:109], v[108:109], v[112:113]
    v_mfma_f32_16x16x32_bf16 v[44:47], a[20:23], v[92:95], v[44:47]
    v_pk_add_f32 v[110:111], v[110:111], v[114:115]
    v_pk_add_f32 v[104:105], v[104:105], v[108:109]
    v_mfma_f32_16x16x32_bf16 v[40:43], a[16:19], v[92:95], v[40:43]
    v_pk_add_f32 v[106:107], v[106:107], v[110:111]
    s_waitcnt lgkmcnt(4)
    v_mfma_f32_16x16x32_bf16 v[32:35], a[24:27], v[96:99], v[32:35]
    ds_read_b128 v[88:91], v4 offset:10240
    v_cvt_pk_bf16_f32 v104, 0, v104
    v_mfma_f32_16x16x32_bf16 v[36:39], a[28:31], v[96:99], v[36:39]
    ds_read_b128 v[92:95], v5 offset:10240
    v_cvt_pk_bf16_f32 v105, 0, v105
    v_mfma_f32_16x16x32_bf16 v[44:47], a[28:31], v[100:103], v[44:47]
    v_cvt_pk_bf16_f32 v106, 0, v106
    v_cvt_pk_bf16_f32 v107, 0, v107
    v_mfma_f32_16x16x32_bf16 v[40:43], a[24:27], v[100:103], v[40:43]
    buffer_store_dwordx4 v[104:107], v15, s[16:19], s25 offen
    s_waitcnt lgkmcnt(4)
    v_mfma_f32_16x16x32_bf16 v[32:35], a[32:35], v[72:75], v[32:35]
    ds_read_b128 v[96:99], v4 offset:11264
    v_mov_b32 v64, v60
    v_mfma_f32_16x16x32_bf16 v[36:39], a[36:39], v[72:75], v[36:39]
    ds_read_b128 v[100:103], v5 offset:11264
    v_mov_b32 v65, v61
    v_mfma_f32_16x16x32_bf16 v[44:47], a[36:39], v[76:79], v[44:47]
    v_mov_b32 v66, v62
    v_mov_b32 v67, v63
    v_mfma_f32_16x16x32_bf16 v[40:43], a[32:35], v[76:79], v[40:43]
    s_waitcnt lgkmcnt(4)
    v_mfma_f32_16x16x32_bf16 v[32:35], a[40:43], v[80:83], v[32:35]
    ds_read_b128 v[72:75], v4 offset:16384
    v_mfma_f32_16x16x32_bf16 v[36:39], a[44:47], v[80:83], v[36:39]
    ds_read_b128 v[76:79], v5 offset:16384
    v_mfma_f32_16x16x32_bf16 v[44:47], a[44:47], v[84:87], v[44:47]
    v_mfma_f32_16x16x32_bf16 v[40:43], a[40:43], v[84:87], v[40:43]
    s_waitcnt lgkmcnt(4)
    v_mfma_f32_16x16x32_bf16 v[32:35], a[48:51], v[88:91], v[32:35]
    ds_read_b128 v[80:83], v4 offset:17408
    v_mfma_f32_16x16x32_bf16 v[36:39], a[52:55], v[88:91], v[36:39]
    ds_read_b128 v[84:87], v5 offset:17408
    v_mfma_f32_16x16x32_bf16 v[44:47], a[52:55], v[92:95], v[44:47]
    v_mfma_f32_16x16x32_bf16 v[40:43], a[48:51], v[92:95], v[40:43]
    s_waitcnt lgkmcnt(4)
    v_mfma_f32_16x16x32_bf16 v[32:35], a[56:59], v[96:99], v[32:35]
    ds_read_b128 v[88:91], v4 offset:18432
    v_mfma_f32_16x16x32_bf16 v[36:39], a[60:63], v[96:99], v[36:39]
    ds_read_b128 v[92:95], v5 offset:18432
    v_mfma_f32_16x16x32_bf16 v[44:47], a[60:63], v[100:103], v[44:47]
    s_cmp_ge_u32 s21, 131072
    s_cselect_b32 s22, 0xfffe0000, s29
    v_mfma_f32_16x16x32_bf16 v[40:43], a[56:59], v[100:103], v[40:43]
    s_add_u32 s21, s21, s22
    s_waitcnt lgkmcnt(4)
    v_mfma_f32_16x16x32_bf16 v[32:35], a[64:67], v[72:75], v[32:35]
    ds_read_b128 v[96:99], v4 offset:19456
    s_add_u32 s34, s34, 3
    v_mfma_f32_16x16x32_bf16 v[36:39], a[68:71], v[72:75], v[36:39]
    ds_read_b128 v[100:103], v5 offset:19456
    s_add_u32 s62, s35, 3
    v_mfma_f32_16x16x32_bf16 v[44:47], a[68:71], v[76:79], v[44:47]
    s_min_u32 s34, s34, s62
    s_add_u32 s25, s25, 0xc0000
    v_mfma_f32_16x16x32_bf16 v[40:43], a[64:67], v[76:79], v[40:43]
    s_cmp_ge_u32 s26, 1
    s_waitcnt lgkmcnt(4)
    v_mfma_f32_16x16x32_bf16 v[32:35], a[72:75], v[80:83], v[32:35]
    ds_read_b128 v[72:75], v4 offset:24576
    s_cselect_b32 s18, 0x1000000, 0
    v_mfma_f32_16x16x32_bf16 v[36:39], a[76:79], v[80:83], v[36:39]
    ds_read_b128 v[76:79], v5 offset:24576
    v_mfma_f32_16x16x32_bf16 v[44:47], a[76:79], v[84:87], v[44:47]
    v_mfma_f32_16x16x32_bf16 v[40:43], a[72:75], v[84:87], v[40:43]
    s_waitcnt lgkmcnt(4)
    v_mfma_f32_16x16x32_bf16 v[32:35], a[80:83], v[88:91], v[32:35]
    ds_read_b128 v[80:83], v4 offset:25600
    s_add_u32 m0, s20, 0
    v_mfma_f32_16x16x32_bf16 v[36:39], a[84:87], v[88:91], v[36:39]
    ds_read_b128 v[84:87], v5 offset:25600
    buffer_load_dwordx4 v1, s[8:11], s23 offen offset:0 lds
    v_mfma_f32_16x16x32_bf16 v[44:47], a[84:87], v[92:95], v[44:47]
    v_mfma_f32_16x16x32_bf16 v[40:43], a[80:83], v[92:95], v[40:43]
    s_waitcnt lgkmcnt(4)
    v_mfma_f32_16x16x32_bf16 v[32:35], a[88:91], v[96:99], v[32:35]
    ds_read_b128 v[88:91], v4 offset:26624
    v_mfma_f32_16x16x32_bf16 v[36:39], a[92:95], v[96:99], v[36:39]
    ds_read_b128 v[92:95], v5 offset:26624
    buffer_load_dwordx4 v1, s[8:11], s23 offen offset:1024 lds
    v_mfma_f32_16x16x32_bf16 v[44:47], a[92:95], v[100:103], v[44:47]
    v_mfma_f32_16x16x32_bf16 v[40:43], a[88:91], v[100:103], v[40:43]
    s_waitcnt lgkmcnt(4)
    v_mfma_f32_16x16x32_bf16 v[32:35], a[96:99], v[72:75], v[32:35]
    ds_read_b128 v[96:99], v4 offset:27648
    v_mfma_f32_16x16x32_bf16 v[36:39], a[100:103], v[72:75], v[36:39]
    ds_read_b128 v[100:103], v5 offset:27648
    v_mfma_f32_16x16x32_bf16 v[44:47], a[100:103], v[76:79], v[44:47]
    v_add_u32 v4, s22, v4
    v_add_u32 v5, s22, v5
    v_mfma_f32_16x16x32_bf16 v[40:43], a[96:99], v[76:79], v[40:43]
    buffer_load_dwordx4 v1, s[8:11], s23 offen offset:2048 lds
    s_waitcnt vmcnt(5)
    s_barrier
    s_waitcnt lgkmcnt(4)
    v_mfma_f32_16x16x32_bf16 v[32:35], a[104:107], v[80:83], v[32:35]
    ds_read_b128 v[72:75], v4 offset:0
    s_add_u32 s26, s26, 1
    v_mfma_f32_16x16x32_bf16 v[36:39], a[108:111], v[80:83], v[36:39]
    ds_read_b128 v[76:79], v5 offset:0
    v_mov_b32 v12, s26
    v_mfma_f32_16x16x32_bf16 v[44:47], a[108:111], v[84:87], v[44:47]
    buffer_store_dword v12, v11, s[8:11], s27 offen
    v_mfma_f32_16x16x32_bf16 v[40:43], a[104:107], v[84:87], v[40:43]
    buffer_load_dwordx4 v1, s[8:11], s23 offen offset:3072 lds
    s_waitcnt lgkmcnt(4)
    v_mfma_f32_16x16x32_bf16 v[32:35], a[112:115], v[88:91], v[32:35]
    ds_read_b128 v[80:83], v4 offset:1024
    v_mfma_f32_16x16x32_bf16 v[36:39], a[116:119], v[88:91], v[36:39]
    ds_read_b128 v[84:87], v5 offset:1024
    v_mov_b32 v18, s26
    v_mfma_f32_16x16x32_bf16 v[44:47], a[116:119], v[92:95], v[44:47]
    v_writelane_b32 v18, s34, 32
    v_writelane_b32 v18, s40, 33
    v_mfma_f32_16x16x32_bf16 v[40:43], a[112:115], v[92:95], v[40:43]
    s_waitcnt lgkmcnt(4)
    v_mfma_f32_16x16x32_bf16 v[32:35], a[120:123], v[96:99], v[32:35]
    ds_read_b128 v[88:91], v4 offset:2048
    s_add_u32 m0, s20, 4096
    v_mfma_f32_16x16x32_bf16 v[36:39], a[124:127], v[96:99], v[36:39]
    ds_read_b128 v[92:95], v5 offset:2048
    buffer_load_dwordx4 v2, s[8:11], s23 offen offset:0 lds
    v_mfma_f32_16x16x32_bf16 v[44:47], a[124:127], v[100:103], v[44:47]
    s_cmp_ge_u32 s21, 131072
    s_cselect_b32 s22, 0xfffe0000, s29
    v_mfma_f32_16x16x32_bf16 v[40:43], a[120:123], v[100:103], v[40:43]
    s_add_u32 s21, s21, s22
    s_waitcnt lgkmcnt(4)
    v_mfma_f32_16x16x32_bf16 v[32:35], a[128:131], v[72:75], v[32:35]
    ds_read_b128 v[96:99], v4 offset:3072
    v_mfma_f32_16x16x32_bf16 v[36:39], a[132:135], v[72:75], v[36:39]
    ds_read_b128 v[100:103], v5 offset:3072
    buffer_load_dwordx4 v2, s[8:11], s23 offen offset:1024 lds
    v_mfma_f32_16x16x32_bf16 v[44:47], a[132:135], v[76:79], v[44:47]
    v_mfma_f32_16x16x32_bf16 v[40:43], a[128:131], v[76:79], v[40:43]
    s_waitcnt lgkmcnt(4)
    v_mfma_f32_16x16x32_bf16 v[32:35], a[136:139], v[80:83], v[32:35]
    ds_read_b128 v[72:75], v4 offset:8192
    v_mfma_f32_16x16x32_bf16 v[36:39], a[140:143], v[80:83], v[36:39]
    ds_read_b128 v[76:79], v5 offset:8192
    v_mfma_f32_16x16x32_bf16 v[44:47], a[140:143], v[84:87], v[44:47]
    buffer_load_dwordx4 v2, s[8:11], s23 offen offset:2048 lds
    v_mfma_f32_16x16x32_bf16 v[40:43], a[136:139], v[84:87], v[40:43]
    s_waitcnt lgkmcnt(4)
    v_mfma_f32_16x16x32_bf16 v[32:35], a[144:147], v[88:91], v[32:35]
    ds_read_b128 v[80:83], v4 offset:9216
    global_load_dword v19, v[16:17], off sc1
    v_mfma_f32_16x16x32_bf16 v[36:39], a[148:151], v[88:91], v[36:39]
    ds_read_b128 v[84:87], v5 offset:9216
    v_mfma_f32_16x16x32_bf16 v[44:47], a[148:151], v[92:95], v[44:47]
    v_mfma_f32_16x16x32_bf16 v[40:43], a[144:147], v[92:95], v[40:43]
    buffer_load_dwordx4 v2, s[8:11], s23 offen offset:3072 lds
    s_waitcnt lgkmcnt(4)
    v_mfma_f32_16x16x32_bf16 v[32:35], a[152:155], v[96:99], v[32:35]
    ds_read_b128 v[88:91], v4 offset:10240
    s_add_u32 s20, s20, 32768
    v_mfma_f32_16x16x32_bf16 v[36:39], a[156:159], v[96:99], v[36:39]
    ds_read_b128 v[92:95], v5 offset:10240
    s_cmp_ge_u32 s20, 163840
    v_mfma_f32_16x16x32_bf16 v[44:47], a[156:159], v[100:103], v[44:47]
    s_cselect_b32 s60, 163840, 0
    s_sub_u32 s20, s20, s60
    v_mfma_f32_16x16x32_bf16 v[40:43], a[152:155], v[100:103], v[40:43]
    s_add_u32 s33, s33, 3
    s_waitcnt lgkmcnt(4)
    v_mfma_f32_16x16x32_bf16 v[32:35], a[160:163], v[72:75], v[32:35]
    ds_read_b128 v[96:99], v4 offset:11264
    s_lshl_b32 s61, s33, 13
    v_mfma_f32_16x16x32_bf16 v[36:39], a[164:167], v[72:75], v[36:39]
    ds_read_b128 v[100:103], v5 offset:11264
    s_and_b32 s61, s61, 0x2000
    v_mfma_f32_16x16x32_bf16 v[44:47], a[164:167], v[76:79], v[44:47]
    s_xor_b32 s61, s61, s31
    s_lshl_b32 s23, s33, 21
    v_mfma_f32_16x16x32_bf16 v[40:43], a[160:163], v[76:79], v[40:43]
    s_add_u32 s23, s23, s61
    s_waitcnt lgkmcnt(4)
    v_mfma_f32_16x16x32_bf16 v[32:35], a[168:171], v[80:83], v[32:35]
    ds_read_b128 v[72:75], v4 offset:16384
    s_cmp_gt_u32 s33, s35
    v_mfma_f32_16x16x32_bf16 v[36:39], a[172:175], v[80:83], v[36:39]
    ds_read_b128 v[76:79], v5 offset:16384
    s_cselect_b32 s23, 0xc000000, s23
    v_mfma_f32_16x16x32_bf16 v[44:47], a[172:175], v[84:87], v[44:47]
    s_add_u32 m0, s20, 0
    v_mfma_f32_16x16x32_bf16 v[40:43], a[168:171], v[84:87], v[40:43]
    buffer_load_dwordx4 v1, s[8:11], s23 offen offset:0 lds
    s_waitcnt lgkmcnt(4)
    v_mfma_f32_16x16x32_bf16 v[32:35], a[176:179], v[88:91], v[32:35]
    ds_read_b128 v[80:83], v4 offset:17408
    buffer_load_dwordx4 v1, s[8:11], s23 offen offset:1024 lds
    v_mfma_f32_16x16x32_bf16 v[36:39], a[180:183], v[88:91], v[36:39]
    ds_read_b128 v[84:87], v5 offset:17408
    v_mfma_f32_16x16x32_bf16 v[44:47], a[180:183], v[92:95], v[44:47]
    buffer_load_dwordx4 v1, s[8:11], s23 offen offset:2048 lds
    v_mfma_f32_16x16x32_bf16 v[40:43], a[176:179], v[92:95], v[40:43]
    s_waitcnt lgkmcnt(4)
    v_mfma_f32_16x16x32_bf16 v[32:35], a[184:187], v[96:99], v[32:35]
    ds_read_b128 v[88:91], v4 offset:18432
    v_mfma_f32_16x16x32_bf16 v[36:39], a[188:191], v[96:99], v[36:39]
    ds_read_b128 v[92:95], v5 offset:18432
    v_mfma_f32_16x16x32_bf16 v[44:47], a[188:191], v[100:103], v[44:47]
    v_mfma_f32_16x16x32_bf16 v[40:43], a[184:187], v[100:103], v[40:43]
    buffer_load_dwordx4 v1, s[8:11], s23 offen offset:3072 lds
    s_waitcnt lgkmcnt(4)
    v_mfma_f32_16x16x32_bf16 v[32:35], a[192:195], v[72:75], v[32:35]
    ds_read_b128 v[96:99], v4 offset:19456
    s_waitcnt vmcnt(5)
    v_cmp_lt_u32 vcc, v19, v18
    v_mfma_f32_16x16x32_bf16 v[36:39], a[196:199], v[72:75], v[36:39]
    ds_read_b128 v[100:103], v5 offset:19456
    v_mfma_f32_16x16x32_bf16 v[44:47], a[196:199], v[76:79], v[44:47]
    v_mfma_f32_16x16x32_bf16 v[40:43], a[192:195], v[76:79], v[40:43]
    s_cbranch_vccnz seg_pslow
seg_pok:
    s_waitcnt lgkmcnt(4)
    v_mfma_f32_16x16x32_bf16 v[32:35], a[200:203], v[80:83], v[32:35]
    ds_read_b128 v[72:75], v4 offset:24576
    buffer_load_dwordx4 v[104:107], v23, s[8:11], s24 offen offset:0 sc1
    v_mfma_f32_16x16x32_bf16 v[36:39], a[204:207], v[80:83], v[36:39]
    ds_read_b128 v[76:79], v5 offset:24576
    buffer_load_dwordx4 v[108:111], v23, s[8:11], s24 offen offset:1024 sc1
    v_mfma_f32_16x16x32_bf16 v[44:47], a[204:207], v[84:87], v[44:47]
    buffer_load_dwordx4 v[112:115], v23, s[8:11], s24 offen offset:2048 sc1
    v_mfma_f32_16x16x32_bf16 v[40:43], a[200:203], v[84:87], v[40:43]
    s_add_u32 m0, s20, 4096
    s_waitcnt lgkmcnt(4)
    v_mfma_f32_16x16x32_bf16 v[32:35], a[208:211], v[88:91], v[32:35]
    ds_read_b128 v[80:83], v4 offset:25600
    buffer_load_dwordx4 v2, s[8:11], s23 offen offset:0 lds
    v_mfma_f32_16x16x32_bf16 v[36:39], a[212:215], v[88:91], v[36:39]
    ds_read_b128 v[84:87], v5 offset:25600
    buffer_load_dwordx4 v2, s[8:11], s23 offen offset:1024 lds
    v_mfma_f32_16x16x32_bf16 v[44:47], a[212:215], v[92:95], v[44:47]
    v_mfma_f32_16x16x32_bf16 v[40:43], a[208:211], v[92:95], v[40:43]
    s_waitcnt lgkmcnt(4)
    v_mfma_f32_16x16x32_bf16 v[32:35], a[216:219], v[96:99], v[32:35]
    ds_read_b128 v[88:91], v4 offset:26624
    v_mfma_f32_16x16x32_bf16 v[36:39], a[220:223], v[96:99], v[36:39]
    ds_read_b128 v[92:95], v5 offset:26624
    v_mfma_f32_16x16x32_bf16 v[44:47], a[220:223], v[100:103], v[44:47]
    buffer_load_dwordx4 v2, s[8:11], s23 offen offset:2048 lds
    v_mfma_f32_16x16x32_bf16 v[40:43], a[216:219], v[100:103], v[40:43]
    s_waitcnt lgkmcnt(4)
    v_mfma_f32_16x16x32_bf16 v[32:35], a[224:227], v[72:75], v[32:35]
    ds_read_b128 v[96:99], v4 offset:27648
    v_mfma_f32_16x16x32_bf16 v[36:39], a[228:231], v[72:75], v[36:39]
    ds_read_b128 v[100:103], v5 offset:27648
    v_mfma_f32_16x16x32_bf16 v[44:47], a[228:231], v[76:79], v[44:47]
    v_add_u32 v4, s22, v4
    v_add_u32 v5, s22, v5
    v_mfma_f32_16x16x32_bf16 v[40:43], a[224:227], v[76:79], v[40:43]
    buffer_load_dwordx4 v2, s[8:11], s23 offen offset:3072 lds
    s_waitcnt vmcnt(26)
    s_barrier
    s_waitcnt lgkmcnt(4)
    v_mfma_f32_16x16x32_bf16 v[32:35], a[232:235], v[80:83], v[32:35]
    ds_read_b128 v[72:75], v4 offset:0
    s_add_u32 s20, s20, 32768
    s_cmp_ge_u32 s20, 163840
    v_mfma_f32_16x16x32_bf16 v[36:39], a[236:239], v[80:83], v[36:39]
    ds_read_b128 v[76:79], v5 offset:0
    s_cselect_b32 s60, 163840, 0
    s_sub_u32 s20, s20, s60
    v_mfma_f32_16x16x32_bf16 v[44:47], a[236:239], v[84:87], v[44:47]
    s_add_u32 s37, s23, 0x600000
    s_xor_b32 s37, s37, 0x2000
    v_mfma_f32_16x16x32_bf16 v[40:43], a[232:235], v[84:87], v[40:43]
    s_cmp_ge_u32 s33, s35
    s_cselect_b32 s62, 0xc000000, s38
    s_waitcnt lgkmcnt(4)
    v_mfma_f32_16x16x32_bf16 v[32:35], a[240:243], v[88:91], v[32:35]
    ds_read_b128 v[80:83], v4 offset:1024
    s_add_u32 s37, s37, s62
    s_add_u32 s23, s23, 0x40000
    v_mfma_f32_16x16x32_bf16 v[36:39], a[244:247], v[88:91], v[36:39]
    ds_read_b128 v[84:87], v5 offset:1024
    v_mfma_f32_16x16x32_bf16 v[44:47], a[244:247], v[92:95], v[44:47]
    v_mfma_f32_16x16x32_bf16 v[40:43], a[240:243], v[92:95], v[40:43]
    s_waitcnt lgkmcnt(4)
    v_mfma_f32_16x16x32_bf16 v[48:51], a[248:251], v[96:99], v[32:35]
    ds_read_b128 v[88:91], v4 offset:2048
    v_mfma_f32_16x16x32_bf16 v[52:55], a[252:255], v[96:99], v[36:39]
    ds_read_b128 v[92:95], v5 offset:2048
    v_mfma_f32_16x16x32_bf16 v[60:63], a[252:255], v[100:103], v[44:47]
    s_cmp_lt_u32 s26, s39
    v_mfma_f32_16x16x32_bf16 v[56:59], a[248:251], v[100:103], v[40:43]
    s_cbranch_scc1 seg_p
    s_xor_b32 s24, s24, 0x80000
    s_waitcnt vmcnt(0)
    v_pk_add_f32 v[104:105], v[104:105], v[64:65]
    v_pk_add_f32 v[106:107], v[106:107], v[66:67]
    v_pk_add_f32 v[108:109], v[108:109], v[112:113]
    v_pk_add_f32 v[110:111], v[110:111], v[114:115]
    v_pk_add_f32 v[104:105], v[104:105], v[108:109]
    v_pk_add_f32 v[106:107], v[106:107], v[110:111]
    v_cvt_pk_bf16_f32 v104, 0, v104
    v_cvt_pk_bf16_f32 v105, 0, v105
    v_cvt_pk_bf16_f32 v106, 0, v106
    v_cvt_pk_bf16_f32 v107, 0, v107
    buffer_store_dwordx4 v[104:107], v15, s[16:19], s25 offen
    buffer_store_dwordx4 v[48:51], v20, s[8:11], s24 offen
    buffer_store_dwordx4 v[52:55], v21, s[8:11], s24 offen
    buffer_store_dwordx4 v[56:59], v22, s[8:11], s24 offen
    s_add_u32 s25, s25, 0xc0000
    s_waitcnt vmcnt(0)
    s_barrier
    s_add_u32 s26, s26, 1
    v_mov_b32 v12, s26
    buffer_store_dword v12, v11, s[8:11], s27 offen
    v_mov_b32 v18, s26
    v_writelane_b32 v18, s34, 32
    v_writelane_b32 v18, s40, 33
L_sp_59:
    global_load_dword v19, v[16:17], off sc1
    s_add_u32 s30, s30, 1
    s_cmp_gt_u32 s30, 0x200000
    s_cbranch_scc1 chain_kernel_wabort
    s_waitcnt vmcnt(0)
    v_cmp_lt_u32 vcc, v19, v18
    s_cbranch_vccz L_spok_60
    s_branch L_sp_59
L_spok_60:
    buffer_load_dwordx4 v[104:107], v23, s[8:11], s24 offen offset:0 sc1
    buffer_load_dwordx4 v[108:111], v23, s[8:11], s24 offen offset:1024 sc1
    buffer_load_dwordx4 v[112:115], v23, s[8:11], s24 offen offset:2048 sc1
    s_waitcnt vmcnt(0) lgkmcnt(0)
    v_pk_add_f32 v[104:105], v[104:105], v[60:61]
    v_pk_add_f32 v[106:107], v[106:107], v[62:63]
    v_pk_add_f32 v[108:109], v[108:109], v[112:113]
    v_pk_add_f32 v[110:111], v[110:111], v[114:115]
    v_pk_add_f32 v[104:105], v[104:105], v[108:109]
    v_pk_add_f32 v[106:107], v[106:107], v[110:111]
    v_cvt_pk_bf16_f32 v104, 0, v104
    v_cvt_pk_bf16_f32 v105, 0, v105
    v_cvt_pk_bf16_f32 v106, 0, v106
    v_cvt_pk_bf16_f32 v107, 0, v107
    buffer_store_dwordx4 v[104:107], v15, s[16:19], s25 offen
seg_t0:
    s_mov_b32 s35, 63
    s_lshr_b32 s60, s57, 3
    s_lshl_b32 s60, s60, 8
    s_add_u32 s60, s60, 0xb201000
    s_add_u32 s37, s60, s100
    s_addc_u32 s38, s101, 0
seg_t:
    s_and_b32 s33, s36, 0xff
    s_cbranch_scc0 seg_end
    s_lshr_b32 s36, s36, 8
    s_lshl_b32 s20, s58, 13
    s_mov_b32 s21, 0
    s_lshr_b32 s60, s57, 4
    s_lshl_b32 s60, s60, 12
    v_add_u32 v5, s60, v1
    v_xor_b32 v4, 4096, v5
    s_lshl_b32 s61, s33, 13
    s_and_b32 s61, s61, 0x2000
    s_xor_b32 s61, s61, s31
    s_lshl_b32 s23, s33, 21
    s_add_u32 s23, s23, s61
    s_cmp_gt_u32 s33, s35
    s_cselect_b32 s23, 0xc000000, s23
    s_xor_b32 s24, s24, 0x80000
    s_lshl_b32 s25, s33, 18
    s_add_u32 s34, s33, 3
    s_min_u32 s34, s34, 64
    v_mov_b32 v18, s26
    v_writelane_b32 v18, s34, 32
    v_writelane_b32 v18, s40, 33
L_sp_61:
    global_load_dword v19, v[16:17], off sc1
    s_add_u32 s30, s30, 1
    s_cmp_gt_u32 s30, 0x200000
    s_cbranch_scc1 chain_kernel_wabort
    s_waitcnt vmcnt(0)
    v_cmp_lt_u32 vcc, v19, v18
    s_cbranch_vccz L_spok_62
    s_sleep 2
    s_branch L_sp_61
L_spok_62:
    s_cmp_lt_u32 s33, 62
    s_cbranch_scc1 L_tf_63
    v_writelane_b32 v16, s37, 33
    v_writelane_b32 v17, s38, 33
    s_mov_b32 s40, 32
    v_mov_b32 v18, s26
    v_writelane_b32 v18, s34, 32
    v_writelane_b32 v18, s40, 33
L_sp_64:
    global_load_dword v19, v[16:17], off sc1
    s_add_u32 s30, s30, 1
    s_cmp_gt_u32 s30, 0x200000
    s_cbranch_scc1 chain_kernel_wabort
    s_waitcnt vmcnt(0)
    v_cmp_lt_u32 vcc, v19, v18
    s_cbranch_vccz L_spok_65
    s_branch L_sp_64
L_spok_65:
L_tf_63:
    s_add_u32 m0, s20, 0
    s_nop 0
    buffer_load_dwordx4 v1, s[8:11], s23 offen offset:0 lds
    buffer_load_dwordx4 v1, s[8:11], s23 offen offset:1024 lds
    buffer_load_dwordx4 v1, s[8:11], s23 offen offset:2048 lds
    buffer_load_dwordx4 v1, s[8:11], s23 offen offset:3072 lds
    s_add_u32 m0, s20, 4096
    s_nop 0
    buffer_load_dwordx4 v2, s[8:11], s23 offen offset:0 lds
    buffer_load_dwordx4 v2, s[8:11], s23 offen offset:1024 lds
    buffer_load_dwordx4 v2, s[8:11], s23 offen offset:2048 lds
    buffer_load_dwordx4 v2, s[8:11], s23 offen offset:3072 lds
    s_add_u32 s20, s20, 32768
    s_cmp_ge_u32 s20, 163840
    s_cselect_b32 s60, 163840, 0
    s_sub_u32 s20, s20, s60
    s_add_u32 s23, s23, 0x40000
    s_add_u32 m0, s20, 0
    s_nop 0
    buffer_load_dwordx4 v1, s[8:11], s23 offen offset:0 lds
    buffer_load_dwordx4 v1, s[8:11], s23 offen offset:1024 lds
    buffer_load_dwordx4 v1, s[8:11], s23 offen offset:2048 lds
    buffer_load_dwordx4 v1, s[8:11], s23 offen offset:3072 lds
    s_add_u32 m0, s20, 4096
    s_nop 0
    buffer_load_dwordx4 v2, s[8:11], s23 offen offset:0 lds
    buffer_load_dwordx4 v2, s[8:11], s23 offen offset:1024 lds
    buffer_load_dwordx4 v2, s[8:11], s23 offen offset:2048 lds
    buffer_load_dwordx4 v2, s[8:11], s23 offen offset:3072 lds
    s_waitcnt vmcnt(8)
    s_barrier
    ds_read_b128 v[72:75], v4 offset:0
    ds_read_b128 v[76:79], v5 offset:0
    ds_read_b128 v[80:83], v4 offset:1024
    ds_read_b128 v[84:87], v5 offset:1024
    ds_read_b128 v[88:91], v4 offset:2048
    ds_read_b128 v[92:95], v5 offset:2048
    s_waitcnt lgkmcnt(4)
    v_mfma_f32_16x16x32_bf16 v[32:35], a[0:3], v[72:75], 0
    ds_read_b128 v[96:99], v4 offset:3072
    v_mfma_f32_16x16x32_bf16 v[36:39], a[4:7], v[72:75], 0
    ds_read_b128 v[100:103], v5 offset:3072
    v_mfma_f32_16x16x32_bf16 v[44:47], a[4:7], v[76:79], 0
    v_mfma_f32_16x16x32_bf16 v[40:43], a[0:3], v[76:79], 0
    s_waitcnt lgkmcnt(4)
    v_mfma_f32_16x16x32_bf16 v[32:35], a[8:11], v[80:83], v[32:35]
    ds_read_b128 v[72:75], v4 offset:8192
    v_mfma_f32_16x16x32_bf16 v[36:39], a[12:15], v[80:83], v[36:39]
    ds_read_b128 v[76:79], v5 offset:8192
    v_mfma_f32_16x16x32_bf16 v[44:47], a[12:15], v[84:87], v[44:47]
    v_mfma_f32_16x16x32_bf16 v[40:43], a[8:11], v[84:87], v[40:43]
    s_waitcnt lgkmcnt(4)
    v_mfma_f32_16x16x32_bf16 v[32:35], a[16:19], v[88:91], v[32:35]
    ds_read_b128 v[80:83], v4 offset:9216
    v_mfma_f32_16x16x32_bf16 v[36:39], a[20:23], v[88:91], v[36:39]
    ds_read_b128 v[84:87], v5 offset:9216
    v_mfma_f32_16x16x32_bf16 v[44:47], a[20:23], v[92:95], v[44:47]
    v_mfma_f32_16x16x32_bf16 v[40:43], a[16:19], v[92:95], v[40:43]
    s_waitcnt lgkmcnt(4)
    v_mfma_f32_16x16x32_bf16 v[32:35], a[24:27], v[96:99], v[32:35]
    ds_read_b128 v[88:91], v4 offset:10240
    v_mfma_f32_16x16x32_bf16 v[36:39], a[28:31], v[96:99], v[36:39]
    ds_read_b128 v[92:95], v5 offset:10240
    v_mfma_f32_16x16x32_bf16 v[44:47], a[28:31], v[100:103], v[44:47]
    v_mfma_f32_16x16x32_bf16 v[40:43], a[24:27], v[100:103], v[40:43]
    s_waitcnt lgkmcnt(4)
    v_mfma_f32_16x16x32_bf16 v[32:35], a[32:35], v[72:75], v[32:35]
    ds_read_b128 v[96:99], v4 offset:11264
    v_mfma_f32_16x16x32_bf16 v[36:39], a[36:39], v[72:75], v[36:39]
    ds_read_b128 v[100:103], v5 offset:11264
    v_mfma_f32_16x16x32_bf16 v[44:47], a[36:39], v[76:79], v[44:47]
    v_mfma_f32_16x16x32_bf16 v[40:43], a[32:35], v[76:79], v[40:43]
    s_waitcnt lgkmcnt(4)
    v_mfma_f32_16x16x32_bf16 v[32:35], a[40:43], v[80:83], v[32:35]
    ds_read_b128 v[72:75], v4 offset:16384
    v_mfma_f32_16x16x32_bf16 v[36:39], a[44:47], v[80:83], v[36:39]
    ds_read_b128 v[76:79], v5 offset:16384
    v_mfma_f32_16x16x32_bf16 v[44:47], a[44:47], v[84:87], v[44:47]
    v_mfma_f32_16x16x32_bf16 v[40:43], a[40:43], v[84:87], v[40:43]
    s_waitcnt lgkmcnt(4)
    v_mfma_f32_16x16x32_bf16 v[32:35], a[48:51], v[88:91], v[32:35]
    ds_read_b128 v[80:83], v4 offset:17408
    v_mfma_f32_16x16x32_bf16 v[36:39], a[52:55], v[88:91], v[36:39]
    ds_read_b128 v[84:87], v5 offset:17408
    v_mfma_f32_16x16x32_bf16 v[44:47], a[52:55], v[92:95], v[44:47]
    v_mfma_f32_16x16x32_bf16 v[40:43], a[48:51], v[92:95], v[40:43]
    s_waitcnt lgkmcnt(4)
    v_mfma_f32_16x16x32_bf16 v[32:35], a[56:59], v[96:99], v[32:35]
    ds_read_b128 v[88:91], v4 offset:18432
    v_mfma_f32_16x16x32_bf16 v[36:39], a[60:63], v[96:99], v[36:39]
    ds_read_b128 v[92:95], v5 offset:18432
    v_mfma_f32_16x16x32_bf16 v[44:47], a[60:63], v[100:103], v[44:47]
    v_mfma_f32_16x16x32_bf16 v[40:43], a[56:59], v[100:103], v[40:43]
    s_waitcnt lgkmcnt(4)
    v_mfma_f32_16x16x32_bf16 v[32:35], a[64:67], v[72:75], v[32:35]
    ds_read_b128 v[96:99], v4 offset:19456
    v_mfma_f32_16x16x32_bf16 v[36:39], a[68:71], v[72:75], v[36:39]
    ds_read_b128 v[100:103], v5 offset:19456
    v_mfma_f32_16x16x32_bf16 v[44:47], a[68:71], v[76:79], v[44:47]
    v_mfma_f32_16x16x32_bf16 v[40:43], a[64:67], v[76:79], v[40:43]
    s_waitcnt lgkmcnt(4)
    v_mfma_f32_16x16x32_bf16 v[32:35], a[72:75], v[80:83], v[32:35]
    ds_read_b128 v[72:75], v4 offset:24576
    v_mfma_f32_16x16x32_bf16 v[36:39], a[76:79], v[80:83], v[36:39]
    ds_read_b128 v[76:79], v5 offset:24576
    v_mfma_f32_16x16x32_bf16 v[44:47], a[76:79], v[84:87], v[44:47]
    v_mfma_f32_16x16x32_bf16 v[40:43], a[72:75], v[84:87], v[40:43]
    s_waitcnt lgkmcnt(4)
    v_mfma_f32_16x16x32_bf16 v[32:35], a[80:83], v[88:91], v[32:35]
    ds_read_b128 v[80:83], v4 offset:25600
    v_mfma_f32_16x16x32_bf16 v[36:39], a[84:87], v[88:91], v[36:39]
    ds_read_b128 v[84:87], v5 offset:25600
    v_mfma_f32_16x16x32_bf16 v[44:47], a[84:87], v[92:95], v[44:47]
    v_mfma_f32_16x16x32_bf16 v[40:43], a[80:83], v[92:95], v[40:43]
    s_waitcnt lgkmcnt(4)
    v_mfma_f32_16x16x32_bf16 v[32:35], a[88:91], v[96:99], v[32:35]
    ds_read_b128 v[88:91], v4 offset:26624
    v_mfma_f32_16x16x32_bf16 v[36:39], a[92:95], v[96:99], v[36:39]
    ds_read_b128 v[92:95], v5 offset:26624
    v_mfma_f32_16x16x32_bf16 v[44:47], a[92:95], v[100:103], v[44:47]
    v_mfma_f32_16x16x32_bf16 v[40:43], a[88:91], v[100:103], v[40:43]
    s_waitcnt lgkmcnt(4)
    v_mfma_f32_16x16x32_bf16 v[32:35], a[96:99], v[72:75], v[32:35]
    ds_read_b128 v[96:99], v4 offset:27648
    v_mfma_f32_16x16x32_bf16 v[36:39], a[100:103], v[72:75], v[36:39]
    ds_read_b128 v[100:103], v5 offset:27648
    v_mfma_f32_16x16x32_bf16 v[44:47], a[100:103], v[76:79], v[44:47]
    v_mfma_f32_16x16x32_bf16 v[40:43], a[96:99], v[76:79], v[40:43]
    s_waitcnt vmcnt(0)
    s_barrier
    s_waitcnt lgkmcnt(4)
    v_mfma_f32_16x16x32_bf16 v[32:35], a[104:107], v[80:83], v[32:35]
    ds_read_b128 v[72:75], v4 offset:32768
    v_mfma_f32_16x16x32_bf16 v[36:39], a[108:111], v[80:83], v[36:39]
    ds_read_b128 v[76:79], v5 offset:32768
    v_mfma_f32_16x16x32_bf16 v[44:47], a[108:111], v[84:87], v[44:47]
    v_mfma_f32_16x16x32_bf16 v[40:43], a[104:107], v[84:87], v[40:43]
    s_waitcnt lgkmcnt(4)
    v_mfma_f32_16x16x32_bf16 v[32:35], a[112:115], v[88:91], v[32:35]
    ds_read_b128 v[80:83], v4 offset:33792
    v_mfma_f32_16x16x32_bf16 v[36:39], a[116:119], v[88:91], v[36:39]
    ds_read_b128 v[84:87], v5 offset:33792
    v_mfma_f32_16x16x32_bf16 v[44:47], a[116:119], v[92:95], v[44:47]
    v_mfma_f32_16x16x32_bf16 v[40:43], a[112:115], v[92:95], v[40:43]
    s_waitcnt lgkmcnt(4)
    v_mfma_f32_16x16x32_bf16 v[32:35], a[120:123], v[96:99], v[32:35]
    ds_read_b128 v[88:91], v4 offset:34816
    v_mfma_f32_16x16x32_bf16 v[36:39], a[124:127], v[96:99], v[36:39]
    ds_read_b128 v[92:95], v5 offset:34816
    v_mfma_f32_16x16x32_bf16 v[44:47], a[124:127], v[100:103], v[44:47]
    v_mfma_f32_16x16x32_bf16 v[40:43], a[120:123], v[100:103], v[40:43]
    s_waitcnt lgkmcnt(4)
    v_mfma_f32_16x16x32_bf16 v[32:35], a[128:131], v[72:75], v[32:35]
    ds_read_b128 v[96:99], v4 offset:35840
    v_mfma_f32_16x16x32_bf16 v[36:39], a[132:135], v[72:75], v[36:39]
    ds_read_b128 v[100:103], v5 offset:35840
    v_mfma_f32_16x16x32_bf16 v[44:47], a[132:135], v[76:79], v[44:47]
    v_mfma_f32_16x16x32_bf16 v[40:43], a[128:131], v[76:79], v[40:43]
    s_waitcnt lgkmcnt(4)
    v_mfma_f32_16x16x32_bf16 v[32:35], a[136:139], v[80:83], v[32:35]
    ds_read_b128 v[72:75], v4 offset:40960
    v_mfma_f32_16x16x32_bf16 v[36:39], a[140:143], v[80:83], v[36:39]
    ds_read_b128 v[76:79], v5 offset:40960
    v_mfma_f32_16x16x32_bf16 v[44:47], a[140:143], v[84:87], v[44:47]
    v_mfma_f32_16x16x32_bf16 v[40:43], a[136:139], v[84:87], v[40:43]
    s_waitcnt lgkmcnt(4)
    v_mfma_f32_16x16x32_bf16 v[32:35], a[144:147], v[88:91], v[32:35]
    ds_read_b128 v[80:83], v4 offset:41984
    v_mfma_f32_16x16x32_bf16 v[36:39], a[148:151], v[88:91], v[36:39]
    ds_read_b128 v[84:87], v5 offset:41984
    v_mfma_f32_16x16x32_bf16 v[44:47], a[148:151], v[92:95], v[44:47]
    v_mfma_f32_16x16x32_bf16 v[40:43], a[144:147], v[92:95], v[40:43]
    s_waitcnt lgkmcnt(4)
    v_mfma_f32_16x16x32_bf16 v[32:35], a[152:155], v[96:99], v[32:35]
    ds_read_b128 v[88:91], v4 offset:43008
    v_mfma_f32_16x16x32_bf16 v[36:39], a[156:159], v[96:99], v[36:39]
    ds_read_b128 v[92:95], v5 offset:43008
    v_mfma_f32_16x16x32_bf16 v[44:47], a[156:159], v[100:103], v[44:47]
    v_mfma_f32_16x16x32_bf16 v[40:43], a[152:155], v[100:103], v[40:43]
    s_waitcnt lgkmcnt(4)
    v_mfma_f32_16x16x32_bf16 v[32:35], a[160:163], v[72:75], v[32:35]
    ds_read_b128 v[96:99], v4 offset:44032
    v_mfma_f32_16x16x32_bf16 v[36:39], a[164:167], v[72:75], v[36:39]
    ds_read_b128 v[100:103], v5 offset:44032
    v_mfma_f32_16x16x32_bf16 v[44:47], a[164:167], v[76:79], v[44:47]
    v_mfma_f32_16x16x32_bf16 v[40:43], a[160:163], v[76:79], v[40:43]
    s_waitcnt lgkmcnt(4)
    v_mfma_f32_16x16x32_bf16 v[32:35], a[168:171], v[80:83], v[32:35]
    ds_read_b128 v[72:75], v4 offset:49152
    v_mfma_f32_16x16x32_bf16 v[36:39], a[172:175], v[80:83], v[36:39]
    ds_read_b128 v[76:79], v5 offset:49152
    v_mfma_f32_16x16x32_bf16 v[44:47], a[172:175], v[84:87], v[44:47]
    v_mfma_f32_16x16x32_bf16 v[40:43], a[168:171], v[84:87], v[40:43]
    s_waitcnt lgkmcnt(4)
    v_mfma_f32_16x16x32_bf16 v[32:35], a[176:179], v[88:91], v[32:35]
    ds_read_b128 v[80:83], v4 offset:50176
    v_mfma_f32_16x16x32_bf16 v[36:39], a[180:183], v[88:91], v[36:39]
    ds_read_b128 v[84:87], v5 offset:50176
    v_mfma_f32_16x16x32_bf16 v[44:47], a[180:183], v[92:95], v[44:47]
    v_mfma_f32_16x16x32_bf16 v[40:43], a[176:179], v[92:95], v[40:43]
    s_waitcnt lgkmcnt(4)
    v_mfma_f32_16x16x32_bf16 v[32:35], a[184:187], v[96:99], v[32:35]
    ds_read_b128 v[88:91], v4 offset:51200
    v_mfma_f32_16x16x32_bf16 v[36:39], a[188:191], v[96:99], v[36:39]
    ds_read_b128 v[92:95], v5 offset:51200
    v_mfma_f32_16x16x32_bf16 v[44:47], a[188:191], v[100:103], v[44:47]
    v_mfma_f32_16x16x32_bf16 v[40:43], a[184:187], v[100:103], v[40:43]
    s_waitcnt lgkmcnt(4)
    v_mfma_f32_16x16x32_bf16 v[32:35], a[192:195], v[72:75], v[32:35]
    ds_read_b128 v[96:99], v4 offset:52224
    v_mfma_f32_16x16x32_bf16 v[36:39], a[196:199], v[72:75], v[36:39]
    ds_read_b128 v[100:103], v5 offset:52224
    v_mfma_f32_16x16x32_bf16 v[44:47], a[196:199], v[76:79], v[44:47]
    v_mfma_f32_16x16x32_bf16 v[40:43], a[192:195], v[76:79], v[40:43]
    s_waitcnt lgkmcnt(4)
    v_mfma_f32_16x16x32_bf16 v[32:35], a[200:203], v[80:83], v[32:35]
    ds_read_b128 v[72:75], v4 offset:57344
    v_mfma_f32_16x16x32_bf16 v[36:39], a[204:207], v[80:83], v[36:39]
    ds_read_b128 v[76:79], v5 offset:57344
    v_mfma_f32_16x16x32_bf16 v[44:47], a[204:207], v[84:87], v[44:47]
    v_mfma_f32_16x16x32_bf16 v[40:43], a[200:203], v[84:87], v[40:43]
    s_waitcnt lgkmcnt(4)
    v_mfma_f32_16x16x32_bf16 v[32:35], a[208:211], v[88:91], v[32:35]
    ds_read_b128 v[80:83], v4 offset:58368
    v_mfma_f32_16x16x32_bf16 v[36:39], a[212:215], v[88:91], v[36:39]
    ds_read_b128 v[84:87], v5 offset:58368
    v_mfma_f32_16x16x32_bf16 v[44:47], a[212:215], v[92:95], v[44:47]
    v_mfma_f32_16x16x32_bf16 v[40:43], a[208:211], v[92:95], v[40:43]
    s_waitcnt lgkmcnt(4)
    v_mfma_f32_16x16x32_bf16 v[32:35], a[216:219], v[96:99], v[32:35]
    ds_read_b128 v[88:91], v4 offset:59392
    v_mfma_f32_16x16x32_bf16 v[36:39], a[220:223], v[96:99], v[36:39]
    ds_read_b128 v[92:95], v5 offset:59392
    v_mfma_f32_16x16x32_bf16 v[44:47], a[220:223], v[100:103], v[44:47]
    v_mfma_f32_16x16x32_bf16 v[40:43], a[216:219], v[100:103], v[40:43]
    s_waitcnt lgkmcnt(4)
    v_mfma_f32_16x16x32_bf16 v[32:35], a[224:227], v[72:75], v[32:35]
    ds_read_b128 v[96:99], v4 offset:60416
    v_mfma_f32_16x16x32_bf16 v[36:39], a[228:231], v[72:75], v[36:39]
    ds_read_b128 v[100:103], v5 offset:60416
    v_mfma_f32_16x16x32_bf16 v[44:47], a[228:231], v[76:79], v[44:47]
    v_mfma_f32_16x16x32_bf16 v[40:43], a[224:227], v[76:79], v[40:43]
    s_waitcnt lgkmcnt(4)
    v_mfma_f32_16x16x32_bf16 v[32:35], a[232:235], v[80:83], v[32:35]
    v_mfma_f32_16x16x32_bf16 v[36:39], a[236:239], v[80:83], v[36:39]
    v_mfma_f32_16x16x32_bf16 v[44:47], a[236:239], v[84:87], v[44:47]
    v_mfma_f32_16x16x32_bf16 v[40:43], a[232:235], v[84:87], v[40:43]
    s_waitcnt lgkmcnt(2)
    v_mfma_f32_16x16x32_bf16 v[32:35], a[240:243], v[88:91], v[32:35]
    v_mfma_f32_16x16x32_bf16 v[36:39], a[244:247], v[88:91], v[36:39]
    v_mfma_f32_16x16x32_bf16 v[44:47], a[244:247], v[92:95], v[44:47]
    v_mfma_f32_16x16x32_bf16 v[40:43], a[240:243], v[92:95], v[40:43]
    s_waitcnt lgkmcnt(0)
    v_mfma_f32_16x16x32_bf16 v[48:51], a[248:251], v[96:99], v[32:35]
    v_mfma_f32_16x16x32_bf16 v[52:55], a[252:255], v[96:99], v[36:39]
    v_mfma_f32_16x16x32_bf16 v[60:63], a[252:255], v[100:103], v[44:47]
    v_mfma_f32_16x16x32_bf16 v[56:59], a[248:251], v[100:103], v[40:43]
    s_nop 7
    buffer_store_dwordx4 v[48:51], v20, s[8:11], s24 offen
    buffer_store_dwordx4 v[52:55], v21, s[8:11], s24 offen
    buffer_store_dwordx4 v[56:59], v22, s[8:11], s24 offen
    s_waitcnt vmcnt(0)
    s_barrier
    s_add_u32 s26, s26, 1
    v_mov_b32 v12, s26
    buffer_store_dword v12, v11, s[8:11], s27 offen
    v_mov_b32 v18, s26
    v_writelane_b32 v18, s34, 32
    v_writelane_b32 v18, s40, 33
L_sp_66:
    global_load_dword v19, v[16:17], off sc1
    s_add_u32 s30, s30, 1
    s_cmp_gt_u32 s30, 0x200000
    s_cbranch_scc1 chain_kernel_wabort
    s_waitcnt vmcnt(0)
    v_cmp_lt_u32 vcc, v19, v18
    s_cbranch_vccz L_spok_67
    s_branch L_sp_66
L_spok_67:
    buffer_load_dwordx4 v[104:107], v23, s[8:11], s24 offen offset:0 sc1
    buffer_load_dwordx4 v[108:111], v23, s[8:11], s24 offen offset:1024 sc1
    buffer_load_dwordx4 v[112:115], v23, s[8:11], s24 offen offset:2048 sc1
    s_waitcnt vmcnt(0)
    v_pk_add_f32 v[104:105], v[104:105], v[60:61]
    v_pk_add_f32 v[106:107], v[106:107], v[62:63]
    v_pk_add_f32 v[108:109], v[108:109], v[112:113]
    v_pk_add_f32 v[110:111], v[110:111], v[114:115]
    v_pk_add_f32 v[104:105], v[104:105], v[108:109]
    v_pk_add_f32 v[106:107], v[106:107], v[110:111]
    v_cvt_pk_bf16_f32 v104, 0, v104
    v_cvt_pk_bf16_f32 v105, 0, v105
    v_cvt_pk_bf16_f32 v106, 0, v106
    v_cvt_pk_bf16_f32 v107, 0, v107
    buffer_store_dwordx4 v[104:107], v15, s[16:19], s25 offen
    s_branch seg_t
seg_end:
    s_endpgm
seg_pslow:
L_sp_68:
    global_load_dword v19, v[16:17], off sc1
    s_add_u32 s30, s30, 1
    s_cmp_gt_u32 s30, 0x200000
    s_cbranch_scc1 chain_kernel_wabort
    s_waitcnt vmcnt(0)
    v_cmp_lt_u32 vcc, v19, v18
    s_cbranch_vccz L_spok_69
    s_sleep 2
    s_branch L_sp_68
L_spok_69:
    s_branch seg_pok
    s_endpgm
chain_kernel_wabort:
    s_mov_b64 exec, 1
    v_mov_b32 v1, 0xdeadbeef
    v_mov_b32 v2, 120
    global_store_dword v2, v1, s[98:99]
    s_endpgm
t_g2_c:
    s_mov_b32 s43, 0
    v_bfe_u32 v16, v0, 5, 1
    v_lshlrev_b32 v23, 13, v16
    v_bfe_u32 v16, v0, 7, 1
    v_lshl_add_u32 v23, v16, 12, v23
    v_bfe_u32 v16, v0, 1, 1
    v_lshl_add_u32 v23, v16, 8, v23
    v_bfe_u32 v16, v0, 1, 1
    v_lshl_add_u32 v23, v16, 6, v23
    v_bfe_u32 v16, v0, 4, 1
    v_lshl_add_u32 v23, v16, 7, v23
    v_bfe_u32 v16, v0, 2, 2
    v_lshl_add_u32 v23, v16, 4, v23
    v_bfe_u32 v16, v0, 0, 1
    v_lshl_add_u32 v23, v16, 3, v23
    v_add_u32 v14, s49, v23
    v_xor_b32 v15, 64, v14
    ds_read_b64_tr_b16 v[72:73], v14 offset:0
    ds_read_b64_tr_b16 v[74:75], v15 offset:0
    ds_read_b128 v[44:47], v12 offset:2048
    ds_read_b128 v[40:43], v12 offset:0
    ds_read_b64_tr_b16 v[76:77], v14 offset:512
    ds_read_b64_tr_b16 v[78:79], v15 offset:512
    ds_read_b128 v[52:55], v12 offset:6144
    ds_read_b128 v[48:51], v12 offset:4096
    ds_read_b128 v[60:63], v12 offset:10240
    ds_read_b128 v[56:59], v12 offset:8192
    ds_read_b128 v[68:71], v12 offset:14336
    ds_read_b128 v[64:67], v12 offset:12288
    s_branch t_g2_as
t_g2:
    s_mov_b32 s43, 0
    v_bfe_u32 v16, v0, 5, 1
    v_lshlrev_b32 v23, 13, v16
    v_bfe_u32 v16, v0, 7, 1
    v_lshl_add_u32 v23, v16, 12, v23
    v_bfe_u32 v16, v0, 1, 1
    v_lshl_add_u32 v23, v16, 8, v23
    v_bfe_u32 v16, v0, 1, 1
    v_lshl_add_u32 v23, v16, 6, v23
    v_bfe_u32 v16, v0, 4, 1
    v_lshl_add_u32 v23, v16, 7, v23
    v_bfe_u32 v16, v0, 2, 2
    v_lshl_add_u32 v23, v16, 4, v23
    v_bfe_u32 v16, v0, 0, 1
    v_lshl_add_u32 v23, v16, 3, v23
    v_add_u32 v14, s49, v23
    v_xor_b32 v15, 64, v14
    ds_read_b64_tr_b16 v[72:73], v14 offset:0
    ds_read_b64_tr_b16 v[74:75], v15 offset:0
    ds_read_b128 v[44:47], v12 offset:2048
    ds_read_b128 v[40:43], v12 offset:0
    ds_read_b64_tr_b16 v[76:77], v14 offset:512
    ds_read_b64_tr_b16 v[78:79], v15 offset:512
    ds_read_b128 v[52:55], v12 offset:6144
    ds_read_b128 v[48:51], v12 offset:4096
    ds_read_b128 v[60:63], v12 offset:10240
    ds_read_b128 v[56:59], v12 offset:8192
    ds_read_b128 v[68:71], v12 offset:14336
    ds_read_b128 v[64:67], v12 offset:12288
    s_waitcnt lgkmcnt(8)
    v_mfma_f32_16x16x32_bf16 a[0:3], v[40:43], v[72:75], 0
    s_xor_b32 m0, s44, 0
    v_mfma_f32_16x16x32_bf16 a[32:35], v[44:47], v[72:75], 0
    buffer_load_dwordx4 v4, s[8:11], s20 offen nt lds
    s_waitcnt lgkmcnt(6)
    v_mfma_f32_16x16x32_bf16 a[36:39], v[44:47], v[76:79], 0
    ds_read_b64_tr_b16 v[80:81], v14 offset:1024
    s_xor_b32 m0, s44, 1024
    v_mfma_f32_16x16x32_bf16 a[4:7], v[40:43], v[76:79], 0
    buffer_load_dwordx4 v5, s[8:11], s20 offen nt lds
    s_waitcnt lgkmcnt(5)
    v_mfma_f32_16x16x32_bf16 a[64:67], v[48:51], v[72:75], 0
    ds_read_b64_tr_b16 v[82:83], v15 offset:1024
    s_add_u32 s20, s20, 128
    v_mfma_f32_16x16x32_bf16 a[96:99], v[52:55], v[72:75], 0
    s_xor_b32 m0, s45, 0
    v_mfma_f32_16x16x32_bf16 a[100:103], v[52:55], v[76:79], 0
    ds_read_b64_tr_b16 v[84:85], v14 offset:1536
    buffer_load_dwordx4 v6, s[12:15], s24 offen lds
    v_mfma_f32_16x16x32_bf16 a[68:71], v[48:51], v[76:79], 0
    s_xor_b32 m0, s45, 1024
    s_waitcnt lgkmcnt(5)
    v_mfma_f32_16x16x32_bf16 a[128:131], v[56:59], v[72:75], 0
    ds_read_b64_tr_b16 v[86:87], v15 offset:1536
    buffer_load_dwordx4 v7, s[12:15], s24 offen lds
    v_mfma_f32_16x16x32_bf16 a[160:163], v[60:63], v[72:75], 0
    s_add_u32 s24, s24, s28
    s_bitcmp1_b32 s43, 0
    v_mfma_f32_16x16x32_bf16 a[164:167], v[60:63], v[76:79], 0
    s_cselect_b32 s61, s5, 0
    s_lshl1_add_u32 s53, s61, s50
    v_mfma_f32_16x16x32_bf16 a[132:135], v[56:59], v[76:79], 0
    s_bitcmp1_b32 s43, 1
    s_waitcnt lgkmcnt(4)
    v_mfma_f32_16x16x32_bf16 a[192:195], v[64:67], v[72:75], 0
    s_cselect_b32 s61, s51, 0
    s_add_u32 s53, s53, s61
    v_mfma_f32_16x16x32_bf16 a[224:227], v[68:71], v[72:75], 0
    s_bitcmp1_b32 s43, 2
    s_cselect_b32 s61, s52, 0
    v_mfma_f32_16x16x32_bf16 a[228:231], v[68:71], v[76:79], 0
    s_add_u32 s53, s53, s61
    s_lshl_b32 s29, s43, 4
    v_mfma_f32_16x16x32_bf16 a[196:199], v[64:67], v[76:79], 0
    s_waitcnt lgkmcnt(2)
    v_mfma_f32_16x16x32_bf16 a[8:11], v[40:43], v[80:83], 0
    s_set_gpr_idx_on s29, gpr_idx(SRC0)
    v_mov_b32 v24, v128
    v_mov_b32 v25, v129
    v_mov_b32 v26, v130
    v_mov_b32 v27, v131
    s_set_gpr_idx_off
    v_mfma_f32_16x16x32_bf16 a[40:43], v[44:47], v[80:83], 0
    s_waitcnt lgkmcnt(0)
    v_mfma_f32_16x16x32_bf16 a[44:47], v[44:47], v[84:87], 0
    ds_read_b64_tr_b16 v[72:73], v14 offset:2048
    s_set_gpr_idx_on s29, gpr_idx(SRC0)
    v_mov_b32 v28, v132
    v_mov_b32 v29, v133
    v_mov_b32 v30, v134
    v_mov_b32 v31, v135
    s_set_gpr_idx_off
    v_mfma_f32_16x16x32_bf16 a[12:15], v[40:43], v[84:87], 0
    v_mfma_f32_16x16x32_bf16 a[72:75], v[48:51], v[80:83], 0
    ds_read_b64_tr_b16 v[74:75], v15 offset:2048
    s_set_gpr_idx_on s29, gpr_idx(SRC0)
    v_mov_b32 v32, v136
    v_mov_b32 v33, v137
    v_mov_b32 v34, v138
    v_mov_b32 v35, v139
    s_set_gpr_idx_off
    v_mfma_f32_16x16x32_bf16 a[104:107], v[52:55], v[80:83], 0
    v_mfma_f32_16x16x32_bf16 a[108:111], v[52:55], v[84:87], 0
    ds_read_b64_tr_b16 v[76:77], v14 offset:2560
    s_set_gpr_idx_on s29, gpr_idx(SRC0)
    v_mov_b32 v36, v140
    v_mov_b32 v37, v141
    v_mov_b32 v38, v142
    v_mov_b32 v39, v143
    s_set_gpr_idx_off
    v_mfma_f32_16x16x32_bf16 a[76:79], v[48:51], v[84:87], 0
    v_mfma_f32_16x16x32_bf16 a[136:139], v[56:59], v[80:83], 0
    ds_read_b64_tr_b16 v[78:79], v15 offset:2560
    buffer_store_dwordx4 v[24:27], v2, s[16:19], s53 offen sc1
    v_mfma_f32_16x16x32_bf16 a[168:171], v[60:63], v[80:83], 0
    v_mfma_f32_16x16x32_bf16 a[172:175], v[60:63], v[84:87], 0
    buffer_store_dwordx4 v[28:31], v3, s[16:19], s53 offen sc1
    v_mfma_f32_16x16x32_bf16 a[140:143], v[56:59], v[84:87], 0
    s_add_u32 s53, s53, s5
    v_mfma_f32_16x16x32_bf16 a[200:203], v[64:67], v[80:83], 0
    buffer_store_dwordx4 v[32:35], v2, s[16:19], s53 offen sc1
    v_mfma_f32_16x16x32_bf16 a[232:235], v[68:71], v[80:83], 0
    v_mfma_f32_16x16x32_bf16 a[236:239], v[68:71], v[84:87], 0
    buffer_store_dwordx4 v[36:39], v3, s[16:19], s53 offen sc1
    v_mfma_f32_16x16x32_bf16 a[204:207], v[64:67], v[84:87], 0
    s_waitcnt lgkmcnt(2)
    v_mfma_f32_16x16x32_bf16 a[16:19], v[40:43], v[72:75], 0
    v_mfma_f32_16x16x32_bf16 a[48:51], v[44:47], v[72:75], 0
    s_waitcnt lgkmcnt(0)
    v_mfma_f32_16x16x32_bf16 a[52:55], v[44:47], v[76:79], 0
    ds_read_b64_tr_b16 v[80:81], v14 offset:3072
    v_mfma_f32_16x16x32_bf16 a[20:23], v[40:43], v[76:79], 0
    v_mfma_f32_16x16x32_bf16 a[80:83], v[48:51], v[72:75], 0
    ds_read_b64_tr_b16 v[82:83], v15 offset:3072
    v_mfma_f32_16x16x32_bf16 a[112:115], v[52:55], v[72:75], 0
    v_mfma_f32_16x16x32_bf16 a[116:119], v[52:55], v[76:79], 0
    ds_read_b64_tr_b16 v[84:85], v14 offset:3584
    v_mfma_f32_16x16x32_bf16 a[84:87], v[48:51], v[76:79], 0
    v_mfma_f32_16x16x32_bf16 a[144:147], v[56:59], v[72:75], 0
    ds_read_b64_tr_b16 v[86:87], v15 offset:3584
    v_mfma_f32_16x16x32_bf16 a[176:179], v[60:63], v[72:75], 0
    v_mfma_f32_16x16x32_bf16 a[180:183], v[60:63], v[76:79], 0
    v_mfma_f32_16x16x32_bf16 a[148:151], v[56:59], v[76:79], 0
    v_mfma_f32_16x16x32_bf16 a[208:211], v[64:67], v[72:75], 0
    v_mfma_f32_16x16x32_bf16 a[240:243], v[68:71], v[72:75], 0
    v_mfma_f32_16x16x32_bf16 a[244:247], v[68:71], v[76:79], 0
    v_mfma_f32_16x16x32_bf16 a[212:215], v[64:67], v[76:79], 0
    s_waitcnt lgkmcnt(2)
    v_mfma_f32_16x16x32_bf16 a[24:27], v[40:43], v[80:83], 0
    ds_read_b64_tr_b16 v[72:73], v14 offset:16384
    v_mfma_f32_16x16x32_bf16 a[56:59], v[44:47], v[80:83], 0
    ds_read_b64_tr_b16 v[74:75], v15 offset:16384
    s_waitcnt lgkmcnt(2)
    v_mfma_f32_16x16x32_bf16 a[60:63], v[44:47], v[84:87], 0
    ds_read_b128 v[44:47], v13 offset:2048
    v_mfma_f32_16x16x32_bf16 a[28:31], v[40:43], v[84:87], 0
    ds_read_b128 v[40:43], v13 offset:0
    v_mfma_f32_16x16x32_bf16 a[88:91], v[48:51], v[80:83], 0
    ds_read_b64_tr_b16 v[76:77], v14 offset:16896
    v_mfma_f32_16x16x32_bf16 a[120:123], v[52:55], v[80:83], 0
    ds_read_b64_tr_b16 v[78:79], v15 offset:16896
    v_mfma_f32_16x16x32_bf16 a[124:127], v[52:55], v[84:87], 0
    ds_read_b128 v[52:55], v13 offset:6144
    v_mfma_f32_16x16x32_bf16 a[92:95], v[48:51], v[84:87], 0
    ds_read_b128 v[48:51], v13 offset:4096
    v_mfma_f32_16x16x32_bf16 a[152:155], v[56:59], v[80:83], 0
    s_xor_b32 m0, s44, 2048
    v_mfma_f32_16x16x32_bf16 a[184:187], v[60:63], v[80:83], 0
    buffer_load_dwordx4 v4, s[8:11], s21 offen nt lds
    v_mfma_f32_16x16x32_bf16 a[188:191], v[60:63], v[84:87], 0
    ds_read_b128 v[60:63], v13 offset:10240
    v_mfma_f32_16x16x32_bf16 a[156:159], v[56:59], v[84:87], 0
    ds_read_b128 v[56:59], v13 offset:8192
    v_mfma_f32_16x16x32_bf16 a[216:219], v[64:67], v[80:83], 0
    s_xor_b32 m0, s44, 3072
    v_mfma_f32_16x16x32_bf16 a[248:251], v[68:71], v[80:83], 0
    buffer_load_dwordx4 v5, s[8:11], s21 offen nt lds
    v_mfma_f32_16x16x32_bf16 a[252:255], v[68:71], v[84:87], 0
    ds_read_b128 v[68:71], v13 offset:14336
    s_add_u32 s21, s21, 128
    v_mfma_f32_16x16x32_bf16 a[220:223], v[64:67], v[84:87], 0
    ds_read_b128 v[64:67], v13 offset:12288
    s_branch t_g2_b
t_g2_hook:
    s_cmp_eq_u32 s43, 1
    s_cbranch_scc1 t_g2_sig0
    s_cmp_eq_u32 s43, 6
    s_cbranch_scc1 t_g2_sws
    s_cmp_eq_u32 s43, 7
    s_cbranch_scc1 t_g2_swp
    s_cmp_lg_u32 s58, 0
    s_cbranch_scc1 t_g2_a
t_g2_wait:
    s_cmp_eq_u32 s3, 0
    s_cbranch_scc1 t_g2_a
    s_mov_b32 s62, 0
L_sw_70:
    s_load_dword s63, s[98:99], s3 glc
    s_add_u32 s62, s62, 1
    s_cmp_gt_u32 s62, 0x200000
    s_cbranch_scc1 chain_kernel_wabort
    s_waitcnt lgkmcnt(0)
    s_cmp_ge_u32 s63, s2
    s_cbranch_scc1 L_swok_71
    s_sleep 16
    s_branch L_sw_70
L_swok_71:
    s_branch t_g2_a
t_g2_sig0:
    s_cmp_eq_u32 s1, 0
    s_cbranch_scc1 t_g2_as
    v_mov_b32 v24, s1
    v_mov_b32 v25, 1
    s_mov_b64 exec, 1
    global_atomic_add v24, v25, s[98:99] sc1
    s_mov_b64 exec, -1
    s_mov_b32 s1, 0
    s_branch t_g2_as
t_g2_sws:
    s_mov_b32 s12, s36
    s_mov_b32 s13, s37
    s_mov_b32 s14, s38
    s_and_b32 s45, s45, 0xffffb7ff
    s_bitcmp1_b32 s94, 1
    s_cselect_b32 s24, s41, 0
    s_cselect_b32 s26, 0, s41
    s_cselect_b32 s60, 0x4000, 0
    s_or_b32 s45, s45, s60
    s_add_u32 s24, s24, s39
    s_add_u32 s26, s26, s39
    s_bitcmp1_b32 s94, 0
    s_cselect_b32 s61, s40, 0
    s_cselect_b32 s62, 0, s40
    s_cselect_b32 s60, 0x800, 0
    s_or_b32 s45, s45, s60
    s_add_u32 s25, s24, s62
    s_add_u32 s24, s24, s61
    s_add_u32 s27, s26, s62
    s_add_u32 s26, s26, s61
    s_mov_b32 s28, s42
    v_mov_b32 v6, v10
    v_mov_b32 v7, v11
    s_branch t_g2_a
t_g2_swp:
    s_mov_b32 s8, s30
    s_mov_b32 s9, s31
    s_mov_b32 s10, s32
    s_and_b32 s44, s44, 0xffffb7ff
    s_bitcmp1_b32 s84, 1
    s_cselect_b32 s20, s35, 0
    s_cselect_b32 s22, 0, s35
    s_cselect_b32 s60, 0x4000, 0
    s_or_b32 s44, s44, s60
    s_add_u32 s20, s20, s33
    s_add_u32 s22, s22, s33
    s_bitcmp1_b32 s84, 0
    s_cselect_b32 s61, s34, 0
    s_cselect_b32 s62, 0, s34
    s_cselect_b32 s60, 0x800, 0
    s_or_b32 s44, s44, s60
    s_add_u32 s21, s20, s62
    s_add_u32 s20, s20, s61
    s_add_u32 s23, s22, s62
    s_add_u32 s22, s22, s61
    v_mov_b32 v4, v8
    v_mov_b32 v5, v9
t_g2_a:
t_g2_as:
    s_waitcnt lgkmcnt(8)
    v_mfma_f32_16x16x32_bf16 a[0:3], v[40:43], v[72:75], a[0:3]
    s_xor_b32 m0, s44, 0
    v_mfma_f32_16x16x32_bf16 a[32:35], v[44:47], v[72:75], a[32:35]
    buffer_load_dwordx4 v4, s[8:11], s20 offen nt lds
    s_waitcnt lgkmcnt(6)
    v_mfma_f32_16x16x32_bf16 a[36:39], v[44:47], v[76:79], a[36:39]
    ds_read_b64_tr_b16 v[80:81], v14 offset:1024
    s_xor_b32 m0, s44, 1024
    v_mfma_f32_16x16x32_bf16 a[4:7], v[40:43], v[76:79], a[4:7]
    buffer_load_dwordx4 v5, s[8:11], s20 offen nt lds
    s_waitcnt lgkmcnt(5)
    v_mfma_f32_16x16x32_bf16 a[64:67], v[48:51], v[72:75], a[64:67]
    ds_read_b64_tr_b16 v[82:83], v15 offset:1024
    s_add_u32 s20, s20, 128
    v_mfma_f32_16x16x32_bf16 a[96:99], v[52:55], v[72:75], a[96:99]
    s_xor_b32 m0, s45, 0
    v_mfma_f32_16x16x32_bf16 a[100:103], v[52:55], v[76:79], a[100:103]
    ds_read_b64_tr_b16 v[84:85], v14 offset:1536
    buffer_load_dwordx4 v6, s[12:15], s24 offen lds
    v_mfma_f32_16x16x32_bf16 a[68:71], v[48:51], v[76:79], a[68:71]
    s_xor_b32 m0, s45, 1024
    s_waitcnt lgkmcnt(5)
    v_mfma_f32_16x16x32_bf16 a[128:131], v[56:59], v[72:75], a[128:131]
    ds_read_b64_tr_b16 v[86:87], v15 offset:1536
    buffer_load_dwordx4 v7, s[12:15], s24 offen lds
    v_mfma_f32_16x16x32_bf16 a[160:163], v[60:63], v[72:75], a[160:163]
    s_add_u32 s24, s24, s28
    s_bitcmp1_b32 s43, 0
    v_mfma_f32_16x16x32_bf16 a[164:167], v[60:63], v[76:79], a[164:167]
    s_cselect_b32 s61, s5, 0
    s_lshl1_add_u32 s53, s61, s50
    v_mfma_f32_16x16x32_bf16 a[132:135], v[56:59], v[76:79], a[132:135]
    s_bitcmp1_b32 s43, 1
    s_waitcnt lgkmcnt(4)
    v_mfma_f32_16x16x32_bf16 a[192:195], v[64:67], v[72:75], a[192:195]
    s_cselect_b32 s61, s51, 0
    s_add_u32 s53, s53, s61
    v_mfma_f32_16x16x32_bf16 a[224:227], v[68:71], v[72:75], a[224:227]
    s_bitcmp1_b32 s43, 2
    s_cselect_b32 s61, s52, 0
    v_mfma_f32_16x16x32_bf16 a[228:231], v[68:71], v[76:79], a[228:231]
    s_add_u32 s53, s53, s61
    s_lshl_b32 s29, s43, 4
    v_mfma_f32_16x16x32_bf16 a[196:199], v[64:67], v[76:79], a[196:199]
    s_waitcnt lgkmcnt(2)
    v_mfma_f32_16x16x32_bf16 a[8:11], v[40:43], v[80:83], a[8:11]
    s_set_gpr_idx_on s29, gpr_idx(SRC0)
    v_mov_b32 v24, v128
    v_mov_b32 v25, v129
    v_mov_b32 v26, v130
    v_mov_b32 v27, v131
    s_set_gpr_idx_off
    v_mfma_f32_16x16x32_bf16 a[40:43], v[44:47], v[80:83], a[40:43]
    s_waitcnt lgkmcnt(0)
    v_mfma_f32_16x16x32_bf16 a[44:47], v[44:47], v[84:87], a[44:47]
    ds_read_b64_tr_b16 v[72:73], v14 offset:2048
    s_set_gpr_idx_on s29, gpr_idx(SRC0)
    v_mov_b32 v28, v132
    v_mov_b32 v29, v133
    v_mov_b32 v30, v134
    v_mov_b32 v31, v135
    s_set_gpr_idx_off
    v_mfma_f32_16x16x32_bf16 a[12:15], v[40:43], v[84:87], a[12:15]
    v_mfma_f32_16x16x32_bf16 a[72:75], v[48:51], v[80:83], a[72:75]
    ds_read_b64_tr_b16 v[74:75], v15 offset:2048
    s_set_gpr_idx_on s29, gpr_idx(SRC0)
    v_mov_b32 v32, v136
    v_mov_b32 v33, v137
    v_mov_b32 v34, v138
    v_mov_b32 v35, v139
    s_set_gpr_idx_off
    v_mfma_f32_16x16x32_bf16 a[104:107], v[52:55], v[80:83], a[104:107]
    v_mfma_f32_16x16x32_bf16 a[108:111], v[52:55], v[84:87], a[108:111]
    ds_read_b64_tr_b16 v[76:77], v14 offset:2560
    s_set_gpr_idx_on s29, gpr_idx(SRC0)
    v_mov_b32 v36, v140
    v_mov_b32 v37, v141
    v_mov_b32 v38, v142
    v_mov_b32 v39, v143
    s_set_gpr_idx_off
    v_mfma_f32_16x16x32_bf16 a[76:79], v[48:51], v[84:87], a[76:79]
    v_mfma_f32_16x16x32_bf16 a[136:139], v[56:59], v[80:83], a[136:139]
    ds_read_b64_tr_b16 v[78:79], v15 offset:2560
    buffer_store_dwordx4 v[24:27], v2, s[16:19], s53 offen sc1
    v_mfma_f32_16x16x32_bf16 a[168:171], v[60:63], v[80:83], a[168:171]
    v_mfma_f32_16x16x32_bf16 a[172:175], v[60:63], v[84:87], a[172:175]
    buffer_store_dwordx4 v[28:31], v3, s[16:19], s53 offen sc1
    v_mfma_f32_16x16x32_bf16 a[140:143], v[56:59], v[84:87], a[140:143]
    s_add_u32 s53, s53, s5
    v_mfma_f32_16x16x32_bf16 a[200:203], v[64:67], v[80:83], a[200:203]
    buffer_store_dwordx4 v[32:35], v2, s[16:19], s53 offen sc1
    v_mfma_f32_16x16x32_bf16 a[232:235], v[68:71], v[80:83], a[232:235]
    v_mfma_f32_16x16x32_bf16 a[236:239], v[68:71], v[84:87], a[236:239]
    buffer_store_dwordx4 v[36:39], v3, s[16:19], s53 offen sc1
    v_mfma_f32_16x16x32_bf16 a[204:207], v[64:67], v[84:87], a[204:207]
    s_waitcnt lgkmcnt(2)
    v_mfma_f32_16x16x32_bf16 a[16:19], v[40:43], v[72:75], a[16:19]
    v_mfma_f32_16x16x32_bf16 a[48:51], v[44:47], v[72:75], a[48:51]
    s_waitcnt lgkmcnt(0)
    v_mfma_f32_16x16x32_bf16 a[52:55], v[44:47], v[76:79], a[52:55]
    ds_read_b64_tr_b16 v[80:81], v14 offset:3072
    v_mfma_f32_16x16x32_bf16 a[20:23], v[40:43], v[76:79], a[20:23]
    v_mfma_f32_16x16x32_bf16 a[80:83], v[48:51], v[72:75], a[80:83]
    ds_read_b64_tr_b16 v[82:83], v15 offset:3072
    v_mfma_f32_16x16x32_bf16 a[112:115], v[52:55], v[72:75], a[112:115]
    v_mfma_f32_16x16x32_bf16 a[116:119], v[52:55], v[76:79], a[116:119]
    ds_read_b64_tr_b16 v[84:85], v14 offset:3584
    v_mfma_f32_16x16x32_bf16 a[84:87], v[48:51], v[76:79], a[84:87]
    v_mfma_f32_16x16x32_bf16 a[144:147], v[56:59], v[72:75], a[144:147]
    ds_read_b64_tr_b16 v[86:87], v15 offset:3584
    v_mfma_f32_16x16x32_bf16 a[176:179], v[60:63], v[72:75], a[176:179]
    v_mfma_f32_16x16x32_bf16 a[180:183], v[60:63], v[76:79], a[180:183]
    v_mfma_f32_16x16x32_bf16 a[148:151], v[56:59], v[76:79], a[148:151]
    v_mfma_f32_16x16x32_bf16 a[208:211], v[64:67], v[72:75], a[208:211]
    v_mfma_f32_16x16x32_bf16 a[240:243], v[68:71], v[72:75], a[240:243]
    v_mfma_f32_16x16x32_bf16 a[244:247], v[68:71], v[76:79], a[244:247]
    v_mfma_f32_16x16x32_bf16 a[212:215], v[64:67], v[76:79], a[212:215]
    s_waitcnt lgkmcnt(2)
    v_mfma_f32_16x16x32_bf16 a[24:27], v[40:43], v[80:83], a[24:27]
    ds_read_b64_tr_b16 v[72:73], v14 offset:16384
    v_mfma_f32_16x16x32_bf16 a[56:59], v[44:47], v[80:83], a[56:59]
    ds_read_b64_tr_b16 v[74:75], v15 offset:16384
    s_waitcnt lgkmcnt(2)
    v_mfma_f32_16x16x32_bf16 a[60:63], v[44:47], v[84:87], a[60:63]
    ds_read_b128 v[44:47], v13 offset:2048
    v_mfma_f32_16x16x32_bf16 a[28:31], v[40:43], v[84:87], a[28:31]
    ds_read_b128 v[40:43], v13 offset:0
    v_mfma_f32_16x16x32_bf16 a[88:91], v[48:51], v[80:83], a[88:91]
    ds_read_b64_tr_b16 v[76:77], v14 offset:16896
    v_mfma_f32_16x16x32_bf16 a[120:123], v[52:55], v[80:83], a[120:123]
    ds_read_b64_tr_b16 v[78:79], v15 offset:16896
    v_mfma_f32_16x16x32_bf16 a[124:127], v[52:55], v[84:87], a[124:127]
    ds_read_b128 v[52:55], v13 offset:6144
    v_mfma_f32_16x16x32_bf16 a[92:95], v[48:51], v[84:87], a[92:95]
    ds_read_b128 v[48:51], v13 offset:4096
    v_mfma_f32_16x16x32_bf16 a[152:155], v[56:59], v[80:83], a[152:155]
    s_xor_b32 m0, s44, 2048
    v_mfma_f32_16x16x32_bf16 a[184:187], v[60:63], v[80:83], a[184:187]
    buffer_load_dwordx4 v4, s[8:11], s21 offen nt lds
    v_mfma_f32_16x16x32_bf16 a[188:191], v[60:63], v[84:87], a[188:191]
    ds_read_b128 v[60:63], v13 offset:10240
    v_mfma_f32_16x16x32_bf16 a[156:159], v[56:59], v[84:87], a[156:159]
    ds_read_b128 v[56:59], v13 offset:8192
    v_mfma_f32_16x16x32_bf16 a[216:219], v[64:67], v[80:83], a[216:219]
    s_xor_b32 m0, s44, 3072
    v_mfma_f32_16x16x32_bf16 a[248:251], v[68:71], v[80:83], a[248:251]
    buffer_load_dwordx4 v5, s[8:11], s21 offen nt lds
    v_mfma_f32_16x16x32_bf16 a[252:255], v[68:71], v[84:87], a[252:255]
    ds_read_b128 v[68:71], v13 offset:14336
    s_add_u32 s21, s21, 128
    v_mfma_f32_16x16x32_bf16 a[220:223], v[64:67], v[84:87], a[220:223]
    ds_read_b128 v[64:67], v13 offset:12288
t_g2_b:
    s_waitcnt lgkmcnt(8)
    v_mfma_f32_16x16x32_bf16 a[0:3], v[40:43], v[72:75], a[0:3]
    v_mfma_f32_16x16x32_bf16 a[32:35], v[44:47], v[72:75], a[32:35]
    s_xor_b32 m0, s44, 16384
    s_waitcnt lgkmcnt(6)
    v_mfma_f32_16x16x32_bf16 a[36:39], v[44:47], v[76:79], a[36:39]
    ds_read_b64_tr_b16 v[80:81], v14 offset:17408
    buffer_load_dwordx4 v4, s[8:11], s22 offen nt lds
    v_mfma_f32_16x16x32_bf16 a[4:7], v[40:43], v[76:79], a[4:7]
    s_cmp_ge_u32 s48, 98304
    s_waitcnt lgkmcnt(5)
    v_mfma_f32_16x16x32_bf16 a[64:67], v[48:51], v[72:75], a[64:67]
    ds_read_b64_tr_b16 v[82:83], v15 offset:17408
    s_cselect_b32 s46, s6, s7
    v_mfma_f32_16x16x32_bf16 a[96:99], v[52:55], v[72:75], a[96:99]
    s_add_u32 s48, s48, s46
    s_xor_b32 m0, s44, 17408
    v_mfma_f32_16x16x32_bf16 a[100:103], v[52:55], v[76:79], a[100:103]
    ds_read_b64_tr_b16 v[84:85], v14 offset:17920
    buffer_load_dwordx4 v5, s[8:11], s22 offen nt lds
    v_mfma_f32_16x16x32_bf16 a[68:71], v[48:51], v[76:79], a[68:71]
    s_add_u32 s22, s22, 128
    s_waitcnt lgkmcnt(5)
    v_mfma_f32_16x16x32_bf16 a[128:131], v[56:59], v[72:75], a[128:131]
    ds_read_b64_tr_b16 v[86:87], v15 offset:17920
    s_cmp_ge_u32 s49, 98304
    v_mfma_f32_16x16x32_bf16 a[160:163], v[60:63], v[72:75], a[160:163]
    s_cselect_b32 s47, s6, s7
    s_add_u32 s49, s49, s47
    v_mfma_f32_16x16x32_bf16 a[164:167], v[60:63], v[76:79], a[164:167]
    s_xor_b32 m0, s44, 18432
    v_mfma_f32_16x16x32_bf16 a[132:135], v[56:59], v[76:79], a[132:135]
    buffer_load_dwordx4 v4, s[8:11], s23 offen nt lds
    s_waitcnt lgkmcnt(4)
    v_mfma_f32_16x16x32_bf16 a[192:195], v[64:67], v[72:75], a[192:195]
    v_mfma_f32_16x16x32_bf16 a[224:227], v[68:71], v[72:75], a[224:227]
    s_xor_b32 m0, s44, 19456
    v_mfma_f32_16x16x32_bf16 a[228:231], v[68:71], v[76:79], a[228:231]
    buffer_load_dwordx4 v5, s[8:11], s23 offen nt lds
    v_mfma_f32_16x16x32_bf16 a[196:199], v[64:67], v[76:79], a[196:199]
    s_add_u32 s23, s23, 128
    s_waitcnt lgkmcnt(2)
    v_mfma_f32_16x16x32_bf16 a[8:11], v[40:43], v[80:83], a[8:11]
    s_cmp_ge_u32 s44, 98304
    s_cselect_b32 s60, s6, s7
    v_mfma_f32_16x16x32_bf16 a[40:43], v[44:47], v[80:83], a[40:43]
    s_add_u32 s44, s44, s60
    s_waitcnt lgkmcnt(0)
    v_mfma_f32_16x16x32_bf16 a[44:47], v[44:47], v[84:87], a[44:47]
    ds_read_b64_tr_b16 v[72:73], v14 offset:18432
    v_add_u32 v12, s46, v12
    v_mfma_f32_16x16x32_bf16 a[12:15], v[40:43], v[84:87], a[12:15]
    v_add_u32 v13, s46, v13
    v_mfma_f32_16x16x32_bf16 a[72:75], v[48:51], v[80:83], a[72:75]
    ds_read_b64_tr_b16 v[74:75], v15 offset:18432
    s_xor_b32 m0, s45, 2048
    v_mfma_f32_16x16x32_bf16 a[104:107], v[52:55], v[80:83], a[104:107]
    buffer_load_dwordx4 v6, s[12:15], s25 offen lds
    v_mfma_f32_16x16x32_bf16 a[108:111], v[52:55], v[84:87], a[108:111]
    ds_read_b64_tr_b16 v[76:77], v14 offset:18944
    v_mfma_f32_16x16x32_bf16 a[76:79], v[48:51], v[84:87], a[76:79]
    v_mfma_f32_16x16x32_bf16 a[136:139], v[56:59], v[80:83], a[136:139]
    ds_read_b64_tr_b16 v[78:79], v15 offset:18944
    s_xor_b32 m0, s45, 3072
    v_mfma_f32_16x16x32_bf16 a[168:171], v[60:63], v[80:83], a[168:171]
    buffer_load_dwordx4 v7, s[12:15], s25 offen lds
    v_mfma_f32_16x16x32_bf16 a[172:175], v[60:63], v[84:87], a[172:175]
    s_add_u32 s25, s25, s28
    v_mfma_f32_16x16x32_bf16 a[140:143], v[56:59], v[84:87], a[140:143]
    v_mfma_f32_16x16x32_bf16 a[200:203], v[64:67], v[80:83], a[200:203]
    s_xor_b32 m0, s45, 16384
    v_mfma_f32_16x16x32_bf16 a[232:235], v[68:71], v[80:83], a[232:235]
    buffer_load_dwordx4 v6, s[12:15], s26 offen lds
    v_mfma_f32_16x16x32_bf16 a[236:239], v[68:71], v[84:87], a[236:239]
    v_mfma_f32_16x16x32_bf16 a[204:207], v[64:67], v[84:87], a[204:207]
    s_waitcnt lgkmcnt(2)
    v_mfma_f32_16x16x32_bf16 a[16:19], v[40:43], v[72:75], a[16:19]
    s_xor_b32 m0, s45, 17408
    v_mfma_f32_16x16x32_bf16 a[48:51], v[44:47], v[72:75], a[48:51]
    buffer_load_dwordx4 v7, s[12:15], s26 offen lds
    s_waitcnt lgkmcnt(0)
    v_mfma_f32_16x16x32_bf16 a[52:55], v[44:47], v[76:79], a[52:55]
    ds_read_b64_tr_b16 v[80:81], v14 offset:19456
    s_add_u32 s26, s26, s28
    v_mfma_f32_16x16x32_bf16 a[20:23], v[40:43], v[76:79], a[20:23]
    v_mfma_f32_16x16x32_bf16 a[80:83], v[48:51], v[72:75], a[80:83]
    ds_read_b64_tr_b16 v[82:83], v15 offset:19456
    s_xor_b32 m0, s45, 18432
    v_mfma_f32_16x16x32_bf16 a[112:115], v[52:55], v[72:75], a[112:115]
    buffer_load_dwordx4 v6, s[12:15], s27 offen lds
    v_mfma_f32_16x16x32_bf16 a[116:119], v[52:55], v[76:79], a[116:119]
    ds_read_b64_tr_b16 v[84:85], v14 offset:19968
    v_mfma_f32_16x16x32_bf16 a[84:87], v[48:51], v[76:79], a[84:87]
    s_xor_b32 m0, s45, 19456
    v_mfma_f32_16x16x32_bf16 a[144:147], v[56:59], v[72:75], a[144:147]
    ds_read_b64_tr_b16 v[86:87], v15 offset:19968
    buffer_load_dwordx4 v7, s[12:15], s27 offen lds
    v_mfma_f32_16x16x32_bf16 a[176:179], v[60:63], v[72:75], a[176:179]
    s_add_u32 s27, s27, s28
    s_cmp_ge_u32 s45, 98304
    v_mfma_f32_16x16x32_bf16 a[180:183], v[60:63], v[76:79], a[180:183]
    s_cselect_b32 s60, s6, s7
    s_add_u32 s45, s45, s60
    v_mfma_f32_16x16x32_bf16 a[148:151], v[56:59], v[76:79], a[148:151]
    v_add_u32 v14, s47, v14
    v_add_u32 v15, s47, v15
    v_mfma_f32_16x16x32_bf16 a[208:211], v[64:67], v[72:75], a[208:211]
    s_add_u32 s43, s43, 1
    s_cmp_eq_u32 s43, 8
    v_mfma_f32_16x16x32_bf16 a[240:243], v[68:71], v[72:75], a[240:243]
    v_mfma_f32_16x16x32_bf16 a[244:247], v[68:71], v[76:79], a[244:247]
    v_mfma_f32_16x16x32_bf16 a[212:215], v[64:67], v[76:79], a[212:215]
    s_waitcnt vmcnt(6) lgkmcnt(0)
    s_barrier
    s_cbranch_scc1 t_g2_last
    v_mfma_f32_16x16x32_bf16 a[24:27], v[40:43], v[80:83], a[24:27]
    ds_read_b64_tr_b16 v[72:73], v14 offset:0
    v_mfma_f32_16x16x32_bf16 a[56:59], v[44:47], v[80:83], a[56:59]
    ds_read_b64_tr_b16 v[74:75], v15 offset:0
    v_mfma_f32_16x16x32_bf16 a[60:63], v[44:47], v[84:87], a[60:63]
    ds_read_b128 v[44:47], v12 offset:2048
    v_mfma_f32_16x16x32_bf16 a[28:31], v[40:43], v[84:87], a[28:31]
    ds_read_b128 v[40:43], v12 offset:0
    v_mfma_f32_16x16x32_bf16 a[88:91], v[48:51], v[80:83], a[88:91]
    ds_read_b64_tr_b16 v[76:77], v14 offset:512
    v_mfma_f32_16x16x32_bf16 a[120:123], v[52:55], v[80:83], a[120:123]
    ds_read_b64_tr_b16 v[78:79], v15 offset:512
    v_mfma_f32_16x16x32_bf16 a[124:127], v[52:55], v[84:87], a[124:127]
    ds_read_b128 v[52:55], v12 offset:6144
    v_mfma_f32_16x16x32_bf16 a[92:95], v[48:51], v[84:87], a[92:95]
    ds_read_b128 v[48:51], v12 offset:4096
    v_mfma_f32_16x16x32_bf16 a[152:155], v[56:59], v[80:83], a[152:155]
    v_mfma_f32_16x16x32_bf16 a[184:187], v[60:63], v[80:83], a[184:187]
    v_mfma_f32_16x16x32_bf16 a[188:191], v[60:63], v[84:87], a[188:191]
    ds_read_b128 v[60:63], v12 offset:10240
    v_mfma_f32_16x16x32_bf16 a[156:159], v[56:59], v[84:87], a[156:159]
    ds_read_b128 v[56:59], v12 offset:8192
    v_mfma_f32_16x16x32_bf16 a[216:219], v[64:67], v[80:83], a[216:219]
    s_sub_u32 s61, s43, 2
    s_cmp_lt_u32 s61, 3
    v_mfma_f32_16x16x32_bf16 a[248:251], v[68:71], v[80:83], a[248:251]
    v_mfma_f32_16x16x32_bf16 a[252:255], v[68:71], v[84:87], a[252:255]
    ds_read_b128 v[68:71], v12 offset:14336
    v_mfma_f32_16x16x32_bf16 a[220:223], v[64:67], v[84:87], a[220:223]
    ds_read_b128 v[64:67], v12 offset:12288
    s_cbranch_scc1 t_g2_a
    s_branch t_g2_hook
t_g2_last:
    v_mfma_f32_16x16x32_bf16 a[24:27], v[40:43], v[80:83], a[24:27]
    v_mfma_f32_16x16x32_bf16 a[56:59], v[44:47], v[80:83], a[56:59]
    v_mfma_f32_16x16x32_bf16 a[60:63], v[44:47], v[84:87], a[60:63]
    v_mfma_f32_16x16x32_bf16 a[28:31], v[40:43], v[84:87], a[28:31]
    v_mfma_f32_16x16x32_bf16 a[88:91], v[48:51], v[80:83], a[88:91]
    v_mfma_f32_16x16x32_bf16 a[120:123], v[52:55], v[80:83], a[120:123]
    v_mfma_f32_16x16x32_bf16 a[124:127], v[52:55], v[84:87], a[124:127]
    v_mfma_f32_16x16x32_bf16 a[92:95], v[48:51], v[84:87], a[92:95]
    v_mfma_f32_16x16x32_bf16 a[152:155], v[56:59], v[80:83], a[152:155]
    v_mfma_f32_16x16x32_bf16 a[184:187], v[60:63], v[80:83], a[184:187]
    v_mfma_f32_16x16x32_bf16 a[188:191], v[60:63], v[84:87], a[188:191]
    v_mfma_f32_16x16x32_bf16 a[156:159], v[56:59], v[84:87], a[156:159]
    v_mfma_f32_16x16x32_bf16 a[216:219], v[64:67], v[80:83], a[216:219]
    v_mfma_f32_16x16x32_bf16 a[248:251], v[68:71], v[80:83], a[248:251]
    v_mfma_f32_16x16x32_bf16 a[252:255], v[68:71], v[84:87], a[252:255]
    v_mfma_f32_16x16x32_bf16 a[220:223], v[64:67], v[84:87], a[220:223]
    s_setpc_b64 s[54:55]
t_g1:
    s_mov_b32 s43, 0
    v_add_u32 v14, s49, v23
    v_xor_b32 v15, 64, v14
    ds_read_b128 v[72:75], v14 offset:0
    ds_read_b128 v[76:79], v14 offset:2048
    ds_read_b128 v[44:47], v12 offset:2048
    ds_read_b128 v[40:43], v12 offset:0
    ds_read_b128 v[52:55], v12 offset:6144
    ds_read_b128 v[48:51], v12 offset:4096
    ds_read_b128 v[60:63], v12 offset:10240
    ds_read_b128 v[56:59], v12 offset:8192
    ds_read_b128 v[68:71], v12 offset:14336
    ds_read_b128 v[64:67], v12 offset:12288
    s_waitcnt lgkmcnt(6)
    v_mfma_f32_16x16x32_bf16 a[0:3], v[40:43], v[72:75], 0
    s_xor_b32 m0, s44, 0
    v_mfma_f32_16x16x32_bf16 a[32:35], v[44:47], v[72:75], 0
    buffer_load_dwordx4 v4, s[8:11], s20 offen lds
    v_mfma_f32_16x16x32_bf16 a[36:39], v[44:47], v[76:79], 0
    ds_read_b128 v[80:83], v14 offset:4096
    s_xor_b32 m0, s44, 1024
    v_mfma_f32_16x16x32_bf16 a[4:7], v[40:43], v[76:79], 0
    buffer_load_dwordx4 v5, s[8:11], s20 offen lds
    s_waitcnt lgkmcnt(5)
    v_mfma_f32_16x16x32_bf16 a[64:67], v[48:51], v[72:75], 0
    ds_read_b128 v[84:87], v14 offset:6144
    s_add_u32 s20, s20, 128
    v_mfma_f32_16x16x32_bf16 a[96:99], v[52:55], v[72:75], 0
    s_xor_b32 m0, s45, 0
    v_mfma_f32_16x16x32_bf16 a[100:103], v[52:55], v[76:79], 0
    buffer_load_dwordx4 v6, s[12:15], s24 offen nt lds
    v_mfma_f32_16x16x32_bf16 a[68:71], v[48:51], v[76:79], 0
    s_xor_b32 m0, s45, 1024
    s_waitcnt lgkmcnt(4)
    v_mfma_f32_16x16x32_bf16 a[128:131], v[56:59], v[72:75], 0
    buffer_load_dwordx4 v7, s[12:15], s24 offen nt lds
    v_mfma_f32_16x16x32_bf16 a[160:163], v[60:63], v[72:75], 0
    s_add_u32 s24, s24, s28
    s_bitcmp1_b32 s43, 0
    v_mfma_f32_16x16x32_bf16 a[164:167], v[60:63], v[76:79], 0
    s_cselect_b32 s61, s5, 0
    s_lshl1_add_u32 s53, s61, s50
    v_mfma_f32_16x16x32_bf16 a[132:135], v[56:59], v[76:79], 0
    s_bitcmp1_b32 s43, 1
    s_waitcnt lgkmcnt(2)
    v_mfma_f32_16x16x32_bf16 a[192:195], v[64:67], v[72:75], 0
    s_cselect_b32 s61, s51, 0
    s_add_u32 s53, s53, s61
    v_mfma_f32_16x16x32_bf16 a[224:227], v[68:71], v[72:75], 0
    s_bitcmp1_b32 s43, 2
    s_cselect_b32 s61, s52, 0
    v_mfma_f32_16x16x32_bf16 a[228:231], v[68:71], v[76:79], 0
    s_add_u32 s53, s53, s61
    s_lshl_b32 s29, s43, 4
    v_mfma_f32_16x16x32_bf16 a[196:199], v[64:67], v[76:79], 0
    s_waitcnt lgkmcnt(1)
    v_mfma_f32_16x16x32_bf16 a[8:11], v[40:43], v[80:83], 0
    s_set_gpr_idx_on s29, gpr_idx(SRC0)
    v_mov_b32 v24, v128
    v_mov_b32 v25, v129
    v_mov_b32 v26, v130
    v_mov_b32 v27, v131
    s_set_gpr_idx_off
    v_mfma_f32_16x16x32_bf16 a[40:43], v[44:47], v[80:83], 0
    s_waitcnt lgkmcnt(0)
    v_mfma_f32_16x16x32_bf16 a[44:47], v[44:47], v[84:87], 0
    ds_read_b128 v[72:75], v14 offset:8192
    s_set_gpr_idx_on s29, gpr_idx(SRC0)
    v_mov_b32 v28, v132
    v_mov_b32 v29, v133
    v_mov_b32 v30, v134
    v_mov_b32 v31, v135
    s_set_gpr_idx_off
    v_mfma_f32_16x16x32_bf16 a[12:15], v[40:43], v[84:87], 0
    v_mfma_f32_16x16x32_bf16 a[72:75], v[48:51], v[80:83], 0
    ds_read_b128 v[76:79], v14 offset:10240
    s_set_gpr_idx_on s29, gpr_idx(SRC0)
    v_mov_b32 v32, v136
    v_mov_b32 v33, v137
    v_mov_b32 v34, v138
    v_mov_b32 v35, v139
    s_set_gpr_idx_off
    v_mfma_f32_16x16x32_bf16 a[104:107], v[52:55], v[80:83], 0
    v_mfma_f32_16x16x32_bf16 a[108:111], v[52:55], v[84:87], 0
    s_set_gpr_idx_on s29, gpr_idx(SRC0)
    v_mov_b32 v36, v140
    v_mov_b32 v37, v141
    v_mov_b32 v38, v142
    v_mov_b32 v39, v143
    s_set_gpr_idx_off
    v_mfma_f32_16x16x32_bf16 a[76:79], v[48:51], v[84:87], 0
    v_mfma_f32_16x16x32_bf16 a[136:139], v[56:59], v[80:83], 0
    buffer_store_dwordx4 v[24:27], v2, s[16:19], s53 offen sc1
    v_mfma_f32_16x16x32_bf16 a[168:171], v[60:63], v[80:83], 0
    v_mfma_f32_16x16x32_bf16 a[172:175], v[60:63], v[84:87], 0
    buffer_store_dwordx4 v[28:31], v3, s[16:19], s53 offen sc1
    v_mfma_f32_16x16x32_bf16 a[140:143], v[56:59], v[84:87], 0
    s_add_u32 s53, s53, s5
    v_mfma_f32_16x16x32_bf16 a[200:203], v[64:67], v[80:83], 0
    buffer_store_dwordx4 v[32:35], v2, s[16:19], s53 offen sc1
    v_mfma_f32_16x16x32_bf16 a[232:235], v[68:71], v[80:83], 0
    v_mfma_f32_16x16x32_bf16 a[236:239], v[68:71], v[84:87], 0
    buffer_store_dwordx4 v[36:39], v3, s[16:19], s53 offen sc1
    v_mfma_f32_16x16x32_bf16 a[204:207], v[64:67], v[84:87], 0
    s_waitcnt lgkmcnt(1)
    v_mfma_f32_16x16x32_bf16 a[16:19], v[40:43], v[72:75], 0
    v_mfma_f32_16x16x32_bf16 a[48:51], v[44:47], v[72:75], 0
    s_waitcnt lgkmcnt(0)
    v_mfma_f32_16x16x32_bf16 a[52:55], v[44:47], v[76:79], 0
    ds_read_b128 v[80:83], v14 offset:12288
    v_mfma_f32_16x16x32_bf16 a[20:23], v[40:43], v[76:79], 0
    v_mfma_f32_16x16x32_bf16 a[80:83], v[48:51], v[72:75], 0
    ds_read_b128 v[84:87], v14 offset:14336
    v_mfma_f32_16x16x32_bf16 a[112:115], v[52:55], v[72:75], 0
    v_mfma_f32_16x16x32_bf16 a[116:119], v[52:55], v[76:79], 0
    v_mfma_f32_16x16x32_bf16 a[84:87], v[48:51], v[76:79], 0
    v_mfma_f32_16x16x32_bf16 a[144:147], v[56:59], v[72:75], 0
    v_mfma_f32_16x16x32_bf16 a[176:179], v[60:63], v[72:75], 0
    v_mfma_f32_16x16x32_bf16 a[180:183], v[60:63], v[76:79], 0
    v_mfma_f32_16x16x32_bf16 a[148:151], v[56:59], v[76:79], 0
    v_mfma_f32_16x16x32_bf16 a[208:211], v[64:67], v[72:75], 0
    v_mfma_f32_16x16x32_bf16 a[240:243], v[68:71], v[72:75], 0
    v_mfma_f32_16x16x32_bf16 a[244:247], v[68:71], v[76:79], 0
    v_mfma_f32_16x16x32_bf16 a[212:215], v[64:67], v[76:79], 0
    s_waitcnt lgkmcnt(1)
    v_mfma_f32_16x16x32_bf16 a[24:27], v[40:43], v[80:83], 0
    ds_read_b128 v[72:75], v15 offset:0
    v_mfma_f32_16x16x32_bf16 a[56:59], v[44:47], v[80:83], 0
    ds_read_b128 v[76:79], v15 offset:2048
    s_waitcnt lgkmcnt(2)
    v_mfma_f32_16x16x32_bf16 a[60:63], v[44:47], v[84:87], 0
    ds_read_b128 v[44:47], v13 offset:2048
    v_mfma_f32_16x16x32_bf16 a[28:31], v[40:43], v[84:87], 0
    ds_read_b128 v[40:43], v13 offset:0
    v_mfma_f32_16x16x32_bf16 a[88:91], v[48:51], v[80:83], 0
    v_mfma_f32_16x16x32_bf16 a[120:123], v[52:55], v[80:83], 0
    v_mfma_f32_16x16x32_bf16 a[124:127], v[52:55], v[84:87], 0
    ds_read_b128 v[52:55], v13 offset:6144
    v_mfma_f32_16x16x32_bf16 a[92:95], v[48:51], v[84:87], 0
    ds_read_b128 v[48:51], v13 offset:4096
    v_mfma_f32_16x16x32_bf16 a[152:155], v[56:59], v[80:83], 0
    s_xor_b32 m0, s44, 2048
    v_mfma_f32_16x16x32_bf16 a[184:187], v[60:63], v[80:83], 0
    buffer_load_dwordx4 v4, s[8:11], s21 offen lds
    v_mfma_f32_16x16x32_bf16 a[188:191], v[60:63], v[84:87], 0
    ds_read_b128 v[60:63], v13 offset:10240
    v_mfma_f32_16x16x32_bf16 a[156:159], v[56:59], v[84:87], 0
    ds_read_b128 v[56:59], v13 offset:8192
    v_mfma_f32_16x16x32_bf16 a[216:219], v[64:67], v[80:83], 0
    s_xor_b32 m0, s44, 3072
    v_mfma_f32_16x16x32_bf16 a[248:251], v[68:71], v[80:83], 0
    buffer_load_dwordx4 v5, s[8:11], s21 offen lds
    v_mfma_f32_16x16x32_bf16 a[252:255], v[68:71], v[84:87], 0
    ds_read_b128 v[68:71], v13 offset:14336
    s_add_u32 s21, s21, 128
    v_mfma_f32_16x16x32_bf16 a[220:223], v[64:67], v[84:87], 0
    ds_read_b128 v[64:67], v13 offset:12288
    s_branch t_g1_b
t_g1_as:
    s_waitcnt lgkmcnt(6)
    v_mfma_f32_16x16x32_bf16 a[0:3], v[40:43], v[72:75], a[0:3]
    s_xor_b32 m0, s44, 0
    v_mfma_f32_16x16x32_bf16 a[32:35], v[44:47], v[72:75], a[32:35]
    buffer_load_dwordx4 v4, s[8:11], s20 offen lds
    v_mfma_f32_16x16x32_bf16 a[36:39], v[44:47], v[76:79], a[36:39]
    ds_read_b128 v[80:83], v14 offset:4096
    s_xor_b32 m0, s44, 1024
    v_mfma_f32_16x16x32_bf16 a[4:7], v[40:43], v[76:79], a[4:7]
    buffer_load_dwordx4 v5, s[8:11], s20 offen lds
    s_waitcnt lgkmcnt(5)
    v_mfma_f32_16x16x32_bf16 a[64:67], v[48:51], v[72:75], a[64:67]
    ds_read_b128 v[84:87], v14 offset:6144
    s_add_u32 s20, s20, 128
    v_mfma_f32_16x16x32_bf16 a[96:99], v[52:55], v[72:75], a[96:99]
    s_xor_b32 m0, s45, 0
    v_mfma_f32_16x16x32_bf16 a[100:103], v[52:55], v[76:79], a[100:103]
    buffer_load_dwordx4 v6, s[12:15], s24 offen nt lds
    v_mfma_f32_16x16x32_bf16 a[68:71], v[48:51], v[76:79], a[68:71]
    s_xor_b32 m0, s45, 1024
    s_waitcnt lgkmcnt(4)
    v_mfma_f32_16x16x32_bf16 a[128:131], v[56:59], v[72:75], a[128:131]
    buffer_load_dwordx4 v7, s[12:15], s24 offen nt lds
    v_mfma_f32_16x16x32_bf16 a[160:163], v[60:63], v[72:75], a[160:163]
    s_add_u32 s24, s24, s28
    s_bitcmp1_b32 s43, 0
    v_mfma_f32_16x16x32_bf16 a[164:167], v[60:63], v[76:79], a[164:167]
    s_cselect_b32 s61, s5, 0
    s_lshl1_add_u32 s53, s61, s50
    v_mfma_f32_16x16x32_bf16 a[132:135], v[56:59], v[76:79], a[132:135]
    s_bitcmp1_b32 s43, 1
    s_waitcnt lgkmcnt(2)
    v_mfma_f32_16x16x32_bf16 a[192:195], v[64:67], v[72:75], a[192:195]
    s_cselect_b32 s61, s51, 0
    s_add_u32 s53, s53, s61
    v_mfma_f32_16x16x32_bf16 a[224:227], v[68:71], v[72:75], a[224:227]
    s_bitcmp1_b32 s43, 2
    s_cselect_b32 s61, s52, 0
    v_mfma_f32_16x16x32_bf16 a[228:231], v[68:71], v[76:79], a[228:231]
    s_add_u32 s53, s53, s61
    s_lshl_b32 s29, s43, 4
    v_mfma_f32_16x16x32_bf16 a[196:199], v[64:67], v[76:79], a[196:199]
    s_waitcnt lgkmcnt(1)
    v_mfma_f32_16x16x32_bf16 a[8:11], v[40:43], v[80:83], a[8:11]
    s_set_gpr_idx_on s29, gpr_idx(SRC0)
    v_mov_b32 v24, v128
    v_mov_b32 v25, v129
    v_mov_b32 v26, v130
    v_mov_b32 v27, v131
    s_set_gpr_idx_off
    v_mfma_f32_16x16x32_bf16 a[40:43], v[44:47], v[80:83], a[40:43]
    s_waitcnt lgkmcnt(0)
    v_mfma_f32_16x16x32_bf16 a[44:47], v[44:47], v[84:87], a[44:47]
    ds_read_b128 v[72:75], v14 offset:8192
    s_set_gpr_idx_on s29, gpr_idx(SRC0)
    v_mov_b32 v28, v132
    v_mov_b32 v29, v133
    v_mov_b32 v30, v134
    v_mov_b32 v31, v135
    s_set_gpr_idx_off
    v_mfma_f32_16x16x32_bf16 a[12:15], v[40:43], v[84:87], a[12:15]
    v_mfma_f32_16x16x32_bf16 a[72:75], v[48:51], v[80:83], a[72:75]
    ds_read_b128 v[76:79], v14 offset:10240
    s_set_gpr_idx_on s29, gpr_idx(SRC0)
    v_mov_b32 v32, v136
    v_mov_b32 v33, v137
    v_mov_b32 v34, v138
    v_mov_b32 v35, v139
    s_set_gpr_idx_off
    v_mfma_f32_16x16x32_bf16 a[104:107], v[52:55], v[80:83], a[104:107]
    v_mfma_f32_16x16x32_bf16 a[108:111], v[52:55], v[84:87], a[108:111]
    s_set_gpr_idx_on s29, gpr_idx(SRC0)
    v_mov_b32 v36, v140
    v_mov_b32 v37, v141
    v_mov_b32 v38, v142
    v_mov_b32 v39, v143
    s_set_gpr_idx_off
    v_mfma_f32_16x16x32_bf16 a[76:79], v[48:51], v[84:87], a[76:79]
    v_mfma_f32_16x16x32_bf16 a[136:139], v[56:59], v[80:83], a[136:139]
    buffer_store_dwordx4 v[24:27], v2, s[16:19], s53 offen sc1
    v_mfma_f32_16x16x32_bf16 a[168:171], v[60:63], v[80:83], a[168:171]
    v_mfma_f32_16x16x32_bf16 a[172:175], v[60:63], v[84:87], a[172:175]
    buffer_store_dwordx4 v[28:31], v3, s[16:19], s53 offen sc1
    v_mfma_f32_16x16x32_bf16 a[140:143], v[56:59], v[84:87], a[140:143]
    s_add_u32 s53, s53, s5
    v_mfma_f32_16x16x32_bf16 a[200:203], v[64:67], v[80:83], a[200:203]
    buffer_store_dwordx4 v[32:35], v2, s[16:19], s53 offen sc1
    v_mfma_f32_16x16x32_bf16 a[232:235], v[68:71], v[80:83], a[232:235]
    v_mfma_f32_16x16x32_bf16 a[236:239], v[68:71], v[84:87], a[236:239]
    buffer_store_dwordx4 v[36:39], v3, s[16:19], s53 offen sc1
    v_mfma_f32_16x16x32_bf16 a[204:207], v[64:67], v[84:87], a[204:207]
    s_waitcnt lgkmcnt(1)
    v_mfma_f32_16x16x32_bf16 a[16:19], v[40:43], v[72:75], a[16:19]
    v_mfma_f32_16x16x32_bf16 a[48:51], v[44:47], v[72:75], a[48:51]
    s_waitcnt lgkmcnt(0)
    v_mfma_f32_16x16x32_bf16 a[52:55], v[44:47], v[76:79], a[52:55]
    ds_read_b128 v[80:83], v14 offset:12288
    v_mfma_f32_16x16x32_bf16 a[20:23], v[40:43], v[76:79], a[20:23]
    v_mfma_f32_16x16x32_bf16 a[80:83], v[48:51], v[72:75], a[80:83]
    ds_read_b128 v[84:87], v14 offset:14336
    v_mfma_f32_16x16x32_bf16 a[112:115], v[52:55], v[72:75], a[112:115]
    v_mfma_f32_16x16x32_bf16 a[116:119], v[52:55], v[76:79], a[116:119]
    v_mfma_f32_16x16x32_bf16 a[84:87], v[48:51], v[76:79], a[84:87]
    v_mfma_f32_16x16x32_bf16 a[144:147], v[56:59], v[72:75], a[144:147]
    v_mfma_f32_16x16x32_bf16 a[176:179], v[60:63], v[72:75], a[176:179]
    v_mfma_f32_16x16x32_bf16 a[180:183], v[60:63], v[76:79], a[180:183]
    v_mfma_f32_16x16x32_bf16 a[148:151], v[56:59], v[76:79], a[148:151]
    v_mfma_f32_16x16x32_bf16 a[208:211], v[64:67], v[72:75], a[208:211]
    v_mfma_f32_16x16x32_bf16 a[240:243], v[68:71], v[72:75], a[240:243]
    v_mfma_f32_16x16x32_bf16 a[244:247], v[68:71], v[76:79], a[244:247]
    v_mfma_f32_16x16x32_bf16 a[212:215], v[64:67], v[76:79], a[212:215]
    s_waitcnt lgkmcnt(1)
    v_mfma_f32_16x16x32_bf16 a[24:27], v[40:43], v[80:83], a[24:27]
    ds_read_b128 v[72:75], v15 offset:0
    v_mfma_f32_16x16x32_bf16 a[56:59], v[44:47], v[80:83], a[56:59]
    ds_read_b128 v[76:79], v15 offset:2048
    s_waitcnt lgkmcnt(2)
    v_mfma_f32_16x16x32_bf16 a[60:63], v[44:47], v[84:87], a[60:63]
    ds_read_b128 v[44:47], v13 offset:2048
    v_mfma_f32_16x16x32_bf16 a[28:31], v[40:43], v[84:87], a[28:31]
    ds_read_b128 v[40:43], v13 offset:0
    v_mfma_f32_16x16x32_bf16 a[88:91], v[48:51], v[80:83], a[88:91]
    v_mfma_f32_16x16x32_bf16 a[120:123], v[52:55], v[80:83], a[120:123]
    v_mfma_f32_16x16x32_bf16 a[124:127], v[52:55], v[84:87], a[124:127]
    ds_read_b128 v[52:55], v13 offset:6144
    v_mfma_f32_16x16x32_bf16 a[92:95], v[48:51], v[84:87], a[92:95]
    ds_read_b128 v[48:51], v13 offset:4096
    v_mfma_f32_16x16x32_bf16 a[152:155], v[56:59], v[80:83], a[152:155]
    s_xor_b32 m0, s44, 2048
    v_mfma_f32_16x16x32_bf16 a[184:187], v[60:63], v[80:83], a[184:187]
    buffer_load_dwordx4 v4, s[8:11], s21 offen lds
    v_mfma_f32_16x16x32_bf16 a[188:191], v[60:63], v[84:87], a[188:191]
    ds_read_b128 v[60:63], v13 offset:10240
    v_mfma_f32_16x16x32_bf16 a[156:159], v[56:59], v[84:87], a[156:159]
    ds_read_b128 v[56:59], v13 offset:8192
    v_mfma_f32_16x16x32_bf16 a[216:219], v[64:67], v[80:83], a[216:219]
    s_xor_b32 m0, s44, 3072
    v_mfma_f32_16x16x32_bf16 a[248:251], v[68:71], v[80:83], a[248:251]
    buffer_load_dwordx4 v5, s[8:11], s21 offen lds
    v_mfma_f32_16x16x32_bf16 a[252:255], v[68:71], v[84:87], a[252:255]
    ds_read_b128 v[68:71], v13 offset:14336
    s_add_u32 s21, s21, 128
    v_mfma_f32_16x16x32_bf16 a[220:223], v[64:67], v[84:87], a[220:223]
    ds_read_b128 v[64:67], v13 offset:12288
    s_branch t_g1_b
t_g1_hook:
    s_cmp_eq_u32 s43, 1
    s_cbranch_scc1 t_g1_sig0
    s_cmp_lt_u32 s43, 8
    s_cbranch_scc1 t_g1_as
    s_cmp_eq_u32 s43, 14
    s_cbranch_scc1 t_g1_sws
    s_cmp_eq_u32 s43, 15
    s_cbranch_scc1 t_g1_swp
    s_cmp_lg_u32 s58, 0
    s_cbranch_scc1 t_g1_a
    s_cmp_eq_u32 s43, 13
    s_cbranch_scc1 t_g1_wait
    s_cmp_lg_u32 s43, 9
    s_cbranch_scc1 t_g1_a
    s_cmp_eq_u32 s4, 0
    s_cbranch_scc1 t_g1_a
    v_mov_b32 v24, s4
    v_mov_b32 v25, 1
    s_mov_b64 exec, 1
    global_atomic_add v24, v25, s[98:99] sc1
    s_mov_b64 exec, -1
    s_branch t_g1_a
t_g1_wait:
    s_cmp_eq_u32 s3, 0
    s_cbranch_scc1 t_g1_a
    s_mov_b32 s62, 0
L_sw_72:
    s_load_dword s63, s[98:99], s3 glc
    s_add_u32 s62, s62, 1
    s_cmp_gt_u32 s62, 0x200000
    s_cbranch_scc1 chain_kernel_wabort
    s_waitcnt lgkmcnt(0)
    s_cmp_ge_u32 s63, s2
    s_cbranch_scc1 L_swok_73
    s_sleep 16
    s_branch L_sw_72
L_swok_73:
    s_branch t_g1_a
t_g1_sig0:
    s_cmp_eq_u32 s1, 0
    s_cbranch_scc1 t_g1_as
    v_mov_b32 v24, s1
    v_mov_b32 v25, 1
    s_mov_b64 exec, 1
    global_atomic_add v24, v25, s[98:99] sc1
    s_mov_b64 exec, -1
    s_mov_b32 s1, 0
    s_branch t_g1_as
t_g1_sws:
    s_mov_b32 s12, s36
    s_mov_b32 s13, s37
    s_mov_b32 s14, s38
    s_and_b32 s45, s45, 0xffffb7ff
    s_bitcmp1_b32 s94, 1
    s_cselect_b32 s24, s41, 0
    s_cselect_b32 s26, 0, s41
    s_cselect_b32 s60, 0x4000, 0
    s_or_b32 s45, s45, s60
    s_add_u32 s24, s24, s39
    s_add_u32 s26, s26, s39
    s_bitcmp1_b32 s94, 0
    s_cselect_b32 s61, s40, 0
    s_cselect_b32 s62, 0, s40
    s_cselect_b32 s60, 0x800, 0
    s_or_b32 s45, s45, s60
    s_add_u32 s25, s24, s62
    s_add_u32 s24, s24, s61
    s_add_u32 s27, s26, s62
    s_add_u32 s26, s26, s61
    s_mov_b32 s28, s42
    v_mov_b32 v6, v10
    v_mov_b32 v7, v11
    s_branch t_g1_a
t_g1_swp:
    s_mov_b32 s8, s30
    s_mov_b32 s9, s31
    s_mov_b32 s10, s32
    s_and_b32 s44, s44, 0xffffb7ff
    s_bitcmp1_b32 s84, 1
    s_cselect_b32 s20, s35, 0
    s_cselect_b32 s22, 0, s35
    s_cselect_b32 s60, 0x4000, 0
    s_or_b32 s44, s44, s60
    s_add_u32 s20, s20, s33
    s_add_u32 s22, s22, s33
    s_bitcmp1_b32 s84, 0
    s_cselect_b32 s61, s34, 0
    s_cselect_b32 s62, 0, s34
    s_cselect_b32 s60, 0x800, 0
    s_or_b32 s44, s44, s60
    s_add_u32 s21, s20, s62
    s_add_u32 s20, s20, s61
    s_add_u32 s23, s22, s62
    s_add_u32 s22, s22, s61
    v_mov_b32 v4, v8
    v_mov_b32 v5, v9
t_g1_a:
    s_waitcnt lgkmcnt(6)
    v_mfma_f32_16x16x32_bf16 a[0:3], v[40:43], v[72:75], a[0:3]
    s_xor_b32 m0, s44, 0
    v_mfma_f32_16x16x32_bf16 a[32:35], v[44:47], v[72:75], a[32:35]
    buffer_load_dwordx4 v4, s[8:11], s20 offen lds
    v_mfma_f32_16x16x32_bf16 a[36:39], v[44:47], v[76:79], a[36:39]
    ds_read_b128 v[80:83], v14 offset:4096
    s_xor_b32 m0, s44, 1024
    v_mfma_f32_16x16x32_bf16 a[4:7], v[40:43], v[76:79], a[4:7]
    buffer_load_dwordx4 v5, s[8:11], s20 offen lds
    s_waitcnt lgkmcnt(5)
    v_mfma_f32_16x16x32_bf16 a[64:67], v[48:51], v[72:75], a[64:67]
    ds_read_b128 v[84:87], v14 offset:6144
    s_add_u32 s20, s20, 128
    v_mfma_f32_16x16x32_bf16 a[96:99], v[52:55], v[72:75], a[96:99]
    s_xor_b32 m0, s45, 0
    v_mfma_f32_16x16x32_bf16 a[100:103], v[52:55], v[76:79], a[100:103]
    buffer_load_dwordx4 v6, s[12:15], s24 offen nt lds
    v_mfma_f32_16x16x32_bf16 a[68:71], v[48:51], v[76:79], a[68:71]
    s_xor_b32 m0, s45, 1024
    s_waitcnt lgkmcnt(4)
    v_mfma_f32_16x16x32_bf16 a[128:131], v[56:59], v[72:75], a[128:131]
    buffer_load_dwordx4 v7, s[12:15], s24 offen nt lds
    v_mfma_f32_16x16x32_bf16 a[160:163], v[60:63], v[72:75], a[160:163]
    s_add_u32 s24, s24, s28
    v_mfma_f32_16x16x32_bf16 a[164:167], v[60:63], v[76:79], a[164:167]
    v_mfma_f32_16x16x32_bf16 a[132:135], v[56:59], v[76:79], a[132:135]
    s_waitcnt lgkmcnt(2)
    v_mfma_f32_16x16x32_bf16 a[192:195], v[64:67], v[72:75], a[192:195]
    v_mfma_f32_16x16x32_bf16 a[224:227], v[68:71], v[72:75], a[224:227]
    v_mfma_f32_16x16x32_bf16 a[228:231], v[68:71], v[76:79], a[228:231]
    v_mfma_f32_16x16x32_bf16 a[196:199], v[64:67], v[76:79], a[196:199]
    s_waitcnt lgkmcnt(1)
    v_mfma_f32_16x16x32_bf16 a[8:11], v[40:43], v[80:83], a[8:11]
    v_mfma_f32_16x16x32_bf16 a[40:43], v[44:47], v[80:83], a[40:43]
    s_waitcnt lgkmcnt(0)
    v_mfma_f32_16x16x32_bf16 a[44:47], v[44:47], v[84:87], a[44:47]
    ds_read_b128 v[72:75], v14 offset:8192
    v_mfma_f32_16x16x32_bf16 a[12:15], v[40:43], v[84:87], a[12:15]
    v_mfma_f32_16x16x32_bf16 a[72:75], v[48:51], v[80:83], a[72:75]
    ds_read_b128 v[76:79], v14 offset:10240
    v_mfma_f32_16x16x32_bf16 a[104:107], v[52:55], v[80:83], a[104:107]
    v_mfma_f32_16x16x32_bf16 a[108:111], v[52:55], v[84:87], a[108:111]
    v_mfma_f32_16x16x32_bf16 a[76:79], v[48:51], v[84:87], a[76:79]
    v_mfma_f32_16x16x32_bf16 a[136:139], v[56:59], v[80:83], a[136:139]
    v_mfma_f32_16x16x32_bf16 a[168:171], v[60:63], v[80:83], a[168:171]
    v_mfma_f32_16x16x32_bf16 a[172:175], v[60:63], v[84:87], a[172:175]
    v_mfma_f32_16x16x32_bf16 a[140:143], v[56:59], v[84:87], a[140:143]
    v_mfma_f32_16x16x32_bf16 a[200:203], v[64:67], v[80:83], a[200:203]
    v_mfma_f32_16x16x32_bf16 a[232:235], v[68:71], v[80:83], a[232:235]
    v_mfma_f32_16x16x32_bf16 a[236:239], v[68:71], v[84:87], a[236:239]
    v_mfma_f32_16x16x32_bf16 a[204:207], v[64:67], v[84:87], a[204:207]
    s_waitcnt lgkmcnt(1)
    v_mfma_f32_16x16x32_bf16 a[16:19], v[40:43], v[72:75], a[16:19]
    v_mfma_f32_16x16x32_bf16 a[48:51], v[44:47], v[72:75], a[48:51]
    s_waitcnt lgkmcnt(0)
    v_mfma_f32_16x16x32_bf16 a[52:55], v[44:47], v[76:79], a[52:55]
    ds_read_b128 v[80:83], v14 offset:12288
    v_mfma_f32_16x16x32_bf16 a[20:23], v[40:43], v[76:79], a[20:23]
    v_mfma_f32_16x16x32_bf16 a[80:83], v[48:51], v[72:75], a[80:83]
    ds_read_b128 v[84:87], v14 offset:14336
    v_mfma_f32_16x16x32_bf16 a[112:115], v[52:55], v[72:75], a[112:115]
    v_mfma_f32_16x16x32_bf16 a[116:119], v[52:55], v[76:79], a[116:119]
    v_mfma_f32_16x16x32_bf16 a[84:87], v[48:51], v[76:79], a[84:87]
    v_mfma_f32_16x16x32_bf16 a[144:147], v[56:59], v[72:75], a[144:147]
    v_mfma_f32_16x16x32_bf16 a[176:179], v[60:63], v[72:75], a[176:179]
    v_mfma_f32_16x16x32_bf16 a[180:183], v[60:63], v[76:79], a[180:183]
    v_mfma_f32_16x16x32_bf16 a[148:151], v[56:59], v[76:79], a[148:151]
    v_mfma_f32_16x16x32_bf16 a[208:211], v[64:67], v[72:75], a[208:211]
    v_mfma_f32_16x16x32_bf16 a[240:243], v[68:71], v[72:75], a[240:243]
    v_mfma_f32_16x16x32_bf16 a[244:247], v[68:71], v[76:79], a[244:247]
    v_mfma_f32_16x16x32_bf16 a[212:215], v[64:67], v[76:79], a[212:215]
    s_waitcnt lgkmcnt(1)
    v_mfma_f32_16x16x32_bf16 a[24:27], v[40:43], v[80:83], a[24:27]
    ds_read_b128 v[72:75], v15 offset:0
    v_mfma_f32_16x16x32_bf16 a[56:59], v[44:47], v[80:83], a[56:59]
    ds_read_b128 v[76:79], v15 offset:2048
    s_waitcnt lgkmcnt(2)
    v_mfma_f32_16x16x32_bf16 a[60:63], v[44:47], v[84:87], a[60:63]
    ds_read_b128 v[44:47], v13 offset:2048
    v_mfma_f32_16x16x32_bf16 a[28:31], v[40:43], v[84:87], a[28:31]
    ds_read_b128 v[40:43], v13 offset:0
    v_mfma_f32_16x16x32_bf16 a[88:91], v[48:51], v[80:83], a[88:91]
    v_mfma_f32_16x16x32_bf16 a[120:123], v[52:55], v[80:83], a[120:123]
    v_mfma_f32_16x16x32_bf16 a[124:127], v[52:55], v[84:87], a[124:127]
    ds_read_b128 v[52:55], v13 offset:6144
    v_mfma_f32_16x16x32_bf16 a[92:95], v[48:51], v[84:87], a[92:95]
    ds_read_b128 v[48:51], v13 offset:4096
    v_mfma_f32_16x16x32_bf16 a[152:155], v[56:59], v[80:83], a[152:155]
    s_xor_b32 m0, s44, 2048
    v_mfma_f32_16x16x32_bf16 a[184:187], v[60:63], v[80:83], a[184:187]
    buffer_load_dwordx4 v4, s[8:11], s21 offen lds
    v_mfma_f32_16x16x32_bf16 a[188:191], v[60:63], v[84:87], a[188:191]
    ds_read_b128 v[60:63], v13 offset:10240
    v_mfma_f32_16x16x32_bf16 a[156:159], v[56:59], v[84:87], a[156:159]
    ds_read_b128 v[56:59], v13 offset:8192
    v_mfma_f32_16x16x32_bf16 a[216:219], v[64:67], v[80:83], a[216:219]
    s_xor_b32 m0, s44, 3072
    v_mfma_f32_16x16x32_bf16 a[248:251], v[68:71], v[80:83], a[248:251]
    buffer_load_dwordx4 v5, s[8:11], s21 offen lds
    v_mfma_f32_16x16x32_bf16 a[252:255], v[68:71], v[84:87], a[252:255]
    ds_read_b128 v[68:71], v13 offset:14336
    s_add_u32 s21, s21, 128
    v_mfma_f32_16x16x32_bf16 a[220:223], v[64:67], v[84:87], a[220:223]
    ds_read_b128 v[64:67], v13 offset:12288
t_g1_b:
    s_waitcnt lgkmcnt(6)
    v_mfma_f32_16x16x32_bf16 a[0:3], v[40:43], v[72:75], a[0:3]
    v_mfma_f32_16x16x32_bf16 a[32:35], v[44:47], v[72:75], a[32:35]
    s_xor_b32 m0, s44, 16384
    v_mfma_f32_16x16x32_bf16 a[36:39], v[44:47], v[76:79], a[36:39]
    ds_read_b128 v[80:83], v15 offset:4096
    buffer_load_dwordx4 v4, s[8:11], s22 offen lds
    v_mfma_f32_16x16x32_bf16 a[4:7], v[40:43], v[76:79], a[4:7]
    s_cmp_ge_u32 s48, 98304
    s_waitcnt lgkmcnt(5)
    v_mfma_f32_16x16x32_bf16 a[64:67], v[48:51], v[72:75], a[64:67]
    ds_read_b128 v[84:87], v15 offset:6144
    s_cselect_b32 s46, s6, s7
    v_mfma_f32_16x16x32_bf16 a[96:99], v[52:55], v[72:75], a[96:99]
    s_add_u32 s48, s48, s46
    s_xor_b32 m0, s44, 17408
    v_mfma_f32_16x16x32_bf16 a[100:103], v[52:55], v[76:79], a[100:103]
    buffer_load_dwordx4 v5, s[8:11], s22 offen lds
    v_mfma_f32_16x16x32_bf16 a[68:71], v[48:51], v[76:79], a[68:71]
    s_add_u32 s22, s22, 128
    s_waitcnt lgkmcnt(4)
    v_mfma_f32_16x16x32_bf16 a[128:131], v[56:59], v[72:75], a[128:131]
    s_cmp_ge_u32 s49, 98304
    s_cselect_b32 s47, s6, s7
    v_mfma_f32_16x16x32_bf16 a[160:163], v[60:63], v[72:75], a[160:163]
    s_add_u32 s49, s49, s47
    s_xor_b32 m0, s44, 18432
    v_mfma_f32_16x16x32_bf16 a[164:167], v[60:63], v[76:79], a[164:167]
    buffer_load_dwordx4 v4, s[8:11], s23 offen lds
    v_mfma_f32_16x16x32_bf16 a[132:135], v[56:59], v[76:79], a[132:135]
    s_waitcnt lgkmcnt(2)
    v_mfma_f32_16x16x32_bf16 a[192:195], v[64:67], v[72:75], a[192:195]
    v_mfma_f32_16x16x32_bf16 a[224:227], v[68:71], v[72:75], a[224:227]
    s_xor_b32 m0, s44, 19456
    v_mfma_f32_16x16x32_bf16 a[228:231], v[68:71], v[76:79], a[228:231]
    buffer_load_dwordx4 v5, s[8:11], s23 offen lds
    v_mfma_f32_16x16x32_bf16 a[196:199], v[64:67], v[76:79], a[196:199]
    s_add_u32 s23, s23, 128
    s_waitcnt lgkmcnt(1)
    v_mfma_f32_16x16x32_bf16 a[8:11], v[40:43], v[80:83], a[8:11]
    s_cmp_ge_u32 s44, 98304
    s_cselect_b32 s60, s6, s7
    v_mfma_f32_16x16x32_bf16 a[40:43], v[44:47], v[80:83], a[40:43]
    s_add_u32 s44, s44, s60
    s_waitcnt lgkmcnt(0)
    v_mfma_f32_16x16x32_bf16 a[44:47], v[44:47], v[84:87], a[44:47]
    ds_read_b128 v[72:75], v15 offset:8192
    v_add_u32 v12, s46, v12
    v_mfma_f32_16x16x32_bf16 a[12:15], v[40:43], v[84:87], a[12:15]
    v_add_u32 v13, s46, v13
    v_add_u32 v14, s47, v14
    v_mfma_f32_16x16x32_bf16 a[72:75], v[48:51], v[80:83], a[72:75]
    ds_read_b128 v[76:79], v15 offset:10240
    s_xor_b32 m0, s45, 2048
    v_mfma_f32_16x16x32_bf16 a[104:107], v[52:55], v[80:83], a[104:107]
    buffer_load_dwordx4 v6, s[12:15], s25 offen nt lds
    v_mfma_f32_16x16x32_bf16 a[108:111], v[52:55], v[84:87], a[108:111]
    v_mfma_f32_16x16x32_bf16 a[76:79], v[48:51], v[84:87], a[76:79]
    v_mfma_f32_16x16x32_bf16 a[136:139], v[56:59], v[80:83], a[136:139]
    s_xor_b32 m0, s45, 3072
    v_mfma_f32_16x16x32_bf16 a[168:171], v[60:63], v[80:83], a[168:171]
    buffer_load_dwordx4 v7, s[12:15], s25 offen nt lds
    v_mfma_f32_16x16x32_bf16 a[172:175], v[60:63], v[84:87], a[172:175]
    s_add_u32 s25, s25, s28
    v_mfma_f32_16x16x32_bf16 a[140:143], v[56:59], v[84:87], a[140:143]
    v_mfma_f32_16x16x32_bf16 a[200:203], v[64:67], v[80:83], a[200:203]
    s_xor_b32 m0, s45, 16384
    v_mfma_f32_16x16x32_bf16 a[232:235], v[68:71], v[80:83], a[232:235]
    buffer_load_dwordx4 v6, s[12:15], s26 offen nt lds
    v_mfma_f32_16x16x32_bf16 a[236:239], v[68:71], v[84:87], a[236:239]
    v_mfma_f32_16x16x32_bf16 a[204:207], v[64:67], v[84:87], a[204:207]
    s_waitcnt lgkmcnt(1)
    v_mfma_f32_16x16x32_bf16 a[16:19], v[40:43], v[72:75], a[16:19]
    s_xor_b32 m0, s45, 17408
    v_mfma_f32_16x16x32_bf16 a[48:51], v[44:47], v[72:75], a[48:51]
    buffer_load_dwordx4 v7, s[12:15], s26 offen nt lds
    s_waitcnt lgkmcnt(0)
    v_mfma_f32_16x16x32_bf16 a[52:55], v[44:47], v[76:79], a[52:55]
    ds_read_b128 v[80:83], v15 offset:12288
    s_add_u32 s26, s26, s28
    v_mfma_f32_16x16x32_bf16 a[20:23], v[40:43], v[76:79], a[20:23]
    v_mfma_f32_16x16x32_bf16 a[80:83], v[48:51], v[72:75], a[80:83]
    ds_read_b128 v[84:87], v15 offset:14336
    s_xor_b32 m0, s45, 18432
    v_mfma_f32_16x16x32_bf16 a[112:115], v[52:55], v[72:75], a[112:115]
    buffer_load_dwordx4 v6, s[12:15], s27 offen nt lds
    v_mfma_f32_16x16x32_bf16 a[116:119], v[52:55], v[76:79], a[116:119]
    v_mfma_f32_16x16x32_bf16 a[84:87], v[48:51], v[76:79], a[84:87]
    s_xor_b32 m0, s45, 19456
    v_mfma_f32_16x16x32_bf16 a[144:147], v[56:59], v[72:75], a[144:147]
    buffer_load_dwordx4 v7, s[12:15], s27 offen nt lds
    v_mfma_f32_16x16x32_bf16 a[176:179], v[60:63], v[72:75], a[176:179]
    s_add_u32 s27, s27, s28
    s_cmp_ge_u32 s45, 98304
    v_mfma_f32_16x16x32_bf16 a[180:183], v[60:63], v[76:79], a[180:183]
    s_cselect_b32 s60, s6, s7
    s_add_u32 s45, s45, s60
    v_mfma_f32_16x16x32_bf16 a[148:151], v[56:59], v[76:79], a[148:151]
    v_add_u32 v15, s47, v15
    v_mfma_f32_16x16x32_bf16 a[208:211], v[64:67], v[72:75], a[208:211]
    s_add_u32 s43, s43, 1
    s_cmp_eq_u32 s43, 16
    v_mfma_f32_16x16x32_bf16 a[240:243], v[68:71], v[72:75], a[240:243]
    v_mfma_f32_16x16x32_bf16 a[244:247], v[68:71], v[76:79], a[244:247]
    v_mfma_f32_16x16x32_bf16 a[212:215], v[64:67], v[76:79], a[212:215]
    s_waitcnt vmcnt(6) lgkmcnt(0)
    s_barrier
    s_cbranch_scc1 t_g1_last
    v_mfma_f32_16x16x32_bf16 a[24:27], v[40:43], v[80:83], a[24:27]
    ds_read_b128 v[72:75], v14 offset:0
    v_mfma_f32_16x16x32_bf16 a[56:59], v[44:47], v[80:83], a[56:59]
    ds_read_b128 v[76:79], v14 offset:2048
    v_mfma_f32_16x16x32_bf16 a[60:63], v[44:47], v[84:87], a[60:63]
    ds_read_b128 v[44:47], v12 offset:2048
    v_mfma_f32_16x16x32_bf16 a[28:31], v[40:43], v[84:87], a[28:31]
    ds_read_b128 v[40:43], v12 offset:0
    v_mfma_f32_16x16x32_bf16 a[88:91], v[48:51], v[80:83], a[88:91]
    v_mfma_f32_16x16x32_bf16 a[120:123], v[52:55], v[80:83], a[120:123]
    v_mfma_f32_16x16x32_bf16 a[124:127], v[52:55], v[84:87], a[124:127]
    ds_read_b128 v[52:55], v12 offset:6144
    v_mfma_f32_16x16x32_bf16 a[92:95], v[48:51], v[84:87], a[92:95]
    ds_read_b128 v[48:51], v12 offset:4096
    v_mfma_f32_16x16x32_bf16 a[152:155], v[56:59], v[80:83], a[152:155]
    v_mfma_f32_16x16x32_bf16 a[184:187], v[60:63], v[80:83], a[184:187]
    v_mfma_f32_16x16x32_bf16 a[188:191], v[60:63], v[84:87], a[188:191]
    ds_read_b128 v[60:63], v12 offset:10240
    v_mfma_f32_16x16x32_bf16 a[156:159], v[56:59], v[84:87], a[156:159]
    ds_read_b128 v[56:59], v12 offset:8192
    v_mfma_f32_16x16x32_bf16 a[216:219], v[64:67], v[80:83], a[216:219]
    s_sub_u32 s61, s43, 10
    s_cmp_lt_u32 s61, 3
    v_mfma_f32_16x16x32_bf16 a[248:251], v[68:71], v[80:83], a[248:251]
    v_mfma_f32_16x16x32_bf16 a[252:255], v[68:71], v[84:87], a[252:255]
    ds_read_b128 v[68:71], v12 offset:14336
    v_mfma_f32_16x16x32_bf16 a[220:223], v[64:67], v[84:87], a[220:223]
    ds_read_b128 v[64:67], v12 offset:12288
    s_cbranch_scc1 t_g1_a
    s_branch t_g1_hook
t_g1_last:
    v_mfma_f32_16x16x32_bf16 a[24:27], v[40:43], v[80:83], a[24:27]
    v_mfma_f32_16x16x32_bf16 a[56:59], v[44:47], v[80:83], a[56:59]
    v_mfma_f32_16x16x32_bf16 a[60:63], v[44:47], v[84:87], a[60:63]
    v_mfma_f32_16x16x32_bf16 a[28:31], v[40:43], v[84:87], a[28:31]
    v_mfma_f32_16x16x32_bf16 a[88:91], v[48:51], v[80:83], a[88:91]
    v_mfma_f32_16x16x32_bf16 a[120:123], v[52:55], v[80:83], a[120:123]
    v_mfma_f32_16x16x32_bf16 a[124:127], v[52:55], v[84:87], a[124:127]
    v_mfma_f32_16x16x32_bf16 a[92:95], v[48:51], v[84:87], a[92:95]
    v_mfma_f32_16x16x32_bf16 a[152:155], v[56:59], v[80:83], a[152:155]
    v_mfma_f32_16x16x32_bf16 a[184:187], v[60:63], v[80:83], a[184:187]
    v_mfma_f32_16x16x32_bf16 a[188:191], v[60:63], v[84:87], a[188:191]
    v_mfma_f32_16x16x32_bf16 a[156:159], v[56:59], v[84:87], a[156:159]
    v_mfma_f32_16x16x32_bf16 a[216:219], v[64:67], v[80:83], a[216:219]
    v_mfma_f32_16x16x32_bf16 a[248:251], v[68:71], v[80:83], a[248:251]
    v_mfma_f32_16x16x32_bf16 a[252:255], v[68:71], v[84:87], a[252:255]
    v_mfma_f32_16x16x32_bf16 a[220:223], v[64:67], v[84:87], a[220:223]
    s_setpc_b64 s[54:55]
t_scan:
    s_nop 7
    v_accvgpr_read_b32 v40, a0
    v_accvgpr_read_b32 v42, a4
    v_accvgpr_read_b32 v44, a8
    v_accvgpr_read_b32 v46, a12
    v_accvgpr_read_b32 v41, a16
    v_accvgpr_read_b32 v43, a20
    v_accvgpr_read_b32 v45, a24
    v_accvgpr_read_b32 v47, a28
    v_accvgpr_read_b32 v48, a1
    v_accvgpr_read_b32 v50, a5
    v_accvgpr_read_b32 v52, a9
    v_accvgpr_read_b32 v54, a13
    v_accvgpr_read_b32 v49, a17
    v_accvgpr_read_b32 v51, a21
    v_accvgpr_read_b32 v53, a25
    v_accvgpr_read_b32 v55, a29
    v_pk_fma_f32 v[56:57], v[88:89], v[40:41], v[48:49] op_sel:[0,0,0] op_sel_hi:[0,1,1]
    v_pk_fma_f32 v[58:59], v[90:91], v[42:43], v[50:51] op_sel:[0,0,0] op_sel_hi:[0,1,1]
    v_pk_fma_f32 v[60:61], v[92:93], v[44:45], v[52:53] op_sel:[0,0,0] op_sel_hi:[0,1,1]
    v_pk_fma_f32 v[62:63], v[94:95], v[46:47], v[54:55] op_sel:[0,0,0] op_sel_hi:[0,1,1]
    v_pk_fma_f32 v[40:41], v[88:89], v[40:41], v[56:57] op_sel:[1,1,0] op_sel_hi:[1,0,1] neg_lo:[1,0,0]
    v_pk_fma_f32 v[42:43], v[90:91], v[42:43], v[58:59] op_sel:[1,1,0] op_sel_hi:[1,0,1] neg_lo:[1,0,0]
    v_pk_fma_f32 v[44:45], v[92:93], v[44:45], v[60:61] op_sel:[1,1,0] op_sel_hi:[1,0,1] neg_lo:[1,0,0]
    v_pk_fma_f32 v[46:47], v[94:95], v[46:47], v[62:63] op_sel:[1,1,0] op_sel_hi:[1,0,1] neg_lo:[1,0,0]
    v_accvgpr_read_b32 v64, a2
    v_accvgpr_read_b32 v66, a6
    v_accvgpr_read_b32 v68, a10
    v_accvgpr_read_b32 v70, a14
    v_accvgpr_read_b32 v65, a18
    v_accvgpr_read_b32 v67, a22
    v_accvgpr_read_b32 v69, a26
    v_accvgpr_read_b32 v71, a30
    v_pk_fma_f32 v[56:57], v[88:89], v[40:41], v[64:65] op_sel:[0,0,0] op_sel_hi:[0,1,1]
    v_pk_fma_f32 v[58:59], v[90:91], v[42:43], v[66:67] op_sel:[0,0,0] op_sel_hi:[0,1,1]
    v_pk_fma_f32 v[60:61], v[92:93], v[44:45], v[68:69] op_sel:[0,0,0] op_sel_hi:[0,1,1]
    v_pk_fma_f32 v[62:63], v[94:95], v[46:47], v[70:71] op_sel:[0,0,0] op_sel_hi:[0,1,1]
    v_pk_fma_f32 v[40:41], v[88:89], v[40:41], v[56:57] op_sel:[1,1,0] op_sel_hi:[1,0,1] neg_lo:[1,0,0]
    v_pk_fma_f32 v[42:43], v[90:91], v[42:43], v[58:59] op_sel:[1,1,0] op_sel_hi:[1,0,1] neg_lo:[1,0,0]
    v_pk_fma_f32 v[44:45], v[92:93], v[44:45], v[60:61] op_sel:[1,1,0] op_sel_hi:[1,0,1] neg_lo:[1,0,0]
    v_pk_fma_f32 v[46:47], v[94:95], v[46:47], v[62:63] op_sel:[1,1,0] op_sel_hi:[1,0,1] neg_lo:[1,0,0]
    v_accvgpr_read_b32 v48, a3
    v_accvgpr_read_b32 v50, a7
    v_accvgpr_read_b32 v52, a11
    v_accvgpr_read_b32 v54, a15
    v_accvgpr_read_b32 v49, a19
    v_accvgpr_read_b32 v51, a23
    v_accvgpr_read_b32 v53, a27
    v_accvgpr_read_b32 v55, a31
    v_pk_fma_f32 v[56:57], v[88:89], v[40:41], v[48:49] op_sel:[0,0,0] op_sel_hi:[0,1,1]
    v_pk_fma_f32 v[58:59], v[90:91], v[42:43], v[50:51] op_sel:[0,0,0] op_sel_hi:[0,1,1]
    v_pk_fma_f32 v[60:61], v[92:93], v[44:45], v[52:53] op_sel:[0,0,0] op_sel_hi:[0,1,1]
    v_pk_fma_f32 v[62:63], v[94:95], v[46:47], v[54:55] op_sel:[0,0,0] op_sel_hi:[0,1,1]
    v_pk_fma_f32 v[40:41], v[88:89], v[40:41], v[56:57] op_sel:[1,1,0] op_sel_hi:[1,0,1] neg_lo:[1,0,0]
    v_pk_fma_f32 v[42:43], v[90:91], v[42:43], v[58:59] op_sel:[1,1,0] op_sel_hi:[1,0,1] neg_lo:[1,0,0]
    v_pk_fma_f32 v[44:45], v[92:93], v[44:45], v[60:61] op_sel:[1,1,0] op_sel_hi:[1,0,1] neg_lo:[1,0,0]
    v_pk_fma_f32 v[46:47], v[94:95], v[46:47], v[62:63] op_sel:[1,1,0] op_sel_hi:[1,0,1] neg_lo:[1,0,0]
    v_accvgpr_read_b32 v64, a32
    v_accvgpr_read_b32 v66, a36
    v_accvgpr_read_b32 v68, a40
    v_accvgpr_read_b32 v70, a44
    v_accvgpr_read_b32 v65, a48
    v_accvgpr_read_b32 v67, a52
    v_accvgpr_read_b32 v69, a56
    v_accvgpr_read_b32 v71, a60
    v_pk_fma_f32 v[56:57], v[88:89], v[40:41], v[64:65] op_sel:[0,0,0] op_sel_hi:[0,1,1]
    v_pk_fma_f32 v[58:59], v[90:91], v[42:43], v[66:67] op_sel:[0,0,0] op_sel_hi:[0,1,1]
    v_pk_fma_f32 v[60:61], v[92:93], v[44:45], v[68:69] op_sel:[0,0,0] op_sel_hi:[0,1,1]
    v_pk_fma_f32 v[62:63], v[94:95], v[46:47], v[70:71] op_sel:[0,0,0] op_sel_hi:[0,1,1]
    v_pk_fma_f32 v[40:41], v[88:89], v[40:41], v[56:57] op_sel:[1,1,0] op_sel_hi:[1,0,1] neg_lo:[1,0,0]
    v_pk_fma_f32 v[42:43], v[90:91], v[42:43], v[58:59] op_sel:[1,1,0] op_sel_hi:[1,0,1] neg_lo:[1,0,0]
    v_pk_fma_f32 v[44:45], v[92:93], v[44:45], v[60:61] op_sel:[1,1,0] op_sel_hi:[1,0,1] neg_lo:[1,0,0]
    v_pk_fma_f32 v[46:47], v[94:95], v[46:47], v[62:63] op_sel:[1,1,0] op_sel_hi:[1,0,1] neg_lo:[1,0,0]
    v_accvgpr_read_b32 v48, a33
    v_accvgpr_read_b32 v50, a37
    v_accvgpr_read_b32 v52, a41
    v_accvgpr_read_b32 v54, a45
    v_accvgpr_read_b32 v49, a49
    v_accvgpr_read_b32 v51, a53
    v_accvgpr_read_b32 v53, a57
    v_accvgpr_read_b32 v55, a61
    v_pk_fma_f32 v[56:57], v[88:89], v[40:41], v[48:49] op_sel:[0,0,0] op_sel_hi:[0,1,1]
    v_pk_fma_f32 v[58:59], v[90:91], v[42:43], v[50:51] op_sel:[0,0,0] op_sel_hi:[0,1,1]
    v_pk_fma_f32 v[60:61], v[92:93], v[44:45], v[52:53] op_sel:[0,0,0] op_sel_hi:[0,1,1]
    v_pk_fma_f32 v[62:63], v[94:95], v[46:47], v[54:55] op_sel:[0,0,0] op_sel_hi:[0,1,1]
    v_pk_fma_f32 v[40:41], v[88:89], v[40:41], v[56:57] op_sel:[1,1,0] op_sel_hi:[1,0,1] neg_lo:[1,0,0]
    v_pk_fma_f32 v[42:43], v[90:91], v[42:43], v[58:59] op_sel:[1,1,0] op_sel_hi:[1,0,1] neg_lo:[1,0,0]
    v_pk_fma_f32 v[44:45], v[92:93], v[44:45], v[60:61] op_sel:[1,1,0] op_sel_hi:[1,0,1] neg_lo:[1,0,0]
    v_pk_fma_f32 v[46:47], v[94:95], v[46:47], v[62:63] op_sel:[1,1,0] op_sel_hi:[1,0,1] neg_lo:[1,0,0]
    v_accvgpr_read_b32 v64, a34
    v_accvgpr_read_b32 v66, a38
    v_accvgpr_read_b32 v68, a42
    v_accvgpr_read_b32 v70, a46
    v_accvgpr_read_b32 v65, a50
    v_accvgpr_read_b32 v67, a54
    v_accvgpr_read_b32 v69, a58
    v_accvgpr_read_b32 v71, a62
    v_pk_fma_f32 v[56:57], v[88:89], v[40:41], v[64:65] op_sel:[0,0,0] op_sel_hi:[0,1,1]
    v_pk_fma_f32 v[58:59], v[90:91], v[42:43], v[66:67] op_sel:[0,0,0] op_sel_hi:[0,1,1]
    v_pk_fma_f32 v[60:61], v[92:93], v[44:45], v[68:69] op_sel:[0,0,0] op_sel_hi:[0,1,1]
    v_pk_fma_f32 v[62:63], v[94:95], v[46:47], v[70:71] op_sel:[0,0,0] op_sel_hi:[0,1,1]
    v_pk_fma_f32 v[40:41], v[88:89], v[40:41], v[56:57] op_sel:[1,1,0] op_sel_hi:[1,0,1] neg_lo:[1,0,0]
    v_pk_fma_f32 v[42:43], v[90:91], v[42:43], v[58:59] op_sel:[1,1,0] op_sel_hi:[1,0,1] neg_lo:[1,0,0]
    v_pk_fma_f32 v[44:45], v[92:93], v[44:45], v[60:61] op_sel:[1,1,0] op_sel_hi:[1,0,1] neg_lo:[1,0,0]
    v_pk_fma_f32 v[46:47], v[94:95], v[46:47], v[62:63] op_sel:[1,1,0] op_sel_hi:[1,0,1] neg_lo:[1,0,0]
    v_accvgpr_read_b32 v48, a35
    v_accvgpr_read_b32 v50, a39
    v_accvgpr_read_b32 v52, a43
    v_accvgpr_read_b32 v54, a47
    v_accvgpr_read_b32 v49, a51
    v_accvgpr_read_b32 v51, a55
    v_accvgpr_read_b32 v53, a59
    v_accvgpr_read_b32 v55, a63
    v_pk_fma_f32 v[56:57], v[88:89], v[40:41], v[48:49] op_sel:[0,0,0] op_sel_hi:[0,1,1]
    v_pk_fma_f32 v[58:59], v[90:91], v[42:43], v[50:51] op_sel:[0,0,0] op_sel_hi:[0,1,1]
    v_pk_fma_f32 v[60:61], v[92:93], v[44:45], v[52:53] op_sel:[0,0,0] op_sel_hi:[0,1,1]
    v_pk_fma_f32 v[62:63], v[94:95], v[46:47], v[54:55] op_sel:[0,0,0] op_sel_hi:[0,1,1]
    v_pk_fma_f32 v[40:41], v[88:89], v[40:41], v[56:57] op_sel:[1,1,0] op_sel_hi:[1,0,1] neg_lo:[1,0,0]
    v_pk_fma_f32 v[42:43], v[90:91], v[42:43], v[58:59] op_sel:[1,1,0] op_sel_hi:[1,0,1] neg_lo:[1,0,0]
    v_pk_fma_f32 v[44:45], v[92:93], v[44:45], v[60:61] op_sel:[1,1,0] op_sel_hi:[1,0,1] neg_lo:[1,0,0]
    v_pk_fma_f32 v[46:47], v[94:95], v[46:47], v[62:63] op_sel:[1,1,0] op_sel_hi:[1,0,1] neg_lo:[1,0,0]
    v_accvgpr_read_b32 v64, a64
    v_accvgpr_read_b32 v66, a68
    v_accvgpr_read_b32 v68, a72
    v_accvgpr_read_b32 v70, a76
    v_accvgpr_read_b32 v65, a80
    v_accvgpr_read_b32 v67, a84
    v_accvgpr_read_b32 v69, a88
    v_accvgpr_read_b32 v71, a92
    v_pk_fma_f32 v[56:57], v[88:89], v[40:41], v[64:65] op_sel:[0,0,0] op_sel_hi:[0,1,1]
    v_pk_fma_f32 v[58:59], v[90:91], v[42:43], v[66:67] op_sel:[0,0,0] op_sel_hi:[0,1,1]
    v_pk_fma_f32 v[60:61], v[92:93], v[44:45], v[68:69] op_sel:[0,0,0] op_sel_hi:[0,1,1]
    v_pk_fma_f32 v[62:63], v[94:95], v[46:47], v[70:71] op_sel:[0,0,0] op_sel_hi:[0,1,1]
    v_pk_fma_f32 v[40:41], v[88:89], v[40:41], v[56:57] op_sel:[1,1,0] op_sel_hi:[1,0,1] neg_lo:[1,0,0]
    v_pk_fma_f32 v[42:43], v[90:91], v[42:43], v[58:59] op_sel:[1,1,0] op_sel_hi:[1,0,1] neg_lo:[1,0,0]
    v_pk_fma_f32 v[44:45], v[92:93], v[44:45], v[60:61] op_sel:[1,1,0] op_sel_hi:[1,0,1] neg_lo:[1,0,0]
    v_pk_fma_f32 v[46:47], v[94:95], v[46:47], v[62:63] op_sel:[1,1,0] op_sel_hi:[1,0,1] neg_lo:[1,0,0]
    v_accvgpr_read_b32 v48, a65
    v_accvgpr_read_b32 v50, a69
    v_accvgpr_read_b32 v52, a73
    v_accvgpr_read_b32 v54, a77
    v_accvgpr_read_b32 v49, a81
    v_accvgpr_read_b32 v51, a85
    v_accvgpr_read_b32 v53, a89
    v_accvgpr_read_b32 v55, a93
    v_pk_fma_f32 v[56:57], v[88:89], v[40:41], v[48:49] op_sel:[0,0,0] op_sel_hi:[0,1,1]
    v_pk_fma_f32 v[58:59], v[90:91], v[42:43], v[50:51] op_sel:[0,0,0] op_sel_hi:[0,1,1]
    v_pk_fma_f32 v[60:61], v[92:93], v[44:45], v[52:53] op_sel:[0,0,0] op_sel_hi:[0,1,1]
    v_pk_fma_f32 v[62:63], v[94:95], v[46:47], v[54:55] op_sel:[0,0,0] op_sel_hi:[0,1,1]
    v_pk_fma_f32 v[40:41], v[88:89], v[40:41], v[56:57] op_sel:[1,1,0] op_sel_hi:[1,0,1] neg_lo:[1,0,0]
    v_pk_fma_f32 v[42:43], v[90:91], v[42:43], v[58:59] op_sel:[1,1,0] op_sel_hi:[1,0,1] neg_lo:[1,0,0]
    v_pk_fma_f32 v[44:45], v[92:93], v[44:45], v[60:61] op_sel:[1,1,0] op_sel_hi:[1,0,1] neg_lo:[1,0,0]
    v_pk_fma_f32 v[46:47], v[94:95], v[46:47], v[62:63] op_sel:[1,1,0] op_sel_hi:[1,0,1] neg_lo:[1,0,0]
    v_accvgpr_read_b32 v64, a66
    v_accvgpr_read_b32 v66, a70
    v_accvgpr_read_b32 v68, a74
    v_accvgpr_read_b32 v70, a78
    v_accvgpr_read_b32 v65, a82
    v_accvgpr_read_b32 v67, a86
    v_accvgpr_read_b32 v69, a90
    v_accvgpr_read_b32 v71, a94
    v_pk_fma_f32 v[56:57], v[88:89], v[40:41], v[64:65] op_sel:[0,0,0] op_sel_hi:[0,1,1]
    v_pk_fma_f32 v[58:59], v[90:91], v[42:43], v[66:67] op_sel:[0,0,0] op_sel_hi:[0,1,1]
    v_pk_fma_f32 v[60:61], v[92:93], v[44:45], v[68:69] op_sel:[0,0,0] op_sel_hi:[0,1,1]
    v_pk_fma_f32 v[62:63], v[94:95], v[46:47], v[70:71] op_sel:[0,0,0] op_sel_hi:[0,1,1]
    v_pk_fma_f32 v[40:41], v[88:89], v[40:41], v[56:57] op_sel:[1,1,0] op_sel_hi:[1,0,1] neg_lo:[1,0,0]
    v_pk_fma_f32 v[42:43], v[90:91], v[42:43], v[58:59] op_sel:[1,1,0] op_sel_hi:[1,0,1] neg_lo:[1,0,0]
    v_pk_fma_f32 v[44:45], v[92:93], v[44:45], v[60:61] op_sel:[1,1,0] op_sel_hi:[1,0,1] neg_lo:[1,0,0]
    v_pk_fma_f32 v[46:47], v[94:95], v[46:47], v[62:63] op_sel:[1,1,0] op_sel_hi:[1,0,1] neg_lo:[1,0,0]
    v_accvgpr_read_b32 v48, a67
    v_accvgpr_read_b32 v50, a71
    v_accvgpr_read_b32 v52, a75
    v_accvgpr_read_b32 v54, a79
    v_accvgpr_read_b32 v49, a83
    v_accvgpr_read_b32 v51, a87
    v_accvgpr_read_b32 v53, a91
    v_accvgpr_read_b32 v55, a95
    v_pk_fma_f32 v[56:57], v[88:89], v[40:41], v[48:49] op_sel:[0,0,0] op_sel_hi:[0,1,1]
    v_pk_fma_f32 v[58:59], v[90:91], v[42:43], v[50:51] op_sel:[0,0,0] op_sel_hi:[0,1,1]
    v_pk_fma_f32 v[60:61], v[92:93], v[44:45], v[52:53] op_sel:[0,0,0] op_sel_hi:[0,1,1]
    v_pk_fma_f32 v[62:63], v[94:95], v[46:47], v[54:55] op_sel:[0,0,0] op_sel_hi:[0,1,1]
    v_pk_fma_f32 v[40:41], v[88:89], v[40:41], v[56:57] op_sel:[1,1,0] op_sel_hi:[1,0,1] neg_lo:[1,0,0]
    v_pk_fma_f32 v[42:43], v[90:91], v[42:43], v[58:59] op_sel:[1,1,0] op_sel_hi:[1,0,1] neg_lo:[1,0,0]
    v_pk_fma_f32 v[44:45], v[92:93], v[44:45], v[60:61] op_sel:[1,1,0] op_sel_hi:[1,0,1] neg_lo:[1,0,0]
    v_pk_fma_f32 v[46:47], v[94:95], v[46:47], v[62:63] op_sel:[1,1,0] op_sel_hi:[1,0,1] neg_lo:[1,0,0]
    v_accvgpr_read_b32 v64, a96
    v_accvgpr_read_b32 v66, a100
    v_accvgpr_read_b32 v68, a104
    v_accvgpr_read_b32 v70, a108
    v_accvgpr_read_b32 v65, a112
    v_accvgpr_read_b32 v67, a116
    v_accvgpr_read_b32 v69, a120
    v_accvgpr_read_b32 v71, a124
    v_pk_fma_f32 v[56:57], v[88:89], v[40:41], v[64:65] op_sel:[0,0,0] op_sel_hi:[0,1,1]
    v_pk_fma_f32 v[58:59], v[90:91], v[42:43], v[66:67] op_sel:[0,0,0] op_sel_hi:[0,1,1]
    v_pk_fma_f32 v[60:61], v[92:93], v[44:45], v[68:69] op_sel:[0,0,0] op_sel_hi:[0,1,1]
    v_pk_fma_f32 v[62:63], v[94:95], v[46:47], v[70:71] op_sel:[0,0,0] op_sel_hi:[0,1,1]
    v_pk_fma_f32 v[40:41], v[88:89], v[40:41], v[56:57] op_sel:[1,1,0] op_sel_hi:[1,0,1] neg_lo:[1,0,0]
    v_pk_fma_f32 v[42:43], v[90:91], v[42:43], v[58:59] op_sel:[1,1,0] op_sel_hi:[1,0,1] neg_lo:[1,0,0]
    v_pk_fma_f32 v[44:45], v[92:93], v[44:45], v[60:61] op_sel:[1,1,0] op_sel_hi:[1,0,1] neg_lo:[1,0,0]
    v_pk_fma_f32 v[46:47], v[94:95], v[46:47], v[62:63] op_sel:[1,1,0] op_sel_hi:[1,0,1] neg_lo:[1,0,0]
    v_accvgpr_read_b32 v48, a97
    v_accvgpr_read_b32 v50, a101
    v_accvgpr_read_b32 v52, a105
    v_accvgpr_read_b32 v54, a109
    v_accvgpr_read_b32 v49, a113
    v_accvgpr_read_b32 v51, a117
    v_accvgpr_read_b32 v53, a121
    v_accvgpr_read_b32 v55, a125
    v_pk_fma_f32 v[56:57], v[88:89], v[40:41], v[48:49] op_sel:[0,0,0] op_sel_hi:[0,1,1]
    v_pk_fma_f32 v[58:59], v[90:91], v[42:43], v[50:51] op_sel:[0,0,0] op_sel_hi:[0,1,1]
    v_pk_fma_f32 v[60:61], v[92:93], v[44:45], v[52:53] op_sel:[0,0,0] op_sel_hi:[0,1,1]
    v_pk_fma_f32 v[62:63], v[94:95], v[46:47], v[54:55] op_sel:[0,0,0] op_sel_hi:[0,1,1]
    v_pk_fma_f32 v[40:41], v[88:89], v[40:41], v[56:57] op_sel:[1,1,0] op_sel_hi:[1,0,1] neg_lo:[1,0,0]
    v_pk_fma_f32 v[42:43], v[90:91], v[42:43], v[58:59] op_sel:[1,1,0] op_sel_hi:[1,0,1] neg_lo:[1,0,0]
    v_pk_fma_f32 v[44:45], v[92:93], v[44:45], v[60:61] op_sel:[1,1,0] op_sel_hi:[1,0,1] neg_lo:[1,0,0]
    v_pk_fma_f32 v[46:47], v[94:95], v[46:47], v[62:63] op_sel:[1,1,0] op_sel_hi:[1,0,1] neg_lo:[1,0,0]
    v_accvgpr_read_b32 v64, a98
    v_accvgpr_read_b32 v66, a102
    v_accvgpr_read_b32 v68, a106
    v_accvgpr_read_b32 v70, a110
    v_accvgpr_read_b32 v65, a114
    v_accvgpr_read_b32 v67, a118
    v_accvgpr_read_b32 v69, a122
    v_accvgpr_read_b32 v71, a126
    v_pk_fma_f32 v[56:57], v[88:89], v[40:41], v[64:65] op_sel:[0,0,0] op_sel_hi:[0,1,1]
    v_pk_fma_f32 v[58:59], v[90:91], v[42:43], v[66:67] op_sel:[0,0,0] op_sel_hi:[0,1,1]
    v_pk_fma_f32 v[60:61], v[92:93], v[44:45], v[68:69] op_sel:[0,0,0] op_sel_hi:[0,1,1]
    v_pk_fma_f32 v[62:63], v[94:95], v[46:47], v[70:71] op_sel:[0,0,0] op_sel_hi:[0,1,1]
    v_pk_fma_f32 v[40:41], v[88:89], v[40:41], v[56:57] op_sel:[1,1,0] op_sel_hi:[1,0,1] neg_lo:[1,0,0]
    v_pk_fma_f32 v[42:43], v[90:91], v[42:43], v[58:59] op_sel:[1,1,0] op_sel_hi:[1,0,1] neg_lo:[1,0,0]
    v_pk_fma_f32 v[44:45], v[92:93], v[44:45], v[60:61] op_sel:[1,1,0] op_sel_hi:[1,0,1] neg_lo:[1,0,0]
    v_pk_fma_f32 v[46:47], v[94:95], v[46:47], v[62:63] op_sel:[1,1,0] op_sel_hi:[1,0,1] neg_lo:[1,0,0]
    v_accvgpr_read_b32 v48, a99
    v_accvgpr_read_b32 v50, a103
    v_accvgpr_read_b32 v52, a107
    v_accvgpr_read_b32 v54, a111
    v_accvgpr_read_b32 v49, a115
    v_accvgpr_read_b32 v51, a119
    v_accvgpr_read_b32 v53, a123
    v_accvgpr_read_b32 v55, a127
    v_pk_fma_f32 v[56:57], v[88:89], v[40:41], v[48:49] op_sel:[0,0,0] op_sel_hi:[0,1,1]
    v_pk_fma_f32 v[58:59], v[90:91], v[42:43], v[50:51] op_sel:[0,0,0] op_sel_hi:[0,1,1]
    v_pk_fma_f32 v[60:61], v[92:93], v[44:45], v[52:53] op_sel:[0,0,0] op_sel_hi:[0,1,1]
    v_pk_fma_f32 v[62:63], v[94:95], v[46:47], v[54:55] op_sel:[0,0,0] op_sel_hi:[0,1,1]
    v_pk_fma_f32 v[40:41], v[88:89], v[40:41], v[56:57] op_sel:[1,1,0] op_sel_hi:[1,0,1] neg_lo:[1,0,0]
    v_pk_fma_f32 v[42:43], v[90:91], v[42:43], v[58:59] op_sel:[1,1,0] op_sel_hi:[1,0,1] neg_lo:[1,0,0]
    v_pk_fma_f32 v[44:45], v[92:93], v[44:45], v[60:61] op_sel:[1,1,0] op_sel_hi:[1,0,1] neg_lo:[1,0,0]
    v_pk_fma_f32 v[46:47], v[94:95], v[46:47], v[62:63] op_sel:[1,1,0] op_sel_hi:[1,0,1] neg_lo:[1,0,0]
    v_accvgpr_read_b32 v64, a128
    v_accvgpr_read_b32 v66, a132
    v_accvgpr_read_b32 v68, a136
    v_accvgpr_read_b32 v70, a140
    v_accvgpr_read_b32 v65, a144
    v_accvgpr_read_b32 v67, a148
    v_accvgpr_read_b32 v69, a152
    v_accvgpr_read_b32 v71, a156
    v_pk_fma_f32 v[56:57], v[88:89], v[40:41], v[64:65] op_sel:[0,0,0] op_sel_hi:[0,1,1]
    v_pk_fma_f32 v[58:59], v[90:91], v[42:43], v[66:67] op_sel:[0,0,0] op_sel_hi:[0,1,1]
    v_pk_fma_f32 v[60:61], v[92:93], v[44:45], v[68:69] op_sel:[0,0,0] op_sel_hi:[0,1,1]
    v_pk_fma_f32 v[62:63], v[94:95], v[46:47], v[70:71] op_sel:[0,0,0] op_sel_hi:[0,1,1]
    v_pk_fma_f32 v[40:41], v[88:89], v[40:41], v[56:57] op_sel:[1,1,0] op_sel_hi:[1,0,1] neg_lo:[1,0,0]
    v_pk_fma_f32 v[42:43], v[90:91], v[42:43], v[58:59] op_sel:[1,1,0] op_sel_hi:[1,0,1] neg_lo:[1,0,0]
    v_pk_fma_f32 v[44:45], v[92:93], v[44:45], v[60:61] op_sel:[1,1,0] op_sel_hi:[1,0,1] neg_lo:[1,0,0]
    v_pk_fma_f32 v[46:47], v[94:95], v[46:47], v[62:63] op_sel:[1,1,0] op_sel_hi:[1,0,1] neg_lo:[1,0,0]
    v_accvgpr_read_b32 v48, a129
    v_accvgpr_read_b32 v50, a133
    v_accvgpr_read_b32 v52, a137
    v_accvgpr_read_b32 v54, a141
    v_accvgpr_read_b32 v49, a145
    v_accvgpr_read_b32 v51, a149
    v_accvgpr_read_b32 v53, a153
    v_accvgpr_read_b32 v55, a157
    v_pk_fma_f32 v[56:57], v[88:89], v[40:41], v[48:49] op_sel:[0,0,0] op_sel_hi:[0,1,1]
    v_pk_fma_f32 v[58:59], v[90:91], v[42:43], v[50:51] op_sel:[0,0,0] op_sel_hi:[0,1,1]
    v_pk_fma_f32 v[60:61], v[92:93], v[44:45], v[52:53] op_sel:[0,0,0] op_sel_hi:[0,1,1]
    v_pk_fma_f32 v[62:63], v[94:95], v[46:47], v[54:55] op_sel:[0,0,0] op_sel_hi:[0,1,1]
    v_pk_fma_f32 v[40:41], v[88:89], v[40:41], v[56:57] op_sel:[1,1,0] op_sel_hi:[1,0,1] neg_lo:[1,0,0]
    v_pk_fma_f32 v[42:43], v[90:91], v[42:43], v[58:59] op_sel:[1,1,0] op_sel_hi:[1,0,1] neg_lo:[1,0,0]
    v_pk_fma_f32 v[44:45], v[92:93], v[44:45], v[60:61] op_sel:[1,1,0] op_sel_hi:[1,0,1] neg_lo:[1,0,0]
    v_pk_fma_f32 v[46:47], v[94:95], v[46:47], v[62:63] op_sel:[1,1,0] op_sel_hi:[1,0,1] neg_lo:[1,0,0]
    v_accvgpr_read_b32 v64, a130
    v_accvgpr_read_b32 v66, a134
    v_accvgpr_read_b32 v68, a138
    v_accvgpr_read_b32 v70, a142
    v_accvgpr_read_b32 v65, a146
    v_accvgpr_read_b32 v67, a150
    v_accvgpr_read_b32 v69, a154
    v_accvgpr_read_b32 v71, a158
    v_pk_fma_f32 v[56:57], v[88:89], v[40:41], v[64:65] op_sel:[0,0,0] op_sel_hi:[0,1,1]
    v_pk_fma_f32 v[58:59], v[90:91], v[42:43], v[66:67] op_sel:[0,0,0] op_sel_hi:[0,1,1]
    v_pk_fma_f32 v[60:61], v[92:93], v[44:45], v[68:69] op_sel:[0,0,0] op_sel_hi:[0,1,1]
    v_pk_fma_f32 v[62:63], v[94:95], v[46:47], v[70:71] op_sel:[0,0,0] op_sel_hi:[0,1,1]
    v_pk_fma_f32 v[40:41], v[88:89], v[40:41], v[56:57] op_sel:[1,1,0] op_sel_hi:[1,0,1] neg_lo:[1,0,0]
    v_pk_fma_f32 v[42:43], v[90:91], v[42:43], v[58:59] op_sel:[1,1,0] op_sel_hi:[1,0,1] neg_lo:[1,0,0]
    v_pk_fma_f32 v[44:45], v[92:93], v[44:45], v[60:61] op_sel:[1,1,0] op_sel_hi:[1,0,1] neg_lo:[1,0,0]
    v_pk_fma_f32 v[46:47], v[94:95], v[46:47], v[62:63] op_sel:[1,1,0] op_sel_hi:[1,0,1] neg_lo:[1,0,0]
    v_accvgpr_read_b32 v48, a131
    v_accvgpr_read_b32 v50, a135
    v_accvgpr_read_b32 v52, a139
    v_accvgpr_read_b32 v54, a143
    v_accvgpr_read_b32 v49, a147
    v_accvgpr_read_b32 v51, a151
    v_accvgpr_read_b32 v53, a155
    v_accvgpr_read_b32 v55, a159
    v_pk_fma_f32 v[56:57], v[88:89], v[40:41], v[48:49] op_sel:[0,0,0] op_sel_hi:[0,1,1]
    v_pk_fma_f32 v[58:59], v[90:91], v[42:43], v[50:51] op_sel:[0,0,0] op_sel_hi:[0,1,1]
    v_pk_fma_f32 v[60:61], v[92:93], v[44:45], v[52:53] op_sel:[0,0,0] op_sel_hi:[0,1,1]
    v_pk_fma_f32 v[62:63], v[94:95], v[46:47], v[54:55] op_sel:[0,0,0] op_sel_hi:[0,1,1]
    v_pk_fma_f32 v[40:41], v[88:89], v[40:41], v[56:57] op_sel:[1,1,0] op_sel_hi:[1,0,1] neg_lo:[1,0,0]
    v_pk_fma_f32 v[42:43], v[90:91], v[42:43], v[58:59] op_sel:[1,1,0] op_sel_hi:[1,0,1] neg_lo:[1,0,0]
    v_pk_fma_f32 v[44:45], v[92:93], v[44:45], v[60:61] op_sel:[1,1,0] op_sel_hi:[1,0,1] neg_lo:[1,0,0]
    v_pk_fma_f32 v[46:47], v[94:95], v[46:47], v[62:63] op_sel:[1,1,0] op_sel_hi:[1,0,1] neg_lo:[1,0,0]
    v_accvgpr_read_b32 v64, a160
    v_accvgpr_read_b32 v66, a164
    v_accvgpr_read_b32 v68, a168
    v_accvgpr_read_b32 v70, a172
    v_accvgpr_read_b32 v65, a176
    v_accvgpr_read_b32 v67, a180
    v_accvgpr_read_b32 v69, a184
    v_accvgpr_read_b32 v71, a188
    v_pk_fma_f32 v[56:57], v[88:89], v[40:41], v[64:65] op_sel:[0,0,0] op_sel_hi:[0,1,1]
    v_pk_fma_f32 v[58:59], v[90:91], v[42:43], v[66:67] op_sel:[0,0,0] op_sel_hi:[0,1,1]
    v_pk_fma_f32 v[60:61], v[92:93], v[44:45], v[68:69] op_sel:[0,0,0] op_sel_hi:[0,1,1]
    v_pk_fma_f32 v[62:63], v[94:95], v[46:47], v[70:71] op_sel:[0,0,0] op_sel_hi:[0,1,1]
    v_pk_fma_f32 v[40:41], v[88:89], v[40:41], v[56:57] op_sel:[1,1,0] op_sel_hi:[1,0,1] neg_lo:[1,0,0]
    v_pk_fma_f32 v[42:43], v[90:91], v[42:43], v[58:59] op_sel:[1,1,0] op_sel_hi:[1,0,1] neg_lo:[1,0,0]
    v_pk_fma_f32 v[44:45], v[92:93], v[44:45], v[60:61] op_sel:[1,1,0] op_sel_hi:[1,0,1] neg_lo:[1,0,0]
    v_pk_fma_f32 v[46:47], v[94:95], v[46:47], v[62:63] op_sel:[1,1,0] op_sel_hi:[1,0,1] neg_lo:[1,0,0]
    v_accvgpr_read_b32 v48, a161
    v_accvgpr_read_b32 v50, a165
    v_accvgpr_read_b32 v52, a169
    v_accvgpr_read_b32 v54, a173
    v_accvgpr_read_b32 v49, a177
    v_accvgpr_read_b32 v51, a181
    v_accvgpr_read_b32 v53, a185
    v_accvgpr_read_b32 v55, a189
    v_pk_fma_f32 v[56:57], v[88:89], v[40:41], v[48:49] op_sel:[0,0,0] op_sel_hi:[0,1,1]
    v_pk_fma_f32 v[58:59], v[90:91], v[42:43], v[50:51] op_sel:[0,0,0] op_sel_hi:[0,1,1]
    v_pk_fma_f32 v[60:61], v[92:93], v[44:45], v[52:53] op_sel:[0,0,0] op_sel_hi:[0,1,1]
    v_pk_fma_f32 v[62:63], v[94:95], v[46:47], v[54:55] op_sel:[0,0,0] op_sel_hi:[0,1,1]
    v_pk_fma_f32 v[40:41], v[88:89], v[40:41], v[56:57] op_sel:[1,1,0] op_sel_hi:[1,0,1] neg_lo:[1,0,0]
    v_pk_fma_f32 v[42:43], v[90:91], v[42:43], v[58:59] op_sel:[1,1,0] op_sel_hi:[1,0,1] neg_lo:[1,0,0]
    v_pk_fma_f32 v[44:45], v[92:93], v[44:45], v[60:61] op_sel:[1,1,0] op_sel_hi:[1,0,1] neg_lo:[1,0,0]
    v_pk_fma_f32 v[46:47], v[94:95], v[46:47], v[62:63] op_sel:[1,1,0] op_sel_hi:[1,0,1] neg_lo:[1,0,0]
    v_accvgpr_read_b32 v64, a162
    v_accvgpr_read_b32 v66, a166
    v_accvgpr_read_b32 v68, a170
    v_accvgpr_read_b32 v70, a174
    v_accvgpr_read_b32 v65, a178
    v_accvgpr_read_b32 v67, a182
    v_accvgpr_read_b32 v69, a186
    v_accvgpr_read_b32 v71, a190
    v_pk_fma_f32 v[56:57], v[88:89], v[40:41], v[64:65] op_sel:[0,0,0] op_sel_hi:[0,1,1]
    v_pk_fma_f32 v[58:59], v[90:91], v[42:43], v[66:67] op_sel:[0,0,0] op_sel_hi:[0,1,1]
    v_pk_fma_f32 v[60:61], v[92:93], v[44:45], v[68:69] op_sel:[0,0,0] op_sel_hi:[0,1,1]
    v_pk_fma_f32 v[62:63], v[94:95], v[46:47], v[70:71] op_sel:[0,0,0] op_sel_hi:[0,1,1]
    v_pk_fma_f32 v[40:41], v[88:89], v[40:41], v[56:57] op_sel:[1,1,0] op_sel_hi:[1,0,1] neg_lo:[1,0,0]
    v_pk_fma_f32 v[42:43], v[90:91], v[42:43], v[58:59] op_sel:[1,1,0] op_sel_hi:[1,0,1] neg_lo:[1,0,0]
    v_pk_fma_f32 v[44:45], v[92:93], v[44:45], v[60:61] op_sel:[1,1,0] op_sel_hi:[1,0,1] neg_lo:[1,0,0]
    v_pk_fma_f32 v[46:47], v[94:95], v[46:47], v[62:63] op_sel:[1,1,0] op_sel_hi:[1,0,1] neg_lo:[1,0,0]
    v_accvgpr_read_b32 v48, a163
    v_accvgpr_read_b32 v50, a167
    v_accvgpr_read_b32 v52, a171
    v_accvgpr_read_b32 v54, a175
    v_accvgpr_read_b32 v49, a179
    v_accvgpr_read_b32 v51, a183
    v_accvgpr_read_b32 v53, a187
    v_accvgpr_read_b32 v55, a191
    v_pk_fma_f32 v[56:57], v[88:89], v[40:41], v[48:49] op_sel:[0,0,0] op_sel_hi:[0,1,1]
    v_pk_fma_f32 v[58:59], v[90:91], v[42:43], v[50:51] op_sel:[0,0,0] op_sel_hi:[0,1,1]
    v_pk_fma_f32 v[60:61], v[92:93], v[44:45], v[52:53] op_sel:[0,0,0] op_sel_hi:[0,1,1]
    v_pk_fma_f32 v[62:63], v[94:95], v[46:47], v[54:55] op_sel:[0,0,0] op_sel_hi:[0,1,1]
    v_pk_fma_f32 v[40:41], v[88:89], v[40:41], v[56:57] op_sel:[1,1,0] op_sel_hi:[1,0,1] neg_lo:[1,0,0]
    v_pk_fma_f32 v[42:43], v[90:91], v[42:43], v[58:59] op_sel:[1,1,0] op_sel_hi:[1,0,1] neg_lo:[1,0,0]
    v_pk_fma_f32 v[44:45], v[92:93], v[44:45], v[60:61] op_sel:[1,1,0] op_sel_hi:[1,0,1] neg_lo:[1,0,0]
    v_pk_fma_f32 v[46:47], v[94:95], v[46:47], v[62:63] op_sel:[1,1,0] op_sel_hi:[1,0,1] neg_lo:[1,0,0]
    v_accvgpr_read_b32 v64, a192
    v_accvgpr_read_b32 v66, a196
    v_accvgpr_read_b32 v68, a200
    v_accvgpr_read_b32 v70, a204
    v_accvgpr_read_b32 v65, a208
    v_accvgpr_read_b32 v67, a212
    v_accvgpr_read_b32 v69, a216
    v_accvgpr_read_b32 v71, a220
    v_pk_fma_f32 v[56:57], v[88:89], v[40:41], v[64:65] op_sel:[0,0,0] op_sel_hi:[0,1,1]
    v_pk_fma_f32 v[58:59], v[90:91], v[42:43], v[66:67] op_sel:[0,0,0] op_sel_hi:[0,1,1]
    v_pk_fma_f32 v[60:61], v[92:93], v[44:45], v[68:69] op_sel:[0,0,0] op_sel_hi:[0,1,1]
    v_pk_fma_f32 v[62:63], v[94:95], v[46:47], v[70:71] op_sel:[0,0,0] op_sel_hi:[0,1,1]
    v_pk_fma_f32 v[40:41], v[88:89], v[40:41], v[56:57] op_sel:[1,1,0] op_sel_hi:[1,0,1] neg_lo:[1,0,0]
    v_pk_fma_f32 v[42:43], v[90:91], v[42:43], v[58:59] op_sel:[1,1,0] op_sel_hi:[1,0,1] neg_lo:[1,0,0]
    v_pk_fma_f32 v[44:45], v[92:93], v[44:45], v[60:61] op_sel:[1,1,0] op_sel_hi:[1,0,1] neg_lo:[1,0,0]
    v_pk_fma_f32 v[46:47], v[94:95], v[46:47], v[62:63] op_sel:[1,1,0] op_sel_hi:[1,0,1] neg_lo:[1,0,0]
    v_accvgpr_read_b32 v48, a193
    v_accvgpr_read_b32 v50, a197
    v_accvgpr_read_b32 v52, a201
    v_accvgpr_read_b32 v54, a205
    v_accvgpr_read_b32 v49, a209
    v_accvgpr_read_b32 v51, a213
    v_accvgpr_read_b32 v53, a217
    v_accvgpr_read_b32 v55, a221
    v_pk_fma_f32 v[56:57], v[88:89], v[40:41], v[48:49] op_sel:[0,0,0] op_sel_hi:[0,1,1]
    v_pk_fma_f32 v[58:59], v[90:91], v[42:43], v[50:51] op_sel:[0,0,0] op_sel_hi:[0,1,1]
    v_pk_fma_f32 v[60:61], v[92:93], v[44:45], v[52:53] op_sel:[0,0,0] op_sel_hi:[0,1,1]
    v_pk_fma_f32 v[62:63], v[94:95], v[46:47], v[54:55] op_sel:[0,0,0] op_sel_hi:[0,1,1]
    v_pk_fma_f32 v[40:41], v[88:89], v[40:41], v[56:57] op_sel:[1,1,0] op_sel_hi:[1,0,1] neg_lo:[1,0,0]
    v_pk_fma_f32 v[42:43], v[90:91], v[42:43], v[58:59] op_sel:[1,1,0] op_sel_hi:[1,0,1] neg_lo:[1,0,0]
    v_pk_fma_f32 v[44:45], v[92:93], v[44:45], v[60:61] op_sel:[1,1,0] op_sel_hi:[1,0,1] neg_lo:[1,0,0]
    v_pk_fma_f32 v[46:47], v[94:95], v[46:47], v[62:63] op_sel:[1,1,0] op_sel_hi:[1,0,1] neg_lo:[1,0,0]
    v_accvgpr_read_b32 v64, a194
    v_accvgpr_read_b32 v66, a198
    v_accvgpr_read_b32 v68, a202
    v_accvgpr_read_b32 v70, a206
    v_accvgpr_read_b32 v65, a210
    v_accvgpr_read_b32 v67, a214
    v_accvgpr_read_b32 v69, a218
    v_accvgpr_read_b32 v71, a222
    v_pk_fma_f32 v[56:57], v[88:89], v[40:41], v[64:65] op_sel:[0,0,0] op_sel_hi:[0,1,1]
    v_pk_fma_f32 v[58:59], v[90:91], v[42:43], v[66:67] op_sel:[0,0,0] op_sel_hi:[0,1,1]
    v_pk_fma_f32 v[60:61], v[92:93], v[44:45], v[68:69] op_sel:[0,0,0] op_sel_hi:[0,1,1]
    v_pk_fma_f32 v[62:63], v[94:95], v[46:47], v[70:71] op_sel:[0,0,0] op_sel_hi:[0,1,1]
    v_pk_fma_f32 v[40:41], v[88:89], v[40:41], v[56:57] op_sel:[1,1,0] op_sel_hi:[1,0,1] neg_lo:[1,0,0]
    v_pk_fma_f32 v[42:43], v[90:91], v[42:43], v[58:59] op_sel:[1,1,0] op_sel_hi:[1,0,1] neg_lo:[1,0,0]
    v_pk_fma_f32 v[44:45], v[92:93], v[44:45], v[60:61] op_sel:[1,1,0] op_sel_hi:[1,0,1] neg_lo:[1,0,0]
    v_pk_fma_f32 v[46:47], v[94:95], v[46:47], v[62:63] op_sel:[1,1,0] op_sel_hi:[1,0,1] neg_lo:[1,0,0]
    v_accvgpr_read_b32 v48, a195
    v_accvgpr_read_b32 v50, a199
    v_accvgpr_read_b32 v52, a203
    v_accvgpr_read_b32 v54, a207
    v_accvgpr_read_b32 v49, a211
    v_accvgpr_read_b32 v51, a215
    v_accvgpr_read_b32 v53, a219
    v_accvgpr_read_b32 v55, a223
    v_pk_fma_f32 v[56:57], v[88:89], v[40:41], v[48:49] op_sel:[0,0,0] op_sel_hi:[0,1,1]
    v_pk_fma_f32 v[58:59], v[90:91], v[42:43], v[50:51] op_sel:[0,0,0] op_sel_hi:[0,1,1]
    v_pk_fma_f32 v[60:61], v[92:93], v[44:45], v[52:53] op_sel:[0,0,0] op_sel_hi:[0,1,1]
    v_pk_fma_f32 v[62:63], v[94:95], v[46:47], v[54:55] op_sel:[0,0,0] op_sel_hi:[0,1,1]
    v_pk_fma_f32 v[40:41], v[88:89], v[40:41], v[56:57] op_sel:[1,1,0] op_sel_hi:[1,0,1] neg_lo:[1,0,0]
    v_pk_fma_f32 v[42:43], v[90:91], v[42:43], v[58:59] op_sel:[1,1,0] op_sel_hi:[1,0,1] neg_lo:[1,0,0]
    v_pk_fma_f32 v[44:45], v[92:93], v[44:45], v[60:61] op_sel:[1,1,0] op_sel_hi:[1,0,1] neg_lo:[1,0,0]
    v_pk_fma_f32 v[46:47], v[94:95], v[46:47], v[62:63] op_sel:[1,1,0] op_sel_hi:[1,0,1] neg_lo:[1,0,0]
    v_accvgpr_read_b32 v64, a224
    v_accvgpr_read_b32 v66, a228
    v_accvgpr_read_b32 v68, a232
    v_accvgpr_read_b32 v70, a236
    v_accvgpr_read_b32 v65, a240
    v_accvgpr_read_b32 v67, a244
    v_accvgpr_read_b32 v69, a248
    v_accvgpr_read_b32 v71, a252
    v_pk_fma_f32 v[56:57], v[88:89], v[40:41], v[64:65] op_sel:[0,0,0] op_sel_hi:[0,1,1]
    v_pk_fma_f32 v[58:59], v[90:91], v[42:43], v[66:67] op_sel:[0,0,0] op_sel_hi:[0,1,1]
    v_pk_fma_f32 v[60:61], v[92:93], v[44:45], v[68:69] op_sel:[0,0,0] op_sel_hi:[0,1,1]
    v_pk_fma_f32 v[62:63], v[94:95], v[46:47], v[70:71] op_sel:[0,0,0] op_sel_hi:[0,1,1]
    v_pk_fma_f32 v[40:41], v[88:89], v[40:41], v[56:57] op_sel:[1,1,0] op_sel_hi:[1,0,1] neg_lo:[1,0,0]
    v_pk_fma_f32 v[42:43], v[90:91], v[42:43], v[58:59] op_sel:[1,1,0] op_sel_hi:[1,0,1] neg_lo:[1,0,0]
    v_pk_fma_f32 v[44:45], v[92:93], v[44:45], v[60:61] op_sel:[1,1,0] op_sel_hi:[1,0,1] neg_lo:[1,0,0]
    v_pk_fma_f32 v[46:47], v[94:95], v[46:47], v[62:63] op_sel:[1,1,0] op_sel_hi:[1,0,1] neg_lo:[1,0,0]
    v_accvgpr_read_b32 v48, a225
    v_accvgpr_read_b32 v50, a229
    v_accvgpr_read_b32 v52, a233
    v_accvgpr_read_b32 v54, a237
    v_accvgpr_read_b32 v49, a241
    v_accvgpr_read_b32 v51, a245
    v_accvgpr_read_b32 v53, a249
    v_accvgpr_read_b32 v55, a253
    v_pk_fma_f32 v[56:57], v[88:89], v[40:41], v[48:49] op_sel:[0,0,0] op_sel_hi:[0,1,1]
    v_pk_fma_f32 v[58:59], v[90:91], v[42:43], v[50:51] op_sel:[0,0,0] op_sel_hi:[0,1,1]
    v_pk_fma_f32 v[60:61], v[92:93], v[44:45], v[52:53] op_sel:[0,0,0] op_sel_hi:[0,1,1]
    v_pk_fma_f32 v[62:63], v[94:95], v[46:47], v[54:55] op_sel:[0,0,0] op_sel_hi:[0,1,1]
    v_pk_fma_f32 v[40:41], v[88:89], v[40:41], v[56:57] op_sel:[1,1,0] op_sel_hi:[1,0,1] neg_lo:[1,0,0]
    v_pk_fma_f32 v[42:43], v[90:91], v[42:43], v[58:59] op_sel:[1,1,0] op_sel_hi:[1,0,1] neg_lo:[1,0,0]
    v_pk_fma_f32 v[44:45], v[92:93], v[44:45], v[60:61] op_sel:[1,1,0] op_sel_hi:[1,0,1] neg_lo:[1,0,0]
    v_pk_fma_f32 v[46:47], v[94:95], v[46:47], v[62:63] op_sel:[1,1,0] op_sel_hi:[1,0,1] neg_lo:[1,0,0]
    v_accvgpr_read_b32 v64, a226
    v_accvgpr_read_b32 v66, a230
    v_accvgpr_read_b32 v68, a234
    v_accvgpr_read_b32 v70, a238
    v_accvgpr_read_b32 v65, a242
    v_accvgpr_read_b32 v67, a246
    v_accvgpr_read_b32 v69, a250
    v_accvgpr_read_b32 v71, a254
    v_pk_fma_f32 v[56:57], v[88:89], v[40:41], v[64:65] op_sel:[0,0,0] op_sel_hi:[0,1,1]
    v_pk_fma_f32 v[58:59], v[90:91], v[42:43], v[66:67] op_sel:[0,0,0] op_sel_hi:[0,1,1]
    v_pk_fma_f32 v[60:61], v[92:93], v[44:45], v[68:69] op_sel:[0,0,0] op_sel_hi:[0,1,1]
    v_pk_fma_f32 v[62:63], v[94:95], v[46:47], v[70:71] op_sel:[0,0,0] op_sel_hi:[0,1,1]
    v_pk_fma_f32 v[40:41], v[88:89], v[40:41], v[56:57] op_sel:[1,1,0] op_sel_hi:[1,0,1] neg_lo:[1,0,0]
    v_pk_fma_f32 v[42:43], v[90:91], v[42:43], v[58:59] op_sel:[1,1,0] op_sel_hi:[1,0,1] neg_lo:[1,0,0]
    v_pk_fma_f32 v[44:45], v[92:93], v[44:45], v[60:61] op_sel:[1,1,0] op_sel_hi:[1,0,1] neg_lo:[1,0,0]
    v_pk_fma_f32 v[46:47], v[94:95], v[46:47], v[62:63] op_sel:[1,1,0] op_sel_hi:[1,0,1] neg_lo:[1,0,0]
    v_accvgpr_read_b32 v48, a227
    v_accvgpr_read_b32 v50, a231
    v_accvgpr_read_b32 v52, a235
    v_accvgpr_read_b32 v54, a239
    v_accvgpr_read_b32 v49, a243
    v_accvgpr_read_b32 v51, a247
    v_accvgpr_read_b32 v53, a251
    v_accvgpr_read_b32 v55, a255
    v_pk_fma_f32 v[56:57], v[88:89], v[40:41], v[48:49] op_sel:[0,0,0] op_sel_hi:[0,1,1]
    v_pk_fma_f32 v[58:59], v[90:91], v[42:43], v[50:51] op_sel:[0,0,0] op_sel_hi:[0,1,1]
    v_pk_fma_f32 v[60:61], v[92:93], v[44:45], v[52:53] op_sel:[0,0,0] op_sel_hi:[0,1,1]
    v_pk_fma_f32 v[62:63], v[94:95], v[46:47], v[54:55] op_sel:[0,0,0] op_sel_hi:[0,1,1]
    v_pk_fma_f32 v[40:41], v[88:89], v[40:41], v[56:57] op_sel:[1,1,0] op_sel_hi:[1,0,1] neg_lo:[1,0,0]
    v_pk_fma_f32 v[42:43], v[90:91], v[42:43], v[58:59] op_sel:[1,1,0] op_sel_hi:[1,0,1] neg_lo:[1,0,0]
    v_pk_fma_f32 v[44:45], v[92:93], v[44:45], v[60:61] op_sel:[1,1,0] op_sel_hi:[1,0,1] neg_lo:[1,0,0]
    v_pk_fma_f32 v[46:47], v[94:95], v[46:47], v[62:63] op_sel:[1,1,0] op_sel_hi:[1,0,1] neg_lo:[1,0,0]
    v_mov_b32 v64, v40
    v_mov_b32 v72, v40
    v_mov_b32 v65, v41
    v_mov_b32 v73, v41
    v_mov_b32 v66, v42
    v_mov_b32 v74, v42
    v_mov_b32 v67, v43
    v_mov_b32 v75, v43
    v_mov_b32 v68, v44
    v_mov_b32 v76, v44
    v_mov_b32 v69, v45
    v_mov_b32 v77, v45
    v_mov_b32 v70, v46
    v_mov_b32 v78, v46
    v_mov_b32 v71, v47
    v_mov_b32 v79, v47
    s_nop 1
    v_permlane16_swap_b32 v64, v72
    v_permlane16_swap_b32 v65, v73
    v_permlane16_swap_b32 v66, v74
    v_permlane16_swap_b32 v67, v75
    v_permlane16_swap_b32 v68, v76
    v_permlane16_swap_b32 v69, v77
    v_permlane16_swap_b32 v70, v78
    v_permlane16_swap_b32 v71, v79
    v_pk_fma_f32 v[56:57], v[104:105], v[64:65], v[72:73] op_sel:[0,0,0] op_sel_hi:[0,1,1]
    v_pk_fma_f32 v[58:59], v[106:107], v[66:67], v[74:75] op_sel:[0,0,0] op_sel_hi:[0,1,1]
    v_pk_fma_f32 v[60:61], v[108:109], v[68:69], v[76:77] op_sel:[0,0,0] op_sel_hi:[0,1,1]
    v_pk_fma_f32 v[62:63], v[110:111], v[70:71], v[78:79] op_sel:[0,0,0] op_sel_hi:[0,1,1]
    v_pk_fma_f32 v[80:81], v[104:105], v[64:65], v[56:57] op_sel:[1,1,0] op_sel_hi:[1,0,1] neg_lo:[1,0,0]
    v_pk_fma_f32 v[82:83], v[106:107], v[66:67], v[58:59] op_sel:[1,1,0] op_sel_hi:[1,0,1] neg_lo:[1,0,0]
    v_pk_fma_f32 v[84:85], v[108:109], v[68:69], v[60:61] op_sel:[1,1,0] op_sel_hi:[1,0,1] neg_lo:[1,0,0]
    v_pk_fma_f32 v[86:87], v[110:111], v[70:71], v[62:63] op_sel:[1,1,0] op_sel_hi:[1,0,1] neg_lo:[1,0,0]
    v_mov_b32 v24, v80
    v_mov_b32 v25, v81
    v_mov_b32 v26, v82
    v_mov_b32 v27, v83
    v_mov_b32 v28, v84
    v_mov_b32 v29, v85
    v_mov_b32 v30, v86
    v_mov_b32 v31, v87
    s_nop 1
    v_permlane32_swap_b32 v80, v24
    v_permlane32_swap_b32 v81, v25
    v_permlane32_swap_b32 v82, v26
    v_permlane32_swap_b32 v83, v27
    v_permlane32_swap_b32 v84, v28
    v_permlane32_swap_b32 v85, v29
    v_permlane32_swap_b32 v86, v30
    v_permlane32_swap_b32 v87, v31
    v_pk_fma_f32 v[56:57], v[112:113], v[80:81], v[24:25] op_sel:[0,0,0] op_sel_hi:[0,1,1]
    v_pk_fma_f32 v[58:59], v[114:115], v[82:83], v[26:27] op_sel:[0,0,0] op_sel_hi:[0,1,1]
    v_pk_fma_f32 v[60:61], v[116:117], v[84:85], v[28:29] op_sel:[0,0,0] op_sel_hi:[0,1,1]
    v_pk_fma_f32 v[62:63], v[118:119], v[86:87], v[30:31] op_sel:[0,0,0] op_sel_hi:[0,1,1]
    v_pk_fma_f32 v[40:41], v[112:113], v[80:81], v[56:57] op_sel:[1,1,0] op_sel_hi:[1,0,1] neg_lo:[1,0,0]
    v_pk_fma_f32 v[42:43], v[114:115], v[82:83], v[58:59] op_sel:[1,1,0] op_sel_hi:[1,0,1] neg_lo:[1,0,0]
    v_pk_fma_f32 v[44:45], v[116:117], v[84:85], v[60:61] op_sel:[1,1,0] op_sel_hi:[1,0,1] neg_lo:[1,0,0]
    v_pk_fma_f32 v[46:47], v[118:119], v[86:87], v[62:63] op_sel:[1,1,0] op_sel_hi:[1,0,1] neg_lo:[1,0,0]
    s_mov_b32 exec_lo, 0xffffffff
    s_mov_b32 exec_hi, 0xffffffff
    v_mov_b32 v122, v40
    v_mov_b32 v123, v41
    s_mov_b32 exec_lo, 0xffff0000
    s_mov_b32 exec_hi, 0xffffffff
    v_mov_b32 v122, v42
    v_mov_b32 v123, v43
    s_mov_b32 exec_lo, 0x0
    s_mov_b32 exec_hi, 0xffffffff
    v_mov_b32 v122, v44
    v_mov_b32 v123, v45
    s_mov_b32 exec_lo, 0x0
    s_mov_b32 exec_hi, 0xffff0000
    v_mov_b32 v122, v46
    v_mov_b32 v123, v47
    s_mov_b64 exec, -1
    v_min_u32 v122, 0xfffffffe, v122
    v_min_u32 v123, 0xfffffffe, v123
    s_and_b32 s53, s58, 1
    s_lshl1_add_u32 s53, s85, s53
    s_lshl_b32 s53, s53, 13
    s_lshr_b32 s29, s58, 1
    s_lshl1_add_u32 s29, s82, s29
    s_lshl_b32 s29, s29, 9
    s_add_u32 s53, s53, s29
    v_lshrrev_b32 v124, 1, v1
    v_add_u32 v124, s53, v124
    s_add_u32 s60, s100, 0xb100000
    s_addc_u32 s61, s101, 0
    s_and_b32 s61, s61, 0xffff
    s_mov_b32 s62, 0x20000
    s_mov_b32 s63, 0x00020000
    buffer_store_dwordx2 v[122:123], v124, s[60:63], 0 offen sc1
    v_subrev_u32 v160, 8192, v124
    v_subrev_u32 v161, 16384, v124
    v_subrev_u32 v162, 24576, v124
    v_subrev_u32 v163, 32768, v124
    v_subrev_u32 v164, 40960, v124
    v_subrev_u32 v165, 49152, v124
    v_subrev_u32 v166, 57344, v124
    v_subrev_u32 v167, 65536, v124
    v_subrev_u32 v168, 73728, v124
    v_subrev_u32 v169, 81920, v124
    v_subrev_u32 v170, 90112, v124
    v_subrev_u32 v171, 98304, v124
    v_subrev_u32 v172, 106496, v124
    v_subrev_u32 v173, 114688, v124
    v_subrev_u32 v174, 122880, v124
    s_mov_b32 s53, 0
L_lb_74:
    buffer_load_dwordx2 v[128:129], v160, s[60:63], 0 offen sc1
    buffer_load_dwordx2 v[130:131], v161, s[60:63], 0 offen sc1
    buffer_load_dwordx2 v[132:133], v162, s[60:63], 0 offen sc1
    buffer_load_dwordx2 v[134:135], v163, s[60:63], 0 offen sc1
    buffer_load_dwordx2 v[136:137], v164, s[60:63], 0 offen sc1
    buffer_load_dwordx2 v[138:139], v165, s[60:63], 0 offen sc1
    buffer_load_dwordx2 v[140:141], v166, s[60:63], 0 offen sc1
    buffer_load_dwordx2 v[142:143], v167, s[60:63], 0 offen sc1
    buffer_load_dwordx2 v[144:145], v168, s[60:63], 0 offen sc1
    buffer_load_dwordx2 v[146:147], v169, s[60:63], 0 offen sc1
    buffer_load_dwordx2 v[148:149], v170, s[60:63], 0 offen sc1
    buffer_load_dwordx2 v[150:151], v171, s[60:63], 0 offen sc1
    buffer_load_dwordx2 v[152:153], v172, s[60:63], 0 offen sc1
    buffer_load_dwordx2 v[154:155], v173, s[60:63], 0 offen sc1
    buffer_load_dwordx2 v[156:157], v174, s[60:63], 0 offen sc1
    s_add_u32 s53, s53, 1
    s_cmp_gt_u32 s53, 0x200000
    s_cbranch_scc1 chain_kernel_wabort
    s_waitcnt vmcnt(0)
    v_max_u32 v56, v128, v129
    v_max3_u32 v56, v56, v130, v131
    v_max3_u32 v56, v56, v132, v133
    v_max3_u32 v56, v56, v134, v135
    v_max3_u32 v56, v56, v136, v137
    v_max3_u32 v56, v56, v138, v139
    v_max3_u32 v56, v56, v140, v141
    v_max3_u32 v56, v56, v142, v143
    v_max3_u32 v56, v56, v144, v145
    v_max3_u32 v56, v56, v146, v147
    v_max3_u32 v56, v56, v148, v149
    v_max3_u32 v56, v56, v150, v151
    v_max3_u32 v56, v56, v152, v153
    v_max3_u32 v56, v56, v154, v155
    v_max3_u32 v56, v56, v156, v157
    v_cmp_eq_u32 vcc, -1, v56
    s_cbranch_vccnz L_lb_74
    v_pk_fma_f32 v[56:57], v[120:121], v[156:157], v[154:155] op_sel:[0,0,0] op_sel_hi:[0,1,1]
    v_pk_fma_f32 v[154:155], v[120:121], v[156:157], v[56:57] op_sel:[1,1,0] op_sel_hi:[1,0,1] neg_lo:[1,0,0]
    v_pk_fma_f32 v[56:57], v[120:121], v[154:155], v[152:153] op_sel:[0,0,0] op_sel_hi:[0,1,1]
    v_pk_fma_f32 v[152:153], v[120:121], v[154:155], v[56:57] op_sel:[1,1,0] op_sel_hi:[1,0,1] neg_lo:[1,0,0]
    v_pk_fma_f32 v[56:57], v[120:121], v[152:153], v[150:151] op_sel:[0,0,0] op_sel_hi:[0,1,1]
    v_pk_fma_f32 v[150:151], v[120:121], v[152:153], v[56:57] op_sel:[1,1,0] op_sel_hi:[1,0,1] neg_lo:[1,0,0]
    v_pk_fma_f32 v[56:57], v[120:121], v[150:151], v[148:149] op_sel:[0,0,0] op_sel_hi:[0,1,1]
    v_pk_fma_f32 v[148:149], v[120:121], v[150:151], v[56:57] op_sel:[1,1,0] op_sel_hi:[1,0,1] neg_lo:[1,0,0]
    v_pk_fma_f32 v[56:57], v[120:121], v[148:149], v[146:147] op_sel:[0,0,0] op_sel_hi:[0,1,1]
    v_pk_fma_f32 v[146:147], v[120:121], v[148:149], v[56:57] op_sel:[1,1,0] op_sel_hi:[1,0,1] neg_lo:[1,0,0]
    v_pk_fma_f32 v[56:57], v[120:121], v[146:147], v[144:145] op_sel:[0,0,0] op_sel_hi:[0,1,1]
    v_pk_fma_f32 v[144:145], v[120:121], v[146:147], v[56:57] op_sel:[1,1,0] op_sel_hi:[1,0,1] neg_lo:[1,0,0]
    v_pk_fma_f32 v[56:57], v[120:121], v[144:145], v[142:143] op_sel:[0,0,0] op_sel_hi:[0,1,1]
    v_pk_fma_f32 v[142:143], v[120:121], v[144:145], v[56:57] op_sel:[1,1,0] op_sel_hi:[1,0,1] neg_lo:[1,0,0]
    v_pk_fma_f32 v[56:57], v[120:121], v[142:143], v[140:141] op_sel:[0,0,0] op_sel_hi:[0,1,1]
    v_pk_fma_f32 v[140:141], v[120:121], v[142:143], v[56:57] op_sel:[1,1,0] op_sel_hi:[1,0,1] neg_lo:[1,0,0]
    v_pk_fma_f32 v[56:57], v[120:121], v[140:141], v[138:139] op_sel:[0,0,0] op_sel_hi:[0,1,1]
    v_pk_fma_f32 v[138:139], v[120:121], v[140:141], v[56:57] op_sel:[1,1,0] op_sel_hi:[1,0,1] neg_lo:[1,0,0]
    v_pk_fma_f32 v[56:57], v[120:121], v[138:139], v[136:137] op_sel:[0,0,0] op_sel_hi:[0,1,1]
    v_pk_fma_f32 v[136:137], v[120:121], v[138:139], v[56:57] op_sel:[1,1,0] op_sel_hi:[1,0,1] neg_lo:[1,0,0]
    v_pk_fma_f32 v[56:57], v[120:121], v[136:137], v[134:135] op_sel:[0,0,0] op_sel_hi:[0,1,1]
    v_pk_fma_f32 v[134:135], v[120:121], v[136:137], v[56:57] op_sel:[1,1,0] op_sel_hi:[1,0,1] neg_lo:[1,0,0]
    v_pk_fma_f32 v[56:57], v[120:121], v[134:135], v[132:133] op_sel:[0,0,0] op_sel_hi:[0,1,1]
    v_pk_fma_f32 v[132:133], v[120:121], v[134:135], v[56:57] op_sel:[1,1,0] op_sel_hi:[1,0,1] neg_lo:[1,0,0]
    v_pk_fma_f32 v[56:57], v[120:121], v[132:133], v[130:131] op_sel:[0,0,0] op_sel_hi:[0,1,1]
    v_pk_fma_f32 v[130:131], v[120:121], v[132:133], v[56:57] op_sel:[1,1,0] op_sel_hi:[1,0,1] neg_lo:[1,0,0]
    v_pk_fma_f32 v[56:57], v[120:121], v[130:131], v[128:129] op_sel:[0,0,0] op_sel_hi:[0,1,1]
    v_pk_fma_f32 v[128:129], v[120:121], v[130:131], v[56:57] op_sel:[1,1,0] op_sel_hi:[1,0,1] neg_lo:[1,0,0]
    v_mov_b32 v32, v128
    v_mov_b32 v34, v128
    v_mov_b32 v33, v129
    v_mov_b32 v35, v129
    s_nop 1
    v_permlane16_swap_b32 v32, v34
    v_permlane16_swap_b32 v33, v35
    v_mov_b32 v36, v32
    v_mov_b32 v37, v33
    v_mov_b32 v38, v34
    v_mov_b32 v39, v35
    s_nop 1
    v_permlane32_swap_b32 v32, v36
    v_permlane32_swap_b32 v33, v37
    v_permlane32_swap_b32 v34, v38
    v_permlane32_swap_b32 v35, v39
    s_mov_b32 exec_lo, 0
    v_pk_fma_f32 v[56:57], v[112:113], v[32:33], v[80:81] op_sel:[0,0,0] op_sel_hi:[0,1,1]
    v_pk_fma_f32 v[58:59], v[114:115], v[34:35], v[82:83] op_sel:[0,0,0] op_sel_hi:[0,1,1]
    v_pk_fma_f32 v[60:61], v[116:117], v[36:37], v[84:85] op_sel:[0,0,0] op_sel_hi:[0,1,1]
    v_pk_fma_f32 v[62:63], v[118:119], v[38:39], v[86:87] op_sel:[0,0,0] op_sel_hi:[0,1,1]
    v_pk_fma_f32 v[32:33], v[112:113], v[32:33], v[56:57] op_sel:[1,1,0] op_sel_hi:[1,0,1] neg_lo:[1,0,0]
    v_pk_fma_f32 v[34:35], v[114:115], v[34:35], v[58:59] op_sel:[1,1,0] op_sel_hi:[1,0,1] neg_lo:[1,0,0]
    v_pk_fma_f32 v[36:37], v[116:117], v[36:37], v[60:61] op_sel:[1,1,0] op_sel_hi:[1,0,1] neg_lo:[1,0,0]
    v_pk_fma_f32 v[38:39], v[118:119], v[38:39], v[62:63] op_sel:[1,1,0] op_sel_hi:[1,0,1] neg_lo:[1,0,0]
    s_mov_b32 exec_lo, 0xffff0000
    s_mov_b32 exec_hi, 0xffff0000
    v_pk_fma_f32 v[56:57], v[104:105], v[32:33], v[64:65] op_sel:[0,0,0] op_sel_hi:[0,1,1]
    v_pk_fma_f32 v[58:59], v[106:107], v[34:35], v[66:67] op_sel:[0,0,0] op_sel_hi:[0,1,1]
    v_pk_fma_f32 v[60:61], v[108:109], v[36:37], v[68:69] op_sel:[0,0,0] op_sel_hi:[0,1,1]
    v_pk_fma_f32 v[62:63], v[110:111], v[38:39], v[70:71] op_sel:[0,0,0] op_sel_hi:[0,1,1]
    v_pk_fma_f32 v[32:33], v[104:105], v[32:33], v[56:57] op_sel:[1,1,0] op_sel_hi:[1,0,1] neg_lo:[1,0,0]
    v_pk_fma_f32 v[34:35], v[106:107], v[34:35], v[58:59] op_sel:[1,1,0] op_sel_hi:[1,0,1] neg_lo:[1,0,0]
    v_pk_fma_f32 v[36:37], v[108:109], v[36:37], v[60:61] op_sel:[1,1,0] op_sel_hi:[1,0,1] neg_lo:[1,0,0]
    v_pk_fma_f32 v[38:39], v[110:111], v[38:39], v[62:63] op_sel:[1,1,0] op_sel_hi:[1,0,1] neg_lo:[1,0,0]
    s_mov_b64 exec, -1
    v_accvgpr_read_b32 v64, a0
    v_accvgpr_read_b32 v66, a4
    v_accvgpr_read_b32 v68, a8
    v_accvgpr_read_b32 v70, a12
    v_accvgpr_read_b32 v65, a16
    v_accvgpr_read_b32 v67, a20
    v_accvgpr_read_b32 v69, a24
    v_accvgpr_read_b32 v71, a28
    v_pk_fma_f32 v[56:57], v[88:89], v[32:33], v[64:65] op_sel:[0,0,0] op_sel_hi:[0,1,1]
    v_pk_fma_f32 v[58:59], v[90:91], v[34:35], v[66:67] op_sel:[0,0,0] op_sel_hi:[0,1,1]
    v_pk_fma_f32 v[60:61], v[92:93], v[36:37], v[68:69] op_sel:[0,0,0] op_sel_hi:[0,1,1]
    v_pk_fma_f32 v[62:63], v[94:95], v[38:39], v[70:71] op_sel:[0,0,0] op_sel_hi:[0,1,1]
    v_pk_fma_f32 v[32:33], v[88:89], v[32:33], v[56:57] op_sel:[1,1,0] op_sel_hi:[1,0,1] neg_lo:[1,0,0]
    v_pk_fma_f32 v[34:35], v[90:91], v[34:35], v[58:59] op_sel:[1,1,0] op_sel_hi:[1,0,1] neg_lo:[1,0,0]
    v_pk_fma_f32 v[36:37], v[92:93], v[36:37], v[60:61] op_sel:[1,1,0] op_sel_hi:[1,0,1] neg_lo:[1,0,0]
    v_pk_fma_f32 v[38:39], v[94:95], v[38:39], v[62:63] op_sel:[1,1,0] op_sel_hi:[1,0,1] neg_lo:[1,0,0]
    v_pk_mul_f32 v[40:41], v[96:97], v[32:33] op_sel:[0,0] op_sel_hi:[0,1]
    v_pk_mul_f32 v[42:43], v[98:99], v[34:35] op_sel:[0,0] op_sel_hi:[0,1]
    v_pk_mul_f32 v[44:45], v[100:101], v[36:37] op_sel:[0,0] op_sel_hi:[0,1]
    v_pk_mul_f32 v[46:47], v[102:103], v[38:39] op_sel:[0,0] op_sel_hi:[0,1]
    v_pk_fma_f32 v[72:73], v[96:97], v[32:33], v[40:41] op_sel:[1,1,0] op_sel_hi:[1,0,1] neg_lo:[1,0,0] neg_hi:[1,0,1]
    v_pk_fma_f32 v[74:75], v[98:99], v[34:35], v[42:43] op_sel:[1,1,0] op_sel_hi:[1,0,1] neg_lo:[1,0,0] neg_hi:[1,0,1]
    v_pk_fma_f32 v[76:77], v[100:101], v[36:37], v[44:45] op_sel:[1,1,0] op_sel_hi:[1,0,1] neg_lo:[1,0,0] neg_hi:[1,0,1]
    v_pk_fma_f32 v[78:79], v[102:103], v[38:39], v[46:47] op_sel:[1,1,0] op_sel_hi:[1,0,1] neg_lo:[1,0,0] neg_hi:[1,0,1]
    v_accvgpr_read_b32 v48, a1
    v_accvgpr_read_b32 v50, a5
    v_accvgpr_read_b32 v52, a9
    v_accvgpr_read_b32 v54, a13
    v_accvgpr_read_b32 v49, a17
    v_accvgpr_read_b32 v51, a21
    v_accvgpr_read_b32 v53, a25
    v_accvgpr_read_b32 v55, a29
    v_pk_fma_f32 v[56:57], v[88:89], v[32:33], v[48:49] op_sel:[0,0,0] op_sel_hi:[0,1,1]
    v_pk_fma_f32 v[58:59], v[90:91], v[34:35], v[50:51] op_sel:[0,0,0] op_sel_hi:[0,1,1]
    v_pk_fma_f32 v[60:61], v[92:93], v[36:37], v[52:53] op_sel:[0,0,0] op_sel_hi:[0,1,1]
    v_pk_fma_f32 v[62:63], v[94:95], v[38:39], v[54:55] op_sel:[0,0,0] op_sel_hi:[0,1,1]
    v_pk_fma_f32 v[32:33], v[88:89], v[32:33], v[56:57] op_sel:[1,1,0] op_sel_hi:[1,0,1] neg_lo:[1,0,0]
    v_pk_fma_f32 v[34:35], v[90:91], v[34:35], v[58:59] op_sel:[1,1,0] op_sel_hi:[1,0,1] neg_lo:[1,0,0]
    v_pk_fma_f32 v[36:37], v[92:93], v[36:37], v[60:61] op_sel:[1,1,0] op_sel_hi:[1,0,1] neg_lo:[1,0,0]
    v_pk_fma_f32 v[38:39], v[94:95], v[38:39], v[62:63] op_sel:[1,1,0] op_sel_hi:[1,0,1] neg_lo:[1,0,0]
    v_pk_mul_f32 v[40:41], v[96:97], v[32:33] op_sel:[0,0] op_sel_hi:[0,1]
    v_pk_mul_f32 v[42:43], v[98:99], v[34:35] op_sel:[0,0] op_sel_hi:[0,1]
    v_pk_mul_f32 v[44:45], v[100:101], v[36:37] op_sel:[0,0] op_sel_hi:[0,1]
    v_pk_mul_f32 v[46:47], v[102:103], v[38:39] op_sel:[0,0] op_sel_hi:[0,1]
    v_pk_fma_f32 v[80:81], v[96:97], v[32:33], v[40:41] op_sel:[1,1,0] op_sel_hi:[1,0,1] neg_lo:[1,0,0] neg_hi:[1,0,1]
    v_pk_fma_f32 v[82:83], v[98:99], v[34:35], v[42:43] op_sel:[1,1,0] op_sel_hi:[1,0,1] neg_lo:[1,0,0] neg_hi:[1,0,1]
    v_pk_fma_f32 v[84:85], v[100:101], v[36:37], v[44:45] op_sel:[1,1,0] op_sel_hi:[1,0,1] neg_lo:[1,0,0] neg_hi:[1,0,1]
    v_pk_fma_f32 v[86:87], v[102:103], v[38:39], v[46:47] op_sel:[1,1,0] op_sel_hi:[1,0,1] neg_lo:[1,0,0] neg_hi:[1,0,1]
    v_cvt_pk_bf16_f32 v128, v72, v80
    v_cvt_pk_bf16_f32 v136, v74, v82
    v_cvt_pk_bf16_f32 v144, v76, v84
    v_cvt_pk_bf16_f32 v152, v78, v86
    v_cvt_pk_bf16_f32 v192, v73, v81
    v_cvt_pk_bf16_f32 v200, v75, v83
    v_cvt_pk_bf16_f32 v208, v77, v85
    v_cvt_pk_bf16_f32 v216, v79, v87
    v_accvgpr_read_b32 v64, a2
    v_accvgpr_read_b32 v66, a6
    v_accvgpr_read_b32 v68, a10
    v_accvgpr_read_b32 v70, a14
    v_accvgpr_read_b32 v65, a18
    v_accvgpr_read_b32 v67, a22
    v_accvgpr_read_b32 v69, a26
    v_accvgpr_read_b32 v71, a30
    v_pk_fma_f32 v[56:57], v[88:89], v[32:33], v[64:65] op_sel:[0,0,0] op_sel_hi:[0,1,1]
    v_pk_fma_f32 v[58:59], v[90:91], v[34:35], v[66:67] op_sel:[0,0,0] op_sel_hi:[0,1,1]
    v_pk_fma_f32 v[60:61], v[92:93], v[36:37], v[68:69] op_sel:[0,0,0] op_sel_hi:[0,1,1]
    v_pk_fma_f32 v[62:63], v[94:95], v[38:39], v[70:71] op_sel:[0,0,0] op_sel_hi:[0,1,1]
    v_pk_fma_f32 v[32:33], v[88:89], v[32:33], v[56:57] op_sel:[1,1,0] op_sel_hi:[1,0,1] neg_lo:[1,0,0]
    v_pk_fma_f32 v[34:35], v[90:91], v[34:35], v[58:59] op_sel:[1,1,0] op_sel_hi:[1,0,1] neg_lo:[1,0,0]
    v_pk_fma_f32 v[36:37], v[92:93], v[36:37], v[60:61] op_sel:[1,1,0] op_sel_hi:[1,0,1] neg_lo:[1,0,0]
    v_pk_fma_f32 v[38:39], v[94:95], v[38:39], v[62:63] op_sel:[1,1,0] op_sel_hi:[1,0,1] neg_lo:[1,0,0]
    v_pk_mul_f32 v[40:41], v[96:97], v[32:33] op_sel:[0,0] op_sel_hi:[0,1]
    v_pk_mul_f32 v[42:43], v[98:99], v[34:35] op_sel:[0,0] op_sel_hi:[0,1]
    v_pk_mul_f32 v[44:45], v[100:101], v[36:37] op_sel:[0,0] op_sel_hi:[0,1]
    v_pk_mul_f32 v[46:47], v[102:103], v[38:39] op_sel:[0,0] op_sel_hi:[0,1]
    v_pk_fma_f32 v[72:73], v[96:97], v[32:33], v[40:41] op_sel:[1,1,0] op_sel_hi:[1,0,1] neg_lo:[1,0,0] neg_hi:[1,0,1]
    v_pk_fma_f32 v[74:75], v[98:99], v[34:35], v[42:43] op_sel:[1,1,0] op_sel_hi:[1,0,1] neg_lo:[1,0,0] neg_hi:[1,0,1]
    v_pk_fma_f32 v[76:77], v[100:101], v[36:37], v[44:45] op_sel:[1,1,0] op_sel_hi:[1,0,1] neg_lo:[1,0,0] neg_hi:[1,0,1]
    v_pk_fma_f32 v[78:79], v[102:103], v[38:39], v[46:47] op_sel:[1,1,0] op_sel_hi:[1,0,1] neg_lo:[1,0,0] neg_hi:[1,0,1]
    v_accvgpr_read_b32 v48, a3
    v_accvgpr_read_b32 v50, a7
    v_accvgpr_read_b32 v52, a11
    v_accvgpr_read_b32 v54, a15
    v_accvgpr_read_b32 v49, a19
    v_accvgpr_read_b32 v51, a23
    v_accvgpr_read_b32 v53, a27
    v_accvgpr_read_b32 v55, a31
    v_pk_fma_f32 v[56:57], v[88:89], v[32:33], v[48:49] op_sel:[0,0,0] op_sel_hi:[0,1,1]
    v_pk_fma_f32 v[58:59], v[90:91], v[34:35], v[50:51] op_sel:[0,0,0] op_sel_hi:[0,1,1]
    v_pk_fma_f32 v[60:61], v[92:93], v[36:37], v[52:53] op_sel:[0,0,0] op_sel_hi:[0,1,1]
    v_pk_fma_f32 v[62:63], v[94:95], v[38:39], v[54:55] op_sel:[0,0,0] op_sel_hi:[0,1,1]
    v_pk_fma_f32 v[32:33], v[88:89], v[32:33], v[56:57] op_sel:[1,1,0] op_sel_hi:[1,0,1] neg_lo:[1,0,0]
    v_pk_fma_f32 v[34:35], v[90:91], v[34:35], v[58:59] op_sel:[1,1,0] op_sel_hi:[1,0,1] neg_lo:[1,0,0]
    v_pk_fma_f32 v[36:37], v[92:93], v[36:37], v[60:61] op_sel:[1,1,0] op_sel_hi:[1,0,1] neg_lo:[1,0,0]
    v_pk_fma_f32 v[38:39], v[94:95], v[38:39], v[62:63] op_sel:[1,1,0] op_sel_hi:[1,0,1] neg_lo:[1,0,0]
    v_pk_mul_f32 v[40:41], v[96:97], v[32:33] op_sel:[0,0] op_sel_hi:[0,1]
    v_pk_mul_f32 v[42:43], v[98:99], v[34:35] op_sel:[0,0] op_sel_hi:[0,1]
    v_pk_mul_f32 v[44:45], v[100:101], v[36:37] op_sel:[0,0] op_sel_hi:[0,1]
    v_pk_mul_f32 v[46:47], v[102:103], v[38:39] op_sel:[0,0] op_sel_hi:[0,1]
    v_pk_fma_f32 v[80:81], v[96:97], v[32:33], v[40:41] op_sel:[1,1,0] op_sel_hi:[1,0,1] neg_lo:[1,0,0] neg_hi:[1,0,1]
    v_pk_fma_f32 v[82:83], v[98:99], v[34:35], v[42:43] op_sel:[1,1,0] op_sel_hi:[1,0,1] neg_lo:[1,0,0] neg_hi:[1,0,1]
    v_pk_fma_f32 v[84:85], v[100:101], v[36:37], v[44:45] op_sel:[1,1,0] op_sel_hi:[1,0,1] neg_lo:[1,0,0] neg_hi:[1,0,1]
    v_pk_fma_f32 v[86:87], v[102:103], v[38:39], v[46:47] op_sel:[1,1,0] op_sel_hi:[1,0,1] neg_lo:[1,0,0] neg_hi:[1,0,1]
    v_cvt_pk_bf16_f32 v129, v72, v80
    v_cvt_pk_bf16_f32 v137, v74, v82
    v_cvt_pk_bf16_f32 v145, v76, v84
    v_cvt_pk_bf16_f32 v153, v78, v86
    v_cvt_pk_bf16_f32 v193, v73, v81
    v_cvt_pk_bf16_f32 v201, v75, v83
    v_cvt_pk_bf16_f32 v209, v77, v85
    v_cvt_pk_bf16_f32 v217, v79, v87
    v_accvgpr_read_b32 v64, a32
    v_accvgpr_read_b32 v66, a36
    v_accvgpr_read_b32 v68, a40
    v_accvgpr_read_b32 v70, a44
    v_accvgpr_read_b32 v65, a48
    v_accvgpr_read_b32 v67, a52
    v_accvgpr_read_b32 v69, a56
    v_accvgpr_read_b32 v71, a60
    v_pk_fma_f32 v[56:57], v[88:89], v[32:33], v[64:65] op_sel:[0,0,0] op_sel_hi:[0,1,1]
    v_pk_fma_f32 v[58:59], v[90:91], v[34:35], v[66:67] op_sel:[0,0,0] op_sel_hi:[0,1,1]
    v_pk_fma_f32 v[60:61], v[92:93], v[36:37], v[68:69] op_sel:[0,0,0] op_sel_hi:[0,1,1]
    v_pk_fma_f32 v[62:63], v[94:95], v[38:39], v[70:71] op_sel:[0,0,0] op_sel_hi:[0,1,1]
    v_pk_fma_f32 v[32:33], v[88:89], v[32:33], v[56:57] op_sel:[1,1,0] op_sel_hi:[1,0,1] neg_lo:[1,0,0]
    v_pk_fma_f32 v[34:35], v[90:91], v[34:35], v[58:59] op_sel:[1,1,0] op_sel_hi:[1,0,1] neg_lo:[1,0,0]
    v_pk_fma_f32 v[36:37], v[92:93], v[36:37], v[60:61] op_sel:[1,1,0] op_sel_hi:[1,0,1] neg_lo:[1,0,0]
    v_pk_fma_f32 v[38:39], v[94:95], v[38:39], v[62:63] op_sel:[1,1,0] op_sel_hi:[1,0,1] neg_lo:[1,0,0]
    v_pk_mul_f32 v[40:41], v[96:97], v[32:33] op_sel:[0,0] op_sel_hi:[0,1]
    v_pk_mul_f32 v[42:43], v[98:99], v[34:35] op_sel:[0,0] op_sel_hi:[0,1]
    v_pk_mul_f32 v[44:45], v[100:101], v[36:37] op_sel:[0,0] op_sel_hi:[0,1]
    v_pk_mul_f32 v[46:47], v[102:103], v[38:39] op_sel:[0,0] op_sel_hi:[0,1]
    v_pk_fma_f32 v[72:73], v[96:97], v[32:33], v[40:41] op_sel:[1,1,0] op_sel_hi:[1,0,1] neg_lo:[1,0,0] neg_hi:[1,0,1]
    v_pk_fma_f32 v[74:75], v[98:99], v[34:35], v[42:43] op_sel:[1,1,0] op_sel_hi:[1,0,1] neg_lo:[1,0,0] neg_hi:[1,0,1]
    v_pk_fma_f32 v[76:77], v[100:101], v[36:37], v[44:45] op_sel:[1,1,0] op_sel_hi:[1,0,1] neg_lo:[1,0,0] neg_hi:[1,0,1]
    v_pk_fma_f32 v[78:79], v[102:103], v[38:39], v[46:47] op_sel:[1,1,0] op_sel_hi:[1,0,1] neg_lo:[1,0,0] neg_hi:[1,0,1]
    v_accvgpr_read_b32 v48, a33
    v_accvgpr_read_b32 v50, a37
    v_accvgpr_read_b32 v52, a41
    v_accvgpr_read_b32 v54, a45
    v_accvgpr_read_b32 v49, a49
    v_accvgpr_read_b32 v51, a53
    v_accvgpr_read_b32 v53, a57
    v_accvgpr_read_b32 v55, a61
    v_pk_fma_f32 v[56:57], v[88:89], v[32:33], v[48:49] op_sel:[0,0,0] op_sel_hi:[0,1,1]
    v_pk_fma_f32 v[58:59], v[90:91], v[34:35], v[50:51] op_sel:[0,0,0] op_sel_hi:[0,1,1]
    v_pk_fma_f32 v[60:61], v[92:93], v[36:37], v[52:53] op_sel:[0,0,0] op_sel_hi:[0,1,1]
    v_pk_fma_f32 v[62:63], v[94:95], v[38:39], v[54:55] op_sel:[0,0,0] op_sel_hi:[0,1,1]
    v_pk_fma_f32 v[32:33], v[88:89], v[32:33], v[56:57] op_sel:[1,1,0] op_sel_hi:[1,0,1] neg_lo:[1,0,0]
    v_pk_fma_f32 v[34:35], v[90:91], v[34:35], v[58:59] op_sel:[1,1,0] op_sel_hi:[1,0,1] neg_lo:[1,0,0]
    v_pk_fma_f32 v[36:37], v[92:93], v[36:37], v[60:61] op_sel:[1,1,0] op_sel_hi:[1,0,1] neg_lo:[1,0,0]
    v_pk_fma_f32 v[38:39], v[94:95], v[38:39], v[62:63] op_sel:[1,1,0] op_sel_hi:[1,0,1] neg_lo:[1,0,0]
    v_pk_mul_f32 v[40:41], v[96:97], v[32:33] op_sel:[0,0] op_sel_hi:[0,1]
    v_pk_mul_f32 v[42:43], v[98:99], v[34:35] op_sel:[0,0] op_sel_hi:[0,1]
    v_pk_mul_f32 v[44:45], v[100:101], v[36:37] op_sel:[0,0] op_sel_hi:[0,1]
    v_pk_mul_f32 v[46:47], v[102:103], v[38:39] op_sel:[0,0] op_sel_hi:[0,1]
    v_pk_fma_f32 v[80:81], v[96:97], v[32:33], v[40:41] op_sel:[1,1,0] op_sel_hi:[1,0,1] neg_lo:[1,0,0] neg_hi:[1,0,1]
    v_pk_fma_f32 v[82:83], v[98:99], v[34:35], v[42:43] op_sel:[1,1,0] op_sel_hi:[1,0,1] neg_lo:[1,0,0] neg_hi:[1,0,1]
    v_pk_fma_f32 v[84:85], v[100:101], v[36:37], v[44:45] op_sel:[1,1,0] op_sel_hi:[1,0,1] neg_lo:[1,0,0] neg_hi:[1,0,1]
    v_pk_fma_f32 v[86:87], v[102:103], v[38:39], v[46:47] op_sel:[1,1,0] op_sel_hi:[1,0,1] neg_lo:[1,0,0] neg_hi:[1,0,1]
    v_cvt_pk_bf16_f32 v130, v72, v80
    v_cvt_pk_bf16_f32 v138, v74, v82
    v_cvt_pk_bf16_f32 v146, v76, v84
    v_cvt_pk_bf16_f32 v154, v78, v86
    v_cvt_pk_bf16_f32 v194, v73, v81
    v_cvt_pk_bf16_f32 v202, v75, v83
    v_cvt_pk_bf16_f32 v210, v77, v85
    v_cvt_pk_bf16_f32 v218, v79, v87
    v_accvgpr_read_b32 v64, a34
    v_accvgpr_read_b32 v66, a38
    v_accvgpr_read_b32 v68, a42
    v_accvgpr_read_b32 v70, a46
    v_accvgpr_read_b32 v65, a50
    v_accvgpr_read_b32 v67, a54
    v_accvgpr_read_b32 v69, a58
    v_accvgpr_read_b32 v71, a62
    v_pk_fma_f32 v[56:57], v[88:89], v[32:33], v[64:65] op_sel:[0,0,0] op_sel_hi:[0,1,1]
    v_pk_fma_f32 v[58:59], v[90:91], v[34:35], v[66:67] op_sel:[0,0,0] op_sel_hi:[0,1,1]
    v_pk_fma_f32 v[60:61], v[92:93], v[36:37], v[68:69] op_sel:[0,0,0] op_sel_hi:[0,1,1]
    v_pk_fma_f32 v[62:63], v[94:95], v[38:39], v[70:71] op_sel:[0,0,0] op_sel_hi:[0,1,1]
    v_pk_fma_f32 v[32:33], v[88:89], v[32:33], v[56:57] op_sel:[1,1,0] op_sel_hi:[1,0,1] neg_lo:[1,0,0]
    v_pk_fma_f32 v[34:35], v[90:91], v[34:35], v[58:59] op_sel:[1,1,0] op_sel_hi:[1,0,1] neg_lo:[1,0,0]
    v_pk_fma_f32 v[36:37], v[92:93], v[36:37], v[60:61] op_sel:[1,1,0] op_sel_hi:[1,0,1] neg_lo:[1,0,0]
    v_pk_fma_f32 v[38:39], v[94:95], v[38:39], v[62:63] op_sel:[1,1,0] op_sel_hi:[1,0,1] neg_lo:[1,0,0]
    v_pk_mul_f32 v[40:41], v[96:97], v[32:33] op_sel:[0,0] op_sel_hi:[0,1]
    v_pk_mul_f32 v[42:43], v[98:99], v[34:35] op_sel:[0,0] op_sel_hi:[0,1]
    v_pk_mul_f32 v[44:45], v[100:101], v[36:37] op_sel:[0,0] op_sel_hi:[0,1]
    v_pk_mul_f32 v[46:47], v[102:103], v[38:39] op_sel:[0,0] op_sel_hi:[0,1]
    v_pk_fma_f32 v[72:73], v[96:97], v[32:33], v[40:41] op_sel:[1,1,0] op_sel_hi:[1,0,1] neg_lo:[1,0,0] neg_hi:[1,0,1]
    v_pk_fma_f32 v[74:75], v[98:99], v[34:35], v[42:43] op_sel:[1,1,0] op_sel_hi:[1,0,1] neg_lo:[1,0,0] neg_hi:[1,0,1]
    v_pk_fma_f32 v[76:77], v[100:101], v[36:37], v[44:45] op_sel:[1,1,0] op_sel_hi:[1,0,1] neg_lo:[1,0,0] neg_hi:[1,0,1]
    v_pk_fma_f32 v[78:79], v[102:103], v[38:39], v[46:47] op_sel:[1,1,0] op_sel_hi:[1,0,1] neg_lo:[1,0,0] neg_hi:[1,0,1]
    v_accvgpr_read_b32 v48, a35
    v_accvgpr_read_b32 v50, a39
    v_accvgpr_read_b32 v52, a43
    v_accvgpr_read_b32 v54, a47
    v_accvgpr_read_b32 v49, a51
    v_accvgpr_read_b32 v51, a55
    v_accvgpr_read_b32 v53, a59
    v_accvgpr_read_b32 v55, a63
    v_pk_fma_f32 v[56:57], v[88:89], v[32:33], v[48:49] op_sel:[0,0,0] op_sel_hi:[0,1,1]
    v_pk_fma_f32 v[58:59], v[90:91], v[34:35], v[50:51] op_sel:[0,0,0] op_sel_hi:[0,1,1]
    v_pk_fma_f32 v[60:61], v[92:93], v[36:37], v[52:53] op_sel:[0,0,0] op_sel_hi:[0,1,1]
    v_pk_fma_f32 v[62:63], v[94:95], v[38:39], v[54:55] op_sel:[0,0,0] op_sel_hi:[0,1,1]
    v_pk_fma_f32 v[32:33], v[88:89], v[32:33], v[56:57] op_sel:[1,1,0] op_sel_hi:[1,0,1] neg_lo:[1,0,0]
    v_pk_fma_f32 v[34:35], v[90:91], v[34:35], v[58:59] op_sel:[1,1,0] op_sel_hi:[1,0,1] neg_lo:[1,0,0]
    v_pk_fma_f32 v[36:37], v[92:93], v[36:37], v[60:61] op_sel:[1,1,0] op_sel_hi:[1,0,1] neg_lo:[1,0,0]
    v_pk_fma_f32 v[38:39], v[94:95], v[38:39], v[62:63] op_sel:[1,1,0] op_sel_hi:[1,0,1] neg_lo:[1,0,0]
    v_pk_mul_f32 v[40:41], v[96:97], v[32:33] op_sel:[0,0] op_sel_hi:[0,1]
    v_pk_mul_f32 v[42:43], v[98:99], v[34:35] op_sel:[0,0] op_sel_hi:[0,1]
    v_pk_mul_f32 v[44:45], v[100:101], v[36:37] op_sel:[0,0] op_sel_hi:[0,1]
    v_pk_mul_f32 v[46:47], v[102:103], v[38:39] op_sel:[0,0] op_sel_hi:[0,1]
    v_pk_fma_f32 v[80:81], v[96:97], v[32:33], v[40:41] op_sel:[1,1,0] op_sel_hi:[1,0,1] neg_lo:[1,0,0] neg_hi:[1,0,1]
    v_pk_fma_f32 v[82:83], v[98:99], v[34:35], v[42:43] op_sel:[1,1,0] op_sel_hi:[1,0,1] neg_lo:[1,0,0] neg_hi:[1,0,1]
    v_pk_fma_f32 v[84:85], v[100:101], v[36:37], v[44:45] op_sel:[1,1,0] op_sel_hi:[1,0,1] neg_lo:[1,0,0] neg_hi:[1,0,1]
    v_pk_fma_f32 v[86:87], v[102:103], v[38:39], v[46:47] op_sel:[1,1,0] op_sel_hi:[1,0,1] neg_lo:[1,0,0] neg_hi:[1,0,1]
    v_cvt_pk_bf16_f32 v131, v72, v80
    v_cvt_pk_bf16_f32 v139, v74, v82
    v_cvt_pk_bf16_f32 v147, v76, v84
    v_cvt_pk_bf16_f32 v155, v78, v86
    v_cvt_pk_bf16_f32 v195, v73, v81
    v_cvt_pk_bf16_f32 v203, v75, v83
    v_cvt_pk_bf16_f32 v211, v77, v85
    v_cvt_pk_bf16_f32 v219, v79, v87
    v_accvgpr_read_b32 v64, a64
    v_accvgpr_read_b32 v66, a68
    v_accvgpr_read_b32 v68, a72
    v_accvgpr_read_b32 v70, a76
    v_accvgpr_read_b32 v65, a80
    v_accvgpr_read_b32 v67, a84
    v_accvgpr_read_b32 v69, a88
    v_accvgpr_read_b32 v71, a92
    v_pk_fma_f32 v[56:57], v[88:89], v[32:33], v[64:65] op_sel:[0,0,0] op_sel_hi:[0,1,1]
    v_pk_fma_f32 v[58:59], v[90:91], v[34:35], v[66:67] op_sel:[0,0,0] op_sel_hi:[0,1,1]
    v_pk_fma_f32 v[60:61], v[92:93], v[36:37], v[68:69] op_sel:[0,0,0] op_sel_hi:[0,1,1]
    v_pk_fma_f32 v[62:63], v[94:95], v[38:39], v[70:71] op_sel:[0,0,0] op_sel_hi:[0,1,1]
    v_pk_fma_f32 v[32:33], v[88:89], v[32:33], v[56:57] op_sel:[1,1,0] op_sel_hi:[1,0,1] neg_lo:[1,0,0]
    v_pk_fma_f32 v[34:35], v[90:91], v[34:35], v[58:59] op_sel:[1,1,0] op_sel_hi:[1,0,1] neg_lo:[1,0,0]
    v_pk_fma_f32 v[36:37], v[92:93], v[36:37], v[60:61] op_sel:[1,1,0] op_sel_hi:[1,0,1] neg_lo:[1,0,0]
    v_pk_fma_f32 v[38:39], v[94:95], v[38:39], v[62:63] op_sel:[1,1,0] op_sel_hi:[1,0,1] neg_lo:[1,0,0]
    v_pk_mul_f32 v[40:41], v[96:97], v[32:33] op_sel:[0,0] op_sel_hi:[0,1]
    v_pk_mul_f32 v[42:43], v[98:99], v[34:35] op_sel:[0,0] op_sel_hi:[0,1]
    v_pk_mul_f32 v[44:45], v[100:101], v[36:37] op_sel:[0,0] op_sel_hi:[0,1]
    v_pk_mul_f32 v[46:47], v[102:103], v[38:39] op_sel:[0,0] op_sel_hi:[0,1]
    v_pk_fma_f32 v[72:73], v[96:97], v[32:33], v[40:41] op_sel:[1,1,0] op_sel_hi:[1,0,1] neg_lo:[1,0,0] neg_hi:[1,0,1]
    v_pk_fma_f32 v[74:75], v[98:99], v[34:35], v[42:43] op_sel:[1,1,0] op_sel_hi:[1,0,1] neg_lo:[1,0,0] neg_hi:[1,0,1]
    v_pk_fma_f32 v[76:77], v[100:101], v[36:37], v[44:45] op_sel:[1,1,0] op_sel_hi:[1,0,1] neg_lo:[1,0,0] neg_hi:[1,0,1]
    v_pk_fma_f32 v[78:79], v[102:103], v[38:39], v[46:47] op_sel:[1,1,0] op_sel_hi:[1,0,1] neg_lo:[1,0,0] neg_hi:[1,0,1]
    v_accvgpr_read_b32 v48, a65
    v_accvgpr_read_b32 v50, a69
    v_accvgpr_read_b32 v52, a73
    v_accvgpr_read_b32 v54, a77
    v_accvgpr_read_b32 v49, a81
    v_accvgpr_read_b32 v51, a85
    v_accvgpr_read_b32 v53, a89
    v_accvgpr_read_b32 v55, a93
    v_pk_fma_f32 v[56:57], v[88:89], v[32:33], v[48:49] op_sel:[0,0,0] op_sel_hi:[0,1,1]
    v_pk_fma_f32 v[58:59], v[90:91], v[34:35], v[50:51] op_sel:[0,0,0] op_sel_hi:[0,1,1]
    v_pk_fma_f32 v[60:61], v[92:93], v[36:37], v[52:53] op_sel:[0,0,0] op_sel_hi:[0,1,1]
    v_pk_fma_f32 v[62:63], v[94:95], v[38:39], v[54:55] op_sel:[0,0,0] op_sel_hi:[0,1,1]
    v_pk_fma_f32 v[32:33], v[88:89], v[32:33], v[56:57] op_sel:[1,1,0] op_sel_hi:[1,0,1] neg_lo:[1,0,0]
    v_pk_fma_f32 v[34:35], v[90:91], v[34:35], v[58:59] op_sel:[1,1,0] op_sel_hi:[1,0,1] neg_lo:[1,0,0]
    v_pk_fma_f32 v[36:37], v[92:93], v[36:37], v[60:61] op_sel:[1,1,0] op_sel_hi:[1,0,1] neg_lo:[1,0,0]
    v_pk_fma_f32 v[38:39], v[94:95], v[38:39], v[62:63] op_sel:[1,1,0] op_sel_hi:[1,0,1] neg_lo:[1,0,0]
    v_pk_mul_f32 v[40:41], v[96:97], v[32:33] op_sel:[0,0] op_sel_hi:[0,1]
    v_pk_mul_f32 v[42:43], v[98:99], v[34:35] op_sel:[0,0] op_sel_hi:[0,1]
    v_pk_mul_f32 v[44:45], v[100:101], v[36:37] op_sel:[0,0] op_sel_hi:[0,1]
    v_pk_mul_f32 v[46:47], v[102:103], v[38:39] op_sel:[0,0] op_sel_hi:[0,1]
    v_pk_fma_f32 v[80:81], v[96:97], v[32:33], v[40:41] op_sel:[1,1,0] op_sel_hi:[1,0,1] neg_lo:[1,0,0] neg_hi:[1,0,1]
    v_pk_fma_f32 v[82:83], v[98:99], v[34:35], v[42:43] op_sel:[1,1,0] op_sel_hi:[1,0,1] neg_lo:[1,0,0] neg_hi:[1,0,1]
    v_pk_fma_f32 v[84:85], v[100:101], v[36:37], v[44:45] op_sel:[1,1,0] op_sel_hi:[1,0,1] neg_lo:[1,0,0] neg_hi:[1,0,1]
    v_pk_fma_f32 v[86:87], v[102:103], v[38:39], v[46:47] op_sel:[1,1,0] op_sel_hi:[1,0,1] neg_lo:[1,0,0] neg_hi:[1,0,1]
    v_cvt_pk_bf16_f32 v132, v72, v80
    v_cvt_pk_bf16_f32 v140, v74, v82
    v_cvt_pk_bf16_f32 v148, v76, v84
    v_cvt_pk_bf16_f32 v156, v78, v86
    v_cvt_pk_bf16_f32 v196, v73, v81
    v_cvt_pk_bf16_f32 v204, v75, v83
    v_cvt_pk_bf16_f32 v212, v77, v85
    v_cvt_pk_bf16_f32 v220, v79, v87
    v_accvgpr_read_b32 v64, a66
    v_accvgpr_read_b32 v66, a70
    v_accvgpr_read_b32 v68, a74
    v_accvgpr_read_b32 v70, a78
    v_accvgpr_read_b32 v65, a82
    v_accvgpr_read_b32 v67, a86
    v_accvgpr_read_b32 v69, a90
    v_accvgpr_read_b32 v71, a94
    v_pk_fma_f32 v[56:57], v[88:89], v[32:33], v[64:65] op_sel:[0,0,0] op_sel_hi:[0,1,1]
    v_pk_fma_f32 v[58:59], v[90:91], v[34:35], v[66:67] op_sel:[0,0,0] op_sel_hi:[0,1,1]
    v_pk_fma_f32 v[60:61], v[92:93], v[36:37], v[68:69] op_sel:[0,0,0] op_sel_hi:[0,1,1]
    v_pk_fma_f32 v[62:63], v[94:95], v[38:39], v[70:71] op_sel:[0,0,0] op_sel_hi:[0,1,1]
    v_pk_fma_f32 v[32:33], v[88:89], v[32:33], v[56:57] op_sel:[1,1,0] op_sel_hi:[1,0,1] neg_lo:[1,0,0]
    v_pk_fma_f32 v[34:35], v[90:91], v[34:35], v[58:59] op_sel:[1,1,0] op_sel_hi:[1,0,1] neg_lo:[1,0,0]
    v_pk_fma_f32 v[36:37], v[92:93], v[36:37], v[60:61] op_sel:[1,1,0] op_sel_hi:[1,0,1] neg_lo:[1,0,0]
    v_pk_fma_f32 v[38:39], v[94:95], v[38:39], v[62:63] op_sel:[1,1,0] op_sel_hi:[1,0,1] neg_lo:[1,0,0]
    v_pk_mul_f32 v[40:41], v[96:97], v[32:33] op_sel:[0,0] op_sel_hi:[0,1]
    v_pk_mul_f32 v[42:43], v[98:99], v[34:35] op_sel:[0,0] op_sel_hi:[0,1]
    v_pk_mul_f32 v[44:45], v[100:101], v[36:37] op_sel:[0,0] op_sel_hi:[0,1]
    v_pk_mul_f32 v[46:47], v[102:103], v[38:39] op_sel:[0,0] op_sel_hi:[0,1]
    v_pk_fma_f32 v[72:73], v[96:97], v[32:33], v[40:41] op_sel:[1,1,0] op_sel_hi:[1,0,1] neg_lo:[1,0,0] neg_hi:[1,0,1]
    v_pk_fma_f32 v[74:75], v[98:99], v[34:35], v[42:43] op_sel:[1,1,0] op_sel_hi:[1,0,1] neg_lo:[1,0,0] neg_hi:[1,0,1]
    v_pk_fma_f32 v[76:77], v[100:101], v[36:37], v[44:45] op_sel:[1,1,0] op_sel_hi:[1,0,1] neg_lo:[1,0,0] neg_hi:[1,0,1]
    v_pk_fma_f32 v[78:79], v[102:103], v[38:39], v[46:47] op_sel:[1,1,0] op_sel_hi:[1,0,1] neg_lo:[1,0,0] neg_hi:[1,0,1]
    v_accvgpr_read_b32 v48, a67
    v_accvgpr_read_b32 v50, a71
    v_accvgpr_read_b32 v52, a75
    v_accvgpr_read_b32 v54, a79
    v_accvgpr_read_b32 v49, a83
    v_accvgpr_read_b32 v51, a87
    v_accvgpr_read_b32 v53, a91
    v_accvgpr_read_b32 v55, a95
    v_pk_fma_f32 v[56:57], v[88:89], v[32:33], v[48:49] op_sel:[0,0,0] op_sel_hi:[0,1,1]
    v_pk_fma_f32 v[58:59], v[90:91], v[34:35], v[50:51] op_sel:[0,0,0] op_sel_hi:[0,1,1]
    v_pk_fma_f32 v[60:61], v[92:93], v[36:37], v[52:53] op_sel:[0,0,0] op_sel_hi:[0,1,1]
    v_pk_fma_f32 v[62:63], v[94:95], v[38:39], v[54:55] op_sel:[0,0,0] op_sel_hi:[0,1,1]
    v_pk_fma_f32 v[32:33], v[88:89], v[32:33], v[56:57] op_sel:[1,1,0] op_sel_hi:[1,0,1] neg_lo:[1,0,0]
    v_pk_fma_f32 v[34:35], v[90:91], v[34:35], v[58:59] op_sel:[1,1,0] op_sel_hi:[1,0,1] neg_lo:[1,0,0]
    v_pk_fma_f32 v[36:37], v[92:93], v[36:37], v[60:61] op_sel:[1,1,0] op_sel_hi:[1,0,1] neg_lo:[1,0,0]
    v_pk_fma_f32 v[38:39], v[94:95], v[38:39], v[62:63] op_sel:[1,1,0] op_sel_hi:[1,0,1] neg_lo:[1,0,0]
    v_pk_mul_f32 v[40:41], v[96:97], v[32:33] op_sel:[0,0] op_sel_hi:[0,1]
    v_pk_mul_f32 v[42:43], v[98:99], v[34:35] op_sel:[0,0] op_sel_hi:[0,1]
    v_pk_mul_f32 v[44:45], v[100:101], v[36:37] op_sel:[0,0] op_sel_hi:[0,1]
    v_pk_mul_f32 v[46:47], v[102:103], v[38:39] op_sel:[0,0] op_sel_hi:[0,1]
    v_pk_fma_f32 v[80:81], v[96:97], v[32:33], v[40:41] op_sel:[1,1,0] op_sel_hi:[1,0,1] neg_lo:[1,0,0] neg_hi:[1,0,1]
    v_pk_fma_f32 v[82:83], v[98:99], v[34:35], v[42:43] op_sel:[1,1,0] op_sel_hi:[1,0,1] neg_lo:[1,0,0] neg_hi:[1,0,1]
    v_pk_fma_f32 v[84:85], v[100:101], v[36:37], v[44:45] op_sel:[1,1,0] op_sel_hi:[1,0,1] neg_lo:[1,0,0] neg_hi:[1,0,1]
    v_pk_fma_f32 v[86:87], v[102:103], v[38:39], v[46:47] op_sel:[1,1,0] op_sel_hi:[1,0,1] neg_lo:[1,0,0] neg_hi:[1,0,1]
    v_cvt_pk_bf16_f32 v133, v72, v80
    v_cvt_pk_bf16_f32 v141, v74, v82
    v_cvt_pk_bf16_f32 v149, v76, v84
    v_cvt_pk_bf16_f32 v157, v78, v86
    v_cvt_pk_bf16_f32 v197, v73, v81
    v_cvt_pk_bf16_f32 v205, v75, v83
    v_cvt_pk_bf16_f32 v213, v77, v85
    v_cvt_pk_bf16_f32 v221, v79, v87
    v_accvgpr_read_b32 v64, a96
    v_accvgpr_read_b32 v66, a100
    v_accvgpr_read_b32 v68, a104
    v_accvgpr_read_b32 v70, a108
    v_accvgpr_read_b32 v65, a112
    v_accvgpr_read_b32 v67, a116
    v_accvgpr_read_b32 v69, a120
    v_accvgpr_read_b32 v71, a124
    v_pk_fma_f32 v[56:57], v[88:89], v[32:33], v[64:65] op_sel:[0,0,0] op_sel_hi:[0,1,1]
    v_pk_fma_f32 v[58:59], v[90:91], v[34:35], v[66:67] op_sel:[0,0,0] op_sel_hi:[0,1,1]
    v_pk_fma_f32 v[60:61], v[92:93], v[36:37], v[68:69] op_sel:[0,0,0] op_sel_hi:[0,1,1]
    v_pk_fma_f32 v[62:63], v[94:95], v[38:39], v[70:71] op_sel:[0,0,0] op_sel_hi:[0,1,1]
    v_pk_fma_f32 v[32:33], v[88:89], v[32:33], v[56:57] op_sel:[1,1,0] op_sel_hi:[1,0,1] neg_lo:[1,0,0]
    v_pk_fma_f32 v[34:35], v[90:91], v[34:35], v[58:59] op_sel:[1,1,0] op_sel_hi:[1,0,1] neg_lo:[1,0,0]
    v_pk_fma_f32 v[36:37], v[92:93], v[36:37], v[60:61] op_sel:[1,1,0] op_sel_hi:[1,0,1] neg_lo:[1,0,0]
    v_pk_fma_f32 v[38:39], v[94:95], v[38:39], v[62:63] op_sel:[1,1,0] op_sel_hi:[1,0,1] neg_lo:[1,0,0]
    v_pk_mul_f32 v[40:41], v[96:97], v[32:33] op_sel:[0,0] op_sel_hi:[0,1]
    v_pk_mul_f32 v[42:43], v[98:99], v[34:35] op_sel:[0,0] op_sel_hi:[0,1]
    v_pk_mul_f32 v[44:45], v[100:101], v[36:37] op_sel:[0,0] op_sel_hi:[0,1]
    v_pk_mul_f32 v[46:47], v[102:103], v[38:39] op_sel:[0,0] op_sel_hi:[0,1]
    v_pk_fma_f32 v[72:73], v[96:97], v[32:33], v[40:41] op_sel:[1,1,0] op_sel_hi:[1,0,1] neg_lo:[1,0,0] neg_hi:[1,0,1]
    v_pk_fma_f32 v[74:75], v[98:99], v[34:35], v[42:43] op_sel:[1,1,0] op_sel_hi:[1,0,1] neg_lo:[1,0,0] neg_hi:[1,0,1]
    v_pk_fma_f32 v[76:77], v[100:101], v[36:37], v[44:45] op_sel:[1,1,0] op_sel_hi:[1,0,1] neg_lo:[1,0,0] neg_hi:[1,0,1]
    v_pk_fma_f32 v[78:79], v[102:103], v[38:39], v[46:47] op_sel:[1,1,0] op_sel_hi:[1,0,1] neg_lo:[1,0,0] neg_hi:[1,0,1]
    v_accvgpr_read_b32 v48, a97
    v_accvgpr_read_b32 v50, a101
    v_accvgpr_read_b32 v52, a105
    v_accvgpr_read_b32 v54, a109
    v_accvgpr_read_b32 v49, a113
    v_accvgpr_read_b32 v51, a117
    v_accvgpr_read_b32 v53, a121
    v_accvgpr_read_b32 v55, a125
    v_pk_fma_f32 v[56:57], v[88:89], v[32:33], v[48:49] op_sel:[0,0,0] op_sel_hi:[0,1,1]
    v_pk_fma_f32 v[58:59], v[90:91], v[34:35], v[50:51] op_sel:[0,0,0] op_sel_hi:[0,1,1]
    v_pk_fma_f32 v[60:61], v[92:93], v[36:37], v[52:53] op_sel:[0,0,0] op_sel_hi:[0,1,1]
    v_pk_fma_f32 v[62:63], v[94:95], v[38:39], v[54:55] op_sel:[0,0,0] op_sel_hi:[0,1,1]
    v_pk_fma_f32 v[32:33], v[88:89], v[32:33], v[56:57] op_sel:[1,1,0] op_sel_hi:[1,0,1] neg_lo:[1,0,0]
    v_pk_fma_f32 v[34:35], v[90:91], v[34:35], v[58:59] op_sel:[1,1,0] op_sel_hi:[1,0,1] neg_lo:[1,0,0]
    v_pk_fma_f32 v[36:37], v[92:93], v[36:37], v[60:61] op_sel:[1,1,0] op_sel_hi:[1,0,1] neg_lo:[1,0,0]
    v_pk_fma_f32 v[38:39], v[94:95], v[38:39], v[62:63] op_sel:[1,1,0] op_sel_hi:[1,0,1] neg_lo:[1,0,0]
    v_pk_mul_f32 v[40:41], v[96:97], v[32:33] op_sel:[0,0] op_sel_hi:[0,1]
    v_pk_mul_f32 v[42:43], v[98:99], v[34:35] op_sel:[0,0] op_sel_hi:[0,1]
    v_pk_mul_f32 v[44:45], v[100:101], v[36:37] op_sel:[0,0] op_sel_hi:[0,1]
    v_pk_mul_f32 v[46:47], v[102:103], v[38:39] op_sel:[0,0] op_sel_hi:[0,1]
    v_pk_fma_f32 v[80:81], v[96:97], v[32:33], v[40:41] op_sel:[1,1,0] op_sel_hi:[1,0,1] neg_lo:[1,0,0] neg_hi:[1,0,1]
    v_pk_fma_f32 v[82:83], v[98:99], v[34:35], v[42:43] op_sel:[1,1,0] op_sel_hi:[1,0,1] neg_lo:[1,0,0] neg_hi:[1,0,1]
    v_pk_fma_f32 v[84:85], v[100:101], v[36:37], v[44:45] op_sel:[1,1,0] op_sel_hi:[1,0,1] neg_lo:[1,0,0] neg_hi:[1,0,1]
    v_pk_fma_f32 v[86:87], v[102:103], v[38:39], v[46:47] op_sel:[1,1,0] op_sel_hi:[1,0,1] neg_lo:[1,0,0] neg_hi:[1,0,1]
    v_cvt_pk_bf16_f32 v134, v72, v80
    v_cvt_pk_bf16_f32 v142, v74, v82
    v_cvt_pk_bf16_f32 v150, v76, v84
    v_cvt_pk_bf16_f32 v158, v78, v86
    v_cvt_pk_bf16_f32 v198, v73, v81
    v_cvt_pk_bf16_f32 v206, v75, v83
    v_cvt_pk_bf16_f32 v214, v77, v85
    v_cvt_pk_bf16_f32 v222, v79, v87
    v_accvgpr_read_b32 v64, a98
    v_accvgpr_read_b32 v66, a102
    v_accvgpr_read_b32 v68, a106
    v_accvgpr_read_b32 v70, a110
    v_accvgpr_read_b32 v65, a114
    v_accvgpr_read_b32 v67, a118
    v_accvgpr_read_b32 v69, a122
    v_accvgpr_read_b32 v71, a126
    v_pk_fma_f32 v[56:57], v[88:89], v[32:33], v[64:65] op_sel:[0,0,0] op_sel_hi:[0,1,1]
    v_pk_fma_f32 v[58:59], v[90:91], v[34:35], v[66:67] op_sel:[0,0,0] op_sel_hi:[0,1,1]
    v_pk_fma_f32 v[60:61], v[92:93], v[36:37], v[68:69] op_sel:[0,0,0] op_sel_hi:[0,1,1]
    v_pk_fma_f32 v[62:63], v[94:95], v[38:39], v[70:71] op_sel:[0,0,0] op_sel_hi:[0,1,1]
    v_pk_fma_f32 v[32:33], v[88:89], v[32:33], v[56:57] op_sel:[1,1,0] op_sel_hi:[1,0,1] neg_lo:[1,0,0]
    v_pk_fma_f32 v[34:35], v[90:91], v[34:35], v[58:59] op_sel:[1,1,0] op_sel_hi:[1,0,1] neg_lo:[1,0,0]
    v_pk_fma_f32 v[36:37], v[92:93], v[36:37], v[60:61] op_sel:[1,1,0] op_sel_hi:[1,0,1] neg_lo:[1,0,0]
    v_pk_fma_f32 v[38:39], v[94:95], v[38:39], v[62:63] op_sel:[1,1,0] op_sel_hi:[1,0,1] neg_lo:[1,0,0]
    v_pk_mul_f32 v[40:41], v[96:97], v[32:33] op_sel:[0,0] op_sel_hi:[0,1]
    v_pk_mul_f32 v[42:43], v[98:99], v[34:35] op_sel:[0,0] op_sel_hi:[0,1]
    v_pk_mul_f32 v[44:45], v[100:101], v[36:37] op_sel:[0,0] op_sel_hi:[0,1]
    v_pk_mul_f32 v[46:47], v[102:103], v[38:39] op_sel:[0,0] op_sel_hi:[0,1]
    v_pk_fma_f32 v[72:73], v[96:97], v[32:33], v[40:41] op_sel:[1,1,0] op_sel_hi:[1,0,1] neg_lo:[1,0,0] neg_hi:[1,0,1]
    v_pk_fma_f32 v[74:75], v[98:99], v[34:35], v[42:43] op_sel:[1,1,0] op_sel_hi:[1,0,1] neg_lo:[1,0,0] neg_hi:[1,0,1]
    v_pk_fma_f32 v[76:77], v[100:101], v[36:37], v[44:45] op_sel:[1,1,0] op_sel_hi:[1,0,1] neg_lo:[1,0,0] neg_hi:[1,0,1]
    v_pk_fma_f32 v[78:79], v[102:103], v[38:39], v[46:47] op_sel:[1,1,0] op_sel_hi:[1,0,1] neg_lo:[1,0,0] neg_hi:[1,0,1]
    v_accvgpr_read_b32 v48, a99
    v_accvgpr_read_b32 v50, a103
    v_accvgpr_read_b32 v52, a107
    v_accvgpr_read_b32 v54, a111
    v_accvgpr_read_b32 v49, a115
    v_accvgpr_read_b32 v51, a119
    v_accvgpr_read_b32 v53, a123
    v_accvgpr_read_b32 v55, a127
    v_pk_fma_f32 v[56:57], v[88:89], v[32:33], v[48:49] op_sel:[0,0,0] op_sel_hi:[0,1,1]
    v_pk_fma_f32 v[58:59], v[90:91], v[34:35], v[50:51] op_sel:[0,0,0] op_sel_hi:[0,1,1]
    v_pk_fma_f32 v[60:61], v[92:93], v[36:37], v[52:53] op_sel:[0,0,0] op_sel_hi:[0,1,1]
    v_pk_fma_f32 v[62:63], v[94:95], v[38:39], v[54:55] op_sel:[0,0,0] op_sel_hi:[0,1,1]
    v_pk_fma_f32 v[32:33], v[88:89], v[32:33], v[56:57] op_sel:[1,1,0] op_sel_hi:[1,0,1] neg_lo:[1,0,0]
    v_pk_fma_f32 v[34:35], v[90:91], v[34:35], v[58:59] op_sel:[1,1,0] op_sel_hi:[1,0,1] neg_lo:[1,0,0]
    v_pk_fma_f32 v[36:37], v[92:93], v[36:37], v[60:61] op_sel:[1,1,0] op_sel_hi:[1,0,1] neg_lo:[1,0,0]
    v_pk_fma_f32 v[38:39], v[94:95], v[38:39], v[62:63] op_sel:[1,1,0] op_sel_hi:[1,0,1] neg_lo:[1,0,0]
    v_pk_mul_f32 v[40:41], v[96:97], v[32:33] op_sel:[0,0] op_sel_hi:[0,1]
    v_pk_mul_f32 v[42:43], v[98:99], v[34:35] op_sel:[0,0] op_sel_hi:[0,1]
    v_pk_mul_f32 v[44:45], v[100:101], v[36:37] op_sel:[0,0] op_sel_hi:[0,1]
    v_pk_mul_f32 v[46:47], v[102:103], v[38:39] op_sel:[0,0] op_sel_hi:[0,1]
    v_pk_fma_f32 v[80:81], v[96:97], v[32:33], v[40:41] op_sel:[1,1,0] op_sel_hi:[1,0,1] neg_lo:[1,0,0] neg_hi:[1,0,1]
    v_pk_fma_f32 v[82:83], v[98:99], v[34:35], v[42:43] op_sel:[1,1,0] op_sel_hi:[1,0,1] neg_lo:[1,0,0] neg_hi:[1,0,1]
    v_pk_fma_f32 v[84:85], v[100:101], v[36:37], v[44:45] op_sel:[1,1,0] op_sel_hi:[1,0,1] neg_lo:[1,0,0] neg_hi:[1,0,1]
    v_pk_fma_f32 v[86:87], v[102:103], v[38:39], v[46:47] op_sel:[1,1,0] op_sel_hi:[1,0,1] neg_lo:[1,0,0] neg_hi:[1,0,1]
    v_cvt_pk_bf16_f32 v135, v72, v80
    v_cvt_pk_bf16_f32 v143, v74, v82
    v_cvt_pk_bf16_f32 v151, v76, v84
    v_cvt_pk_bf16_f32 v159, v78, v86
    v_cvt_pk_bf16_f32 v199, v73, v81
    v_cvt_pk_bf16_f32 v207, v75, v83
    v_cvt_pk_bf16_f32 v215, v77, v85
    v_cvt_pk_bf16_f32 v223, v79, v87
    v_accvgpr_read_b32 v64, a128
    v_accvgpr_read_b32 v66, a132
    v_accvgpr_read_b32 v68, a136
    v_accvgpr_read_b32 v70, a140
    v_accvgpr_read_b32 v65, a144
    v_accvgpr_read_b32 v67, a148
    v_accvgpr_read_b32 v69, a152
    v_accvgpr_read_b32 v71, a156
    v_pk_fma_f32 v[56:57], v[88:89], v[32:33], v[64:65] op_sel:[0,0,0] op_sel_hi:[0,1,1]
    v_pk_fma_f32 v[58:59], v[90:91], v[34:35], v[66:67] op_sel:[0,0,0] op_sel_hi:[0,1,1]
    v_pk_fma_f32 v[60:61], v[92:93], v[36:37], v[68:69] op_sel:[0,0,0] op_sel_hi:[0,1,1]
    v_pk_fma_f32 v[62:63], v[94:95], v[38:39], v[70:71] op_sel:[0,0,0] op_sel_hi:[0,1,1]
    v_pk_fma_f32 v[32:33], v[88:89], v[32:33], v[56:57] op_sel:[1,1,0] op_sel_hi:[1,0,1] neg_lo:[1,0,0]
    v_pk_fma_f32 v[34:35], v[90:91], v[34:35], v[58:59] op_sel:[1,1,0] op_sel_hi:[1,0,1] neg_lo:[1,0,0]
    v_pk_fma_f32 v[36:37], v[92:93], v[36:37], v[60:61] op_sel:[1,1,0] op_sel_hi:[1,0,1] neg_lo:[1,0,0]
    v_pk_fma_f32 v[38:39], v[94:95], v[38:39], v[62:63] op_sel:[1,1,0] op_sel_hi:[1,0,1] neg_lo:[1,0,0]
    v_pk_mul_f32 v[40:41], v[96:97], v[32:33] op_sel:[0,0] op_sel_hi:[0,1]
    v_pk_mul_f32 v[42:43], v[98:99], v[34:35] op_sel:[0,0] op_sel_hi:[0,1]
    v_pk_mul_f32 v[44:45], v[100:101], v[36:37] op_sel:[0,0] op_sel_hi:[0,1]
    v_pk_mul_f32 v[46:47], v[102:103], v[38:39] op_sel:[0,0] op_sel_hi:[0,1]
    v_pk_fma_f32 v[72:73], v[96:97], v[32:33], v[40:41] op_sel:[1,1,0] op_sel_hi:[1,0,1] neg_lo:[1,0,0] neg_hi:[1,0,1]
    v_pk_fma_f32 v[74:75], v[98:99], v[34:35], v[42:43] op_sel:[1,1,0] op_sel_hi:[1,0,1] neg_lo:[1,0,0] neg_hi:[1,0,1]
    v_pk_fma_f32 v[76:77], v[100:101], v[36:37], v[44:45] op_sel:[1,1,0] op_sel_hi:[1,0,1] neg_lo:[1,0,0] neg_hi:[1,0,1]
    v_pk_fma_f32 v[78:79], v[102:103], v[38:39], v[46:47] op_sel:[1,1,0] op_sel_hi:[1,0,1] neg_lo:[1,0,0] neg_hi:[1,0,1]
    v_accvgpr_read_b32 v48, a129
    v_accvgpr_read_b32 v50, a133
    v_accvgpr_read_b32 v52, a137
    v_accvgpr_read_b32 v54, a141
    v_accvgpr_read_b32 v49, a145
    v_accvgpr_read_b32 v51, a149
    v_accvgpr_read_b32 v53, a153
    v_accvgpr_read_b32 v55, a157
    v_pk_fma_f32 v[56:57], v[88:89], v[32:33], v[48:49] op_sel:[0,0,0] op_sel_hi:[0,1,1]
    v_pk_fma_f32 v[58:59], v[90:91], v[34:35], v[50:51] op_sel:[0,0,0] op_sel_hi:[0,1,1]
    v_pk_fma_f32 v[60:61], v[92:93], v[36:37], v[52:53] op_sel:[0,0,0] op_sel_hi:[0,1,1]
    v_pk_fma_f32 v[62:63], v[94:95], v[38:39], v[54:55] op_sel:[0,0,0] op_sel_hi:[0,1,1]
    v_pk_fma_f32 v[32:33], v[88:89], v[32:33], v[56:57] op_sel:[1,1,0] op_sel_hi:[1,0,1] neg_lo:[1,0,0]
    v_pk_fma_f32 v[34:35], v[90:91], v[34:35], v[58:59] op_sel:[1,1,0] op_sel_hi:[1,0,1] neg_lo:[1,0,0]
    v_pk_fma_f32 v[36:37], v[92:93], v[36:37], v[60:61] op_sel:[1,1,0] op_sel_hi:[1,0,1] neg_lo:[1,0,0]
    v_pk_fma_f32 v[38:39], v[94:95], v[38:39], v[62:63] op_sel:[1,1,0] op_sel_hi:[1,0,1] neg_lo:[1,0,0]
    v_pk_mul_f32 v[40:41], v[96:97], v[32:33] op_sel:[0,0] op_sel_hi:[0,1]
    v_pk_mul_f32 v[42:43], v[98:99], v[34:35] op_sel:[0,0] op_sel_hi:[0,1]
    v_pk_mul_f32 v[44:45], v[100:101], v[36:37] op_sel:[0,0] op_sel_hi:[0,1]
    v_pk_mul_f32 v[46:47], v[102:103], v[38:39] op_sel:[0,0] op_sel_hi:[0,1]
    v_pk_fma_f32 v[80:81], v[96:97], v[32:33], v[40:41] op_sel:[1,1,0] op_sel_hi:[1,0,1] neg_lo:[1,0,0] neg_hi:[1,0,1]
    v_pk_fma_f32 v[82:83], v[98:99], v[34:35], v[42:43] op_sel:[1,1,0] op_sel_hi:[1,0,1] neg_lo:[1,0,0] neg_hi:[1,0,1]
    v_pk_fma_f32 v[84:85], v[100:101], v[36:37], v[44:45] op_sel:[1,1,0] op_sel_hi:[1,0,1] neg_lo:[1,0,0] neg_hi:[1,0,1]
    v_pk_fma_f32 v[86:87], v[102:103], v[38:39], v[46:47] op_sel:[1,1,0] op_sel_hi:[1,0,1] neg_lo:[1,0,0] neg_hi:[1,0,1]
    v_cvt_pk_bf16_f32 v160, v72, v80
    v_cvt_pk_bf16_f32 v168, v74, v82
    v_cvt_pk_bf16_f32 v176, v76, v84
    v_cvt_pk_bf16_f32 v184, v78, v86
    v_cvt_pk_bf16_f32 v224, v73, v81
    v_cvt_pk_bf16_f32 v232, v75, v83
    v_cvt_pk_bf16_f32 v240, v77, v85
    v_cvt_pk_bf16_f32 v248, v79, v87
    v_accvgpr_read_b32 v64, a130
    v_accvgpr_read_b32 v66, a134
    v_accvgpr_read_b32 v68, a138
    v_accvgpr_read_b32 v70, a142
    v_accvgpr_read_b32 v65, a146
    v_accvgpr_read_b32 v67, a150
    v_accvgpr_read_b32 v69, a154
    v_accvgpr_read_b32 v71, a158
    v_pk_fma_f32 v[56:57], v[88:89], v[32:33], v[64:65] op_sel:[0,0,0] op_sel_hi:[0,1,1]
    v_pk_fma_f32 v[58:59], v[90:91], v[34:35], v[66:67] op_sel:[0,0,0] op_sel_hi:[0,1,1]
    v_pk_fma_f32 v[60:61], v[92:93], v[36:37], v[68:69] op_sel:[0,0,0] op_sel_hi:[0,1,1]
    v_pk_fma_f32 v[62:63], v[94:95], v[38:39], v[70:71] op_sel:[0,0,0] op_sel_hi:[0,1,1]
    v_pk_fma_f32 v[32:33], v[88:89], v[32:33], v[56:57] op_sel:[1,1,0] op_sel_hi:[1,0,1] neg_lo:[1,0,0]
    v_pk_fma_f32 v[34:35], v[90:91], v[34:35], v[58:59] op_sel:[1,1,0] op_sel_hi:[1,0,1] neg_lo:[1,0,0]
    v_pk_fma_f32 v[36:37], v[92:93], v[36:37], v[60:61] op_sel:[1,1,0] op_sel_hi:[1,0,1] neg_lo:[1,0,0]
    v_pk_fma_f32 v[38:39], v[94:95], v[38:39], v[62:63] op_sel:[1,1,0] op_sel_hi:[1,0,1] neg_lo:[1,0,0]
    v_pk_mul_f32 v[40:41], v[96:97], v[32:33] op_sel:[0,0] op_sel_hi:[0,1]
    v_pk_mul_f32 v[42:43], v[98:99], v[34:35] op_sel:[0,0] op_sel_hi:[0,1]
    v_pk_mul_f32 v[44:45], v[100:101], v[36:37] op_sel:[0,0] op_sel_hi:[0,1]
    v_pk_mul_f32 v[46:47], v[102:103], v[38:39] op_sel:[0,0] op_sel_hi:[0,1]
    v_pk_fma_f32 v[72:73], v[96:97], v[32:33], v[40:41] op_sel:[1,1,0] op_sel_hi:[1,0,1] neg_lo:[1,0,0] neg_hi:[1,0,1]
    v_pk_fma_f32 v[74:75], v[98:99], v[34:35], v[42:43] op_sel:[1,1,0] op_sel_hi:[1,0,1] neg_lo:[1,0,0] neg_hi:[1,0,1]
    v_pk_fma_f32 v[76:77], v[100:101], v[36:37], v[44:45] op_sel:[1,1,0] op_sel_hi:[1,0,1] neg_lo:[1,0,0] neg_hi:[1,0,1]
    v_pk_fma_f32 v[78:79], v[102:103], v[38:39], v[46:47] op_sel:[1,1,0] op_sel_hi:[1,0,1] neg_lo:[1,0,0] neg_hi:[1,0,1]
    v_accvgpr_read_b32 v48, a131
    v_accvgpr_read_b32 v50, a135
    v_accvgpr_read_b32 v52, a139
    v_accvgpr_read_b32 v54, a143
    v_accvgpr_read_b32 v49, a147
    v_accvgpr_read_b32 v51, a151
    v_accvgpr_read_b32 v53, a155
    v_accvgpr_read_b32 v55, a159
    v_pk_fma_f32 v[56:57], v[88:89], v[32:33], v[48:49] op_sel:[0,0,0] op_sel_hi:[0,1,1]
    v_pk_fma_f32 v[58:59], v[90:91], v[34:35], v[50:51] op_sel:[0,0,0] op_sel_hi:[0,1,1]
    v_pk_fma_f32 v[60:61], v[92:93], v[36:37], v[52:53] op_sel:[0,0,0] op_sel_hi:[0,1,1]
    v_pk_fma_f32 v[62:63], v[94:95], v[38:39], v[54:55] op_sel:[0,0,0] op_sel_hi:[0,1,1]
    v_pk_fma_f32 v[32:33], v[88:89], v[32:33], v[56:57] op_sel:[1,1,0] op_sel_hi:[1,0,1] neg_lo:[1,0,0]
    v_pk_fma_f32 v[34:35], v[90:91], v[34:35], v[58:59] op_sel:[1,1,0] op_sel_hi:[1,0,1] neg_lo:[1,0,0]
    v_pk_fma_f32 v[36:37], v[92:93], v[36:37], v[60:61] op_sel:[1,1,0] op_sel_hi:[1,0,1] neg_lo:[1,0,0]
    v_pk_fma_f32 v[38:39], v[94:95], v[38:39], v[62:63] op_sel:[1,1,0] op_sel_hi:[1,0,1] neg_lo:[1,0,0]
    v_pk_mul_f32 v[40:41], v[96:97], v[32:33] op_sel:[0,0] op_sel_hi:[0,1]
    v_pk_mul_f32 v[42:43], v[98:99], v[34:35] op_sel:[0,0] op_sel_hi:[0,1]
    v_pk_mul_f32 v[44:45], v[100:101], v[36:37] op_sel:[0,0] op_sel_hi:[0,1]
    v_pk_mul_f32 v[46:47], v[102:103], v[38:39] op_sel:[0,0] op_sel_hi:[0,1]
    v_pk_fma_f32 v[80:81], v[96:97], v[32:33], v[40:41] op_sel:[1,1,0] op_sel_hi:[1,0,1] neg_lo:[1,0,0] neg_hi:[1,0,1]
    v_pk_fma_f32 v[82:83], v[98:99], v[34:35], v[42:43] op_sel:[1,1,0] op_sel_hi:[1,0,1] neg_lo:[1,0,0] neg_hi:[1,0,1]
    v_pk_fma_f32 v[84:85], v[100:101], v[36:37], v[44:45] op_sel:[1,1,0] op_sel_hi:[1,0,1] neg_lo:[1,0,0] neg_hi:[1,0,1]
    v_pk_fma_f32 v[86:87], v[102:103], v[38:39], v[46:47] op_sel:[1,1,0] op_sel_hi:[1,0,1] neg_lo:[1,0,0] neg_hi:[1,0,1]
    v_cvt_pk_bf16_f32 v161, v72, v80
    v_cvt_pk_bf16_f32 v169, v74, v82
    v_cvt_pk_bf16_f32 v177, v76, v84
    v_cvt_pk_bf16_f32 v185, v78, v86
    v_cvt_pk_bf16_f32 v225, v73, v81
    v_cvt_pk_bf16_f32 v233, v75, v83
    v_cvt_pk_bf16_f32 v241, v77, v85
    v_cvt_pk_bf16_f32 v249, v79, v87
    v_accvgpr_read_b32 v64, a160
    v_accvgpr_read_b32 v66, a164
    v_accvgpr_read_b32 v68, a168
    v_accvgpr_read_b32 v70, a172
    v_accvgpr_read_b32 v65, a176
    v_accvgpr_read_b32 v67, a180
    v_accvgpr_read_b32 v69, a184
    v_accvgpr_read_b32 v71, a188
    v_pk_fma_f32 v[56:57], v[88:89], v[32:33], v[64:65] op_sel:[0,0,0] op_sel_hi:[0,1,1]
    v_pk_fma_f32 v[58:59], v[90:91], v[34:35], v[66:67] op_sel:[0,0,0] op_sel_hi:[0,1,1]
    v_pk_fma_f32 v[60:61], v[92:93], v[36:37], v[68:69] op_sel:[0,0,0] op_sel_hi:[0,1,1]
    v_pk_fma_f32 v[62:63], v[94:95], v[38:39], v[70:71] op_sel:[0,0,0] op_sel_hi:[0,1,1]
    v_pk_fma_f32 v[32:33], v[88:89], v[32:33], v[56:57] op_sel:[1,1,0] op_sel_hi:[1,0,1] neg_lo:[1,0,0]
    v_pk_fma_f32 v[34:35], v[90:91], v[34:35], v[58:59] op_sel:[1,1,0] op_sel_hi:[1,0,1] neg_lo:[1,0,0]
    v_pk_fma_f32 v[36:37], v[92:93], v[36:37], v[60:61] op_sel:[1,1,0] op_sel_hi:[1,0,1] neg_lo:[1,0,0]
    v_pk_fma_f32 v[38:39], v[94:95], v[38:39], v[62:63] op_sel:[1,1,0] op_sel_hi:[1,0,1] neg_lo:[1,0,0]
    v_pk_mul_f32 v[40:41], v[96:97], v[32:33] op_sel:[0,0] op_sel_hi:[0,1]
    v_pk_mul_f32 v[42:43], v[98:99], v[34:35] op_sel:[0,0] op_sel_hi:[0,1]
    v_pk_mul_f32 v[44:45], v[100:101], v[36:37] op_sel:[0,0] op_sel_hi:[0,1]
    v_pk_mul_f32 v[46:47], v[102:103], v[38:39] op_sel:[0,0] op_sel_hi:[0,1]
    v_pk_fma_f32 v[72:73], v[96:97], v[32:33], v[40:41] op_sel:[1,1,0] op_sel_hi:[1,0,1] neg_lo:[1,0,0] neg_hi:[1,0,1]
    v_pk_fma_f32 v[74:75], v[98:99], v[34:35], v[42:43] op_sel:[1,1,0] op_sel_hi:[1,0,1] neg_lo:[1,0,0] neg_hi:[1,0,1]
    v_pk_fma_f32 v[76:77], v[100:101], v[36:37], v[44:45] op_sel:[1,1,0] op_sel_hi:[1,0,1] neg_lo:[1,0,0] neg_hi:[1,0,1]
    v_pk_fma_f32 v[78:79], v[102:103], v[38:39], v[46:47] op_sel:[1,1,0] op_sel_hi:[1,0,1] neg_lo:[1,0,0] neg_hi:[1,0,1]
    v_accvgpr_read_b32 v48, a161
    v_accvgpr_read_b32 v50, a165
    v_accvgpr_read_b32 v52, a169
    v_accvgpr_read_b32 v54, a173
    v_accvgpr_read_b32 v49, a177
    v_accvgpr_read_b32 v51, a181
    v_accvgpr_read_b32 v53, a185
    v_accvgpr_read_b32 v55, a189
    v_pk_fma_f32 v[56:57], v[88:89], v[32:33], v[48:49] op_sel:[0,0,0] op_sel_hi:[0,1,1]
    v_pk_fma_f32 v[58:59], v[90:91], v[34:35], v[50:51] op_sel:[0,0,0] op_sel_hi:[0,1,1]
    v_pk_fma_f32 v[60:61], v[92:93], v[36:37], v[52:53] op_sel:[0,0,0] op_sel_hi:[0,1,1]
    v_pk_fma_f32 v[62:63], v[94:95], v[38:39], v[54:55] op_sel:[0,0,0] op_sel_hi:[0,1,1]
    v_pk_fma_f32 v[32:33], v[88:89], v[32:33], v[56:57] op_sel:[1,1,0] op_sel_hi:[1,0,1] neg_lo:[1,0,0]
    v_pk_fma_f32 v[34:35], v[90:91], v[34:35], v[58:59] op_sel:[1,1,0] op_sel_hi:[1,0,1] neg_lo:[1,0,0]
    v_pk_fma_f32 v[36:37], v[92:93], v[36:37], v[60:61] op_sel:[1,1,0] op_sel_hi:[1,0,1] neg_lo:[1,0,0]
    v_pk_fma_f32 v[38:39], v[94:95], v[38:39], v[62:63] op_sel:[1,1,0] op_sel_hi:[1,0,1] neg_lo:[1,0,0]
    v_pk_mul_f32 v[40:41], v[96:97], v[32:33] op_sel:[0,0] op_sel_hi:[0,1]
    v_pk_mul_f32 v[42:43], v[98:99], v[34:35] op_sel:[0,0] op_sel_hi:[0,1]
    v_pk_mul_f32 v[44:45], v[100:101], v[36:37] op_sel:[0,0] op_sel_hi:[0,1]
    v_pk_mul_f32 v[46:47], v[102:103], v[38:39] op_sel:[0,0] op_sel_hi:[0,1]
    v_pk_fma_f32 v[80:81], v[96:97], v[32:33], v[40:41] op_sel:[1,1,0] op_sel_hi:[1,0,1] neg_lo:[1,0,0] neg_hi:[1,0,1]
    v_pk_fma_f32 v[82:83], v[98:99], v[34:35], v[42:43] op_sel:[1,1,0] op_sel_hi:[1,0,1] neg_lo:[1,0,0] neg_hi:[1,0,1]
    v_pk_fma_f32 v[84:85], v[100:101], v[36:37], v[44:45] op_sel:[1,1,0] op_sel_hi:[1,0,1] neg_lo:[1,0,0] neg_hi:[1,0,1]
    v_pk_fma_f32 v[86:87], v[102:103], v[38:39], v[46:47] op_sel:[1,1,0] op_sel_hi:[1,0,1] neg_lo:[1,0,0] neg_hi:[1,0,1]
    v_cvt_pk_bf16_f32 v162, v72, v80
    v_cvt_pk_bf16_f32 v170, v74, v82
    v_cvt_pk_bf16_f32 v178, v76, v84
    v_cvt_pk_bf16_f32 v186, v78, v86
    v_cvt_pk_bf16_f32 v226, v73, v81
    v_cvt_pk_bf16_f32 v234, v75, v83
    v_cvt_pk_bf16_f32 v242, v77, v85
    v_cvt_pk_bf16_f32 v250, v79, v87
    v_accvgpr_read_b32 v64, a162
    v_accvgpr_read_b32 v66, a166
    v_accvgpr_read_b32 v68, a170
    v_accvgpr_read_b32 v70, a174
    v_accvgpr_read_b32 v65, a178
    v_accvgpr_read_b32 v67, a182
    v_accvgpr_read_b32 v69, a186
    v_accvgpr_read_b32 v71, a190
    v_pk_fma_f32 v[56:57], v[88:89], v[32:33], v[64:65] op_sel:[0,0,0] op_sel_hi:[0,1,1]
    v_pk_fma_f32 v[58:59], v[90:91], v[34:35], v[66:67] op_sel:[0,0,0] op_sel_hi:[0,1,1]
    v_pk_fma_f32 v[60:61], v[92:93], v[36:37], v[68:69] op_sel:[0,0,0] op_sel_hi:[0,1,1]
    v_pk_fma_f32 v[62:63], v[94:95], v[38:39], v[70:71] op_sel:[0,0,0] op_sel_hi:[0,1,1]
    v_pk_fma_f32 v[32:33], v[88:89], v[32:33], v[56:57] op_sel:[1,1,0] op_sel_hi:[1,0,1] neg_lo:[1,0,0]
    v_pk_fma_f32 v[34:35], v[90:91], v[34:35], v[58:59] op_sel:[1,1,0] op_sel_hi:[1,0,1] neg_lo:[1,0,0]
    v_pk_fma_f32 v[36:37], v[92:93], v[36:37], v[60:61] op_sel:[1,1,0] op_sel_hi:[1,0,1] neg_lo:[1,0,0]
    v_pk_fma_f32 v[38:39], v[94:95], v[38:39], v[62:63] op_sel:[1,1,0] op_sel_hi:[1,0,1] neg_lo:[1,0,0]
    v_pk_mul_f32 v[40:41], v[96:97], v[32:33] op_sel:[0,0] op_sel_hi:[0,1]
    v_pk_mul_f32 v[42:43], v[98:99], v[34:35] op_sel:[0,0] op_sel_hi:[0,1]
    v_pk_mul_f32 v[44:45], v[100:101], v[36:37] op_sel:[0,0] op_sel_hi:[0,1]
    v_pk_mul_f32 v[46:47], v[102:103], v[38:39] op_sel:[0,0] op_sel_hi:[0,1]
    v_pk_fma_f32 v[72:73], v[96:97], v[32:33], v[40:41] op_sel:[1,1,0] op_sel_hi:[1,0,1] neg_lo:[1,0,0] neg_hi:[1,0,1]
    v_pk_fma_f32 v[74:75], v[98:99], v[34:35], v[42:43] op_sel:[1,1,0] op_sel_hi:[1,0,1] neg_lo:[1,0,0] neg_hi:[1,0,1]
    v_pk_fma_f32 v[76:77], v[100:101], v[36:37], v[44:45] op_sel:[1,1,0] op_sel_hi:[1,0,1] neg_lo:[1,0,0] neg_hi:[1,0,1]
    v_pk_fma_f32 v[78:79], v[102:103], v[38:39], v[46:47] op_sel:[1,1,0] op_sel_hi:[1,0,1] neg_lo:[1,0,0] neg_hi:[1,0,1]
    v_accvgpr_read_b32 v48, a163
    v_accvgpr_read_b32 v50, a167
    v_accvgpr_read_b32 v52, a171
    v_accvgpr_read_b32 v54, a175
    v_accvgpr_read_b32 v49, a179
    v_accvgpr_read_b32 v51, a183
    v_accvgpr_read_b32 v53, a187
    v_accvgpr_read_b32 v55, a191
    v_pk_fma_f32 v[56:57], v[88:89], v[32:33], v[48:49] op_sel:[0,0,0] op_sel_hi:[0,1,1]
    v_pk_fma_f32 v[58:59], v[90:91], v[34:35], v[50:51] op_sel:[0,0,0] op_sel_hi:[0,1,1]
    v_pk_fma_f32 v[60:61], v[92:93], v[36:37], v[52:53] op_sel:[0,0,0] op_sel_hi:[0,1,1]
    v_pk_fma_f32 v[62:63], v[94:95], v[38:39], v[54:55] op_sel:[0,0,0] op_sel_hi:[0,1,1]
    v_pk_fma_f32 v[32:33], v[88:89], v[32:33], v[56:57] op_sel:[1,1,0] op_sel_hi:[1,0,1] neg_lo:[1,0,0]
    v_pk_fma_f32 v[34:35], v[90:91], v[34:35], v[58:59] op_sel:[1,1,0] op_sel_hi:[1,0,1] neg_lo:[1,0,0]
    v_pk_fma_f32 v[36:37], v[92:93], v[36:37], v[60:61] op_sel:[1,1,0] op_sel_hi:[1,0,1] neg_lo:[1,0,0]
    v_pk_fma_f32 v[38:39], v[94:95], v[38:39], v[62:63] op_sel:[1,1,0] op_sel_hi:[1,0,1] neg_lo:[1,0,0]
    v_pk_mul_f32 v[40:41], v[96:97], v[32:33] op_sel:[0,0] op_sel_hi:[0,1]
    v_pk_mul_f32 v[42:43], v[98:99], v[34:35] op_sel:[0,0] op_sel_hi:[0,1]
    v_pk_mul_f32 v[44:45], v[100:101], v[36:37] op_sel:[0,0] op_sel_hi:[0,1]
    v_pk_mul_f32 v[46:47], v[102:103], v[38:39] op_sel:[0,0] op_sel_hi:[0,1]
    v_pk_fma_f32 v[80:81], v[96:97], v[32:33], v[40:41] op_sel:[1,1,0] op_sel_hi:[1,0,1] neg_lo:[1,0,0] neg_hi:[1,0,1]
    v_pk_fma_f32 v[82:83], v[98:99], v[34:35], v[42:43] op_sel:[1,1,0] op_sel_hi:[1,0,1] neg_lo:[1,0,0] neg_hi:[1,0,1]
    v_pk_fma_f32 v[84:85], v[100:101], v[36:37], v[44:45] op_sel:[1,1,0] op_sel_hi:[1,0,1] neg_lo:[1,0,0] neg_hi:[1,0,1]
    v_pk_fma_f32 v[86:87], v[102:103], v[38:39], v[46:47] op_sel:[1,1,0] op_sel_hi:[1,0,1] neg_lo:[1,0,0] neg_hi:[1,0,1]
    v_cvt_pk_bf16_f32 v163, v72, v80
    v_cvt_pk_bf16_f32 v171, v74, v82
    v_cvt_pk_bf16_f32 v179, v76, v84
    v_cvt_pk_bf16_f32 v187, v78, v86
    v_cvt_pk_bf16_f32 v227, v73, v81
    v_cvt_pk_bf16_f32 v235, v75, v83
    v_cvt_pk_bf16_f32 v243, v77, v85
    v_cvt_pk_bf16_f32 v251, v79, v87
    v_accvgpr_read_b32 v64, a192
    v_accvgpr_read_b32 v66, a196
    v_accvgpr_read_b32 v68, a200
    v_accvgpr_read_b32 v70, a204
    v_accvgpr_read_b32 v65, a208
    v_accvgpr_read_b32 v67, a212
    v_accvgpr_read_b32 v69, a216
    v_accvgpr_read_b32 v71, a220
    v_pk_fma_f32 v[56:57], v[88:89], v[32:33], v[64:65] op_sel:[0,0,0] op_sel_hi:[0,1,1]
    v_pk_fma_f32 v[58:59], v[90:91], v[34:35], v[66:67] op_sel:[0,0,0] op_sel_hi:[0,1,1]
    v_pk_fma_f32 v[60:61], v[92:93], v[36:37], v[68:69] op_sel:[0,0,0] op_sel_hi:[0,1,1]
    v_pk_fma_f32 v[62:63], v[94:95], v[38:39], v[70:71] op_sel:[0,0,0] op_sel_hi:[0,1,1]
    v_pk_fma_f32 v[32:33], v[88:89], v[32:33], v[56:57] op_sel:[1,1,0] op_sel_hi:[1,0,1] neg_lo:[1,0,0]
    v_pk_fma_f32 v[34:35], v[90:91], v[34:35], v[58:59] op_sel:[1,1,0] op_sel_hi:[1,0,1] neg_lo:[1,0,0]
    v_pk_fma_f32 v[36:37], v[92:93], v[36:37], v[60:61] op_sel:[1,1,0] op_sel_hi:[1,0,1] neg_lo:[1,0,0]
    v_pk_fma_f32 v[38:39], v[94:95], v[38:39], v[62:63] op_sel:[1,1,0] op_sel_hi:[1,0,1] neg_lo:[1,0,0]
    v_pk_mul_f32 v[40:41], v[96:97], v[32:33] op_sel:[0,0] op_sel_hi:[0,1]
    v_pk_mul_f32 v[42:43], v[98:99], v[34:35] op_sel:[0,0] op_sel_hi:[0,1]
    v_pk_mul_f32 v[44:45], v[100:101], v[36:37] op_sel:[0,0] op_sel_hi:[0,1]
    v_pk_mul_f32 v[46:47], v[102:103], v[38:39] op_sel:[0,0] op_sel_hi:[0,1]
    v_pk_fma_f32 v[72:73], v[96:97], v[32:33], v[40:41] op_sel:[1,1,0] op_sel_hi:[1,0,1] neg_lo:[1,0,0] neg_hi:[1,0,1]
    v_pk_fma_f32 v[74:75], v[98:99], v[34:35], v[42:43] op_sel:[1,1,0] op_sel_hi:[1,0,1] neg_lo:[1,0,0] neg_hi:[1,0,1]
    v_pk_fma_f32 v[76:77], v[100:101], v[36:37], v[44:45] op_sel:[1,1,0] op_sel_hi:[1,0,1] neg_lo:[1,0,0] neg_hi:[1,0,1]
    v_pk_fma_f32 v[78:79], v[102:103], v[38:39], v[46:47] op_sel:[1,1,0] op_sel_hi:[1,0,1] neg_lo:[1,0,0] neg_hi:[1,0,1]
    v_accvgpr_read_b32 v48, a193
    v_accvgpr_read_b32 v50, a197
    v_accvgpr_read_b32 v52, a201
    v_accvgpr_read_b32 v54, a205
    v_accvgpr_read_b32 v49, a209
    v_accvgpr_read_b32 v51, a213
    v_accvgpr_read_b32 v53, a217
    v_accvgpr_read_b32 v55, a221
    v_pk_fma_f32 v[56:57], v[88:89], v[32:33], v[48:49] op_sel:[0,0,0] op_sel_hi:[0,1,1]
    v_pk_fma_f32 v[58:59], v[90:91], v[34:35], v[50:51] op_sel:[0,0,0] op_sel_hi:[0,1,1]
    v_pk_fma_f32 v[60:61], v[92:93], v[36:37], v[52:53] op_sel:[0,0,0] op_sel_hi:[0,1,1]
    v_pk_fma_f32 v[62:63], v[94:95], v[38:39], v[54:55] op_sel:[0,0,0] op_sel_hi:[0,1,1]
    v_pk_fma_f32 v[32:33], v[88:89], v[32:33], v[56:57] op_sel:[1,1,0] op_sel_hi:[1,0,1] neg_lo:[1,0,0]
    v_pk_fma_f32 v[34:35], v[90:91], v[34:35], v[58:59] op_sel:[1,1,0] op_sel_hi:[1,0,1] neg_lo:[1,0,0]
    v_pk_fma_f32 v[36:37], v[92:93], v[36:37], v[60:61] op_sel:[1,1,0] op_sel_hi:[1,0,1] neg_lo:[1,0,0]
    v_pk_fma_f32 v[38:39], v[94:95], v[38:39], v[62:63] op_sel:[1,1,0] op_sel_hi:[1,0,1] neg_lo:[1,0,0]
    v_pk_mul_f32 v[40:41], v[96:97], v[32:33] op_sel:[0,0] op_sel_hi:[0,1]
    v_pk_mul_f32 v[42:43], v[98:99], v[34:35] op_sel:[0,0] op_sel_hi:[0,1]
    v_pk_mul_f32 v[44:45], v[100:101], v[36:37] op_sel:[0,0] op_sel_hi:[0,1]
    v_pk_mul_f32 v[46:47], v[102:103], v[38:39] op_sel:[0,0] op_sel_hi:[0,1]
    v_pk_fma_f32 v[80:81], v[96:97], v[32:33], v[40:41] op_sel:[1,1,0] op_sel_hi:[1,0,1] neg_lo:[1,0,0] neg_hi:[1,0,1]
    v_pk_fma_f32 v[82:83], v[98:99], v[34:35], v[42:43] op_sel:[1,1,0] op_sel_hi:[1,0,1] neg_lo:[1,0,0] neg_hi:[1,0,1]
    v_pk_fma_f32 v[84:85], v[100:101], v[36:37], v[44:45] op_sel:[1,1,0] op_sel_hi:[1,0,1] neg_lo:[1,0,0] neg_hi:[1,0,1]
    v_pk_fma_f32 v[86:87], v[102:103], v[38:39], v[46:47] op_sel:[1,1,0] op_sel_hi:[1,0,1] neg_lo:[1,0,0] neg_hi:[1,0,1]
    v_cvt_pk_bf16_f32 v164, v72, v80
    v_cvt_pk_bf16_f32 v172, v74, v82
    v_cvt_pk_bf16_f32 v180, v76, v84
    v_cvt_pk_bf16_f32 v188, v78, v86
    v_cvt_pk_bf16_f32 v228, v73, v81
    v_cvt_pk_bf16_f32 v236, v75, v83
    v_cvt_pk_bf16_f32 v244, v77, v85
    v_cvt_pk_bf16_f32 v252, v79, v87
    v_accvgpr_read_b32 v64, a194
    v_accvgpr_read_b32 v66, a198
    v_accvgpr_read_b32 v68, a202
    v_accvgpr_read_b32 v70, a206
    v_accvgpr_read_b32 v65, a210
    v_accvgpr_read_b32 v67, a214
    v_accvgpr_read_b32 v69, a218
    v_accvgpr_read_b32 v71, a222
    v_pk_fma_f32 v[56:57], v[88:89], v[32:33], v[64:65] op_sel:[0,0,0] op_sel_hi:[0,1,1]
    v_pk_fma_f32 v[58:59], v[90:91], v[34:35], v[66:67] op_sel:[0,0,0] op_sel_hi:[0,1,1]
    v_pk_fma_f32 v[60:61], v[92:93], v[36:37], v[68:69] op_sel:[0,0,0] op_sel_hi:[0,1,1]
    v_pk_fma_f32 v[62:63], v[94:95], v[38:39], v[70:71] op_sel:[0,0,0] op_sel_hi:[0,1,1]
    v_pk_fma_f32 v[32:33], v[88:89], v[32:33], v[56:57] op_sel:[1,1,0] op_sel_hi:[1,0,1] neg_lo:[1,0,0]
    v_pk_fma_f32 v[34:35], v[90:91], v[34:35], v[58:59] op_sel:[1,1,0] op_sel_hi:[1,0,1] neg_lo:[1,0,0]
    v_pk_fma_f32 v[36:37], v[92:93], v[36:37], v[60:61] op_sel:[1,1,0] op_sel_hi:[1,0,1] neg_lo:[1,0,0]
    v_pk_fma_f32 v[38:39], v[94:95], v[38:39], v[62:63] op_sel:[1,1,0] op_sel_hi:[1,0,1] neg_lo:[1,0,0]
    v_pk_mul_f32 v[40:41], v[96:97], v[32:33] op_sel:[0,0] op_sel_hi:[0,1]
    v_pk_mul_f32 v[42:43], v[98:99], v[34:35] op_sel:[0,0] op_sel_hi:[0,1]
    v_pk_mul_f32 v[44:45], v[100:101], v[36:37] op_sel:[0,0] op_sel_hi:[0,1]
    v_pk_mul_f32 v[46:47], v[102:103], v[38:39] op_sel:[0,0] op_sel_hi:[0,1]
    v_pk_fma_f32 v[72:73], v[96:97], v[32:33], v[40:41] op_sel:[1,1,0] op_sel_hi:[1,0,1] neg_lo:[1,0,0] neg_hi:[1,0,1]
    v_pk_fma_f32 v[74:75], v[98:99], v[34:35], v[42:43] op_sel:[1,1,0] op_sel_hi:[1,0,1] neg_lo:[1,0,0] neg_hi:[1,0,1]
    v_pk_fma_f32 v[76:77], v[100:101], v[36:37], v[44:45] op_sel:[1,1,0] op_sel_hi:[1,0,1] neg_lo:[1,0,0] neg_hi:[1,0,1]
    v_pk_fma_f32 v[78:79], v[102:103], v[38:39], v[46:47] op_sel:[1,1,0] op_sel_hi:[1,0,1] neg_lo:[1,0,0] neg_hi:[1,0,1]
    v_accvgpr_read_b32 v48, a195
    v_accvgpr_read_b32 v50, a199
    v_accvgpr_read_b32 v52, a203
    v_accvgpr_read_b32 v54, a207
    v_accvgpr_read_b32 v49, a211
    v_accvgpr_read_b32 v51, a215
    v_accvgpr_read_b32 v53, a219
    v_accvgpr_read_b32 v55, a223
    v_pk_fma_f32 v[56:57], v[88:89], v[32:33], v[48:49] op_sel:[0,0,0] op_sel_hi:[0,1,1]
    v_pk_fma_f32 v[58:59], v[90:91], v[34:35], v[50:51] op_sel:[0,0,0] op_sel_hi:[0,1,1]
    v_pk_fma_f32 v[60:61], v[92:93], v[36:37], v[52:53] op_sel:[0,0,0] op_sel_hi:[0,1,1]
    v_pk_fma_f32 v[62:63], v[94:95], v[38:39], v[54:55] op_sel:[0,0,0] op_sel_hi:[0,1,1]
    v_pk_fma_f32 v[32:33], v[88:89], v[32:33], v[56:57] op_sel:[1,1,0] op_sel_hi:[1,0,1] neg_lo:[1,0,0]
    v_pk_fma_f32 v[34:35], v[90:91], v[34:35], v[58:59] op_sel:[1,1,0] op_sel_hi:[1,0,1] neg_lo:[1,0,0]
    v_pk_fma_f32 v[36:37], v[92:93], v[36:37], v[60:61] op_sel:[1,1,0] op_sel_hi:[1,0,1] neg_lo:[1,0,0]
    v_pk_fma_f32 v[38:39], v[94:95], v[38:39], v[62:63] op_sel:[1,1,0] op_sel_hi:[1,0,1] neg_lo:[1,0,0]
    v_pk_mul_f32 v[40:41], v[96:97], v[32:33] op_sel:[0,0] op_sel_hi:[0,1]
    v_pk_mul_f32 v[42:43], v[98:99], v[34:35] op_sel:[0,0] op_sel_hi:[0,1]
    v_pk_mul_f32 v[44:45], v[100:101], v[36:37] op_sel:[0,0] op_sel_hi:[0,1]
    v_pk_mul_f32 v[46:47], v[102:103], v[38:39] op_sel:[0,0] op_sel_hi:[0,1]
    v_pk_fma_f32 v[80:81], v[96:97], v[32:33], v[40:41] op_sel:[1,1,0] op_sel_hi:[1,0,1] neg_lo:[1,0,0] neg_hi:[1,0,1]
    v_pk_fma_f32 v[82:83], v[98:99], v[34:35], v[42:43] op_sel:[1,1,0] op_sel_hi:[1,0,1] neg_lo:[1,0,0] neg_hi:[1,0,1]
    v_pk_fma_f32 v[84:85], v[100:101], v[36:37], v[44:45] op_sel:[1,1,0] op_sel_hi:[1,0,1] neg_lo:[1,0,0] neg_hi:[1,0,1]
    v_pk_fma_f32 v[86:87], v[102:103], v[38:39], v[46:47] op_sel:[1,1,0] op_sel_hi:[1,0,1] neg_lo:[1,0,0] neg_hi:[1,0,1]
    v_cvt_pk_bf16_f32 v165, v72, v80
    v_cvt_pk_bf16_f32 v173, v74, v82
    v_cvt_pk_bf16_f32 v181, v76, v84
    v_cvt_pk_bf16_f32 v189, v78, v86
    v_cvt_pk_bf16_f32 v229, v73, v81
    v_cvt_pk_bf16_f32 v237, v75, v83
    v_cvt_pk_bf16_f32 v245, v77, v85
    v_cvt_pk_bf16_f32 v253, v79, v87
    v_accvgpr_read_b32 v64, a224
    v_accvgpr_read_b32 v66, a228
    v_accvgpr_read_b32 v68, a232
    v_accvgpr_read_b32 v70, a236
    v_accvgpr_read_b32 v65, a240
    v_accvgpr_read_b32 v67, a244
    v_accvgpr_read_b32 v69, a248
    v_accvgpr_read_b32 v71, a252
    v_pk_fma_f32 v[56:57], v[88:89], v[32:33], v[64:65] op_sel:[0,0,0] op_sel_hi:[0,1,1]
    v_pk_fma_f32 v[58:59], v[90:91], v[34:35], v[66:67] op_sel:[0,0,0] op_sel_hi:[0,1,1]
    v_pk_fma_f32 v[60:61], v[92:93], v[36:37], v[68:69] op_sel:[0,0,0] op_sel_hi:[0,1,1]
    v_pk_fma_f32 v[62:63], v[94:95], v[38:39], v[70:71] op_sel:[0,0,0] op_sel_hi:[0,1,1]
    v_pk_fma_f32 v[32:33], v[88:89], v[32:33], v[56:57] op_sel:[1,1,0] op_sel_hi:[1,0,1] neg_lo:[1,0,0]
    v_pk_fma_f32 v[34:35], v[90:91], v[34:35], v[58:59] op_sel:[1,1,0] op_sel_hi:[1,0,1] neg_lo:[1,0,0]
    v_pk_fma_f32 v[36:37], v[92:93], v[36:37], v[60:61] op_sel:[1,1,0] op_sel_hi:[1,0,1] neg_lo:[1,0,0]
    v_pk_fma_f32 v[38:39], v[94:95], v[38:39], v[62:63] op_sel:[1,1,0] op_sel_hi:[1,0,1] neg_lo:[1,0,0]
    v_pk_mul_f32 v[40:41], v[96:97], v[32:33] op_sel:[0,0] op_sel_hi:[0,1]
    v_pk_mul_f32 v[42:43], v[98:99], v[34:35] op_sel:[0,0] op_sel_hi:[0,1]
    v_pk_mul_f32 v[44:45], v[100:101], v[36:37] op_sel:[0,0] op_sel_hi:[0,1]
    v_pk_mul_f32 v[46:47], v[102:103], v[38:39] op_sel:[0,0] op_sel_hi:[0,1]
    v_pk_fma_f32 v[72:73], v[96:97], v[32:33], v[40:41] op_sel:[1,1,0] op_sel_hi:[1,0,1] neg_lo:[1,0,0] neg_hi:[1,0,1]
    v_pk_fma_f32 v[74:75], v[98:99], v[34:35], v[42:43] op_sel:[1,1,0] op_sel_hi:[1,0,1] neg_lo:[1,0,0] neg_hi:[1,0,1]
    v_pk_fma_f32 v[76:77], v[100:101], v[36:37], v[44:45] op_sel:[1,1,0] op_sel_hi:[1,0,1] neg_lo:[1,0,0] neg_hi:[1,0,1]
    v_pk_fma_f32 v[78:79], v[102:103], v[38:39], v[46:47] op_sel:[1,1,0] op_sel_hi:[1,0,1] neg_lo:[1,0,0] neg_hi:[1,0,1]
    v_accvgpr_read_b32 v48, a225
    v_accvgpr_read_b32 v50, a229
    v_accvgpr_read_b32 v52, a233
    v_accvgpr_read_b32 v54, a237
    v_accvgpr_read_b32 v49, a241
    v_accvgpr_read_b32 v51, a245
    v_accvgpr_read_b32 v53, a249
    v_accvgpr_read_b32 v55, a253
    v_pk_fma_f32 v[56:57], v[88:89], v[32:33], v[48:49] op_sel:[0,0,0] op_sel_hi:[0,1,1]
    v_pk_fma_f32 v[58:59], v[90:91], v[34:35], v[50:51] op_sel:[0,0,0] op_sel_hi:[0,1,1]
    v_pk_fma_f32 v[60:61], v[92:93], v[36:37], v[52:53] op_sel:[0,0,0] op_sel_hi:[0,1,1]
    v_pk_fma_f32 v[62:63], v[94:95], v[38:39], v[54:55] op_sel:[0,0,0] op_sel_hi:[0,1,1]
    v_pk_fma_f32 v[32:33], v[88:89], v[32:33], v[56:57] op_sel:[1,1,0] op_sel_hi:[1,0,1] neg_lo:[1,0,0]
    v_pk_fma_f32 v[34:35], v[90:91], v[34:35], v[58:59] op_sel:[1,1,0] op_sel_hi:[1,0,1] neg_lo:[1,0,0]
    v_pk_fma_f32 v[36:37], v[92:93], v[36:37], v[60:61] op_sel:[1,1,0] op_sel_hi:[1,0,1] neg_lo:[1,0,0]
    v_pk_fma_f32 v[38:39], v[94:95], v[38:39], v[62:63] op_sel:[1,1,0] op_sel_hi:[1,0,1] neg_lo:[1,0,0]
    v_pk_mul_f32 v[40:41], v[96:97], v[32:33] op_sel:[0,0] op_sel_hi:[0,1]
    v_pk_mul_f32 v[42:43], v[98:99], v[34:35] op_sel:[0,0] op_sel_hi:[0,1]
    v_pk_mul_f32 v[44:45], v[100:101], v[36:37] op_sel:[0,0] op_sel_hi:[0,1]
    v_pk_mul_f32 v[46:47], v[102:103], v[38:39] op_sel:[0,0] op_sel_hi:[0,1]
    v_pk_fma_f32 v[80:81], v[96:97], v[32:33], v[40:41] op_sel:[1,1,0] op_sel_hi:[1,0,1] neg_lo:[1,0,0] neg_hi:[1,0,1]
    v_pk_fma_f32 v[82:83], v[98:99], v[34:35], v[42:43] op_sel:[1,1,0] op_sel_hi:[1,0,1] neg_lo:[1,0,0] neg_hi:[1,0,1]
    v_pk_fma_f32 v[84:85], v[100:101], v[36:37], v[44:45] op_sel:[1,1,0] op_sel_hi:[1,0,1] neg_lo:[1,0,0] neg_hi:[1,0,1]
    v_pk_fma_f32 v[86:87], v[102:103], v[38:39], v[46:47] op_sel:[1,1,0] op_sel_hi:[1,0,1] neg_lo:[1,0,0] neg_hi:[1,0,1]
    v_cvt_pk_bf16_f32 v166, v72, v80
    v_cvt_pk_bf16_f32 v174, v74, v82
    v_cvt_pk_bf16_f32 v182, v76, v84
    v_cvt_pk_bf16_f32 v190, v78, v86
    v_cvt_pk_bf16_f32 v230, v73, v81
    v_cvt_pk_bf16_f32 v238, v75, v83
    v_cvt_pk_bf16_f32 v246, v77, v85
    v_cvt_pk_bf16_f32 v254, v79, v87
    v_accvgpr_read_b32 v64, a226
    v_accvgpr_read_b32 v66, a230
    v_accvgpr_read_b32 v68, a234
    v_accvgpr_read_b32 v70, a238
    v_accvgpr_read_b32 v65, a242
    v_accvgpr_read_b32 v67, a246
    v_accvgpr_read_b32 v69, a250
    v_accvgpr_read_b32 v71, a254
    v_pk_fma_f32 v[56:57], v[88:89], v[32:33], v[64:65] op_sel:[0,0,0] op_sel_hi:[0,1,1]
    v_pk_fma_f32 v[58:59], v[90:91], v[34:35], v[66:67] op_sel:[0,0,0] op_sel_hi:[0,1,1]
    v_pk_fma_f32 v[60:61], v[92:93], v[36:37], v[68:69] op_sel:[0,0,0] op_sel_hi:[0,1,1]
    v_pk_fma_f32 v[62:63], v[94:95], v[38:39], v[70:71] op_sel:[0,0,0] op_sel_hi:[0,1,1]
    v_pk_fma_f32 v[32:33], v[88:89], v[32:33], v[56:57] op_sel:[1,1,0] op_sel_hi:[1,0,1] neg_lo:[1,0,0]
    v_pk_fma_f32 v[34:35], v[90:91], v[34:35], v[58:59] op_sel:[1,1,0] op_sel_hi:[1,0,1] neg_lo:[1,0,0]
    v_pk_fma_f32 v[36:37], v[92:93], v[36:37], v[60:61] op_sel:[1,1,0] op_sel_hi:[1,0,1] neg_lo:[1,0,0]
    v_pk_fma_f32 v[38:39], v[94:95], v[38:39], v[62:63] op_sel:[1,1,0] op_sel_hi:[1,0,1] neg_lo:[1,0,0]
    v_pk_mul_f32 v[40:41], v[96:97], v[32:33] op_sel:[0,0] op_sel_hi:[0,1]
    v_pk_mul_f32 v[42:43], v[98:99], v[34:35] op_sel:[0,0] op_sel_hi:[0,1]
    v_pk_mul_f32 v[44:45], v[100:101], v[36:37] op_sel:[0,0] op_sel_hi:[0,1]
    v_pk_mul_f32 v[46:47], v[102:103], v[38:39] op_sel:[0,0] op_sel_hi:[0,1]
    v_pk_fma_f32 v[72:73], v[96:97], v[32:33], v[40:41] op_sel:[1,1,0] op_sel_hi:[1,0,1] neg_lo:[1,0,0] neg_hi:[1,0,1]
    v_pk_fma_f32 v[74:75], v[98:99], v[34:35], v[42:43] op_sel:[1,1,0] op_sel_hi:[1,0,1] neg_lo:[1,0,0] neg_hi:[1,0,1]
    v_pk_fma_f32 v[76:77], v[100:101], v[36:37], v[44:45] op_sel:[1,1,0] op_sel_hi:[1,0,1] neg_lo:[1,0,0] neg_hi:[1,0,1]
    v_pk_fma_f32 v[78:79], v[102:103], v[38:39], v[46:47] op_sel:[1,1,0] op_sel_hi:[1,0,1] neg_lo:[1,0,0] neg_hi:[1,0,1]
    v_accvgpr_read_b32 v48, a227
    v_accvgpr_read_b32 v50, a231
    v_accvgpr_read_b32 v52, a235
    v_accvgpr_read_b32 v54, a239
    v_accvgpr_read_b32 v49, a243
    v_accvgpr_read_b32 v51, a247
    v_accvgpr_read_b32 v53, a251
    v_accvgpr_read_b32 v55, a255
    v_pk_fma_f32 v[56:57], v[88:89], v[32:33], v[48:49] op_sel:[0,0,0] op_sel_hi:[0,1,1]
    v_pk_fma_f32 v[58:59], v[90:91], v[34:35], v[50:51] op_sel:[0,0,0] op_sel_hi:[0,1,1]
    v_pk_fma_f32 v[60:61], v[92:93], v[36:37], v[52:53] op_sel:[0,0,0] op_sel_hi:[0,1,1]
    v_pk_fma_f32 v[62:63], v[94:95], v[38:39], v[54:55] op_sel:[0,0,0] op_sel_hi:[0,1,1]
    v_pk_fma_f32 v[32:33], v[88:89], v[32:33], v[56:57] op_sel:[1,1,0] op_sel_hi:[1,0,1] neg_lo:[1,0,0]
    v_pk_fma_f32 v[34:35], v[90:91], v[34:35], v[58:59] op_sel:[1,1,0] op_sel_hi:[1,0,1] neg_lo:[1,0,0]
    v_pk_fma_f32 v[36:37], v[92:93], v[36:37], v[60:61] op_sel:[1,1,0] op_sel_hi:[1,0,1] neg_lo:[1,0,0]
    v_pk_fma_f32 v[38:39], v[94:95], v[38:39], v[62:63] op_sel:[1,1,0] op_sel_hi:[1,0,1] neg_lo:[1,0,0]
    v_pk_mul_f32 v[40:41], v[96:97], v[32:33] op_sel:[0,0] op_sel_hi:[0,1]
    v_pk_mul_f32 v[42:43], v[98:99], v[34:35] op_sel:[0,0] op_sel_hi:[0,1]
    v_pk_mul_f32 v[44:45], v[100:101], v[36:37] op_sel:[0,0] op_sel_hi:[0,1]
    v_pk_mul_f32 v[46:47], v[102:103], v[38:39] op_sel:[0,0] op_sel_hi:[0,1]
    v_pk_fma_f32 v[80:81], v[96:97], v[32:33], v[40:41] op_sel:[1,1,0] op_sel_hi:[1,0,1] neg_lo:[1,0,0] neg_hi:[1,0,1]
    v_pk_fma_f32 v[82:83], v[98:99], v[34:35], v[42:43] op_sel:[1,1,0] op_sel_hi:[1,0,1] neg_lo:[1,0,0] neg_hi:[1,0,1]
    v_pk_fma_f32 v[84:85], v[100:101], v[36:37], v[44:45] op_sel:[1,1,0] op_sel_hi:[1,0,1] neg_lo:[1,0,0] neg_hi:[1,0,1]
    v_pk_fma_f32 v[86:87], v[102:103], v[38:39], v[46:47] op_sel:[1,1,0] op_sel_hi:[1,0,1] neg_lo:[1,0,0] neg_hi:[1,0,1]
    v_cvt_pk_bf16_f32 v167, v72, v80
    v_cvt_pk_bf16_f32 v175, v74, v82
    v_cvt_pk_bf16_f32 v183, v76, v84
    v_cvt_pk_bf16_f32 v191, v78, v86
    v_cvt_pk_bf16_f32 v231, v73, v81
    v_cvt_pk_bf16_f32 v239, v75, v83
    v_cvt_pk_bf16_f32 v247, v77, v85
    v_cvt_pk_bf16_f32 v255, v79, v87
    s_lshl_b32 s61, s85, 13
    s_andn2_b32 s61, 0x2000, s61
    s_xor_b32 s61, s61, s59
    s_lshl_b32 s50, s85, 21
    s_add_u32 s50, s50, s61
    s_lshr_b32 s60, s82, 2
    s_lshl_b32 s60, s60, 20
    s_add_u32 s50, s50, s60
    s_lshl_b32 s29, s29, 7
    s_and_b32 s29, s29, 0x7ffff
    s_add_u32 s50, s50, s29
    s_and_b32 s60, s58, 1
    s_lshl_b32 s60, s60, 12
    s_add_u32 s50, s50, s60
    s_add_u32 s50, s50, 0xa000000
    s_mov_b32 s5, 16384
    s_mov_b32 s51, 2048
    s_mov_b32 s52, 0x80000
    v_bfe_u32 v2, v0, 4, 1
    v_lshlrev_b32 v2, 6, v2
    v_xor_b32 v2, v2, v1
    v_add_u32 v3, 1024, v2
    s_setpc_b64 s[54:55]
.section .rodata,"a"
.p2align 6
.amdhsa_kernel chain_kernel
  .amdhsa_next_free_vgpr 512
  .amdhsa_next_free_sgpr 102
  .amdhsa_accum_offset 256
  .amdhsa_group_segment_fixed_size 0
  .amdhsa_kernarg_size 152
  .amdhsa_user_sgpr_count 2
  .amdhsa_user_sgpr_kernarg_segment_ptr 1
  .amdhsa_system_sgpr_workgroup_id_x 1
  .amdhsa_float_denorm_mode_32 3
  .amdhsa_float_denorm_mode_16_64 3
.end_amdhsa_kernel
```

```asm
; @launch kernel=chain_kernel grid=(256,1,1) block=(256,1,1) lds=163840
.amdgcn_target "amdgcn-amd-amdhsa--gfx950"
.text
.globl chain_kernel
.p2align 8
.type chain_kernel,@function
chain_kernel:
    s_cmp_ge_u32 s2, 256
    s_cbranch_scc1 chain_kernel_end
    s_load_dwordx4 s[96:99], s[0:1], 128
    s_load_dwordx2 s[100:101], s[0:1], 144
    s_load_dwordx16 s[64:79], s[0:1], 0
    s_load_dwordx16 s[80:95], s[0:1], 64
    s_getreg_b32 s16, hwreg(HW_REG_XCC_ID)
    s_and_b32 s16, s16, 7
    v_lshrrev_b32 v1, 6, v0
    s_nop 0
    v_readfirstlane_b32 s18, v1
    s_waitcnt lgkmcnt(0)
    s_lshr_b32 s17, s2, 3
    s_mov_b32 s2, 0
    s_cmp_lg_u32 s18, 0
    s_cbranch_scc1 L_role_1
    s_lshl_b32 s12, s16, 8
    s_add_u32 s12, s12, 0xb200000
    v_lshl_add_u32 v1, v0, 2, s12
    v_mov_b32 v2, 0
    global_store_dword v1, v2, s[100:101]
    s_lshl_b32 s12, s16, 3
    s_add_u32 s12, s12, 128
    s_lshl_b32 s94, 1, s17
    s_mov_b32 s95, 0x100
    s_waitcnt vmcnt(0)
    s_atomic_add_x2 s[94:95], s[98:99], s12 glc
L_role_1:
    s_cmp_ge_u32 s16, 4
    s_cbranch_scc1 chain_kernel_worker
chain_start:
    s_mov_b32 s8, s100
    s_and_b32 s9, s101, 0xffff
    s_mov_b32 s10, 0x10000000
    s_mov_b32 s11, 0x00020000
    s_mov_b32 s33, 0
    s_xor_b32 s29, s17, 8
    s_and_b32 s28, s17, 1
    s_bfe_u32 s20, s17, 0x10001
    s_xor_b32 s20, s20, 1
    s_lshl1_add_u32 s28, s28, s20
    s_lshl_b32 s20, s16, 10
    s_lshr_b32 s21, s17, 2
    s_lshl_b32 s21, s21, 7
    s_add_u32 s20, s20, s21
    v_bfe_u32 v160, v0, 5, 1
    v_lshlrev_b32 v162, 1, v160
    v_bfe_u32 v160, v0, 3, 1
    v_add_u32 v162, v162, v160
    v_bfe_u32 v160, v0, 4, 1
    v_lshl_add_u32 v162, v160, 3, v162
    v_lshrrev_b32 v160, 6, v0
    v_lshl_add_u32 v162, v160, 8, v162
    v_and_b32 v161, 7, v0
    v_lshlrev_b32 v163, 13, v162
    v_lshl_add_u32 v163, v161, 4, v163
    s_and_b32 s21, s28, 1
    s_lshl_b32 s21, s21, 6
    s_add_u32 s21, s21, s20
    s_lshl_b32 s21, s21, 1
    v_add_u32 v163, s21, v163
    v_add_u32 v164, 0x8000, v163
    v_bfe_u32 v160, v0, 4, 2
    v_lshlrev_b32 v162, 1, v160
    v_bfe_u32 v160, v0, 2, 1
    v_add_u32 v162, v162, v160
    v_bfe_u32 v160, v0, 3, 1
    v_lshl_add_u32 v162, v160, 3, v162
    v_lshrrev_b32 v160, 6, v0
    v_lshl_add_u32 v162, v160, 8, v162
    v_and_b32 v161, 3, v0
    v_lshlrev_b32 v165, 13, v162
    v_lshl_add_u32 v165, v161, 4, v165
    s_and_b32 s21, s17, 3
    s_lshl_b32 s21, s21, 5
    s_add_u32 s21, s21, s20
    s_lshl_b32 s21, s21, 1
    v_add_u32 v165, s21, v165
    v_bfe_u32 v166, v0, 2, 1
    v_bfe_u32 v160, v0, 4, 1
    v_lshl_add_u32 v166, v160, 1, v166
    v_bfe_u32 v160, v0, 3, 1
    v_lshl_add_u32 v166, v160, 2, v166
    v_bfe_u32 v160, v0, 5, 1
    v_lshl_add_u32 v166, v160, 4, v166
    v_lshrrev_b32 v160, 6, v0
    v_lshl_add_u32 v166, v160, 8, v166
    s_lshl_b32 s21, s16, 10
    v_add_u32 v166, s21, v166
    v_lshlrev_b32 v166, 11, v166
    v_lshl_add_u32 v166, v161, 4, v166
    s_lshl_b32 s21, s29, 6
    v_add_u32 v166, s21, v166
    s_lshl_b32 s80, s18, 15
    s_add_u32 s80, s80, 32768
    s_bitcmp1_b32 s28, 1
    s_cselect_b32 s12, s88, s86
    s_cselect_b32 s13, s89, s87
    s_and_b32 s13, s13, 0xffff
    s_mov_b32 s14, 0x800000
    s_mov_b32 s15, 0x00020000
    s_mov_b32 s4, s90
    s_and_b32 s5, s91, 0xffff
    s_mov_b32 s6, 0x800000
    s_mov_b32 s7, 0x00020000
    s_mov_b32 s40, s92
    s_and_b32 s41, s93, 0xffff
    s_mov_b32 s42, 0x800000
    s_mov_b32 s43, 0x00020000
    s_add_u32 m0, s80, 0
    s_mov_b32 s81, 0
    buffer_load_dwordx4 v163, s[12:15], s81 offen nt lds
    s_add_u32 m0, s80, 1024
    s_mov_b32 s81, 0
    buffer_load_dwordx4 v164, s[12:15], s81 offen nt lds
    s_add_u32 m0, s80, 2048
    s_mov_b32 s81, 131072
    buffer_load_dwordx4 v163, s[12:15], s81 offen nt lds
    s_add_u32 m0, s80, 3072
    s_mov_b32 s81, 131072
    buffer_load_dwordx4 v164, s[12:15], s81 offen nt lds
    s_mov_b32 s81, 0
    buffer_load_dwordx4 v[32:35], v165, s[4:7], s81 offen nt
    s_mov_b32 s81, 0
    buffer_load_dwordx4 v[96:99], v166, s[40:43], s81 offen nt
    s_mov_b32 s81, 131072
    buffer_load_dwordx4 v[36:39], v165, s[4:7], s81 offen nt
    s_mov_b32 s81, 16384
    buffer_load_dwordx4 v[100:103], v166, s[40:43], s81 offen nt
    s_mov_b32 s24, 0x00ff00ff
    s_mov_b32 s25, 0x00ff00ff
    s_mov_b32 s26, 0x55555555
    s_mov_b32 s27, 0x55555555
    s_mov_b32 s56, 0x3fb8aa3b
    s_mov_b32 s57, 0x3fb8aa3b
    s_mov_b32 s58, 0x3db504f3
    s_mov_b32 s59, 0x3db504f3
    s_lshl_b32 s53, s16, 16
    s_add_u32 s53, s53, 0xb000000
    s_lshl_b32 s47, s16, 5
    s_add_u32 s47, s47, s17
    s_mov_b64 s[60:61], s[98:99]
    v_mov_b32 v28, -1
    v_mov_b32 v29, -1
    v_mov_b32 v30, -1
    v_mov_b32 v31, -1
    v_and_b32 v210, 63, v0
    v_and_b32 v208, 15, v0
    v_bfe_u32 v209, v0, 4, 2
    v_lshlrev_b32 v1, 4, v210
    v_lshlrev_b32 v26, 3, v210
    s_lshl_b32 s21, s18, 12
    v_add_u32 v2, s21, v1
    s_xor_b32 s22, s18, 3
    s_lshl_b32 s22, s22, 4
    v_xor_b32 v3, s22, v2
    v_add_u32 v3, 16384, v3
    s_and_b32 s22, s22, 16
    s_lshl_b32 s22, s22, 1
    v_xor_b32 v2, s22, v2
    v_mov_b32 v19, 0xeeeeeeee
    v_mov_b32 v212, 0x44444444
    v_cndmask_b32 v19, v19, v212, s[24:25]
    v_mov_b32 v18, 0x03020706
    v_mov_b32 v212, 0x05040100
    v_cndmask_b32 v18, v18, v212, s[26:27]
    s_lshr_b32 s21, s17, 2
    s_lshl_b32 s21, s21, 12
    s_add_u32 s21, s21, 32768
    v_add_u32 v5, s21, v1
    s_and_b32 s22, s28, 1
    s_lshl_b32 s22, s22, 11
    s_add_u32 s21, s21, s22
    s_bfe_u32 s22, s28, 0x10001
    s_lshl_b32 s22, s22, 7
    s_add_u32 s23, s21, s22
    s_add_u32 m0, s80, 4096
    s_mov_b32 s81, 262144
    buffer_load_dwordx4 v163, s[12:15], s81 offen nt lds
    s_add_u32 m0, s80, 5120
    s_mov_b32 s81, 262144
    buffer_load_dwordx4 v164, s[12:15], s81 offen nt lds
    s_add_u32 m0, s80, 6144
    s_mov_b32 s81, 393216
    buffer_load_dwordx4 v163, s[12:15], s81 offen nt lds
    s_add_u32 m0, s80, 7168
    s_mov_b32 s81, 393216
    buffer_load_dwordx4 v164, s[12:15], s81 offen nt lds
    s_mov_b32 s81, 262144
    buffer_load_dwordx4 v[40:43], v165, s[4:7], s81 offen nt
    s_mov_b32 s81, 65536
    buffer_load_dwordx4 v[104:107], v166, s[40:43], s81 offen nt
    s_mov_b32 s81, 393216
    buffer_load_dwordx4 v[44:47], v165, s[4:7], s81 offen nt
    s_mov_b32 s81, 81920
    buffer_load_dwordx4 v[108:111], v166, s[40:43], s81 offen nt
    v_and_b32 v212, 1, v209
    v_lshlrev_b32 v234, 6, v212
    v_and_b32 v212, 1, v208
    v_lshl_add_u32 v234, v212, 4, v234
    v_bfe_u32 v212, v208, 1, 2
    v_lshl_add_u32 v234, v212, 2, v234
    s_and_b32 s22, s18, 1
    s_lshl_b32 s22, s22, 5
    v_add_u32 v234, s22, v234
    v_lshrrev_b32 v212, 3, v208
    v_and_b32 v213, 2, v209
    v_add_u32 v212, v212, v213
    s_and_b32 s22, s18, 2
    s_lshl_b32 s22, s22, 1
    v_add_u32 v212, s22, v212
    v_lshl_add_u32 v4, v212, 8, v234
    v_lshl_add_u32 v234, v212, 7, v234
    v_add_u32 v4, s23, v4
    v_lshrrev_b32 v212, 3, v210
    v_and_b32 v213, 7, v210
    v_lshlrev_b32 v22, 8, v212
    v_lshl_add_u32 v22, v213, 4, v22
    v_add_u32 v22, s23, v22
    s_lshr_b32 s20, s47, 2
    s_or_b32 s76, s16, s18
    s_or_b32 s76, s76, s2
    s_cbranch_scc1 L_cal_2
    s_waitcnt lgkmcnt(0)
    s_lshr_b32 s74, s95, 8
    s_cmp_ge_u32 s74, 15
    s_cbranch_scc1 L_cal_2
    s_lshl_b32 s76, s74, 14
    s_add_u32 s76, s76, 0xb400000
    s_add_u32 s64, s100, s76
    s_addc_u32 s65, s101, 0
    s_mov_b32 s76, 0
    s_atomic_or s76, s[64:65], 0
    s_atomic_or s76, s[64:65], 0x2000
    s_waitcnt lgkmcnt(0)
    s_mov_b32 s77, -1
    s_mov_b32 s78, -1
    s_memtime s[66:67]
    s_atomic_or s76, s[64:65], 0
    s_waitcnt lgkmcnt(0)
    s_memtime s[68:69]
    s_atomic_or s76, s[64:65], 0x2000
    s_waitcnt lgkmcnt(0)
    s_sub_u32 s79, s68, s66
    s_memtime s[66:67]
    s_min_u32 s77, s77, s79
    s_waitcnt lgkmcnt(0)
    s_sub_u32 s79, s66, s68
    s_min_u32 s78, s78, s79
    s_memtime s[66:67]
    s_atomic_or s76, s[64:65], 0
    s_waitcnt lgkmcnt(0)
    s_memtime s[68:69]
    s_atomic_or s76, s[64:65], 0x2000
    s_waitcnt lgkmcnt(0)
    s_sub_u32 s79, s68, s66
    s_memtime s[66:67]
    s_min_u32 s77, s77, s79
    s_waitcnt lgkmcnt(0)
    s_sub_u32 s79, s66, s68
    s_min_u32 s78, s78, s79
    s_memtime s[66:67]
    s_atomic_or s76, s[64:65], 0
    s_waitcnt lgkmcnt(0)
    s_memtime s[68:69]
    s_atomic_or s76, s[64:65], 0x2000
    s_waitcnt lgkmcnt(0)
    s_sub_u32 s79, s68, s66
    s_memtime s[66:67]
    s_min_u32 s77, s77, s79
    s_waitcnt lgkmcnt(0)
    s_sub_u32 s79, s66, s68
    s_min_u32 s78, s78, s79
    s_memtime s[66:67]
    s_atomic_or s76, s[64:65], 0
    s_waitcnt lgkmcnt(0)
    s_memtime s[68:69]
    s_atomic_or s76, s[64:65], 0x2000
    s_waitcnt lgkmcnt(0)
    s_sub_u32 s79, s68, s66
    s_memtime s[66:67]
    s_min_u32 s77, s77, s79
    s_waitcnt lgkmcnt(0)
    s_sub_u32 s79, s66, s68
    s_min_u32 s78, s78, s79
    s_cmp_lt_u32 s78, s77
    s_cselect_b32 s76, 0x101, 1
    s_atomic_add s76, s[98:99], 4
    s_waitcnt lgkmcnt(0)
L_cal_2:
    s_add_u32 m0, s80, 8192
    s_mov_b32 s81, 524288
    buffer_load_dwordx4 v163, s[12:15], s81 offen nt lds
    s_add_u32 m0, s80, 9216
    s_mov_b32 s81, 524288
    buffer_load_dwordx4 v164, s[12:15], s81 offen nt lds
    s_add_u32 m0, s80, 10240
    s_mov_b32 s81, 655360
    buffer_load_dwordx4 v163, s[12:15], s81 offen nt lds
    s_add_u32 m0, s80, 11264
    s_mov_b32 s81, 655360
    buffer_load_dwordx4 v164, s[12:15], s81 offen nt lds
    s_mov_b32 s81, 524288
    buffer_load_dwordx4 v[48:51], v165, s[4:7], s81 offen nt
    s_mov_b32 s81, 131072
    buffer_load_dwordx4 v[112:115], v166, s[40:43], s81 offen nt
    s_mov_b32 s81, 655360
    buffer_load_dwordx4 v[52:55], v165, s[4:7], s81 offen nt
    s_mov_b32 s81, 147456
    buffer_load_dwordx4 v[116:119], v166, s[40:43], s81 offen nt
    s_lshl_b32 s48, s20, 16
    s_and_b32 s21, s17, 3
    s_lshl_b32 s22, s21, 11
    s_add_u32 s22, s22, 0x4000
    v_add_u32 v237, s22, v1
    v_lshlrev_b32 v236, 7, v208
    v_and_b32 v212, 1, v209
    v_lshl_add_u32 v236, v212, 15, v236
    s_lshl_b32 s22, s21, 11
    v_add_u32 v236, s22, v236
    v_mov_b32 v25, v236
    s_cmp_lt_u32 s18, 2
    s_cselect_b32 s38, 0xf0000000, 0
    s_cmp_lg_u32 s18, 1
    s_cselect_b32 s39, 0xf0000000, 0
    s_lshr_b32 s22, s18, 1
    s_mul_i32 s54, s22, 10240
    s_lshl_b32 s22, s22, 15
    s_and_b32 s23, s18, 1
    s_lshl_b32 s23, s23, 12
    s_add_u32 s54, s54, s23
    s_add_u32 s54, s54, 32768
    s_add_u32 s22, s22, s23
    v_add_u32 v235, s22, v1
    s_add_u32 m0, s80, 12288
    s_mov_b32 s81, 786432
    buffer_load_dwordx4 v163, s[12:15], s81 offen nt lds
    s_add_u32 m0, s80, 13312
    s_mov_b32 s81, 786432
    buffer_load_dwordx4 v164, s[12:15], s81 offen nt lds
    s_add_u32 m0, s80, 14336
    s_mov_b32 s81, 917504
    buffer_load_dwordx4 v163, s[12:15], s81 offen nt lds
    s_add_u32 m0, s80, 15360
    s_mov_b32 s81, 917504
    buffer_load_dwordx4 v164, s[12:15], s81 offen nt lds
    s_mov_b32 s81, 786432
    buffer_load_dwordx4 v[56:59], v165, s[4:7], s81 offen nt
    s_mov_b32 s81, 196608
    buffer_load_dwordx4 v[120:123], v166, s[40:43], s81 offen nt
    s_mov_b32 s81, 917504
    buffer_load_dwordx4 v[60:63], v165, s[4:7], s81 offen nt
    s_mov_b32 s81, 212992
    buffer_load_dwordx4 v[124:127], v166, s[40:43], s81 offen nt
    s_lshl_b32 s51, s18, 11
    v_add_u32 v243, s51, v1
    v_add_u32 v244, 0x8000, v243
    v_lshrrev_b32 v212, 3, v210
    v_lshl_add_u32 v24, v212, 7, v5
    v_add_u32 v24, 128, v24
    s_and_b32 s22, s18, 1
    s_lshl_b32 s22, s22, 12
    v_add_u32 v242, s22, v1
    s_lshl_b32 s21, s21, 10
    s_add_u32 s21, s21, 0xc000
    v_add_u32 v23, s21, v242
    v_lshlrev_b32 v241, 7, v209
    v_bfe_u32 v212, v0, 2, 1
    v_lshl_add_u32 v241, v212, 6, v241
    v_bfe_u32 v212, v0, 3, 1
    v_lshl_add_u32 v241, v212, 5, v241
    v_bfe_u32 v212, v0, 0, 1
    v_lshl_add_u32 v241, v212, 4, v241
    v_and_b32 v212, 7, v208
    v_lshlrev_b32 v6, 4, v212
    v_lshl_add_u32 v6, v209, 7, v6
    s_lshl_b32 s21, s17, 9
    s_add_u32 s22, s21, 16384
    s_add_u32 m0, s80, 16384
    s_mov_b32 s81, 1048576
    buffer_load_dwordx4 v163, s[12:15], s81 offen nt lds
    s_add_u32 m0, s80, 17408
    s_mov_b32 s81, 1048576
    buffer_load_dwordx4 v164, s[12:15], s81 offen nt lds
    s_add_u32 m0, s80, 18432
    s_mov_b32 s81, 1179648
    buffer_load_dwordx4 v163, s[12:15], s81 offen nt lds
    s_add_u32 m0, s80, 19456
    s_mov_b32 s81, 1179648
    buffer_load_dwordx4 v164, s[12:15], s81 offen nt lds
    s_mov_b32 s81, 1048576
    buffer_load_dwordx4 v[64:67], v165, s[4:7], s81 offen nt
    s_mov_b32 s81, 262144
    buffer_load_dwordx4 v[128:131], v166, s[40:43], s81 offen nt
    s_mov_b32 s81, 1179648
    buffer_load_dwordx4 v[68:71], v165, s[4:7], s81 offen nt
    s_mov_b32 s81, 278528
    buffer_load_dwordx4 v[132:135], v166, s[40:43], s81 offen nt
    v_add_u32 v6, s22, v6
    v_lshrrev_b32 v212, 3, v208
    v_and_b32 v213, 2, v209
    v_add_u32 v212, v212, v213
    v_lshlrev_b32 v7, 7, v212
    v_and_b32 v212, 1, v209
    v_lshl_add_u32 v7, v212, 6, v7
    v_bfe_u32 v212, v208, 1, 2
    v_lshl_add_u32 v7, v212, 2, v7
    s_lshl_b32 s21, s29, 9
    s_lshl_b32 s22, s18, 4
    s_add_u32 s21, s21, s22
    v_add_u32 v7, s21, v7
    v_bfe_u32 v212, v210, 1, 3
    v_and_b32 v213, 1, v210
    v_lshlrev_b32 v27, 11, v212
    v_lshl_add_u32 v27, v213, 3, v27
    v_lshl_add_u32 v27, v209, 4, v27
    s_lshl_b32 s21, s29, 6
    v_add_u32 v27, s21, v27
    v_lshlrev_b32 v212, 2, v210
    s_xor_b32 s21, s18, 3
    s_mul_i32 s21, s21, 768
    s_add_u32 s21, s21, 0
    s_add_u32 m0, s80, 20480
    s_mov_b32 s81, 1310720
    buffer_load_dwordx4 v163, s[12:15], s81 offen nt lds
    s_add_u32 m0, s80, 21504
    s_mov_b32 s81, 1310720
    buffer_load_dwordx4 v164, s[12:15], s81 offen nt lds
    s_add_u32 m0, s80, 22528
    s_mov_b32 s81, 1441792
    buffer_load_dwordx4 v163, s[12:15], s81 offen nt lds
    s_add_u32 m0, s80, 23552
    s_mov_b32 s81, 1441792
    buffer_load_dwordx4 v164, s[12:15], s81 offen nt lds
    s_mov_b32 s81, 1310720
    buffer_load_dwordx4 v[72:75], v165, s[4:7], s81 offen nt
    s_mov_b32 s81, 327680
    buffer_load_dwordx4 v[136:139], v166, s[40:43], s81 offen nt
    s_mov_b32 s81, 1441792
    buffer_load_dwordx4 v[76:79], v165, s[4:7], s81 offen nt
    s_mov_b32 s81, 344064
    buffer_load_dwordx4 v[140:143], v166, s[40:43], s81 offen nt
    v_add_u32 v238, s21, v212
    v_lshlrev_b32 v12, 1, v238
    s_xor_b32 s21, s18, 2
    s_mul_i32 s21, s21, 768
    s_add_u32 s21, s21, 256
    v_add_u32 v239, s21, v212
    v_lshlrev_b32 v13, 1, v239
    s_xor_b32 s21, s18, 1
    s_mul_i32 s21, s21, 768
    s_add_u32 s21, s21, 512
    v_add_u32 v240, s21, v212
    v_lshlrev_b32 v14, 1, v240
    s_mul_i32 s21, s18, 768
    v_add_u32 v17, s21, v212
    v_lshlrev_b32 v15, 1, v17
    s_lshl_b32 s21, s18, 10
    v_add_u32 v16, s21, v1
    global_load_dwordx2 v[246:247], v27, s[84:85]
    v_and_b32 v208, 15, v0
    v_bfe_u32 v209, v0, 6, 1
    v_lshl_add_u32 v208, v209, 4, v208
    v_bfe_u32 v209, v0, 4, 2
    v_lshlrev_b32 v209, 2, v209
    v_sub_u32 v208, v208, v209
    s_or_b32 s76, s2, s18
    s_cbranch_scc1 L_rw_3
    s_lshl_b32 s78, s16, 3
    s_add_u32 s78, s78, 128
    s_mov_b32 s79, 0
L_rp_4:
    s_load_dwordx2 s[76:77], s[98:99], s78 glc
    s_add_u32 s79, s79, 1
    s_cmp_gt_u32 s79, 0x100000
    s_cbranch_scc1 chain_kernel_abort
    s_waitcnt lgkmcnt(0)
    s_cmp_lt_u32 s77, 0x2000
    s_cbranch_scc1 L_rp_4
    s_lshr_b32 s77, s95, 8
    s_cmp_eq_u32 s76, -1
    s_cselect_b32 s94, -1, s77
L_rw_3:
    s_waitcnt vmcnt(44)
    s_add_u32 m0, s80, 24576
    s_mov_b32 s81, 1572864
    buffer_load_dwordx4 v163, s[12:15], s81 offen nt lds
    s_add_u32 m0, s80, 25600
    s_mov_b32 s81, 1572864
    buffer_load_dwordx4 v164, s[12:15], s81 offen nt lds
    s_add_u32 m0, s80, 26624
    s_mov_b32 s81, 1703936
    buffer_load_dwordx4 v163, s[12:15], s81 offen nt lds
    s_add_u32 m0, s80, 27648
    s_mov_b32 s81, 1703936
    buffer_load_dwordx4 v164, s[12:15], s81 offen nt lds
    s_mov_b32 s81, 1572864
    buffer_load_dwordx4 v[80:83], v165, s[4:7], s81 offen nt
    s_mov_b32 s81, 393216
    buffer_load_dwordx4 v[144:147], v166, s[40:43], s81 offen nt
    s_mov_b32 s81, 1703936
    buffer_load_dwordx4 v[84:87], v165, s[4:7], s81 offen nt
    s_mov_b32 s81, 409600
    buffer_load_dwordx4 v[148:151], v166, s[40:43], s81 offen nt
    v_mov_b32 v209, 0xff800000
    v_cmp_gt_i32 vcc, 0, v208
    s_nop 1
    v_cndmask_b32 v226, 0, v209, vcc
    v_cmp_gt_i32 vcc, 1, v208
    s_nop 1
    v_cndmask_b32 v227, 0, v209, vcc
    v_cmp_gt_i32 vcc, 2, v208
    s_nop 1
    v_cndmask_b32 v228, 0, v209, vcc
    v_cmp_gt_i32 vcc, 3, v208
    s_nop 1
    v_cndmask_b32 v229, 0, v209, vcc
    v_cmp_gt_i32 vcc, 16, v208
    s_nop 1
    v_cndmask_b32 v230, 0, v209, vcc
    v_cmp_gt_i32 vcc, 17, v208
    s_nop 1
    v_cndmask_b32 v231, 0, v209, vcc
    v_cmp_gt_i32 vcc, 18, v208
    s_nop 1
    v_cndmask_b32 v232, 0, v209, vcc
    v_cmp_gt_i32 vcc, 19, v208
    s_nop 1
    v_cndmask_b32 v233, 0, v209, vcc
    s_waitcnt vmcnt(44)
    s_add_u32 m0, s80, 28672
    s_mov_b32 s81, 1835008
    buffer_load_dwordx4 v163, s[12:15], s81 offen nt lds
    s_add_u32 m0, s80, 29696
    s_mov_b32 s81, 1835008
    buffer_load_dwordx4 v164, s[12:15], s81 offen nt lds
    s_add_u32 m0, s80, 30720
    s_mov_b32 s81, 1966080
    buffer_load_dwordx4 v163, s[12:15], s81 offen nt lds
    s_add_u32 m0, s80, 31744
    s_mov_b32 s81, 1966080
    buffer_load_dwordx4 v164, s[12:15], s81 offen nt lds
    s_mov_b32 s81, 1835008
    buffer_load_dwordx4 v[88:91], v165, s[4:7], s81 offen nt
    s_mov_b32 s81, 458752
    buffer_load_dwordx4 v[152:155], v166, s[40:43], s81 offen nt
    s_mov_b32 s81, 1966080
    buffer_load_dwordx4 v[92:95], v165, s[4:7], s81 offen nt
    s_mov_b32 s81, 475136
    buffer_load_dwordx4 v[156:159], v166, s[40:43], s81 offen nt
    s_cmp_lg_u32 s2, 0
    s_cbranch_scc1 L_rok_5
    v_mov_b32 v208, 31744
    s_cmp_lg_u32 s18, 0
    s_cbranch_scc1 L_rw_6
    v_mov_b32 v209, s94
    ds_write_b32 v208, v209
    s_waitcnt lgkmcnt(0)
L_rw_6:
    s_barrier
    ds_read_b32 v209, v208
    s_waitcnt lgkmcnt(0)
    v_readfirstlane_b32 s20, v209
    s_mov_b32 s2, 1
    s_cmp_eq_u32 s20, -1
    s_cbranch_scc1 L_rok_5
    s_mov_b32 s17, s20
    s_waitcnt vmcnt(0)
    s_barrier
    s_cmp_ge_u32 s17, 32
    s_cbranch_scc1 chain_kernel_end
    s_branch chain_start
L_rok_5:
    s_lshl_b32 s42, s18, 18
    s_add_u32 s42, s42, s53
    buffer_store_dwordx4 v[28:31], v22, s[8:11], s42 offen
    s_lshl_b32 s21, s29, 9
    s_add_u32 s21, s21, s42
    buffer_store_dwordx2 v[28:29], v26, s[8:11], s21 offen
    s_xor_b32 s21, s21, 20480
    buffer_store_dwordx2 v[28:29], v26, s[8:11], s21 offen
    s_lshl_b32 s62, s16, 8
    s_add_u32 s62, s62, 0xb200000
    s_cmp_eq_u32 s17, 1
    s_cselect_b32 s21, s62, 0x10000000
    v_mov_b32 v248, 0
    s_add_u32 s21, s21, 4096
    buffer_store_dword v248, v248, s[8:11], s21 offen sc1
    v_mov_b32 v249, 4
    global_load_dword v249, v249, s[60:61] sc1
    v_bfe_u32 v160, v0, 4, 2
    v_lshlrev_b32 v160, 3, v160
    v_bfe_u32 v162, v0, 2, 2
    v_add_u32 v160, v160, v162
    v_and_b32 v161, 3, v0
    v_bfe_u32 v163, v0, 3, 1
    v_lshlrev_b32 v162, 7, v160
    v_and_b32 v164, 1, v0
    v_lshl_add_u32 v162, v164, 5, v162
    v_bfe_u32 v164, v0, 1, 1
    v_lshl_add_u32 v162, v164, 3, v162
    v_lshl_add_u32 v162, v163, 4, v162
    s_lshr_b32 s21, s18, 1
    s_xor_b32 s21, s21, 1
    s_lshl_b32 s21, s21, 6
    s_add_u32 s21, s21, s80
    v_add_u32 v167, s21, v162
    v_xor_b32 v168, 256, v167
    s_lshr_b32 s21, s18, 1
    s_xor_b32 s21, s21, 0
    s_lshl_b32 s21, s21, 6
    s_add_u32 s21, s21, s80
    v_add_u32 v169, s21, v162
    v_xor_b32 v170, 256, v169
    s_waitcnt vmcnt(44)
    ds_read_b64_tr_b16 a[0:1], v167 offset:0
    ds_read_b64_tr_b16 a[2:3], v167 offset:512
    ds_read_b64_tr_b16 a[4:5], v167 offset:4096
    ds_read_b64_tr_b16 a[6:7], v167 offset:4608
    ds_read_b64_tr_b16 a[32:33], v168 offset:0
    ds_read_b64_tr_b16 a[34:35], v168 offset:512
    ds_read_b64_tr_b16 a[36:37], v168 offset:4096
    ds_read_b64_tr_b16 a[38:39], v168 offset:4608
    s_waitcnt lgkmcnt(0)
    ds_read_b64_tr_b16 a[64:65], v169 offset:0
    ds_read_b64_tr_b16 a[66:67], v169 offset:512
    ds_read_b64_tr_b16 a[68:69], v169 offset:4096
    ds_read_b64_tr_b16 a[70:71], v169 offset:4608
    ds_read_b64_tr_b16 a[96:97], v170 offset:0
    ds_read_b64_tr_b16 a[98:99], v170 offset:512
    ds_read_b64_tr_b16 a[100:101], v170 offset:4096
    ds_read_b64_tr_b16 a[102:103], v170 offset:4608
    s_waitcnt lgkmcnt(0)
    s_waitcnt vmcnt(41)
    ds_read_b64_tr_b16 a[8:9], v167 offset:8192
    ds_read_b64_tr_b16 a[10:11], v167 offset:8704
    ds_read_b64_tr_b16 a[12:13], v167 offset:12288
    ds_read_b64_tr_b16 a[14:15], v167 offset:12800
    ds_read_b64_tr_b16 a[40:41], v168 offset:8192
    ds_read_b64_tr_b16 a[42:43], v168 offset:8704
    ds_read_b64_tr_b16 a[44:45], v168 offset:12288
    ds_read_b64_tr_b16 a[46:47], v168 offset:12800
    s_waitcnt lgkmcnt(0)
    ds_read_b64_tr_b16 a[72:73], v169 offset:8192
    ds_read_b64_tr_b16 a[74:75], v169 offset:8704
    ds_read_b64_tr_b16 a[76:77], v169 offset:12288
    ds_read_b64_tr_b16 a[78:79], v169 offset:12800
    ds_read_b64_tr_b16 a[104:105], v170 offset:8192
    ds_read_b64_tr_b16 a[106:107], v170 offset:8704
    ds_read_b64_tr_b16 a[108:109], v170 offset:12288
    ds_read_b64_tr_b16 a[110:111], v170 offset:12800
    s_waitcnt lgkmcnt(0)
    s_waitcnt vmcnt(25)
    ds_read_b64_tr_b16 a[16:17], v167 offset:16384
    ds_read_b64_tr_b16 a[18:19], v167 offset:16896
    ds_read_b64_tr_b16 a[20:21], v167 offset:20480
    ds_read_b64_tr_b16 a[22:23], v167 offset:20992
    ds_read_b64_tr_b16 a[48:49], v168 offset:16384
    ds_read_b64_tr_b16 a[50:51], v168 offset:16896
    ds_read_b64_tr_b16 a[52:53], v168 offset:20480
    ds_read_b64_tr_b16 a[54:55], v168 offset:20992
    s_waitcnt lgkmcnt(0)
    ds_read_b64_tr_b16 a[80:81], v169 offset:16384
    ds_read_b64_tr_b16 a[82:83], v169 offset:16896
    ds_read_b64_tr_b16 a[84:85], v169 offset:20480
    ds_read_b64_tr_b16 a[86:87], v169 offset:20992
    ds_read_b64_tr_b16 a[112:113], v170 offset:16384
    ds_read_b64_tr_b16 a[114:115], v170 offset:16896
    ds_read_b64_tr_b16 a[116:117], v170 offset:20480
    ds_read_b64_tr_b16 a[118:119], v170 offset:20992
    s_waitcnt lgkmcnt(0)
    s_waitcnt vmcnt(9)
    ds_read_b64_tr_b16 a[24:25], v167 offset:24576
    ds_read_b64_tr_b16 a[26:27], v167 offset:25088
    ds_read_b64_tr_b16 a[28:29], v167 offset:28672
    ds_read_b64_tr_b16 a[30:31], v167 offset:29184
    ds_read_b64_tr_b16 a[56:57], v168 offset:24576
    ds_read_b64_tr_b16 a[58:59], v168 offset:25088
    ds_read_b64_tr_b16 a[60:61], v168 offset:28672
    ds_read_b64_tr_b16 a[62:63], v168 offset:29184
    s_waitcnt lgkmcnt(0)
    ds_read_b64_tr_b16 a[88:89], v169 offset:24576
    ds_read_b64_tr_b16 a[90:91], v169 offset:25088
    ds_read_b64_tr_b16 a[92:93], v169 offset:28672
    ds_read_b64_tr_b16 a[94:95], v169 offset:29184
    ds_read_b64_tr_b16 a[120:121], v170 offset:24576
    ds_read_b64_tr_b16 a[122:123], v170 offset:25088
    ds_read_b64_tr_b16 a[124:125], v170 offset:28672
    ds_read_b64_tr_b16 a[126:127], v170 offset:29184
    s_waitcnt lgkmcnt(0)
    v_add_u32 v171, s80, v1
    v_lshlrev_b32 v162, 6, v160
    v_add_u32 v162, s80, v162
    v_lshl_add_u32 v169, v161, 3, v162
    v_lshl_add_u32 v169, v163, 5, v169
    v_xor_b32 v170, 128, v169
    s_waitcnt vmcnt(0)
    s_barrier
    s_load_dwordx16 s[64:79], s[0:1], 0
    v_lshlrev_b32 v208, 3, v1
    s_lshl2_add_u32 s20, s47, s18
    s_lshl_b32 s20, s20, 13
    s_and_b32 s21, s20, 0x1fffff
    s_waitcnt lgkmcnt(0)
    s_bitcmp1_b32 s20, 21
    s_cselect_b64 s[22:23], s[72:73], s[70:71]
    s_mov_b32 s12, s22
    s_and_b32 s13, s23, 0xffff
    s_mov_b32 s14, 0x200000
    s_mov_b32 s15, 0x00020000
    buffer_load_dword v250, v208, s[12:15], s21 offen
    s_bitcmp1_b32 s20, 21
    s_cselect_b64 s[22:23], s[76:77], s[74:75]
    s_mov_b32 s12, s22
    s_and_b32 s13, s23, 0xffff
    s_mov_b32 s14, 0x200000
    s_mov_b32 s15, 0x00020000
    buffer_load_dword v250, v208, s[12:15], s21 offen
    s_mov_b32 s12, s82
    s_and_b32 s13, s83, 0xffff
    s_mov_b32 s14, 0x400000
    s_mov_b32 s15, 0x00020000
    buffer_load_dword v250, v208, s[12:15], s20 offen
    v_and_b32 v208, 15, v0
    v_lshlrev_b32 v208, 7, v208
    s_lshl_b32 s21, s17, 11
    s_add_u32 s21, s21, s42
    buffer_load_dword v250, v208, s[8:11], s21 offen sc1
    s_cmp_lg_u32 s18, 0
    s_cbranch_scc1 L_m0_7
    s_lshl2_add_u32 s21, s17, s62
    buffer_store_dword v28, v248, s[8:11], s21 offen
    s_lshl_b32 s21, s29, 9
    s_add_u32 s21, s21, s53
    v_min_u32 v246, 0xfffffffe, v246
    v_min_u32 v247, 0xfffffffe, v247
    buffer_store_dwordx2 v[246:247], v26, s[8:11], s21 offen
L_m0_7:
    ds_write_b128 v171, v[32:35] offset:0
    ds_write_b128 v171, v[36:39] offset:1024
    ds_write_b128 v171, v[40:43] offset:2048
    ds_write_b128 v171, v[44:47] offset:3072
    ds_write_b128 v171, v[48:51] offset:4096
    ds_write_b128 v171, v[52:55] offset:5120
    ds_write_b128 v171, v[56:59] offset:6144
    ds_write_b128 v171, v[60:63] offset:7168
    ds_write_b128 v171, v[64:67] offset:8192
    ds_write_b128 v171, v[68:71] offset:9216
    ds_write_b128 v171, v[72:75] offset:10240
    ds_write_b128 v171, v[76:79] offset:11264
    ds_write_b128 v171, v[80:83] offset:12288
    ds_write_b128 v171, v[84:87] offset:13312
    ds_write_b128 v171, v[88:91] offset:14336
    ds_write_b128 v171, v[92:95] offset:15360
    s_waitcnt lgkmcnt(0)
    ds_read_b64_tr_b16 a[128:129], v169 offset:0
    ds_read_b64_tr_b16 a[130:131], v169 offset:256
    ds_read_b64_tr_b16 a[132:133], v169 offset:2048
    ds_read_b64_tr_b16 a[134:135], v169 offset:2304
    ds_read_b64_tr_b16 a[160:161], v170 offset:0
    ds_read_b64_tr_b16 a[162:163], v170 offset:256
    ds_read_b64_tr_b16 a[164:165], v170 offset:2048
    ds_read_b64_tr_b16 a[166:167], v170 offset:2304
    s_waitcnt lgkmcnt(0)
    ds_read_b64_tr_b16 a[136:137], v169 offset:4096
    ds_read_b64_tr_b16 a[138:139], v169 offset:4352
    ds_read_b64_tr_b16 a[140:141], v169 offset:6144
    ds_read_b64_tr_b16 a[142:143], v169 offset:6400
    ds_read_b64_tr_b16 a[168:169], v170 offset:4096
    ds_read_b64_tr_b16 a[170:171], v170 offset:4352
    ds_read_b64_tr_b16 a[172:173], v170 offset:6144
    ds_read_b64_tr_b16 a[174:175], v170 offset:6400
    s_waitcnt lgkmcnt(0)
    ds_read_b64_tr_b16 a[144:145], v169 offset:8192
    ds_read_b64_tr_b16 a[146:147], v169 offset:8448
    ds_read_b64_tr_b16 a[148:149], v169 offset:10240
    ds_read_b64_tr_b16 a[150:151], v169 offset:10496
    ds_read_b64_tr_b16 a[176:177], v170 offset:8192
    ds_read_b64_tr_b16 a[178:179], v170 offset:8448
    ds_read_b64_tr_b16 a[180:181], v170 offset:10240
    ds_read_b64_tr_b16 a[182:183], v170 offset:10496
    s_waitcnt lgkmcnt(0)
    ds_read_b64_tr_b16 a[152:153], v169 offset:12288
    ds_read_b64_tr_b16 a[154:155], v169 offset:12544
    ds_read_b64_tr_b16 a[156:157], v169 offset:14336
    ds_read_b64_tr_b16 a[158:159], v169 offset:14592
    ds_read_b64_tr_b16 a[184:185], v170 offset:12288
    ds_read_b64_tr_b16 a[186:187], v170 offset:12544
    ds_read_b64_tr_b16 a[188:189], v170 offset:14336
    ds_read_b64_tr_b16 a[190:191], v170 offset:14592
    s_waitcnt lgkmcnt(0)
    ds_write_b128 v171, v[96:99] offset:16384
    ds_write_b128 v171, v[100:103] offset:17408
    ds_write_b128 v171, v[104:107] offset:18432
    ds_write_b128 v171, v[108:111] offset:19456
    ds_write_b128 v171, v[112:115] offset:20480
    ds_write_b128 v171, v[116:119] offset:21504
    ds_write_b128 v171, v[120:123] offset:22528
    ds_write_b128 v171, v[124:127] offset:23552
    ds_write_b128 v171, v[128:131] offset:24576
    ds_write_b128 v171, v[132:135] offset:25600
    ds_write_b128 v171, v[136:139] offset:26624
    ds_write_b128 v171, v[140:143] offset:27648
    ds_write_b128 v171, v[144:147] offset:28672
    ds_write_b128 v171, v[148:151] offset:29696
    ds_write_b128 v171, v[152:155] offset:30720
    ds_write_b128 v171, v[156:159] offset:31744
    s_waitcnt lgkmcnt(0)
    ds_read_b64_tr_b16 a[192:193], v169 offset:16384
    ds_read_b64_tr_b16 a[194:195], v169 offset:16640
    ds_read_b64_tr_b16 a[196:197], v169 offset:18432
    ds_read_b64_tr_b16 a[198:199], v169 offset:18688
    ds_read_b64_tr_b16 a[224:225], v170 offset:16384
    ds_read_b64_tr_b16 a[226:227], v170 offset:16640
    ds_read_b64_tr_b16 a[228:229], v170 offset:18432
    ds_read_b64_tr_b16 a[230:231], v170 offset:18688
    s_waitcnt lgkmcnt(0)
    ds_read_b64_tr_b16 a[200:201], v169 offset:20480
    ds_read_b64_tr_b16 a[202:203], v169 offset:20736
    ds_read_b64_tr_b16 a[204:205], v169 offset:22528
    ds_read_b64_tr_b16 a[206:207], v169 offset:22784
    ds_read_b64_tr_b16 a[232:233], v170 offset:20480
    ds_read_b64_tr_b16 a[234:235], v170 offset:20736
    ds_read_b64_tr_b16 a[236:237], v170 offset:22528
    ds_read_b64_tr_b16 a[238:239], v170 offset:22784
    s_waitcnt lgkmcnt(0)
    ds_read_b64_tr_b16 a[208:209], v169 offset:24576
    ds_read_b64_tr_b16 a[210:211], v169 offset:24832
    ds_read_b64_tr_b16 a[212:213], v169 offset:26624
    ds_read_b64_tr_b16 a[214:215], v169 offset:26880
    ds_read_b64_tr_b16 a[240:241], v170 offset:24576
    ds_read_b64_tr_b16 a[242:243], v170 offset:24832
    ds_read_b64_tr_b16 a[244:245], v170 offset:26624
    ds_read_b64_tr_b16 a[246:247], v170 offset:26880
    s_waitcnt lgkmcnt(0)
    ds_read_b64_tr_b16 a[216:217], v169 offset:28672
    ds_read_b64_tr_b16 a[218:219], v169 offset:28928
    ds_read_b64_tr_b16 a[220:221], v169 offset:30720
    ds_read_b64_tr_b16 a[222:223], v169 offset:30976
    ds_read_b64_tr_b16 a[248:249], v170 offset:28672
    ds_read_b64_tr_b16 a[250:251], v170 offset:28928
    ds_read_b64_tr_b16 a[252:253], v170 offset:30720
    ds_read_b64_tr_b16 a[254:255], v170 offset:30976
    s_waitcnt lgkmcnt(0)
    s_mov_b32 s19, 0
    s_mov_b32 s55, 0
    s_mov_b32 s30, 0xc0000
    s_mov_b32 s41, s53
    v_mov_b32 v197, 0
    v_mov_b32 v198, 0
    v_mov_b32 v216, 0x3f803f80
    v_mov_b32 v217, 0x3f803f80
    v_mov_b32 v218, 0x3f803f80
    v_mov_b32 v219, 0x3f803f80
    v_mov_b32 v64, 0
    v_mov_b32 v65, 0
    v_mov_b32 v66, 0
    v_mov_b32 v67, 0
    v_mov_b32 v68, 0
    v_mov_b32 v69, 0
    v_mov_b32 v70, 0
    v_mov_b32 v71, 0
    v_mov_b32 v72, 0
    v_mov_b32 v73, 0
    v_mov_b32 v74, 0
    v_mov_b32 v75, 0
    v_mov_b32 v76, 0
    v_mov_b32 v77, 0
    v_mov_b32 v78, 0
    v_mov_b32 v79, 0
    v_mov_b32 v248, 4
    s_branch L_kvw_8_c
L_kvw_8:
    global_load_dword v249, v248, s[60:61] sc1
    s_add_u32 s33, s33, 1
    s_cmp_gt_u32 s33, 0x100000
    s_cbranch_scc1 chain_kernel_abort
    s_waitcnt vmcnt(0)
L_kvw_8_c:
    v_readfirstlane_b32 s20, v249
    s_and_b32 s21, s20, 0xff
    s_cmp_ge_u32 s21, 15
    s_cbranch_scc1 L_kvok_9
    s_sleep 16
    s_branch L_kvw_8
L_kvok_9:
    s_cmp_ge_u32 s20, 0x800
    s_cselect_b32 s50, 0x2000, 0
    s_add_u32 s52, s50, 0x8000000
    s_add_u32 s48, s48, s50
    v_and_b32 v208, 63, v0
    v_lshlrev_b32 v208, 2, v208
    s_lshr_b32 s22, s17, 3
    s_lshl_b32 s22, s22, 14
    s_and_b32 s23, s17, 7
    s_lshl_b32 s23, s23, 10
    s_add_u32 s22, s22, s23
    s_lshl_b32 s23, s18, 8
    s_add_u32 s22, s22, s23
    s_xor_b32 s21, s16, 0
    s_lshl_b32 s21, s21, 16
    s_add_u32 s21, s21, s22
    v_add_u32 v8, s21, v208
    s_xor_b32 s21, s16, 1
    s_lshl_b32 s21, s21, 16
    s_add_u32 s21, s21, s22
    v_add_u32 v9, s21, v208
    s_xor_b32 s21, s16, 2
    s_lshl_b32 s21, s21, 16
    s_add_u32 s21, s21, s22
    v_add_u32 v10, s21, v208
    s_xor_b32 s21, s16, 3
    s_lshl_b32 s21, s21, 16
    s_add_u32 s21, s21, s22
    v_add_u32 v11, s21, v208
    s_barrier
    s_add_u32 s21, s19, 0
    s_min_u32 s21, s21, 63
    s_lshl_b32 s31, s21, 21
    s_lshl_b32 s21, s21, 13
    s_and_b32 s21, s21, 0x2000
    s_xor_b32 s21, s21, s48
    s_add_u32 s31, s31, s21
    s_cmp_lg_u32 s18, 1
    s_cbranch_scc1 L_init0_10
    v_mov_b32 v248, 0
    s_lshl2_add_u32 s20, s17, s18
    s_cmp_lg_u32 s20, 5
    s_cbranch_scc1 L_rlo_12
L_rl_11:
    s_load_dword s20, s[60:61], 64 glc
    s_add_u32 s33, s33, 1
    s_cmp_gt_u32 s33, 0x100000
    s_cbranch_scc1 chain_kernel_abort
    s_waitcnt lgkmcnt(0)
    s_cmp_lt_u32 s20, 96
    s_cbranch_scc1 L_rl_11
    v_mov_b32 v249, 1
    buffer_store_dword v249, v248, s[8:11], s62 offen offset:128
    s_branch L_rlok_13
L_rlo_12:
    buffer_load_dword v249, v248, s[8:11], s62 offen offset:128 sc1
    s_add_u32 s33, s33, 1
    s_cmp_gt_u32 s33, 0x100000
    s_cbranch_scc1 chain_kernel_abort
    s_waitcnt vmcnt(0)
    v_readfirstlane_b32 s20, v249
    s_cmp_ge_u32 s20, 1
    s_cbranch_scc1 L_rlok_13
    s_sleep 1
    s_branch L_rlo_12
L_rlok_13:
    s_mov_b32 m0, 40960
    s_nop 0
    buffer_load_dwordx4 v237, s[8:11], s31 offen offset:0 lds
    buffer_load_dwordx4 v237, s[8:11], s31 offen offset:1024 lds
L_init0_10:
    s_cmp_lg_u32 s18, 2
    s_cbranch_scc1 L_init2_14
    v_and_b32 v248, 31, v0
    v_lshlrev_b32 v248, 2, v248
L_initp_15:
    buffer_load_dword v249, v248, s[8:11], s62 offen sc1
    s_add_u32 s33, s33, 1
    s_cmp_gt_u32 s33, 0x100000
    s_cbranch_scc1 chain_kernel_abort
    s_waitcnt vmcnt(0)
    v_cmp_eq_u32 vcc, 0, v249
    s_cbranch_vccz L_init2_14
    s_sleep 2
    s_branch L_initp_15
L_init2_14:
    s_barrier
    s_mov_b32 m0, s54
    s_nop 0
    buffer_load_dwordx4 v235, s[8:11], s31 offen offset:0 lds
    buffer_load_dwordx4 v235, s[8:11], s31 offen offset:1024 lds
    buffer_load_dwordx4 v235, s[8:11], s31 offen offset:2048 lds
    buffer_load_dwordx4 v235, s[8:11], s31 offen offset:3072 lds
    s_waitcnt vmcnt(0) lgkmcnt(0)
    s_barrier
chain_kernel_loop:
    s_mov_b32 s40, s41
    v_mov_b32 v64, 0
    v_mov_b32 v65, 0
    v_mov_b32 v66, 0
    v_mov_b32 v67, 0
    v_mov_b32 v68, 0
    v_mov_b32 v69, 0
    v_mov_b32 v70, 0
    v_mov_b32 v71, 0
    v_mov_b32 v72, 0
    v_mov_b32 v73, 0
    v_mov_b32 v74, 0
    v_mov_b32 v75, 0
    v_mov_b32 v76, 0
    v_mov_b32 v77, 0
    v_mov_b32 v78, 0
    v_mov_b32 v79, 0
    s_add_u32 s30, s30, 0x40000
    s_and_b32 s30, s30, 0xc0000
    s_xor_b32 s20, s30, 0x80000
    s_add_u32 s42, s53, s20
    s_lshl_b32 s43, s19, 19
    s_lshl_b32 s20, s19, 11
    s_and_b32 s20, s20, 0x2000
    s_xor_b32 s20, s20, s52
    s_add_u32 s43, s43, s20
    s_add_u32 s44, s43, 0x40000
    s_add_u32 s20, s30, 0x40000
    s_and_b32 s20, s20, 0xc0000
    s_add_u32 s41, s53, s20
    s_nop 13
    buffer_load_dwordx4 v[32:35], v2, s[8:11], s40 offen offset:0 sc1
    s_nop 13
    buffer_load_dwordx4 v[36:39], v2, s[8:11], s40 offen offset:1024 sc1
    s_nop 13
    buffer_load_dwordx4 v[40:43], v2, s[8:11], s40 offen offset:2048 sc1
    s_nop 13
    buffer_load_dwordx4 v[44:47], v2, s[8:11], s40 offen offset:3072 sc1
Gq_18_s0123:
    s_waitcnt vmcnt(3)
    v_cmp_eq_u32 vcc, -1, v32
    v_mov_b32_dpp v48, v32 row_ror:8 row_mask:0xf bank_mask:0xf
    v_mov_b32_dpp v49, v33 row_ror:8 row_mask:0xf bank_mask:0xf
    v_mov_b32_dpp v50, v34 row_ror:8 row_mask:0xf bank_mask:0xf
    v_mov_b32_dpp v51, v35 row_ror:8 row_mask:0xf bank_mask:0xf
    s_cbranch_vccnz Gq_18_f0123
    v_smfmac_f32_16x16x64_bf16 v[64:67], v[32:35], a[0:7], v19
    v_smfmac_f32_16x16x64_bf16 v[68:71], v[32:35], a[64:71], v19
Gq_18_s123p0:
    s_waitcnt vmcnt(2)
    v_cmp_eq_u32 vcc, -1, v36
    v_smfmac_f32_16x16x64_bf16 v[64:67], v[48:51], a[32:39], v19
    v_mov_b32_dpp v52, v36 row_ror:8 row_mask:0xf bank_mask:0xf
    v_mov_b32_dpp v53, v37 row_ror:8 row_mask:0xf bank_mask:0xf
    v_smfmac_f32_16x16x64_bf16 v[68:71], v[48:51], a[96:103], v19
    v_mov_b32_dpp v54, v38 row_ror:8 row_mask:0xf bank_mask:0xf
    v_mov_b32_dpp v55, v39 row_ror:8 row_mask:0xf bank_mask:0xf
    s_cbranch_vccnz Gq_18_f123p0
    v_smfmac_f32_16x16x64_bf16 v[64:67], v[36:39], a[8:15], v19
    v_smfmac_f32_16x16x64_bf16 v[68:71], v[36:39], a[72:79], v19
Gq_18_s23p1:
    s_waitcnt vmcnt(1)
    v_cmp_eq_u32 vcc, -1, v40
    v_smfmac_f32_16x16x64_bf16 v[64:67], v[52:55], a[40:47], v19
    v_mov_b32_dpp v56, v40 row_ror:8 row_mask:0xf bank_mask:0xf
    v_mov_b32_dpp v57, v41 row_ror:8 row_mask:0xf bank_mask:0xf
    v_smfmac_f32_16x16x64_bf16 v[68:71], v[52:55], a[104:111], v19
    v_mov_b32_dpp v58, v42 row_ror:8 row_mask:0xf bank_mask:0xf
    v_mov_b32_dpp v59, v43 row_ror:8 row_mask:0xf bank_mask:0xf
    s_cbranch_vccnz Gq_18_f23p1
    v_smfmac_f32_16x16x64_bf16 v[64:67], v[40:43], a[16:23], v19
    v_smfmac_f32_16x16x64_bf16 v[68:71], v[40:43], a[80:87], v19
Gq_18_s3p2:
    s_waitcnt vmcnt(0)
    v_cmp_eq_u32 vcc, -1, v44
    v_smfmac_f32_16x16x64_bf16 v[64:67], v[56:59], a[48:55], v19
    v_mov_b32_dpp v60, v44 row_ror:8 row_mask:0xf bank_mask:0xf
    v_mov_b32_dpp v61, v45 row_ror:8 row_mask:0xf bank_mask:0xf
    v_smfmac_f32_16x16x64_bf16 v[68:71], v[56:59], a[112:119], v19
    v_mov_b32_dpp v62, v46 row_ror:8 row_mask:0xf bank_mask:0xf
    v_mov_b32_dpp v63, v47 row_ror:8 row_mask:0xf bank_mask:0xf
    s_cbranch_vccnz Gq_18_f3p2
    v_smfmac_f32_16x16x64_bf16 v[64:67], v[44:47], a[24:31], v19
    v_smfmac_f32_16x16x64_bf16 v[68:71], v[44:47], a[88:95], v19
    v_smfmac_f32_16x16x64_bf16 v[64:67], v[60:63], a[56:63], v19
    v_smfmac_f32_16x16x64_bf16 v[68:71], v[60:63], a[120:127], v19
Gq_18_done:
    v_max3_u32 v20, v33, v34, v35
    v_max3_u32 v208, v37, v38, v39
    v_max3_u32 v209, v41, v42, v43
    v_max3_u32 v210, v45, v46, v47
    ds_write_b64 v12, v[64:65] offset:0
    ds_write_b64 v13, v[66:67] offset:0
    v_max_u32 v20, v20, v208
    v_max3_u32 v20, v20, v209, v210
    ds_write_b64 v14, v[68:69] offset:0
    s_add_u32 m0, s51, 32768
    v_cmp_eq_u32 vcc, -1, v20
    buffer_load_dwordx4 v243, s[8:11], s31 offen offset:0 lds
    buffer_load_dwordx4 v243, s[8:11], s31 offen offset:1024 lds
    v_smfmac_f32_16x16x64_bf16 v[72:75], v[32:35], a[128:135], v19
    v_smfmac_f32_16x16x64_bf16 v[72:75], v[48:51], a[160:167], v19
    s_cbranch_vccnz Gq_18_redo
    s_waitcnt lgkmcnt(0)
    s_barrier
    ds_read_b64 v[80:81], v15 offset:0
    ds_read_b64 v[82:83], v15 offset:512
    ds_read_b64 v[84:85], v15 offset:1024
    v_smfmac_f32_16x16x64_bf16 v[72:75], v[36:39], a[136:143], v19
    v_smfmac_f32_16x16x64_bf16 v[72:75], v[52:55], a[168:175], v19
    s_waitcnt lgkmcnt(2)
    v_pk_add_f32 v[70:71], v[70:71], v[80:81]
    s_waitcnt lgkmcnt(0)
    v_pk_add_f32 v[82:83], v[82:83], v[84:85]
    v_pk_add_f32 v[70:71], v[70:71], v[82:83]
    v_cvt_pk_bf16_f32 v70, v70, v71
    s_cmp_lg_u32 s18, 0
    s_nop 0
    v_mov_b32_dpp v71, v70 quad_perm:[1,0,3,2] row_mask:0xf bank_mask:0xf
    v_perm_b32 v70, v71, v70, v18
    v_min_u32 v70, 0xfffffffe, v70
    buffer_store_dword v70, v4, s[8:11], s40 offen
    v_smfmac_f32_16x16x64_bf16 v[72:75], v[40:43], a[144:151], v19
    v_smfmac_f32_16x16x64_bf16 v[72:75], v[56:59], a[176:183], v19
    v_smfmac_f32_16x16x64_bf16 v[72:75], v[44:47], a[152:159], v19
    v_smfmac_f32_16x16x64_bf16 v[72:75], v[60:63], a[184:191], v19
    s_nop 7
    ds_write_b128 v16, v[72:75] offset:12288
    s_cbranch_scc1 L_help_16
    s_nop 15
    s_nop 11
    buffer_load_dwordx4 v[148:151], v5, s[8:11], s40 offen offset:0 sc1
    buffer_load_dwordx4 v[152:155], v5, s[8:11], s40 offen offset:1024 sc1
    buffer_load_dwordx4 v[156:159], v5, s[8:11], s40 offen offset:2048 sc1
    buffer_load_dwordx4 v[160:163], v5, s[8:11], s40 offen offset:3072 sc1
    s_waitcnt vmcnt(5) lgkmcnt(0)
    s_barrier
    ds_read_b128 v[104:107], v1 offset:32768
    ds_read_b128 v[108:111], v1 offset:33792
    ds_read_b128 v[112:115], v1 offset:34816
    ds_read_b128 v[116:119], v1 offset:35840
    ds_read_b128 v[120:123], v1 offset:36864
    ds_read_b128 v[124:127], v1 offset:37888
    ds_read_b128 v[128:131], v1 offset:38912
    ds_read_b128 v[132:135], v1 offset:39936
    ds_read_b128 v[136:139], v1 offset:40960
    ds_read_b128 v[140:143], v1 offset:41984
    buffer_load_dwordx4 v[164:167], v5, s[8:11], s40 offen offset:0 sc1
    buffer_load_dwordx4 v[168:171], v5, s[8:11], s40 offen offset:1024 sc1
    buffer_load_dwordx4 v[172:175], v5, s[8:11], s40 offen offset:2048 sc1
    buffer_load_dwordx4 v[176:179], v5, s[8:11], s40 offen offset:3072 sc1
    s_nop 13
    buffer_load_dwordx4 v[32:35], v5, s[8:11], s40 offen offset:0 sc1
    buffer_load_dwordx4 v[36:39], v5, s[8:11], s40 offen offset:1024 sc1
    buffer_load_dwordx4 v[40:43], v5, s[8:11], s40 offen offset:2048 sc1
    buffer_load_dwordx4 v[44:47], v5, s[8:11], s40 offen offset:3072 sc1
    s_waitcnt lgkmcnt(0)
L_sd_19_0_0:
    s_waitcnt vmcnt(11)
    v_max3_u32 v20, v148, v149, v150
    v_mfma_f32_16x16x32_bf16 v[88:91], v[148:151], v[148:151], 0
    v_max_u32 v20, v20, v151
    v_cmp_eq_u32 vcc, -1, v20
    v_mfma_f32_16x16x32_bf16 v[84:87], v[120:123], v[148:151], 0
    v_mfma_f32_16x16x32_bf16 v[80:83], v[104:107], v[148:151], 0
    s_cbranch_vccnz L_sd_19_1_0
L_sd_19_0_1:
    s_waitcnt vmcnt(10)
    v_max3_u32 v20, v152, v153, v154
    v_mfma_f32_16x16x32_bf16 v[100:103], v[152:155], v[152:155], v[88:91]
    v_max_u32 v20, v20, v155
    v_cmp_eq_u32 vcc, -1, v20
    v_mfma_f32_16x16x32_bf16 v[96:99], v[124:127], v[152:155], v[84:87]
    v_mfma_f32_16x16x32_bf16 v[92:95], v[108:111], v[152:155], v[80:83]
    s_cbranch_vccnz L_sd_19_1_1
L_sd_19_0_2:
    s_waitcnt vmcnt(9)
    v_max3_u32 v20, v156, v157, v158
    v_mfma_f32_16x16x32_bf16 v[228:231], v[156:159], v[156:159], v[100:103]
    v_max_u32 v20, v20, v159
    v_cmp_eq_u32 vcc, -1, v20
    v_mfma_f32_16x16x32_bf16 v[224:227], v[128:131], v[156:159], v[96:99]
    v_mfma_f32_16x16x32_bf16 v[220:223], v[112:115], v[156:159], v[92:95]
    s_cbranch_vccnz L_sd_19_1_2
L_sd_19_0_3:
    s_waitcnt vmcnt(8)
    v_max3_u32 v20, v160, v161, v162
    v_mfma_f32_16x16x32_bf16 v[188:191], v[160:163], v[160:163], v[228:231]
    v_max_u32 v20, v20, v163
    v_cmp_eq_u32 vcc, -1, v20
    v_mfma_f32_16x16x32_bf16 v[184:187], v[132:135], v[160:163], v[224:227]
    v_mfma_f32_16x16x32_bf16 v[180:183], v[116:119], v[160:163], v[220:223]
    v_mov_b32_dpp v188, v189 row_ror:8 row_mask:0xf bank_mask:0xc
    v_mov_b32_dpp v190, v191 row_ror:8 row_mask:0xf bank_mask:0xc
    s_cbranch_vccnz L_sd_19_1_3
L_sd_19:
    s_barrier
    v_permlane32_swap_b32 v188, v190
    ds_read_b64 v[144:145], v26 offset:28672
    s_cmp_eq_u32 s19, 63
    s_cbranch_scc1 chain_kernel_fin
    v_mov_b32_dpp v180, v184 row_ror:8 row_mask:0xf bank_mask:0xc
    v_mov_b32_dpp v181, v185 row_ror:8 row_mask:0xf bank_mask:0xc
    v_mov_b32_dpp v182, v186 row_ror:8 row_mask:0xf bank_mask:0xc
    v_mov_b32_dpp v183, v187 row_ror:8 row_mask:0xf bank_mask:0xc
    v_max3_f32 v208, v190, v180, v181
    v_max3_f32 v208, v208, v182, v183
    v_cvt_pk_bf16_f32 v180, 0, v180
    v_cvt_pk_bf16_f32 v181, 0, v181
    v_max_f32_dpp v208, v208, v208 row_ror:8 row_mask:0xf bank_mask:0xf
    v_mov_b32 v209, v208
    v_cvt_pk_bf16_f32 v182, 0, v182
    v_cvt_pk_bf16_f32 v183, 0, v183
    v_permlane16_swap_b32 v208, v209
    v_cvt_pk_bf16_f32 v190, 0, v190
    v_max_f32 v208, v208, v209
    v_mov_b32 v209, v208
    v_pk_mul_f32 v[180:181], v[180:181], s[58:59]
    v_pk_mul_f32 v[182:183], v[182:183], s[58:59]
    v_permlane32_swap_b32 v208, v209
    v_mul_f32 v190, s58, v190
    v_max_f32 v208, v208, v209
    v_cvt_pk_bf16_f32 v190, 0, v190
    v_cvt_pk_bf16_f32 v208, 0, v208
    v_cvt_pk_bf16_f32 v180, 0, v180
    v_mul_f32 v208, s58, v208
    v_cvt_pk_bf16_f32 v181, 0, v181
    v_cvt_pk_bf16_f32 v208, 0, v208
    v_cvt_pk_bf16_f32 v182, 0, v182
    v_mul_f32 v208, s56, v208
    v_cvt_pk_bf16_f32 v183, 0, v183
    v_fma_f32 v190, v190, s56, -v208
    v_pk_fma_f32 v[180:181], v[180:181], s[56:57], v[208:209] op_sel_hi:[1,1,0] neg_lo:[0,0,1] neg_hi:[0,0,1]
    v_exp_f32 v190, v190
    v_pk_fma_f32 v[182:183], v[182:183], s[56:57], v[208:209] op_sel_hi:[1,1,0] neg_lo:[0,0,1] neg_hi:[0,0,1]
    v_exp_f32 v180, v180
    v_mov_b32_dpp v209, v190 row_ror:8 row_mask:0xf bank_mask:0xf
    v_exp_f32 v181, v181
    v_cvt_pk_bf16_f32 v196, v190, v209
    v_cvt_pk_bf16_f32 v199, v190, v209
    v_exp_f32 v182, v182
    v_mfma_f32_16x16x16_bf16 v[184:187], v[216:217], v[196:197], 0
    v_exp_f32 v183, v183
    s_waitcnt lgkmcnt(0)
    v_mfma_f32_16x16x16_bf16 v[200:203], v[144:145], v[196:197], 0
    v_cvt_pk_bf16_f32 v192, v180, v181
    v_cvt_pk_bf16_f32 v193, v182, v183
    v_mfma_f32_16x16x16_bf16 v[204:207], v[144:145], v[198:199], 0
    v_mov_b32_dpp v194, v192 row_ror:8 row_mask:0xf bank_mask:0xf
    v_mov_b32_dpp v195, v193 row_ror:8 row_mask:0xf bank_mask:0xf
    s_mov_b64 exec, s[24:25]
    s_nop 0
    v_mfma_f32_16x16x32_bf16 v[184:187], v[216:219], v[192:195], v[184:187]
    v_mfma_f32_16x16x32_bf16 v[200:203], v[136:139], v[192:195], v[200:203]
    v_mfma_f32_16x16x32_bf16 v[204:207], v[140:143], v[192:195], v[204:207]
    s_nop 0
    v_rcp_f32 v184, v184
    s_nop 1
    v_pk_mul_f32 v[200:201], v[200:201], v[184:185] op_sel_hi:[1,0]
    v_pk_mul_f32 v[202:203], v[202:203], v[184:185] op_sel_hi:[1,0]
    v_cvt_pk_bf16_f32 v200, v200, v201
    v_cvt_pk_bf16_f32 v201, v202, v203
    v_pk_mul_f32 v[204:205], v[204:205], v[184:185] op_sel_hi:[1,0]
    v_pk_mul_f32 v[206:207], v[206:207], v[184:185] op_sel_hi:[1,0]
    v_cvt_pk_bf16_f32 v202, v204, v205
    v_cvt_pk_bf16_f32 v203, v206, v207
    v_min_u32 v200, 0xfffffffe, v200
    v_min_u32 v201, 0xfffffffe, v201
    v_min_u32 v202, 0xfffffffe, v202
    v_min_u32 v203, 0xfffffffe, v203
    buffer_store_dwordx4 v[200:203], v6, s[8:11], s40 offen
    s_mov_b64 exec, -1
L_b4_17:
    s_barrier
    s_add_u32 s21, s19, 1
    s_min_u32 s21, s21, 63
    s_lshl_b32 s31, s21, 21
    s_lshl_b32 s21, s21, 13
    s_and_b32 s21, s21, 0x2000
    s_xor_b32 s21, s21, s48
    s_add_u32 s31, s31, s21
    s_add_u32 s19, s19, 1
    s_nop 15
    s_nop 11
    buffer_load_dwordx4 v[32:35], v3, s[8:11], s40 offen offset:0 sc1
    s_nop 13
    buffer_load_dwordx4 v[36:39], v3, s[8:11], s40 offen offset:1024 sc1
    s_nop 13
    buffer_load_dwordx4 v[40:43], v3, s[8:11], s40 offen offset:2048 sc1
    s_nop 13
    buffer_load_dwordx4 v[44:47], v3, s[8:11], s40 offen offset:3072 sc1
Go_20_s0123:
    s_waitcnt vmcnt(3)
    v_cmp_eq_u32 vcc, -1, v32
    v_mov_b32_dpp v48, v32 row_ror:8 row_mask:0xf bank_mask:0xf
    v_mov_b32_dpp v49, v33 row_ror:8 row_mask:0xf bank_mask:0xf
    v_mov_b32_dpp v50, v34 row_ror:8 row_mask:0xf bank_mask:0xf
    v_mov_b32_dpp v51, v35 row_ror:8 row_mask:0xf bank_mask:0xf
    s_cbranch_vccnz Go_20_f0123
    v_smfmac_f32_16x16x64_bf16 v[76:79], v[32:35], a[192:199], v19
    v_smfmac_f32_16x16x64_bf16 v[76:79], v[48:51], a[224:231], v19
Go_20_s123:
    s_waitcnt vmcnt(2)
    v_cmp_eq_u32 vcc, -1, v36
    v_mov_b32_dpp v52, v36 row_ror:8 row_mask:0xf bank_mask:0xf
    v_mov_b32_dpp v53, v37 row_ror:8 row_mask:0xf bank_mask:0xf
    v_mov_b32_dpp v54, v38 row_ror:8 row_mask:0xf bank_mask:0xf
    v_mov_b32_dpp v55, v39 row_ror:8 row_mask:0xf bank_mask:0xf
    s_cbranch_vccnz Go_20_f123
    v_smfmac_f32_16x16x64_bf16 v[76:79], v[36:39], a[200:207], v19
    v_smfmac_f32_16x16x64_bf16 v[76:79], v[52:55], a[232:239], v19
Go_20_s23:
    s_waitcnt vmcnt(1)
    v_cmp_eq_u32 vcc, -1, v40
    v_mov_b32_dpp v56, v40 row_ror:8 row_mask:0xf bank_mask:0xf
    v_mov_b32_dpp v57, v41 row_ror:8 row_mask:0xf bank_mask:0xf
    v_mov_b32_dpp v58, v42 row_ror:8 row_mask:0xf bank_mask:0xf
    v_mov_b32_dpp v59, v43 row_ror:8 row_mask:0xf bank_mask:0xf
    s_cbranch_vccnz Go_20_f23
    v_smfmac_f32_16x16x64_bf16 v[76:79], v[40:43], a[208:215], v19
    v_smfmac_f32_16x16x64_bf16 v[76:79], v[56:59], a[240:247], v19
Go_20_s3:
    s_waitcnt vmcnt(0)
    v_cmp_eq_u32 vcc, -1, v44
    v_mov_b32_dpp v60, v44 row_ror:8 row_mask:0xf bank_mask:0xf
    v_mov_b32_dpp v61, v45 row_ror:8 row_mask:0xf bank_mask:0xf
    v_mov_b32_dpp v62, v46 row_ror:8 row_mask:0xf bank_mask:0xf
    v_mov_b32_dpp v63, v47 row_ror:8 row_mask:0xf bank_mask:0xf
    s_cbranch_vccnz Go_20_f3
    v_smfmac_f32_16x16x64_bf16 v[76:79], v[44:47], a[216:223], v19
    v_smfmac_f32_16x16x64_bf16 v[76:79], v[60:63], a[248:255], v19
Go_20_done:
    v_max3_u32 v20, v33, v34, v35
    v_max3_u32 v208, v37, v38, v39
    v_max3_u32 v209, v41, v42, v43
    v_max3_u32 v210, v45, v46, v47
    v_max_u32 v20, v20, v208
    v_max3_u32 v20, v20, v209, v210
    v_cmp_eq_u32 vcc, -1, v20
    s_nop 0
    ds_write_b32 v238, v76 offset:20480
    ds_write_b32 v239, v77 offset:20480
    ds_write_b32 v240, v78 offset:20480
    s_cbranch_vccnz Go_20_redo
    s_waitcnt lgkmcnt(0)
    s_barrier
    ds_read_b32 v80, v17 offset:20480
    ds_read_b32 v81, v17 offset:20736
    ds_read_b32 v82, v17 offset:20992
    s_cmp_lt_u32 s18, 2
    s_waitcnt lgkmcnt(2)
    v_add_f32 v80, v80, v79
    s_waitcnt lgkmcnt(0)
    v_add_f32 v81, v81, v82
    v_add_f32 v80, v80, v81
    v_min_u32 v80, 0xfffffffe, v80
    buffer_store_dword v80, v8, s[8:11], s43 offen sc1
    buffer_store_dword v80, v8, s[8:11], s44 offen sc1
    ds_read_b128 v[164:167], v241 offset:51200
    ds_read_b128 v[168:171], v241 offset:51712
    ds_read_b128 v[172:175], v241 offset:52224
    ds_read_b128 v[176:179], v241 offset:52736
    s_waitcnt lgkmcnt(3)
    v_mfma_f32_16x16x32_bf16 v[188:191], v[164:167], v[148:151], 0
    s_waitcnt lgkmcnt(2)
    v_mfma_f32_16x16x32_bf16 v[188:191], v[168:171], v[152:155], v[188:191]
    s_waitcnt lgkmcnt(1)
    v_mfma_f32_16x16x32_bf16 v[188:191], v[172:175], v[156:159], v[188:191]
    s_waitcnt lgkmcnt(0)
    v_mfma_f32_16x16x32_bf16 v[188:191], v[176:179], v[160:163], v[188:191]
    s_nop 7
    v_cvt_pk_bf16_f32 v188, 0, v188
    v_cvt_pk_bf16_f32 v189, 0, v189
    v_pk_mul_f32 v[188:189], v[188:189], s[58:59]
    v_cvt_pk_bf16_f32 v188, 0, v188
    v_cvt_pk_bf16_f32 v189, 0, v189
    v_max3_f32 v86, v86, v188, v189
    v_mov_b32 v87, v86
    s_nop 1
    v_permlane16_swap_b32 v86, v87
    buffer_load_dword v220, v9, s[8:11], s43 offen sc1
    buffer_load_dword v221, v10, s[8:11], s43 offen sc1
    buffer_load_dword v222, v11, s[8:11], s43 offen sc1
    v_max_f32 v86, v86, v87
    v_mov_b32 v87, v86
    s_nop 1
    v_permlane32_swap_b32 v86, v87
    v_max_f32 v86, v86, v87
    v_mul_f32 v86, s56, v86
    v_pk_fma_f32 v[180:181], v[180:181], s[56:57], v[86:87] op_sel_hi:[1,1,0] neg_lo:[0,0,1] neg_hi:[0,0,1]
    v_pk_fma_f32 v[182:183], v[182:183], s[56:57], v[86:87] op_sel_hi:[1,1,0] neg_lo:[0,0,1] neg_hi:[0,0,1]
    v_pk_fma_f32 v[184:185], v[184:185], s[56:57], v[86:87] op_sel_hi:[1,1,0] neg_lo:[0,0,1] neg_hi:[0,0,1]
    v_pk_fma_f32 v[186:187], v[186:187], s[56:57], v[86:87] op_sel_hi:[1,1,0] neg_lo:[0,0,1] neg_hi:[0,0,1]
    v_pk_fma_f32 v[188:189], v[188:189], s[56:57], v[86:87] op_sel_hi:[1,1,0] neg_lo:[0,0,1] neg_hi:[0,0,1]
    v_exp_f32 v180, v180
    v_exp_f32 v181, v181
    v_exp_f32 v182, v182
    v_exp_f32 v183, v183
    v_exp_f32 v184, v184
    v_exp_f32 v185, v185
    v_exp_f32 v186, v186
    buffer_load_dword v223, v9, s[8:11], s44 offen sc1
    buffer_load_dword v224, v10, s[8:11], s44 offen sc1
    buffer_load_dword v225, v11, s[8:11], s44 offen sc1
    s_add_u32 m0, s51, 43008
    v_exp_f32 v187, v187
    v_exp_f32 v188, v188
    v_exp_f32 v189, v189
    v_pk_add_f32 v[88:89], v[180:181], v[182:183]
    v_pk_add_f32 v[90:91], v[184:185], v[186:187]
    v_pk_add_f32 v[88:89], v[88:89], v[188:189]
    buffer_load_dwordx4 v244, s[8:11], s31 offen offset:0 lds
    v_pk_add_f32 v[88:89], v[88:89], v[90:91]
    v_add_f32 v88, v88, v89
    v_mov_b32 v87, v88
    s_nop 1
    v_permlane16_swap_b32 v88, v87
    v_add_f32 v88, v88, v87
    buffer_load_dwordx4 v244, s[8:11], s31 offen offset:1024 lds
    v_mov_b32 v87, v88
    s_nop 1
    v_permlane32_swap_b32 v88, v87
    v_add_f32 v88, v88, v87
    v_rcp_f32 v88, v88
    s_nop 0
    v_pk_mul_f32 v[180:181], v[180:181], v[88:89] op_sel_hi:[1,0]
    v_pk_mul_f32 v[182:183], v[182:183], v[88:89] op_sel_hi:[1,0]
    v_pk_mul_f32 v[184:185], v[184:185], v[88:89] op_sel_hi:[1,0]
    v_pk_mul_f32 v[186:187], v[186:187], v[88:89] op_sel_hi:[1,0]
    v_pk_mul_f32 v[188:189], v[188:189], v[88:89] op_sel_hi:[1,0]
    v_cvt_pk_bf16_f32 v192, v180, v181
    v_cvt_pk_bf16_f32 v193, v182, v183
    v_cvt_pk_bf16_f32 v194, v184, v185
    v_cvt_pk_bf16_f32 v195, v186, v187
    v_cvt_pk_bf16_f32 v196, v188, v189
    v_cvt_pk_bf16_f32 v199, v188, v189
    v_mfma_f32_16x16x32_bf16 v[200:203], v[136:139], v[192:195], 0
    v_mfma_f32_16x16x32_bf16 v[204:207], v[140:143], v[192:195], 0
    v_mfma_f32_16x16x16_bf16 v[200:203], v[144:145], v[196:197], v[200:203]
    v_mfma_f32_16x16x16_bf16 v[204:207], v[144:145], v[198:199], v[204:207]
L_pj_22:
    s_waitcnt vmcnt(7)
    v_add_f32 v208, v80, v220
    s_waitcnt vmcnt(5)
    v_max3_u32 v20, v220, v221, v222
    v_add_f32 v209, v221, v222
    v_cmp_eq_u32 vcc, -1, v20
    v_add_f32 v208, v208, v209
    s_nop 1
    v_mov_b32_dpp v209, v208 quad_perm:[1,0,3,2] row_mask:0xf bank_mask:0xf
    s_mov_b64 exec, s[26:27]
    v_cvt_pk_bf16_f32 v208, v208, v209
    v_min_u32 v208, 0xfffffffe, v208
    s_cbranch_vccnz L_pf_27
L_pd_26:
    buffer_store_dword v208, v7, s[8:11], s41 offen
    s_mov_b64 exec, -1
    s_branch chain_kernel_loop
L_help_16:
    s_waitcnt vmcnt(1) lgkmcnt(0)
    s_barrier
    s_cmp_ge_u32 s18, 2
    s_cbranch_scc1 L_w2_31
    ds_read_b128 v[80:83], v1 offset:12288
    ds_read_b128 v[84:87], v1 offset:14336
    ds_read_b128 v[88:91], v1 offset:15360
    s_waitcnt lgkmcnt(2)
    v_pk_add_f32 v[72:73], v[72:73], v[82:83]
    v_pk_add_f32 v[74:75], v[74:75], v[80:81]
    s_waitcnt lgkmcnt(1)
    v_pk_add_f32 v[72:73], v[72:73], v[86:87]
    v_pk_add_f32 v[74:75], v[74:75], v[84:85]
    s_waitcnt lgkmcnt(0)
    v_pk_add_f32 v[72:73], v[72:73], v[88:89]
    v_pk_add_f32 v[74:75], v[74:75], v[90:91]
    v_cvt_pk_bf16_f32 v144, v72, v73
    v_cvt_pk_bf16_f32 v145, v74, v75
    s_nop 1
    v_permlane32_swap_b32 v144, v145
    s_nop 1
    ds_write_b64 v26, v[144:145] offset:28672
    s_add_u32 s21, s19, 1
    s_min_u32 s21, s21, 63
    s_lshl_b32 s63, s21, 21
    s_lshl_b32 s21, s21, 13
    s_and_b32 s21, s21, 0x2000
    s_xor_b32 s21, s21, s48
    s_add_u32 s63, s63, s21
    s_nop 15
    s_nop 0
    buffer_load_dword v250, v25, s[8:11], s63 offen sc1
    s_add_u32 s20, s19, 2
    s_min_u32 s20, s20, 63
    s_bfm_b64 s[22:23], s20, 0
    s_and_b32 s22, s22, 0x204225f
    s_and_b32 s23, s23, 0x80004004
    s_bcnt1_i32_b64 s32, s[22:23]
    s_lshl_b32 s32, s32, 2
    s_add_u32 s32, s32, 64
    s_cmp_eq_u32 s47, 1
    s_cselect_b32 s32, s32, s55
    s_add_u32 s21, s19, 1
    s_min_u32 s21, s21, 63
    s_lshl_b32 s31, s21, 21
    s_lshl_b32 s21, s21, 13
    s_and_b32 s21, s21, 0x2000
    s_xor_b32 s21, s21, s48
    s_add_u32 s31, s31, s21
    s_waitcnt lgkmcnt(0)
    s_cmp_eq_u32 s32, s55
    s_cbranch_scc1 L_nog_34
    s_load_dword s22, s[60:61], s32 glc
L_nog_34:
    s_mov_b32 s23, 1
    s_barrier
    s_cmp_lg_u32 s19, 0
    s_cbranch_scc1 L_ns0_37
    v_mov_b32 v248, 0
    s_lshl2_add_u32 s20, s17, s18
    s_cmp_lg_u32 s20, 5
    s_cbranch_scc1 L_rlo_39
L_rl_38:
    s_load_dword s20, s[60:61], 68 glc
    s_add_u32 s33, s33, 1
    s_cmp_gt_u32 s33, 0x100000
    s_cbranch_scc1 chain_kernel_abort
    s_waitcnt lgkmcnt(0)
    s_cmp_lt_u32 s20, 96
    s_cbranch_scc1 L_rl_38
    v_mov_b32 v249, 2
    buffer_store_dword v249, v248, s[8:11], s62 offen offset:128
    s_branch L_rlok_40
L_rlo_39:
    buffer_load_dword v249, v248, s[8:11], s62 offen offset:128 sc1
    s_add_u32 s33, s33, 1
    s_cmp_gt_u32 s33, 0x100000
    s_cbranch_scc1 chain_kernel_abort
    s_waitcnt vmcnt(0)
    v_readfirstlane_b32 s20, v249
    s_cmp_ge_u32 s20, 2
    s_cbranch_scc1 L_rlok_40
    s_sleep 1
    s_branch L_rlo_39
L_rlok_40:
L_ns0_37:
    s_mov_b32 m0, 40960
    s_nop 0
    buffer_load_dwordx4 v237, s[8:11], s31 offen offset:0 lds
    buffer_load_dwordx4 v237, s[8:11], s31 offen offset:1024 lds
    s_cmp_lg_u32 s47, 0
    s_cbranch_scc1 L_nof_36
    s_atomic_add s23, s[60:61], 208
L_nof_36:
    buffer_store_dwordx4 v[28:31], v22, s[8:11], s42 offen
    s_lshl_b32 s21, s29, 9
    s_add_u32 s21, s21, s42
    buffer_store_dwordx2 v[28:29], v26, s[8:11], s21 offen
    s_xor_b32 s21, s21, 20480
    buffer_store_dwordx2 v[28:29], v26, s[8:11], s21 offen
    s_cmp_eq_u32 s32, s55
    s_cbranch_scc1 L_he_33
    s_mov_b32 s55, s32
L_gr_35:
    s_waitcnt lgkmcnt(0)
    s_cmp_ge_u32 s22, 96
    s_cbranch_scc1 L_he_33
    s_add_u32 s33, s33, 1
    s_cmp_gt_u32 s33, 0x100000
    s_cbranch_scc1 chain_kernel_abort
    s_load_dword s22, s[60:61], s32 glc
    s_branch L_gr_35
L_w2_31:
    ds_read_b128 v[148:151], v242 offset:43008
    ds_read_b128 v[104:107], v1 offset:32768
    ds_read_b128 v[108:111], v1 offset:36864
    ds_read_b128 v[152:155], v242 offset:44032
    ds_read_b128 v[112:115], v1 offset:33792
    ds_read_b128 v[116:119], v1 offset:37888
    ds_read_b128 v[156:159], v242 offset:45056
    ds_read_b128 v[120:123], v1 offset:34816
    ds_read_b128 v[124:127], v1 offset:38912
    ds_read_b128 v[160:163], v242 offset:46080
    ds_read_b128 v[128:131], v1 offset:35840
    ds_read_b128 v[132:135], v1 offset:39936
    ds_read_b128 v[136:139], v1 offset:40960
    ds_read_b128 v[140:143], v1 offset:41984
    v_cvt_pk_bf16_f32 v200, v200, v201
    v_cvt_pk_bf16_f32 v201, v202, v203
    v_cvt_pk_bf16_f32 v202, v204, v205
    v_cvt_pk_bf16_f32 v203, v206, v207
    s_add_u32 s21, s19, -1
    s_lshl_b32 s32, s21, 21
    s_lshl_b32 s21, s21, 13
    s_and_b32 s21, s21, 0x2000
    s_xor_b32 s21, s21, s48
    s_add_u32 s32, s32, s21
    s_waitcnt lgkmcnt(11)
    v_mfma_f32_16x16x32_bf16 v[180:183], v[104:107], v[148:151], 0
    v_mfma_f32_16x16x32_bf16 v[184:187], v[108:111], v[148:151], 0
    s_waitcnt lgkmcnt(8)
    v_mfma_f32_16x16x32_bf16 v[180:183], v[112:115], v[152:155], v[180:183]
    v_mfma_f32_16x16x32_bf16 v[184:187], v[116:119], v[152:155], v[184:187]
    buffer_store_dwordx4 v[200:203], v23, s[8:11], s32 offen sc1
    s_waitcnt lgkmcnt(5)
    v_mfma_f32_16x16x32_bf16 v[180:183], v[120:123], v[156:159], v[180:183]
    v_mfma_f32_16x16x32_bf16 v[184:187], v[124:127], v[156:159], v[184:187]
    s_waitcnt lgkmcnt(2)
    v_mfma_f32_16x16x32_bf16 v[180:183], v[128:131], v[160:163], v[180:183]
    v_mfma_f32_16x16x32_bf16 v[184:187], v[132:135], v[160:163], v[184:187]
    s_add_u32 s21, s19, 1
    s_min_u32 s21, s21, 63
    s_lshl_b32 s31, s21, 21
    s_lshl_b32 s21, s21, 13
    s_and_b32 s21, s21, 0x2000
    s_xor_b32 s21, s21, s48
    s_add_u32 s31, s31, s21
    v_cvt_pk_bf16_f32 v180, 0, v180
    v_cvt_pk_bf16_f32 v181, 0, v181
    v_cvt_pk_bf16_f32 v182, 0, v182
    v_cvt_pk_bf16_f32 v183, 0, v183
    v_cvt_pk_bf16_f32 v184, 0, v184
    v_cvt_pk_bf16_f32 v185, 0, v185
    v_cvt_pk_bf16_f32 v186, 0, v186
    v_cvt_pk_bf16_f32 v187, 0, v187
    v_pk_mul_f32 v[180:181], v[180:181], s[58:59]
    v_pk_mul_f32 v[182:183], v[182:183], s[58:59]
    v_pk_mul_f32 v[184:185], v[184:185], s[58:59]
    v_pk_mul_f32 v[186:187], v[186:187], s[58:59]
    v_cvt_pk_bf16_f32 v180, 0, v180
    v_cvt_pk_bf16_f32 v181, 0, v181
    v_cvt_pk_bf16_f32 v182, 0, v182
    v_cvt_pk_bf16_f32 v183, 0, v183
    v_cvt_pk_bf16_f32 v184, 0, v184
    v_cvt_pk_bf16_f32 v185, 0, v185
    v_cvt_pk_bf16_f32 v186, 0, v186
    v_cvt_pk_bf16_f32 v187, 0, v187
    v_pk_add_f32 v[180:181], v[180:181], v[226:227]
    v_pk_add_f32 v[182:183], v[182:183], v[228:229]
    v_pk_add_f32 v[184:185], v[184:185], v[230:231]
    v_pk_add_f32 v[186:187], v[186:187], v[232:233]
    v_max3_f32 v86, v180, v181, v182
    v_max3_f32 v87, v183, v184, v185
    v_max3_f32 v86, v86, v186, v187
    v_max_f32 v86, v86, v87
    s_cmp_eq_u32 s18, 3
    s_waitcnt lgkmcnt(0)
    s_barrier
    ds_read_b64 v[144:145], v26 offset:28672
    s_cbranch_scc0 L_he_33
    s_mov_b32 m0, 51200
    s_nop 0
    buffer_load_dwordx4 v24, s[8:11], s40 offen offset:0 sc1 lds
    s_mov_b32 m0, 50176
    s_nop 0
    buffer_load_dwordx4 v24, s[8:11], s40 offen offset:2048 sc1 lds
L_he_33:
    s_cmp_lg_u32 s19, 63
    s_cbranch_scc1 L_b4_17
chain_kernel_fin:
    s_waitcnt vmcnt(0) lgkmcnt(0)
    s_barrier
    s_cmp_lt_u32 s18, 2
    s_cbranch_scc1 L_f2_41
    ds_read_b128 v[164:167], v241 offset:51200
    ds_read_b128 v[168:171], v241 offset:51712
    ds_read_b128 v[172:175], v241 offset:52224
    ds_read_b128 v[176:179], v241 offset:52736
    s_waitcnt lgkmcnt(3)
    v_mfma_f32_16x16x32_bf16 v[188:191], v[164:167], v[148:151], 0
    s_waitcnt lgkmcnt(2)
    v_mfma_f32_16x16x32_bf16 v[188:191], v[168:171], v[152:155], v[188:191]
    s_waitcnt lgkmcnt(1)
    v_mfma_f32_16x16x32_bf16 v[188:191], v[172:175], v[156:159], v[188:191]
    s_waitcnt lgkmcnt(0)
    v_mfma_f32_16x16x32_bf16 v[188:191], v[176:179], v[160:163], v[188:191]
    s_nop 7
    v_cvt_pk_bf16_f32 v188, 0, v188
    v_cvt_pk_bf16_f32 v189, 0, v189
    v_pk_mul_f32 v[188:189], v[188:189], s[58:59]
    v_cvt_pk_bf16_f32 v188, 0, v188
    v_cvt_pk_bf16_f32 v189, 0, v189
    v_max3_f32 v86, v86, v188, v189
    v_mov_b32 v87, v86
    s_nop 1
    v_permlane16_swap_b32 v86, v87
    v_max_f32 v86, v86, v87
    v_mov_b32 v87, v86
    s_nop 1
    v_permlane32_swap_b32 v86, v87
    v_max_f32 v86, v86, v87
    v_mul_f32 v86, s56, v86
    v_pk_fma_f32 v[180:181], v[180:181], s[56:57], v[86:87] op_sel_hi:[1,1,0] neg_lo:[0,0,1] neg_hi:[0,0,1]
    v_pk_fma_f32 v[182:183], v[182:183], s[56:57], v[86:87] op_sel_hi:[1,1,0] neg_lo:[0,0,1] neg_hi:[0,0,1]
    v_pk_fma_f32 v[184:185], v[184:185], s[56:57], v[86:87] op_sel_hi:[1,1,0] neg_lo:[0,0,1] neg_hi:[0,0,1]
    v_pk_fma_f32 v[186:187], v[186:187], s[56:57], v[86:87] op_sel_hi:[1,1,0] neg_lo:[0,0,1] neg_hi:[0,0,1]
    v_pk_fma_f32 v[188:189], v[188:189], s[56:57], v[86:87] op_sel_hi:[1,1,0] neg_lo:[0,0,1] neg_hi:[0,0,1]
    v_exp_f32 v180, v180
    v_exp_f32 v181, v181
    v_exp_f32 v182, v182
    v_exp_f32 v183, v183
    v_exp_f32 v184, v184
    v_exp_f32 v185, v185
    v_exp_f32 v186, v186
    v_exp_f32 v187, v187
    v_exp_f32 v188, v188
    v_exp_f32 v189, v189
    v_pk_add_f32 v[88:89], v[180:181], v[182:183]
    v_pk_add_f32 v[90:91], v[184:185], v[186:187]
    v_pk_add_f32 v[88:89], v[88:89], v[188:189]
    v_pk_add_f32 v[88:89], v[88:89], v[90:91]
    v_add_f32 v88, v88, v89
    v_mov_b32 v87, v88
    s_nop 1
    v_permlane16_swap_b32 v88, v87
    v_add_f32 v88, v88, v87
    v_mov_b32 v87, v88
    s_nop 1
    v_permlane32_swap_b32 v88, v87
    v_add_f32 v88, v88, v87
    v_rcp_f32 v88, v88
    s_nop 0
    v_pk_mul_f32 v[180:181], v[180:181], v[88:89] op_sel_hi:[1,0]
    v_pk_mul_f32 v[182:183], v[182:183], v[88:89] op_sel_hi:[1,0]
    v_pk_mul_f32 v[184:185], v[184:185], v[88:89] op_sel_hi:[1,0]
    v_pk_mul_f32 v[186:187], v[186:187], v[88:89] op_sel_hi:[1,0]
    v_pk_mul_f32 v[188:189], v[188:189], v[88:89] op_sel_hi:[1,0]
    v_cvt_pk_bf16_f32 v192, v180, v181
    v_cvt_pk_bf16_f32 v193, v182, v183
    v_cvt_pk_bf16_f32 v194, v184, v185
    v_cvt_pk_bf16_f32 v195, v186, v187
    v_cvt_pk_bf16_f32 v196, v188, v189
    v_cvt_pk_bf16_f32 v199, v188, v189
    v_mfma_f32_16x16x32_bf16 v[200:203], v[136:139], v[192:195], 0
    v_mfma_f32_16x16x32_bf16 v[204:207], v[140:143], v[192:195], 0
    v_mfma_f32_16x16x16_bf16 v[200:203], v[144:145], v[196:197], v[200:203]
    v_mfma_f32_16x16x16_bf16 v[204:207], v[144:145], v[198:199], v[204:207]
    s_add_u32 s21, s19, 0
    s_min_u32 s21, s21, 63
    s_lshl_b32 s32, s21, 21
    s_lshl_b32 s21, s21, 13
    s_and_b32 s21, s21, 0x2000
    s_xor_b32 s21, s21, s48
    s_add_u32 s32, s32, s21
    s_nop 1
    v_cvt_pk_bf16_f32 v200, v200, v201
    v_cvt_pk_bf16_f32 v201, v202, v203
    v_cvt_pk_bf16_f32 v202, v204, v205
    v_cvt_pk_bf16_f32 v203, v206, v207
    buffer_store_dwordx4 v[200:203], v23, s[8:11], s32 offen sc1
    s_waitcnt vmcnt(0)
L_f2_41:
    s_barrier
    s_cmp_lg_u32 s18, 0
    s_cbranch_scc1 chain_kernel_done
    s_add_u32 s20, s62, 4096
    s_mov_b32 s21, 1
    s_atomic_add s21, s[100:101], s20
    s_branch chain_kernel_done
Gq_18_f0123:
    buffer_load_dwordx4 v[32:35], v2, s[8:11], s40 offen offset:0 sc1
    s_branch Gq_18_s1230
Gq_18_f123p0:
    buffer_load_dwordx4 v[36:39], v2, s[8:11], s40 offen offset:1024 sc1
    s_add_u32 s33, s33, 1
    s_cmp_gt_u32 s33, 0x100000
    s_cbranch_scc1 chain_kernel_abort
    s_branch Gq_18_s231
Gq_18_f23p1:
    buffer_load_dwordx4 v[40:43], v2, s[8:11], s40 offen offset:2048 sc1
    s_add_u32 s33, s33, 1
    s_cmp_gt_u32 s33, 0x100000
    s_cbranch_scc1 chain_kernel_abort
    s_branch Gq_18_s32
Gq_18_f3p2:
    buffer_load_dwordx4 v[44:47], v2, s[8:11], s40 offen offset:3072 sc1
    s_add_u32 s33, s33, 1
    s_cmp_gt_u32 s33, 0x100000
    s_cbranch_scc1 chain_kernel_abort
    s_branch Gq_18_s3
Gq_18_redo:
    buffer_load_dwordx4 v[32:35], v2, s[8:11], s40 offen offset:0 sc1
    buffer_load_dwordx4 v[36:39], v2, s[8:11], s40 offen offset:1024 sc1
    buffer_load_dwordx4 v[40:43], v2, s[8:11], s40 offen offset:2048 sc1
    buffer_load_dwordx4 v[44:47], v2, s[8:11], s40 offen offset:3072 sc1
    s_add_u32 s33, s33, 1
    s_cmp_gt_u32 s33, 0x100000
    s_cbranch_scc1 chain_kernel_abort
    s_nop 5
    v_mov_b32 v64, 0
    v_mov_b32 v65, 0
    v_mov_b32 v66, 0
    v_mov_b32 v67, 0
    v_mov_b32 v68, 0
    v_mov_b32 v69, 0
    v_mov_b32 v70, 0
    v_mov_b32 v71, 0
    v_mov_b32 v72, 0
    v_mov_b32 v73, 0
    v_mov_b32 v74, 0
    v_mov_b32 v75, 0
    s_branch Gq_18_s0123
Gq_18_s1230:
    s_waitcnt vmcnt(3)
    v_cmp_eq_u32 vcc, -1, v36
    v_mov_b32_dpp v52, v36 row_ror:8 row_mask:0xf bank_mask:0xf
    v_mov_b32_dpp v53, v37 row_ror:8 row_mask:0xf bank_mask:0xf
    v_mov_b32_dpp v54, v38 row_ror:8 row_mask:0xf bank_mask:0xf
    v_mov_b32_dpp v55, v39 row_ror:8 row_mask:0xf bank_mask:0xf
    s_cbranch_vccnz Gq_18_f1230
    v_smfmac_f32_16x16x64_bf16 v[64:67], v[36:39], a[8:15], v19
    v_smfmac_f32_16x16x64_bf16 v[68:71], v[36:39], a[72:79], v19
Gq_18_s230p1:
    s_waitcnt vmcnt(2)
    v_cmp_eq_u32 vcc, -1, v40
    v_smfmac_f32_16x16x64_bf16 v[64:67], v[52:55], a[40:47], v19
    v_mov_b32_dpp v56, v40 row_ror:8 row_mask:0xf bank_mask:0xf
    v_mov_b32_dpp v57, v41 row_ror:8 row_mask:0xf bank_mask:0xf
    v_smfmac_f32_16x16x64_bf16 v[68:71], v[52:55], a[104:111], v19
    v_mov_b32_dpp v58, v42 row_ror:8 row_mask:0xf bank_mask:0xf
    v_mov_b32_dpp v59, v43 row_ror:8 row_mask:0xf bank_mask:0xf
    s_cbranch_vccnz Gq_18_f230p1
    v_smfmac_f32_16x16x64_bf16 v[64:67], v[40:43], a[16:23], v19
    v_smfmac_f32_16x16x64_bf16 v[68:71], v[40:43], a[80:87], v19
Gq_18_s30p2:
    s_waitcnt vmcnt(1)
    v_cmp_eq_u32 vcc, -1, v44
    v_smfmac_f32_16x16x64_bf16 v[64:67], v[56:59], a[48:55], v19
    v_mov_b32_dpp v60, v44 row_ror:8 row_mask:0xf bank_mask:0xf
    v_mov_b32_dpp v61, v45 row_ror:8 row_mask:0xf bank_mask:0xf
    v_smfmac_f32_16x16x64_bf16 v[68:71], v[56:59], a[112:119], v19
    v_mov_b32_dpp v62, v46 row_ror:8 row_mask:0xf bank_mask:0xf
    v_mov_b32_dpp v63, v47 row_ror:8 row_mask:0xf bank_mask:0xf
    s_cbranch_vccnz Gq_18_f30p2
    v_smfmac_f32_16x16x64_bf16 v[64:67], v[44:47], a[24:31], v19
    v_smfmac_f32_16x16x64_bf16 v[68:71], v[44:47], a[88:95], v19
Gq_18_s0p3:
    s_waitcnt vmcnt(0)
    v_cmp_eq_u32 vcc, -1, v32
    v_smfmac_f32_16x16x64_bf16 v[64:67], v[60:63], a[56:63], v19
    v_mov_b32_dpp v48, v32 row_ror:8 row_mask:0xf bank_mask:0xf
    v_mov_b32_dpp v49, v33 row_ror:8 row_mask:0xf bank_mask:0xf
    v_smfmac_f32_16x16x64_bf16 v[68:71], v[60:63], a[120:127], v19
    v_mov_b32_dpp v50, v34 row_ror:8 row_mask:0xf bank_mask:0xf
    v_mov_b32_dpp v51, v35 row_ror:8 row_mask:0xf bank_mask:0xf
    s_cbranch_vccnz Gq_18_f0p3
    v_smfmac_f32_16x16x64_bf16 v[64:67], v[32:35], a[0:7], v19
    v_smfmac_f32_16x16x64_bf16 v[68:71], v[32:35], a[64:71], v19
    v_smfmac_f32_16x16x64_bf16 v[64:67], v[48:51], a[32:39], v19
    v_smfmac_f32_16x16x64_bf16 v[68:71], v[48:51], a[96:103], v19
    s_branch Gq_18_done
Gq_18_f1230:
    buffer_load_dwordx4 v[36:39], v2, s[8:11], s40 offen offset:1024 sc1
    s_add_u32 s33, s33, 1
    s_cmp_gt_u32 s33, 0x100000
    s_cbranch_scc1 chain_kernel_abort
    s_branch Gq_18_s2301
Gq_18_f230p1:
    buffer_load_dwordx4 v[40:43], v2, s[8:11], s40 offen offset:2048 sc1
    s_add_u32 s33, s33, 1
    s_cmp_gt_u32 s33, 0x100000
    s_cbranch_scc1 chain_kernel_abort
    s_branch Gq_18_s302
Gq_18_f30p2:
    buffer_load_dwordx4 v[44:47], v2, s[8:11], s40 offen offset:3072 sc1
    s_add_u32 s33, s33, 1
    s_cmp_gt_u32 s33, 0x100000
    s_cbranch_scc1 chain_kernel_abort
    s_branch Gq_18_s03
Gq_18_f0p3:
    buffer_load_dwordx4 v[32:35], v2, s[8:11], s40 offen offset:0 sc1
    s_add_u32 s33, s33, 1
    s_cmp_gt_u32 s33, 0x100000
    s_cbranch_scc1 chain_kernel_abort
    s_branch Gq_18_s0
Gq_18_s231:
    s_waitcnt vmcnt(2)
    v_cmp_eq_u32 vcc, -1, v40
    v_mov_b32_dpp v56, v40 row_ror:8 row_mask:0xf bank_mask:0xf
    v_mov_b32_dpp v57, v41 row_ror:8 row_mask:0xf bank_mask:0xf
    v_mov_b32_dpp v58, v42 row_ror:8 row_mask:0xf bank_mask:0xf
    v_mov_b32_dpp v59, v43 row_ror:8 row_mask:0xf bank_mask:0xf
    s_cbranch_vccnz Gq_18_f231
    v_smfmac_f32_16x16x64_bf16 v[64:67], v[40:43], a[16:23], v19
    v_smfmac_f32_16x16x64_bf16 v[68:71], v[40:43], a[80:87], v19
Gq_18_s31p2:
    s_waitcnt vmcnt(1)
    v_cmp_eq_u32 vcc, -1, v44
    v_smfmac_f32_16x16x64_bf16 v[64:67], v[56:59], a[48:55], v19
    v_mov_b32_dpp v60, v44 row_ror:8 row_mask:0xf bank_mask:0xf
    v_mov_b32_dpp v61, v45 row_ror:8 row_mask:0xf bank_mask:0xf
    v_smfmac_f32_16x16x64_bf16 v[68:71], v[56:59], a[112:119], v19
    v_mov_b32_dpp v62, v46 row_ror:8 row_mask:0xf bank_mask:0xf
    v_mov_b32_dpp v63, v47 row_ror:8 row_mask:0xf bank_mask:0xf
    s_cbranch_vccnz Gq_18_f31p2
    v_smfmac_f32_16x16x64_bf16 v[64:67], v[44:47], a[24:31], v19
    v_smfmac_f32_16x16x64_bf16 v[68:71], v[44:47], a[88:95], v19
Gq_18_s1p3:
    s_waitcnt vmcnt(0)
    v_cmp_eq_u32 vcc, -1, v36
    v_smfmac_f32_16x16x64_bf16 v[64:67], v[60:63], a[56:63], v19
    v_mov_b32_dpp v52, v36 row_ror:8 row_mask:0xf bank_mask:0xf
    v_mov_b32_dpp v53, v37 row_ror:8 row_mask:0xf bank_mask:0xf
    v_smfmac_f32_16x16x64_bf16 v[68:71], v[60:63], a[120:127], v19
    v_mov_b32_dpp v54, v38 row_ror:8 row_mask:0xf bank_mask:0xf
    v_mov_b32_dpp v55, v39 row_ror:8 row_mask:0xf bank_mask:0xf
    s_cbranch_vccnz Gq_18_f1p3
    v_smfmac_f32_16x16x64_bf16 v[64:67], v[36:39], a[8:15], v19
    v_smfmac_f32_16x16x64_bf16 v[68:71], v[36:39], a[72:79], v19
    v_smfmac_f32_16x16x64_bf16 v[64:67], v[52:55], a[40:47], v19
    v_smfmac_f32_16x16x64_bf16 v[68:71], v[52:55], a[104:111], v19
    s_branch Gq_18_done
Gq_18_f231:
    buffer_load_dwordx4 v[40:43], v2, s[8:11], s40 offen offset:2048 sc1
    s_add_u32 s33, s33, 1
    s_cmp_gt_u32 s33, 0x100000
    s_cbranch_scc1 chain_kernel_abort
    s_branch Gq_18_s312
Gq_18_f31p2:
    buffer_load_dwordx4 v[44:47], v2, s[8:11], s40 offen offset:3072 sc1
    s_add_u32 s33, s33, 1
    s_cmp_gt_u32 s33, 0x100000
    s_cbranch_scc1 chain_kernel_abort
    s_branch Gq_18_s13
Gq_18_f1p3:
    buffer_load_dwordx4 v[36:39], v2, s[8:11], s40 offen offset:1024 sc1
    s_add_u32 s33, s33, 1
    s_cmp_gt_u32 s33, 0x100000
    s_cbranch_scc1 chain_kernel_abort
    s_branch Gq_18_s1
Gq_18_s32:
    s_waitcnt vmcnt(1)
    v_cmp_eq_u32 vcc, -1, v44
    v_mov_b32_dpp v60, v44 row_ror:8 row_mask:0xf bank_mask:0xf
    v_mov_b32_dpp v61, v45 row_ror:8 row_mask:0xf bank_mask:0xf
    v_mov_b32_dpp v62, v46 row_ror:8 row_mask:0xf bank_mask:0xf
    v_mov_b32_dpp v63, v47 row_ror:8 row_mask:0xf bank_mask:0xf
    s_cbranch_vccnz Gq_18_f32
    v_smfmac_f32_16x16x64_bf16 v[64:67], v[44:47], a[24:31], v19
    v_smfmac_f32_16x16x64_bf16 v[68:71], v[44:47], a[88:95], v19
Gq_18_s2p3:
    s_waitcnt vmcnt(0)
    v_cmp_eq_u32 vcc, -1, v40
    v_smfmac_f32_16x16x64_bf16 v[64:67], v[60:63], a[56:63], v19
    v_mov_b32_dpp v56, v40 row_ror:8 row_mask:0xf bank_mask:0xf
    v_mov_b32_dpp v57, v41 row_ror:8 row_mask:0xf bank_mask:0xf
    v_smfmac_f32_16x16x64_bf16 v[68:71], v[60:63], a[120:127], v19
    v_mov_b32_dpp v58, v42 row_ror:8 row_mask:0xf bank_mask:0xf
    v_mov_b32_dpp v59, v43 row_ror:8 row_mask:0xf bank_mask:0xf
    s_cbranch_vccnz Gq_18_f2p3
    v_smfmac_f32_16x16x64_bf16 v[64:67], v[40:43], a[16:23], v19
    v_smfmac_f32_16x16x64_bf16 v[68:71], v[40:43], a[80:87], v19
    v_smfmac_f32_16x16x64_bf16 v[64:67], v[56:59], a[48:55], v19
    v_smfmac_f32_16x16x64_bf16 v[68:71], v[56:59], a[112:119], v19
    s_branch Gq_18_done
Gq_18_f32:
    buffer_load_dwordx4 v[44:47], v2, s[8:11], s40 offen offset:3072 sc1
    s_add_u32 s33, s33, 1
    s_cmp_gt_u32 s33, 0x100000
    s_cbranch_scc1 chain_kernel_abort
    s_branch Gq_18_s23
Gq_18_f2p3:
    buffer_load_dwordx4 v[40:43], v2, s[8:11], s40 offen offset:2048 sc1
    s_add_u32 s33, s33, 1
    s_cmp_gt_u32 s33, 0x100000
    s_cbranch_scc1 chain_kernel_abort
    s_branch Gq_18_s2
Gq_18_s3:
    s_waitcnt vmcnt(0)
    v_cmp_eq_u32 vcc, -1, v44
    v_mov_b32_dpp v60, v44 row_ror:8 row_mask:0xf bank_mask:0xf
    v_mov_b32_dpp v61, v45 row_ror:8 row_mask:0xf bank_mask:0xf
    v_mov_b32_dpp v62, v46 row_ror:8 row_mask:0xf bank_mask:0xf
    v_mov_b32_dpp v63, v47 row_ror:8 row_mask:0xf bank_mask:0xf
    s_cbranch_vccnz Gq_18_f3
    v_smfmac_f32_16x16x64_bf16 v[64:67], v[44:47], a[24:31], v19
    v_smfmac_f32_16x16x64_bf16 v[68:71], v[44:47], a[88:95], v19
    v_smfmac_f32_16x16x64_bf16 v[64:67], v[60:63], a[56:63], v19
    v_smfmac_f32_16x16x64_bf16 v[68:71], v[60:63], a[120:127], v19
    s_branch Gq_18_done
Gq_18_f3:
    buffer_load_dwordx4 v[44:47], v2, s[8:11], s40 offen offset:3072 sc1
    s_add_u32 s33, s33, 1
    s_cmp_gt_u32 s33, 0x100000
    s_cbranch_scc1 chain_kernel_abort
    s_branch Gq_18_s3
Gq_18_s2301:
    s_waitcnt vmcnt(3)
    v_cmp_eq_u32 vcc, -1, v40
    v_mov_b32_dpp v56, v40 row_ror:8 row_mask:0xf bank_mask:0xf
    v_mov_b32_dpp v57, v41 row_ror:8 row_mask:0xf bank_mask:0xf
    v_mov_b32_dpp v58, v42 row_ror:8 row_mask:0xf bank_mask:0xf
    v_mov_b32_dpp v59, v43 row_ror:8 row_mask:0xf bank_mask:0xf
    s_cbranch_vccnz Gq_18_f2301
    v_smfmac_f32_16x16x64_bf16 v[64:67], v[40:43], a[16:23], v19
    v_smfmac_f32_16x16x64_bf16 v[68:71], v[40:43], a[80:87], v19
Gq_18_s301p2:
    s_waitcnt vmcnt(2)
    v_cmp_eq_u32 vcc, -1, v44
    v_smfmac_f32_16x16x64_bf16 v[64:67], v[56:59], a[48:55], v19
    v_mov_b32_dpp v60, v44 row_ror:8 row_mask:0xf bank_mask:0xf
    v_mov_b32_dpp v61, v45 row_ror:8 row_mask:0xf bank_mask:0xf
    v_smfmac_f32_16x16x64_bf16 v[68:71], v[56:59], a[112:119], v19
    v_mov_b32_dpp v62, v46 row_ror:8 row_mask:0xf bank_mask:0xf
    v_mov_b32_dpp v63, v47 row_ror:8 row_mask:0xf bank_mask:0xf
    s_cbranch_vccnz Gq_18_f301p2
    v_smfmac_f32_16x16x64_bf16 v[64:67], v[44:47], a[24:31], v19
    v_smfmac_f32_16x16x64_bf16 v[68:71], v[44:47], a[88:95], v19
Gq_18_s01p3:
    s_waitcnt vmcnt(1)
    v_cmp_eq_u32 vcc, -1, v32
    v_smfmac_f32_16x16x64_bf16 v[64:67], v[60:63], a[56:63], v19
    v_mov_b32_dpp v48, v32 row_ror:8 row_mask:0xf bank_mask:0xf
    v_mov_b32_dpp v49, v33 row_ror:8 row_mask:0xf bank_mask:0xf
    v_smfmac_f32_16x16x64_bf16 v[68:71], v[60:63], a[120:127], v19
    v_mov_b32_dpp v50, v34 row_ror:8 row_mask:0xf bank_mask:0xf
    v_mov_b32_dpp v51, v35 row_ror:8 row_mask:0xf bank_mask:0xf
    s_cbranch_vccnz Gq_18_f01p3
    v_smfmac_f32_16x16x64_bf16 v[64:67], v[32:35], a[0:7], v19
    v_smfmac_f32_16x16x64_bf16 v[68:71], v[32:35], a[64:71], v19
Gq_18_s1p0:
    s_waitcnt vmcnt(0)
    v_cmp_eq_u32 vcc, -1, v36
    v_smfmac_f32_16x16x64_bf16 v[64:67], v[48:51], a[32:39], v19
    v_mov_b32_dpp v52, v36 row_ror:8 row_mask:0xf bank_mask:0xf
    v_mov_b32_dpp v53, v37 row_ror:8 row_mask:0xf bank_mask:0xf
    v_smfmac_f32_16x16x64_bf16 v[68:71], v[48:51], a[96:103], v19
    v_mov_b32_dpp v54, v38 row_ror:8 row_mask:0xf bank_mask:0xf
    v_mov_b32_dpp v55, v39 row_ror:8 row_mask:0xf bank_mask:0xf
    s_cbranch_vccnz Gq_18_f1p0
    v_smfmac_f32_16x16x64_bf16 v[64:67], v[36:39], a[8:15], v19
    v_smfmac_f32_16x16x64_bf16 v[68:71], v[36:39], a[72:79], v19
    v_smfmac_f32_16x16x64_bf16 v[64:67], v[52:55], a[40:47], v19
    v_smfmac_f32_16x16x64_bf16 v[68:71], v[52:55], a[104:111], v19
    s_branch Gq_18_done
Gq_18_f2301:
    buffer_load_dwordx4 v[40:43], v2, s[8:11], s40 offen offset:2048 sc1
    s_add_u32 s33, s33, 1
    s_cmp_gt_u32 s33, 0x100000
    s_cbranch_scc1 chain_kernel_abort
    s_branch Gq_18_s3012
Gq_18_f301p2:
    buffer_load_dwordx4 v[44:47], v2, s[8:11], s40 offen offset:3072 sc1
    s_add_u32 s33, s33, 1
    s_cmp_gt_u32 s33, 0x100000
    s_cbranch_scc1 chain_kernel_abort
    s_branch Gq_18_s013
Gq_18_f01p3:
    buffer_load_dwordx4 v[32:35], v2, s[8:11], s40 offen offset:0 sc1
    s_add_u32 s33, s33, 1
    s_cmp_gt_u32 s33, 0x100000
    s_cbranch_scc1 chain_kernel_abort
    s_branch Gq_18_s10
Gq_18_f1p0:
    buffer_load_dwordx4 v[36:39], v2, s[8:11], s40 offen offset:1024 sc1
    s_add_u32 s33, s33, 1
    s_cmp_gt_u32 s33, 0x100000
    s_cbranch_scc1 chain_kernel_abort
    s_branch Gq_18_s1
Gq_18_s302:
    s_waitcnt vmcnt(2)
    v_cmp_eq_u32 vcc, -1, v44
    v_mov_b32_dpp v60, v44 row_ror:8 row_mask:0xf bank_mask:0xf
    v_mov_b32_dpp v61, v45 row_ror:8 row_mask:0xf bank_mask:0xf
    v_mov_b32_dpp v62, v46 row_ror:8 row_mask:0xf bank_mask:0xf
    v_mov_b32_dpp v63, v47 row_ror:8 row_mask:0xf bank_mask:0xf
    s_cbranch_vccnz Gq_18_f302
    v_smfmac_f32_16x16x64_bf16 v[64:67], v[44:47], a[24:31], v19
    v_smfmac_f32_16x16x64_bf16 v[68:71], v[44:47], a[88:95], v19
Gq_18_s02p3:
    s_waitcnt vmcnt(1)
    v_cmp_eq_u32 vcc, -1, v32
    v_smfmac_f32_16x16x64_bf16 v[64:67], v[60:63], a[56:63], v19
    v_mov_b32_dpp v48, v32 row_ror:8 row_mask:0xf bank_mask:0xf
    v_mov_b32_dpp v49, v33 row_ror:8 row_mask:0xf bank_mask:0xf
    v_smfmac_f32_16x16x64_bf16 v[68:71], v[60:63], a[120:127], v19
    v_mov_b32_dpp v50, v34 row_ror:8 row_mask:0xf bank_mask:0xf
    v_mov_b32_dpp v51, v35 row_ror:8 row_mask:0xf bank_mask:0xf
    s_cbranch_vccnz Gq_18_f02p3
    v_smfmac_f32_16x16x64_bf16 v[64:67], v[32:35], a[0:7], v19
    v_smfmac_f32_16x16x64_bf16 v[68:71], v[32:35], a[64:71], v19
Gq_18_s2p0:
    s_waitcnt vmcnt(0)
    v_cmp_eq_u32 vcc, -1, v40
    v_smfmac_f32_16x16x64_bf16 v[64:67], v[48:51], a[32:39], v19
    v_mov_b32_dpp v56, v40 row_ror:8 row_mask:0xf bank_mask:0xf
    v_mov_b32_dpp v57, v41 row_ror:8 row_mask:0xf bank_mask:0xf
    v_smfmac_f32_16x16x64_bf16 v[68:71], v[48:51], a[96:103], v19
    v_mov_b32_dpp v58, v42 row_ror:8 row_mask:0xf bank_mask:0xf
    v_mov_b32_dpp v59, v43 row_ror:8 row_mask:0xf bank_mask:0xf
    s_cbranch_vccnz Gq_18_f2p0
    v_smfmac_f32_16x16x64_bf16 v[64:67], v[40:43], a[16:23], v19
    v_smfmac_f32_16x16x64_bf16 v[68:71], v[40:43], a[80:87], v19
    v_smfmac_f32_16x16x64_bf16 v[64:67], v[56:59], a[48:55], v19
    v_smfmac_f32_16x16x64_bf16 v[68:71], v[56:59], a[112:119], v19
    s_branch Gq_18_done
Gq_18_f302:
    buffer_load_dwordx4 v[44:47], v2, s[8:11], s40 offen offset:3072 sc1
    s_add_u32 s33, s33, 1
    s_cmp_gt_u32 s33, 0x100000
    s_cbranch_scc1 chain_kernel_abort
    s_branch Gq_18_s023
Gq_18_f02p3:
    buffer_load_dwordx4 v[32:35], v2, s[8:11], s40 offen offset:0 sc1
    s_add_u32 s33, s33, 1
    s_cmp_gt_u32 s33, 0x100000
    s_cbranch_scc1 chain_kernel_abort
    s_branch Gq_18_s20
Gq_18_f2p0:
    buffer_load_dwordx4 v[40:43], v2, s[8:11], s40 offen offset:2048 sc1
    s_add_u32 s33, s33, 1
    s_cmp_gt_u32 s33, 0x100000
    s_cbranch_scc1 chain_kernel_abort
    s_branch Gq_18_s2
Gq_18_s03:
    s_waitcnt vmcnt(1)
    v_cmp_eq_u32 vcc, -1, v32
    v_mov_b32_dpp v48, v32 row_ror:8 row_mask:0xf bank_mask:0xf
    v_mov_b32_dpp v49, v33 row_ror:8 row_mask:0xf bank_mask:0xf
    v_mov_b32_dpp v50, v34 row_ror:8 row_mask:0xf bank_mask:0xf
    v_mov_b32_dpp v51, v35 row_ror:8 row_mask:0xf bank_mask:0xf
    s_cbranch_vccnz Gq_18_f03
    v_smfmac_f32_16x16x64_bf16 v[64:67], v[32:35], a[0:7], v19
    v_smfmac_f32_16x16x64_bf16 v[68:71], v[32:35], a[64:71], v19
Gq_18_s3p0:
    s_waitcnt vmcnt(0)
    v_cmp_eq_u32 vcc, -1, v44
    v_smfmac_f32_16x16x64_bf16 v[64:67], v[48:51], a[32:39], v19
    v_mov_b32_dpp v60, v44 row_ror:8 row_mask:0xf bank_mask:0xf
    v_mov_b32_dpp v61, v45 row_ror:8 row_mask:0xf bank_mask:0xf
    v_smfmac_f32_16x16x64_bf16 v[68:71], v[48:51], a[96:103], v19
    v_mov_b32_dpp v62, v46 row_ror:8 row_mask:0xf bank_mask:0xf
    v_mov_b32_dpp v63, v47 row_ror:8 row_mask:0xf bank_mask:0xf
    s_cbranch_vccnz Gq_18_f3p0
    v_smfmac_f32_16x16x64_bf16 v[64:67], v[44:47], a[24:31], v19
    v_smfmac_f32_16x16x64_bf16 v[68:71], v[44:47], a[88:95], v19
    v_smfmac_f32_16x16x64_bf16 v[64:67], v[60:63], a[56:63], v19
    v_smfmac_f32_16x16x64_bf16 v[68:71], v[60:63], a[120:127], v19
    s_branch Gq_18_done
Gq_18_f03:
    buffer_load_dwordx4 v[32:35], v2, s[8:11], s40 offen offset:0 sc1
    s_add_u32 s33, s33, 1
    s_cmp_gt_u32 s33, 0x100000
    s_cbranch_scc1 chain_kernel_abort
    s_branch Gq_18_s30
Gq_18_f3p0:
    buffer_load_dwordx4 v[44:47], v2, s[8:11], s40 offen offset:3072 sc1
    s_add_u32 s33, s33, 1
    s_cmp_gt_u32 s33, 0x100000
    s_cbranch_scc1 chain_kernel_abort
    s_branch Gq_18_s3
Gq_18_s0:
    s_waitcnt vmcnt(0)
    v_cmp_eq_u32 vcc, -1, v32
    v_mov_b32_dpp v48, v32 row_ror:8 row_mask:0xf bank_mask:0xf
    v_mov_b32_dpp v49, v33 row_ror:8 row_mask:0xf bank_mask:0xf
    v_mov_b32_dpp v50, v34 row_ror:8 row_mask:0xf bank_mask:0xf
    v_mov_b32_dpp v51, v35 row_ror:8 row_mask:0xf bank_mask:0xf
    s_cbranch_vccnz Gq_18_f0
    v_smfmac_f32_16x16x64_bf16 v[64:67], v[32:35], a[0:7], v19
    v_smfmac_f32_16x16x64_bf16 v[68:71], v[32:35], a[64:71], v19
    v_smfmac_f32_16x16x64_bf16 v[64:67], v[48:51], a[32:39], v19
    v_smfmac_f32_16x16x64_bf16 v[68:71], v[48:51], a[96:103], v19
    s_branch Gq_18_done
Gq_18_f0:
    buffer_load_dwordx4 v[32:35], v2, s[8:11], s40 offen offset:0 sc1
    s_add_u32 s33, s33, 1
    s_cmp_gt_u32 s33, 0x100000
    s_cbranch_scc1 chain_kernel_abort
    s_branch Gq_18_s0
Gq_18_s312:
    s_waitcnt vmcnt(2)
    v_cmp_eq_u32 vcc, -1, v44
    v_mov_b32_dpp v60, v44 row_ror:8 row_mask:0xf bank_mask:0xf
    v_mov_b32_dpp v61, v45 row_ror:8 row_mask:0xf bank_mask:0xf
    v_mov_b32_dpp v62, v46 row_ror:8 row_mask:0xf bank_mask:0xf
    v_mov_b32_dpp v63, v47 row_ror:8 row_mask:0xf bank_mask:0xf
    s_cbranch_vccnz Gq_18_f312
    v_smfmac_f32_16x16x64_bf16 v[64:67], v[44:47], a[24:31], v19
    v_smfmac_f32_16x16x64_bf16 v[68:71], v[44:47], a[88:95], v19
Gq_18_s12p3:
    s_waitcnt vmcnt(1)
    v_cmp_eq_u32 vcc, -1, v36
    v_smfmac_f32_16x16x64_bf16 v[64:67], v[60:63], a[56:63], v19
    v_mov_b32_dpp v52, v36 row_ror:8 row_mask:0xf bank_mask:0xf
    v_mov_b32_dpp v53, v37 row_ror:8 row_mask:0xf bank_mask:0xf
    v_smfmac_f32_16x16x64_bf16 v[68:71], v[60:63], a[120:127], v19
    v_mov_b32_dpp v54, v38 row_ror:8 row_mask:0xf bank_mask:0xf
    v_mov_b32_dpp v55, v39 row_ror:8 row_mask:0xf bank_mask:0xf
    s_cbranch_vccnz Gq_18_f12p3
    v_smfmac_f32_16x16x64_bf16 v[64:67], v[36:39], a[8:15], v19
    v_smfmac_f32_16x16x64_bf16 v[68:71], v[36:39], a[72:79], v19
Gq_18_s2p1:
    s_waitcnt vmcnt(0)
    v_cmp_eq_u32 vcc, -1, v40
    v_smfmac_f32_16x16x64_bf16 v[64:67], v[52:55], a[40:47], v19
    v_mov_b32_dpp v56, v40 row_ror:8 row_mask:0xf bank_mask:0xf
    v_mov_b32_dpp v57, v41 row_ror:8 row_mask:0xf bank_mask:0xf
    v_smfmac_f32_16x16x64_bf16 v[68:71], v[52:55], a[104:111], v19
    v_mov_b32_dpp v58, v42 row_ror:8 row_mask:0xf bank_mask:0xf
    v_mov_b32_dpp v59, v43 row_ror:8 row_mask:0xf bank_mask:0xf
    s_cbranch_vccnz Gq_18_f2p1
    v_smfmac_f32_16x16x64_bf16 v[64:67], v[40:43], a[16:23], v19
    v_smfmac_f32_16x16x64_bf16 v[68:71], v[40:43], a[80:87], v19
    v_smfmac_f32_16x16x64_bf16 v[64:67], v[56:59], a[48:55], v19
    v_smfmac_f32_16x16x64_bf16 v[68:71], v[56:59], a[112:119], v19
    s_branch Gq_18_done
Gq_18_f312:
    buffer_load_dwordx4 v[44:47], v2, s[8:11], s40 offen offset:3072 sc1
    s_add_u32 s33, s33, 1
    s_cmp_gt_u32 s33, 0x100000
    s_cbranch_scc1 chain_kernel_abort
    s_branch Gq_18_s123
Gq_18_f12p3:
    buffer_load_dwordx4 v[36:39], v2, s[8:11], s40 offen offset:1024 sc1
    s_add_u32 s33, s33, 1
    s_cmp_gt_u32 s33, 0x100000
    s_cbranch_scc1 chain_kernel_abort
    s_branch Gq_18_s21
Gq_18_f2p1:
    buffer_load_dwordx4 v[40:43], v2, s[8:11], s40 offen offset:2048 sc1
    s_add_u32 s33, s33, 1
    s_cmp_gt_u32 s33, 0x100000
    s_cbranch_scc1 chain_kernel_abort
    s_branch Gq_18_s2
Gq_18_s13:
    s_waitcnt vmcnt(1)
    v_cmp_eq_u32 vcc, -1, v36
    v_mov_b32_dpp v52, v36 row_ror:8 row_mask:0xf bank_mask:0xf
    v_mov_b32_dpp v53, v37 row_ror:8 row_mask:0xf bank_mask:0xf
    v_mov_b32_dpp v54, v38 row_ror:8 row_mask:0xf bank_mask:0xf
    v_mov_b32_dpp v55, v39 row_ror:8 row_mask:0xf bank_mask:0xf
    s_cbranch_vccnz Gq_18_f13
    v_smfmac_f32_16x16x64_bf16 v[64:67], v[36:39], a[8:15], v19
    v_smfmac_f32_16x16x64_bf16 v[68:71], v[36:39], a[72:79], v19
Gq_18_s3p1:
    s_waitcnt vmcnt(0)
    v_cmp_eq_u32 vcc, -1, v44
    v_smfmac_f32_16x16x64_bf16 v[64:67], v[52:55], a[40:47], v19
    v_mov_b32_dpp v60, v44 row_ror:8 row_mask:0xf bank_mask:0xf
    v_mov_b32_dpp v61, v45 row_ror:8 row_mask:0xf bank_mask:0xf
    v_smfmac_f32_16x16x64_bf16 v[68:71], v[52:55], a[104:111], v19
    v_mov_b32_dpp v62, v46 row_ror:8 row_mask:0xf bank_mask:0xf
    v_mov_b32_dpp v63, v47 row_ror:8 row_mask:0xf bank_mask:0xf
    s_cbranch_vccnz Gq_18_f3p1
    v_smfmac_f32_16x16x64_bf16 v[64:67], v[44:47], a[24:31], v19
    v_smfmac_f32_16x16x64_bf16 v[68:71], v[44:47], a[88:95], v19
    v_smfmac_f32_16x16x64_bf16 v[64:67], v[60:63], a[56:63], v19
    v_smfmac_f32_16x16x64_bf16 v[68:71], v[60:63], a[120:127], v19
    s_branch Gq_18_done
Gq_18_f13:
    buffer_load_dwordx4 v[36:39], v2, s[8:11], s40 offen offset:1024 sc1
    s_add_u32 s33, s33, 1
    s_cmp_gt_u32 s33, 0x100000
    s_cbranch_scc1 chain_kernel_abort
    s_branch Gq_18_s31
Gq_18_f3p1:
    buffer_load_dwordx4 v[44:47], v2, s[8:11], s40 offen offset:3072 sc1
    s_add_u32 s33, s33, 1
    s_cmp_gt_u32 s33, 0x100000
    s_cbranch_scc1 chain_kernel_abort
    s_branch Gq_18_s3
Gq_18_s1:
    s_waitcnt vmcnt(0)
    v_cmp_eq_u32 vcc, -1, v36
    v_mov_b32_dpp v52, v36 row_ror:8 row_mask:0xf bank_mask:0xf
    v_mov_b32_dpp v53, v37 row_ror:8 row_mask:0xf bank_mask:0xf
    v_mov_b32_dpp v54, v38 row_ror:8 row_mask:0xf bank_mask:0xf
    v_mov_b32_dpp v55, v39 row_ror:8 row_mask:0xf bank_mask:0xf
    s_cbranch_vccnz Gq_18_f1
    v_smfmac_f32_16x16x64_bf16 v[64:67], v[36:39], a[8:15], v19
    v_smfmac_f32_16x16x64_bf16 v[68:71], v[36:39], a[72:79], v19
    v_smfmac_f32_16x16x64_bf16 v[64:67], v[52:55], a[40:47], v19
    v_smfmac_f32_16x16x64_bf16 v[68:71], v[52:55], a[104:111], v19
    s_branch Gq_18_done
Gq_18_f1:
    buffer_load_dwordx4 v[36:39], v2, s[8:11], s40 offen offset:1024 sc1
    s_add_u32 s33, s33, 1
    s_cmp_gt_u32 s33, 0x100000
    s_cbranch_scc1 chain_kernel_abort
    s_branch Gq_18_s1
Gq_18_s23:
    s_waitcnt vmcnt(1)
    v_cmp_eq_u32 vcc, -1, v40
    v_mov_b32_dpp v56, v40 row_ror:8 row_mask:0xf bank_mask:0xf
    v_mov_b32_dpp v57, v41 row_ror:8 row_mask:0xf bank_mask:0xf
    v_mov_b32_dpp v58, v42 row_ror:8 row_mask:0xf bank_mask:0xf
    v_mov_b32_dpp v59, v43 row_ror:8 row_mask:0xf bank_mask:0xf
    s_cbranch_vccnz Gq_18_f23
    v_smfmac_f32_16x16x64_bf16 v[64:67], v[40:43], a[16:23], v19
    v_smfmac_f32_16x16x64_bf16 v[68:71], v[40:43], a[80:87], v19
    s_branch Gq_18_s3p2
Gq_18_f23:
    buffer_load_dwordx4 v[40:43], v2, s[8:11], s40 offen offset:2048 sc1
    s_add_u32 s33, s33, 1
    s_cmp_gt_u32 s33, 0x100000
    s_cbranch_scc1 chain_kernel_abort
    s_branch Gq_18_s32
Gq_18_s2:
    s_waitcnt vmcnt(0)
    v_cmp_eq_u32 vcc, -1, v40
    v_mov_b32_dpp v56, v40 row_ror:8 row_mask:0xf bank_mask:0xf
    v_mov_b32_dpp v57, v41 row_ror:8 row_mask:0xf bank_mask:0xf
    v_mov_b32_dpp v58, v42 row_ror:8 row_mask:0xf bank_mask:0xf
    v_mov_b32_dpp v59, v43 row_ror:8 row_mask:0xf bank_mask:0xf
    s_cbranch_vccnz Gq_18_f2
    v_smfmac_f32_16x16x64_bf16 v[64:67], v[40:43], a[16:23], v19
    v_smfmac_f32_16x16x64_bf16 v[68:71], v[40:43], a[80:87], v19
    v_smfmac_f32_16x16x64_bf16 v[64:67], v[56:59], a[48:55], v19
    v_smfmac_f32_16x16x64_bf16 v[68:71], v[56:59], a[112:119], v19
    s_branch Gq_18_done
Gq_18_f2:
    buffer_load_dwordx4 v[40:43], v2, s[8:11], s40 offen offset:2048 sc1
    s_add_u32 s33, s33, 1
    s_cmp_gt_u32 s33, 0x100000
    s_cbranch_scc1 chain_kernel_abort
    s_branch Gq_18_s2
Gq_18_s3012:
    s_waitcnt vmcnt(3)
    v_cmp_eq_u32 vcc, -1, v44
    v_mov_b32_dpp v60, v44 row_ror:8 row_mask:0xf bank_mask:0xf
    v_mov_b32_dpp v61, v45 row_ror:8 row_mask:0xf bank_mask:0xf
    v_mov_b32_dpp v62, v46 row_ror:8 row_mask:0xf bank_mask:0xf
    v_mov_b32_dpp v63, v47 row_ror:8 row_mask:0xf bank_mask:0xf
    s_cbranch_vccnz Gq_18_f3012
    v_smfmac_f32_16x16x64_bf16 v[64:67], v[44:47], a[24:31], v19
    v_smfmac_f32_16x16x64_bf16 v[68:71], v[44:47], a[88:95], v19
Gq_18_s012p3:
    s_waitcnt vmcnt(2)
    v_cmp_eq_u32 vcc, -1, v32
    v_smfmac_f32_16x16x64_bf16 v[64:67], v[60:63], a[56:63], v19
    v_mov_b32_dpp v48, v32 row_ror:8 row_mask:0xf bank_mask:0xf
    v_mov_b32_dpp v49, v33 row_ror:8 row_mask:0xf bank_mask:0xf
    v_smfmac_f32_16x16x64_bf16 v[68:71], v[60:63], a[120:127], v19
    v_mov_b32_dpp v50, v34 row_ror:8 row_mask:0xf bank_mask:0xf
    v_mov_b32_dpp v51, v35 row_ror:8 row_mask:0xf bank_mask:0xf
    s_cbranch_vccnz Gq_18_f012p3
    v_smfmac_f32_16x16x64_bf16 v[64:67], v[32:35], a[0:7], v19
    v_smfmac_f32_16x16x64_bf16 v[68:71], v[32:35], a[64:71], v19
Gq_18_s12p0:
    s_waitcnt vmcnt(1)
    v_cmp_eq_u32 vcc, -1, v36
    v_smfmac_f32_16x16x64_bf16 v[64:67], v[48:51], a[32:39], v19
    v_mov_b32_dpp v52, v36 row_ror:8 row_mask:0xf bank_mask:0xf
    v_mov_b32_dpp v53, v37 row_ror:8 row_mask:0xf bank_mask:0xf
    v_smfmac_f32_16x16x64_bf16 v[68:71], v[48:51], a[96:103], v19
    v_mov_b32_dpp v54, v38 row_ror:8 row_mask:0xf bank_mask:0xf
    v_mov_b32_dpp v55, v39 row_ror:8 row_mask:0xf bank_mask:0xf
    s_cbranch_vccnz Gq_18_f12p0
    v_smfmac_f32_16x16x64_bf16 v[64:67], v[36:39], a[8:15], v19
    v_smfmac_f32_16x16x64_bf16 v[68:71], v[36:39], a[72:79], v19
    s_branch Gq_18_s2p1
Gq_18_f3012:
    buffer_load_dwordx4 v[44:47], v2, s[8:11], s40 offen offset:3072 sc1
    s_add_u32 s33, s33, 1
    s_cmp_gt_u32 s33, 0x100000
    s_cbranch_scc1 chain_kernel_abort
    s_branch Gq_18_s0123
Gq_18_f012p3:
    buffer_load_dwordx4 v[32:35], v2, s[8:11], s40 offen offset:0 sc1
    s_add_u32 s33, s33, 1
    s_cmp_gt_u32 s33, 0x100000
    s_cbranch_scc1 chain_kernel_abort
    s_branch Gq_18_s120
Gq_18_f12p0:
    buffer_load_dwordx4 v[36:39], v2, s[8:11], s40 offen offset:1024 sc1
    s_add_u32 s33, s33, 1
    s_cmp_gt_u32 s33, 0x100000
    s_cbranch_scc1 chain_kernel_abort
    s_branch Gq_18_s21
Gq_18_s013:
    s_waitcnt vmcnt(2)
    v_cmp_eq_u32 vcc, -1, v32
    v_mov_b32_dpp v48, v32 row_ror:8 row_mask:0xf bank_mask:0xf
    v_mov_b32_dpp v49, v33 row_ror:8 row_mask:0xf bank_mask:0xf
    v_mov_b32_dpp v50, v34 row_ror:8 row_mask:0xf bank_mask:0xf
    v_mov_b32_dpp v51, v35 row_ror:8 row_mask:0xf bank_mask:0xf
    s_cbranch_vccnz Gq_18_f013
    v_smfmac_f32_16x16x64_bf16 v[64:67], v[32:35], a[0:7], v19
    v_smfmac_f32_16x16x64_bf16 v[68:71], v[32:35], a[64:71], v19
Gq_18_s13p0:
    s_waitcnt vmcnt(1)
    v_cmp_eq_u32 vcc, -1, v36
    v_smfmac_f32_16x16x64_bf16 v[64:67], v[48:51], a[32:39], v19
    v_mov_b32_dpp v52, v36 row_ror:8 row_mask:0xf bank_mask:0xf
    v_mov_b32_dpp v53, v37 row_ror:8 row_mask:0xf bank_mask:0xf
    v_smfmac_f32_16x16x64_bf16 v[68:71], v[48:51], a[96:103], v19
    v_mov_b32_dpp v54, v38 row_ror:8 row_mask:0xf bank_mask:0xf
    v_mov_b32_dpp v55, v39 row_ror:8 row_mask:0xf bank_mask:0xf
    s_cbranch_vccnz Gq_18_f13p0
    v_smfmac_f32_16x16x64_bf16 v[64:67], v[36:39], a[8:15], v19
    v_smfmac_f32_16x16x64_bf16 v[68:71], v[36:39], a[72:79], v19
    s_branch Gq_18_s3p1
Gq_18_f013:
    buffer_load_dwordx4 v[32:35], v2, s[8:11], s40 offen offset:0 sc1
    s_add_u32 s33, s33, 1
    s_cmp_gt_u32 s33, 0x100000
    s_cbranch_scc1 chain_kernel_abort
    s_branch Gq_18_s130
Gq_18_f13p0:
    buffer_load_dwordx4 v[36:39], v2, s[8:11], s40 offen offset:1024 sc1
    s_add_u32 s33, s33, 1
    s_cmp_gt_u32 s33, 0x100000
    s_cbranch_scc1 chain_kernel_abort
    s_branch Gq_18_s31
Gq_18_s10:
    s_waitcnt vmcnt(1)
    v_cmp_eq_u32 vcc, -1, v36
    v_mov_b32_dpp v52, v36 row_ror:8 row_mask:0xf bank_mask:0xf
    v_mov_b32_dpp v53, v37 row_ror:8 row_mask:0xf bank_mask:0xf
    v_mov_b32_dpp v54, v38 row_ror:8 row_mask:0xf bank_mask:0xf
    v_mov_b32_dpp v55, v39 row_ror:8 row_mask:0xf bank_mask:0xf
    s_cbranch_vccnz Gq_18_f10
    v_smfmac_f32_16x16x64_bf16 v[64:67], v[36:39], a[8:15], v19
    v_smfmac_f32_16x16x64_bf16 v[68:71], v[36:39], a[72:79], v19
Gq_18_s0p1:
    s_waitcnt vmcnt(0)
    v_cmp_eq_u32 vcc, -1, v32
    v_smfmac_f32_16x16x64_bf16 v[64:67], v[52:55], a[40:47], v19
    v_mov_b32_dpp v48, v32 row_ror:8 row_mask:0xf bank_mask:0xf
    v_mov_b32_dpp v49, v33 row_ror:8 row_mask:0xf bank_mask:0xf
    v_smfmac_f32_16x16x64_bf16 v[68:71], v[52:55], a[104:111], v19
    v_mov_b32_dpp v50, v34 row_ror:8 row_mask:0xf bank_mask:0xf
    v_mov_b32_dpp v51, v35 row_ror:8 row_mask:0xf bank_mask:0xf
    s_cbranch_vccnz Gq_18_f0p1
    v_smfmac_f32_16x16x64_bf16 v[64:67], v[32:35], a[0:7], v19
    v_smfmac_f32_16x16x64_bf16 v[68:71], v[32:35], a[64:71], v19
    v_smfmac_f32_16x16x64_bf16 v[64:67], v[48:51], a[32:39], v19
    v_smfmac_f32_16x16x64_bf16 v[68:71], v[48:51], a[96:103], v19
    s_branch Gq_18_done
Gq_18_f10:
    buffer_load_dwordx4 v[36:39], v2, s[8:11], s40 offen offset:1024 sc1
    s_add_u32 s33, s33, 1
    s_cmp_gt_u32 s33, 0x100000
    s_cbranch_scc1 chain_kernel_abort
    s_branch Gq_18_s01
Gq_18_f0p1:
    buffer_load_dwordx4 v[32:35], v2, s[8:11], s40 offen offset:0 sc1
    s_add_u32 s33, s33, 1
    s_cmp_gt_u32 s33, 0x100000
    s_cbranch_scc1 chain_kernel_abort
    s_branch Gq_18_s0
Gq_18_s023:
    s_waitcnt vmcnt(2)
    v_cmp_eq_u32 vcc, -1, v32
    v_mov_b32_dpp v48, v32 row_ror:8 row_mask:0xf bank_mask:0xf
    v_mov_b32_dpp v49, v33 row_ror:8 row_mask:0xf bank_mask:0xf
    v_mov_b32_dpp v50, v34 row_ror:8 row_mask:0xf bank_mask:0xf
    v_mov_b32_dpp v51, v35 row_ror:8 row_mask:0xf bank_mask:0xf
    s_cbranch_vccnz Gq_18_f023
    v_smfmac_f32_16x16x64_bf16 v[64:67], v[32:35], a[0:7], v19
    v_smfmac_f32_16x16x64_bf16 v[68:71], v[32:35], a[64:71], v19
Gq_18_s23p0:
    s_waitcnt vmcnt(1)
    v_cmp_eq_u32 vcc, -1, v40
    v_smfmac_f32_16x16x64_bf16 v[64:67], v[48:51], a[32:39], v19
    v_mov_b32_dpp v56, v40 row_ror:8 row_mask:0xf bank_mask:0xf
    v_mov_b32_dpp v57, v41 row_ror:8 row_mask:0xf bank_mask:0xf
    v_smfmac_f32_16x16x64_bf16 v[68:71], v[48:51], a[96:103], v19
    v_mov_b32_dpp v58, v42 row_ror:8 row_mask:0xf bank_mask:0xf
    v_mov_b32_dpp v59, v43 row_ror:8 row_mask:0xf bank_mask:0xf
    s_cbranch_vccnz Gq_18_f23p0
    v_smfmac_f32_16x16x64_bf16 v[64:67], v[40:43], a[16:23], v19
    v_smfmac_f32_16x16x64_bf16 v[68:71], v[40:43], a[80:87], v19
    s_branch Gq_18_s3p2
Gq_18_f023:
    buffer_load_dwordx4 v[32:35], v2, s[8:11], s40 offen offset:0 sc1
    s_add_u32 s33, s33, 1
    s_cmp_gt_u32 s33, 0x100000
    s_cbranch_scc1 chain_kernel_abort
    s_branch Gq_18_s230
Gq_18_f23p0:
    buffer_load_dwordx4 v[40:43], v2, s[8:11], s40 offen offset:2048 sc1
    s_add_u32 s33, s33, 1
    s_cmp_gt_u32 s33, 0x100000
    s_cbranch_scc1 chain_kernel_abort
    s_branch Gq_18_s32
Gq_18_s20:
    s_waitcnt vmcnt(1)
    v_cmp_eq_u32 vcc, -1, v40
    v_mov_b32_dpp v56, v40 row_ror:8 row_mask:0xf bank_mask:0xf
    v_mov_b32_dpp v57, v41 row_ror:8 row_mask:0xf bank_mask:0xf
    v_mov_b32_dpp v58, v42 row_ror:8 row_mask:0xf bank_mask:0xf
    v_mov_b32_dpp v59, v43 row_ror:8 row_mask:0xf bank_mask:0xf
    s_cbranch_vccnz Gq_18_f20
    v_smfmac_f32_16x16x64_bf16 v[64:67], v[40:43], a[16:23], v19
    v_smfmac_f32_16x16x64_bf16 v[68:71], v[40:43], a[80:87], v19
Gq_18_s0p2:
    s_waitcnt vmcnt(0)
    v_cmp_eq_u32 vcc, -1, v32
    v_smfmac_f32_16x16x64_bf16 v[64:67], v[56:59], a[48:55], v19
    v_mov_b32_dpp v48, v32 row_ror:8 row_mask:0xf bank_mask:0xf
    v_mov_b32_dpp v49, v33 row_ror:8 row_mask:0xf bank_mask:0xf
    v_smfmac_f32_16x16x64_bf16 v[68:71], v[56:59], a[112:119], v19
    v_mov_b32_dpp v50, v34 row_ror:8 row_mask:0xf bank_mask:0xf
    v_mov_b32_dpp v51, v35 row_ror:8 row_mask:0xf bank_mask:0xf
    s_cbranch_vccnz Gq_18_f0p2
    v_smfmac_f32_16x16x64_bf16 v[64:67], v[32:35], a[0:7], v19
    v_smfmac_f32_16x16x64_bf16 v[68:71], v[32:35], a[64:71], v19
    v_smfmac_f32_16x16x64_bf16 v[64:67], v[48:51], a[32:39], v19
    v_smfmac_f32_16x16x64_bf16 v[68:71], v[48:51], a[96:103], v19
    s_branch Gq_18_done
Gq_18_f20:
    buffer_load_dwordx4 v[40:43], v2, s[8:11], s40 offen offset:2048 sc1
    s_add_u32 s33, s33, 1
    s_cmp_gt_u32 s33, 0x100000
    s_cbranch_scc1 chain_kernel_abort
    s_branch Gq_18_s02
Gq_18_f0p2:
    buffer_load_dwordx4 v[32:35], v2, s[8:11], s40 offen offset:0 sc1
    s_add_u32 s33, s33, 1
    s_cmp_gt_u32 s33, 0x100000
    s_cbranch_scc1 chain_kernel_abort
    s_branch Gq_18_s0
Gq_18_s30:
    s_waitcnt vmcnt(1)
    v_cmp_eq_u32 vcc, -1, v44
    v_mov_b32_dpp v60, v44 row_ror:8 row_mask:0xf bank_mask:0xf
    v_mov_b32_dpp v61, v45 row_ror:8 row_mask:0xf bank_mask:0xf
    v_mov_b32_dpp v62, v46 row_ror:8 row_mask:0xf bank_mask:0xf
    v_mov_b32_dpp v63, v47 row_ror:8 row_mask:0xf bank_mask:0xf
    s_cbranch_vccnz Gq_18_f30
    v_smfmac_f32_16x16x64_bf16 v[64:67], v[44:47], a[24:31], v19
    v_smfmac_f32_16x16x64_bf16 v[68:71], v[44:47], a[88:95], v19
    s_branch Gq_18_s0p3
Gq_18_f30:
    buffer_load_dwordx4 v[44:47], v2, s[8:11], s40 offen offset:3072 sc1
    s_add_u32 s33, s33, 1
    s_cmp_gt_u32 s33, 0x100000
    s_cbranch_scc1 chain_kernel_abort
    s_branch Gq_18_s03
Gq_18_s123:
    s_waitcnt vmcnt(2)
    v_cmp_eq_u32 vcc, -1, v36
    v_mov_b32_dpp v52, v36 row_ror:8 row_mask:0xf bank_mask:0xf
    v_mov_b32_dpp v53, v37 row_ror:8 row_mask:0xf bank_mask:0xf
    v_mov_b32_dpp v54, v38 row_ror:8 row_mask:0xf bank_mask:0xf
    v_mov_b32_dpp v55, v39 row_ror:8 row_mask:0xf bank_mask:0xf
    s_cbranch_vccnz Gq_18_f123
    v_smfmac_f32_16x16x64_bf16 v[64:67], v[36:39], a[8:15], v19
    v_smfmac_f32_16x16x64_bf16 v[68:71], v[36:39], a[72:79], v19
    s_branch Gq_18_s23p1
Gq_18_f123:
    buffer_load_dwordx4 v[36:39], v2, s[8:11], s40 offen offset:1024 sc1
    s_add_u32 s33, s33, 1
    s_cmp_gt_u32 s33, 0x100000
    s_cbranch_scc1 chain_kernel_abort
    s_branch Gq_18_s231
Gq_18_s21:
    s_waitcnt vmcnt(1)
    v_cmp_eq_u32 vcc, -1, v40
    v_mov_b32_dpp v56, v40 row_ror:8 row_mask:0xf bank_mask:0xf
    v_mov_b32_dpp v57, v41 row_ror:8 row_mask:0xf bank_mask:0xf
    v_mov_b32_dpp v58, v42 row_ror:8 row_mask:0xf bank_mask:0xf
    v_mov_b32_dpp v59, v43 row_ror:8 row_mask:0xf bank_mask:0xf
    s_cbranch_vccnz Gq_18_f21
    v_smfmac_f32_16x16x64_bf16 v[64:67], v[40:43], a[16:23], v19
    v_smfmac_f32_16x16x64_bf16 v[68:71], v[40:43], a[80:87], v19
Gq_18_s1p2:
    s_waitcnt vmcnt(0)
    v_cmp_eq_u32 vcc, -1, v36
    v_smfmac_f32_16x16x64_bf16 v[64:67], v[56:59], a[48:55], v19
    v_mov_b32_dpp v52, v36 row_ror:8 row_mask:0xf bank_mask:0xf
    v_mov_b32_dpp v53, v37 row_ror:8 row_mask:0xf bank_mask:0xf
    v_smfmac_f32_16x16x64_bf16 v[68:71], v[56:59], a[112:119], v19
    v_mov_b32_dpp v54, v38 row_ror:8 row_mask:0xf bank_mask:0xf
    v_mov_b32_dpp v55, v39 row_ror:8 row_mask:0xf bank_mask:0xf
    s_cbranch_vccnz Gq_18_f1p2
    v_smfmac_f32_16x16x64_bf16 v[64:67], v[36:39], a[8:15], v19
    v_smfmac_f32_16x16x64_bf16 v[68:71], v[36:39], a[72:79], v19
    v_smfmac_f32_16x16x64_bf16 v[64:67], v[52:55], a[40:47], v19
    v_smfmac_f32_16x16x64_bf16 v[68:71], v[52:55], a[104:111], v19
    s_branch Gq_18_done
Gq_18_f21:
    buffer_load_dwordx4 v[40:43], v2, s[8:11], s40 offen offset:2048 sc1
    s_add_u32 s33, s33, 1
    s_cmp_gt_u32 s33, 0x100000
    s_cbranch_scc1 chain_kernel_abort
    s_branch Gq_18_s12
Gq_18_f1p2:
    buffer_load_dwordx4 v[36:39], v2, s[8:11], s40 offen offset:1024 sc1
    s_add_u32 s33, s33, 1
    s_cmp_gt_u32 s33, 0x100000
    s_cbranch_scc1 chain_kernel_abort
    s_branch Gq_18_s1
Gq_18_s31:
    s_waitcnt vmcnt(1)
    v_cmp_eq_u32 vcc, -1, v44
    v_mov_b32_dpp v60, v44 row_ror:8 row_mask:0xf bank_mask:0xf
    v_mov_b32_dpp v61, v45 row_ror:8 row_mask:0xf bank_mask:0xf
    v_mov_b32_dpp v62, v46 row_ror:8 row_mask:0xf bank_mask:0xf
    v_mov_b32_dpp v63, v47 row_ror:8 row_mask:0xf bank_mask:0xf
    s_cbranch_vccnz Gq_18_f31
    v_smfmac_f32_16x16x64_bf16 v[64:67], v[44:47], a[24:31], v19
    v_smfmac_f32_16x16x64_bf16 v[68:71], v[44:47], a[88:95], v19
    s_branch Gq_18_s1p3
Gq_18_f31:
    buffer_load_dwordx4 v[44:47], v2, s[8:11], s40 offen offset:3072 sc1
    s_add_u32 s33, s33, 1
    s_cmp_gt_u32 s33, 0x100000
    s_cbranch_scc1 chain_kernel_abort
    s_branch Gq_18_s13
Gq_18_s120:
    s_waitcnt vmcnt(2)
    v_cmp_eq_u32 vcc, -1, v36
    v_mov_b32_dpp v52, v36 row_ror:8 row_mask:0xf bank_mask:0xf
    v_mov_b32_dpp v53, v37 row_ror:8 row_mask:0xf bank_mask:0xf
    v_mov_b32_dpp v54, v38 row_ror:8 row_mask:0xf bank_mask:0xf
    v_mov_b32_dpp v55, v39 row_ror:8 row_mask:0xf bank_mask:0xf
    s_cbranch_vccnz Gq_18_f120
    v_smfmac_f32_16x16x64_bf16 v[64:67], v[36:39], a[8:15], v19
    v_smfmac_f32_16x16x64_bf16 v[68:71], v[36:39], a[72:79], v19
Gq_18_s20p1:
    s_waitcnt vmcnt(1)
    v_cmp_eq_u32 vcc, -1, v40
    v_smfmac_f32_16x16x64_bf16 v[64:67], v[52:55], a[40:47], v19
    v_mov_b32_dpp v56, v40 row_ror:8 row_mask:0xf bank_mask:0xf
    v_mov_b32_dpp v57, v41 row_ror:8 row_mask:0xf bank_mask:0xf
    v_smfmac_f32_16x16x64_bf16 v[68:71], v[52:55], a[104:111], v19
    v_mov_b32_dpp v58, v42 row_ror:8 row_mask:0xf bank_mask:0xf
    v_mov_b32_dpp v59, v43 row_ror:8 row_mask:0xf bank_mask:0xf
    s_cbranch_vccnz Gq_18_f20p1
    v_smfmac_f32_16x16x64_bf16 v[64:67], v[40:43], a[16:23], v19
    v_smfmac_f32_16x16x64_bf16 v[68:71], v[40:43], a[80:87], v19
    s_branch Gq_18_s0p2
Gq_18_f120:
    buffer_load_dwordx4 v[36:39], v2, s[8:11], s40 offen offset:1024 sc1
    s_add_u32 s33, s33, 1
    s_cmp_gt_u32 s33, 0x100000
    s_cbranch_scc1 chain_kernel_abort
    s_branch Gq_18_s201
Gq_18_f20p1:
    buffer_load_dwordx4 v[40:43], v2, s[8:11], s40 offen offset:2048 sc1
    s_add_u32 s33, s33, 1
    s_cmp_gt_u32 s33, 0x100000
    s_cbranch_scc1 chain_kernel_abort
    s_branch Gq_18_s02
Gq_18_s130:
    s_waitcnt vmcnt(2)
    v_cmp_eq_u32 vcc, -1, v36
    v_mov_b32_dpp v52, v36 row_ror:8 row_mask:0xf bank_mask:0xf
    v_mov_b32_dpp v53, v37 row_ror:8 row_mask:0xf bank_mask:0xf
    v_mov_b32_dpp v54, v38 row_ror:8 row_mask:0xf bank_mask:0xf
    v_mov_b32_dpp v55, v39 row_ror:8 row_mask:0xf bank_mask:0xf
    s_cbranch_vccnz Gq_18_f130
    v_smfmac_f32_16x16x64_bf16 v[64:67], v[36:39], a[8:15], v19
    v_smfmac_f32_16x16x64_bf16 v[68:71], v[36:39], a[72:79], v19
Gq_18_s30p1:
    s_waitcnt vmcnt(1)
    v_cmp_eq_u32 vcc, -1, v44
    v_smfmac_f32_16x16x64_bf16 v[64:67], v[52:55], a[40:47], v19
    v_mov_b32_dpp v60, v44 row_ror:8 row_mask:0xf bank_mask:0xf
    v_mov_b32_dpp v61, v45 row_ror:8 row_mask:0xf bank_mask:0xf
    v_smfmac_f32_16x16x64_bf16 v[68:71], v[52:55], a[104:111], v19
    v_mov_b32_dpp v62, v46 row_ror:8 row_mask:0xf bank_mask:0xf
    v_mov_b32_dpp v63, v47 row_ror:8 row_mask:0xf bank_mask:0xf
    s_cbranch_vccnz Gq_18_f30p1
    v_smfmac_f32_16x16x64_bf16 v[64:67], v[44:47], a[24:31], v19
    v_smfmac_f32_16x16x64_bf16 v[68:71], v[44:47], a[88:95], v19
    s_branch Gq_18_s0p3
Gq_18_f130:
    buffer_load_dwordx4 v[36:39], v2, s[8:11], s40 offen offset:1024 sc1
    s_add_u32 s33, s33, 1
    s_cmp_gt_u32 s33, 0x100000
    s_cbranch_scc1 chain_kernel_abort
    s_branch Gq_18_s301
Gq_18_f30p1:
    buffer_load_dwordx4 v[44:47], v2, s[8:11], s40 offen offset:3072 sc1
    s_add_u32 s33, s33, 1
    s_cmp_gt_u32 s33, 0x100000
    s_cbranch_scc1 chain_kernel_abort
    s_branch Gq_18_s03
Gq_18_s01:
    s_waitcnt vmcnt(1)
    v_cmp_eq_u32 vcc, -1, v32
    v_mov_b32_dpp v48, v32 row_ror:8 row_mask:0xf bank_mask:0xf
    v_mov_b32_dpp v49, v33 row_ror:8 row_mask:0xf bank_mask:0xf
    v_mov_b32_dpp v50, v34 row_ror:8 row_mask:0xf bank_mask:0xf
    v_mov_b32_dpp v51, v35 row_ror:8 row_mask:0xf bank_mask:0xf
    s_cbranch_vccnz Gq_18_f01
    v_smfmac_f32_16x16x64_bf16 v[64:67], v[32:35], a[0:7], v19
    v_smfmac_f32_16x16x64_bf16 v[68:71], v[32:35], a[64:71], v19
    s_branch Gq_18_s1p0
Gq_18_f01:
    buffer_load_dwordx4 v[32:35], v2, s[8:11], s40 offen offset:0 sc1
    s_add_u32 s33, s33, 1
    s_cmp_gt_u32 s33, 0x100000
    s_cbranch_scc1 chain_kernel_abort
    s_branch Gq_18_s10
Gq_18_s230:
    s_waitcnt vmcnt(2)
    v_cmp_eq_u32 vcc, -1, v40
    v_mov_b32_dpp v56, v40 row_ror:8 row_mask:0xf bank_mask:0xf
    v_mov_b32_dpp v57, v41 row_ror:8 row_mask:0xf bank_mask:0xf
    v_mov_b32_dpp v58, v42 row_ror:8 row_mask:0xf bank_mask:0xf
    v_mov_b32_dpp v59, v43 row_ror:8 row_mask:0xf bank_mask:0xf
    s_cbranch_vccnz Gq_18_f230
    v_smfmac_f32_16x16x64_bf16 v[64:67], v[40:43], a[16:23], v19
    v_smfmac_f32_16x16x64_bf16 v[68:71], v[40:43], a[80:87], v19
    s_branch Gq_18_s30p2
Gq_18_f230:
    buffer_load_dwordx4 v[40:43], v2, s[8:11], s40 offen offset:2048 sc1
    s_add_u32 s33, s33, 1
    s_cmp_gt_u32 s33, 0x100000
    s_cbranch_scc1 chain_kernel_abort
    s_branch Gq_18_s302
Gq_18_s02:
    s_waitcnt vmcnt(1)
    v_cmp_eq_u32 vcc, -1, v32
    v_mov_b32_dpp v48, v32 row_ror:8 row_mask:0xf bank_mask:0xf
    v_mov_b32_dpp v49, v33 row_ror:8 row_mask:0xf bank_mask:0xf
    v_mov_b32_dpp v50, v34 row_ror:8 row_mask:0xf bank_mask:0xf
    v_mov_b32_dpp v51, v35 row_ror:8 row_mask:0xf bank_mask:0xf
    s_cbranch_vccnz Gq_18_f02
    v_smfmac_f32_16x16x64_bf16 v[64:67], v[32:35], a[0:7], v19
    v_smfmac_f32_16x16x64_bf16 v[68:71], v[32:35], a[64:71], v19
    s_branch Gq_18_s2p0
Gq_18_f02:
    buffer_load_dwordx4 v[32:35], v2, s[8:11], s40 offen offset:0 sc1
    s_add_u32 s33, s33, 1
    s_cmp_gt_u32 s33, 0x100000
    s_cbranch_scc1 chain_kernel_abort
    s_branch Gq_18_s20
Gq_18_s12:
    s_waitcnt vmcnt(1)
    v_cmp_eq_u32 vcc, -1, v36
    v_mov_b32_dpp v52, v36 row_ror:8 row_mask:0xf bank_mask:0xf
    v_mov_b32_dpp v53, v37 row_ror:8 row_mask:0xf bank_mask:0xf
    v_mov_b32_dpp v54, v38 row_ror:8 row_mask:0xf bank_mask:0xf
    v_mov_b32_dpp v55, v39 row_ror:8 row_mask:0xf bank_mask:0xf
    s_cbranch_vccnz Gq_18_f12
    v_smfmac_f32_16x16x64_bf16 v[64:67], v[36:39], a[8:15], v19
    v_smfmac_f32_16x16x64_bf16 v[68:71], v[36:39], a[72:79], v19
    s_branch Gq_18_s2p1
Gq_18_f12:
    buffer_load_dwordx4 v[36:39], v2, s[8:11], s40 offen offset:1024 sc1
    s_add_u32 s33, s33, 1
    s_cmp_gt_u32 s33, 0x100000
    s_cbranch_scc1 chain_kernel_abort
    s_branch Gq_18_s21
Gq_18_s201:
    s_waitcnt vmcnt(2)
    v_cmp_eq_u32 vcc, -1, v40
    v_mov_b32_dpp v56, v40 row_ror:8 row_mask:0xf bank_mask:0xf
    v_mov_b32_dpp v57, v41 row_ror:8 row_mask:0xf bank_mask:0xf
    v_mov_b32_dpp v58, v42 row_ror:8 row_mask:0xf bank_mask:0xf
    v_mov_b32_dpp v59, v43 row_ror:8 row_mask:0xf bank_mask:0xf
    s_cbranch_vccnz Gq_18_f201
    v_smfmac_f32_16x16x64_bf16 v[64:67], v[40:43], a[16:23], v19
    v_smfmac_f32_16x16x64_bf16 v[68:71], v[40:43], a[80:87], v19
Gq_18_s01p2:
    s_waitcnt vmcnt(1)
    v_cmp_eq_u32 vcc, -1, v32
    v_smfmac_f32_16x16x64_bf16 v[64:67], v[56:59], a[48:55], v19
    v_mov_b32_dpp v48, v32 row_ror:8 row_mask:0xf bank_mask:0xf
    v_mov_b32_dpp v49, v33 row_ror:8 row_mask:0xf bank_mask:0xf
    v_smfmac_f32_16x16x64_bf16 v[68:71], v[56:59], a[112:119], v19
    v_mov_b32_dpp v50, v34 row_ror:8 row_mask:0xf bank_mask:0xf
    v_mov_b32_dpp v51, v35 row_ror:8 row_mask:0xf bank_mask:0xf
    s_cbranch_vccnz Gq_18_f01p2
    v_smfmac_f32_16x16x64_bf16 v[64:67], v[32:35], a[0:7], v19
    v_smfmac_f32_16x16x64_bf16 v[68:71], v[32:35], a[64:71], v19
    s_branch Gq_18_s1p0
Gq_18_f201:
    buffer_load_dwordx4 v[40:43], v2, s[8:11], s40 offen offset:2048 sc1
    s_add_u32 s33, s33, 1
    s_cmp_gt_u32 s33, 0x100000
    s_cbranch_scc1 chain_kernel_abort
    s_branch Gq_18_s012
Gq_18_f01p2:
    buffer_load_dwordx4 v[32:35], v2, s[8:11], s40 offen offset:0 sc1
    s_add_u32 s33, s33, 1
    s_cmp_gt_u32 s33, 0x100000
    s_cbranch_scc1 chain_kernel_abort
    s_branch Gq_18_s10
Gq_18_s301:
    s_waitcnt vmcnt(2)
    v_cmp_eq_u32 vcc, -1, v44
    v_mov_b32_dpp v60, v44 row_ror:8 row_mask:0xf bank_mask:0xf
    v_mov_b32_dpp v61, v45 row_ror:8 row_mask:0xf bank_mask:0xf
    v_mov_b32_dpp v62, v46 row_ror:8 row_mask:0xf bank_mask:0xf
    v_mov_b32_dpp v63, v47 row_ror:8 row_mask:0xf bank_mask:0xf
    s_cbranch_vccnz Gq_18_f301
    v_smfmac_f32_16x16x64_bf16 v[64:67], v[44:47], a[24:31], v19
    v_smfmac_f32_16x16x64_bf16 v[68:71], v[44:47], a[88:95], v19
    s_branch Gq_18_s01p3
Gq_18_f301:
    buffer_load_dwordx4 v[44:47], v2, s[8:11], s40 offen offset:3072 sc1
    s_add_u32 s33, s33, 1
    s_cmp_gt_u32 s33, 0x100000
    s_cbranch_scc1 chain_kernel_abort
    s_branch Gq_18_s013
Gq_18_s012:
    s_waitcnt vmcnt(2)
    v_cmp_eq_u32 vcc, -1, v32
    v_mov_b32_dpp v48, v32 row_ror:8 row_mask:0xf bank_mask:0xf
    v_mov_b32_dpp v49, v33 row_ror:8 row_mask:0xf bank_mask:0xf
    v_mov_b32_dpp v50, v34 row_ror:8 row_mask:0xf bank_mask:0xf
    v_mov_b32_dpp v51, v35 row_ror:8 row_mask:0xf bank_mask:0xf
    s_cbranch_vccnz Gq_18_f012
    v_smfmac_f32_16x16x64_bf16 v[64:67], v[32:35], a[0:7], v19
    v_smfmac_f32_16x16x64_bf16 v[68:71], v[32:35], a[64:71], v19
    s_branch Gq_18_s12p0
Gq_18_f012:
    buffer_load_dwordx4 v[32:35], v2, s[8:11], s40 offen offset:0 sc1
    s_add_u32 s33, s33, 1
    s_cmp_gt_u32 s33, 0x100000
    s_cbranch_scc1 chain_kernel_abort
    s_branch Gq_18_s120
L_sd_19_0_0f:
    s_branch L_sd_19_1_0
L_sd_19_0_1f:
    s_branch L_sd_19_1_1
L_sd_19_0_2f:
    s_branch L_sd_19_1_2
L_sd_19_0_3f:
    s_branch L_sd_19_1_3
L_sd_19_1_0:
    s_waitcnt vmcnt(7)
    v_max3_u32 v20, v164, v165, v166
    v_mfma_f32_16x16x32_bf16 v[88:91], v[164:167], v[164:167], 0
    v_max_u32 v20, v20, v167
    v_cmp_eq_u32 vcc, -1, v20
    v_mfma_f32_16x16x32_bf16 v[84:87], v[120:123], v[164:167], 0
    v_mfma_f32_16x16x32_bf16 v[80:83], v[104:107], v[164:167], 0
    s_cbranch_vccnz L_sd_19_2_0
L_sd_19_1_1:
    s_waitcnt vmcnt(6)
    v_max3_u32 v20, v168, v169, v170
    v_mfma_f32_16x16x32_bf16 v[100:103], v[168:171], v[168:171], v[88:91]
    v_max_u32 v20, v20, v171
    v_cmp_eq_u32 vcc, -1, v20
    v_mfma_f32_16x16x32_bf16 v[96:99], v[124:127], v[168:171], v[84:87]
    v_mfma_f32_16x16x32_bf16 v[92:95], v[108:111], v[168:171], v[80:83]
    s_cbranch_vccnz L_sd_19_2_1
L_sd_19_1_2:
    s_waitcnt vmcnt(5)
    v_max3_u32 v20, v172, v173, v174
    v_mfma_f32_16x16x32_bf16 v[228:231], v[172:175], v[172:175], v[100:103]
    v_max_u32 v20, v20, v175
    v_cmp_eq_u32 vcc, -1, v20
    v_mfma_f32_16x16x32_bf16 v[224:227], v[128:131], v[172:175], v[96:99]
    v_mfma_f32_16x16x32_bf16 v[220:223], v[112:115], v[172:175], v[92:95]
    s_cbranch_vccnz L_sd_19_2_2
L_sd_19_1_3:
    s_waitcnt vmcnt(4)
    v_max3_u32 v20, v176, v177, v178
    v_mfma_f32_16x16x32_bf16 v[188:191], v[176:179], v[176:179], v[228:231]
    v_max_u32 v20, v20, v179
    v_cmp_eq_u32 vcc, -1, v20
    v_mfma_f32_16x16x32_bf16 v[184:187], v[132:135], v[176:179], v[224:227]
    v_mfma_f32_16x16x32_bf16 v[180:183], v[116:119], v[176:179], v[220:223]
    v_mov_b32_dpp v188, v189 row_ror:8 row_mask:0xf bank_mask:0xc
    v_mov_b32_dpp v190, v191 row_ror:8 row_mask:0xf bank_mask:0xc
    s_cbranch_vccnz L_sd_19_2_3
    s_branch L_sd_19
L_sd_19_1_0f:
    s_branch L_sd_19_2_0
L_sd_19_1_1f:
    s_branch L_sd_19_2_1
L_sd_19_1_2f:
    s_branch L_sd_19_2_2
L_sd_19_1_3f:
    s_branch L_sd_19_2_3
L_sd_19_2_0:
    s_waitcnt vmcnt(3)
    v_max3_u32 v20, v32, v33, v34
    v_mfma_f32_16x16x32_bf16 v[88:91], v[32:35], v[32:35], 0
    v_max_u32 v20, v20, v35
    v_cmp_eq_u32 vcc, -1, v20
    v_mfma_f32_16x16x32_bf16 v[84:87], v[120:123], v[32:35], 0
    v_mfma_f32_16x16x32_bf16 v[80:83], v[104:107], v[32:35], 0
    s_cbranch_vccnz L_sd_19_2_0f
L_sd_19_2_1:
    s_waitcnt vmcnt(2)
    v_max3_u32 v20, v36, v37, v38
    v_mfma_f32_16x16x32_bf16 v[100:103], v[36:39], v[36:39], v[88:91]
    v_max_u32 v20, v20, v39
    v_cmp_eq_u32 vcc, -1, v20
    v_mfma_f32_16x16x32_bf16 v[96:99], v[124:127], v[36:39], v[84:87]
    v_mfma_f32_16x16x32_bf16 v[92:95], v[108:111], v[36:39], v[80:83]
    s_cbranch_vccnz L_sd_19_2_1f
L_sd_19_2_2:
    s_waitcnt vmcnt(1)
    v_max3_u32 v20, v40, v41, v42
    v_mfma_f32_16x16x32_bf16 v[228:231], v[40:43], v[40:43], v[100:103]
    v_max_u32 v20, v20, v43
    v_cmp_eq_u32 vcc, -1, v20
    v_mfma_f32_16x16x32_bf16 v[224:227], v[128:131], v[40:43], v[96:99]
    v_mfma_f32_16x16x32_bf16 v[220:223], v[112:115], v[40:43], v[92:95]
    s_cbranch_vccnz L_sd_19_2_2f
L_sd_19_2_3:
    s_waitcnt vmcnt(0)
    v_max3_u32 v20, v44, v45, v46
    v_mfma_f32_16x16x32_bf16 v[188:191], v[44:47], v[44:47], v[228:231]
    v_max_u32 v20, v20, v47
    v_cmp_eq_u32 vcc, -1, v20
    v_mfma_f32_16x16x32_bf16 v[184:187], v[132:135], v[44:47], v[224:227]
    v_mfma_f32_16x16x32_bf16 v[180:183], v[116:119], v[44:47], v[220:223]
    v_mov_b32_dpp v188, v189 row_ror:8 row_mask:0xf bank_mask:0xc
    v_mov_b32_dpp v190, v191 row_ror:8 row_mask:0xf bank_mask:0xc
    s_cbranch_vccnz L_sd_19_2_3f
    s_branch L_sd_19
L_sd_19_2_0f:
    buffer_load_dwordx4 v[148:151], v5, s[8:11], s40 offen offset:0 sc1
    buffer_load_dwordx4 v[152:155], v5, s[8:11], s40 offen offset:1024 sc1
    buffer_load_dwordx4 v[156:159], v5, s[8:11], s40 offen offset:2048 sc1
    buffer_load_dwordx4 v[160:163], v5, s[8:11], s40 offen offset:3072 sc1
    s_add_u32 s33, s33, 1
    s_cmp_gt_u32 s33, 0x100000
    s_cbranch_scc1 chain_kernel_abort
    s_branch L_sd_19_3_0
L_sd_19_2_1f:
    buffer_load_dwordx4 v[152:155], v5, s[8:11], s40 offen offset:1024 sc1
    buffer_load_dwordx4 v[156:159], v5, s[8:11], s40 offen offset:2048 sc1
    buffer_load_dwordx4 v[160:163], v5, s[8:11], s40 offen offset:3072 sc1
    s_add_u32 s33, s33, 1
    s_cmp_gt_u32 s33, 0x100000
    s_cbranch_scc1 chain_kernel_abort
    s_branch L_sd_19_3_1
L_sd_19_2_2f:
    buffer_load_dwordx4 v[156:159], v5, s[8:11], s40 offen offset:2048 sc1
    buffer_load_dwordx4 v[160:163], v5, s[8:11], s40 offen offset:3072 sc1
    s_add_u32 s33, s33, 1
    s_cmp_gt_u32 s33, 0x100000
    s_cbranch_scc1 chain_kernel_abort
    s_branch L_sd_19_3_2
L_sd_19_2_3f:
    buffer_load_dwordx4 v[160:163], v5, s[8:11], s40 offen offset:3072 sc1
    s_add_u32 s33, s33, 1
    s_cmp_gt_u32 s33, 0x100000
    s_cbranch_scc1 chain_kernel_abort
    s_branch L_sd_19_3_3
L_sd_19_3_0:
    s_waitcnt vmcnt(3)
    v_max3_u32 v20, v148, v149, v150
    v_mfma_f32_16x16x32_bf16 v[88:91], v[148:151], v[148:151], 0
    v_max_u32 v20, v20, v151
    v_cmp_eq_u32 vcc, -1, v20
    v_mfma_f32_16x16x32_bf16 v[84:87], v[120:123], v[148:151], 0
    v_mfma_f32_16x16x32_bf16 v[80:83], v[104:107], v[148:151], 0
    s_cbranch_vccnz L_sd_19_3_0f
L_sd_19_3_1:
    s_waitcnt vmcnt(2)
    v_max3_u32 v20, v152, v153, v154
    v_mfma_f32_16x16x32_bf16 v[100:103], v[152:155], v[152:155], v[88:91]
    v_max_u32 v20, v20, v155
    v_cmp_eq_u32 vcc, -1, v20
    v_mfma_f32_16x16x32_bf16 v[96:99], v[124:127], v[152:155], v[84:87]
    v_mfma_f32_16x16x32_bf16 v[92:95], v[108:111], v[152:155], v[80:83]
    s_cbranch_vccnz L_sd_19_3_1f
L_sd_19_3_2:
    s_waitcnt vmcnt(1)
    v_max3_u32 v20, v156, v157, v158
    v_mfma_f32_16x16x32_bf16 v[228:231], v[156:159], v[156:159], v[100:103]
    v_max_u32 v20, v20, v159
    v_cmp_eq_u32 vcc, -1, v20
    v_mfma_f32_16x16x32_bf16 v[224:227], v[128:131], v[156:159], v[96:99]
    v_mfma_f32_16x16x32_bf16 v[220:223], v[112:115], v[156:159], v[92:95]
    s_cbranch_vccnz L_sd_19_3_2f
L_sd_19_3_3:
    s_waitcnt vmcnt(0)
    v_max3_u32 v20, v160, v161, v162
    v_mfma_f32_16x16x32_bf16 v[188:191], v[160:163], v[160:163], v[228:231]
    v_max_u32 v20, v20, v163
    v_cmp_eq_u32 vcc, -1, v20
    v_mfma_f32_16x16x32_bf16 v[184:187], v[132:135], v[160:163], v[224:227]
    v_mfma_f32_16x16x32_bf16 v[180:183], v[116:119], v[160:163], v[220:223]
    v_mov_b32_dpp v188, v189 row_ror:8 row_mask:0xf bank_mask:0xc
    v_mov_b32_dpp v190, v191 row_ror:8 row_mask:0xf bank_mask:0xc
    s_cbranch_vccnz L_sd_19_3_3f
    s_branch L_sd_19
L_sd_19_3_0f:
    buffer_load_dwordx4 v[148:151], v5, s[8:11], s40 offen offset:0 sc1
    buffer_load_dwordx4 v[152:155], v5, s[8:11], s40 offen offset:1024 sc1
    buffer_load_dwordx4 v[156:159], v5, s[8:11], s40 offen offset:2048 sc1
    buffer_load_dwordx4 v[160:163], v5, s[8:11], s40 offen offset:3072 sc1
    s_add_u32 s33, s33, 1
    s_cmp_gt_u32 s33, 0x100000
    s_cbranch_scc1 chain_kernel_abort
    s_branch L_sd_19_3_0
L_sd_19_3_1f:
    buffer_load_dwordx4 v[152:155], v5, s[8:11], s40 offen offset:1024 sc1
    buffer_load_dwordx4 v[156:159], v5, s[8:11], s40 offen offset:2048 sc1
    buffer_load_dwordx4 v[160:163], v5, s[8:11], s40 offen offset:3072 sc1
    s_add_u32 s33, s33, 1
    s_cmp_gt_u32 s33, 0x100000
    s_cbranch_scc1 chain_kernel_abort
    s_branch L_sd_19_3_1
L_sd_19_3_2f:
    buffer_load_dwordx4 v[156:159], v5, s[8:11], s40 offen offset:2048 sc1
    buffer_load_dwordx4 v[160:163], v5, s[8:11], s40 offen offset:3072 sc1
    s_add_u32 s33, s33, 1
    s_cmp_gt_u32 s33, 0x100000
    s_cbranch_scc1 chain_kernel_abort
    s_branch L_sd_19_3_2
L_sd_19_3_3f:
    buffer_load_dwordx4 v[160:163], v5, s[8:11], s40 offen offset:3072 sc1
    s_add_u32 s33, s33, 1
    s_cmp_gt_u32 s33, 0x100000
    s_cbranch_scc1 chain_kernel_abort
    s_branch L_sd_19_3_3
Go_20_f0123:
    buffer_load_dwordx4 v[32:35], v3, s[8:11], s40 offen offset:0 sc1
    s_branch Go_20_s1230
Go_20_f123:
    buffer_load_dwordx4 v[36:39], v3, s[8:11], s40 offen offset:1024 sc1
    s_add_u32 s33, s33, 1
    s_cmp_gt_u32 s33, 0x100000
    s_cbranch_scc1 chain_kernel_abort
    s_branch Go_20_s231
Go_20_f23:
    buffer_load_dwordx4 v[40:43], v3, s[8:11], s40 offen offset:2048 sc1
    s_add_u32 s33, s33, 1
    s_cmp_gt_u32 s33, 0x100000
    s_cbranch_scc1 chain_kernel_abort
    s_branch Go_20_s32
Go_20_f3:
    buffer_load_dwordx4 v[44:47], v3, s[8:11], s40 offen offset:3072 sc1
    s_add_u32 s33, s33, 1
    s_cmp_gt_u32 s33, 0x100000
    s_cbranch_scc1 chain_kernel_abort
    s_branch Go_20_s3
Go_20_redo:
    buffer_load_dwordx4 v[32:35], v3, s[8:11], s40 offen offset:0 sc1
    buffer_load_dwordx4 v[36:39], v3, s[8:11], s40 offen offset:1024 sc1
    buffer_load_dwordx4 v[40:43], v3, s[8:11], s40 offen offset:2048 sc1
    buffer_load_dwordx4 v[44:47], v3, s[8:11], s40 offen offset:3072 sc1
    s_add_u32 s33, s33, 1
    s_cmp_gt_u32 s33, 0x100000
    s_cbranch_scc1 chain_kernel_abort
    s_nop 5
    v_mov_b32 v76, 0
    v_mov_b32 v77, 0
    v_mov_b32 v78, 0
    v_mov_b32 v79, 0
    s_branch Go_20_s0123
Go_20_s1230:
    s_waitcnt vmcnt(3)
    v_cmp_eq_u32 vcc, -1, v36
    v_mov_b32_dpp v52, v36 row_ror:8 row_mask:0xf bank_mask:0xf
    v_mov_b32_dpp v53, v37 row_ror:8 row_mask:0xf bank_mask:0xf
    v_mov_b32_dpp v54, v38 row_ror:8 row_mask:0xf bank_mask:0xf
    v_mov_b32_dpp v55, v39 row_ror:8 row_mask:0xf bank_mask:0xf
    s_cbranch_vccnz Go_20_f1230
    v_smfmac_f32_16x16x64_bf16 v[76:79], v[36:39], a[200:207], v19
    v_smfmac_f32_16x16x64_bf16 v[76:79], v[52:55], a[232:239], v19
Go_20_s230:
    s_waitcnt vmcnt(2)
    v_cmp_eq_u32 vcc, -1, v40
    v_mov_b32_dpp v56, v40 row_ror:8 row_mask:0xf bank_mask:0xf
    v_mov_b32_dpp v57, v41 row_ror:8 row_mask:0xf bank_mask:0xf
    v_mov_b32_dpp v58, v42 row_ror:8 row_mask:0xf bank_mask:0xf
    v_mov_b32_dpp v59, v43 row_ror:8 row_mask:0xf bank_mask:0xf
    s_cbranch_vccnz Go_20_f230
    v_smfmac_f32_16x16x64_bf16 v[76:79], v[40:43], a[208:215], v19
    v_smfmac_f32_16x16x64_bf16 v[76:79], v[56:59], a[240:247], v19
Go_20_s30:
    s_waitcnt vmcnt(1)
    v_cmp_eq_u32 vcc, -1, v44
    v_mov_b32_dpp v60, v44 row_ror:8 row_mask:0xf bank_mask:0xf
    v_mov_b32_dpp v61, v45 row_ror:8 row_mask:0xf bank_mask:0xf
    v_mov_b32_dpp v62, v46 row_ror:8 row_mask:0xf bank_mask:0xf
    v_mov_b32_dpp v63, v47 row_ror:8 row_mask:0xf bank_mask:0xf
    s_cbranch_vccnz Go_20_f30
    v_smfmac_f32_16x16x64_bf16 v[76:79], v[44:47], a[216:223], v19
    v_smfmac_f32_16x16x64_bf16 v[76:79], v[60:63], a[248:255], v19
Go_20_s0:
    s_waitcnt vmcnt(0)
    v_cmp_eq_u32 vcc, -1, v32
    v_mov_b32_dpp v48, v32 row_ror:8 row_mask:0xf bank_mask:0xf
    v_mov_b32_dpp v49, v33 row_ror:8 row_mask:0xf bank_mask:0xf
    v_mov_b32_dpp v50, v34 row_ror:8 row_mask:0xf bank_mask:0xf
    v_mov_b32_dpp v51, v35 row_ror:8 row_mask:0xf bank_mask:0xf
    s_cbranch_vccnz Go_20_f0
    v_smfmac_f32_16x16x64_bf16 v[76:79], v[32:35], a[192:199], v19
    v_smfmac_f32_16x16x64_bf16 v[76:79], v[48:51], a[224:231], v19
    s_branch Go_20_done
Go_20_f1230:
    buffer_load_dwordx4 v[36:39], v3, s[8:11], s40 offen offset:1024 sc1
    s_add_u32 s33, s33, 1
    s_cmp_gt_u32 s33, 0x100000
    s_cbranch_scc1 chain_kernel_abort
    s_branch Go_20_s2301
Go_20_f230:
    buffer_load_dwordx4 v[40:43], v3, s[8:11], s40 offen offset:2048 sc1
    s_add_u32 s33, s33, 1
    s_cmp_gt_u32 s33, 0x100000
    s_cbranch_scc1 chain_kernel_abort
    s_branch Go_20_s302
Go_20_f30:
    buffer_load_dwordx4 v[44:47], v3, s[8:11], s40 offen offset:3072 sc1
    s_add_u32 s33, s33, 1
    s_cmp_gt_u32 s33, 0x100000
    s_cbranch_scc1 chain_kernel_abort
    s_branch Go_20_s03
Go_20_f0:
    buffer_load_dwordx4 v[32:35], v3, s[8:11], s40 offen offset:0 sc1
    s_add_u32 s33, s33, 1
    s_cmp_gt_u32 s33, 0x100000
    s_cbranch_scc1 chain_kernel_abort
    s_branch Go_20_s0
Go_20_s231:
    s_waitcnt vmcnt(2)
    v_cmp_eq_u32 vcc, -1, v40
    v_mov_b32_dpp v56, v40 row_ror:8 row_mask:0xf bank_mask:0xf
    v_mov_b32_dpp v57, v41 row_ror:8 row_mask:0xf bank_mask:0xf
    v_mov_b32_dpp v58, v42 row_ror:8 row_mask:0xf bank_mask:0xf
    v_mov_b32_dpp v59, v43 row_ror:8 row_mask:0xf bank_mask:0xf
    s_cbranch_vccnz Go_20_f231
    v_smfmac_f32_16x16x64_bf16 v[76:79], v[40:43], a[208:215], v19
    v_smfmac_f32_16x16x64_bf16 v[76:79], v[56:59], a[240:247], v19
Go_20_s31:
    s_waitcnt vmcnt(1)
    v_cmp_eq_u32 vcc, -1, v44
    v_mov_b32_dpp v60, v44 row_ror:8 row_mask:0xf bank_mask:0xf
    v_mov_b32_dpp v61, v45 row_ror:8 row_mask:0xf bank_mask:0xf
    v_mov_b32_dpp v62, v46 row_ror:8 row_mask:0xf bank_mask:0xf
    v_mov_b32_dpp v63, v47 row_ror:8 row_mask:0xf bank_mask:0xf
    s_cbranch_vccnz Go_20_f31
    v_smfmac_f32_16x16x64_bf16 v[76:79], v[44:47], a[216:223], v19
    v_smfmac_f32_16x16x64_bf16 v[76:79], v[60:63], a[248:255], v19
Go_20_s1:
    s_waitcnt vmcnt(0)
    v_cmp_eq_u32 vcc, -1, v36
    v_mov_b32_dpp v52, v36 row_ror:8 row_mask:0xf bank_mask:0xf
    v_mov_b32_dpp v53, v37 row_ror:8 row_mask:0xf bank_mask:0xf
    v_mov_b32_dpp v54, v38 row_ror:8 row_mask:0xf bank_mask:0xf
    v_mov_b32_dpp v55, v39 row_ror:8 row_mask:0xf bank_mask:0xf
    s_cbranch_vccnz Go_20_f1
    v_smfmac_f32_16x16x64_bf16 v[76:79], v[36:39], a[200:207], v19
    v_smfmac_f32_16x16x64_bf16 v[76:79], v[52:55], a[232:239], v19
    s_branch Go_20_done
Go_20_f231:
    buffer_load_dwordx4 v[40:43], v3, s[8:11], s40 offen offset:2048 sc1
    s_add_u32 s33, s33, 1
    s_cmp_gt_u32 s33, 0x100000
    s_cbranch_scc1 chain_kernel_abort
    s_branch Go_20_s312
Go_20_f31:
    buffer_load_dwordx4 v[44:47], v3, s[8:11], s40 offen offset:3072 sc1
    s_add_u32 s33, s33, 1
    s_cmp_gt_u32 s33, 0x100000
    s_cbranch_scc1 chain_kernel_abort
    s_branch Go_20_s13
Go_20_f1:
    buffer_load_dwordx4 v[36:39], v3, s[8:11], s40 offen offset:1024 sc1
    s_add_u32 s33, s33, 1
    s_cmp_gt_u32 s33, 0x100000
    s_cbranch_scc1 chain_kernel_abort
    s_branch Go_20_s1
Go_20_s32:
    s_waitcnt vmcnt(1)
    v_cmp_eq_u32 vcc, -1, v44
    v_mov_b32_dpp v60, v44 row_ror:8 row_mask:0xf bank_mask:0xf
    v_mov_b32_dpp v61, v45 row_ror:8 row_mask:0xf bank_mask:0xf
    v_mov_b32_dpp v62, v46 row_ror:8 row_mask:0xf bank_mask:0xf
    v_mov_b32_dpp v63, v47 row_ror:8 row_mask:0xf bank_mask:0xf
    s_cbranch_vccnz Go_20_f32
    v_smfmac_f32_16x16x64_bf16 v[76:79], v[44:47], a[216:223], v19
    v_smfmac_f32_16x16x64_bf16 v[76:79], v[60:63], a[248:255], v19
Go_20_s2:
    s_waitcnt vmcnt(0)
    v_cmp_eq_u32 vcc, -1, v40
    v_mov_b32_dpp v56, v40 row_ror:8 row_mask:0xf bank_mask:0xf
    v_mov_b32_dpp v57, v41 row_ror:8 row_mask:0xf bank_mask:0xf
    v_mov_b32_dpp v58, v42 row_ror:8 row_mask:0xf bank_mask:0xf
    v_mov_b32_dpp v59, v43 row_ror:8 row_mask:0xf bank_mask:0xf
    s_cbranch_vccnz Go_20_f2
    v_smfmac_f32_16x16x64_bf16 v[76:79], v[40:43], a[208:215], v19
    v_smfmac_f32_16x16x64_bf16 v[76:79], v[56:59], a[240:247], v19
    s_branch Go_20_done
Go_20_f32:
    buffer_load_dwordx4 v[44:47], v3, s[8:11], s40 offen offset:3072 sc1
    s_add_u32 s33, s33, 1
    s_cmp_gt_u32 s33, 0x100000
    s_cbranch_scc1 chain_kernel_abort
    s_branch Go_20_s23
Go_20_f2:
    buffer_load_dwordx4 v[40:43], v3, s[8:11], s40 offen offset:2048 sc1
    s_add_u32 s33, s33, 1
    s_cmp_gt_u32 s33, 0x100000
    s_cbranch_scc1 chain_kernel_abort
    s_branch Go_20_s2
Go_20_s2301:
    s_waitcnt vmcnt(3)
    v_cmp_eq_u32 vcc, -1, v40
    v_mov_b32_dpp v56, v40 row_ror:8 row_mask:0xf bank_mask:0xf
    v_mov_b32_dpp v57, v41 row_ror:8 row_mask:0xf bank_mask:0xf
    v_mov_b32_dpp v58, v42 row_ror:8 row_mask:0xf bank_mask:0xf
    v_mov_b32_dpp v59, v43 row_ror:8 row_mask:0xf bank_mask:0xf
    s_cbranch_vccnz Go_20_f2301
    v_smfmac_f32_16x16x64_bf16 v[76:79], v[40:43], a[208:215], v19
    v_smfmac_f32_16x16x64_bf16 v[76:79], v[56:59], a[240:247], v19
Go_20_s301:
    s_waitcnt vmcnt(2)
    v_cmp_eq_u32 vcc, -1, v44
    v_mov_b32_dpp v60, v44 row_ror:8 row_mask:0xf bank_mask:0xf
    v_mov_b32_dpp v61, v45 row_ror:8 row_mask:0xf bank_mask:0xf
    v_mov_b32_dpp v62, v46 row_ror:8 row_mask:0xf bank_mask:0xf
    v_mov_b32_dpp v63, v47 row_ror:8 row_mask:0xf bank_mask:0xf
    s_cbranch_vccnz Go_20_f301
    v_smfmac_f32_16x16x64_bf16 v[76:79], v[44:47], a[216:223], v19
    v_smfmac_f32_16x16x64_bf16 v[76:79], v[60:63], a[248:255], v19
Go_20_s01:
    s_waitcnt vmcnt(1)
    v_cmp_eq_u32 vcc, -1, v32
    v_mov_b32_dpp v48, v32 row_ror:8 row_mask:0xf bank_mask:0xf
    v_mov_b32_dpp v49, v33 row_ror:8 row_mask:0xf bank_mask:0xf
    v_mov_b32_dpp v50, v34 row_ror:8 row_mask:0xf bank_mask:0xf
    v_mov_b32_dpp v51, v35 row_ror:8 row_mask:0xf bank_mask:0xf
    s_cbranch_vccnz Go_20_f01
    v_smfmac_f32_16x16x64_bf16 v[76:79], v[32:35], a[192:199], v19
    v_smfmac_f32_16x16x64_bf16 v[76:79], v[48:51], a[224:231], v19
    s_branch Go_20_s1
Go_20_f2301:
    buffer_load_dwordx4 v[40:43], v3, s[8:11], s40 offen offset:2048 sc1
    s_add_u32 s33, s33, 1
    s_cmp_gt_u32 s33, 0x100000
    s_cbranch_scc1 chain_kernel_abort
    s_branch Go_20_s3012
Go_20_f301:
    buffer_load_dwordx4 v[44:47], v3, s[8:11], s40 offen offset:3072 sc1
    s_add_u32 s33, s33, 1
    s_cmp_gt_u32 s33, 0x100000
    s_cbranch_scc1 chain_kernel_abort
    s_branch Go_20_s013
Go_20_f01:
    buffer_load_dwordx4 v[32:35], v3, s[8:11], s40 offen offset:0 sc1
    s_add_u32 s33, s33, 1
    s_cmp_gt_u32 s33, 0x100000
    s_cbranch_scc1 chain_kernel_abort
    s_branch Go_20_s10
Go_20_s302:
    s_waitcnt vmcnt(2)
    v_cmp_eq_u32 vcc, -1, v44
    v_mov_b32_dpp v60, v44 row_ror:8 row_mask:0xf bank_mask:0xf
    v_mov_b32_dpp v61, v45 row_ror:8 row_mask:0xf bank_mask:0xf
    v_mov_b32_dpp v62, v46 row_ror:8 row_mask:0xf bank_mask:0xf
    v_mov_b32_dpp v63, v47 row_ror:8 row_mask:0xf bank_mask:0xf
    s_cbranch_vccnz Go_20_f302
    v_smfmac_f32_16x16x64_bf16 v[76:79], v[44:47], a[216:223], v19
    v_smfmac_f32_16x16x64_bf16 v[76:79], v[60:63], a[248:255], v19
Go_20_s02:
    s_waitcnt vmcnt(1)
    v_cmp_eq_u32 vcc, -1, v32
    v_mov_b32_dpp v48, v32 row_ror:8 row_mask:0xf bank_mask:0xf
    v_mov_b32_dpp v49, v33 row_ror:8 row_mask:0xf bank_mask:0xf
    v_mov_b32_dpp v50, v34 row_ror:8 row_mask:0xf bank_mask:0xf
    v_mov_b32_dpp v51, v35 row_ror:8 row_mask:0xf bank_mask:0xf
    s_cbranch_vccnz Go_20_f02
    v_smfmac_f32_16x16x64_bf16 v[76:79], v[32:35], a[192:199], v19
    v_smfmac_f32_16x16x64_bf16 v[76:79], v[48:51], a[224:231], v19
    s_branch Go_20_s2
Go_20_f302:
    buffer_load_dwordx4 v[44:47], v3, s[8:11], s40 offen offset:3072 sc1
    s_add_u32 s33, s33, 1
    s_cmp_gt_u32 s33, 0x100000
    s_cbranch_scc1 chain_kernel_abort
    s_branch Go_20_s023
Go_20_f02:
    buffer_load_dwordx4 v[32:35], v3, s[8:11], s40 offen offset:0 sc1
    s_add_u32 s33, s33, 1
    s_cmp_gt_u32 s33, 0x100000
    s_cbranch_scc1 chain_kernel_abort
    s_branch Go_20_s20
Go_20_s03:
    s_waitcnt vmcnt(1)
    v_cmp_eq_u32 vcc, -1, v32
    v_mov_b32_dpp v48, v32 row_ror:8 row_mask:0xf bank_mask:0xf
    v_mov_b32_dpp v49, v33 row_ror:8 row_mask:0xf bank_mask:0xf
    v_mov_b32_dpp v50, v34 row_ror:8 row_mask:0xf bank_mask:0xf
    v_mov_b32_dpp v51, v35 row_ror:8 row_mask:0xf bank_mask:0xf
    s_cbranch_vccnz Go_20_f03
    v_smfmac_f32_16x16x64_bf16 v[76:79], v[32:35], a[192:199], v19
    v_smfmac_f32_16x16x64_bf16 v[76:79], v[48:51], a[224:231], v19
    s_branch Go_20_s3
Go_20_f03:
    buffer_load_dwordx4 v[32:35], v3, s[8:11], s40 offen offset:0 sc1
    s_add_u32 s33, s33, 1
    s_cmp_gt_u32 s33, 0x100000
    s_cbranch_scc1 chain_kernel_abort
    s_branch Go_20_s30
Go_20_s312:
    s_waitcnt vmcnt(2)
    v_cmp_eq_u32 vcc, -1, v44
    v_mov_b32_dpp v60, v44 row_ror:8 row_mask:0xf bank_mask:0xf
    v_mov_b32_dpp v61, v45 row_ror:8 row_mask:0xf bank_mask:0xf
    v_mov_b32_dpp v62, v46 row_ror:8 row_mask:0xf bank_mask:0xf
    v_mov_b32_dpp v63, v47 row_ror:8 row_mask:0xf bank_mask:0xf
    s_cbranch_vccnz Go_20_f312
    v_smfmac_f32_16x16x64_bf16 v[76:79], v[44:47], a[216:223], v19
    v_smfmac_f32_16x16x64_bf16 v[76:79], v[60:63], a[248:255], v19
Go_20_s12:
    s_waitcnt vmcnt(1)
    v_cmp_eq_u32 vcc, -1, v36
    v_mov_b32_dpp v52, v36 row_ror:8 row_mask:0xf bank_mask:0xf
    v_mov_b32_dpp v53, v37 row_ror:8 row_mask:0xf bank_mask:0xf
    v_mov_b32_dpp v54, v38 row_ror:8 row_mask:0xf bank_mask:0xf
    v_mov_b32_dpp v55, v39 row_ror:8 row_mask:0xf bank_mask:0xf
    s_cbranch_vccnz Go_20_f12
    v_smfmac_f32_16x16x64_bf16 v[76:79], v[36:39], a[200:207], v19
    v_smfmac_f32_16x16x64_bf16 v[76:79], v[52:55], a[232:239], v19
    s_branch Go_20_s2
Go_20_f312:
    buffer_load_dwordx4 v[44:47], v3, s[8:11], s40 offen offset:3072 sc1
    s_add_u32 s33, s33, 1
    s_cmp_gt_u32 s33, 0x100000
    s_cbranch_scc1 chain_kernel_abort
    s_branch Go_20_s123
Go_20_f12:
    buffer_load_dwordx4 v[36:39], v3, s[8:11], s40 offen offset:1024 sc1
    s_add_u32 s33, s33, 1
    s_cmp_gt_u32 s33, 0x100000
    s_cbranch_scc1 chain_kernel_abort
    s_branch Go_20_s21
Go_20_s13:
    s_waitcnt vmcnt(1)
    v_cmp_eq_u32 vcc, -1, v36
    v_mov_b32_dpp v52, v36 row_ror:8 row_mask:0xf bank_mask:0xf
    v_mov_b32_dpp v53, v37 row_ror:8 row_mask:0xf bank_mask:0xf
    v_mov_b32_dpp v54, v38 row_ror:8 row_mask:0xf bank_mask:0xf
    v_mov_b32_dpp v55, v39 row_ror:8 row_mask:0xf bank_mask:0xf
    s_cbranch_vccnz Go_20_f13
    v_smfmac_f32_16x16x64_bf16 v[76:79], v[36:39], a[200:207], v19
    v_smfmac_f32_16x16x64_bf16 v[76:79], v[52:55], a[232:239], v19
    s_branch Go_20_s3
Go_20_f13:
    buffer_load_dwordx4 v[36:39], v3, s[8:11], s40 offen offset:1024 sc1
    s_add_u32 s33, s33, 1
    s_cmp_gt_u32 s33, 0x100000
    s_cbranch_scc1 chain_kernel_abort
    s_branch Go_20_s31
Go_20_s3012:
    s_waitcnt vmcnt(3)
    v_cmp_eq_u32 vcc, -1, v44
    v_mov_b32_dpp v60, v44 row_ror:8 row_mask:0xf bank_mask:0xf
    v_mov_b32_dpp v61, v45 row_ror:8 row_mask:0xf bank_mask:0xf
    v_mov_b32_dpp v62, v46 row_ror:8 row_mask:0xf bank_mask:0xf
    v_mov_b32_dpp v63, v47 row_ror:8 row_mask:0xf bank_mask:0xf
    s_cbranch_vccnz Go_20_f3012
    v_smfmac_f32_16x16x64_bf16 v[76:79], v[44:47], a[216:223], v19
    v_smfmac_f32_16x16x64_bf16 v[76:79], v[60:63], a[248:255], v19
Go_20_s012:
    s_waitcnt vmcnt(2)
    v_cmp_eq_u32 vcc, -1, v32
    v_mov_b32_dpp v48, v32 row_ror:8 row_mask:0xf bank_mask:0xf
    v_mov_b32_dpp v49, v33 row_ror:8 row_mask:0xf bank_mask:0xf
    v_mov_b32_dpp v50, v34 row_ror:8 row_mask:0xf bank_mask:0xf
    v_mov_b32_dpp v51, v35 row_ror:8 row_mask:0xf bank_mask:0xf
    s_cbranch_vccnz Go_20_f012
    v_smfmac_f32_16x16x64_bf16 v[76:79], v[32:35], a[192:199], v19
    v_smfmac_f32_16x16x64_bf16 v[76:79], v[48:51], a[224:231], v19
    s_branch Go_20_s12
Go_20_f3012:
    buffer_load_dwordx4 v[44:47], v3, s[8:11], s40 offen offset:3072 sc1
    s_add_u32 s33, s33, 1
    s_cmp_gt_u32 s33, 0x100000
    s_cbranch_scc1 chain_kernel_abort
    s_branch Go_20_s0123
Go_20_f012:
    buffer_load_dwordx4 v[32:35], v3, s[8:11], s40 offen offset:0 sc1
    s_add_u32 s33, s33, 1
    s_cmp_gt_u32 s33, 0x100000
    s_cbranch_scc1 chain_kernel_abort
    s_branch Go_20_s120
Go_20_s013:
    s_waitcnt vmcnt(2)
    v_cmp_eq_u32 vcc, -1, v32
    v_mov_b32_dpp v48, v32 row_ror:8 row_mask:0xf bank_mask:0xf
    v_mov_b32_dpp v49, v33 row_ror:8 row_mask:0xf bank_mask:0xf
    v_mov_b32_dpp v50, v34 row_ror:8 row_mask:0xf bank_mask:0xf
    v_mov_b32_dpp v51, v35 row_ror:8 row_mask:0xf bank_mask:0xf
    s_cbranch_vccnz Go_20_f013
    v_smfmac_f32_16x16x64_bf16 v[76:79], v[32:35], a[192:199], v19
    v_smfmac_f32_16x16x64_bf16 v[76:79], v[48:51], a[224:231], v19
    s_branch Go_20_s13
Go_20_f013:
    buffer_load_dwordx4 v[32:35], v3, s[8:11], s40 offen offset:0 sc1
    s_add_u32 s33, s33, 1
    s_cmp_gt_u32 s33, 0x100000
    s_cbranch_scc1 chain_kernel_abort
    s_branch Go_20_s130
Go_20_s10:
    s_waitcnt vmcnt(1)
    v_cmp_eq_u32 vcc, -1, v36
    v_mov_b32_dpp v52, v36 row_ror:8 row_mask:0xf bank_mask:0xf
    v_mov_b32_dpp v53, v37 row_ror:8 row_mask:0xf bank_mask:0xf
    v_mov_b32_dpp v54, v38 row_ror:8 row_mask:0xf bank_mask:0xf
    v_mov_b32_dpp v55, v39 row_ror:8 row_mask:0xf bank_mask:0xf
    s_cbranch_vccnz Go_20_f10
    v_smfmac_f32_16x16x64_bf16 v[76:79], v[36:39], a[200:207], v19
    v_smfmac_f32_16x16x64_bf16 v[76:79], v[52:55], a[232:239], v19
    s_branch Go_20_s0
Go_20_f10:
    buffer_load_dwordx4 v[36:39], v3, s[8:11], s40 offen offset:1024 sc1
    s_add_u32 s33, s33, 1
    s_cmp_gt_u32 s33, 0x100000
    s_cbranch_scc1 chain_kernel_abort
    s_branch Go_20_s01
Go_20_s023:
    s_waitcnt vmcnt(2)
    v_cmp_eq_u32 vcc, -1, v32
    v_mov_b32_dpp v48, v32 row_ror:8 row_mask:0xf bank_mask:0xf
    v_mov_b32_dpp v49, v33 row_ror:8 row_mask:0xf bank_mask:0xf
    v_mov_b32_dpp v50, v34 row_ror:8 row_mask:0xf bank_mask:0xf
    v_mov_b32_dpp v51, v35 row_ror:8 row_mask:0xf bank_mask:0xf
    s_cbranch_vccnz Go_20_f023
    v_smfmac_f32_16x16x64_bf16 v[76:79], v[32:35], a[192:199], v19
    v_smfmac_f32_16x16x64_bf16 v[76:79], v[48:51], a[224:231], v19
    s_branch Go_20_s23
Go_20_f023:
    buffer_load_dwordx4 v[32:35], v3, s[8:11], s40 offen offset:0 sc1
    s_add_u32 s33, s33, 1
    s_cmp_gt_u32 s33, 0x100000
    s_cbranch_scc1 chain_kernel_abort
    s_branch Go_20_s230
Go_20_s20:
    s_waitcnt vmcnt(1)
    v_cmp_eq_u32 vcc, -1, v40
    v_mov_b32_dpp v56, v40 row_ror:8 row_mask:0xf bank_mask:0xf
    v_mov_b32_dpp v57, v41 row_ror:8 row_mask:0xf bank_mask:0xf
    v_mov_b32_dpp v58, v42 row_ror:8 row_mask:0xf bank_mask:0xf
    v_mov_b32_dpp v59, v43 row_ror:8 row_mask:0xf bank_mask:0xf
    s_cbranch_vccnz Go_20_f20
    v_smfmac_f32_16x16x64_bf16 v[76:79], v[40:43], a[208:215], v19
    v_smfmac_f32_16x16x64_bf16 v[76:79], v[56:59], a[240:247], v19
    s_branch Go_20_s0
Go_20_f20:
    buffer_load_dwordx4 v[40:43], v3, s[8:11], s40 offen offset:2048 sc1
    s_add_u32 s33, s33, 1
    s_cmp_gt_u32 s33, 0x100000
    s_cbranch_scc1 chain_kernel_abort
    s_branch Go_20_s02
Go_20_s21:
    s_waitcnt vmcnt(1)
    v_cmp_eq_u32 vcc, -1, v40
    v_mov_b32_dpp v56, v40 row_ror:8 row_mask:0xf bank_mask:0xf
    v_mov_b32_dpp v57, v41 row_ror:8 row_mask:0xf bank_mask:0xf
    v_mov_b32_dpp v58, v42 row_ror:8 row_mask:0xf bank_mask:0xf
    v_mov_b32_dpp v59, v43 row_ror:8 row_mask:0xf bank_mask:0xf
    s_cbranch_vccnz Go_20_f21
    v_smfmac_f32_16x16x64_bf16 v[76:79], v[40:43], a[208:215], v19
    v_smfmac_f32_16x16x64_bf16 v[76:79], v[56:59], a[240:247], v19
    s_branch Go_20_s1
Go_20_f21:
    buffer_load_dwordx4 v[40:43], v3, s[8:11], s40 offen offset:2048 sc1
    s_add_u32 s33, s33, 1
    s_cmp_gt_u32 s33, 0x100000
    s_cbranch_scc1 chain_kernel_abort
    s_branch Go_20_s12
Go_20_s120:
    s_waitcnt vmcnt(2)
    v_cmp_eq_u32 vcc, -1, v36
    v_mov_b32_dpp v52, v36 row_ror:8 row_mask:0xf bank_mask:0xf
    v_mov_b32_dpp v53, v37 row_ror:8 row_mask:0xf bank_mask:0xf
    v_mov_b32_dpp v54, v38 row_ror:8 row_mask:0xf bank_mask:0xf
    v_mov_b32_dpp v55, v39 row_ror:8 row_mask:0xf bank_mask:0xf
    s_cbranch_vccnz Go_20_f120
    v_smfmac_f32_16x16x64_bf16 v[76:79], v[36:39], a[200:207], v19
    v_smfmac_f32_16x16x64_bf16 v[76:79], v[52:55], a[232:239], v19
    s_branch Go_20_s20
Go_20_f120:
    buffer_load_dwordx4 v[36:39], v3, s[8:11], s40 offen offset:1024 sc1
    s_add_u32 s33, s33, 1
    s_cmp_gt_u32 s33, 0x100000
    s_cbranch_scc1 chain_kernel_abort
    s_branch Go_20_s201
Go_20_s130:
    s_waitcnt vmcnt(2)
    v_cmp_eq_u32 vcc, -1, v36
    v_mov_b32_dpp v52, v36 row_ror:8 row_mask:0xf bank_mask:0xf
    v_mov_b32_dpp v53, v37 row_ror:8 row_mask:0xf bank_mask:0xf
    v_mov_b32_dpp v54, v38 row_ror:8 row_mask:0xf bank_mask:0xf
    v_mov_b32_dpp v55, v39 row_ror:8 row_mask:0xf bank_mask:0xf
    s_cbranch_vccnz Go_20_f130
    v_smfmac_f32_16x16x64_bf16 v[76:79], v[36:39], a[200:207], v19
    v_smfmac_f32_16x16x64_bf16 v[76:79], v[52:55], a[232:239], v19
    s_branch Go_20_s30
Go_20_f130:
    buffer_load_dwordx4 v[36:39], v3, s[8:11], s40 offen offset:1024 sc1
    s_add_u32 s33, s33, 1
    s_cmp_gt_u32 s33, 0x100000
    s_cbranch_scc1 chain_kernel_abort
    s_branch Go_20_s301
Go_20_s201:
    s_waitcnt vmcnt(2)
    v_cmp_eq_u32 vcc, -1, v40
    v_mov_b32_dpp v56, v40 row_ror:8 row_mask:0xf bank_mask:0xf
    v_mov_b32_dpp v57, v41 row_ror:8 row_mask:0xf bank_mask:0xf
    v_mov_b32_dpp v58, v42 row_ror:8 row_mask:0xf bank_mask:0xf
    v_mov_b32_dpp v59, v43 row_ror:8 row_mask:0xf bank_mask:0xf
    s_cbranch_vccnz Go_20_f201
    v_smfmac_f32_16x16x64_bf16 v[76:79], v[40:43], a[208:215], v19
    v_smfmac_f32_16x16x64_bf16 v[76:79], v[56:59], a[240:247], v19
    s_branch Go_20_s01
Go_20_f201:
    buffer_load_dwordx4 v[40:43], v3, s[8:11], s40 offen offset:2048 sc1
    s_add_u32 s33, s33, 1
    s_cmp_gt_u32 s33, 0x100000
    s_cbranch_scc1 chain_kernel_abort
    s_branch Go_20_s012
L_pf_27:
    s_mov_b64 exec, -1
    buffer_load_dword v220, v9, s[8:11], s43 offen sc1
    buffer_load_dword v221, v10, s[8:11], s43 offen sc1
    buffer_load_dword v222, v11, s[8:11], s43 offen sc1
    s_add_u32 s33, s33, 1
    s_cmp_gt_u32 s33, 0x100000
    s_cbranch_scc1 chain_kernel_abort
    s_branch L_pb1_25
L_pb1_25:
    s_waitcnt vmcnt(7)
    v_add_f32 v208, v80, v223
    s_waitcnt vmcnt(5)
    v_max3_u32 v20, v223, v224, v225
    v_add_f32 v209, v224, v225
    v_cmp_eq_u32 vcc, -1, v20
    v_add_f32 v208, v208, v209
    s_nop 1
    v_mov_b32_dpp v209, v208 quad_perm:[1,0,3,2] row_mask:0xf bank_mask:0xf
    s_mov_b64 exec, s[26:27]
    v_cvt_pk_bf16_f32 v208, v208, v209
    v_min_u32 v208, 0xfffffffe, v208
    s_cbranch_vccnz L_pf_28
    s_branch L_pd_26
L_pf_28:
    s_mov_b64 exec, -1
    buffer_load_dword v223, v9, s[8:11], s44 offen sc1
    buffer_load_dword v224, v10, s[8:11], s44 offen sc1
    buffer_load_dword v225, v11, s[8:11], s44 offen sc1
    s_add_u32 s33, s33, 1
    s_cmp_gt_u32 s33, 0x100000
    s_cbranch_scc1 chain_kernel_abort
    s_branch L_pa_23
L_pa_23:
    s_waitcnt vmcnt(5)
    v_add_f32 v208, v80, v220
    s_waitcnt vmcnt(3)
    v_max3_u32 v20, v220, v221, v222
    v_add_f32 v209, v221, v222
    v_cmp_eq_u32 vcc, -1, v20
    v_add_f32 v208, v208, v209
    s_nop 1
    v_mov_b32_dpp v209, v208 quad_perm:[1,0,3,2] row_mask:0xf bank_mask:0xf
    s_mov_b64 exec, s[26:27]
    v_cvt_pk_bf16_f32 v208, v208, v209
    v_min_u32 v208, 0xfffffffe, v208
    s_cbranch_vccnz L_pf_29
    s_branch L_pd_26
L_pf_29:
    s_mov_b64 exec, -1
    buffer_load_dword v220, v9, s[8:11], s43 offen sc1
    buffer_load_dword v221, v10, s[8:11], s43 offen sc1
    buffer_load_dword v222, v11, s[8:11], s43 offen sc1
    s_add_u32 s33, s33, 1
    s_cmp_gt_u32 s33, 0x100000
    s_cbranch_scc1 chain_kernel_abort
    s_branch L_pb_24
L_pb_24:
    s_waitcnt vmcnt(5)
    v_add_f32 v208, v80, v223
    s_waitcnt vmcnt(3)
    v_max3_u32 v20, v223, v224, v225
    v_add_f32 v209, v224, v225
    v_cmp_eq_u32 vcc, -1, v20
    v_add_f32 v208, v208, v209
    s_nop 1
    v_mov_b32_dpp v209, v208 quad_perm:[1,0,3,2] row_mask:0xf bank_mask:0xf
    s_mov_b64 exec, s[26:27]
    v_cvt_pk_bf16_f32 v208, v208, v209
    v_min_u32 v208, 0xfffffffe, v208
    s_cbranch_vccnz L_pf_30
    s_branch L_pd_26
L_pf_30:
    s_mov_b64 exec, -1
    buffer_load_dword v223, v9, s[8:11], s44 offen sc1
    buffer_load_dword v224, v10, s[8:11], s44 offen sc1
    buffer_load_dword v225, v11, s[8:11], s44 offen sc1
    s_add_u32 s33, s33, 1
    s_cmp_gt_u32 s33, 0x100000
    s_cbranch_scc1 chain_kernel_abort
    s_branch L_pa_23
chain_kernel_abort:
    s_mov_b32 s12, s98
    s_and_b32 s13, s99, 0xffff
    s_mov_b32 s14, 0x100
    s_mov_b32 s15, 0x00020000
    s_mov_b64 exec, 1
    v_mov_b32 v1, s19
    v_or_b32 v1, 0xdead0000, v1
    v_mov_b32 v2, 124
    buffer_store_dword v1, v2, s[12:15], 0 offen
chain_kernel_done:
    s_endpgm
chain_kernel_end:
    s_endpgm
chain_kernel_worker:
    s_sub_u32 s56, s16, 4
    s_mov_b32 s57, s17
    s_mov_b32 s58, s18
    s_cmp_eq_u32 s56, 0
    s_cbranch_scc1 L_big_42
kvs_start:
    s_cmp_eq_u32 s56, 3
    s_cselect_b64 s[12:13], s[90:91], s[88:89]
    s_cmp_eq_u32 s56, 1
    s_cselect_b64 s[12:13], s[86:87], s[12:13]
    s_and_b32 s13, s13, 0xffff
    s_mov_b32 s14, 0x800000
    s_mov_b32 s15, 0x00020000
    s_lshl_b32 s28, s57, 8
    v_bfe_u32 v24, v0, 4, 3
    v_lshlrev_b32 v24, 1, v24
    v_and_b32 v25, 15, v0
    v_xor_b32 v24, v24, v25
    v_lshlrev_b32 v6, 4, v24
    v_bfe_u32 v24, v0, 4, 2
    v_lshl_add_u32 v6, v24, 13, v6
    v_bfe_u32 v24, v0, 6, 1
    v_lshl_add_u32 v6, v24, 16, v6
    v_bfe_u32 v24, v0, 7, 1
    v_lshl_add_u32 v6, v24, 15, v6
    s_and_b32 s60, s58, 1
    s_lshl_b32 s61, s60, 11
    s_lshr_b32 s60, s58, 1
    s_lshl_b32 s60, s60, 10
    s_add_u32 s32, s60, s61
    s_add_u32 m0, s32, 0
    s_add_u32 s61, s28, 0x0
    buffer_load_dwordx4 v6, s[12:15], s61 offen nt lds
    s_add_u32 m0, s32, 4096
    s_add_u32 s61, s28, 0x20000
    buffer_load_dwordx4 v6, s[12:15], s61 offen nt lds
    s_add_u32 m0, s32, 8192
    s_add_u32 s61, s28, 0x40000
    buffer_load_dwordx4 v6, s[12:15], s61 offen nt lds
    s_add_u32 m0, s32, 12288
    s_add_u32 s61, s28, 0x60000
    buffer_load_dwordx4 v6, s[12:15], s61 offen nt lds
    s_add_u32 m0, s32, 16384
    s_add_u32 s61, s28, 0x80000
    buffer_load_dwordx4 v6, s[12:15], s61 offen nt lds
    s_add_u32 m0, s32, 20480
    s_add_u32 s61, s28, 0xa0000
    buffer_load_dwordx4 v6, s[12:15], s61 offen nt lds
    s_add_u32 m0, s32, 24576
    s_add_u32 s61, s28, 0xc0000
    buffer_load_dwordx4 v6, s[12:15], s61 offen nt lds
    s_add_u32 m0, s32, 28672
    s_add_u32 s61, s28, 0xe0000
    buffer_load_dwordx4 v6, s[12:15], s61 offen nt lds
    s_mov_b32 s8, s82
    s_and_b32 s9, s83, 0xffff
    s_mov_b32 s10, 0x400000
    s_mov_b32 s11, 0x00020000
    s_mov_b32 s16, s100
    s_and_b32 s17, s101, 0xffff
    s_mov_b32 s18, 0xa000000
    s_mov_b32 s19, 0x00020000
    v_and_b32 v24, 63, v0
    v_lshlrev_b32 v1, 4, v24
    v_add_u32 v12, 4096, v1
    v_lshlrev_b32 v10, 7, v24
    s_lshl_b32 s27, s57, 13
    s_and_b32 s60, s58, 1
    s_lshl_b32 s60, s60, 18
    s_add_u32 s60, s60, s27
    buffer_load_dword v13, v10, s[8:11], s60 offen
    s_add_u32 s27, s27, 0x80000
    s_add_u32 m0, s32, 32768
    s_add_u32 s61, s28, 0x100000
    buffer_load_dwordx4 v6, s[12:15], s61 offen nt lds
    s_add_u32 m0, s32, 36864
    s_add_u32 s61, s28, 0x120000
    buffer_load_dwordx4 v6, s[12:15], s61 offen nt lds
    s_add_u32 m0, s32, 40960
    s_add_u32 s61, s28, 0x140000
    buffer_load_dwordx4 v6, s[12:15], s61 offen nt lds
    s_add_u32 m0, s32, 45056
    s_add_u32 s61, s28, 0x160000
    buffer_load_dwordx4 v6, s[12:15], s61 offen nt lds
    s_add_u32 m0, s32, 49152
    s_add_u32 s61, s28, 0x180000
    buffer_load_dwordx4 v6, s[12:15], s61 offen nt lds
    s_add_u32 m0, s32, 53248
    s_add_u32 s61, s28, 0x1a0000
    buffer_load_dwordx4 v6, s[12:15], s61 offen nt lds
    s_add_u32 m0, s32, 57344
    s_add_u32 s61, s28, 0x1c0000
    buffer_load_dwordx4 v6, s[12:15], s61 offen nt lds
    s_add_u32 m0, s32, 61440
    s_add_u32 s61, s28, 0x1e0000
    buffer_load_dwordx4 v6, s[12:15], s61 offen nt lds
    v_bfe_u32 v24, v0, 4, 3
    v_and_b32 v25, 7, v0
    v_xor_b32 v24, v24, v25
    v_lshlrev_b32 v2, 4, v24
    v_lshrrev_b32 v24, 3, v0
    v_lshl_add_u32 v2, v24, 11, v2
    v_bfe_u32 v24, v0, 1, 3
    v_bfe_u32 v25, v0, 4, 2
    v_xor_b32 v24, v24, v25
    v_lshlrev_b32 v4, 4, v24
    v_and_b32 v25, 15, v0
    v_lshl_add_u32 v4, v25, 7, v4
    v_add_u32 v4, 98304, v4
    v_xor_b32 v5, 64, v4
    s_add_u32 m0, s32, 65536
    s_add_u32 s61, s28, 0x200000
    buffer_load_dwordx4 v6, s[12:15], s61 offen nt lds
    s_add_u32 m0, s32, 69632
    s_add_u32 s61, s28, 0x220000
    buffer_load_dwordx4 v6, s[12:15], s61 offen nt lds
    s_add_u32 m0, s32, 73728
    s_add_u32 s61, s28, 0x240000
    buffer_load_dwordx4 v6, s[12:15], s61 offen nt lds
    s_add_u32 m0, s32, 77824
    s_add_u32 s61, s28, 0x260000
    buffer_load_dwordx4 v6, s[12:15], s61 offen nt lds
    s_add_u32 m0, s32, 81920
    s_add_u32 s61, s28, 0x280000
    buffer_load_dwordx4 v6, s[12:15], s61 offen nt lds
    s_add_u32 m0, s32, 86016
    s_add_u32 s61, s28, 0x2a0000
    buffer_load_dwordx4 v6, s[12:15], s61 offen nt lds
    s_add_u32 m0, s32, 90112
    s_add_u32 s61, s28, 0x2c0000
    buffer_load_dwordx4 v6, s[12:15], s61 offen nt lds
    s_add_u32 m0, s32, 94208
    s_add_u32 s61, s28, 0x2e0000
    buffer_load_dwordx4 v6, s[12:15], s61 offen nt lds
    v_bfe_u32 v24, v0, 2, 3
    v_lshrrev_b32 v25, 6, v0
    v_lshlrev_b32 v25, 1, v25
    v_xor_b32 v24, v24, v25
    v_lshlrev_b32 v8, 5, v24
    v_bfe_u32 v24, v0, 0, 2
    v_lshl_add_u32 v8, v24, 3, v8
    v_bfe_u32 v24, v0, 2, 2
    v_lshl_add_u32 v8, v24, 8, v8
    v_bfe_u32 v24, v0, 4, 2
    v_lshl_add_u32 v8, v24, 11, v8
    v_xor_b32 v9, 32, v8
    v_mov_b32 v28, -1
    v_mov_b32 v29, -1
    v_mov_b32 v30, -1
    v_mov_b32 v31, -1
    s_lshl_b32 s20, s58, 10
    s_add_u32 s20, s20, 98304
    s_mov_b32 s21, 98304
    s_mov_b32 s23, 0
    s_mov_b32 s29, 32768
    s_add_u32 m0, s32, 98304
    s_add_u32 s61, s28, 0x300000
    buffer_load_dwordx4 v6, s[12:15], s61 offen nt lds
    s_add_u32 m0, s32, 102400
    s_add_u32 s61, s28, 0x320000
    buffer_load_dwordx4 v6, s[12:15], s61 offen nt lds
    s_add_u32 m0, s32, 106496
    s_add_u32 s61, s28, 0x340000
    buffer_load_dwordx4 v6, s[12:15], s61 offen nt lds
    s_add_u32 m0, s32, 110592
    s_add_u32 s61, s28, 0x360000
    buffer_load_dwordx4 v6, s[12:15], s61 offen nt lds
    s_add_u32 m0, s32, 114688
    s_add_u32 s61, s28, 0x380000
    buffer_load_dwordx4 v6, s[12:15], s61 offen nt lds
    s_add_u32 m0, s32, 118784
    s_add_u32 s61, s28, 0x3a0000
    buffer_load_dwordx4 v6, s[12:15], s61 offen nt lds
    s_add_u32 m0, s32, 122880
    s_add_u32 s61, s28, 0x3c0000
    buffer_load_dwordx4 v6, s[12:15], s61 offen nt lds
    s_add_u32 m0, s32, 126976
    s_add_u32 s61, s28, 0x3e0000
    buffer_load_dwordx4 v6, s[12:15], s61 offen nt lds
    s_lshl_b32 s30, s57, 16
    s_cmp_eq_u32 s56, 3
    s_cselect_b32 s60, 11, 10
    s_cselect_b32 s61, 0x4000, 0
    s_lshl_b32 s60, s58, s60
    s_add_u32 s30, s30, s60
    s_add_u32 s30, s30, s61
    s_lshl_b32 s31, s57, 14
    s_lshr_b32 s61, s61, 2
    s_add_u32 s31, s31, s61
    s_lshl_b32 s60, s58, 10
    s_add_u32 s31, s31, s60
    s_add_u32 s31, s31, 0x8000000
    s_cmp_eq_u32 s56, 1
    s_cselect_b32 s31, 0xa000000, s31
    s_cselect_b32 s60, 0x8000, 0
    s_add_u32 s30, s30, s60
    s_add_u32 m0, s32, 131072
    s_add_u32 s61, s28, 0x400000
    buffer_load_dwordx4 v6, s[12:15], s61 offen nt lds
    s_add_u32 m0, s32, 135168
    s_add_u32 s61, s28, 0x420000
    buffer_load_dwordx4 v6, s[12:15], s61 offen nt lds
    s_add_u32 m0, s32, 139264
    s_add_u32 s61, s28, 0x440000
    buffer_load_dwordx4 v6, s[12:15], s61 offen nt lds
    s_add_u32 m0, s32, 143360
    s_add_u32 s61, s28, 0x460000
    buffer_load_dwordx4 v6, s[12:15], s61 offen nt lds
    s_add_u32 m0, s32, 147456
    s_add_u32 s61, s28, 0x480000
    buffer_load_dwordx4 v6, s[12:15], s61 offen nt lds
    s_add_u32 m0, s32, 151552
    s_add_u32 s61, s28, 0x4a0000
    buffer_load_dwordx4 v6, s[12:15], s61 offen nt lds
    s_add_u32 m0, s32, 155648
    s_add_u32 s61, s28, 0x4c0000
    buffer_load_dwordx4 v6, s[12:15], s61 offen nt lds
    s_add_u32 m0, s32, 159744
    s_add_u32 s61, s28, 0x4e0000
    buffer_load_dwordx4 v6, s[12:15], s61 offen nt lds
    s_waitcnt vmcnt(33)
    s_barrier
    ds_read_b64_tr_b16 a[0:1], v8 offset:0
    ds_read_b64_tr_b16 a[2:3], v8 offset:1024
    ds_read_b64_tr_b16 a[4:5], v9 offset:0
    ds_read_b64_tr_b16 a[6:7], v9 offset:1024
    ds_read_b64_tr_b16 a[8:9], v8 offset:8192
    ds_read_b64_tr_b16 a[10:11], v8 offset:9216
    ds_read_b64_tr_b16 a[12:13], v9 offset:8192
    ds_read_b64_tr_b16 a[14:15], v9 offset:9216
    s_waitcnt lgkmcnt(0)
    ds_read_b64_tr_b16 a[16:17], v8 offset:16384
    ds_read_b64_tr_b16 a[18:19], v8 offset:17408
    ds_read_b64_tr_b16 a[20:21], v9 offset:16384
    ds_read_b64_tr_b16 a[22:23], v9 offset:17408
    ds_read_b64_tr_b16 a[24:25], v8 offset:24576
    ds_read_b64_tr_b16 a[26:27], v8 offset:25600
    ds_read_b64_tr_b16 a[28:29], v9 offset:24576
    ds_read_b64_tr_b16 a[30:31], v9 offset:25600
    s_waitcnt lgkmcnt(0)
    s_waitcnt vmcnt(24)
    s_barrier
    s_add_u32 m0, s32, 0
    s_add_u32 s61, s28, 0x500000
    buffer_load_dwordx4 v6, s[12:15], s61 offen nt lds
    s_add_u32 m0, s32, 4096
    s_add_u32 s61, s28, 0x520000
    buffer_load_dwordx4 v6, s[12:15], s61 offen nt lds
    s_add_u32 m0, s32, 8192
    s_add_u32 s61, s28, 0x540000
    buffer_load_dwordx4 v6, s[12:15], s61 offen nt lds
    s_add_u32 m0, s32, 12288
    s_add_u32 s61, s28, 0x560000
    buffer_load_dwordx4 v6, s[12:15], s61 offen nt lds
    s_add_u32 m0, s32, 16384
    s_add_u32 s61, s28, 0x580000
    buffer_load_dwordx4 v6, s[12:15], s61 offen nt lds
    s_add_u32 m0, s32, 20480
    s_add_u32 s61, s28, 0x5a0000
    buffer_load_dwordx4 v6, s[12:15], s61 offen nt lds
    s_add_u32 m0, s32, 24576
    s_add_u32 s61, s28, 0x5c0000
    buffer_load_dwordx4 v6, s[12:15], s61 offen nt lds
    s_add_u32 m0, s32, 28672
    s_add_u32 s61, s28, 0x5e0000
    buffer_load_dwordx4 v6, s[12:15], s61 offen nt lds
    ds_read_b64_tr_b16 a[32:33], v8 offset:32768
    ds_read_b64_tr_b16 a[34:35], v8 offset:33792
    ds_read_b64_tr_b16 a[36:37], v9 offset:32768
    ds_read_b64_tr_b16 a[38:39], v9 offset:33792
    ds_read_b64_tr_b16 a[40:41], v8 offset:40960
    ds_read_b64_tr_b16 a[42:43], v8 offset:41984
    ds_read_b64_tr_b16 a[44:45], v9 offset:40960
    ds_read_b64_tr_b16 a[46:47], v9 offset:41984
    s_waitcnt lgkmcnt(0)
    ds_read_b64_tr_b16 a[48:49], v8 offset:49152
    ds_read_b64_tr_b16 a[50:51], v8 offset:50176
    ds_read_b64_tr_b16 a[52:53], v9 offset:49152
    ds_read_b64_tr_b16 a[54:55], v9 offset:50176
    ds_read_b64_tr_b16 a[56:57], v8 offset:57344
    ds_read_b64_tr_b16 a[58:59], v8 offset:58368
    ds_read_b64_tr_b16 a[60:61], v9 offset:57344
    ds_read_b64_tr_b16 a[62:63], v9 offset:58368
    s_waitcnt lgkmcnt(0)
    s_waitcnt vmcnt(24)
    s_barrier
    s_add_u32 m0, s32, 32768
    s_add_u32 s61, s28, 0x600000
    buffer_load_dwordx4 v6, s[12:15], s61 offen nt lds
    s_add_u32 m0, s32, 36864
    s_add_u32 s61, s28, 0x620000
    buffer_load_dwordx4 v6, s[12:15], s61 offen nt lds
    s_add_u32 m0, s32, 40960
    s_add_u32 s61, s28, 0x640000
    buffer_load_dwordx4 v6, s[12:15], s61 offen nt lds
    s_add_u32 m0, s32, 45056
    s_add_u32 s61, s28, 0x660000
    buffer_load_dwordx4 v6, s[12:15], s61 offen nt lds
    s_add_u32 m0, s32, 49152
    s_add_u32 s61, s28, 0x680000
    buffer_load_dwordx4 v6, s[12:15], s61 offen nt lds
    s_add_u32 m0, s32, 53248
    s_add_u32 s61, s28, 0x6a0000
    buffer_load_dwordx4 v6, s[12:15], s61 offen nt lds
    s_add_u32 m0, s32, 57344
    s_add_u32 s61, s28, 0x6c0000
    buffer_load_dwordx4 v6, s[12:15], s61 offen nt lds
    s_add_u32 m0, s32, 61440
    s_add_u32 s61, s28, 0x6e0000
    buffer_load_dwordx4 v6, s[12:15], s61 offen nt lds
    v_add_u32 v8, 0x10000, v8
    v_add_u32 v9, 0x10000, v9
    ds_read_b64_tr_b16 a[64:65], v8 offset:0
    ds_read_b64_tr_b16 a[66:67], v8 offset:1024
    ds_read_b64_tr_b16 a[68:69], v9 offset:0
    ds_read_b64_tr_b16 a[70:71], v9 offset:1024
    ds_read_b64_tr_b16 a[72:73], v8 offset:8192
    ds_read_b64_tr_b16 a[74:75], v8 offset:9216
    ds_read_b64_tr_b16 a[76:77], v9 offset:8192
    ds_read_b64_tr_b16 a[78:79], v9 offset:9216
    s_waitcnt lgkmcnt(0)
    ds_read_b64_tr_b16 a[80:81], v8 offset:16384
    ds_read_b64_tr_b16 a[82:83], v8 offset:17408
    ds_read_b64_tr_b16 a[84:85], v9 offset:16384
    ds_read_b64_tr_b16 a[86:87], v9 offset:17408
    ds_read_b64_tr_b16 a[88:89], v8 offset:24576
    ds_read_b64_tr_b16 a[90:91], v8 offset:25600
    ds_read_b64_tr_b16 a[92:93], v9 offset:24576
    ds_read_b64_tr_b16 a[94:95], v9 offset:25600
    s_waitcnt lgkmcnt(0)
    s_waitcnt vmcnt(24)
    s_barrier
    s_add_u32 m0, s32, 65536
    s_add_u32 s61, s28, 0x700000
    buffer_load_dwordx4 v6, s[12:15], s61 offen nt lds
    s_add_u32 m0, s32, 69632
    s_add_u32 s61, s28, 0x720000
    buffer_load_dwordx4 v6, s[12:15], s61 offen nt lds
    s_add_u32 m0, s32, 73728
    s_add_u32 s61, s28, 0x740000
    buffer_load_dwordx4 v6, s[12:15], s61 offen nt lds
    s_add_u32 m0, s32, 77824
    s_add_u32 s61, s28, 0x760000
    buffer_load_dwordx4 v6, s[12:15], s61 offen nt lds
    s_add_u32 m0, s32, 81920
    s_add_u32 s61, s28, 0x780000
    buffer_load_dwordx4 v6, s[12:15], s61 offen nt lds
    s_add_u32 m0, s32, 86016
    s_add_u32 s61, s28, 0x7a0000
    buffer_load_dwordx4 v6, s[12:15], s61 offen nt lds
    s_add_u32 m0, s32, 90112
    s_add_u32 s61, s28, 0x7c0000
    buffer_load_dwordx4 v6, s[12:15], s61 offen nt lds
    s_add_u32 m0, s32, 94208
    s_add_u32 s61, s28, 0x7e0000
    buffer_load_dwordx4 v6, s[12:15], s61 offen nt lds
    v_mov_b32 v24, 4
    global_load_dword v11, v24, s[98:99] sc1
    s_or_b32 s60, s2, s58
    s_cbranch_scc1 L_rw_43
    s_lshl_b32 s62, s56, 3
    s_add_u32 s62, s62, 160
    s_mov_b32 s63, 0
L_rp_44:
    s_load_dwordx2 s[60:61], s[98:99], s62 glc
    s_add_u32 s63, s63, 1
    s_cmp_gt_u32 s63, 0x100000
    s_cbranch_scc1 chain_kernel_wabort
    s_waitcnt lgkmcnt(0)
    s_cmp_lt_u32 s61, 0x2000
    s_cbranch_scc1 L_rp_44
    s_lshr_b32 s61, s95, 8
    s_cmp_eq_u32 s60, -1
    s_cselect_b32 s94, -1, s61
L_rw_43:
    ds_read_b64_tr_b16 a[96:97], v8 offset:32768
    ds_read_b64_tr_b16 a[98:99], v8 offset:33792
    ds_read_b64_tr_b16 a[100:101], v9 offset:32768
    ds_read_b64_tr_b16 a[102:103], v9 offset:33792
    ds_read_b64_tr_b16 a[104:105], v8 offset:40960
    ds_read_b64_tr_b16 a[106:107], v8 offset:41984
    ds_read_b64_tr_b16 a[108:109], v9 offset:40960
    ds_read_b64_tr_b16 a[110:111], v9 offset:41984
    s_waitcnt lgkmcnt(0)
    ds_read_b64_tr_b16 a[112:113], v8 offset:49152
    ds_read_b64_tr_b16 a[114:115], v8 offset:50176
    ds_read_b64_tr_b16 a[116:117], v9 offset:49152
    ds_read_b64_tr_b16 a[118:119], v9 offset:50176
    ds_read_b64_tr_b16 a[120:121], v8 offset:57344
    ds_read_b64_tr_b16 a[122:123], v8 offset:58368
    ds_read_b64_tr_b16 a[124:125], v9 offset:57344
    ds_read_b64_tr_b16 a[126:127], v9 offset:58368
    s_waitcnt lgkmcnt(0)
    s_waitcnt vmcnt(24)
    s_barrier
    s_add_u32 m0, s20, 0
    s_nop 0
    buffer_load_dwordx4 v2, s[8:11], s23 offen offset:0 lds
    s_add_u32 m0, s20, 3968
    s_nop 0
    buffer_load_dwordx4 v2, s[8:11], s23 offen offset:128 lds
    s_add_u32 m0, s20, 7936
    s_nop 0
    buffer_load_dwordx4 v2, s[8:11], s23 offen offset:256 lds
    s_add_u32 m0, s20, 11904
    s_nop 0
    buffer_load_dwordx4 v2, s[8:11], s23 offen offset:384 lds
    s_add_u32 m0, s20, 15872
    s_nop 0
    buffer_load_dwordx4 v2, s[8:11], s23 offen offset:512 lds
    s_add_u32 m0, s20, 19840
    s_nop 0
    buffer_load_dwordx4 v2, s[8:11], s23 offen offset:640 lds
    s_add_u32 m0, s20, 23808
    s_nop 0
    buffer_load_dwordx4 v2, s[8:11], s23 offen offset:768 lds
    s_add_u32 m0, s20, 27776
    s_nop 0
    buffer_load_dwordx4 v2, s[8:11], s23 offen offset:896 lds
    s_add_u32 s23, s23, 1024
    s_bitcmp1_b32 s23, 11
    s_cselect_b32 s60, 0xf800, 0
    s_add_u32 s23, s23, s60
    s_add_u32 s20, s20, 32768
    s_cmp_ge_u32 s20, 163840
    s_cselect_b32 s60, 163840, 0
    s_sub_u32 s20, s20, s60
    v_add_u32 v8, 0x10000, v8
    v_add_u32 v9, 0x10000, v9
    ds_read_b64_tr_b16 a[128:129], v8 offset:0
    ds_read_b64_tr_b16 a[130:131], v8 offset:1024
    ds_read_b64_tr_b16 a[132:133], v9 offset:0
    ds_read_b64_tr_b16 a[134:135], v9 offset:1024
    ds_read_b64_tr_b16 a[136:137], v8 offset:8192
    ds_read_b64_tr_b16 a[138:139], v8 offset:9216
    ds_read_b64_tr_b16 a[140:141], v9 offset:8192
    ds_read_b64_tr_b16 a[142:143], v9 offset:9216
    s_waitcnt lgkmcnt(0)
    ds_read_b64_tr_b16 a[144:145], v8 offset:16384
    ds_read_b64_tr_b16 a[146:147], v8 offset:17408
    ds_read_b64_tr_b16 a[148:149], v9 offset:16384
    ds_read_b64_tr_b16 a[150:151], v9 offset:17408
    ds_read_b64_tr_b16 a[152:153], v8 offset:24576
    ds_read_b64_tr_b16 a[154:155], v8 offset:25600
    ds_read_b64_tr_b16 a[156:157], v9 offset:24576
    ds_read_b64_tr_b16 a[158:159], v9 offset:25600
    s_waitcnt lgkmcnt(0)
    s_waitcnt vmcnt(24)
    s_barrier
    s_add_u32 m0, s20, 0
    s_nop 0
    buffer_load_dwordx4 v2, s[8:11], s23 offen offset:0 lds
    s_add_u32 m0, s20, 3968
    s_nop 0
    buffer_load_dwordx4 v2, s[8:11], s23 offen offset:128 lds
    s_add_u32 m0, s20, 7936
    s_nop 0
    buffer_load_dwordx4 v2, s[8:11], s23 offen offset:256 lds
    s_add_u32 m0, s20, 11904
    s_nop 0
    buffer_load_dwordx4 v2, s[8:11], s23 offen offset:384 lds
    s_add_u32 m0, s20, 15872
    s_nop 0
    buffer_load_dwordx4 v2, s[8:11], s23 offen offset:512 lds
    s_add_u32 m0, s20, 19840
    s_nop 0
    buffer_load_dwordx4 v2, s[8:11], s23 offen offset:640 lds
    s_add_u32 m0, s20, 23808
    s_nop 0
    buffer_load_dwordx4 v2, s[8:11], s23 offen offset:768 lds
    s_add_u32 m0, s20, 27776
    s_nop 0
    buffer_load_dwordx4 v2, s[8:11], s23 offen offset:896 lds
    s_add_u32 s23, s23, 1024
    s_bitcmp1_b32 s23, 11
    s_cselect_b32 s60, 0xf800, 0
    s_add_u32 s23, s23, s60
    s_add_u32 s20, s20, 32768
    s_cmp_ge_u32 s20, 163840
    s_cselect_b32 s60, 163840, 0
    s_sub_u32 s20, s20, s60
    v_add_u32 v8, 0xfffe0000, v8
    v_add_u32 v9, 0xfffe0000, v9
    ds_read_b64_tr_b16 a[160:161], v8 offset:0
    ds_read_b64_tr_b16 a[162:163], v8 offset:1024
    ds_read_b64_tr_b16 a[164:165], v9 offset:0
    ds_read_b64_tr_b16 a[166:167], v9 offset:1024
    ds_read_b64_tr_b16 a[168:169], v8 offset:8192
    ds_read_b64_tr_b16 a[170:171], v8 offset:9216
    ds_read_b64_tr_b16 a[172:173], v9 offset:8192
    ds_read_b64_tr_b16 a[174:175], v9 offset:9216
    s_waitcnt lgkmcnt(0)
    ds_read_b64_tr_b16 a[176:177], v8 offset:16384
    ds_read_b64_tr_b16 a[178:179], v8 offset:17408
    ds_read_b64_tr_b16 a[180:181], v9 offset:16384
    ds_read_b64_tr_b16 a[182:183], v9 offset:17408
    ds_read_b64_tr_b16 a[184:185], v8 offset:24576
    ds_read_b64_tr_b16 a[186:187], v8 offset:25600
    ds_read_b64_tr_b16 a[188:189], v9 offset:24576
    ds_read_b64_tr_b16 a[190:191], v9 offset:25600
    s_waitcnt lgkmcnt(0)
    s_waitcnt vmcnt(24)
    s_barrier
    s_add_u32 m0, s20, 0
    s_nop 0
    buffer_load_dwordx4 v2, s[8:11], s23 offen offset:0 lds
    s_add_u32 m0, s20, 3968
    s_nop 0
    buffer_load_dwordx4 v2, s[8:11], s23 offen offset:128 lds
    s_add_u32 m0, s20, 7936
    s_nop 0
    buffer_load_dwordx4 v2, s[8:11], s23 offen offset:256 lds
    s_add_u32 m0, s20, 11904
    s_nop 0
    buffer_load_dwordx4 v2, s[8:11], s23 offen offset:384 lds
    s_add_u32 m0, s20, 15872
    s_nop 0
    buffer_load_dwordx4 v2, s[8:11], s23 offen offset:512 lds
    s_add_u32 m0, s20, 19840
    s_nop 0
    buffer_load_dwordx4 v2, s[8:11], s23 offen offset:640 lds
    s_add_u32 m0, s20, 23808
    s_nop 0
    buffer_load_dwordx4 v2, s[8:11], s23 offen offset:768 lds
    s_add_u32 m0, s20, 27776
    s_nop 0
    buffer_load_dwordx4 v2, s[8:11], s23 offen offset:896 lds
    s_add_u32 s23, s23, 1024
    s_bitcmp1_b32 s23, 11
    s_cselect_b32 s60, 0xf800, 0
    s_add_u32 s23, s23, s60
    s_add_u32 s20, s20, 32768
    s_cmp_ge_u32 s20, 163840
    s_cselect_b32 s60, 163840, 0
    s_sub_u32 s20, s20, s60
    ds_read_b64_tr_b16 a[192:193], v8 offset:32768
    ds_read_b64_tr_b16 a[194:195], v8 offset:33792
    ds_read_b64_tr_b16 a[196:197], v9 offset:32768
    ds_read_b64_tr_b16 a[198:199], v9 offset:33792
    ds_read_b64_tr_b16 a[200:201], v8 offset:40960
    ds_read_b64_tr_b16 a[202:203], v8 offset:41984
    ds_read_b64_tr_b16 a[204:205], v9 offset:40960
    ds_read_b64_tr_b16 a[206:207], v9 offset:41984
    s_waitcnt lgkmcnt(0)
    ds_read_b64_tr_b16 a[208:209], v8 offset:49152
    ds_read_b64_tr_b16 a[210:211], v8 offset:50176
    ds_read_b64_tr_b16 a[212:213], v9 offset:49152
    ds_read_b64_tr_b16 a[214:215], v9 offset:50176
    ds_read_b64_tr_b16 a[216:217], v8 offset:57344
    ds_read_b64_tr_b16 a[218:219], v8 offset:58368
    ds_read_b64_tr_b16 a[220:221], v9 offset:57344
    ds_read_b64_tr_b16 a[222:223], v9 offset:58368
    s_waitcnt lgkmcnt(0)
    s_waitcnt vmcnt(24)
    s_barrier
    s_cmp_lg_u32 s2, 0
    s_cbranch_scc1 L_rok_45
    v_mov_b32 v24, 32768
    s_cmp_lg_u32 s58, 0
    s_cbranch_scc1 L_rw_46
    v_mov_b32 v25, s94
    ds_write_b32 v24, v25
    s_waitcnt lgkmcnt(0)
L_rw_46:
    s_barrier
    ds_read_b32 v25, v24
    s_waitcnt lgkmcnt(0)
    v_readfirstlane_b32 s60, v25
    s_mov_b32 s2, 1
    s_cmp_eq_u32 s60, -1
    s_cbranch_scc1 L_rok_45
    s_mov_b32 s57, s60
    s_waitcnt vmcnt(0)
    s_barrier
    s_cmp_ge_u32 s57, 32
    s_cbranch_scc1 chain_kernel_end
    s_branch kvs_start
L_rok_45:
    v_add_u32 v8, 0x10000, v8
    v_add_u32 v9, 0x10000, v9
    ds_read_b64_tr_b16 a[224:225], v8 offset:0
    ds_read_b64_tr_b16 a[226:227], v8 offset:1024
    ds_read_b64_tr_b16 a[228:229], v9 offset:0
    ds_read_b64_tr_b16 a[230:231], v9 offset:1024
    ds_read_b64_tr_b16 a[232:233], v8 offset:8192
    ds_read_b64_tr_b16 a[234:235], v8 offset:9216
    ds_read_b64_tr_b16 a[236:237], v9 offset:8192
    ds_read_b64_tr_b16 a[238:239], v9 offset:9216
    s_waitcnt lgkmcnt(0)
    ds_read_b64_tr_b16 a[240:241], v8 offset:16384
    ds_read_b64_tr_b16 a[242:243], v8 offset:17408
    ds_read_b64_tr_b16 a[244:245], v9 offset:16384
    ds_read_b64_tr_b16 a[246:247], v9 offset:17408
    ds_read_b64_tr_b16 a[248:249], v8 offset:24576
    ds_read_b64_tr_b16 a[250:251], v8 offset:25600
    ds_read_b64_tr_b16 a[252:253], v9 offset:24576
    ds_read_b64_tr_b16 a[254:255], v9 offset:25600
    s_waitcnt lgkmcnt(0)
    s_waitcnt vmcnt(16)
    s_barrier
    s_mov_b32 s62, 0
L_pp_47:
    v_readfirstlane_b32 s59, v11
    s_and_b32 s60, s59, 0xff
    s_cmp_ge_u32 s60, 15
    s_cbranch_scc1 L_pok_48
    v_mov_b32 v24, 4
    global_load_dword v11, v24, s[98:99] sc1
    s_add_u32 s62, s62, 1
    s_cmp_gt_u32 s62, 0x200000
    s_cbranch_scc1 chain_kernel_wabort
    s_waitcnt vmcnt(0)
    s_branch L_pp_47
L_pok_48:
    s_cmp_ge_u32 s59, 0x800
    s_cselect_b32 s59, 0x2000, 0
    s_xor_b32 s31, s31, s59
    s_xor_b32 s30, s30, s59
    s_mov_b32 s24, 0
    s_mov_b32 s18, 0
    s_cmp_eq_u32 s56, 3
    s_cbranch_scc1 L_kvv_49
    ds_read_b128 v[72:75], v4 offset:0
    ds_read_b128 v[76:79], v4 offset:2048
    ds_read_b128 v[80:83], v5 offset:0
    ds_read_b128 v[84:87], v5 offset:2048
    ds_read_b128 v[88:91], v4 offset:4096
    ds_read_b128 v[92:95], v4 offset:6144
    s_mov_b32 s34, 0x2042258
    s_mov_b32 s35, 0x40004004
    s_cmp_eq_u32 s58, 0
    s_cselect_b32 s33, s27, 0x400000
    s_mov_b32 s25, 0
    s_mov_b32 s26, 0
kvsk:
    s_waitcnt lgkmcnt(4)
    v_mfma_f32_16x16x32_bf16 v[32:35], a[0:3], v[72:75], 0
    ds_read_b128 v[96:99], v5 offset:4096
    v_mfma_f32_16x16x32_bf16 v[36:39], a[4:7], v[72:75], 0
    ds_read_b128 v[100:103], v5 offset:6144
    v_mfma_f32_16x16x32_bf16 v[44:47], a[4:7], v[76:79], 0
    v_mfma_f32_16x16x32_bf16 v[40:43], a[0:3], v[76:79], 0
    v_cvt_pk_bf16_f32 v64, v48, v49
    s_waitcnt lgkmcnt(4)
    v_mfma_f32_16x16x32_bf16 v[32:35], a[8:11], v[80:83], v[32:35]
    ds_read_b128 v[72:75], v4 offset:8192
    v_cvt_pk_bf16_f32 v65, v50, v51
    v_mfma_f32_16x16x32_bf16 v[36:39], a[12:15], v[80:83], v[36:39]
    ds_read_b128 v[76:79], v4 offset:10240
    v_cvt_pk_bf16_f32 v66, v52, v53
    v_mfma_f32_16x16x32_bf16 v[44:47], a[12:15], v[84:87], v[44:47]
    v_cvt_pk_bf16_f32 v67, v54, v55
    v_cvt_pk_bf16_f32 v68, v56, v57
    v_mfma_f32_16x16x32_bf16 v[40:43], a[8:11], v[84:87], v[40:43]
    v_cvt_pk_bf16_f32 v69, v58, v59
    s_waitcnt lgkmcnt(4)
    v_mfma_f32_16x16x32_bf16 v[32:35], a[16:19], v[88:91], v[32:35]
    ds_read_b128 v[80:83], v5 offset:8192
    v_cvt_pk_bf16_f32 v70, v60, v61
    v_mfma_f32_16x16x32_bf16 v[36:39], a[20:23], v[88:91], v[36:39]
    ds_read_b128 v[84:87], v5 offset:10240
    v_cvt_pk_bf16_f32 v71, v62, v63
    v_mfma_f32_16x16x32_bf16 v[44:47], a[20:23], v[92:95], v[44:47]
    buffer_store_dwordx4 v[64:67], v1, s[16:19], s25 offen sc1
    v_mfma_f32_16x16x32_bf16 v[40:43], a[16:19], v[92:95], v[40:43]
    buffer_store_dwordx4 v[68:71], v12, s[16:19], s25 offen sc1
    s_waitcnt lgkmcnt(4)
    v_mfma_f32_16x16x32_bf16 v[32:35], a[24:27], v[96:99], v[32:35]
    ds_read_b128 v[88:91], v4 offset:12288
    buffer_store_dwordx4 v[28:31], v1, s[16:19], s26 offen sc1
    v_mfma_f32_16x16x32_bf16 v[36:39], a[28:31], v[96:99], v[36:39]
    ds_read_b128 v[92:95], v4 offset:14336
    v_mfma_f32_16x16x32_bf16 v[44:47], a[28:31], v[100:103], v[44:47]
    v_mfma_f32_16x16x32_bf16 v[40:43], a[24:27], v[100:103], v[40:43]
    buffer_load_dword v13, v10, s[8:11], s33 offen
    s_waitcnt lgkmcnt(4)
    v_mfma_f32_16x16x32_bf16 v[32:35], a[32:35], v[72:75], v[32:35]
    ds_read_b128 v[96:99], v5 offset:12288
    v_mfma_f32_16x16x32_bf16 v[36:39], a[36:39], v[72:75], v[36:39]
    ds_read_b128 v[100:103], v5 offset:14336
    v_mfma_f32_16x16x32_bf16 v[44:47], a[36:39], v[76:79], v[44:47]
    s_mov_b32 s18, 0xa000000
    s_lshl_b32 s25, s24, 21
    v_mfma_f32_16x16x32_bf16 v[40:43], a[32:35], v[76:79], v[40:43]
    s_lshl_b32 s62, s24, 13
    s_waitcnt lgkmcnt(4)
    v_mfma_f32_16x16x32_bf16 v[32:35], a[40:43], v[80:83], v[32:35]
    ds_read_b128 v[72:75], v4 offset:16384
    s_and_b32 s62, s62, 0x2000
    v_mfma_f32_16x16x32_bf16 v[36:39], a[44:47], v[80:83], v[36:39]
    ds_read_b128 v[76:79], v4 offset:18432
    s_xor_b32 s62, s62, s30
    v_mfma_f32_16x16x32_bf16 v[44:47], a[44:47], v[84:87], v[44:47]
    s_add_u32 s25, s25, s62
    s_lshl_b32 s26, s24, 19
    v_mfma_f32_16x16x32_bf16 v[40:43], a[40:43], v[84:87], v[40:43]
    s_lshl_b32 s62, s24, 11
    s_waitcnt lgkmcnt(4)
    v_mfma_f32_16x16x32_bf16 v[32:35], a[48:51], v[88:91], v[32:35]
    ds_read_b128 v[80:83], v5 offset:16384
    s_and_b32 s62, s62, 0x2000
    v_mfma_f32_16x16x32_bf16 v[36:39], a[52:55], v[88:91], v[36:39]
    ds_read_b128 v[84:87], v5 offset:18432
    s_xor_b32 s62, s62, s31
    v_mfma_f32_16x16x32_bf16 v[44:47], a[52:55], v[92:95], v[44:47]
    s_add_u32 s26, s26, s62
    s_cmp_ge_u32 s21, 131072
    v_mfma_f32_16x16x32_bf16 v[40:43], a[48:51], v[92:95], v[40:43]
    s_cselect_b32 s22, 0xfffe0000, s29
    s_waitcnt lgkmcnt(4)
    v_mfma_f32_16x16x32_bf16 v[32:35], a[56:59], v[96:99], v[32:35]
    ds_read_b128 v[88:91], v4 offset:20480
    s_add_u32 s21, s21, s22
    v_mfma_f32_16x16x32_bf16 v[36:39], a[60:63], v[96:99], v[36:39]
    ds_read_b128 v[92:95], v4 offset:22528
    s_add_u32 s27, s27, 0x10000
    v_mfma_f32_16x16x32_bf16 v[44:47], a[60:63], v[100:103], v[44:47]
    s_andn2_b32 s61, 3, s24
    s_or_b32 s61, s61, s58
    v_mfma_f32_16x16x32_bf16 v[40:43], a[56:59], v[100:103], v[40:43]
    s_cselect_b32 s33, 0x400000, s27
    s_waitcnt lgkmcnt(4)
    v_mfma_f32_16x16x32_bf16 v[32:35], a[64:67], v[72:75], v[32:35]
    ds_read_b128 v[96:99], v5 offset:20480
    s_cmp_lt_u32 s24, 4
    v_mfma_f32_16x16x32_bf16 v[36:39], a[68:71], v[72:75], v[36:39]
    ds_read_b128 v[100:103], v5 offset:22528
    s_cselect_b64 vcc, -1, 0
    v_mfma_f32_16x16x32_bf16 v[44:47], a[68:71], v[76:79], v[44:47]
    v_mfma_f32_16x16x32_bf16 v[40:43], a[64:67], v[76:79], v[40:43]
    s_waitcnt lgkmcnt(4)
    v_mfma_f32_16x16x32_bf16 v[32:35], a[72:75], v[80:83], v[32:35]
    ds_read_b128 v[72:75], v4 offset:24576
    v_mfma_f32_16x16x32_bf16 v[36:39], a[76:79], v[80:83], v[36:39]
    ds_read_b128 v[76:79], v4 offset:26624
    v_mfma_f32_16x16x32_bf16 v[44:47], a[76:79], v[84:87], v[44:47]
    v_mfma_f32_16x16x32_bf16 v[40:43], a[72:75], v[84:87], v[40:43]
    s_waitcnt lgkmcnt(4)
    v_mfma_f32_16x16x32_bf16 v[32:35], a[80:83], v[88:91], v[32:35]
    ds_read_b128 v[80:83], v5 offset:24576
    s_add_u32 m0, s20, 0
    v_mfma_f32_16x16x32_bf16 v[36:39], a[84:87], v[88:91], v[36:39]
    ds_read_b128 v[84:87], v5 offset:26624
    buffer_load_dwordx4 v2, s[8:11], s23 offen offset:0 lds
    v_mfma_f32_16x16x32_bf16 v[44:47], a[84:87], v[92:95], v[44:47]
    v_mfma_f32_16x16x32_bf16 v[40:43], a[80:83], v[92:95], v[40:43]
    s_waitcnt lgkmcnt(4)
    v_mfma_f32_16x16x32_bf16 v[32:35], a[88:91], v[96:99], v[32:35]
    ds_read_b128 v[88:91], v4 offset:28672
    v_mfma_f32_16x16x32_bf16 v[36:39], a[92:95], v[96:99], v[36:39]
    ds_read_b128 v[92:95], v4 offset:30720
    s_add_u32 m0, s20, 3968
    v_mfma_f32_16x16x32_bf16 v[44:47], a[92:95], v[100:103], v[44:47]
    buffer_load_dwordx4 v2, s[8:11], s23 offen offset:128 lds
    v_mfma_f32_16x16x32_bf16 v[40:43], a[88:91], v[100:103], v[40:43]
    v_add_u32 v4, s22, v4
    s_waitcnt lgkmcnt(4)
    v_mfma_f32_16x16x32_bf16 v[32:35], a[96:99], v[72:75], v[32:35]
    ds_read_b128 v[96:99], v5 offset:28672
    v_mfma_f32_16x16x32_bf16 v[36:39], a[100:103], v[72:75], v[36:39]
    ds_read_b128 v[100:103], v5 offset:30720
    v_mfma_f32_16x16x32_bf16 v[44:47], a[100:103], v[76:79], v[44:47]
    v_add_u32 v5, s22, v5
    s_add_u32 m0, s20, 7936
    v_mfma_f32_16x16x32_bf16 v[40:43], a[96:99], v[76:79], v[40:43]
    buffer_load_dwordx4 v2, s[8:11], s23 offen offset:256 lds
    s_waitcnt vmcnt(15)
    s_cbranch_vccnz kvsk_early
    s_barrier
kvsk_mid:
    s_waitcnt lgkmcnt(4)
    v_mfma_f32_16x16x32_bf16 v[32:35], a[104:107], v[80:83], v[32:35]
    ds_read_b128 v[72:75], v4 offset:0
    v_mfma_f32_16x16x32_bf16 v[36:39], a[108:111], v[80:83], v[36:39]
    ds_read_b128 v[76:79], v4 offset:2048
    v_mfma_f32_16x16x32_bf16 v[44:47], a[108:111], v[84:87], v[44:47]
    v_mfma_f32_16x16x32_bf16 v[40:43], a[104:107], v[84:87], v[40:43]
    s_add_u32 m0, s20, 11904
    s_waitcnt lgkmcnt(4)
    v_mfma_f32_16x16x32_bf16 v[32:35], a[112:115], v[88:91], v[32:35]
    ds_read_b128 v[80:83], v5 offset:0
    buffer_load_dwordx4 v2, s[8:11], s23 offen offset:384 lds
    v_mfma_f32_16x16x32_bf16 v[36:39], a[116:119], v[88:91], v[36:39]
    ds_read_b128 v[84:87], v5 offset:2048
    v_mfma_f32_16x16x32_bf16 v[44:47], a[116:119], v[92:95], v[44:47]
    v_mfma_f32_16x16x32_bf16 v[40:43], a[112:115], v[92:95], v[40:43]
    s_waitcnt lgkmcnt(4)
    v_mfma_f32_16x16x32_bf16 v[32:35], a[120:123], v[96:99], v[32:35]
    ds_read_b128 v[88:91], v4 offset:4096
    s_add_u32 m0, s20, 15872
    v_mfma_f32_16x16x32_bf16 v[36:39], a[124:127], v[96:99], v[36:39]
    ds_read_b128 v[92:95], v4 offset:6144
    buffer_load_dwordx4 v2, s[8:11], s23 offen offset:512 lds
    v_mfma_f32_16x16x32_bf16 v[44:47], a[124:127], v[100:103], v[44:47]
    s_cmp_ge_u32 s21, 131072
    s_cselect_b32 s22, 0xfffe0000, s29
    v_mfma_f32_16x16x32_bf16 v[40:43], a[120:123], v[100:103], v[40:43]
    s_add_u32 s21, s21, s22
    s_waitcnt lgkmcnt(4)
    v_mfma_f32_16x16x32_bf16 v[32:35], a[128:131], v[72:75], v[32:35]
    ds_read_b128 v[96:99], v5 offset:4096
    v_mfma_f32_16x16x32_bf16 v[36:39], a[132:135], v[72:75], v[36:39]
    ds_read_b128 v[100:103], v5 offset:6144
    s_add_u32 m0, s20, 19840
    v_mfma_f32_16x16x32_bf16 v[44:47], a[132:135], v[76:79], v[44:47]
    buffer_load_dwordx4 v2, s[8:11], s23 offen offset:640 lds
    v_mfma_f32_16x16x32_bf16 v[40:43], a[128:131], v[76:79], v[40:43]
    s_waitcnt lgkmcnt(4)
    v_mfma_f32_16x16x32_bf16 v[32:35], a[136:139], v[80:83], v[32:35]
    ds_read_b128 v[72:75], v4 offset:8192
    v_mfma_f32_16x16x32_bf16 v[36:39], a[140:143], v[80:83], v[36:39]
    ds_read_b128 v[76:79], v4 offset:10240
    v_mfma_f32_16x16x32_bf16 v[44:47], a[140:143], v[84:87], v[44:47]
    s_add_u32 m0, s20, 23808
    v_mfma_f32_16x16x32_bf16 v[40:43], a[136:139], v[84:87], v[40:43]
    buffer_load_dwordx4 v2, s[8:11], s23 offen offset:768 lds
    s_waitcnt lgkmcnt(4)
    v_mfma_f32_16x16x32_bf16 v[32:35], a[144:147], v[88:91], v[32:35]
    ds_read_b128 v[80:83], v5 offset:8192
    v_mfma_f32_16x16x32_bf16 v[36:39], a[148:151], v[88:91], v[36:39]
    ds_read_b128 v[84:87], v5 offset:10240
    v_mfma_f32_16x16x32_bf16 v[44:47], a[148:151], v[92:95], v[44:47]
    v_mfma_f32_16x16x32_bf16 v[40:43], a[144:147], v[92:95], v[40:43]
    s_add_u32 m0, s20, 27776
    s_waitcnt lgkmcnt(4)
    v_mfma_f32_16x16x32_bf16 v[32:35], a[152:155], v[96:99], v[32:35]
    ds_read_b128 v[88:91], v4 offset:12288
    buffer_load_dwordx4 v2, s[8:11], s23 offen offset:896 lds
    v_mfma_f32_16x16x32_bf16 v[36:39], a[156:159], v[96:99], v[36:39]
    ds_read_b128 v[92:95], v4 offset:14336
    s_add_u32 s23, s23, 1024
    v_mfma_f32_16x16x32_bf16 v[44:47], a[156:159], v[100:103], v[44:47]
    s_bitcmp1_b32 s23, 11
    s_cselect_b32 s60, 0xf800, 0
    v_mfma_f32_16x16x32_bf16 v[40:43], a[152:155], v[100:103], v[40:43]
    s_add_u32 s23, s23, s60
    s_waitcnt lgkmcnt(4)
    v_mfma_f32_16x16x32_bf16 v[32:35], a[160:163], v[72:75], v[32:35]
    ds_read_b128 v[96:99], v5 offset:12288
    s_add_u32 s20, s20, 32768
    v_mfma_f32_16x16x32_bf16 v[36:39], a[164:167], v[72:75], v[36:39]
    ds_read_b128 v[100:103], v5 offset:14336
    s_cmp_ge_u32 s20, 163840
    v_mfma_f32_16x16x32_bf16 v[44:47], a[164:167], v[76:79], v[44:47]
    s_cselect_b32 s60, 163840, 0
    s_sub_u32 s20, s20, s60
    v_mfma_f32_16x16x32_bf16 v[40:43], a[160:163], v[76:79], v[40:43]
    s_add_u32 m0, s20, 0
    s_waitcnt lgkmcnt(4)
    v_mfma_f32_16x16x32_bf16 v[32:35], a[168:171], v[80:83], v[32:35]
    ds_read_b128 v[72:75], v4 offset:16384
    buffer_load_dwordx4 v2, s[8:11], s23 offen offset:0 lds
    v_mfma_f32_16x16x32_bf16 v[36:39], a[172:175], v[80:83], v[36:39]
    ds_read_b128 v[76:79], v4 offset:18432
    s_add_u32 m0, s20, 3968
    v_mfma_f32_16x16x32_bf16 v[44:47], a[172:175], v[84:87], v[44:47]
    buffer_load_dwordx4 v2, s[8:11], s23 offen offset:128 lds
    v_mfma_f32_16x16x32_bf16 v[40:43], a[168:171], v[84:87], v[40:43]
    s_waitcnt lgkmcnt(4)
    v_mfma_f32_16x16x32_bf16 v[32:35], a[176:179], v[88:91], v[32:35]
    ds_read_b128 v[80:83], v5 offset:16384
    v_mfma_f32_16x16x32_bf16 v[36:39], a[180:183], v[88:91], v[36:39]
    ds_read_b128 v[84:87], v5 offset:18432
    v_mfma_f32_16x16x32_bf16 v[44:47], a[180:183], v[92:95], v[44:47]
    s_add_u32 m0, s20, 7936
    v_mfma_f32_16x16x32_bf16 v[40:43], a[176:179], v[92:95], v[40:43]
    buffer_load_dwordx4 v2, s[8:11], s23 offen offset:256 lds
    s_waitcnt lgkmcnt(4)
    v_mfma_f32_16x16x32_bf16 v[32:35], a[184:187], v[96:99], v[32:35]
    ds_read_b128 v[88:91], v4 offset:20480
    v_mfma_f32_16x16x32_bf16 v[36:39], a[188:191], v[96:99], v[36:39]
    ds_read_b128 v[92:95], v4 offset:22528
    v_mfma_f32_16x16x32_bf16 v[44:47], a[188:191], v[100:103], v[44:47]
    v_mfma_f32_16x16x32_bf16 v[40:43], a[184:187], v[100:103], v[40:43]
    s_add_u32 m0, s20, 11904
    s_waitcnt lgkmcnt(4)
    v_mfma_f32_16x16x32_bf16 v[32:35], a[192:195], v[72:75], v[32:35]
    ds_read_b128 v[96:99], v5 offset:20480
    buffer_load_dwordx4 v2, s[8:11], s23 offen offset:384 lds
    v_mfma_f32_16x16x32_bf16 v[36:39], a[196:199], v[72:75], v[36:39]
    ds_read_b128 v[100:103], v5 offset:22528
    v_mfma_f32_16x16x32_bf16 v[44:47], a[196:199], v[76:79], v[44:47]
    v_mfma_f32_16x16x32_bf16 v[40:43], a[192:195], v[76:79], v[40:43]
    s_waitcnt lgkmcnt(4)
    v_mfma_f32_16x16x32_bf16 v[32:35], a[200:203], v[80:83], v[32:35]
    ds_read_b128 v[72:75], v4 offset:24576
    s_add_u32 m0, s20, 15872
    v_mfma_f32_16x16x32_bf16 v[36:39], a[204:207], v[80:83], v[36:39]
    ds_read_b128 v[76:79], v4 offset:26624
    buffer_load_dwordx4 v2, s[8:11], s23 offen offset:512 lds
    v_mfma_f32_16x16x32_bf16 v[44:47], a[204:207], v[84:87], v[44:47]
    v_mfma_f32_16x16x32_bf16 v[40:43], a[200:203], v[84:87], v[40:43]
    s_waitcnt lgkmcnt(4)
    v_mfma_f32_16x16x32_bf16 v[32:35], a[208:211], v[88:91], v[32:35]
    ds_read_b128 v[80:83], v5 offset:24576
    v_mfma_f32_16x16x32_bf16 v[36:39], a[212:215], v[88:91], v[36:39]
    ds_read_b128 v[84:87], v5 offset:26624
    s_add_u32 m0, s20, 19840
    v_mfma_f32_16x16x32_bf16 v[44:47], a[212:215], v[92:95], v[44:47]
    buffer_load_dwordx4 v2, s[8:11], s23 offen offset:640 lds
    v_mfma_f32_16x16x32_bf16 v[40:43], a[208:211], v[92:95], v[40:43]
    s_waitcnt lgkmcnt(4)
    v_mfma_f32_16x16x32_bf16 v[32:35], a[216:219], v[96:99], v[32:35]
    ds_read_b128 v[88:91], v4 offset:28672
    v_mfma_f32_16x16x32_bf16 v[36:39], a[220:223], v[96:99], v[36:39]
    ds_read_b128 v[92:95], v4 offset:30720
    v_mfma_f32_16x16x32_bf16 v[44:47], a[220:223], v[100:103], v[44:47]
    v_add_u32 v4, s22, v4
    s_add_u32 m0, s20, 23808
    v_mfma_f32_16x16x32_bf16 v[40:43], a[216:219], v[100:103], v[40:43]
    buffer_load_dwordx4 v2, s[8:11], s23 offen offset:768 lds
    s_waitcnt lgkmcnt(4)
    v_mfma_f32_16x16x32_bf16 v[32:35], a[224:227], v[72:75], v[32:35]
    ds_read_b128 v[96:99], v5 offset:28672
    v_mfma_f32_16x16x32_bf16 v[36:39], a[228:231], v[72:75], v[36:39]
    ds_read_b128 v[100:103], v5 offset:30720
    v_mfma_f32_16x16x32_bf16 v[44:47], a[228:231], v[76:79], v[44:47]
    v_add_u32 v5, s22, v5
    v_mfma_f32_16x16x32_bf16 v[40:43], a[224:227], v[76:79], v[40:43]
    s_add_u32 m0, s20, 27776
    s_waitcnt vmcnt(16)
    s_barrier
    s_waitcnt lgkmcnt(4)
    v_mfma_f32_16x16x32_bf16 v[32:35], a[232:235], v[80:83], v[32:35]
    ds_read_b128 v[72:75], v4 offset:0
    buffer_load_dwordx4 v2, s[8:11], s23 offen offset:896 lds
    v_mfma_f32_16x16x32_bf16 v[36:39], a[236:239], v[80:83], v[36:39]
    ds_read_b128 v[76:79], v4 offset:2048
    s_add_u32 s23, s23, 1024
    v_mfma_f32_16x16x32_bf16 v[44:47], a[236:239], v[84:87], v[44:47]
    s_bitcmp1_b32 s23, 11
    s_cselect_b32 s60, 0xf800, 0
    v_mfma_f32_16x16x32_bf16 v[40:43], a[232:235], v[84:87], v[40:43]
    s_add_u32 s23, s23, s60
    s_waitcnt lgkmcnt(4)
    v_mfma_f32_16x16x32_bf16 v[32:35], a[240:243], v[88:91], v[32:35]
    ds_read_b128 v[80:83], v5 offset:0
    s_add_u32 s20, s20, 32768
    s_cmp_ge_u32 s20, 163840
    v_mfma_f32_16x16x32_bf16 v[36:39], a[244:247], v[88:91], v[36:39]
    ds_read_b128 v[84:87], v5 offset:2048
    s_cselect_b32 s60, 163840, 0
    s_sub_u32 s20, s20, s60
    v_mfma_f32_16x16x32_bf16 v[44:47], a[244:247], v[92:95], v[44:47]
    v_mfma_f32_16x16x32_bf16 v[40:43], a[240:243], v[92:95], v[40:43]
    s_waitcnt lgkmcnt(4)
    v_mfma_f32_16x16x32_bf16 v[48:51], a[248:251], v[96:99], v[32:35]
    ds_read_b128 v[88:91], v4 offset:4096
    s_add_u32 s24, s24, 1
    s_sub_u32 s61, s24, 2
    v_mfma_f32_16x16x32_bf16 v[52:55], a[252:255], v[96:99], v[36:39]
    ds_read_b128 v[92:95], v4 offset:6144
    s_bitcmp1_b64 s[34:35], s61
    v_mfma_f32_16x16x32_bf16 v[60:63], a[252:255], v[100:103], v[44:47]
    v_mfma_f32_16x16x32_bf16 v[56:59], a[248:251], v[100:103], v[40:43]
    s_cbranch_scc0 kvsk
    s_cmp_eq_u32 s24, 64
    s_cbranch_scc1 kvsk_fin
    s_cmp_lg_u32 s58, 0
    s_cbranch_scc1 kvsk
    s_bfm_b64 s[62:63], s61, 0
    s_and_b32 s62, s62, 0x204225f
    s_and_b32 s63, s63, 0x80004004
    s_bcnt1_i32_b64 s60, s[62:63]
    s_lshl_b32 s60, s60, 2
    s_add_u32 s60, s60, 64
    v_mov_b32 v24, s60
    v_mov_b32 v25, 1
    s_mov_b64 exec, 1
    global_atomic_add v24, v25, s[98:99] sc1
    s_mov_b64 exec, -1
    s_branch kvsk
kvsk_early:
    s_waitcnt vmcnt(4)
    s_barrier
    s_cmp_eq_u32 s24, 0
    s_cbranch_scc1 kvsk_mid
    s_cmp_lg_u32 s58, 0
    s_cbranch_scc1 kvsk_mid
    s_lshl_b32 s60, s24, 2
    s_add_u32 s60, s60, 60
    v_mov_b32 v24, s60
    v_mov_b32 v25, 1
    s_mov_b64 exec, 1
    global_atomic_add v24, v25, s[98:99] sc1
    s_mov_b64 exec, -1
    s_branch kvsk_mid
kvsk_fin:
    s_nop 7
    v_cvt_pk_bf16_f32 v64, v48, v49
    v_cvt_pk_bf16_f32 v65, v50, v51
    v_cvt_pk_bf16_f32 v66, v52, v53
    v_cvt_pk_bf16_f32 v67, v54, v55
    v_cvt_pk_bf16_f32 v68, v56, v57
    v_cvt_pk_bf16_f32 v69, v58, v59
    v_cvt_pk_bf16_f32 v70, v60, v61
    v_cvt_pk_bf16_f32 v71, v62, v63
    buffer_store_dwordx4 v[64:67], v1, s[16:19], s25 offen sc1
    buffer_store_dwordx4 v[68:71], v12, s[16:19], s25 offen sc1
    buffer_store_dwordx4 v[28:31], v1, s[16:19], s26 offen sc1
    s_waitcnt vmcnt(0) lgkmcnt(0)
    s_barrier
    s_cmp_lg_u32 s58, 0
    s_cbranch_scc1 L_kve_50
    s_mov_b32 s60, 112
    v_mov_b32 v24, s60
    v_mov_b32 v25, 1
    s_mov_b64 exec, 1
    global_atomic_add v24, v25, s[98:99] sc1
    s_mov_b64 exec, -1
    s_branch L_kve_50
L_kvv_49:
    ds_read_b128 v[72:75], v4 offset:0
    ds_read_b128 v[76:79], v4 offset:2048
    ds_read_b128 v[80:83], v5 offset:0
    ds_read_b128 v[84:87], v5 offset:2048
    ds_read_b128 v[88:91], v4 offset:4096
    ds_read_b128 v[92:95], v4 offset:6144
    s_mov_b32 s34, 0x2042258
    s_mov_b32 s35, 0x40004004
    s_cmp_eq_u32 s58, 0
    s_cselect_b32 s33, s27, 0x400000
    s_mov_b32 s25, 0
    s_mov_b32 s26, 0
kvsv:
    s_waitcnt lgkmcnt(4)
    v_mfma_f32_16x16x32_bf16 v[32:35], v[72:75], a[0:3], 0
    ds_read_b128 v[96:99], v5 offset:4096
    v_mfma_f32_16x16x32_bf16 v[40:43], v[72:75], a[4:7], 0
    ds_read_b128 v[100:103], v5 offset:6144
    v_mfma_f32_16x16x32_bf16 v[44:47], v[76:79], a[4:7], 0
    v_mfma_f32_16x16x32_bf16 v[36:39], v[76:79], a[0:3], 0
    v_cvt_pk_bf16_f32 v64, v48, v49
    s_waitcnt lgkmcnt(4)
    v_mfma_f32_16x16x32_bf16 v[32:35], v[80:83], a[8:11], v[32:35]
    ds_read_b128 v[72:75], v4 offset:8192
    v_cvt_pk_bf16_f32 v65, v50, v51
    v_mfma_f32_16x16x32_bf16 v[40:43], v[80:83], a[12:15], v[40:43]
    ds_read_b128 v[76:79], v4 offset:10240
    v_cvt_pk_bf16_f32 v66, v52, v53
    v_mfma_f32_16x16x32_bf16 v[44:47], v[84:87], a[12:15], v[44:47]
    v_cvt_pk_bf16_f32 v67, v54, v55
    v_cvt_pk_bf16_f32 v68, v56, v57
    v_mfma_f32_16x16x32_bf16 v[36:39], v[84:87], a[8:11], v[36:39]
    v_cvt_pk_bf16_f32 v69, v58, v59
    s_waitcnt lgkmcnt(4)
    v_mfma_f32_16x16x32_bf16 v[32:35], v[88:91], a[16:19], v[32:35]
    ds_read_b128 v[80:83], v5 offset:8192
    v_cvt_pk_bf16_f32 v70, v60, v61
    v_mfma_f32_16x16x32_bf16 v[40:43], v[88:91], a[20:23], v[40:43]
    ds_read_b128 v[84:87], v5 offset:10240
    v_cvt_pk_bf16_f32 v71, v62, v63
    v_mfma_f32_16x16x32_bf16 v[44:47], v[92:95], a[20:23], v[44:47]
    buffer_store_dwordx4 v[64:67], v1, s[16:19], s25 offen sc1
    v_mfma_f32_16x16x32_bf16 v[36:39], v[92:95], a[16:19], v[36:39]
    buffer_store_dwordx4 v[68:71], v1, s[16:19], s25 offen offset:1024 sc1
    s_waitcnt lgkmcnt(4)
    v_mfma_f32_16x16x32_bf16 v[32:35], v[96:99], a[24:27], v[32:35]
    ds_read_b128 v[88:91], v4 offset:12288
    buffer_store_dwordx4 v[28:31], v1, s[16:19], s26 offen sc1
    v_mfma_f32_16x16x32_bf16 v[40:43], v[96:99], a[28:31], v[40:43]
    ds_read_b128 v[92:95], v4 offset:14336
    v_mfma_f32_16x16x32_bf16 v[44:47], v[100:103], a[28:31], v[44:47]
    v_mfma_f32_16x16x32_bf16 v[36:39], v[100:103], a[24:27], v[36:39]
    buffer_load_dword v13, v10, s[8:11], s33 offen
    s_waitcnt lgkmcnt(4)
    v_mfma_f32_16x16x32_bf16 v[32:35], v[72:75], a[32:35], v[32:35]
    ds_read_b128 v[96:99], v5 offset:12288
    v_mfma_f32_16x16x32_bf16 v[40:43], v[72:75], a[36:39], v[40:43]
    ds_read_b128 v[100:103], v5 offset:14336
    v_mfma_f32_16x16x32_bf16 v[44:47], v[76:79], a[36:39], v[44:47]
    s_mov_b32 s18, 0xa000000
    s_lshl_b32 s25, s24, 21
    v_mfma_f32_16x16x32_bf16 v[36:39], v[76:79], a[32:35], v[36:39]
    s_lshl_b32 s62, s24, 13
    s_waitcnt lgkmcnt(4)
    v_mfma_f32_16x16x32_bf16 v[32:35], v[80:83], a[40:43], v[32:35]
    ds_read_b128 v[72:75], v4 offset:16384
    s_and_b32 s62, s62, 0x2000
    v_mfma_f32_16x16x32_bf16 v[40:43], v[80:83], a[44:47], v[40:43]
    ds_read_b128 v[76:79], v4 offset:18432
    s_xor_b32 s62, s62, s30
    v_mfma_f32_16x16x32_bf16 v[44:47], v[84:87], a[44:47], v[44:47]
    s_add_u32 s25, s25, s62
    s_lshl_b32 s26, s24, 19
    v_mfma_f32_16x16x32_bf16 v[36:39], v[84:87], a[40:43], v[36:39]
    s_lshl_b32 s62, s24, 11
    s_waitcnt lgkmcnt(4)
    v_mfma_f32_16x16x32_bf16 v[32:35], v[88:91], a[48:51], v[32:35]
    ds_read_b128 v[80:83], v5 offset:16384
    s_and_b32 s62, s62, 0x2000
    v_mfma_f32_16x16x32_bf16 v[40:43], v[88:91], a[52:55], v[40:43]
    ds_read_b128 v[84:87], v5 offset:18432
    s_xor_b32 s62, s62, s31
    v_mfma_f32_16x16x32_bf16 v[44:47], v[92:95], a[52:55], v[44:47]
    s_add_u32 s26, s26, s62
    s_cmp_ge_u32 s21, 131072
    v_mfma_f32_16x16x32_bf16 v[36:39], v[92:95], a[48:51], v[36:39]
    s_cselect_b32 s22, 0xfffe0000, s29
    s_waitcnt lgkmcnt(4)
    v_mfma_f32_16x16x32_bf16 v[32:35], v[96:99], a[56:59], v[32:35]
    ds_read_b128 v[88:91], v4 offset:20480
    s_add_u32 s21, s21, s22
    v_mfma_f32_16x16x32_bf16 v[40:43], v[96:99], a[60:63], v[40:43]
    ds_read_b128 v[92:95], v4 offset:22528
    s_add_u32 s27, s27, 0x10000
    v_mfma_f32_16x16x32_bf16 v[44:47], v[100:103], a[60:63], v[44:47]
    s_andn2_b32 s61, 3, s24
    s_or_b32 s61, s61, s58
    v_mfma_f32_16x16x32_bf16 v[36:39], v[100:103], a[56:59], v[36:39]
    s_cselect_b32 s33, 0x400000, s27
    s_waitcnt lgkmcnt(4)
    v_mfma_f32_16x16x32_bf16 v[32:35], v[72:75], a[64:67], v[32:35]
    ds_read_b128 v[96:99], v5 offset:20480
    s_cmp_lt_u32 s24, 4
    v_mfma_f32_16x16x32_bf16 v[40:43], v[72:75], a[68:71], v[40:43]
    ds_read_b128 v[100:103], v5 offset:22528
    s_cselect_b64 vcc, -1, 0
    v_mfma_f32_16x16x32_bf16 v[44:47], v[76:79], a[68:71], v[44:47]
    v_mfma_f32_16x16x32_bf16 v[36:39], v[76:79], a[64:67], v[36:39]
    s_waitcnt lgkmcnt(4)
    v_mfma_f32_16x16x32_bf16 v[32:35], v[80:83], a[72:75], v[32:35]
    ds_read_b128 v[72:75], v4 offset:24576
    v_mfma_f32_16x16x32_bf16 v[40:43], v[80:83], a[76:79], v[40:43]
    ds_read_b128 v[76:79], v4 offset:26624
    v_mfma_f32_16x16x32_bf16 v[44:47], v[84:87], a[76:79], v[44:47]
    v_mfma_f32_16x16x32_bf16 v[36:39], v[84:87], a[72:75], v[36:39]
    s_waitcnt lgkmcnt(4)
    v_mfma_f32_16x16x32_bf16 v[32:35], v[88:91], a[80:83], v[32:35]
    ds_read_b128 v[80:83], v5 offset:24576
    s_add_u32 m0, s20, 0
    v_mfma_f32_16x16x32_bf16 v[40:43], v[88:91], a[84:87], v[40:43]
    ds_read_b128 v[84:87], v5 offset:26624
    buffer_load_dwordx4 v2, s[8:11], s23 offen offset:0 lds
    v_mfma_f32_16x16x32_bf16 v[44:47], v[92:95], a[84:87], v[44:47]
    v_mfma_f32_16x16x32_bf16 v[36:39], v[92:95], a[80:83], v[36:39]
    s_waitcnt lgkmcnt(4)
    v_mfma_f32_16x16x32_bf16 v[32:35], v[96:99], a[88:91], v[32:35]
    ds_read_b128 v[88:91], v4 offset:28672
    v_mfma_f32_16x16x32_bf16 v[40:43], v[96:99], a[92:95], v[40:43]
    ds_read_b128 v[92:95], v4 offset:30720
    s_add_u32 m0, s20, 3968
    v_mfma_f32_16x16x32_bf16 v[44:47], v[100:103], a[92:95], v[44:47]
    buffer_load_dwordx4 v2, s[8:11], s23 offen offset:128 lds
    v_mfma_f32_16x16x32_bf16 v[36:39], v[100:103], a[88:91], v[36:39]
    v_add_u32 v4, s22, v4
    s_waitcnt lgkmcnt(4)
    v_mfma_f32_16x16x32_bf16 v[32:35], v[72:75], a[96:99], v[32:35]
    ds_read_b128 v[96:99], v5 offset:28672
    v_mfma_f32_16x16x32_bf16 v[40:43], v[72:75], a[100:103], v[40:43]
    ds_read_b128 v[100:103], v5 offset:30720
    v_mfma_f32_16x16x32_bf16 v[44:47], v[76:79], a[100:103], v[44:47]
    v_add_u32 v5, s22, v5
    s_add_u32 m0, s20, 7936
    v_mfma_f32_16x16x32_bf16 v[36:39], v[76:79], a[96:99], v[36:39]
    buffer_load_dwordx4 v2, s[8:11], s23 offen offset:256 lds
    s_waitcnt vmcnt(15)
    s_cbranch_vccnz kvsv_early
    s_barrier
kvsv_mid:
    s_waitcnt lgkmcnt(4)
    v_mfma_f32_16x16x32_bf16 v[32:35], v[80:83], a[104:107], v[32:35]
    ds_read_b128 v[72:75], v4 offset:0
    v_mfma_f32_16x16x32_bf16 v[40:43], v[80:83], a[108:111], v[40:43]
    ds_read_b128 v[76:79], v4 offset:2048
    v_mfma_f32_16x16x32_bf16 v[44:47], v[84:87], a[108:111], v[44:47]
    v_mfma_f32_16x16x32_bf16 v[36:39], v[84:87], a[104:107], v[36:39]
    s_add_u32 m0, s20, 11904
    s_waitcnt lgkmcnt(4)
    v_mfma_f32_16x16x32_bf16 v[32:35], v[88:91], a[112:115], v[32:35]
    ds_read_b128 v[80:83], v5 offset:0
    buffer_load_dwordx4 v2, s[8:11], s23 offen offset:384 lds
    v_mfma_f32_16x16x32_bf16 v[40:43], v[88:91], a[116:119], v[40:43]
    ds_read_b128 v[84:87], v5 offset:2048
    v_mfma_f32_16x16x32_bf16 v[44:47], v[92:95], a[116:119], v[44:47]
    v_mfma_f32_16x16x32_bf16 v[36:39], v[92:95], a[112:115], v[36:39]
    s_waitcnt lgkmcnt(4)
    v_mfma_f32_16x16x32_bf16 v[32:35], v[96:99], a[120:123], v[32:35]
    ds_read_b128 v[88:91], v4 offset:4096
    s_add_u32 m0, s20, 15872
    v_mfma_f32_16x16x32_bf16 v[40:43], v[96:99], a[124:127], v[40:43]
    ds_read_b128 v[92:95], v4 offset:6144
    buffer_load_dwordx4 v2, s[8:11], s23 offen offset:512 lds
    v_mfma_f32_16x16x32_bf16 v[44:47], v[100:103], a[124:127], v[44:47]
    s_cmp_ge_u32 s21, 131072
    s_cselect_b32 s22, 0xfffe0000, s29
    v_mfma_f32_16x16x32_bf16 v[36:39], v[100:103], a[120:123], v[36:39]
    s_add_u32 s21, s21, s22
    s_waitcnt lgkmcnt(4)
    v_mfma_f32_16x16x32_bf16 v[32:35], v[72:75], a[128:131], v[32:35]
    ds_read_b128 v[96:99], v5 offset:4096
    v_mfma_f32_16x16x32_bf16 v[40:43], v[72:75], a[132:135], v[40:43]
    ds_read_b128 v[100:103], v5 offset:6144
    s_add_u32 m0, s20, 19840
    v_mfma_f32_16x16x32_bf16 v[44:47], v[76:79], a[132:135], v[44:47]
    buffer_load_dwordx4 v2, s[8:11], s23 offen offset:640 lds
    v_mfma_f32_16x16x32_bf16 v[36:39], v[76:79], a[128:131], v[36:39]
    s_waitcnt lgkmcnt(4)
    v_mfma_f32_16x16x32_bf16 v[32:35], v[80:83], a[136:139], v[32:35]
    ds_read_b128 v[72:75], v4 offset:8192
    v_mfma_f32_16x16x32_bf16 v[40:43], v[80:83], a[140:143], v[40:43]
    ds_read_b128 v[76:79], v4 offset:10240
    v_mfma_f32_16x16x32_bf16 v[44:47], v[84:87], a[140:143], v[44:47]
    s_add_u32 m0, s20, 23808
    v_mfma_f32_16x16x32_bf16 v[36:39], v[84:87], a[136:139], v[36:39]
    buffer_load_dwordx4 v2, s[8:11], s23 offen offset:768 lds
    s_waitcnt lgkmcnt(4)
    v_mfma_f32_16x16x32_bf16 v[32:35], v[88:91], a[144:147], v[32:35]
    ds_read_b128 v[80:83], v5 offset:8192
    v_mfma_f32_16x16x32_bf16 v[40:43], v[88:91], a[148:151], v[40:43]
    ds_read_b128 v[84:87], v5 offset:10240
    v_mfma_f32_16x16x32_bf16 v[44:47], v[92:95], a[148:151], v[44:47]
    v_mfma_f32_16x16x32_bf16 v[36:39], v[92:95], a[144:147], v[36:39]
    s_add_u32 m0, s20, 27776
    s_waitcnt lgkmcnt(4)
    v_mfma_f32_16x16x32_bf16 v[32:35], v[96:99], a[152:155], v[32:35]
    ds_read_b128 v[88:91], v4 offset:12288
    buffer_load_dwordx4 v2, s[8:11], s23 offen offset:896 lds
    v_mfma_f32_16x16x32_bf16 v[40:43], v[96:99], a[156:159], v[40:43]
    ds_read_b128 v[92:95], v4 offset:14336
    s_add_u32 s23, s23, 1024
    v_mfma_f32_16x16x32_bf16 v[44:47], v[100:103], a[156:159], v[44:47]
    s_bitcmp1_b32 s23, 11
    s_cselect_b32 s60, 0xf800, 0
    v_mfma_f32_16x16x32_bf16 v[36:39], v[100:103], a[152:155], v[36:39]
    s_add_u32 s23, s23, s60
    s_waitcnt lgkmcnt(4)
    v_mfma_f32_16x16x32_bf16 v[32:35], v[72:75], a[160:163], v[32:35]
    ds_read_b128 v[96:99], v5 offset:12288
    s_add_u32 s20, s20, 32768
    v_mfma_f32_16x16x32_bf16 v[40:43], v[72:75], a[164:167], v[40:43]
    ds_read_b128 v[100:103], v5 offset:14336
    s_cmp_ge_u32 s20, 163840
    v_mfma_f32_16x16x32_bf16 v[44:47], v[76:79], a[164:167], v[44:47]
    s_cselect_b32 s60, 163840, 0
    s_sub_u32 s20, s20, s60
    v_mfma_f32_16x16x32_bf16 v[36:39], v[76:79], a[160:163], v[36:39]
    s_add_u32 m0, s20, 0
    s_waitcnt lgkmcnt(4)
    v_mfma_f32_16x16x32_bf16 v[32:35], v[80:83], a[168:171], v[32:35]
    ds_read_b128 v[72:75], v4 offset:16384
    buffer_load_dwordx4 v2, s[8:11], s23 offen offset:0 lds
    v_mfma_f32_16x16x32_bf16 v[40:43], v[80:83], a[172:175], v[40:43]
    ds_read_b128 v[76:79], v4 offset:18432
    s_add_u32 m0, s20, 3968
    v_mfma_f32_16x16x32_bf16 v[44:47], v[84:87], a[172:175], v[44:47]
    buffer_load_dwordx4 v2, s[8:11], s23 offen offset:128 lds
    v_mfma_f32_16x16x32_bf16 v[36:39], v[84:87], a[168:171], v[36:39]
    s_waitcnt lgkmcnt(4)
    v_mfma_f32_16x16x32_bf16 v[32:35], v[88:91], a[176:179], v[32:35]
    ds_read_b128 v[80:83], v5 offset:16384
    v_mfma_f32_16x16x32_bf16 v[40:43], v[88:91], a[180:183], v[40:43]
    ds_read_b128 v[84:87], v5 offset:18432
    v_mfma_f32_16x16x32_bf16 v[44:47], v[92:95], a[180:183], v[44:47]
    s_add_u32 m0, s20, 7936
    v_mfma_f32_16x16x32_bf16 v[36:39], v[92:95], a[176:179], v[36:39]
    buffer_load_dwordx4 v2, s[8:11], s23 offen offset:256 lds
    s_waitcnt lgkmcnt(4)
    v_mfma_f32_16x16x32_bf16 v[32:35], v[96:99], a[184:187], v[32:35]
    ds_read_b128 v[88:91], v4 offset:20480
    v_mfma_f32_16x16x32_bf16 v[40:43], v[96:99], a[188:191], v[40:43]
    ds_read_b128 v[92:95], v4 offset:22528
    v_mfma_f32_16x16x32_bf16 v[44:47], v[100:103], a[188:191], v[44:47]
    v_mfma_f32_16x16x32_bf16 v[36:39], v[100:103], a[184:187], v[36:39]
    s_add_u32 m0, s20, 11904
    s_waitcnt lgkmcnt(4)
    v_mfma_f32_16x16x32_bf16 v[32:35], v[72:75], a[192:195], v[32:35]
    ds_read_b128 v[96:99], v5 offset:20480
    buffer_load_dwordx4 v2, s[8:11], s23 offen offset:384 lds
    v_mfma_f32_16x16x32_bf16 v[40:43], v[72:75], a[196:199], v[40:43]
    ds_read_b128 v[100:103], v5 offset:22528
    v_mfma_f32_16x16x32_bf16 v[44:47], v[76:79], a[196:199], v[44:47]
    v_mfma_f32_16x16x32_bf16 v[36:39], v[76:79], a[192:195], v[36:39]
    s_waitcnt lgkmcnt(4)
    v_mfma_f32_16x16x32_bf16 v[32:35], v[80:83], a[200:203], v[32:35]
    ds_read_b128 v[72:75], v4 offset:24576
    s_add_u32 m0, s20, 15872
    v_mfma_f32_16x16x32_bf16 v[40:43], v[80:83], a[204:207], v[40:43]
    ds_read_b128 v[76:79], v4 offset:26624
    buffer_load_dwordx4 v2, s[8:11], s23 offen offset:512 lds
    v_mfma_f32_16x16x32_bf16 v[44:47], v[84:87], a[204:207], v[44:47]
    v_mfma_f32_16x16x32_bf16 v[36:39], v[84:87], a[200:203], v[36:39]
    s_waitcnt lgkmcnt(4)
    v_mfma_f32_16x16x32_bf16 v[32:35], v[88:91], a[208:211], v[32:35]
    ds_read_b128 v[80:83], v5 offset:24576
    v_mfma_f32_16x16x32_bf16 v[40:43], v[88:91], a[212:215], v[40:43]
    ds_read_b128 v[84:87], v5 offset:26624
    s_add_u32 m0, s20, 19840
    v_mfma_f32_16x16x32_bf16 v[44:47], v[92:95], a[212:215], v[44:47]
    buffer_load_dwordx4 v2, s[8:11], s23 offen offset:640 lds
    v_mfma_f32_16x16x32_bf16 v[36:39], v[92:95], a[208:211], v[36:39]
    s_waitcnt lgkmcnt(4)
    v_mfma_f32_16x16x32_bf16 v[32:35], v[96:99], a[216:219], v[32:35]
    ds_read_b128 v[88:91], v4 offset:28672
    v_mfma_f32_16x16x32_bf16 v[40:43], v[96:99], a[220:223], v[40:43]
    ds_read_b128 v[92:95], v4 offset:30720
    v_mfma_f32_16x16x32_bf16 v[44:47], v[100:103], a[220:223], v[44:47]
    v_add_u32 v4, s22, v4
    s_add_u32 m0, s20, 23808
    v_mfma_f32_16x16x32_bf16 v[36:39], v[100:103], a[216:219], v[36:39]
    buffer_load_dwordx4 v2, s[8:11], s23 offen offset:768 lds
    s_waitcnt lgkmcnt(4)
    v_mfma_f32_16x16x32_bf16 v[32:35], v[72:75], a[224:227], v[32:35]
    ds_read_b128 v[96:99], v5 offset:28672
    v_mfma_f32_16x16x32_bf16 v[40:43], v[72:75], a[228:231], v[40:43]
    ds_read_b128 v[100:103], v5 offset:30720
    v_mfma_f32_16x16x32_bf16 v[44:47], v[76:79], a[228:231], v[44:47]
    v_add_u32 v5, s22, v5
    v_mfma_f32_16x16x32_bf16 v[36:39], v[76:79], a[224:227], v[36:39]
    s_add_u32 m0, s20, 27776
    s_waitcnt vmcnt(16)
    s_barrier
    s_waitcnt lgkmcnt(4)
    v_mfma_f32_16x16x32_bf16 v[32:35], v[80:83], a[232:235], v[32:35]
    ds_read_b128 v[72:75], v4 offset:0
    buffer_load_dwordx4 v2, s[8:11], s23 offen offset:896 lds
    v_mfma_f32_16x16x32_bf16 v[40:43], v[80:83], a[236:239], v[40:43]
    ds_read_b128 v[76:79], v4 offset:2048
    s_add_u32 s23, s23, 1024
    v_mfma_f32_16x16x32_bf16 v[44:47], v[84:87], a[236:239], v[44:47]
    s_bitcmp1_b32 s23, 11
    s_cselect_b32 s60, 0xf800, 0
    v_mfma_f32_16x16x32_bf16 v[36:39], v[84:87], a[232:235], v[36:39]
    s_add_u32 s23, s23, s60
    s_waitcnt lgkmcnt(4)
    v_mfma_f32_16x16x32_bf16 v[32:35], v[88:91], a[240:243], v[32:35]
    ds_read_b128 v[80:83], v5 offset:0
    s_add_u32 s20, s20, 32768
    s_cmp_ge_u32 s20, 163840
    v_mfma_f32_16x16x32_bf16 v[40:43], v[88:91], a[244:247], v[40:43]
    ds_read_b128 v[84:87], v5 offset:2048
    s_cselect_b32 s60, 163840, 0
    s_sub_u32 s20, s20, s60
    v_mfma_f32_16x16x32_bf16 v[44:47], v[92:95], a[244:247], v[44:47]
    v_mfma_f32_16x16x32_bf16 v[36:39], v[92:95], a[240:243], v[36:39]
    s_waitcnt lgkmcnt(4)
    v_mfma_f32_16x16x32_bf16 v[48:51], v[96:99], a[248:251], v[32:35]
    ds_read_b128 v[88:91], v4 offset:4096
    s_add_u32 s24, s24, 1
    s_sub_u32 s61, s24, 2
    v_mfma_f32_16x16x32_bf16 v[56:59], v[96:99], a[252:255], v[40:43]
    ds_read_b128 v[92:95], v4 offset:6144
    s_bitcmp1_b64 s[34:35], s61
    v_mfma_f32_16x16x32_bf16 v[60:63], v[100:103], a[252:255], v[44:47]
    v_mfma_f32_16x16x32_bf16 v[52:55], v[100:103], a[248:251], v[36:39]
    s_cbranch_scc0 kvsv
    s_cmp_eq_u32 s24, 64
    s_cbranch_scc1 kvsv_fin
    s_cmp_lg_u32 s58, 0
    s_cbranch_scc1 kvsv
    s_bfm_b64 s[62:63], s61, 0
    s_and_b32 s62, s62, 0x204225f
    s_and_b32 s63, s63, 0x80004004
    s_bcnt1_i32_b64 s60, s[62:63]
    s_lshl_b32 s60, s60, 2
    s_add_u32 s60, s60, 64
    v_mov_b32 v24, s60
    v_mov_b32 v25, 1
    s_mov_b64 exec, 1
    global_atomic_add v24, v25, s[98:99] sc1
    s_mov_b64 exec, -1
    s_branch kvsv
kvsv_early:
    s_waitcnt vmcnt(4)
    s_barrier
    s_cmp_eq_u32 s24, 0
    s_cbranch_scc1 kvsv_mid
    s_cmp_lg_u32 s58, 0
    s_cbranch_scc1 kvsv_mid
    s_lshl_b32 s60, s24, 2
    s_add_u32 s60, s60, 60
    v_mov_b32 v24, s60
    v_mov_b32 v25, 1
    s_mov_b64 exec, 1
    global_atomic_add v24, v25, s[98:99] sc1
    s_mov_b64 exec, -1
    s_branch kvsv_mid
kvsv_fin:
    s_nop 7
    v_cvt_pk_bf16_f32 v64, v48, v49
    v_cvt_pk_bf16_f32 v65, v50, v51
    v_cvt_pk_bf16_f32 v66, v52, v53
    v_cvt_pk_bf16_f32 v67, v54, v55
    v_cvt_pk_bf16_f32 v68, v56, v57
    v_cvt_pk_bf16_f32 v69, v58, v59
    v_cvt_pk_bf16_f32 v70, v60, v61
    v_cvt_pk_bf16_f32 v71, v62, v63
    buffer_store_dwordx4 v[64:67], v1, s[16:19], s25 offen sc1
    buffer_store_dwordx4 v[68:71], v1, s[16:19], s25 offen offset:1024 sc1
    buffer_store_dwordx4 v[28:31], v1, s[16:19], s26 offen sc1
    s_waitcnt vmcnt(0) lgkmcnt(0)
    s_barrier
    s_cmp_lg_u32 s58, 0
    s_cbranch_scc1 L_kve_50
    s_mov_b32 s60, 112
    v_mov_b32 v24, s60
    v_mov_b32 v25, 1
    s_mov_b64 exec, 1
    global_atomic_add v24, v25, s[98:99] sc1
    s_mov_b64 exec, -1
    s_branch L_kve_50
L_kve_50:
    s_branch chain_kernel_seg
L_big_42:
    v_and_b32 v24, 63, v0
    v_lshlrev_b32 v1, 4, v24
    v_mov_b32 v2, v1
    v_add_u32 v3, 1024, v1
    v_bfe_u32 v24, v0, 1, 3
    v_bfe_u32 v25, v0, 4, 2
    v_xor_b32 v24, v24, v25
    v_lshlrev_b32 v24, 4, v24
    v_and_b32 v25, 15, v0
    v_lshl_add_u32 v24, v25, 7, v24
    s_lshr_b32 s60, s58, 1
    s_lshl_b32 s60, s60, 14
    v_add_u32 v23, s60, v24
    s_and_b32 s60, s58, 1
    s_lshl_b32 s60, s60, 14
    s_add_u32 s60, s60, 32768
    v_add_u32 v12, s60, v24
    v_xor_b32 v13, 64, v12
    v_bfe_u32 v24, v0, 2, 3
    v_lshlrev_b32 v22, 5, v24
    v_and_b32 v24, 3, v0
    v_lshl_add_u32 v22, v24, 3, v22
    v_bfe_u32 v24, v0, 2, 2
    v_lshl_add_u32 v22, v24, 9, v22
    v_bfe_u32 v24, v0, 4, 2
    v_lshl_add_u32 v22, v24, 12, v22
    v_bfe_u32 v24, v0, 7, 1
    v_lshl_add_u32 v22, v24, 8, v22
    s_mov_b32 s49, 0
    s_mov_b32 s48, 32768
    s_lshl_b32 s45, s58, 12
    s_add_u32 s44, s45, 32768
    s_mov_b32 s11, 0x00020000
    s_mov_b32 s15, 0x00020000
    s_mov_b32 s19, 0x00020000
    s_mov_b32 s91, 0x00020000
    s_mov_b32 s90, 0x200000
    v_bfe_u32 v24, v0, 2, 3
    v_lshlrev_b32 v125, 11, v24
    v_and_b32 v24, 3, v0
    v_lshl_add_u32 v125, v24, 7, v125
    s_and_b32 s82, s57, 3
    s_lshr_b32 s85, s57, 2
    s_and_b32 s0, s82, 3
    s_lshl2_add_u32 s0, s85, s0
    s_lshl_b32 s60, s85, 19
    s_mov_b32 s30, s64
    s_and_b32 s31, s65, 0xffff
    s_mov_b32 s32, 0x400000
    s_mov_b32 s33, s60
    s_mov_b32 s34, 0x2000
    s_mov_b32 s35, 0x40000
    s_lshl_b32 s60, s82, 18
    s_mov_b32 s36, s70
    s_and_b32 s37, s71, 0xffff
    s_mov_b32 s38, 0x200000
    s_mov_b32 s39, s60
    s_mov_b32 s40, 0x8000
    s_mov_b32 s41, 0x20000
    s_mov_b32 s42, 0x80
    s_cmp_ge_u32 s58, 2
    s_cselect_b32 s36, s72, s70
    s_cselect_b32 s37, s73, s71
    s_and_b32 s37, s37, 0xffff
    v_bfe_u32 v24, v0, 4, 2
    v_and_b32 v25, 7, v0
    v_xor_b32 v24, v24, v25
    v_lshlrev_b32 v8, 4, v24
    v_bfe_u32 v24, v0, 3, 2
    v_lshl_add_u32 v8, v24, 11, v8
    v_bfe_u32 v24, v0, 5, 1
    v_lshl_add_u32 v8, v24, 16, v8
    v_lshrrev_b32 v24, 6, v0
    v_lshl_add_u32 v8, v24, 14, v8
    v_xor_b32 v9, 64, v8
    v_add_u32 v9, 0x20000, v9
    v_bfe_u32 v24, v0, 4, 2
    v_and_b32 v25, 7, v0
    v_xor_b32 v24, v24, v25
    v_lshlrev_b32 v10, 4, v24
    v_bfe_u32 v24, v0, 3, 3
    v_lshl_add_u32 v10, v24, 11, v10
    v_bfe_u32 v24, v0, 6, 1
    v_lshl_add_u32 v10, v24, 16, v10
    v_xor_b32 v11, 64, v10
    v_add_u32 v11, 0x4000, v11
    v_and_b32 v24, 15, v0
    v_bfe_u32 v25, v0, 7, 1
    v_lshl_add_u32 v24, v25, 6, v24
    v_lshlrev_b32 v24, 1, v24
    s_lshl_b32 s53, s82, 8
    s_mov_b32 s60, s66
    s_and_b32 s61, s67, 0xffff
    s_mov_b32 s62, 0x800
    s_mov_b32 s63, 0x00020000
    buffer_load_ushort v192, v24, s[60:63], s53 offen offset:0
    buffer_load_ushort v200, v24, s[60:63], s53 offen offset:32
    buffer_load_ushort v208, v24, s[60:63], s53 offen offset:64
    buffer_load_ushort v216, v24, s[60:63], s53 offen offset:96
    s_mov_b32 s60, s68
    s_and_b32 s61, s69, 0xffff
    s_mov_b32 s62, 0x800
    s_mov_b32 s63, 0x00020000
    buffer_load_ushort v193, v24, s[60:63], s53 offen offset:0
    buffer_load_ushort v201, v24, s[60:63], s53 offen offset:32
    buffer_load_ushort v209, v24, s[60:63], s53 offen offset:64
    buffer_load_ushort v217, v24, s[60:63], s53 offen offset:96
    s_mov_b32 s60, s78
    s_and_b32 s61, s79, 0xffff
    s_mov_b32 s62, 0x800
    s_mov_b32 s63, 0x00020000
    buffer_load_ushort v194, v24, s[60:63], s53 offen offset:0
    buffer_load_ushort v202, v24, s[60:63], s53 offen offset:32
    buffer_load_ushort v210, v24, s[60:63], s53 offen offset:64
    buffer_load_ushort v218, v24, s[60:63], s53 offen offset:96
    s_mov_b32 s6, 0xfffe8000
    s_mov_b32 s7, 65536
    s_mov_b32 s12, s36
    s_mov_b32 s13, s37
    s_mov_b32 s14, s38
    s_and_b32 s45, s45, 0xffffb7ff
    s_bitcmp1_b32 s0, 3
    s_cselect_b32 s24, s41, 0
    s_cselect_b32 s26, 0, s41
    s_cselect_b32 s60, 0x4000, 0
    s_or_b32 s45, s45, s60
    s_add_u32 s24, s24, s39
    s_add_u32 s26, s26, s39
    s_bitcmp1_b32 s0, 2
    s_cselect_b32 s61, s40, 0
    s_cselect_b32 s62, 0, s40
    s_cselect_b32 s60, 0x800, 0
    s_or_b32 s45, s45, s60
    s_add_u32 s25, s24, s62
    s_add_u32 s24, s24, s61
    s_add_u32 s27, s26, s62
    s_add_u32 s26, s26, s61
    s_mov_b32 s28, s42
    v_mov_b32 v6, v10
    v_mov_b32 v7, v11
    s_mov_b32 s8, s30
    s_mov_b32 s9, s31
    s_mov_b32 s10, s32
    s_and_b32 s44, s44, 0xffffb7ff
    s_bitcmp1_b32 s0, 1
    s_cselect_b32 s20, s35, 0
    s_cselect_b32 s22, 0, s35
    s_cselect_b32 s60, 0x4000, 0
    s_or_b32 s44, s44, s60
    s_add_u32 s20, s20, s33
    s_add_u32 s22, s22, s33
    s_bitcmp1_b32 s0, 0
    s_cselect_b32 s61, s34, 0
    s_cselect_b32 s62, 0, s34
    s_cselect_b32 s60, 0x800, 0
    s_or_b32 s44, s44, s60
    s_add_u32 s21, s20, s62
    s_add_u32 s20, s20, s61
    s_add_u32 s23, s22, s62
    s_add_u32 s22, s22, s61
    v_mov_b32 v4, v8
    v_mov_b32 v5, v9
    s_xor_b32 m0, s45, 0
    s_nop 0
    buffer_load_dwordx4 v6, s[12:15], s24 offen lds
    s_xor_b32 m0, s45, 1024
    s_nop 0
    buffer_load_dwordx4 v7, s[12:15], s24 offen lds
    s_xor_b32 m0, s45, 2048
    s_nop 0
    buffer_load_dwordx4 v6, s[12:15], s25 offen lds
    s_xor_b32 m0, s45, 3072
    s_nop 0
    buffer_load_dwordx4 v7, s[12:15], s25 offen lds
    s_xor_b32 m0, s45, 16384
    s_nop 0
    buffer_load_dwordx4 v6, s[12:15], s26 offen lds
    s_xor_b32 m0, s45, 17408
    s_nop 0
    buffer_load_dwordx4 v7, s[12:15], s26 offen lds
    s_xor_b32 m0, s45, 18432
    s_nop 0
    buffer_load_dwordx4 v6, s[12:15], s27 offen lds
    s_xor_b32 m0, s45, 19456
    s_nop 0
    buffer_load_dwordx4 v7, s[12:15], s27 offen lds
    s_add_u32 s24, s24, s28
    s_add_u32 s25, s25, s28
    s_add_u32 s26, s26, s28
    s_add_u32 s27, s27, s28
    s_cmp_ge_u32 s45, 98304
    s_cselect_b32 s60, s6, s7
    s_add_u32 s45, s45, s60
    s_xor_b32 m0, s44, 0
    s_nop 0
    buffer_load_dwordx4 v4, s[8:11], s20 offen lds
    s_xor_b32 m0, s44, 1024
    s_nop 0
    buffer_load_dwordx4 v5, s[8:11], s20 offen lds
    s_xor_b32 m0, s44, 2048
    s_nop 0
    buffer_load_dwordx4 v4, s[8:11], s21 offen lds
    s_xor_b32 m0, s44, 3072
    s_nop 0
    buffer_load_dwordx4 v5, s[8:11], s21 offen lds
    s_xor_b32 m0, s44, 16384
    s_nop 0
    buffer_load_dwordx4 v4, s[8:11], s22 offen lds
    s_xor_b32 m0, s44, 17408
    s_nop 0
    buffer_load_dwordx4 v5, s[8:11], s22 offen lds
    s_xor_b32 m0, s44, 18432
    s_nop 0
    buffer_load_dwordx4 v4, s[8:11], s23 offen lds
    s_xor_b32 m0, s44, 19456
    s_nop 0
    buffer_load_dwordx4 v5, s[8:11], s23 offen lds
    s_add_u32 s20, s20, 128
    s_add_u32 s21, s21, 128
    s_add_u32 s22, s22, 128
    s_add_u32 s23, s23, 128
    s_cmp_ge_u32 s44, 98304
    s_cselect_b32 s60, s6, s7
    s_add_u32 s44, s44, s60
    s_xor_b32 m0, s45, 0
    s_nop 0
    buffer_load_dwordx4 v6, s[12:15], s24 offen lds
    s_xor_b32 m0, s45, 1024
    s_nop 0
    buffer_load_dwordx4 v7, s[12:15], s24 offen lds
    s_xor_b32 m0, s45, 2048
    s_nop 0
    buffer_load_dwordx4 v6, s[12:15], s25 offen lds
    s_xor_b32 m0, s45, 3072
    s_nop 0
    buffer_load_dwordx4 v7, s[12:15], s25 offen lds
    s_xor_b32 m0, s45, 16384
    s_nop 0
    buffer_load_dwordx4 v6, s[12:15], s26 offen lds
    s_xor_b32 m0, s45, 17408
    s_nop 0
    buffer_load_dwordx4 v7, s[12:15], s26 offen lds
    s_xor_b32 m0, s45, 18432
    s_nop 0
    buffer_load_dwordx4 v6, s[12:15], s27 offen lds
    s_xor_b32 m0, s45, 19456
    s_nop 0
    buffer_load_dwordx4 v7, s[12:15], s27 offen lds
    s_add_u32 s24, s24, s28
    s_add_u32 s25, s25, s28
    s_add_u32 s26, s26, s28
    s_add_u32 s27, s27, s28
    s_cmp_ge_u32 s45, 98304
    s_cselect_b32 s60, s6, s7
    s_add_u32 s45, s45, s60
    s_add_u32 s39, s39, 0x100000
    s_mov_b32 s16, s100
    s_and_b32 s17, s101, 0xffff
    s_mov_b32 s18, 0x0
    s_mov_b32 s19, 0x00020000
    s_lshr_b32 s60, s85, 2
    s_lshl_b32 s60, s60, 21
    s_add_u32 s86, s64, s60
    s_addc_u32 s87, s65, 0
    s_and_b32 s60, s57, 15
    s_lshl1_add_u32 s60, s60, s58
    s_lshl_b32 s84, s60, 16
    s_bitcmp1_b32 s85, 0
    s_cselect_b64 s[62:63], s[72:73], s[70:71]
    s_lshr_b32 s60, s85, 1
    s_lshl2_add_u32 s60, s82, s60
    s_add_u32 s60, s60, 0
    s_lshl_b32 s60, s60, 16
    s_cmp_eq_u32 s58, 2
    s_cselect_b64 s[86:87], s[62:63], s[86:87]
    s_cselect_b32 s84, s60, s84
    s_cmp_eq_u32 s58, 3
    s_cselect_b32 s84, 0x40000000, s84
    s_and_b32 s87, s87, 0xffff
    s_mov_b64 s[88:89], s[86:87]
    s_add_u32 s83, s84, 512
    s_lshr_b32 s60, s85, 2
    s_lshl_b32 s60, s60, 21
    s_add_u32 s86, s64, s60
    s_addc_u32 s87, s65, 0
    s_and_b32 s60, s57, 15
    s_lshl1_add_u32 s60, s60, s58
    s_lshl_b32 s84, s60, 16
    s_bitcmp1_b32 s85, 0
    s_cselect_b64 s[62:63], s[72:73], s[70:71]
    s_lshr_b32 s60, s85, 1
    s_lshl2_add_u32 s60, s82, s60
    s_add_u32 s60, s60, 16
    s_lshl_b32 s60, s60, 16
    s_cmp_eq_u32 s58, 2
    s_cselect_b64 s[86:87], s[62:63], s[86:87]
    s_cselect_b32 s84, s60, s84
    s_cmp_eq_u32 s58, 3
    s_cselect_b32 s84, 0x40000000, s84
    s_and_b32 s87, s87, 0xffff
    s_waitcnt vmcnt(24)
    v_lshlrev_b32 v192, 16, v192
    v_lshlrev_b32 v200, 16, v200
    v_lshlrev_b32 v208, 16, v208
    v_lshlrev_b32 v216, 16, v216
    v_lshlrev_b32 v193, 16, v193
    v_lshlrev_b32 v201, 16, v201
    v_lshlrev_b32 v209, 16, v209
    v_lshlrev_b32 v217, 16, v217
    v_lshlrev_b32 v194, 16, v194
    v_lshlrev_b32 v202, 16, v202
    v_lshlrev_b32 v210, 16, v210
    v_lshlrev_b32 v218, 16, v218
    v_mul_f32 v194, 0x3fb8aa3b, v194
    v_mul_f32 v202, 0x3fb8aa3b, v202
    v_mul_f32 v210, 0x3fb8aa3b, v210
    v_mul_f32 v218, 0x3fb8aa3b, v218
    v_exp_f32 v194, v194
    v_exp_f32 v202, v202
    v_exp_f32 v210, v210
    v_exp_f32 v218, v218
    v_cvt_pk_bf16_f32 v194, 0, v194
    v_cvt_pk_bf16_f32 v202, 0, v202
    v_cvt_pk_bf16_f32 v210, 0, v210
    v_cvt_pk_bf16_f32 v218, 0, v218
    v_mul_f32 v195, v194, v192
    v_mul_f32 v203, v202, v200
    v_mul_f32 v211, v210, v208
    v_mul_f32 v219, v218, v216
    v_mul_f32 v196, v194, v193
    v_mul_f32 v204, v202, v201
    v_mul_f32 v212, v210, v209
    v_mul_f32 v220, v218, v217
    v_mul_f32 v195, 0x3fb8aa3b, v195
    v_mul_f32 v203, 0x3fb8aa3b, v203
    v_mul_f32 v211, 0x3fb8aa3b, v211
    v_mul_f32 v219, 0x3fb8aa3b, v219
    v_exp_f32 v195, v195
    v_exp_f32 v203, v203
    v_exp_f32 v211, v211
    v_exp_f32 v219, v219
    v_mul_f32 v196, 0x3e22f983, v196
    v_mul_f32 v204, 0x3e22f983, v204
    v_mul_f32 v212, 0x3e22f983, v212
    v_mul_f32 v220, 0x3e22f983, v220
    v_fract_f32 v196, v196
    v_fract_f32 v204, v204
    v_fract_f32 v212, v212
    v_fract_f32 v220, v220
    v_cos_f32 v197, v196
    v_cos_f32 v205, v204
    v_cos_f32 v213, v212
    v_cos_f32 v221, v220
    v_sin_f32 v198, v196
    v_sin_f32 v206, v204
    v_sin_f32 v214, v212
    v_sin_f32 v222, v220
    v_mul_f32 v88, v195, v197
    v_mul_f32 v90, v203, v205
    v_mul_f32 v92, v211, v213
    v_mul_f32 v94, v219, v221
    v_mul_f32 v89, v195, v198
    v_mul_f32 v91, v203, v206
    v_mul_f32 v93, v211, v214
    v_mul_f32 v95, v219, v222
    v_add_f32 v197, -1.0, v88
    v_add_f32 v205, -1.0, v90
    v_add_f32 v213, -1.0, v92
    v_add_f32 v221, -1.0, v94
    v_mul_f32 v198, v197, v192
    v_mul_f32 v206, v205, v200
    v_mul_f32 v214, v213, v208
    v_mul_f32 v222, v221, v216
    v_fma_f32 v198, v89, v193, v198
    v_fma_f32 v206, v91, v201, v206
    v_fma_f32 v214, v93, v209, v214
    v_fma_f32 v222, v95, v217, v222
    v_mul_f32 v199, v89, v192
    v_mul_f32 v207, v91, v200
    v_mul_f32 v215, v93, v208
    v_mul_f32 v223, v95, v216
    v_fma_f32 v199, -v197, v193, v199
    v_fma_f32 v207, -v205, v201, v207
    v_fma_f32 v215, -v213, v209, v215
    v_fma_f32 v223, -v221, v217, v223
    v_mul_f32 v195, v192, v192
    v_mul_f32 v203, v200, v200
    v_mul_f32 v211, v208, v208
    v_mul_f32 v219, v216, v216
    v_fma_f32 v195, v193, v193, v195
    v_fma_f32 v203, v201, v201, v203
    v_fma_f32 v211, v209, v209, v211
    v_fma_f32 v219, v217, v217, v219
    v_rcp_f32 v195, v195
    v_rcp_f32 v203, v203
    v_rcp_f32 v211, v211
    v_rcp_f32 v219, v219
    v_add_f32 v195, v195, v195
    v_add_f32 v203, v203, v203
    v_add_f32 v211, v211, v211
    v_add_f32 v219, v219, v219
    v_mul_f32 v96, v198, v195
    v_mul_f32 v98, v206, v203
    v_mul_f32 v100, v214, v211
    v_mul_f32 v102, v222, v219
    v_mul_f32 v97, v199, v195
    v_mul_f32 v99, v207, v203
    v_mul_f32 v101, v215, v211
    v_mul_f32 v103, v223, v219
    v_pk_mul_f32 v[192:193], v[88:89], v[88:89] op_sel:[0,0] op_sel_hi:[0,1]
    v_pk_mul_f32 v[200:201], v[90:91], v[90:91] op_sel:[0,0] op_sel_hi:[0,1]
    v_pk_mul_f32 v[208:209], v[92:93], v[92:93] op_sel:[0,0] op_sel_hi:[0,1]
    v_pk_mul_f32 v[216:217], v[94:95], v[94:95] op_sel:[0,0] op_sel_hi:[0,1]
    v_pk_fma_f32 v[104:105], v[88:89], v[88:89], v[192:193] op_sel:[1,1,0] op_sel_hi:[1,0,1] neg_lo:[1,0,0]
    v_pk_fma_f32 v[106:107], v[90:91], v[90:91], v[200:201] op_sel:[1,1,0] op_sel_hi:[1,0,1] neg_lo:[1,0,0]
    v_pk_fma_f32 v[108:109], v[92:93], v[92:93], v[208:209] op_sel:[1,1,0] op_sel_hi:[1,0,1] neg_lo:[1,0,0]
    v_pk_fma_f32 v[110:111], v[94:95], v[94:95], v[216:217] op_sel:[1,1,0] op_sel_hi:[1,0,1] neg_lo:[1,0,0]
    v_pk_mul_f32 v[192:193], v[104:105], v[104:105] op_sel:[0,0] op_sel_hi:[0,1]
    v_pk_mul_f32 v[200:201], v[106:107], v[106:107] op_sel:[0,0] op_sel_hi:[0,1]
    v_pk_mul_f32 v[208:209], v[108:109], v[108:109] op_sel:[0,0] op_sel_hi:[0,1]
    v_pk_mul_f32 v[216:217], v[110:111], v[110:111] op_sel:[0,0] op_sel_hi:[0,1]
    v_pk_fma_f32 v[104:105], v[104:105], v[104:105], v[192:193] op_sel:[1,1,0] op_sel_hi:[1,0,1] neg_lo:[1,0,0]
    v_pk_fma_f32 v[106:107], v[106:107], v[106:107], v[200:201] op_sel:[1,1,0] op_sel_hi:[1,0,1] neg_lo:[1,0,0]
    v_pk_fma_f32 v[108:109], v[108:109], v[108:109], v[208:209] op_sel:[1,1,0] op_sel_hi:[1,0,1] neg_lo:[1,0,0]
    v_pk_fma_f32 v[110:111], v[110:111], v[110:111], v[216:217] op_sel:[1,1,0] op_sel_hi:[1,0,1] neg_lo:[1,0,0]
    v_pk_mul_f32 v[192:193], v[104:105], v[104:105] op_sel:[0,0] op_sel_hi:[0,1]
    v_pk_mul_f32 v[200:201], v[106:107], v[106:107] op_sel:[0,0] op_sel_hi:[0,1]
    v_pk_mul_f32 v[208:209], v[108:109], v[108:109] op_sel:[0,0] op_sel_hi:[0,1]
    v_pk_mul_f32 v[216:217], v[110:111], v[110:111] op_sel:[0,0] op_sel_hi:[0,1]
    v_pk_fma_f32 v[104:105], v[104:105], v[104:105], v[192:193] op_sel:[1,1,0] op_sel_hi:[1,0,1] neg_lo:[1,0,0]
    v_pk_fma_f32 v[106:107], v[106:107], v[106:107], v[200:201] op_sel:[1,1,0] op_sel_hi:[1,0,1] neg_lo:[1,0,0]
    v_pk_fma_f32 v[108:109], v[108:109], v[108:109], v[208:209] op_sel:[1,1,0] op_sel_hi:[1,0,1] neg_lo:[1,0,0]
    v_pk_fma_f32 v[110:111], v[110:111], v[110:111], v[216:217] op_sel:[1,1,0] op_sel_hi:[1,0,1] neg_lo:[1,0,0]
    v_pk_mul_f32 v[192:193], v[104:105], v[104:105] op_sel:[0,0] op_sel_hi:[0,1]
    v_pk_mul_f32 v[200:201], v[106:107], v[106:107] op_sel:[0,0] op_sel_hi:[0,1]
    v_pk_mul_f32 v[208:209], v[108:109], v[108:109] op_sel:[0,0] op_sel_hi:[0,1]
    v_pk_mul_f32 v[216:217], v[110:111], v[110:111] op_sel:[0,0] op_sel_hi:[0,1]
    v_pk_fma_f32 v[104:105], v[104:105], v[104:105], v[192:193] op_sel:[1,1,0] op_sel_hi:[1,0,1] neg_lo:[1,0,0]
    v_pk_fma_f32 v[106:107], v[106:107], v[106:107], v[200:201] op_sel:[1,1,0] op_sel_hi:[1,0,1] neg_lo:[1,0,0]
    v_pk_fma_f32 v[108:109], v[108:109], v[108:109], v[208:209] op_sel:[1,1,0] op_sel_hi:[1,0,1] neg_lo:[1,0,0]
    v_pk_fma_f32 v[110:111], v[110:111], v[110:111], v[216:217] op_sel:[1,1,0] op_sel_hi:[1,0,1] neg_lo:[1,0,0]
    v_pk_mul_f32 v[192:193], v[104:105], v[104:105] op_sel:[0,0] op_sel_hi:[0,1]
    v_pk_mul_f32 v[200:201], v[106:107], v[106:107] op_sel:[0,0] op_sel_hi:[0,1]
    v_pk_mul_f32 v[208:209], v[108:109], v[108:109] op_sel:[0,0] op_sel_hi:[0,1]
    v_pk_mul_f32 v[216:217], v[110:111], v[110:111] op_sel:[0,0] op_sel_hi:[0,1]
    v_pk_fma_f32 v[104:105], v[104:105], v[104:105], v[192:193] op_sel:[1,1,0] op_sel_hi:[1,0,1] neg_lo:[1,0,0]
    v_pk_fma_f32 v[106:107], v[106:107], v[106:107], v[200:201] op_sel:[1,1,0] op_sel_hi:[1,0,1] neg_lo:[1,0,0]
    v_pk_fma_f32 v[108:109], v[108:109], v[108:109], v[208:209] op_sel:[1,1,0] op_sel_hi:[1,0,1] neg_lo:[1,0,0]
    v_pk_fma_f32 v[110:111], v[110:111], v[110:111], v[216:217] op_sel:[1,1,0] op_sel_hi:[1,0,1] neg_lo:[1,0,0]
    v_pk_mul_f32 v[192:193], v[104:105], v[104:105] op_sel:[0,0] op_sel_hi:[0,1]
    v_pk_mul_f32 v[200:201], v[106:107], v[106:107] op_sel:[0,0] op_sel_hi:[0,1]
    v_pk_mul_f32 v[208:209], v[108:109], v[108:109] op_sel:[0,0] op_sel_hi:[0,1]
    v_pk_mul_f32 v[216:217], v[110:111], v[110:111] op_sel:[0,0] op_sel_hi:[0,1]
    v_pk_fma_f32 v[112:113], v[104:105], v[104:105], v[192:193] op_sel:[1,1,0] op_sel_hi:[1,0,1] neg_lo:[1,0,0]
    v_pk_fma_f32 v[114:115], v[106:107], v[106:107], v[200:201] op_sel:[1,1,0] op_sel_hi:[1,0,1] neg_lo:[1,0,0]
    v_pk_fma_f32 v[116:117], v[108:109], v[108:109], v[208:209] op_sel:[1,1,0] op_sel_hi:[1,0,1] neg_lo:[1,0,0]
    v_pk_fma_f32 v[118:119], v[110:111], v[110:111], v[216:217] op_sel:[1,1,0] op_sel_hi:[1,0,1] neg_lo:[1,0,0]
    v_pk_mul_f32 v[192:193], v[112:113], v[112:113] op_sel:[0,0] op_sel_hi:[0,1]
    v_pk_mul_f32 v[200:201], v[114:115], v[114:115] op_sel:[0,0] op_sel_hi:[0,1]
    v_pk_mul_f32 v[208:209], v[116:117], v[116:117] op_sel:[0,0] op_sel_hi:[0,1]
    v_pk_mul_f32 v[216:217], v[118:119], v[118:119] op_sel:[0,0] op_sel_hi:[0,1]
    v_pk_fma_f32 v[196:197], v[112:113], v[112:113], v[192:193] op_sel:[1,1,0] op_sel_hi:[1,0,1] neg_lo:[1,0,0]
    v_pk_fma_f32 v[204:205], v[114:115], v[114:115], v[200:201] op_sel:[1,1,0] op_sel_hi:[1,0,1] neg_lo:[1,0,0]
    v_pk_fma_f32 v[212:213], v[116:117], v[116:117], v[208:209] op_sel:[1,1,0] op_sel_hi:[1,0,1] neg_lo:[1,0,0]
    v_pk_fma_f32 v[220:221], v[118:119], v[118:119], v[216:217] op_sel:[1,1,0] op_sel_hi:[1,0,1] neg_lo:[1,0,0]
    s_mov_b32 exec_lo, 0xffffffff
    s_mov_b32 exec_hi, 0xffffffff
    v_mov_b32 v120, v196
    v_mov_b32 v121, v197
    s_mov_b32 exec_lo, 0xffff0000
    s_mov_b32 exec_hi, 0xffffffff
    v_mov_b32 v120, v204
    v_mov_b32 v121, v205
    s_mov_b32 exec_lo, 0x0
    s_mov_b32 exec_hi, 0xffffffff
    v_mov_b32 v120, v212
    v_mov_b32 v121, v213
    s_mov_b32 exec_lo, 0x0
    s_mov_b32 exec_hi, 0xffff0000
    v_mov_b32 v120, v220
    v_mov_b32 v121, v221
    s_mov_b64 exec, -1
    s_mov_b32 s1, 0
    s_mov_b32 s4, 0
    s_mov_b32 s3, 0
    s_mov_b32 s50, 0
    s_mov_b32 s5, 0
    s_mov_b32 s51, 0
    s_mov_b32 s52, 0
    s_waitcnt vmcnt(8)
    s_barrier
    s_call_b64 s[54:55], t_g1
    v_mov_b32 v24, 4
    global_load_dword v123, v24, s[98:99] sc1
    s_or_b32 s60, s2, s58
    s_cbranch_scc1 L_rw_51
    s_lshl_b32 s62, s56, 3
    s_add_u32 s62, s62, 160
    s_mov_b32 s63, 0
L_rp_52:
    s_load_dwordx2 s[60:61], s[98:99], s62 glc
    s_add_u32 s63, s63, 1
    s_cmp_gt_u32 s63, 0x100000
    s_cbranch_scc1 chain_kernel_wabort
    s_waitcnt lgkmcnt(0)
    s_cmp_lt_u32 s61, 0x2000
    s_cbranch_scc1 L_rp_52
    s_lshr_b32 s61, s95, 8
    s_cmp_eq_u32 s60, -1
    s_cselect_b32 s94, -1, s61
L_rw_51:
    s_cmp_lg_u32 s2, 0
    s_cbranch_scc1 L_rok_53
    v_mov_b32 v24, 0
    s_cmp_lg_u32 s58, 0
    s_cbranch_scc1 L_rw_54
    v_mov_b32 v25, s94
    ds_write_b32 v24, v25
    s_waitcnt lgkmcnt(0)
L_rw_54:
    s_barrier
    ds_read_b32 v25, v24
    s_waitcnt lgkmcnt(0)
    v_readfirstlane_b32 s60, v25
    s_mov_b32 s2, 1
    s_cmp_eq_u32 s60, -1
    s_cbranch_scc1 L_rok_53
    s_mov_b32 s57, s60
    s_waitcnt vmcnt(0)
    s_barrier
    s_cmp_ge_u32 s57, 32
    s_cbranch_scc1 chain_kernel_end
    s_branch L_big_42
L_rok_53:
    s_waitcnt vmcnt(0)
    s_mov_b32 s62, 0
L_pp_55:
    v_readfirstlane_b32 s59, v123
    s_and_b32 s60, s59, 0xff
    s_cmp_ge_u32 s60, 15
    s_cbranch_scc1 L_pok_56
    v_mov_b32 v24, 4
    global_load_dword v123, v24, s[98:99] sc1
    s_add_u32 s62, s62, 1
    s_cmp_gt_u32 s62, 0x200000
    s_cbranch_scc1 chain_kernel_wabort
    s_waitcnt vmcnt(0)
    s_branch L_pp_55
L_pok_56:
    s_cmp_ge_u32 s59, 0x800
    s_cselect_b32 s59, 0x2000, 0
    s_call_b64 s[54:55], t_scan
    s_add_u32 s82, s82, 4
    v_and_b32 v24, 15, v0
    v_bfe_u32 v25, v0, 7, 1
    v_lshl_add_u32 v24, v25, 6, v24
    v_lshlrev_b32 v24, 1, v24
    s_lshl_b32 s53, s82, 8
    s_mov_b32 s60, s66
    s_and_b32 s61, s67, 0xffff
    s_mov_b32 s62, 0x800
    s_mov_b32 s63, 0x00020000
    buffer_load_ushort v40, v24, s[60:63], s53 offen offset:0
    buffer_load_ushort v48, v24, s[60:63], s53 offen offset:32
    buffer_load_ushort v56, v24, s[60:63], s53 offen offset:64
    buffer_load_ushort v64, v24, s[60:63], s53 offen offset:96
    s_mov_b32 s60, s68
    s_and_b32 s61, s69, 0xffff
    s_mov_b32 s62, 0x800
    s_mov_b32 s63, 0x00020000
    buffer_load_ushort v41, v24, s[60:63], s53 offen offset:0
    buffer_load_ushort v49, v24, s[60:63], s53 offen offset:32
    buffer_load_ushort v57, v24, s[60:63], s53 offen offset:64
    buffer_load_ushort v65, v24, s[60:63], s53 offen offset:96
    s_mov_b32 s60, s78
    s_and_b32 s61, s79, 0xffff
    s_mov_b32 s62, 0x800
    s_mov_b32 s63, 0x00020000
    buffer_load_ushort v42, v24, s[60:63], s53 offen offset:0
    buffer_load_ushort v50, v24, s[60:63], s53 offen offset:32
    buffer_load_ushort v58, v24, s[60:63], s53 offen offset:64
    buffer_load_ushort v66, v24, s[60:63], s53 offen offset:96
    s_and_b32 s62, s57, 7
    s_lshr_b32 s63, s57, 3
    s_lshl_b32 s60, s63, 19
    s_add_u32 s60, s60, 0
    s_mov_b32 s30, s74
    s_and_b32 s31, s75, 0xffff
    s_mov_b32 s32, 0x200000
    s_mov_b32 s33, s60
    s_mov_b32 s34, 0x8000
    s_mov_b32 s35, 0x40000
    s_lshl_b32 s61, s62, 13
    s_andn2_b32 s61, 0x2000, s61
    s_xor_b32 s61, s61, s59
    s_lshl_b32 s60, s62, 21
    s_add_u32 s60, s60, s61
    s_add_u32 s60, s60, 0x0
    s_add_u32 s36, s100, 0xa000000
    s_addc_u32 s37, s101, 0
    s_and_b32 s37, s37, 0xffff
    s_mov_b32 s38, 0x1000000
    s_mov_b32 s39, s60
    s_mov_b32 s40, 0x800
    s_mov_b32 s41, 0x8000
    s_mov_b32 s42, 0x10000
    s_and_b32 s0, s62, 3
    s_lshl2_add_u32 s0, s63, s0
    s_mov_b64 s[86:87], s[30:31]
    s_lshl_b32 s62, s62, 16
    s_add_u32 s84, s33, s62
    s_cmp_eq_u32 s58, 0
    s_cselect_b32 s84, s84, 0x40000000
    v_bfe_u32 v24, v0, 4, 2
    v_and_b32 v25, 7, v0
    v_xor_b32 v24, v24, v25
    v_lshlrev_b32 v8, 4, v24
    v_bfe_u32 v24, v0, 3, 3
    v_lshl_add_u32 v8, v24, 11, v8
    v_bfe_u32 v24, v0, 6, 2
    v_lshl_add_u32 v8, v24, 16, v8
    v_xor_b32 v9, 64, v8
    v_add_u32 v9, 0x4000, v9
    s_lshr_b32 s61, s58, 1
    s_lshl_b32 s61, s61, 14
    v_add_u32 v10, s61, v1
    s_and_b32 s61, s58, 1
    s_lshl_b32 s61, s61, 12
    v_add_u32 v10, s61, v10
    v_add_u32 v11, 1024, v10
    s_mov_b32 s18, 0xc000000
    s_mov_b32 s4, 12
    s_mov_b32 s3, 12
    s_waitcnt vmcnt(0)
    v_lshlrev_b32 v40, 16, v40
    v_lshlrev_b32 v48, 16, v48
    v_lshlrev_b32 v56, 16, v56
    v_lshlrev_b32 v64, 16, v64
    v_lshlrev_b32 v41, 16, v41
    v_lshlrev_b32 v49, 16, v49
    v_lshlrev_b32 v57, 16, v57
    v_lshlrev_b32 v65, 16, v65
    v_lshlrev_b32 v42, 16, v42
    v_lshlrev_b32 v50, 16, v50
    v_lshlrev_b32 v58, 16, v58
    v_lshlrev_b32 v66, 16, v66
    v_mul_f32 v42, 0x3fb8aa3b, v42
    v_mul_f32 v50, 0x3fb8aa3b, v50
    v_mul_f32 v58, 0x3fb8aa3b, v58
    v_mul_f32 v66, 0x3fb8aa3b, v66
    v_exp_f32 v42, v42
    v_exp_f32 v50, v50
    v_exp_f32 v58, v58
    v_exp_f32 v66, v66
    v_cvt_pk_bf16_f32 v42, 0, v42
    v_cvt_pk_bf16_f32 v50, 0, v50
    v_cvt_pk_bf16_f32 v58, 0, v58
    v_cvt_pk_bf16_f32 v66, 0, v66
    v_mul_f32 v43, v42, v40
    v_mul_f32 v51, v50, v48
    v_mul_f32 v59, v58, v56
    v_mul_f32 v67, v66, v64
    v_mul_f32 v44, v42, v41
    v_mul_f32 v52, v50, v49
    v_mul_f32 v60, v58, v57
    v_mul_f32 v68, v66, v65
    v_mul_f32 v43, 0x3fb8aa3b, v43
    v_mul_f32 v51, 0x3fb8aa3b, v51
    v_mul_f32 v59, 0x3fb8aa3b, v59
    v_mul_f32 v67, 0x3fb8aa3b, v67
    v_exp_f32 v43, v43
    v_exp_f32 v51, v51
    v_exp_f32 v59, v59
    v_exp_f32 v67, v67
    v_mul_f32 v44, 0x3e22f983, v44
    v_mul_f32 v52, 0x3e22f983, v52
    v_mul_f32 v60, 0x3e22f983, v60
    v_mul_f32 v68, 0x3e22f983, v68
    v_fract_f32 v44, v44
    v_fract_f32 v52, v52
    v_fract_f32 v60, v60
    v_fract_f32 v68, v68
    v_cos_f32 v45, v44
    v_cos_f32 v53, v52
    v_cos_f32 v61, v60
    v_cos_f32 v69, v68
    v_sin_f32 v46, v44
    v_sin_f32 v54, v52
    v_sin_f32 v62, v60
    v_sin_f32 v70, v68
    v_mul_f32 v88, v43, v45
    v_mul_f32 v90, v51, v53
    v_mul_f32 v92, v59, v61
    v_mul_f32 v94, v67, v69
    v_mul_f32 v89, v43, v46
    v_mul_f32 v91, v51, v54
    v_mul_f32 v93, v59, v62
    v_mul_f32 v95, v67, v70
    v_add_f32 v45, -1.0, v88
    v_add_f32 v53, -1.0, v90
    v_add_f32 v61, -1.0, v92
    v_add_f32 v69, -1.0, v94
    v_mul_f32 v46, v45, v40
    v_mul_f32 v54, v53, v48
    v_mul_f32 v62, v61, v56
    v_mul_f32 v70, v69, v64
    v_fma_f32 v46, v89, v41, v46
    v_fma_f32 v54, v91, v49, v54
    v_fma_f32 v62, v93, v57, v62
    v_fma_f32 v70, v95, v65, v70
    v_mul_f32 v47, v89, v40
    v_mul_f32 v55, v91, v48
    v_mul_f32 v63, v93, v56
    v_mul_f32 v71, v95, v64
    v_fma_f32 v47, -v45, v41, v47
    v_fma_f32 v55, -v53, v49, v55
    v_fma_f32 v63, -v61, v57, v63
    v_fma_f32 v71, -v69, v65, v71
    v_mul_f32 v43, v40, v40
    v_mul_f32 v51, v48, v48
    v_mul_f32 v59, v56, v56
    v_mul_f32 v67, v64, v64
    v_fma_f32 v43, v41, v41, v43
    v_fma_f32 v51, v49, v49, v51
    v_fma_f32 v59, v57, v57, v59
    v_fma_f32 v67, v65, v65, v67
    v_rcp_f32 v43, v43
    v_rcp_f32 v51, v51
    v_rcp_f32 v59, v59
    v_rcp_f32 v67, v67
    v_add_f32 v43, v43, v43
    v_add_f32 v51, v51, v51
    v_add_f32 v59, v59, v59
    v_add_f32 v67, v67, v67
    v_mul_f32 v96, v46, v43
    v_mul_f32 v98, v54, v51
    v_mul_f32 v100, v62, v59
    v_mul_f32 v102, v70, v67
    v_mul_f32 v97, v47, v43
    v_mul_f32 v99, v55, v51
    v_mul_f32 v101, v63, v59
    v_mul_f32 v103, v71, v67
    v_pk_mul_f32 v[40:41], v[88:89], v[88:89] op_sel:[0,0] op_sel_hi:[0,1]
    v_pk_mul_f32 v[48:49], v[90:91], v[90:91] op_sel:[0,0] op_sel_hi:[0,1]
    v_pk_mul_f32 v[56:57], v[92:93], v[92:93] op_sel:[0,0] op_sel_hi:[0,1]
    v_pk_mul_f32 v[64:65], v[94:95], v[94:95] op_sel:[0,0] op_sel_hi:[0,1]
    v_pk_fma_f32 v[104:105], v[88:89], v[88:89], v[40:41] op_sel:[1,1,0] op_sel_hi:[1,0,1] neg_lo:[1,0,0]
    v_pk_fma_f32 v[106:107], v[90:91], v[90:91], v[48:49] op_sel:[1,1,0] op_sel_hi:[1,0,1] neg_lo:[1,0,0]
    v_pk_fma_f32 v[108:109], v[92:93], v[92:93], v[56:57] op_sel:[1,1,0] op_sel_hi:[1,0,1] neg_lo:[1,0,0]
    v_pk_fma_f32 v[110:111], v[94:95], v[94:95], v[64:65] op_sel:[1,1,0] op_sel_hi:[1,0,1] neg_lo:[1,0,0]
    v_pk_mul_f32 v[40:41], v[104:105], v[104:105] op_sel:[0,0] op_sel_hi:[0,1]
    v_pk_mul_f32 v[48:49], v[106:107], v[106:107] op_sel:[0,0] op_sel_hi:[0,1]
    v_pk_mul_f32 v[56:57], v[108:109], v[108:109] op_sel:[0,0] op_sel_hi:[0,1]
    v_pk_mul_f32 v[64:65], v[110:111], v[110:111] op_sel:[0,0] op_sel_hi:[0,1]
    v_pk_fma_f32 v[104:105], v[104:105], v[104:105], v[40:41] op_sel:[1,1,0] op_sel_hi:[1,0,1] neg_lo:[1,0,0]
    v_pk_fma_f32 v[106:107], v[106:107], v[106:107], v[48:49] op_sel:[1,1,0] op_sel_hi:[1,0,1] neg_lo:[1,0,0]
    v_pk_fma_f32 v[108:109], v[108:109], v[108:109], v[56:57] op_sel:[1,1,0] op_sel_hi:[1,0,1] neg_lo:[1,0,0]
    v_pk_fma_f32 v[110:111], v[110:111], v[110:111], v[64:65] op_sel:[1,1,0] op_sel_hi:[1,0,1] neg_lo:[1,0,0]
    v_pk_mul_f32 v[40:41], v[104:105], v[104:105] op_sel:[0,0] op_sel_hi:[0,1]
    v_pk_mul_f32 v[48:49], v[106:107], v[106:107] op_sel:[0,0] op_sel_hi:[0,1]
    v_pk_mul_f32 v[56:57], v[108:109], v[108:109] op_sel:[0,0] op_sel_hi:[0,1]
    v_pk_mul_f32 v[64:65], v[110:111], v[110:111] op_sel:[0,0] op_sel_hi:[0,1]
    v_pk_fma_f32 v[104:105], v[104:105], v[104:105], v[40:41] op_sel:[1,1,0] op_sel_hi:[1,0,1] neg_lo:[1,0,0]
    v_pk_fma_f32 v[106:107], v[106:107], v[106:107], v[48:49] op_sel:[1,1,0] op_sel_hi:[1,0,1] neg_lo:[1,0,0]
    v_pk_fma_f32 v[108:109], v[108:109], v[108:109], v[56:57] op_sel:[1,1,0] op_sel_hi:[1,0,1] neg_lo:[1,0,0]
    v_pk_fma_f32 v[110:111], v[110:111], v[110:111], v[64:65] op_sel:[1,1,0] op_sel_hi:[1,0,1] neg_lo:[1,0,0]
    v_pk_mul_f32 v[40:41], v[104:105], v[104:105] op_sel:[0,0] op_sel_hi:[0,1]
    v_pk_mul_f32 v[48:49], v[106:107], v[106:107] op_sel:[0,0] op_sel_hi:[0,1]
    v_pk_mul_f32 v[56:57], v[108:109], v[108:109] op_sel:[0,0] op_sel_hi:[0,1]
    v_pk_mul_f32 v[64:65], v[110:111], v[110:111] op_sel:[0,0] op_sel_hi:[0,1]
    v_pk_fma_f32 v[104:105], v[104:105], v[104:105], v[40:41] op_sel:[1,1,0] op_sel_hi:[1,0,1] neg_lo:[1,0,0]
    v_pk_fma_f32 v[106:107], v[106:107], v[106:107], v[48:49] op_sel:[1,1,0] op_sel_hi:[1,0,1] neg_lo:[1,0,0]
    v_pk_fma_f32 v[108:109], v[108:109], v[108:109], v[56:57] op_sel:[1,1,0] op_sel_hi:[1,0,1] neg_lo:[1,0,0]
    v_pk_fma_f32 v[110:111], v[110:111], v[110:111], v[64:65] op_sel:[1,1,0] op_sel_hi:[1,0,1] neg_lo:[1,0,0]
    v_pk_mul_f32 v[40:41], v[104:105], v[104:105] op_sel:[0,0] op_sel_hi:[0,1]
    v_pk_mul_f32 v[48:49], v[106:107], v[106:107] op_sel:[0,0] op_sel_hi:[0,1]
    v_pk_mul_f32 v[56:57], v[108:109], v[108:109] op_sel:[0,0] op_sel_hi:[0,1]
    v_pk_mul_f32 v[64:65], v[110:111], v[110:111] op_sel:[0,0] op_sel_hi:[0,1]
    v_pk_fma_f32 v[104:105], v[104:105], v[104:105], v[40:41] op_sel:[1,1,0] op_sel_hi:[1,0,1] neg_lo:[1,0,0]
    v_pk_fma_f32 v[106:107], v[106:107], v[106:107], v[48:49] op_sel:[1,1,0] op_sel_hi:[1,0,1] neg_lo:[1,0,0]
    v_pk_fma_f32 v[108:109], v[108:109], v[108:109], v[56:57] op_sel:[1,1,0] op_sel_hi:[1,0,1] neg_lo:[1,0,0]
    v_pk_fma_f32 v[110:111], v[110:111], v[110:111], v[64:65] op_sel:[1,1,0] op_sel_hi:[1,0,1] neg_lo:[1,0,0]
    v_pk_mul_f32 v[40:41], v[104:105], v[104:105] op_sel:[0,0] op_sel_hi:[0,1]
    v_pk_mul_f32 v[48:49], v[106:107], v[106:107] op_sel:[0,0] op_sel_hi:[0,1]
    v_pk_mul_f32 v[56:57], v[108:109], v[108:109] op_sel:[0,0] op_sel_hi:[0,1]
    v_pk_mul_f32 v[64:65], v[110:111], v[110:111] op_sel:[0,0] op_sel_hi:[0,1]
    v_pk_fma_f32 v[112:113], v[104:105], v[104:105], v[40:41] op_sel:[1,1,0] op_sel_hi:[1,0,1] neg_lo:[1,0,0]
    v_pk_fma_f32 v[114:115], v[106:107], v[106:107], v[48:49] op_sel:[1,1,0] op_sel_hi:[1,0,1] neg_lo:[1,0,0]
    v_pk_fma_f32 v[116:117], v[108:109], v[108:109], v[56:57] op_sel:[1,1,0] op_sel_hi:[1,0,1] neg_lo:[1,0,0]
    v_pk_fma_f32 v[118:119], v[110:111], v[110:111], v[64:65] op_sel:[1,1,0] op_sel_hi:[1,0,1] neg_lo:[1,0,0]
    v_pk_mul_f32 v[40:41], v[112:113], v[112:113] op_sel:[0,0] op_sel_hi:[0,1]
    v_pk_mul_f32 v[48:49], v[114:115], v[114:115] op_sel:[0,0] op_sel_hi:[0,1]
    v_pk_mul_f32 v[56:57], v[116:117], v[116:117] op_sel:[0,0] op_sel_hi:[0,1]
    v_pk_mul_f32 v[64:65], v[118:119], v[118:119] op_sel:[0,0] op_sel_hi:[0,1]
    v_pk_fma_f32 v[44:45], v[112:113], v[112:113], v[40:41] op_sel:[1,1,0] op_sel_hi:[1,0,1] neg_lo:[1,0,0]
    v_pk_fma_f32 v[52:53], v[114:115], v[114:115], v[48:49] op_sel:[1,1,0] op_sel_hi:[1,0,1] neg_lo:[1,0,0]
    v_pk_fma_f32 v[60:61], v[116:117], v[116:117], v[56:57] op_sel:[1,1,0] op_sel_hi:[1,0,1] neg_lo:[1,0,0]
    v_pk_fma_f32 v[68:69], v[118:119], v[118:119], v[64:65] op_sel:[1,1,0] op_sel_hi:[1,0,1] neg_lo:[1,0,0]
    s_mov_b32 exec_lo, 0xffffffff
    s_mov_b32 exec_hi, 0xffffffff
    v_mov_b32 v120, v44
    v_mov_b32 v121, v45
    s_mov_b32 exec_lo, 0xffff0000
    s_mov_b32 exec_hi, 0xffffffff
    v_mov_b32 v120, v52
    v_mov_b32 v121, v53
    s_mov_b32 exec_lo, 0x0
    s_mov_b32 exec_hi, 0xffffffff
    v_mov_b32 v120, v60
    v_mov_b32 v121, v61
    s_mov_b32 exec_lo, 0x0
    s_mov_b32 exec_hi, 0xffff0000
    v_mov_b32 v120, v68
    v_mov_b32 v121, v69
    s_mov_b64 exec, -1
    s_call_b64 s[54:55], t_g1
    s_call_b64 s[54:55], t_scan
    s_and_b32 s62, s57, 7
    s_lshr_b32 s63, s57, 3
    s_lshl_b32 s60, s63, 19
    s_add_u32 s60, s60, 0
    s_mov_b32 s30, s76
    s_and_b32 s31, s77, 0xffff
    s_mov_b32 s32, 0x200000
    s_mov_b32 s33, s60
    s_mov_b32 s34, 0x8000
    s_mov_b32 s35, 0x40000
    s_lshl_b32 s61, s62, 13
    s_andn2_b32 s61, 0x2000, s61
    s_xor_b32 s61, s61, s59
    s_lshl_b32 s60, s62, 21
    s_add_u32 s60, s60, s61
    s_add_u32 s60, s60, 0x80000
    s_add_u32 s36, s100, 0xa000000
    s_addc_u32 s37, s101, 0
    s_and_b32 s37, s37, 0xffff
    s_mov_b32 s38, 0x1000000
    s_mov_b32 s39, s60
    s_mov_b32 s40, 0x800
    s_mov_b32 s41, 0x8000
    s_mov_b32 s42, 0x10000
    s_and_b32 s0, s62, 3
    s_lshl2_add_u32 s0, s63, s0
    s_mov_b64 s[86:87], s[30:31]
    s_lshl_b32 s62, s62, 16
    s_add_u32 s84, s33, s62
    s_cmp_eq_u32 s58, 0
    s_cselect_b32 s84, s84, 0x40000000
    s_mov_b32 s3, 0
    s_call_b64 s[54:55], t_g2
    s_and_b32 s62, s57, 7
    s_lshr_b32 s63, s57, 3
    s_lshl_b32 s60, s63, 19
    s_add_u32 s60, s60, 1024
    s_mov_b32 s30, s74
    s_and_b32 s31, s75, 0xffff
    s_mov_b32 s32, 0x200000
    s_mov_b32 s33, s60
    s_mov_b32 s34, 0x8000
    s_mov_b32 s35, 0x40000
    s_lshl_b32 s61, s62, 13
    s_andn2_b32 s61, 0x2000, s61
    s_xor_b32 s61, s61, s59
    s_lshl_b32 s60, s62, 21
    s_add_u32 s60, s60, s61
    s_add_u32 s60, s60, 0x100000
    s_add_u32 s36, s100, 0xa000000
    s_addc_u32 s37, s101, 0
    s_and_b32 s37, s37, 0xffff
    s_mov_b32 s38, 0x1000000
    s_mov_b32 s39, s60
    s_mov_b32 s40, 0x800
    s_mov_b32 s41, 0x8000
    s_mov_b32 s42, 0x10000
    s_and_b32 s0, s62, 3
    s_lshl2_add_u32 s0, s63, s0
    s_mov_b64 s[86:87], s[30:31]
    s_lshl_b32 s62, s62, 16
    s_add_u32 s84, s33, s62
    s_cmp_eq_u32 s58, 0
    s_cselect_b32 s84, s84, 0x40000000
    s_mov_b32 s18, 0
    s_cmp_eq_u32 s58, 0
    s_cselect_b32 s1, 16, 0
    s_mov_b32 s3, 16
    s_call_b64 s[54:55], t_g2_c
    s_and_b32 s62, s57, 7
    s_lshr_b32 s63, s57, 3
    s_lshl_b32 s60, s63, 19
    s_add_u32 s60, s60, 1024
    s_mov_b32 s30, s76
    s_and_b32 s31, s77, 0xffff
    s_mov_b32 s32, 0x200000
    s_mov_b32 s33, s60
    s_mov_b32 s34, 0x8000
    s_mov_b32 s35, 0x40000
    s_lshl_b32 s61, s62, 13
    s_andn2_b32 s61, 0x2000, s61
    s_xor_b32 s61, s61, s59
    s_lshl_b32 s60, s62, 21
    s_add_u32 s60, s60, s61
    s_add_u32 s60, s60, 0x180000
    s_add_u32 s36, s100, 0xa000000
    s_addc_u32 s37, s101, 0
    s_and_b32 s37, s37, 0xffff
    s_mov_b32 s38, 0x1000000
    s_mov_b32 s39, s60
    s_mov_b32 s40, 0x800
    s_mov_b32 s41, 0x8000
    s_mov_b32 s42, 0x10000
    s_and_b32 s0, s62, 3
    s_lshl2_add_u32 s0, s63, s0
    s_mov_b64 s[86:87], s[30:31]
    s_lshl_b32 s62, s62, 16
    s_add_u32 s84, s33, s62
    s_cmp_eq_u32 s58, 0
    s_cselect_b32 s84, s84, 0x40000000
    s_mov_b32 s3, 0
    s_call_b64 s[54:55], t_g2_c
    s_mov_b32 s32, 0
    s_mov_b32 s38, 0
    s_mov_b32 s84, 0x40000000
    s_call_b64 s[54:55], t_g2_c
    s_and_b32 s85, s57, 7
    s_lshr_b32 s82, s57, 3
    s_waitcnt vmcnt(0)
    s_barrier
    v_and_b32 v26, 31, v0
    v_bfe_u32 v25, v0, 6, 1
    v_lshl_add_u32 v27, v25, 5, v26
    v_bfe_u32 v28, v0, 5, 1
    v_bfe_u32 v24, v0, 7, 1
    v_lshl_add_u32 v24, v24, 7, v28
    v_lshlrev_b32 v25, 13, v24
    v_lshl_add_u32 v25, v27, 4, v25
    v_lshlrev_b32 v24, 11, v24
    v_lshl_add_u32 v24, v27, 3, v24
    v_lshlrev_b32 v27, 3, v27
    s_mov_b32 s60, s80
    s_and_b32 s61, s81, 0xffff
    s_mov_b32 s62, 0x800
    s_mov_b32 s63, 0x00020000
    s_lshl_b32 s53, s82, 9
    buffer_load_dwordx2 v[44:45], v27, s[60:63], s53 offen
    s_mov_b32 s8, s64
    s_and_b32 s9, s65, 0xffff
    s_mov_b32 s10, 0x400000
    s_mov_b32 s11, 0x00020000
    s_mov_b32 s12, s96
    s_and_b32 s13, s97, 0xffff
    s_mov_b32 s14, 0x1000000
    s_mov_b32 s15, 0x00020000
    s_lshl_b32 s50, s85, 19
    s_add_u32 s50, s50, s53
    s_add_u32 s53, s50, 0x0
    buffer_load_dwordx2 v[128:129], v24, s[8:11], s53 offen
    s_add_u32 s53, s50, 0x1000
    buffer_load_dwordx2 v[130:131], v24, s[8:11], s53 offen
    s_add_u32 s53, s50, 0x2000
    buffer_load_dwordx2 v[132:133], v24, s[8:11], s53 offen
    s_add_u32 s53, s50, 0x3000
    buffer_load_dwordx2 v[134:135], v24, s[8:11], s53 offen
    s_add_u32 s53, s50, 0x10000
    buffer_load_dwordx2 v[136:137], v24, s[8:11], s53 offen
    s_add_u32 s53, s50, 0x11000
    buffer_load_dwordx2 v[138:139], v24, s[8:11], s53 offen
    s_add_u32 s53, s50, 0x12000
    buffer_load_dwordx2 v[140:141], v24, s[8:11], s53 offen
    s_add_u32 s53, s50, 0x13000
    buffer_load_dwordx2 v[142:143], v24, s[8:11], s53 offen
    s_add_u32 s53, s50, 0x20000
    buffer_load_dwordx2 v[144:145], v24, s[8:11], s53 offen
    s_add_u32 s53, s50, 0x21000
    buffer_load_dwordx2 v[146:147], v24, s[8:11], s53 offen
    s_add_u32 s53, s50, 0x22000
    buffer_load_dwordx2 v[148:149], v24, s[8:11], s53 offen
    s_add_u32 s53, s50, 0x23000
    buffer_load_dwordx2 v[150:151], v24, s[8:11], s53 offen
    s_add_u32 s53, s50, 0x30000
    buffer_load_dwordx2 v[152:153], v24, s[8:11], s53 offen
    s_add_u32 s53, s50, 0x31000
    buffer_load_dwordx2 v[154:155], v24, s[8:11], s53 offen
    s_add_u32 s53, s50, 0x32000
    buffer_load_dwordx2 v[156:157], v24, s[8:11], s53 offen
    s_add_u32 s53, s50, 0x33000
    buffer_load_dwordx2 v[158:159], v24, s[8:11], s53 offen
    s_add_u32 s53, s50, 0x4000
    buffer_load_dwordx2 v[160:161], v24, s[8:11], s53 offen
    s_add_u32 s53, s50, 0x5000
    buffer_load_dwordx2 v[162:163], v24, s[8:11], s53 offen
    s_add_u32 s53, s50, 0x6000
    buffer_load_dwordx2 v[164:165], v24, s[8:11], s53 offen
    s_add_u32 s53, s50, 0x7000
    buffer_load_dwordx2 v[166:167], v24, s[8:11], s53 offen
    s_add_u32 s53, s50, 0x14000
    buffer_load_dwordx2 v[168:169], v24, s[8:11], s53 offen
    s_add_u32 s53, s50, 0x15000
    buffer_load_dwordx2 v[170:171], v24, s[8:11], s53 offen
    s_add_u32 s53, s50, 0x16000
    buffer_load_dwordx2 v[172:173], v24, s[8:11], s53 offen
    s_add_u32 s53, s50, 0x17000
    buffer_load_dwordx2 v[174:175], v24, s[8:11], s53 offen
    s_add_u32 s53, s50, 0x24000
    buffer_load_dwordx2 v[176:177], v24, s[8:11], s53 offen
    s_add_u32 s53, s50, 0x25000
    buffer_load_dwordx2 v[178:179], v24, s[8:11], s53 offen
    s_add_u32 s53, s50, 0x26000
    buffer_load_dwordx2 v[180:181], v24, s[8:11], s53 offen
    s_add_u32 s53, s50, 0x27000
    buffer_load_dwordx2 v[182:183], v24, s[8:11], s53 offen
    s_add_u32 s53, s50, 0x34000
    buffer_load_dwordx2 v[184:185], v24, s[8:11], s53 offen
    s_add_u32 s53, s50, 0x35000
    buffer_load_dwordx2 v[186:187], v24, s[8:11], s53 offen
    s_add_u32 s53, s50, 0x36000
    buffer_load_dwordx2 v[188:189], v24, s[8:11], s53 offen
    s_add_u32 s53, s50, 0x37000
    buffer_load_dwordx2 v[190:191], v24, s[8:11], s53 offen
    s_mul_i32 s60, s58, 33792
    v_mul_u32_u24 v28, 528, v28
    v_lshl_add_u32 v28, v26, 4, v28
    v_add_u32 v28, s60, v28
    v_and_b32 v27, 15, v0
    v_mul_u32_u24 v27, 528, v27
    v_bfe_u32 v26, v0, 4, 2
    v_lshl_add_u32 v27, v26, 4, v27
    v_add_u32 v27, s60, v27
    s_lshl_b32 s51, s85, 21
    s_lshl_b32 s52, s82, 10
    s_add_u32 s51, s51, s52
    ds_write_b128 v27, a[0:3] offset:0
    ds_write_b128 v27, a[32:35] offset:64
    ds_write_b128 v27, a[64:67] offset:128
    ds_write_b128 v27, a[96:99] offset:192
    ds_write_b128 v27, a[128:131] offset:256
    ds_write_b128 v27, a[160:163] offset:320
    ds_write_b128 v27, a[192:195] offset:384
    ds_write_b128 v27, a[224:227] offset:448
    ds_read_b128 v[48:51], v28 offset:0
    ds_read_b128 v[52:55], v28 offset:1056
    ds_read_b128 v[56:59], v28 offset:2112
    ds_read_b128 v[60:63], v28 offset:3168
    ds_read_b128 v[64:67], v28 offset:4224
    ds_read_b128 v[68:71], v28 offset:5280
    ds_read_b128 v[72:75], v28 offset:6336
    ds_read_b128 v[76:79], v28 offset:7392
    ds_write_b128 v27, a[4:7] offset:8448
    ds_write_b128 v27, a[36:39] offset:8512
    ds_write_b128 v27, a[68:71] offset:8576
    ds_write_b128 v27, a[100:103] offset:8640
    ds_write_b128 v27, a[132:135] offset:8704
    ds_write_b128 v27, a[164:167] offset:8768
    ds_write_b128 v27, a[196:199] offset:8832
    ds_write_b128 v27, a[228:231] offset:8896
    s_waitcnt vmcnt(32)
    v_lshlrev_b32 v40, 16, v44
    v_and_b32 v41, 0xffff0000, v44
    v_lshlrev_b32 v42, 16, v45
    v_and_b32 v43, 0xffff0000, v45
    s_waitcnt vmcnt(24) lgkmcnt(8)
    ds_read_b128 v[80:83], v28 offset:8448
    ds_read_b128 v[84:87], v28 offset:9504
    ds_read_b128 v[88:91], v28 offset:10560
    ds_read_b128 v[92:95], v28 offset:11616
    ds_read_b128 v[96:99], v28 offset:12672
    ds_read_b128 v[100:103], v28 offset:13728
    ds_read_b128 v[104:107], v28 offset:14784
    ds_read_b128 v[108:111], v28 offset:15840
    ds_write_b128 v27, a[8:11] offset:16896
    ds_write_b128 v27, a[40:43] offset:16960
    ds_write_b128 v27, a[72:75] offset:17024
    ds_write_b128 v27, a[104:107] offset:17088
    ds_write_b128 v27, a[136:139] offset:17152
    ds_write_b128 v27, a[168:171] offset:17216
    ds_write_b128 v27, a[200:203] offset:17280
    ds_write_b128 v27, a[232:235] offset:17344
    v_lshlrev_b32 v112, 16, v128
    v_and_b32 v113, 0xffff0000, v128
    v_lshlrev_b32 v114, 16, v129
    v_and_b32 v115, 0xffff0000, v129
    v_pk_mul_f32 v[112:113], v[112:113], v[40:41]
    v_pk_mul_f32 v[114:115], v[114:115], v[42:43]
    s_add_u32 s52, s51, 0x0
    v_cvt_pk_bf16_f32 v112, 0, v112
    v_cvt_pk_bf16_f32 v113, 0, v113
    v_cvt_pk_bf16_f32 v114, 0, v114
    v_cvt_pk_bf16_f32 v115, 0, v115
    v_pk_add_f32 v[48:49], v[48:49], v[112:113]
    v_pk_add_f32 v[50:51], v[50:51], v[114:115]
    buffer_store_dwordx4 v[48:51], v25, s[12:15], s52 offen
    v_lshlrev_b32 v116, 16, v130
    v_and_b32 v117, 0xffff0000, v130
    v_lshlrev_b32 v118, 16, v131
    v_and_b32 v119, 0xffff0000, v131
    v_pk_mul_f32 v[116:117], v[116:117], v[40:41]
    v_pk_mul_f32 v[118:119], v[118:119], v[42:43]
    s_add_u32 s52, s51, 0x4000
    v_cvt_pk_bf16_f32 v116, 0, v116
    v_cvt_pk_bf16_f32 v117, 0, v117
    v_cvt_pk_bf16_f32 v118, 0, v118
    v_cvt_pk_bf16_f32 v119, 0, v119
    v_pk_add_f32 v[52:53], v[52:53], v[116:117]
    v_pk_add_f32 v[54:55], v[54:55], v[118:119]
    buffer_store_dwordx4 v[52:55], v25, s[12:15], s52 offen
    v_lshlrev_b32 v112, 16, v132
    v_and_b32 v113, 0xffff0000, v132
    v_lshlrev_b32 v114, 16, v133
    v_and_b32 v115, 0xffff0000, v133
    v_pk_mul_f32 v[112:113], v[112:113], v[40:41]
    v_pk_mul_f32 v[114:115], v[114:115], v[42:43]
    s_add_u32 s52, s51, 0x8000
    v_cvt_pk_bf16_f32 v112, 0, v112
    v_cvt_pk_bf16_f32 v113, 0, v113
    v_cvt_pk_bf16_f32 v114, 0, v114
    v_cvt_pk_bf16_f32 v115, 0, v115
    v_pk_add_f32 v[56:57], v[56:57], v[112:113]
    v_pk_add_f32 v[58:59], v[58:59], v[114:115]
    buffer_store_dwordx4 v[56:59], v25, s[12:15], s52 offen
    v_lshlrev_b32 v116, 16, v134
    v_and_b32 v117, 0xffff0000, v134
    v_lshlrev_b32 v118, 16, v135
    v_and_b32 v119, 0xffff0000, v135
    v_pk_mul_f32 v[116:117], v[116:117], v[40:41]
    v_pk_mul_f32 v[118:119], v[118:119], v[42:43]
    s_add_u32 s52, s51, 0xc000
    v_cvt_pk_bf16_f32 v116, 0, v116
    v_cvt_pk_bf16_f32 v117, 0, v117
    v_cvt_pk_bf16_f32 v118, 0, v118
    v_cvt_pk_bf16_f32 v119, 0, v119
    v_pk_add_f32 v[60:61], v[60:61], v[116:117]
    v_pk_add_f32 v[62:63], v[62:63], v[118:119]
    buffer_store_dwordx4 v[60:63], v25, s[12:15], s52 offen
    v_lshlrev_b32 v112, 16, v136
    v_and_b32 v113, 0xffff0000, v136
    v_lshlrev_b32 v114, 16, v137
    v_and_b32 v115, 0xffff0000, v137
    v_pk_mul_f32 v[112:113], v[112:113], v[40:41]
    v_pk_mul_f32 v[114:115], v[114:115], v[42:43]
    s_add_u32 s52, s51, 0x40000
    v_cvt_pk_bf16_f32 v112, 0, v112
    v_cvt_pk_bf16_f32 v113, 0, v113
    v_cvt_pk_bf16_f32 v114, 0, v114
    v_cvt_pk_bf16_f32 v115, 0, v115
    v_pk_add_f32 v[64:65], v[64:65], v[112:113]
    v_pk_add_f32 v[66:67], v[66:67], v[114:115]
    buffer_store_dwordx4 v[64:67], v25, s[12:15], s52 offen
    v_lshlrev_b32 v116, 16, v138
    v_and_b32 v117, 0xffff0000, v138
    v_lshlrev_b32 v118, 16, v139
    v_and_b32 v119, 0xffff0000, v139
    v_pk_mul_f32 v[116:117], v[116:117], v[40:41]
    v_pk_mul_f32 v[118:119], v[118:119], v[42:43]
    s_add_u32 s52, s51, 0x44000
    v_cvt_pk_bf16_f32 v116, 0, v116
    v_cvt_pk_bf16_f32 v117, 0, v117
    v_cvt_pk_bf16_f32 v118, 0, v118
    v_cvt_pk_bf16_f32 v119, 0, v119
    v_pk_add_f32 v[68:69], v[68:69], v[116:117]
    v_pk_add_f32 v[70:71], v[70:71], v[118:119]
    buffer_store_dwordx4 v[68:71], v25, s[12:15], s52 offen
    v_lshlrev_b32 v112, 16, v140
    v_and_b32 v113, 0xffff0000, v140
    v_lshlrev_b32 v114, 16, v141
    v_and_b32 v115, 0xffff0000, v141
    v_pk_mul_f32 v[112:113], v[112:113], v[40:41]
    v_pk_mul_f32 v[114:115], v[114:115], v[42:43]
    s_add_u32 s52, s51, 0x48000
    v_cvt_pk_bf16_f32 v112, 0, v112
    v_cvt_pk_bf16_f32 v113, 0, v113
    v_cvt_pk_bf16_f32 v114, 0, v114
    v_cvt_pk_bf16_f32 v115, 0, v115
    v_pk_add_f32 v[72:73], v[72:73], v[112:113]
    v_pk_add_f32 v[74:75], v[74:75], v[114:115]
    buffer_store_dwordx4 v[72:75], v25, s[12:15], s52 offen
    v_lshlrev_b32 v116, 16, v142
    v_and_b32 v117, 0xffff0000, v142
    v_lshlrev_b32 v118, 16, v143
    v_and_b32 v119, 0xffff0000, v143
    v_pk_mul_f32 v[116:117], v[116:117], v[40:41]
    v_pk_mul_f32 v[118:119], v[118:119], v[42:43]
    s_add_u32 s52, s51, 0x4c000
    v_cvt_pk_bf16_f32 v116, 0, v116
    v_cvt_pk_bf16_f32 v117, 0, v117
    v_cvt_pk_bf16_f32 v118, 0, v118
    v_cvt_pk_bf16_f32 v119, 0, v119
    v_pk_add_f32 v[76:77], v[76:77], v[116:117]
    v_pk_add_f32 v[78:79], v[78:79], v[118:119]
    buffer_store_dwordx4 v[76:79], v25, s[12:15], s52 offen
    s_add_u32 s53, s50, 0x8000
    buffer_load_dwordx2 v[192:193], v24, s[8:11], s53 offen
    s_add_u32 s53, s50, 0x9000
    buffer_load_dwordx2 v[194:195], v24, s[8:11], s53 offen
    s_add_u32 s53, s50, 0xa000
    buffer_load_dwordx2 v[196:197], v24, s[8:11], s53 offen
    s_add_u32 s53, s50, 0xb000
    buffer_load_dwordx2 v[198:199], v24, s[8:11], s53 offen
    s_add_u32 s53, s50, 0x18000
    buffer_load_dwordx2 v[200:201], v24, s[8:11], s53 offen
    s_add_u32 s53, s50, 0x19000
    buffer_load_dwordx2 v[202:203], v24, s[8:11], s53 offen
    s_add_u32 s53, s50, 0x1a000
    buffer_load_dwordx2 v[204:205], v24, s[8:11], s53 offen
    s_add_u32 s53, s50, 0x1b000
    buffer_load_dwordx2 v[206:207], v24, s[8:11], s53 offen
    s_waitcnt vmcnt(32) lgkmcnt(8)
    ds_read_b128 v[48:51], v28 offset:16896
    ds_read_b128 v[52:55], v28 offset:17952
    ds_read_b128 v[56:59], v28 offset:19008
    ds_read_b128 v[60:63], v28 offset:20064
    ds_read_b128 v[64:67], v28 offset:21120
    ds_read_b128 v[68:71], v28 offset:22176
    ds_read_b128 v[72:75], v28 offset:23232
    ds_read_b128 v[76:79], v28 offset:24288
    ds_write_b128 v27, a[12:15] offset:25344
    ds_write_b128 v27, a[44:47] offset:25408
    ds_write_b128 v27, a[76:79] offset:25472
    ds_write_b128 v27, a[108:111] offset:25536
    ds_write_b128 v27, a[140:143] offset:25600
    ds_write_b128 v27, a[172:175] offset:25664
    ds_write_b128 v27, a[204:207] offset:25728
    ds_write_b128 v27, a[236:239] offset:25792
    v_lshlrev_b32 v112, 16, v144
    v_and_b32 v113, 0xffff0000, v144
    v_lshlrev_b32 v114, 16, v145
    v_and_b32 v115, 0xffff0000, v145
    v_pk_mul_f32 v[112:113], v[112:113], v[40:41]
    v_pk_mul_f32 v[114:115], v[114:115], v[42:43]
    s_add_u32 s52, s51, 0x80000
    v_cvt_pk_bf16_f32 v112, 0, v112
    v_cvt_pk_bf16_f32 v113, 0, v113
    v_cvt_pk_bf16_f32 v114, 0, v114
    v_cvt_pk_bf16_f32 v115, 0, v115
    v_pk_add_f32 v[80:81], v[80:81], v[112:113]
    v_pk_add_f32 v[82:83], v[82:83], v[114:115]
    buffer_store_dwordx4 v[80:83], v25, s[12:15], s52 offen
    v_lshlrev_b32 v116, 16, v146
    v_and_b32 v117, 0xffff0000, v146
    v_lshlrev_b32 v118, 16, v147
    v_and_b32 v119, 0xffff0000, v147
    v_pk_mul_f32 v[116:117], v[116:117], v[40:41]
    v_pk_mul_f32 v[118:119], v[118:119], v[42:43]
    s_add_u32 s52, s51, 0x84000
    v_cvt_pk_bf16_f32 v116, 0, v116
    v_cvt_pk_bf16_f32 v117, 0, v117
    v_cvt_pk_bf16_f32 v118, 0, v118
    v_cvt_pk_bf16_f32 v119, 0, v119
    v_pk_add_f32 v[84:85], v[84:85], v[116:117]
    v_pk_add_f32 v[86:87], v[86:87], v[118:119]
    buffer_store_dwordx4 v[84:87], v25, s[12:15], s52 offen
    v_lshlrev_b32 v112, 16, v148
    v_and_b32 v113, 0xffff0000, v148
    v_lshlrev_b32 v114, 16, v149
    v_and_b32 v115, 0xffff0000, v149
    v_pk_mul_f32 v[112:113], v[112:113], v[40:41]
    v_pk_mul_f32 v[114:115], v[114:115], v[42:43]
    s_add_u32 s52, s51, 0x88000
    v_cvt_pk_bf16_f32 v112, 0, v112
    v_cvt_pk_bf16_f32 v113, 0, v113
    v_cvt_pk_bf16_f32 v114, 0, v114
    v_cvt_pk_bf16_f32 v115, 0, v115
    v_pk_add_f32 v[88:89], v[88:89], v[112:113]
    v_pk_add_f32 v[90:91], v[90:91], v[114:115]
    buffer_store_dwordx4 v[88:91], v25, s[12:15], s52 offen
    v_lshlrev_b32 v116, 16, v150
    v_and_b32 v117, 0xffff0000, v150
    v_lshlrev_b32 v118, 16, v151
    v_and_b32 v119, 0xffff0000, v151
    v_pk_mul_f32 v[116:117], v[116:117], v[40:41]
    v_pk_mul_f32 v[118:119], v[118:119], v[42:43]
    s_add_u32 s52, s51, 0x8c000
    v_cvt_pk_bf16_f32 v116, 0, v116
    v_cvt_pk_bf16_f32 v117, 0, v117
    v_cvt_pk_bf16_f32 v118, 0, v118
    v_cvt_pk_bf16_f32 v119, 0, v119
    v_pk_add_f32 v[92:93], v[92:93], v[116:117]
    v_pk_add_f32 v[94:95], v[94:95], v[118:119]
    buffer_store_dwordx4 v[92:95], v25, s[12:15], s52 offen
    v_lshlrev_b32 v112, 16, v152
    v_and_b32 v113, 0xffff0000, v152
    v_lshlrev_b32 v114, 16, v153
    v_and_b32 v115, 0xffff0000, v153
    v_pk_mul_f32 v[112:113], v[112:113], v[40:41]
    v_pk_mul_f32 v[114:115], v[114:115], v[42:43]
    s_add_u32 s52, s51, 0xc0000
    v_cvt_pk_bf16_f32 v112, 0, v112
    v_cvt_pk_bf16_f32 v113, 0, v113
    v_cvt_pk_bf16_f32 v114, 0, v114
    v_cvt_pk_bf16_f32 v115, 0, v115
    v_pk_add_f32 v[96:97], v[96:97], v[112:113]
    v_pk_add_f32 v[98:99], v[98:99], v[114:115]
    buffer_store_dwordx4 v[96:99], v25, s[12:15], s52 offen
    v_lshlrev_b32 v116, 16, v154
    v_and_b32 v117, 0xffff0000, v154
    v_lshlrev_b32 v118, 16, v155
    v_and_b32 v119, 0xffff0000, v155
    v_pk_mul_f32 v[116:117], v[116:117], v[40:41]
    v_pk_mul_f32 v[118:119], v[118:119], v[42:43]
    s_add_u32 s52, s51, 0xc4000
    v_cvt_pk_bf16_f32 v116, 0, v116
    v_cvt_pk_bf16_f32 v117, 0, v117
    v_cvt_pk_bf16_f32 v118, 0, v118
    v_cvt_pk_bf16_f32 v119, 0, v119
    v_pk_add_f32 v[100:101], v[100:101], v[116:117]
    v_pk_add_f32 v[102:103], v[102:103], v[118:119]
    buffer_store_dwordx4 v[100:103], v25, s[12:15], s52 offen
    v_lshlrev_b32 v112, 16, v156
    v_and_b32 v113, 0xffff0000, v156
    v_lshlrev_b32 v114, 16, v157
    v_and_b32 v115, 0xffff0000, v157
    v_pk_mul_f32 v[112:113], v[112:113], v[40:41]
    v_pk_mul_f32 v[114:115], v[114:115], v[42:43]
    s_add_u32 s52, s51, 0xc8000
    v_cvt_pk_bf16_f32 v112, 0, v112
    v_cvt_pk_bf16_f32 v113, 0, v113
    v_cvt_pk_bf16_f32 v114, 0, v114
    v_cvt_pk_bf16_f32 v115, 0, v115
    v_pk_add_f32 v[104:105], v[104:105], v[112:113]
    v_pk_add_f32 v[106:107], v[106:107], v[114:115]
    buffer_store_dwordx4 v[104:107], v25, s[12:15], s52 offen
    v_lshlrev_b32 v116, 16, v158
    v_and_b32 v117, 0xffff0000, v158
    v_lshlrev_b32 v118, 16, v159
    v_and_b32 v119, 0xffff0000, v159
    v_pk_mul_f32 v[116:117], v[116:117], v[40:41]
    v_pk_mul_f32 v[118:119], v[118:119], v[42:43]
    s_add_u32 s52, s51, 0xcc000
    v_cvt_pk_bf16_f32 v116, 0, v116
    v_cvt_pk_bf16_f32 v117, 0, v117
    v_cvt_pk_bf16_f32 v118, 0, v118
    v_cvt_pk_bf16_f32 v119, 0, v119
    v_pk_add_f32 v[108:109], v[108:109], v[116:117]
    v_pk_add_f32 v[110:111], v[110:111], v[118:119]
    buffer_store_dwordx4 v[108:111], v25, s[12:15], s52 offen
    s_add_u32 s53, s50, 0x28000
    buffer_load_dwordx2 v[208:209], v24, s[8:11], s53 offen
    s_add_u32 s53, s50, 0x29000
    buffer_load_dwordx2 v[210:211], v24, s[8:11], s53 offen
    s_add_u32 s53, s50, 0x2a000
    buffer_load_dwordx2 v[212:213], v24, s[8:11], s53 offen
    s_add_u32 s53, s50, 0x2b000
    buffer_load_dwordx2 v[214:215], v24, s[8:11], s53 offen
    s_add_u32 s53, s50, 0x38000
    buffer_load_dwordx2 v[216:217], v24, s[8:11], s53 offen
    s_add_u32 s53, s50, 0x39000
    buffer_load_dwordx2 v[218:219], v24, s[8:11], s53 offen
    s_add_u32 s53, s50, 0x3a000
    buffer_load_dwordx2 v[220:221], v24, s[8:11], s53 offen
    s_add_u32 s53, s50, 0x3b000
    buffer_load_dwordx2 v[222:223], v24, s[8:11], s53 offen
    s_waitcnt vmcnt(40) lgkmcnt(8)
    ds_read_b128 v[80:83], v28 offset:25344
    ds_read_b128 v[84:87], v28 offset:26400
    ds_read_b128 v[88:91], v28 offset:27456
    ds_read_b128 v[92:95], v28 offset:28512
    ds_read_b128 v[96:99], v28 offset:29568
    ds_read_b128 v[100:103], v28 offset:30624
    ds_read_b128 v[104:107], v28 offset:31680
    ds_read_b128 v[108:111], v28 offset:32736
    ds_write_b128 v27, a[16:19] offset:0
    ds_write_b128 v27, a[48:51] offset:64
    ds_write_b128 v27, a[80:83] offset:128
    ds_write_b128 v27, a[112:115] offset:192
    ds_write_b128 v27, a[144:147] offset:256
    ds_write_b128 v27, a[176:179] offset:320
    ds_write_b128 v27, a[208:211] offset:384
    ds_write_b128 v27, a[240:243] offset:448
    v_lshlrev_b32 v112, 16, v160
    v_and_b32 v113, 0xffff0000, v160
    v_lshlrev_b32 v114, 16, v161
    v_and_b32 v115, 0xffff0000, v161
    v_pk_mul_f32 v[112:113], v[112:113], v[40:41]
    v_pk_mul_f32 v[114:115], v[114:115], v[42:43]
    s_add_u32 s52, s51, 0x10000
    v_cvt_pk_bf16_f32 v112, 0, v112
    v_cvt_pk_bf16_f32 v113, 0, v113
    v_cvt_pk_bf16_f32 v114, 0, v114
    v_cvt_pk_bf16_f32 v115, 0, v115
    v_pk_add_f32 v[48:49], v[48:49], v[112:113]
    v_pk_add_f32 v[50:51], v[50:51], v[114:115]
    buffer_store_dwordx4 v[48:51], v25, s[12:15], s52 offen
    v_lshlrev_b32 v116, 16, v162
    v_and_b32 v117, 0xffff0000, v162
    v_lshlrev_b32 v118, 16, v163
    v_and_b32 v119, 0xffff0000, v163
    v_pk_mul_f32 v[116:117], v[116:117], v[40:41]
    v_pk_mul_f32 v[118:119], v[118:119], v[42:43]
    s_add_u32 s52, s51, 0x14000
    v_cvt_pk_bf16_f32 v116, 0, v116
    v_cvt_pk_bf16_f32 v117, 0, v117
    v_cvt_pk_bf16_f32 v118, 0, v118
    v_cvt_pk_bf16_f32 v119, 0, v119
    v_pk_add_f32 v[52:53], v[52:53], v[116:117]
    v_pk_add_f32 v[54:55], v[54:55], v[118:119]
    buffer_store_dwordx4 v[52:55], v25, s[12:15], s52 offen
    v_lshlrev_b32 v112, 16, v164
    v_and_b32 v113, 0xffff0000, v164
    v_lshlrev_b32 v114, 16, v165
    v_and_b32 v115, 0xffff0000, v165
    v_pk_mul_f32 v[112:113], v[112:113], v[40:41]
    v_pk_mul_f32 v[114:115], v[114:115], v[42:43]
    s_add_u32 s52, s51, 0x18000
    v_cvt_pk_bf16_f32 v112, 0, v112
    v_cvt_pk_bf16_f32 v113, 0, v113
    v_cvt_pk_bf16_f32 v114, 0, v114
    v_cvt_pk_bf16_f32 v115, 0, v115
    v_pk_add_f32 v[56:57], v[56:57], v[112:113]
    v_pk_add_f32 v[58:59], v[58:59], v[114:115]
    buffer_store_dwordx4 v[56:59], v25, s[12:15], s52 offen
    v_lshlrev_b32 v116, 16, v166
    v_and_b32 v117, 0xffff0000, v166
    v_lshlrev_b32 v118, 16, v167
    v_and_b32 v119, 0xffff0000, v167
    v_pk_mul_f32 v[116:117], v[116:117], v[40:41]
    v_pk_mul_f32 v[118:119], v[118:119], v[42:43]
    s_add_u32 s52, s51, 0x1c000
    v_cvt_pk_bf16_f32 v116, 0, v116
    v_cvt_pk_bf16_f32 v117, 0, v117
    v_cvt_pk_bf16_f32 v118, 0, v118
    v_cvt_pk_bf16_f32 v119, 0, v119
    v_pk_add_f32 v[60:61], v[60:61], v[116:117]
    v_pk_add_f32 v[62:63], v[62:63], v[118:119]
    buffer_store_dwordx4 v[60:63], v25, s[12:15], s52 offen
    v_lshlrev_b32 v112, 16, v168
    v_and_b32 v113, 0xffff0000, v168
    v_lshlrev_b32 v114, 16, v169
    v_and_b32 v115, 0xffff0000, v169
    v_pk_mul_f32 v[112:113], v[112:113], v[40:41]
    v_pk_mul_f32 v[114:115], v[114:115], v[42:43]
    s_add_u32 s52, s51, 0x50000
    v_cvt_pk_bf16_f32 v112, 0, v112
    v_cvt_pk_bf16_f32 v113, 0, v113
    v_cvt_pk_bf16_f32 v114, 0, v114
    v_cvt_pk_bf16_f32 v115, 0, v115
    v_pk_add_f32 v[64:65], v[64:65], v[112:113]
    v_pk_add_f32 v[66:67], v[66:67], v[114:115]
    buffer_store_dwordx4 v[64:67], v25, s[12:15], s52 offen
    v_lshlrev_b32 v116, 16, v170
    v_and_b32 v117, 0xffff0000, v170
    v_lshlrev_b32 v118, 16, v171
    v_and_b32 v119, 0xffff0000, v171
    v_pk_mul_f32 v[116:117], v[116:117], v[40:41]
    v_pk_mul_f32 v[118:119], v[118:119], v[42:43]
    s_add_u32 s52, s51, 0x54000
    v_cvt_pk_bf16_f32 v116, 0, v116
    v_cvt_pk_bf16_f32 v117, 0, v117
    v_cvt_pk_bf16_f32 v118, 0, v118
    v_cvt_pk_bf16_f32 v119, 0, v119
    v_pk_add_f32 v[68:69], v[68:69], v[116:117]
    v_pk_add_f32 v[70:71], v[70:71], v[118:119]
    buffer_store_dwordx4 v[68:71], v25, s[12:15], s52 offen
    v_lshlrev_b32 v112, 16, v172
    v_and_b32 v113, 0xffff0000, v172
    v_lshlrev_b32 v114, 16, v173
    v_and_b32 v115, 0xffff0000, v173
    v_pk_mul_f32 v[112:113], v[112:113], v[40:41]
    v_pk_mul_f32 v[114:115], v[114:115], v[42:43]
    s_add_u32 s52, s51, 0x58000
    v_cvt_pk_bf16_f32 v112, 0, v112
    v_cvt_pk_bf16_f32 v113, 0, v113
    v_cvt_pk_bf16_f32 v114, 0, v114
    v_cvt_pk_bf16_f32 v115, 0, v115
    v_pk_add_f32 v[72:73], v[72:73], v[112:113]
    v_pk_add_f32 v[74:75], v[74:75], v[114:115]
    buffer_store_dwordx4 v[72:75], v25, s[12:15], s52 offen
    v_lshlrev_b32 v116, 16, v174
    v_and_b32 v117, 0xffff0000, v174
    v_lshlrev_b32 v118, 16, v175
    v_and_b32 v119, 0xffff0000, v175
    v_pk_mul_f32 v[116:117], v[116:117], v[40:41]
    v_pk_mul_f32 v[118:119], v[118:119], v[42:43]
    s_add_u32 s52, s51, 0x5c000
    v_cvt_pk_bf16_f32 v116, 0, v116
    v_cvt_pk_bf16_f32 v117, 0, v117
    v_cvt_pk_bf16_f32 v118, 0, v118
    v_cvt_pk_bf16_f32 v119, 0, v119
    v_pk_add_f32 v[76:77], v[76:77], v[116:117]
    v_pk_add_f32 v[78:79], v[78:79], v[118:119]
    buffer_store_dwordx4 v[76:79], v25, s[12:15], s52 offen
    s_add_u32 s53, s50, 0xc000
    buffer_load_dwordx2 v[224:225], v24, s[8:11], s53 offen
    s_add_u32 s53, s50, 0xd000
    buffer_load_dwordx2 v[226:227], v24, s[8:11], s53 offen
    s_add_u32 s53, s50, 0xe000
    buffer_load_dwordx2 v[228:229], v24, s[8:11], s53 offen
    s_add_u32 s53, s50, 0xf000
    buffer_load_dwordx2 v[230:231], v24, s[8:11], s53 offen
    s_add_u32 s53, s50, 0x1c000
    buffer_load_dwordx2 v[232:233], v24, s[8:11], s53 offen
    s_add_u32 s53, s50, 0x1d000
    buffer_load_dwordx2 v[234:235], v24, s[8:11], s53 offen
    s_add_u32 s53, s50, 0x1e000
    buffer_load_dwordx2 v[236:237], v24, s[8:11], s53 offen
    s_add_u32 s53, s50, 0x1f000
    buffer_load_dwordx2 v[238:239], v24, s[8:11], s53 offen
    s_waitcnt vmcnt(48) lgkmcnt(8)
    ds_read_b128 v[48:51], v28 offset:0
    ds_read_b128 v[52:55], v28 offset:1056
    ds_read_b128 v[56:59], v28 offset:2112
    ds_read_b128 v[60:63], v28 offset:3168
    ds_read_b128 v[64:67], v28 offset:4224
    ds_read_b128 v[68:71], v28 offset:5280
    ds_read_b128 v[72:75], v28 offset:6336
    ds_read_b128 v[76:79], v28 offset:7392
    ds_write_b128 v27, a[20:23] offset:8448
    ds_write_b128 v27, a[52:55] offset:8512
    ds_write_b128 v27, a[84:87] offset:8576
    ds_write_b128 v27, a[116:119] offset:8640
    ds_write_b128 v27, a[148:151] offset:8704
    ds_write_b128 v27, a[180:183] offset:8768
    ds_write_b128 v27, a[212:215] offset:8832
    ds_write_b128 v27, a[244:247] offset:8896
    v_lshlrev_b32 v112, 16, v176
    v_and_b32 v113, 0xffff0000, v176
    v_lshlrev_b32 v114, 16, v177
    v_and_b32 v115, 0xffff0000, v177
    v_pk_mul_f32 v[112:113], v[112:113], v[40:41]
    v_pk_mul_f32 v[114:115], v[114:115], v[42:43]
    s_add_u32 s52, s51, 0x90000
    v_cvt_pk_bf16_f32 v112, 0, v112
    v_cvt_pk_bf16_f32 v113, 0, v113
    v_cvt_pk_bf16_f32 v114, 0, v114
    v_cvt_pk_bf16_f32 v115, 0, v115
    v_pk_add_f32 v[80:81], v[80:81], v[112:113]
    v_pk_add_f32 v[82:83], v[82:83], v[114:115]
    buffer_store_dwordx4 v[80:83], v25, s[12:15], s52 offen
    v_lshlrev_b32 v116, 16, v178
    v_and_b32 v117, 0xffff0000, v178
    v_lshlrev_b32 v118, 16, v179
    v_and_b32 v119, 0xffff0000, v179
    v_pk_mul_f32 v[116:117], v[116:117], v[40:41]
    v_pk_mul_f32 v[118:119], v[118:119], v[42:43]
    s_add_u32 s52, s51, 0x94000
    v_cvt_pk_bf16_f32 v116, 0, v116
    v_cvt_pk_bf16_f32 v117, 0, v117
    v_cvt_pk_bf16_f32 v118, 0, v118
    v_cvt_pk_bf16_f32 v119, 0, v119
    v_pk_add_f32 v[84:85], v[84:85], v[116:117]
    v_pk_add_f32 v[86:87], v[86:87], v[118:119]
    buffer_store_dwordx4 v[84:87], v25, s[12:15], s52 offen
    v_lshlrev_b32 v112, 16, v180
    v_and_b32 v113, 0xffff0000, v180
    v_lshlrev_b32 v114, 16, v181
    v_and_b32 v115, 0xffff0000, v181
    v_pk_mul_f32 v[112:113], v[112:113], v[40:41]
    v_pk_mul_f32 v[114:115], v[114:115], v[42:43]
    s_add_u32 s52, s51, 0x98000
    v_cvt_pk_bf16_f32 v112, 0, v112
    v_cvt_pk_bf16_f32 v113, 0, v113
    v_cvt_pk_bf16_f32 v114, 0, v114
    v_cvt_pk_bf16_f32 v115, 0, v115
    v_pk_add_f32 v[88:89], v[88:89], v[112:113]
    v_pk_add_f32 v[90:91], v[90:91], v[114:115]
    buffer_store_dwordx4 v[88:91], v25, s[12:15], s52 offen
    v_lshlrev_b32 v116, 16, v182
    v_and_b32 v117, 0xffff0000, v182
    v_lshlrev_b32 v118, 16, v183
    v_and_b32 v119, 0xffff0000, v183
    v_pk_mul_f32 v[116:117], v[116:117], v[40:41]
    v_pk_mul_f32 v[118:119], v[118:119], v[42:43]
    s_add_u32 s52, s51, 0x9c000
    v_cvt_pk_bf16_f32 v116, 0, v116
    v_cvt_pk_bf16_f32 v117, 0, v117
    v_cvt_pk_bf16_f32 v118, 0, v118
    v_cvt_pk_bf16_f32 v119, 0, v119
    v_pk_add_f32 v[92:93], v[92:93], v[116:117]
    v_pk_add_f32 v[94:95], v[94:95], v[118:119]
    buffer_store_dwordx4 v[92:95], v25, s[12:15], s52 offen
    v_lshlrev_b32 v112, 16, v184
    v_and_b32 v113, 0xffff0000, v184
    v_lshlrev_b32 v114, 16, v185
    v_and_b32 v115, 0xffff0000, v185
    v_pk_mul_f32 v[112:113], v[112:113], v[40:41]
    v_pk_mul_f32 v[114:115], v[114:115], v[42:43]
    s_add_u32 s52, s51, 0xd0000
    v_cvt_pk_bf16_f32 v112, 0, v112
    v_cvt_pk_bf16_f32 v113, 0, v113
    v_cvt_pk_bf16_f32 v114, 0, v114
    v_cvt_pk_bf16_f32 v115, 0, v115
    v_pk_add_f32 v[96:97], v[96:97], v[112:113]
    v_pk_add_f32 v[98:99], v[98:99], v[114:115]
    buffer_store_dwordx4 v[96:99], v25, s[12:15], s52 offen
    v_lshlrev_b32 v116, 16, v186
    v_and_b32 v117, 0xffff0000, v186
    v_lshlrev_b32 v118, 16, v187
    v_and_b32 v119, 0xffff0000, v187
    v_pk_mul_f32 v[116:117], v[116:117], v[40:41]
    v_pk_mul_f32 v[118:119], v[118:119], v[42:43]
    s_add_u32 s52, s51, 0xd4000
    v_cvt_pk_bf16_f32 v116, 0, v116
    v_cvt_pk_bf16_f32 v117, 0, v117
    v_cvt_pk_bf16_f32 v118, 0, v118
    v_cvt_pk_bf16_f32 v119, 0, v119
    v_pk_add_f32 v[100:101], v[100:101], v[116:117]
    v_pk_add_f32 v[102:103], v[102:103], v[118:119]
    buffer_store_dwordx4 v[100:103], v25, s[12:15], s52 offen
    v_lshlrev_b32 v112, 16, v188
    v_and_b32 v113, 0xffff0000, v188
    v_lshlrev_b32 v114, 16, v189
    v_and_b32 v115, 0xffff0000, v189
    v_pk_mul_f32 v[112:113], v[112:113], v[40:41]
    v_pk_mul_f32 v[114:115], v[114:115], v[42:43]
    s_add_u32 s52, s51, 0xd8000
    v_cvt_pk_bf16_f32 v112, 0, v112
    v_cvt_pk_bf16_f32 v113, 0, v113
    v_cvt_pk_bf16_f32 v114, 0, v114
    v_cvt_pk_bf16_f32 v115, 0, v115
    v_pk_add_f32 v[104:105], v[104:105], v[112:113]
    v_pk_add_f32 v[106:107], v[106:107], v[114:115]
    buffer_store_dwordx4 v[104:107], v25, s[12:15], s52 offen
    v_lshlrev_b32 v116, 16, v190
    v_and_b32 v117, 0xffff0000, v190
    v_lshlrev_b32 v118, 16, v191
    v_and_b32 v119, 0xffff0000, v191
    v_pk_mul_f32 v[116:117], v[116:117], v[40:41]
    v_pk_mul_f32 v[118:119], v[118:119], v[42:43]
    s_add_u32 s52, s51, 0xdc000
    v_cvt_pk_bf16_f32 v116, 0, v116
    v_cvt_pk_bf16_f32 v117, 0, v117
    v_cvt_pk_bf16_f32 v118, 0, v118
    v_cvt_pk_bf16_f32 v119, 0, v119
    v_pk_add_f32 v[108:109], v[108:109], v[116:117]
    v_pk_add_f32 v[110:111], v[110:111], v[118:119]
    buffer_store_dwordx4 v[108:111], v25, s[12:15], s52 offen
    s_add_u32 s53, s50, 0x2c000
    buffer_load_dwordx2 v[240:241], v24, s[8:11], s53 offen
    s_add_u32 s53, s50, 0x2d000
    buffer_load_dwordx2 v[242:243], v24, s[8:11], s53 offen
    s_add_u32 s53, s50, 0x2e000
    buffer_load_dwordx2 v[244:245], v24, s[8:11], s53 offen
    s_add_u32 s53, s50, 0x2f000
    buffer_load_dwordx2 v[246:247], v24, s[8:11], s53 offen
    s_add_u32 s53, s50, 0x3c000
    buffer_load_dwordx2 v[248:249], v24, s[8:11], s53 offen
    s_add_u32 s53, s50, 0x3d000
    buffer_load_dwordx2 v[250:251], v24, s[8:11], s53 offen
    s_add_u32 s53, s50, 0x3e000
    buffer_load_dwordx2 v[252:253], v24, s[8:11], s53 offen
    s_add_u32 s53, s50, 0x3f000
    buffer_load_dwordx2 v[254:255], v24, s[8:11], s53 offen
    s_waitcnt vmcnt(48) lgkmcnt(8)
    ds_read_b128 v[80:83], v28 offset:8448
    ds_read_b128 v[84:87], v28 offset:9504
    ds_read_b128 v[88:91], v28 offset:10560
    ds_read_b128 v[92:95], v28 offset:11616
    ds_read_b128 v[96:99], v28 offset:12672
    ds_read_b128 v[100:103], v28 offset:13728
    ds_read_b128 v[104:107], v28 offset:14784
    ds_read_b128 v[108:111], v28 offset:15840
    ds_write_b128 v27, a[24:27] offset:16896
    ds_write_b128 v27, a[56:59] offset:16960
    ds_write_b128 v27, a[88:91] offset:17024
    ds_write_b128 v27, a[120:123] offset:17088
    ds_write_b128 v27, a[152:155] offset:17152
    ds_write_b128 v27, a[184:187] offset:17216
    ds_write_b128 v27, a[216:219] offset:17280
    ds_write_b128 v27, a[248:251] offset:17344
    v_lshlrev_b32 v112, 16, v192
    v_and_b32 v113, 0xffff0000, v192
    v_lshlrev_b32 v114, 16, v193
    v_and_b32 v115, 0xffff0000, v193
    v_pk_mul_f32 v[112:113], v[112:113], v[40:41]
    v_pk_mul_f32 v[114:115], v[114:115], v[42:43]
    s_add_u32 s52, s51, 0x20000
    v_cvt_pk_bf16_f32 v112, 0, v112
    v_cvt_pk_bf16_f32 v113, 0, v113
    v_cvt_pk_bf16_f32 v114, 0, v114
    v_cvt_pk_bf16_f32 v115, 0, v115
    v_pk_add_f32 v[48:49], v[48:49], v[112:113]
    v_pk_add_f32 v[50:51], v[50:51], v[114:115]
    buffer_store_dwordx4 v[48:51], v25, s[12:15], s52 offen
    v_lshlrev_b32 v116, 16, v194
    v_and_b32 v117, 0xffff0000, v194
    v_lshlrev_b32 v118, 16, v195
    v_and_b32 v119, 0xffff0000, v195
    v_pk_mul_f32 v[116:117], v[116:117], v[40:41]
    v_pk_mul_f32 v[118:119], v[118:119], v[42:43]
    s_add_u32 s52, s51, 0x24000
    v_cvt_pk_bf16_f32 v116, 0, v116
    v_cvt_pk_bf16_f32 v117, 0, v117
    v_cvt_pk_bf16_f32 v118, 0, v118
    v_cvt_pk_bf16_f32 v119, 0, v119
    v_pk_add_f32 v[52:53], v[52:53], v[116:117]
    v_pk_add_f32 v[54:55], v[54:55], v[118:119]
    buffer_store_dwordx4 v[52:55], v25, s[12:15], s52 offen
    v_lshlrev_b32 v112, 16, v196
    v_and_b32 v113, 0xffff0000, v196
    v_lshlrev_b32 v114, 16, v197
    v_and_b32 v115, 0xffff0000, v197
    v_pk_mul_f32 v[112:113], v[112:113], v[40:41]
    v_pk_mul_f32 v[114:115], v[114:115], v[42:43]
    s_add_u32 s52, s51, 0x28000
    v_cvt_pk_bf16_f32 v112, 0, v112
    v_cvt_pk_bf16_f32 v113, 0, v113
    v_cvt_pk_bf16_f32 v114, 0, v114
    v_cvt_pk_bf16_f32 v115, 0, v115
    v_pk_add_f32 v[56:57], v[56:57], v[112:113]
    v_pk_add_f32 v[58:59], v[58:59], v[114:115]
    buffer_store_dwordx4 v[56:59], v25, s[12:15], s52 offen
    v_lshlrev_b32 v116, 16, v198
    v_and_b32 v117, 0xffff0000, v198
    v_lshlrev_b32 v118, 16, v199
    v_and_b32 v119, 0xffff0000, v199
    v_pk_mul_f32 v[116:117], v[116:117], v[40:41]
    v_pk_mul_f32 v[118:119], v[118:119], v[42:43]
    s_add_u32 s52, s51, 0x2c000
    v_cvt_pk_bf16_f32 v116, 0, v116
    v_cvt_pk_bf16_f32 v117, 0, v117
    v_cvt_pk_bf16_f32 v118, 0, v118
    v_cvt_pk_bf16_f32 v119, 0, v119
    v_pk_add_f32 v[60:61], v[60:61], v[116:117]
    v_pk_add_f32 v[62:63], v[62:63], v[118:119]
    buffer_store_dwordx4 v[60:63], v25, s[12:15], s52 offen
    v_lshlrev_b32 v112, 16, v200
    v_and_b32 v113, 0xffff0000, v200
    v_lshlrev_b32 v114, 16, v201
    v_and_b32 v115, 0xffff0000, v201
    v_pk_mul_f32 v[112:113], v[112:113], v[40:41]
    v_pk_mul_f32 v[114:115], v[114:115], v[42:43]
    s_add_u32 s52, s51, 0x60000
    v_cvt_pk_bf16_f32 v112, 0, v112
    v_cvt_pk_bf16_f32 v113, 0, v113
    v_cvt_pk_bf16_f32 v114, 0, v114
    v_cvt_pk_bf16_f32 v115, 0, v115
    v_pk_add_f32 v[64:65], v[64:65], v[112:113]
    v_pk_add_f32 v[66:67], v[66:67], v[114:115]
    buffer_store_dwordx4 v[64:67], v25, s[12:15], s52 offen
    v_lshlrev_b32 v116, 16, v202
    v_and_b32 v117, 0xffff0000, v202
    v_lshlrev_b32 v118, 16, v203
    v_and_b32 v119, 0xffff0000, v203
    v_pk_mul_f32 v[116:117], v[116:117], v[40:41]
    v_pk_mul_f32 v[118:119], v[118:119], v[42:43]
    s_add_u32 s52, s51, 0x64000
    v_cvt_pk_bf16_f32 v116, 0, v116
    v_cvt_pk_bf16_f32 v117, 0, v117
    v_cvt_pk_bf16_f32 v118, 0, v118
    v_cvt_pk_bf16_f32 v119, 0, v119
    v_pk_add_f32 v[68:69], v[68:69], v[116:117]
    v_pk_add_f32 v[70:71], v[70:71], v[118:119]
    buffer_store_dwordx4 v[68:71], v25, s[12:15], s52 offen
    v_lshlrev_b32 v112, 16, v204
    v_and_b32 v113, 0xffff0000, v204
    v_lshlrev_b32 v114, 16, v205
    v_and_b32 v115, 0xffff0000, v205
    v_pk_mul_f32 v[112:113], v[112:113], v[40:41]
    v_pk_mul_f32 v[114:115], v[114:115], v[42:43]
    s_add_u32 s52, s51, 0x68000
    v_cvt_pk_bf16_f32 v112, 0, v112
    v_cvt_pk_bf16_f32 v113, 0, v113
    v_cvt_pk_bf16_f32 v114, 0, v114
    v_cvt_pk_bf16_f32 v115, 0, v115
    v_pk_add_f32 v[72:73], v[72:73], v[112:113]
    v_pk_add_f32 v[74:75], v[74:75], v[114:115]
    buffer_store_dwordx4 v[72:75], v25, s[12:15], s52 offen
    v_lshlrev_b32 v116, 16, v206
    v_and_b32 v117, 0xffff0000, v206
    v_lshlrev_b32 v118, 16, v207
    v_and_b32 v119, 0xffff0000, v207
    v_pk_mul_f32 v[116:117], v[116:117], v[40:41]
    v_pk_mul_f32 v[118:119], v[118:119], v[42:43]
    s_add_u32 s52, s51, 0x6c000
    v_cvt_pk_bf16_f32 v116, 0, v116
    v_cvt_pk_bf16_f32 v117, 0, v117
    v_cvt_pk_bf16_f32 v118, 0, v118
    v_cvt_pk_bf16_f32 v119, 0, v119
    v_pk_add_f32 v[76:77], v[76:77], v[116:117]
    v_pk_add_f32 v[78:79], v[78:79], v[118:119]
    buffer_store_dwordx4 v[76:79], v25, s[12:15], s52 offen
    s_waitcnt vmcnt(40) lgkmcnt(8)
    ds_read_b128 v[48:51], v28 offset:16896
    ds_read_b128 v[52:55], v28 offset:17952
    ds_read_b128 v[56:59], v28 offset:19008
    ds_read_b128 v[60:63], v28 offset:20064
    ds_read_b128 v[64:67], v28 offset:21120
    ds_read_b128 v[68:71], v28 offset:22176
    ds_read_b128 v[72:75], v28 offset:23232
    ds_read_b128 v[76:79], v28 offset:24288
    ds_write_b128 v27, a[28:31] offset:25344
    ds_write_b128 v27, a[60:63] offset:25408
    ds_write_b128 v27, a[92:95] offset:25472
    ds_write_b128 v27, a[124:127] offset:25536
    ds_write_b128 v27, a[156:159] offset:25600
    ds_write_b128 v27, a[188:191] offset:25664
    ds_write_b128 v27, a[220:223] offset:25728
    ds_write_b128 v27, a[252:255] offset:25792
    v_lshlrev_b32 v112, 16, v208
    v_and_b32 v113, 0xffff0000, v208
    v_lshlrev_b32 v114, 16, v209
    v_and_b32 v115, 0xffff0000, v209
    v_pk_mul_f32 v[112:113], v[112:113], v[40:41]
    v_pk_mul_f32 v[114:115], v[114:115], v[42:43]
    s_add_u32 s52, s51, 0xa0000
    v_cvt_pk_bf16_f32 v112, 0, v112
    v_cvt_pk_bf16_f32 v113, 0, v113
    v_cvt_pk_bf16_f32 v114, 0, v114
    v_cvt_pk_bf16_f32 v115, 0, v115
    v_pk_add_f32 v[80:81], v[80:81], v[112:113]
    v_pk_add_f32 v[82:83], v[82:83], v[114:115]
    buffer_store_dwordx4 v[80:83], v25, s[12:15], s52 offen
    v_lshlrev_b32 v116, 16, v210
    v_and_b32 v117, 0xffff0000, v210
    v_lshlrev_b32 v118, 16, v211
    v_and_b32 v119, 0xffff0000, v211
    v_pk_mul_f32 v[116:117], v[116:117], v[40:41]
    v_pk_mul_f32 v[118:119], v[118:119], v[42:43]
    s_add_u32 s52, s51, 0xa4000
    v_cvt_pk_bf16_f32 v116, 0, v116
    v_cvt_pk_bf16_f32 v117, 0, v117
    v_cvt_pk_bf16_f32 v118, 0, v118
    v_cvt_pk_bf16_f32 v119, 0, v119
    v_pk_add_f32 v[84:85], v[84:85], v[116:117]
    v_pk_add_f32 v[86:87], v[86:87], v[118:119]
    buffer_store_dwordx4 v[84:87], v25, s[12:15], s52 offen
    v_lshlrev_b32 v112, 16, v212
    v_and_b32 v113, 0xffff0000, v212
    v_lshlrev_b32 v114, 16, v213
    v_and_b32 v115, 0xffff0000, v213
    v_pk_mul_f32 v[112:113], v[112:113], v[40:41]
    v_pk_mul_f32 v[114:115], v[114:115], v[42:43]
    s_add_u32 s52, s51, 0xa8000
    v_cvt_pk_bf16_f32 v112, 0, v112
    v_cvt_pk_bf16_f32 v113, 0, v113
    v_cvt_pk_bf16_f32 v114, 0, v114
    v_cvt_pk_bf16_f32 v115, 0, v115
    v_pk_add_f32 v[88:89], v[88:89], v[112:113]
    v_pk_add_f32 v[90:91], v[90:91], v[114:115]
    buffer_store_dwordx4 v[88:91], v25, s[12:15], s52 offen
    v_lshlrev_b32 v116, 16, v214
    v_and_b32 v117, 0xffff0000, v214
    v_lshlrev_b32 v118, 16, v215
    v_and_b32 v119, 0xffff0000, v215
    v_pk_mul_f32 v[116:117], v[116:117], v[40:41]
    v_pk_mul_f32 v[118:119], v[118:119], v[42:43]
    s_add_u32 s52, s51, 0xac000
    v_cvt_pk_bf16_f32 v116, 0, v116
    v_cvt_pk_bf16_f32 v117, 0, v117
    v_cvt_pk_bf16_f32 v118, 0, v118
    v_cvt_pk_bf16_f32 v119, 0, v119
    v_pk_add_f32 v[92:93], v[92:93], v[116:117]
    v_pk_add_f32 v[94:95], v[94:95], v[118:119]
    buffer_store_dwordx4 v[92:95], v25, s[12:15], s52 offen
    v_lshlrev_b32 v112, 16, v216
    v_and_b32 v113, 0xffff0000, v216
    v_lshlrev_b32 v114, 16, v217
    v_and_b32 v115, 0xffff0000, v217
    v_pk_mul_f32 v[112:113], v[112:113], v[40:41]
    v_pk_mul_f32 v[114:115], v[114:115], v[42:43]
    s_add_u32 s52, s51, 0xe0000
    v_cvt_pk_bf16_f32 v112, 0, v112
    v_cvt_pk_bf16_f32 v113, 0, v113
    v_cvt_pk_bf16_f32 v114, 0, v114
    v_cvt_pk_bf16_f32 v115, 0, v115
    v_pk_add_f32 v[96:97], v[96:97], v[112:113]
    v_pk_add_f32 v[98:99], v[98:99], v[114:115]
    buffer_store_dwordx4 v[96:99], v25, s[12:15], s52 offen
    v_lshlrev_b32 v116, 16, v218
    v_and_b32 v117, 0xffff0000, v218
    v_lshlrev_b32 v118, 16, v219
    v_and_b32 v119, 0xffff0000, v219
    v_pk_mul_f32 v[116:117], v[116:117], v[40:41]
    v_pk_mul_f32 v[118:119], v[118:119], v[42:43]
    s_add_u32 s52, s51, 0xe4000
    v_cvt_pk_bf16_f32 v116, 0, v116
    v_cvt_pk_bf16_f32 v117, 0, v117
    v_cvt_pk_bf16_f32 v118, 0, v118
    v_cvt_pk_bf16_f32 v119, 0, v119
    v_pk_add_f32 v[100:101], v[100:101], v[116:117]
    v_pk_add_f32 v[102:103], v[102:103], v[118:119]
    buffer_store_dwordx4 v[100:103], v25, s[12:15], s52 offen
    v_lshlrev_b32 v112, 16, v220
    v_and_b32 v113, 0xffff0000, v220
    v_lshlrev_b32 v114, 16, v221
    v_and_b32 v115, 0xffff0000, v221
    v_pk_mul_f32 v[112:113], v[112:113], v[40:41]
    v_pk_mul_f32 v[114:115], v[114:115], v[42:43]
    s_add_u32 s52, s51, 0xe8000
    v_cvt_pk_bf16_f32 v112, 0, v112
    v_cvt_pk_bf16_f32 v113, 0, v113
    v_cvt_pk_bf16_f32 v114, 0, v114
    v_cvt_pk_bf16_f32 v115, 0, v115
    v_pk_add_f32 v[104:105], v[104:105], v[112:113]
    v_pk_add_f32 v[106:107], v[106:107], v[114:115]
    buffer_store_dwordx4 v[104:107], v25, s[12:15], s52 offen
    v_lshlrev_b32 v116, 16, v222
    v_and_b32 v117, 0xffff0000, v222
    v_lshlrev_b32 v118, 16, v223
    v_and_b32 v119, 0xffff0000, v223
    v_pk_mul_f32 v[116:117], v[116:117], v[40:41]
    v_pk_mul_f32 v[118:119], v[118:119], v[42:43]
    s_add_u32 s52, s51, 0xec000
    v_cvt_pk_bf16_f32 v116, 0, v116
    v_cvt_pk_bf16_f32 v117, 0, v117
    v_cvt_pk_bf16_f32 v118, 0, v118
    v_cvt_pk_bf16_f32 v119, 0, v119
    v_pk_add_f32 v[108:109], v[108:109], v[116:117]
    v_pk_add_f32 v[110:111], v[110:111], v[118:119]
    buffer_store_dwordx4 v[108:111], v25, s[12:15], s52 offen
    s_waitcnt vmcnt(32) lgkmcnt(8)
    ds_read_b128 v[80:83], v28 offset:25344
    ds_read_b128 v[84:87], v28 offset:26400
    ds_read_b128 v[88:91], v28 offset:27456
    ds_read_b128 v[92:95], v28 offset:28512
    ds_read_b128 v[96:99], v28 offset:29568
    ds_read_b128 v[100:103], v28 offset:30624
    ds_read_b128 v[104:107], v28 offset:31680
    ds_read_b128 v[108:111], v28 offset:32736
    v_lshlrev_b32 v112, 16, v224
    v_and_b32 v113, 0xffff0000, v224
    v_lshlrev_b32 v114, 16, v225
    v_and_b32 v115, 0xffff0000, v225
    v_pk_mul_f32 v[112:113], v[112:113], v[40:41]
    v_pk_mul_f32 v[114:115], v[114:115], v[42:43]
    s_add_u32 s52, s51, 0x30000
    v_cvt_pk_bf16_f32 v112, 0, v112
    v_cvt_pk_bf16_f32 v113, 0, v113
    v_cvt_pk_bf16_f32 v114, 0, v114
    v_cvt_pk_bf16_f32 v115, 0, v115
    v_pk_add_f32 v[48:49], v[48:49], v[112:113]
    v_pk_add_f32 v[50:51], v[50:51], v[114:115]
    buffer_store_dwordx4 v[48:51], v25, s[12:15], s52 offen
    v_lshlrev_b32 v116, 16, v226
    v_and_b32 v117, 0xffff0000, v226
    v_lshlrev_b32 v118, 16, v227
    v_and_b32 v119, 0xffff0000, v227
    v_pk_mul_f32 v[116:117], v[116:117], v[40:41]
    v_pk_mul_f32 v[118:119], v[118:119], v[42:43]
    s_add_u32 s52, s51, 0x34000
    v_cvt_pk_bf16_f32 v116, 0, v116
    v_cvt_pk_bf16_f32 v117, 0, v117
    v_cvt_pk_bf16_f32 v118, 0, v118
    v_cvt_pk_bf16_f32 v119, 0, v119
    v_pk_add_f32 v[52:53], v[52:53], v[116:117]
    v_pk_add_f32 v[54:55], v[54:55], v[118:119]
    buffer_store_dwordx4 v[52:55], v25, s[12:15], s52 offen
    v_lshlrev_b32 v112, 16, v228
    v_and_b32 v113, 0xffff0000, v228
    v_lshlrev_b32 v114, 16, v229
    v_and_b32 v115, 0xffff0000, v229
    v_pk_mul_f32 v[112:113], v[112:113], v[40:41]
    v_pk_mul_f32 v[114:115], v[114:115], v[42:43]
    s_add_u32 s52, s51, 0x38000
    v_cvt_pk_bf16_f32 v112, 0, v112
    v_cvt_pk_bf16_f32 v113, 0, v113
    v_cvt_pk_bf16_f32 v114, 0, v114
    v_cvt_pk_bf16_f32 v115, 0, v115
    v_pk_add_f32 v[56:57], v[56:57], v[112:113]
    v_pk_add_f32 v[58:59], v[58:59], v[114:115]
    buffer_store_dwordx4 v[56:59], v25, s[12:15], s52 offen
    v_lshlrev_b32 v116, 16, v230
    v_and_b32 v117, 0xffff0000, v230
    v_lshlrev_b32 v118, 16, v231
    v_and_b32 v119, 0xffff0000, v231
    v_pk_mul_f32 v[116:117], v[116:117], v[40:41]
    v_pk_mul_f32 v[118:119], v[118:119], v[42:43]
    s_add_u32 s52, s51, 0x3c000
    v_cvt_pk_bf16_f32 v116, 0, v116
    v_cvt_pk_bf16_f32 v117, 0, v117
    v_cvt_pk_bf16_f32 v118, 0, v118
    v_cvt_pk_bf16_f32 v119, 0, v119
    v_pk_add_f32 v[60:61], v[60:61], v[116:117]
    v_pk_add_f32 v[62:63], v[62:63], v[118:119]
    buffer_store_dwordx4 v[60:63], v25, s[12:15], s52 offen
    v_lshlrev_b32 v112, 16, v232
    v_and_b32 v113, 0xffff0000, v232
    v_lshlrev_b32 v114, 16, v233
    v_and_b32 v115, 0xffff0000, v233
    v_pk_mul_f32 v[112:113], v[112:113], v[40:41]
    v_pk_mul_f32 v[114:115], v[114:115], v[42:43]
    s_add_u32 s52, s51, 0x70000
    v_cvt_pk_bf16_f32 v112, 0, v112
    v_cvt_pk_bf16_f32 v113, 0, v113
    v_cvt_pk_bf16_f32 v114, 0, v114
    v_cvt_pk_bf16_f32 v115, 0, v115
    v_pk_add_f32 v[64:65], v[64:65], v[112:113]
    v_pk_add_f32 v[66:67], v[66:67], v[114:115]
    buffer_store_dwordx4 v[64:67], v25, s[12:15], s52 offen
    v_lshlrev_b32 v116, 16, v234
    v_and_b32 v117, 0xffff0000, v234
    v_lshlrev_b32 v118, 16, v235
    v_and_b32 v119, 0xffff0000, v235
    v_pk_mul_f32 v[116:117], v[116:117], v[40:41]
    v_pk_mul_f32 v[118:119], v[118:119], v[42:43]
    s_add_u32 s52, s51, 0x74000
    v_cvt_pk_bf16_f32 v116, 0, v116
    v_cvt_pk_bf16_f32 v117, 0, v117
    v_cvt_pk_bf16_f32 v118, 0, v118
    v_cvt_pk_bf16_f32 v119, 0, v119
    v_pk_add_f32 v[68:69], v[68:69], v[116:117]
    v_pk_add_f32 v[70:71], v[70:71], v[118:119]
    buffer_store_dwordx4 v[68:71], v25, s[12:15], s52 offen
    v_lshlrev_b32 v112, 16, v236
    v_and_b32 v113, 0xffff0000, v236
    v_lshlrev_b32 v114, 16, v237
    v_and_b32 v115, 0xffff0000, v237
    v_pk_mul_f32 v[112:113], v[112:113], v[40:41]
    v_pk_mul_f32 v[114:115], v[114:115], v[42:43]
    s_add_u32 s52, s51, 0x78000
    v_cvt_pk_bf16_f32 v112, 0, v112
    v_cvt_pk_bf16_f32 v113, 0, v113
    v_cvt_pk_bf16_f32 v114, 0, v114
    v_cvt_pk_bf16_f32 v115, 0, v115
    v_pk_add_f32 v[72:73], v[72:73], v[112:113]
    v_pk_add_f32 v[74:75], v[74:75], v[114:115]
    buffer_store_dwordx4 v[72:75], v25, s[12:15], s52 offen
    v_lshlrev_b32 v116, 16, v238
    v_and_b32 v117, 0xffff0000, v238
    v_lshlrev_b32 v118, 16, v239
    v_and_b32 v119, 0xffff0000, v239
    v_pk_mul_f32 v[116:117], v[116:117], v[40:41]
    v_pk_mul_f32 v[118:119], v[118:119], v[42:43]
    s_add_u32 s52, s51, 0x7c000
    v_cvt_pk_bf16_f32 v116, 0, v116
    v_cvt_pk_bf16_f32 v117, 0, v117
    v_cvt_pk_bf16_f32 v118, 0, v118
    v_cvt_pk_bf16_f32 v119, 0, v119
    v_pk_add_f32 v[76:77], v[76:77], v[116:117]
    v_pk_add_f32 v[78:79], v[78:79], v[118:119]
    buffer_store_dwordx4 v[76:79], v25, s[12:15], s52 offen
    s_waitcnt vmcnt(24) lgkmcnt(0)
    v_lshlrev_b32 v112, 16, v240
    v_and_b32 v113, 0xffff0000, v240
    v_lshlrev_b32 v114, 16, v241
    v_and_b32 v115, 0xffff0000, v241
    v_pk_mul_f32 v[112:113], v[112:113], v[40:41]
    v_pk_mul_f32 v[114:115], v[114:115], v[42:43]
    s_add_u32 s52, s51, 0xb0000
    v_cvt_pk_bf16_f32 v112, 0, v112
    v_cvt_pk_bf16_f32 v113, 0, v113
    v_cvt_pk_bf16_f32 v114, 0, v114
    v_cvt_pk_bf16_f32 v115, 0, v115
    v_pk_add_f32 v[80:81], v[80:81], v[112:113]
    v_pk_add_f32 v[82:83], v[82:83], v[114:115]
    buffer_store_dwordx4 v[80:83], v25, s[12:15], s52 offen
    v_lshlrev_b32 v116, 16, v242
    v_and_b32 v117, 0xffff0000, v242
    v_lshlrev_b32 v118, 16, v243
    v_and_b32 v119, 0xffff0000, v243
    v_pk_mul_f32 v[116:117], v[116:117], v[40:41]
    v_pk_mul_f32 v[118:119], v[118:119], v[42:43]
    s_add_u32 s52, s51, 0xb4000
    v_cvt_pk_bf16_f32 v116, 0, v116
    v_cvt_pk_bf16_f32 v117, 0, v117
    v_cvt_pk_bf16_f32 v118, 0, v118
    v_cvt_pk_bf16_f32 v119, 0, v119
    v_pk_add_f32 v[84:85], v[84:85], v[116:117]
    v_pk_add_f32 v[86:87], v[86:87], v[118:119]
    buffer_store_dwordx4 v[84:87], v25, s[12:15], s52 offen
    v_lshlrev_b32 v112, 16, v244
    v_and_b32 v113, 0xffff0000, v244
    v_lshlrev_b32 v114, 16, v245
    v_and_b32 v115, 0xffff0000, v245
    v_pk_mul_f32 v[112:113], v[112:113], v[40:41]
    v_pk_mul_f32 v[114:115], v[114:115], v[42:43]
    s_add_u32 s52, s51, 0xb8000
    v_cvt_pk_bf16_f32 v112, 0, v112
    v_cvt_pk_bf16_f32 v113, 0, v113
    v_cvt_pk_bf16_f32 v114, 0, v114
    v_cvt_pk_bf16_f32 v115, 0, v115
    v_pk_add_f32 v[88:89], v[88:89], v[112:113]
    v_pk_add_f32 v[90:91], v[90:91], v[114:115]
    buffer_store_dwordx4 v[88:91], v25, s[12:15], s52 offen
    v_lshlrev_b32 v116, 16, v246
    v_and_b32 v117, 0xffff0000, v246
    v_lshlrev_b32 v118, 16, v247
    v_and_b32 v119, 0xffff0000, v247
    v_pk_mul_f32 v[116:117], v[116:117], v[40:41]
    v_pk_mul_f32 v[118:119], v[118:119], v[42:43]
    s_add_u32 s52, s51, 0xbc000
    v_cvt_pk_bf16_f32 v116, 0, v116
    v_cvt_pk_bf16_f32 v117, 0, v117
    v_cvt_pk_bf16_f32 v118, 0, v118
    v_cvt_pk_bf16_f32 v119, 0, v119
    v_pk_add_f32 v[92:93], v[92:93], v[116:117]
    v_pk_add_f32 v[94:95], v[94:95], v[118:119]
    buffer_store_dwordx4 v[92:95], v25, s[12:15], s52 offen
    v_lshlrev_b32 v112, 16, v248
    v_and_b32 v113, 0xffff0000, v248
    v_lshlrev_b32 v114, 16, v249
    v_and_b32 v115, 0xffff0000, v249
    v_pk_mul_f32 v[112:113], v[112:113], v[40:41]
    v_pk_mul_f32 v[114:115], v[114:115], v[42:43]
    s_add_u32 s52, s51, 0xf0000
    v_cvt_pk_bf16_f32 v112, 0, v112
    v_cvt_pk_bf16_f32 v113, 0, v113
    v_cvt_pk_bf16_f32 v114, 0, v114
    v_cvt_pk_bf16_f32 v115, 0, v115
    v_pk_add_f32 v[96:97], v[96:97], v[112:113]
    v_pk_add_f32 v[98:99], v[98:99], v[114:115]
    buffer_store_dwordx4 v[96:99], v25, s[12:15], s52 offen
    v_lshlrev_b32 v116, 16, v250
    v_and_b32 v117, 0xffff0000, v250
    v_lshlrev_b32 v118, 16, v251
    v_and_b32 v119, 0xffff0000, v251
    v_pk_mul_f32 v[116:117], v[116:117], v[40:41]
    v_pk_mul_f32 v[118:119], v[118:119], v[42:43]
    s_add_u32 s52, s51, 0xf4000
    v_cvt_pk_bf16_f32 v116, 0, v116
    v_cvt_pk_bf16_f32 v117, 0, v117
    v_cvt_pk_bf16_f32 v118, 0, v118
    v_cvt_pk_bf16_f32 v119, 0, v119
    v_pk_add_f32 v[100:101], v[100:101], v[116:117]
    v_pk_add_f32 v[102:103], v[102:103], v[118:119]
    buffer_store_dwordx4 v[100:103], v25, s[12:15], s52 offen
    v_lshlrev_b32 v112, 16, v252
    v_and_b32 v113, 0xffff0000, v252
    v_lshlrev_b32 v114, 16, v253
    v_and_b32 v115, 0xffff0000, v253
    v_pk_mul_f32 v[112:113], v[112:113], v[40:41]
    v_pk_mul_f32 v[114:115], v[114:115], v[42:43]
    s_add_u32 s52, s51, 0xf8000
    v_cvt_pk_bf16_f32 v112, 0, v112
    v_cvt_pk_bf16_f32 v113, 0, v113
    v_cvt_pk_bf16_f32 v114, 0, v114
    v_cvt_pk_bf16_f32 v115, 0, v115
    v_pk_add_f32 v[104:105], v[104:105], v[112:113]
    v_pk_add_f32 v[106:107], v[106:107], v[114:115]
    buffer_store_dwordx4 v[104:107], v25, s[12:15], s52 offen
    v_lshlrev_b32 v116, 16, v254
    v_and_b32 v117, 0xffff0000, v254
    v_lshlrev_b32 v118, 16, v255
    v_and_b32 v119, 0xffff0000, v255
    v_pk_mul_f32 v[116:117], v[116:117], v[40:41]
    v_pk_mul_f32 v[118:119], v[118:119], v[42:43]
    s_add_u32 s52, s51, 0xfc000
    v_cvt_pk_bf16_f32 v116, 0, v116
    v_cvt_pk_bf16_f32 v117, 0, v117
    v_cvt_pk_bf16_f32 v118, 0, v118
    v_cvt_pk_bf16_f32 v119, 0, v119
    v_pk_add_f32 v[108:109], v[108:109], v[116:117]
    v_pk_add_f32 v[110:111], v[110:111], v[118:119]
    buffer_store_dwordx4 v[108:111], v25, s[12:15], s52 offen
chain_kernel_seg:
    s_xor_b32 s57, s57, 2
    s_waitcnt vmcnt(0) lgkmcnt(0)
    s_barrier
    s_mov_b32 s12, s92
    s_and_b32 s13, s93, 0xffff
    s_mov_b32 s14, 0x800000
    s_mov_b32 s15, 0x00020000
    s_lshr_b32 s60, s57, 3
    s_lshl_b32 s28, s60, 21
    s_and_b32 s60, s57, 7
    s_lshl_b32 s60, s60, 8
    s_add_u32 s28, s28, s60
    v_bfe_u32 v24, v0, 4, 3
    v_lshlrev_b32 v24, 1, v24
    v_and_b32 v25, 15, v0
    v_xor_b32 v24, v24, v25
    v_lshlrev_b32 v6, 4, v24
    v_bfe_u32 v24, v0, 4, 2
    v_lshl_add_u32 v6, v24, 11, v6
    v_bfe_u32 v24, v0, 6, 1
    v_lshl_add_u32 v6, v24, 13, v6
    v_bfe_u32 v24, v0, 7, 1
    v_lshl_add_u32 v6, v24, 15, v6
    s_and_b32 s60, s58, 1
    s_lshl_b32 s61, s60, 11
    s_lshr_b32 s60, s58, 1
    s_lshl_b32 s60, s60, 10
    s_add_u32 s32, s60, s61
    s_add_u32 m0, s32, 0
    s_add_u32 s61, s28, 0x0
    buffer_load_dwordx4 v6, s[12:15], s61 offen nt lds
    s_add_u32 m0, s32, 4096
    s_add_u32 s61, s28, 0x4000
    buffer_load_dwordx4 v6, s[12:15], s61 offen nt lds
    s_add_u32 m0, s32, 8192
    s_add_u32 s61, s28, 0x10000
    buffer_load_dwordx4 v6, s[12:15], s61 offen nt lds
    s_add_u32 m0, s32, 12288
    s_add_u32 s61, s28, 0x14000
    buffer_load_dwordx4 v6, s[12:15], s61 offen nt lds
    s_add_u32 m0, s32, 16384
    s_add_u32 s61, s28, 0x20000
    buffer_load_dwordx4 v6, s[12:15], s61 offen nt lds
    s_add_u32 m0, s32, 20480
    s_add_u32 s61, s28, 0x24000
    buffer_load_dwordx4 v6, s[12:15], s61 offen nt lds
    s_add_u32 m0, s32, 24576
    s_add_u32 s61, s28, 0x30000
    buffer_load_dwordx4 v6, s[12:15], s61 offen nt lds
    s_add_u32 m0, s32, 28672
    s_add_u32 s61, s28, 0x34000
    buffer_load_dwordx4 v6, s[12:15], s61 offen nt lds
    s_mov_b32 s8, s100
    s_and_b32 s9, s101, 0xffff
    s_mov_b32 s10, 0xc000000
    s_mov_b32 s11, 0x00020000
    s_mov_b32 s16, s96
    s_and_b32 s17, s97, 0xffff
    s_mov_b32 s18, 0x1000000
    s_mov_b32 s19, 0x00020000
    v_and_b32 v24, 63, v0
    v_lshlrev_b32 v1, 4, v24
    v_add_u32 v2, 4096, v1
    v_lshlrev_b32 v10, 7, v24
    v_mov_b32 v11, 0
    s_lshl_b32 s60, s56, 8
    s_add_u32 s60, s60, 0xb200400
    s_lshl2_add_u32 s27, s57, s60
    s_and_b32 s38, s57, 7
    s_lshl_b32 s38, s38, 16
    s_cmp_eq_u32 s58, 0
    s_cselect_b32 s27, s27, 0xc000000
    s_cselect_b32 s38, s38, 0xc000000
    s_add_u32 s60, s60, s100
    s_addc_u32 s61, s101, 0
    v_and_b32 v25, 31, v0
    v_lshlrev_b32 v25, 2, v25
    v_add_u32 v16, s60, v25
    v_mov_b32 v17, s61
    s_add_u32 s60, s98, 208
    s_addc_u32 s61, s99, 0
    v_writelane_b32 v16, s60, 32
    v_writelane_b32 v17, s61, 32
    s_mov_b32 s26, 0
    s_mov_b32 s30, 0
    s_mov_b32 s40, 0
    s_mov_b32 s29, 32768
    v_and_b32 v24, 15, v0
    v_lshlrev_b32 v15, 13, v24
    v_bfe_u32 v24, v0, 4, 2
    v_lshl_add_u32 v15, v24, 4, v15
    s_lshr_b32 s60, s57, 4
    s_lshl_b32 s60, s60, 17
    s_and_b32 s61, s57, 7
    s_lshl_b32 s61, s61, 9
    s_add_u32 s60, s60, s61
    s_lshl_b32 s61, s58, 7
    s_add_u32 s60, s60, s61
    s_and_b32 s61, s57, 8
    s_lshl_b32 s61, s61, 3
    s_add_u32 s60, s60, s61
    s_add_u32 s60, s60, 4096
    v_add_u32 v15, s60, v15
    s_lshl_b32 s61, s58, 12
    s_xor_b32 s60, s57, 24
    s_lshl_b32 s60, s60, 14
    s_add_u32 s60, s60, s61
    s_add_u32 s60, s60, 0
    v_add_u32 v20, s60, v1
    s_xor_b32 s60, s57, 16
    s_lshl_b32 s60, s60, 14
    s_add_u32 s60, s60, s61
    s_add_u32 s60, s60, 1024
    v_add_u32 v21, s60, v1
    s_xor_b32 s60, s57, 8
    s_lshl_b32 s60, s60, 14
    s_add_u32 s60, s60, s61
    s_add_u32 s60, s60, 2048
    v_add_u32 v22, s60, v1
    s_xor_b32 s60, s57, 0
    s_lshl_b32 s60, s60, 14
    s_add_u32 s60, s60, s61
    s_add_u32 s60, s60, 0
    v_add_u32 v23, s60, v1
    s_lshl_b32 s24, s56, 20
    s_add_u32 s24, s24, 0xb800000
    s_and_b32 s60, s57, 24
    s_add_u32 s60, s60, s58
    s_lshl_b32 s31, s60, 16
    s_add_u32 s31, s31, 0xc000
    s_add_u32 s31, s31, s59
    s_mul_i32 s33, s56, 8
    s_lshr_b32 s33, 0x201000c, s33
    s_and_b32 s33, s33, 255
    s_mul_i32 s39, s56, 8
    s_lshr_b32 s39, 0xf0f0f0c, s39
    s_and_b32 s39, s39, 255
    s_cmp_eq_u32 s56, 0
    s_cmov_b32 s36, 0x3c
    s_cmp_eq_u32 s56, 1
    s_cmov_b32 s36, 0x3d39
    s_cmp_eq_u32 s56, 2
    s_cmov_b32 s36, 0x3e3a
    s_cmp_eq_u32 s56, 3
    s_cmov_b32 s36, 0x3f3b
    s_add_u32 m0, s32, 32768
    s_add_u32 s61, s28, 0x40000
    buffer_load_dwordx4 v6, s[12:15], s61 offen nt lds
    s_add_u32 m0, s32, 36864
    s_add_u32 s61, s28, 0x44000
    buffer_load_dwordx4 v6, s[12:15], s61 offen nt lds
    s_add_u32 m0, s32, 40960
    s_add_u32 s61, s28, 0x50000
    buffer_load_dwordx4 v6, s[12:15], s61 offen nt lds
    s_add_u32 m0, s32, 45056
    s_add_u32 s61, s28, 0x54000
    buffer_load_dwordx4 v6, s[12:15], s61 offen nt lds
    s_add_u32 m0, s32, 49152
    s_add_u32 s61, s28, 0x60000
    buffer_load_dwordx4 v6, s[12:15], s61 offen nt lds
    s_add_u32 m0, s32, 53248
    s_add_u32 s61, s28, 0x64000
    buffer_load_dwordx4 v6, s[12:15], s61 offen nt lds
    s_add_u32 m0, s32, 57344
    s_add_u32 s61, s28, 0x70000
    buffer_load_dwordx4 v6, s[12:15], s61 offen nt lds
    s_add_u32 m0, s32, 61440
    s_add_u32 s61, s28, 0x74000
    buffer_load_dwordx4 v6, s[12:15], s61 offen nt lds
    s_add_u32 m0, s32, 65536
    s_add_u32 s61, s28, 0x80000
    buffer_load_dwordx4 v6, s[12:15], s61 offen nt lds
    s_add_u32 m0, s32, 69632
    s_add_u32 s61, s28, 0x84000
    buffer_load_dwordx4 v6, s[12:15], s61 offen nt lds
    s_add_u32 m0, s32, 73728
    s_add_u32 s61, s28, 0x90000
    buffer_load_dwordx4 v6, s[12:15], s61 offen nt lds
    s_add_u32 m0, s32, 77824
    s_add_u32 s61, s28, 0x94000
    buffer_load_dwordx4 v6, s[12:15], s61 offen nt lds
    s_add_u32 m0, s32, 81920
    s_add_u32 s61, s28, 0xa0000
    buffer_load_dwordx4 v6, s[12:15], s61 offen nt lds
    s_add_u32 m0, s32, 86016
    s_add_u32 s61, s28, 0xa4000
    buffer_load_dwordx4 v6, s[12:15], s61 offen nt lds
    s_add_u32 m0, s32, 90112
    s_add_u32 s61, s28, 0xb0000
    buffer_load_dwordx4 v6, s[12:15], s61 offen nt lds
    s_add_u32 m0, s32, 94208
    s_add_u32 s61, s28, 0xb4000
    buffer_load_dwordx4 v6, s[12:15], s61 offen nt lds
    s_add_u32 m0, s32, 98304
    s_add_u32 s61, s28, 0xc0000
    buffer_load_dwordx4 v6, s[12:15], s61 offen nt lds
    s_add_u32 m0, s32, 102400
    s_add_u32 s61, s28, 0xc4000
    buffer_load_dwordx4 v6, s[12:15], s61 offen nt lds
    s_add_u32 m0, s32, 106496
    s_add_u32 s61, s28, 0xd0000
    buffer_load_dwordx4 v6, s[12:15], s61 offen nt lds
    s_add_u32 m0, s32, 110592
    s_add_u32 s61, s28, 0xd4000
    buffer_load_dwordx4 v6, s[12:15], s61 offen nt lds
    s_add_u32 m0, s32, 114688
    s_add_u32 s61, s28, 0xe0000
    buffer_load_dwordx4 v6, s[12:15], s61 offen nt lds
    s_add_u32 m0, s32, 118784
    s_add_u32 s61, s28, 0xe4000
    buffer_load_dwordx4 v6, s[12:15], s61 offen nt lds
    s_add_u32 m0, s32, 122880
    s_add_u32 s61, s28, 0xf0000
    buffer_load_dwordx4 v6, s[12:15], s61 offen nt lds
    s_add_u32 m0, s32, 126976
    s_add_u32 s61, s28, 0xf4000
    buffer_load_dwordx4 v6, s[12:15], s61 offen nt lds
    s_add_u32 m0, s32, 131072
    s_add_u32 s61, s28, 0x100000
    buffer_load_dwordx4 v6, s[12:15], s61 offen nt lds
    s_add_u32 m0, s32, 135168
    s_add_u32 s61, s28, 0x104000
    buffer_load_dwordx4 v6, s[12:15], s61 offen nt lds
    s_add_u32 m0, s32, 139264
    s_add_u32 s61, s28, 0x110000
    buffer_load_dwordx4 v6, s[12:15], s61 offen nt lds
    s_add_u32 m0, s32, 143360
    s_add_u32 s61, s28, 0x114000
    buffer_load_dwordx4 v6, s[12:15], s61 offen nt lds
    s_add_u32 m0, s32, 147456
    s_add_u32 s61, s28, 0x120000
    buffer_load_dwordx4 v6, s[12:15], s61 offen nt lds
    s_add_u32 m0, s32, 151552
    s_add_u32 s61, s28, 0x124000
    buffer_load_dwordx4 v6, s[12:15], s61 offen nt lds
    s_add_u32 m0, s32, 155648
    s_add_u32 s61, s28, 0x130000
    buffer_load_dwordx4 v6, s[12:15], s61 offen nt lds
    s_add_u32 m0, s32, 159744
    s_add_u32 s61, s28, 0x134000
    buffer_load_dwordx4 v6, s[12:15], s61 offen nt lds
    s_andn2_b32 s60, 8, s57
    s_lshl_b32 s60, s60, 2
    v_bfe_u32 v24, v0, 2, 3
    v_lshrrev_b32 v25, 6, v0
    v_lshlrev_b32 v25, 1, v25
    v_xor_b32 v24, v24, v25
    v_lshlrev_b32 v8, 5, v24
    v_bfe_u32 v24, v0, 0, 2
    v_lshl_add_u32 v8, v24, 3, v8
    v_bfe_u32 v24, v0, 2, 2
    v_lshl_add_u32 v8, v24, 8, v8
    v_bfe_u32 v24, v0, 4, 2
    v_lshl_add_u32 v8, v24, 11, v8
    v_xor_b32 v8, s60, v8
    v_xor_b32 v9, 32, v8
    s_waitcnt vmcnt(32)
    s_barrier
    ds_read_b64_tr_b16 a[0:1], v8 offset:0
    ds_read_b64_tr_b16 a[2:3], v8 offset:1024
    ds_read_b64_tr_b16 a[4:5], v9 offset:0
    ds_read_b64_tr_b16 a[6:7], v9 offset:1024
    ds_read_b64_tr_b16 a[8:9], v8 offset:8192
    ds_read_b64_tr_b16 a[10:11], v8 offset:9216
    ds_read_b64_tr_b16 a[12:13], v9 offset:8192
    ds_read_b64_tr_b16 a[14:15], v9 offset:9216
    s_waitcnt lgkmcnt(0)
    ds_read_b64_tr_b16 a[16:17], v8 offset:16384
    ds_read_b64_tr_b16 a[18:19], v8 offset:17408
    ds_read_b64_tr_b16 a[20:21], v9 offset:16384
    ds_read_b64_tr_b16 a[22:23], v9 offset:17408
    ds_read_b64_tr_b16 a[24:25], v8 offset:24576
    ds_read_b64_tr_b16 a[26:27], v8 offset:25600
    ds_read_b64_tr_b16 a[28:29], v9 offset:24576
    ds_read_b64_tr_b16 a[30:31], v9 offset:25600
    s_waitcnt lgkmcnt(0)
    s_waitcnt vmcnt(24)
    s_barrier
    s_add_u32 m0, s32, 0
    s_add_u32 s61, s28, 0x140000
    buffer_load_dwordx4 v6, s[12:15], s61 offen nt lds
    s_add_u32 m0, s32, 4096
    s_add_u32 s61, s28, 0x144000
    buffer_load_dwordx4 v6, s[12:15], s61 offen nt lds
    s_add_u32 m0, s32, 8192
    s_add_u32 s61, s28, 0x150000
    buffer_load_dwordx4 v6, s[12:15], s61 offen nt lds
    s_add_u32 m0, s32, 12288
    s_add_u32 s61, s28, 0x154000
    buffer_load_dwordx4 v6, s[12:15], s61 offen nt lds
    s_add_u32 m0, s32, 16384
    s_add_u32 s61, s28, 0x160000
    buffer_load_dwordx4 v6, s[12:15], s61 offen nt lds
    s_add_u32 m0, s32, 20480
    s_add_u32 s61, s28, 0x164000
    buffer_load_dwordx4 v6, s[12:15], s61 offen nt lds
    s_add_u32 m0, s32, 24576
    s_add_u32 s61, s28, 0x170000
    buffer_load_dwordx4 v6, s[12:15], s61 offen nt lds
    s_add_u32 m0, s32, 28672
    s_add_u32 s61, s28, 0x174000
    buffer_load_dwordx4 v6, s[12:15], s61 offen nt lds
    ds_read_b64_tr_b16 a[32:33], v8 offset:32768
    ds_read_b64_tr_b16 a[34:35], v8 offset:33792
    ds_read_b64_tr_b16 a[36:37], v9 offset:32768
    ds_read_b64_tr_b16 a[38:39], v9 offset:33792
    ds_read_b64_tr_b16 a[40:41], v8 offset:40960
    ds_read_b64_tr_b16 a[42:43], v8 offset:41984
    ds_read_b64_tr_b16 a[44:45], v9 offset:40960
    ds_read_b64_tr_b16 a[46:47], v9 offset:41984
    s_waitcnt lgkmcnt(0)
    ds_read_b64_tr_b16 a[48:49], v8 offset:49152
    ds_read_b64_tr_b16 a[50:51], v8 offset:50176
    ds_read_b64_tr_b16 a[52:53], v9 offset:49152
    ds_read_b64_tr_b16 a[54:55], v9 offset:50176
    ds_read_b64_tr_b16 a[56:57], v8 offset:57344
    ds_read_b64_tr_b16 a[58:59], v8 offset:58368
    ds_read_b64_tr_b16 a[60:61], v9 offset:57344
    ds_read_b64_tr_b16 a[62:63], v9 offset:58368
    s_waitcnt lgkmcnt(0)
    s_waitcnt vmcnt(24)
    s_barrier
    s_add_u32 m0, s32, 32768
    s_add_u32 s61, s28, 0x180000
    buffer_load_dwordx4 v6, s[12:15], s61 offen nt lds
    s_add_u32 m0, s32, 36864
    s_add_u32 s61, s28, 0x184000
    buffer_load_dwordx4 v6, s[12:15], s61 offen nt lds
    s_add_u32 m0, s32, 40960
    s_add_u32 s61, s28, 0x190000
    buffer_load_dwordx4 v6, s[12:15], s61 offen nt lds
    s_add_u32 m0, s32, 45056
    s_add_u32 s61, s28, 0x194000
    buffer_load_dwordx4 v6, s[12:15], s61 offen nt lds
    s_add_u32 m0, s32, 49152
    s_add_u32 s61, s28, 0x1a0000
    buffer_load_dwordx4 v6, s[12:15], s61 offen nt lds
    s_add_u32 m0, s32, 53248
    s_add_u32 s61, s28, 0x1a4000
    buffer_load_dwordx4 v6, s[12:15], s61 offen nt lds
    s_add_u32 m0, s32, 57344
    s_add_u32 s61, s28, 0x1b0000
    buffer_load_dwordx4 v6, s[12:15], s61 offen nt lds
    s_add_u32 m0, s32, 61440
    s_add_u32 s61, s28, 0x1b4000
    buffer_load_dwordx4 v6, s[12:15], s61 offen nt lds
    v_add_u32 v8, 0x10000, v8
    v_add_u32 v9, 0x10000, v9
    ds_read_b64_tr_b16 a[64:65], v8 offset:0
    ds_read_b64_tr_b16 a[66:67], v8 offset:1024
    ds_read_b64_tr_b16 a[68:69], v9 offset:0
    ds_read_b64_tr_b16 a[70:71], v9 offset:1024
    ds_read_b64_tr_b16 a[72:73], v8 offset:8192
    ds_read_b64_tr_b16 a[74:75], v8 offset:9216
    ds_read_b64_tr_b16 a[76:77], v9 offset:8192
    ds_read_b64_tr_b16 a[78:79], v9 offset:9216
    s_waitcnt lgkmcnt(0)
    ds_read_b64_tr_b16 a[80:81], v8 offset:16384
    ds_read_b64_tr_b16 a[82:83], v8 offset:17408
    ds_read_b64_tr_b16 a[84:85], v9 offset:16384
    ds_read_b64_tr_b16 a[86:87], v9 offset:17408
    ds_read_b64_tr_b16 a[88:89], v8 offset:24576
    ds_read_b64_tr_b16 a[90:91], v8 offset:25600
    ds_read_b64_tr_b16 a[92:93], v9 offset:24576
    ds_read_b64_tr_b16 a[94:95], v9 offset:25600
    s_waitcnt lgkmcnt(0)
    s_waitcnt vmcnt(24)
    s_barrier
    s_add_u32 m0, s32, 65536
    s_add_u32 s61, s28, 0x1c0000
    buffer_load_dwordx4 v6, s[12:15], s61 offen nt lds
    s_add_u32 m0, s32, 69632
    s_add_u32 s61, s28, 0x1c4000
    buffer_load_dwordx4 v6, s[12:15], s61 offen nt lds
    s_add_u32 m0, s32, 73728
    s_add_u32 s61, s28, 0x1d0000
    buffer_load_dwordx4 v6, s[12:15], s61 offen nt lds
    s_add_u32 m0, s32, 77824
    s_add_u32 s61, s28, 0x1d4000
    buffer_load_dwordx4 v6, s[12:15], s61 offen nt lds
    s_add_u32 m0, s32, 81920
    s_add_u32 s61, s28, 0x1e0000
    buffer_load_dwordx4 v6, s[12:15], s61 offen nt lds
    s_add_u32 m0, s32, 86016
    s_add_u32 s61, s28, 0x1e4000
    buffer_load_dwordx4 v6, s[12:15], s61 offen nt lds
    s_add_u32 m0, s32, 90112
    s_add_u32 s61, s28, 0x1f0000
    buffer_load_dwordx4 v6, s[12:15], s61 offen nt lds
    s_add_u32 m0, s32, 94208
    s_add_u32 s61, s28, 0x1f4000
    buffer_load_dwordx4 v6, s[12:15], s61 offen nt lds
    ds_read_b64_tr_b16 a[96:97], v8 offset:32768
    ds_read_b64_tr_b16 a[98:99], v8 offset:33792
    ds_read_b64_tr_b16 a[100:101], v9 offset:32768
    ds_read_b64_tr_b16 a[102:103], v9 offset:33792
    ds_read_b64_tr_b16 a[104:105], v8 offset:40960
    ds_read_b64_tr_b16 a[106:107], v8 offset:41984
    ds_read_b64_tr_b16 a[108:109], v9 offset:40960
    ds_read_b64_tr_b16 a[110:111], v9 offset:41984
    s_waitcnt lgkmcnt(0)
    ds_read_b64_tr_b16 a[112:113], v8 offset:49152
    ds_read_b64_tr_b16 a[114:115], v8 offset:50176
    ds_read_b64_tr_b16 a[116:117], v9 offset:49152
    ds_read_b64_tr_b16 a[118:119], v9 offset:50176
    ds_read_b64_tr_b16 a[120:121], v8 offset:57344
    ds_read_b64_tr_b16 a[122:123], v8 offset:58368
    ds_read_b64_tr_b16 a[124:125], v9 offset:57344
    ds_read_b64_tr_b16 a[126:127], v9 offset:58368
    s_waitcnt lgkmcnt(0)
    s_waitcnt vmcnt(24)
    s_barrier
    v_add_u32 v8, 0x10000, v8
    v_add_u32 v9, 0x10000, v9
    ds_read_b64_tr_b16 a[128:129], v8 offset:0
    ds_read_b64_tr_b16 a[130:131], v8 offset:1024
    ds_read_b64_tr_b16 a[132:133], v9 offset:0
    ds_read_b64_tr_b16 a[134:135], v9 offset:1024
    ds_read_b64_tr_b16 a[136:137], v8 offset:8192
    ds_read_b64_tr_b16 a[138:139], v8 offset:9216
    ds_read_b64_tr_b16 a[140:141], v9 offset:8192
    ds_read_b64_tr_b16 a[142:143], v9 offset:9216
    s_waitcnt lgkmcnt(0)
    ds_read_b64_tr_b16 a[144:145], v8 offset:16384
    ds_read_b64_tr_b16 a[146:147], v8 offset:17408
    ds_read_b64_tr_b16 a[148:149], v9 offset:16384
    ds_read_b64_tr_b16 a[150:151], v9 offset:17408
    ds_read_b64_tr_b16 a[152:153], v8 offset:24576
    ds_read_b64_tr_b16 a[154:155], v8 offset:25600
    ds_read_b64_tr_b16 a[156:157], v9 offset:24576
    ds_read_b64_tr_b16 a[158:159], v9 offset:25600
    s_waitcnt lgkmcnt(0)
    s_waitcnt vmcnt(16)
    s_barrier
    v_add_u32 v8, 0xfffe0000, v8
    v_add_u32 v9, 0xfffe0000, v9
    ds_read_b64_tr_b16 a[160:161], v8 offset:0
    ds_read_b64_tr_b16 a[162:163], v8 offset:1024
    ds_read_b64_tr_b16 a[164:165], v9 offset:0
    ds_read_b64_tr_b16 a[166:167], v9 offset:1024
    ds_read_b64_tr_b16 a[168:169], v8 offset:8192
    ds_read_b64_tr_b16 a[170:171], v8 offset:9216
    ds_read_b64_tr_b16 a[172:173], v9 offset:8192
    ds_read_b64_tr_b16 a[174:175], v9 offset:9216
    s_waitcnt lgkmcnt(0)
    ds_read_b64_tr_b16 a[176:177], v8 offset:16384
    ds_read_b64_tr_b16 a[178:179], v8 offset:17408
    ds_read_b64_tr_b16 a[180:181], v9 offset:16384
    ds_read_b64_tr_b16 a[182:183], v9 offset:17408
    ds_read_b64_tr_b16 a[184:185], v8 offset:24576
    ds_read_b64_tr_b16 a[186:187], v8 offset:25600
    ds_read_b64_tr_b16 a[188:189], v9 offset:24576
    ds_read_b64_tr_b16 a[190:191], v9 offset:25600
    s_waitcnt lgkmcnt(0)
    s_waitcnt vmcnt(8)
    s_barrier
    ds_read_b64_tr_b16 a[192:193], v8 offset:32768
    ds_read_b64_tr_b16 a[194:195], v8 offset:33792
    ds_read_b64_tr_b16 a[196:197], v9 offset:32768
    ds_read_b64_tr_b16 a[198:199], v9 offset:33792
    ds_read_b64_tr_b16 a[200:201], v8 offset:40960
    ds_read_b64_tr_b16 a[202:203], v8 offset:41984
    ds_read_b64_tr_b16 a[204:205], v9 offset:40960
    ds_read_b64_tr_b16 a[206:207], v9 offset:41984
    s_waitcnt lgkmcnt(0)
    ds_read_b64_tr_b16 a[208:209], v8 offset:49152
    ds_read_b64_tr_b16 a[210:211], v8 offset:50176
    ds_read_b64_tr_b16 a[212:213], v9 offset:49152
    ds_read_b64_tr_b16 a[214:215], v9 offset:50176
    ds_read_b64_tr_b16 a[216:217], v8 offset:57344
    ds_read_b64_tr_b16 a[218:219], v8 offset:58368
    ds_read_b64_tr_b16 a[220:221], v9 offset:57344
    ds_read_b64_tr_b16 a[222:223], v9 offset:58368
    s_waitcnt lgkmcnt(0)
    s_waitcnt vmcnt(0)
    s_barrier
    v_add_u32 v8, 0x10000, v8
    v_add_u32 v9, 0x10000, v9
    ds_read_b64_tr_b16 a[224:225], v8 offset:0
    ds_read_b64_tr_b16 a[226:227], v8 offset:1024
    ds_read_b64_tr_b16 a[228:229], v9 offset:0
    ds_read_b64_tr_b16 a[230:231], v9 offset:1024
    ds_read_b64_tr_b16 a[232:233], v8 offset:8192
    ds_read_b64_tr_b16 a[234:235], v8 offset:9216
    ds_read_b64_tr_b16 a[236:237], v9 offset:8192
    ds_read_b64_tr_b16 a[238:239], v9 offset:9216
    s_waitcnt lgkmcnt(0)
    ds_read_b64_tr_b16 a[240:241], v8 offset:16384
    ds_read_b64_tr_b16 a[242:243], v8 offset:17408
    ds_read_b64_tr_b16 a[244:245], v9 offset:16384
    ds_read_b64_tr_b16 a[246:247], v9 offset:17408
    ds_read_b64_tr_b16 a[248:249], v8 offset:24576
    ds_read_b64_tr_b16 a[250:251], v8 offset:25600
    ds_read_b64_tr_b16 a[252:253], v9 offset:24576
    ds_read_b64_tr_b16 a[254:255], v9 offset:25600
    s_waitcnt lgkmcnt(0)
    s_barrier
    s_cmp_eq_u32 s39, 0
    s_cbranch_scc1 seg_t0
    s_lshl_b32 s20, s58, 13
    s_mov_b32 s21, 0
    s_lshr_b32 s60, s57, 4
    s_lshl_b32 s60, s60, 12
    v_add_u32 v5, s60, v1
    v_xor_b32 v4, 4096, v5
    s_mul_i32 s35, s56, 8
    s_lshr_b32 s35, 0x37363538, s35
    s_and_b32 s35, s35, 255
    s_add_u32 s34, s33, 11
    s_mov_b32 s25, 0
    s_mov_b32 s42, 0
    s_mov_b32 s18, 0
    v_mov_b32 v18, s26
    v_writelane_b32 v18, s34, 32
    v_writelane_b32 v18, s40, 33
L_sp_57:
    global_load_dword v19, v[16:17], off sc1
    s_add_u32 s30, s30, 1
    s_cmp_gt_u32 s30, 0x200000
    s_cbranch_scc1 chain_kernel_wabort
    s_waitcnt vmcnt(0)
    v_cmp_lt_u32 vcc, v19, v18
    s_cbranch_vccz L_spok_58
    s_sleep 4
    s_branch L_sp_57
L_spok_58:
    s_cmp_lt_u32 s33, 9
    s_cselect_b32 s41, 3, 4
    s_add_u32 s41, s41, s33
    s_lshl_b32 s61, s33, 13
    s_and_b32 s61, s61, 0x2000
    s_xor_b32 s61, s61, s31
    s_lshl_b32 s23, s33, 21
    s_add_u32 s23, s23, s61
    s_cmp_gt_u32 s33, s35
    s_cselect_b32 s23, 0xc000000, s23
    s_add_u32 m0, s20, 0
    s_nop 0
    buffer_load_dwordx4 v1, s[8:11], s23 offen offset:0 lds
    buffer_load_dwordx4 v1, s[8:11], s23 offen offset:1024 lds
    buffer_load_dwordx4 v1, s[8:11], s23 offen offset:2048 lds
    buffer_load_dwordx4 v1, s[8:11], s23 offen offset:3072 lds
    s_add_u32 m0, s20, 4096
    s_nop 0
    buffer_load_dwordx4 v2, s[8:11], s23 offen offset:0 lds
    buffer_load_dwordx4 v2, s[8:11], s23 offen offset:1024 lds
    buffer_load_dwordx4 v2, s[8:11], s23 offen offset:2048 lds
    buffer_load_dwordx4 v2, s[8:11], s23 offen offset:3072 lds
    s_add_u32 s20, s20, 32768
    s_cmp_ge_u32 s20, 163840
    s_cselect_b32 s60, 163840, 0
    s_sub_u32 s20, s20, s60
    s_add_u32 s23, s23, 0x40000
    s_add_u32 m0, s20, 0
    s_nop 0
    buffer_load_dwordx4 v1, s[8:11], s23 offen offset:0 lds
    buffer_load_dwordx4 v1, s[8:11], s23 offen offset:1024 lds
    buffer_load_dwordx4 v1, s[8:11], s23 offen offset:2048 lds
    buffer_load_dwordx4 v1, s[8:11], s23 offen offset:3072 lds
    s_add_u32 m0, s20, 4096
    s_nop 0
    buffer_load_dwordx4 v2, s[8:11], s23 offen offset:0 lds
    buffer_load_dwordx4 v2, s[8:11], s23 offen offset:1024 lds
    buffer_load_dwordx4 v2, s[8:11], s23 offen offset:2048 lds
    buffer_load_dwordx4 v2, s[8:11], s23 offen offset:3072 lds
    s_add_u32 s20, s20, 32768
    s_cmp_ge_u32 s20, 163840
    s_cselect_b32 s60, 163840, 0
    s_sub_u32 s20, s20, s60
    s_lshl_b32 s42, s42, 8
    s_or_b32 s42, s42, s33
    s_mov_b32 s33, s41
    s_cmp_lt_u32 s33, 9
    s_cselect_b32 s41, 3, 4
    s_add_u32 s41, s41, s33
    s_lshl_b32 s61, s33, 13
    s_and_b32 s61, s61, 0x2000
    s_xor_b32 s61, s61, s31
    s_lshl_b32 s23, s33, 21
    s_add_u32 s23, s23, s61
    s_cmp_gt_u32 s33, s35
    s_cselect_b32 s23, 0xc000000, s23
    s_add_u32 m0, s20, 0
    s_nop 0
    buffer_load_dwordx4 v1, s[8:11], s23 offen offset:0 lds
    buffer_load_dwordx4 v1, s[8:11], s23 offen offset:1024 lds
    buffer_load_dwordx4 v1, s[8:11], s23 offen offset:2048 lds
    buffer_load_dwordx4 v1, s[8:11], s23 offen offset:3072 lds
    s_add_u32 m0, s20, 4096
    s_nop 0
    buffer_load_dwordx4 v2, s[8:11], s23 offen offset:0 lds
    buffer_load_dwordx4 v2, s[8:11], s23 offen offset:1024 lds
    buffer_load_dwordx4 v2, s[8:11], s23 offen offset:2048 lds
    buffer_load_dwordx4 v2, s[8:11], s23 offen offset:3072 lds
    s_add_u32 s20, s20, 32768
    s_cmp_ge_u32 s20, 163840
    s_cselect_b32 s60, 163840, 0
    s_sub_u32 s20, s20, s60
    s_add_u32 s23, s23, 0x40000
    s_mov_b32 s37, 0xc000000
    s_waitcnt vmcnt(8)
    s_barrier
    ds_read_b128 v[72:75], v4 offset:0
    ds_read_b128 v[76:79], v5 offset:0
    ds_read_b128 v[80:83], v4 offset:1024
    ds_read_b128 v[84:87], v5 offset:1024
    ds_read_b128 v[88:91], v4 offset:2048
    ds_read_b128 v[92:95], v5 offset:2048
seg_p:
    s_waitcnt lgkmcnt(4)
    v_mfma_f32_16x16x32_bf16 v[32:35], a[0:3], v[72:75], 0
    ds_read_b128 v[96:99], v4 offset:3072
    s_waitcnt vmcnt(4)
    v_mfma_f32_16x16x32_bf16 v[36:39], a[4:7], v[72:75], 0
    ds_read_b128 v[100:103], v5 offset:3072
    v_pk_add_f32 v[104:105], v[104:105], v[64:65]
    v_mfma_f32_16x16x32_bf16 v[44:47], a[4:7], v[76:79], 0
    v_pk_add_f32 v[106:107], v[106:107], v[66:67]
    s_xor_b32 s24, s24, 0x80000
    v_mfma_f32_16x16x32_bf16 v[40:43], a[0:3], v[76:79], 0
    buffer_store_dwordx4 v[48:51], v20, s[8:11], s24 offen
    s_waitcnt lgkmcnt(4)
    v_mfma_f32_16x16x32_bf16 v[32:35], a[8:11], v[80:83], v[32:35]
    ds_read_b128 v[72:75], v4 offset:8192
    v_mfma_f32_16x16x32_bf16 v[36:39], a[12:15], v[80:83], v[36:39]
    ds_read_b128 v[76:79], v5 offset:8192
    buffer_store_dwordx4 v[52:55], v21, s[8:11], s24 offen
    v_mfma_f32_16x16x32_bf16 v[44:47], a[12:15], v[84:87], v[44:47]
    v_mfma_f32_16x16x32_bf16 v[40:43], a[8:11], v[84:87], v[40:43]
    buffer_store_dwordx4 v[56:59], v22, s[8:11], s24 offen
    s_waitcnt lgkmcnt(4)
    v_mfma_f32_16x16x32_bf16 v[32:35], a[16:19], v[88:91], v[32:35]
    ds_read_b128 v[80:83], v4 offset:9216
    buffer_load_dword v13, v10, s[8:11], s37 offen
    v_mfma_f32_16x16x32_bf16 v[36:39], a[20:23], v[88:91], v[36:39]
    ds_read_b128 v[84:87], v5 offset:9216
    v_pk_add_f32 v[108:109], v[108:109], v[112:113]
    v_mfma_f32_16x16x32_bf16 v[44:47], a[20:23], v[92:95], v[44:47]
    v_pk_add_f32 v[110:111], v[110:111], v[114:115]
    v_pk_add_f32 v[104:105], v[104:105], v[108:109]
    v_mfma_f32_16x16x32_bf16 v[40:43], a[16:19], v[92:95], v[40:43]
    v_pk_add_f32 v[106:107], v[106:107], v[110:111]
    s_waitcnt lgkmcnt(4)
    v_mfma_f32_16x16x32_bf16 v[32:35], a[24:27], v[96:99], v[32:35]
    ds_read_b128 v[88:91], v4 offset:10240
    v_cvt_pk_bf16_f32 v104, 0, v104
    v_mfma_f32_16x16x32_bf16 v[36:39], a[28:31], v[96:99], v[36:39]
    ds_read_b128 v[92:95], v5 offset:10240
    v_cvt_pk_bf16_f32 v105, 0, v105
    v_mfma_f32_16x16x32_bf16 v[44:47], a[28:31], v[100:103], v[44:47]
    v_cvt_pk_bf16_f32 v106, 0, v106
    v_cvt_pk_bf16_f32 v107, 0, v107
    v_mfma_f32_16x16x32_bf16 v[40:43], a[24:27], v[100:103], v[40:43]
    buffer_store_dwordx4 v[104:107], v15, s[16:19], s25 offen
    s_waitcnt lgkmcnt(4)
    v_mfma_f32_16x16x32_bf16 v[32:35], a[32:35], v[72:75], v[32:35]
    ds_read_b128 v[96:99], v4 offset:11264
    v_mov_b32 v64, v60
    v_mfma_f32_16x16x32_bf16 v[36:39], a[36:39], v[72:75], v[36:39]
    ds_read_b128 v[100:103], v5 offset:11264
    v_mov_b32 v65, v61
    v_mfma_f32_16x16x32_bf16 v[44:47], a[36:39], v[76:79], v[44:47]
    v_mov_b32 v66, v62
    v_mov_b32 v67, v63
    v_mfma_f32_16x16x32_bf16 v[40:43], a[32:35], v[76:79], v[40:43]
    s_waitcnt lgkmcnt(4)
    v_mfma_f32_16x16x32_bf16 v[32:35], a[40:43], v[80:83], v[32:35]
    ds_read_b128 v[72:75], v4 offset:16384
    v_mfma_f32_16x16x32_bf16 v[36:39], a[44:47], v[80:83], v[36:39]
    ds_read_b128 v[76:79], v5 offset:16384
    v_mfma_f32_16x16x32_bf16 v[44:47], a[44:47], v[84:87], v[44:47]
    v_mfma_f32_16x16x32_bf16 v[40:43], a[40:43], v[84:87], v[40:43]
    s_waitcnt lgkmcnt(4)
    v_mfma_f32_16x16x32_bf16 v[32:35], a[48:51], v[88:91], v[32:35]
    ds_read_b128 v[80:83], v4 offset:17408
    s_lshl_b32 s42, s42, 8
    v_mfma_f32_16x16x32_bf16 v[36:39], a[52:55], v[88:91], v[36:39]
    ds_read_b128 v[84:87], v5 offset:17408
    s_or_b32 s42, s42, s33
    v_mfma_f32_16x16x32_bf16 v[44:47], a[52:55], v[92:95], v[44:47]
    s_mov_b32 s33, s41
    s_cmp_lt_u32 s33, 9
    v_mfma_f32_16x16x32_bf16 v[40:43], a[48:51], v[92:95], v[40:43]
    s_cselect_b32 s41, 3, 4
    s_waitcnt lgkmcnt(4)
    v_mfma_f32_16x16x32_bf16 v[32:35], a[56:59], v[96:99], v[32:35]
    ds_read_b128 v[88:91], v4 offset:18432
    s_add_u32 s41, s41, s33
    v_mfma_f32_16x16x32_bf16 v[36:39], a[60:63], v[96:99], v[36:39]
    ds_read_b128 v[92:95], v5 offset:18432
    s_cmp_ge_u32 s21, 131072
    v_mfma_f32_16x16x32_bf16 v[44:47], a[60:63], v[100:103], v[44:47]
    s_cselect_b32 s22, 0xfffe0000, s29
    s_add_u32 s21, s21, s22
    v_mfma_f32_16x16x32_bf16 v[40:43], a[56:59], v[100:103], v[40:43]
    s_min_u32 s34, s41, s35
    s_waitcnt lgkmcnt(4)
    v_mfma_f32_16x16x32_bf16 v[32:35], a[64:67], v[72:75], v[32:35]
    ds_read_b128 v[96:99], v4 offset:19456
    s_add_u32 s34, s34, 3
    v_mfma_f32_16x16x32_bf16 v[36:39], a[68:71], v[72:75], v[36:39]
    ds_read_b128 v[100:103], v5 offset:19456
    s_bfe_u32 s25, s42, 0x80010
    v_mfma_f32_16x16x32_bf16 v[44:47], a[68:71], v[76:79], v[44:47]
    s_lshl_b32 s25, s25, 18
    s_cmp_ge_u32 s26, 1
    v_mfma_f32_16x16x32_bf16 v[40:43], a[64:67], v[76:79], v[40:43]
    s_cselect_b32 s18, 0x1000000, 0
    s_waitcnt lgkmcnt(4)
    v_mfma_f32_16x16x32_bf16 v[32:35], a[72:75], v[80:83], v[32:35]
    ds_read_b128 v[72:75], v4 offset:24576
    v_mfma_f32_16x16x32_bf16 v[36:39], a[76:79], v[80:83], v[36:39]
    ds_read_b128 v[76:79], v5 offset:24576
    v_mfma_f32_16x16x32_bf16 v[44:47], a[76:79], v[84:87], v[44:47]
    v_mfma_f32_16x16x32_bf16 v[40:43], a[72:75], v[84:87], v[40:43]
    s_waitcnt lgkmcnt(4)
    v_mfma_f32_16x16x32_bf16 v[32:35], a[80:83], v[88:91], v[32:35]
    ds_read_b128 v[80:83], v4 offset:25600
    s_add_u32 m0, s20, 0
    v_mfma_f32_16x16x32_bf16 v[36:39], a[84:87], v[88:91], v[36:39]
    ds_read_b128 v[84:87], v5 offset:25600
    buffer_load_dwordx4 v1, s[8:11], s23 offen offset:0 lds
    v_mfma_f32_16x16x32_bf16 v[44:47], a[84:87], v[92:95], v[44:47]
    v_mfma_f32_16x16x32_bf16 v[40:43], a[80:83], v[92:95], v[40:43]
    s_waitcnt lgkmcnt(4)
    v_mfma_f32_16x16x32_bf16 v[32:35], a[88:91], v[96:99], v[32:35]
    ds_read_b128 v[88:91], v4 offset:26624
    v_mfma_f32_16x16x32_bf16 v[36:39], a[92:95], v[96:99], v[36:39]
    ds_read_b128 v[92:95], v5 offset:26624
    buffer_load_dwordx4 v1, s[8:11], s23 offen offset:1024 lds
    v_mfma_f32_16x16x32_bf16 v[44:47], a[92:95], v[100:103], v[44:47]
    v_mfma_f32_16x16x32_bf16 v[40:43], a[88:91], v[100:103], v[40:43]
    s_waitcnt lgkmcnt(4)
    v_mfma_f32_16x16x32_bf16 v[32:35], a[96:99], v[72:75], v[32:35]
    ds_read_b128 v[96:99], v4 offset:27648
    v_mfma_f32_16x16x32_bf16 v[36:39], a[100:103], v[72:75], v[36:39]
    ds_read_b128 v[100:103], v5 offset:27648
    v_mfma_f32_16x16x32_bf16 v[44:47], a[100:103], v[76:79], v[44:47]
    v_add_u32 v4, s22, v4
    v_add_u32 v5, s22, v5
    v_mfma_f32_16x16x32_bf16 v[40:43], a[96:99], v[76:79], v[40:43]
    buffer_load_dwordx4 v1, s[8:11], s23 offen offset:2048 lds
    s_waitcnt vmcnt(5)
    s_barrier
    s_waitcnt lgkmcnt(4)
    v_mfma_f32_16x16x32_bf16 v[32:35], a[104:107], v[80:83], v[32:35]
    ds_read_b128 v[72:75], v4 offset:0
    s_add_u32 s26, s26, 1
    v_mfma_f32_16x16x32_bf16 v[36:39], a[108:111], v[80:83], v[36:39]
    ds_read_b128 v[76:79], v5 offset:0
    v_mov_b32 v12, s26
    v_mfma_f32_16x16x32_bf16 v[44:47], a[108:111], v[84:87], v[44:47]
    buffer_store_dword v12, v11, s[8:11], s27 offen
    v_mfma_f32_16x16x32_bf16 v[40:43], a[104:107], v[84:87], v[40:43]
    buffer_load_dwordx4 v1, s[8:11], s23 offen offset:3072 lds
    s_waitcnt lgkmcnt(4)
    v_mfma_f32_16x16x32_bf16 v[32:35], a[112:115], v[88:91], v[32:35]
    ds_read_b128 v[80:83], v4 offset:1024
    v_mfma_f32_16x16x32_bf16 v[36:39], a[116:119], v[88:91], v[36:39]
    ds_read_b128 v[84:87], v5 offset:1024
    v_mov_b32 v18, s26
    v_mfma_f32_16x16x32_bf16 v[44:47], a[116:119], v[92:95], v[44:47]
    v_writelane_b32 v18, s34, 32
    v_writelane_b32 v18, s40, 33
    v_mfma_f32_16x16x32_bf16 v[40:43], a[112:115], v[92:95], v[40:43]
    s_waitcnt lgkmcnt(4)
    v_mfma_f32_16x16x32_bf16 v[32:35], a[120:123], v[96:99], v[32:35]
    ds_read_b128 v[88:91], v4 offset:2048
    s_add_u32 m0, s20, 4096
    v_mfma_f32_16x16x32_bf16 v[36:39], a[124:127], v[96:99], v[36:39]
    ds_read_b128 v[92:95], v5 offset:2048
    buffer_load_dwordx4 v2, s[8:11], s23 offen offset:0 lds
    v_mfma_f32_16x16x32_bf16 v[44:47], a[124:127], v[100:103], v[44:47]
    s_cmp_ge_u32 s21, 131072
    s_cselect_b32 s22, 0xfffe0000, s29
    v_mfma_f32_16x16x32_bf16 v[40:43], a[120:123], v[100:103], v[40:43]
    s_add_u32 s21, s21, s22
    s_waitcnt lgkmcnt(4)
    v_mfma_f32_16x16x32_bf16 v[32:35], a[128:131], v[72:75], v[32:35]
    ds_read_b128 v[96:99], v4 offset:3072
    s_lshl_b32 s61, s41, 13
    v_mfma_f32_16x16x32_bf16 v[36:39], a[132:135], v[72:75], v[36:39]
    ds_read_b128 v[100:103], v5 offset:3072
    s_and_b32 s61, s61, 0x2000
    v_mfma_f32_16x16x32_bf16 v[44:47], a[132:135], v[76:79], v[44:47]
    s_xor_b32 s61, s61, s31
    s_lshl_b32 s37, s41, 21
    v_mfma_f32_16x16x32_bf16 v[40:43], a[128:131], v[76:79], v[40:43]
    s_add_u32 s37, s37, s61
    s_waitcnt lgkmcnt(4)
    v_mfma_f32_16x16x32_bf16 v[32:35], a[136:139], v[80:83], v[32:35]
    ds_read_b128 v[72:75], v4 offset:8192
    s_cmp_gt_u32 s41, s35
    v_mfma_f32_16x16x32_bf16 v[36:39], a[140:143], v[80:83], v[36:39]
    ds_read_b128 v[76:79], v5 offset:8192
    s_cselect_b32 s37, 0xc000000, s37
    v_mfma_f32_16x16x32_bf16 v[44:47], a[140:143], v[84:87], v[44:47]
    s_add_u32 s37, s37, s38
    buffer_load_dwordx4 v2, s[8:11], s23 offen offset:1024 lds
    v_mfma_f32_16x16x32_bf16 v[40:43], a[136:139], v[84:87], v[40:43]
    buffer_load_dwordx4 v2, s[8:11], s23 offen offset:2048 lds
    s_waitcnt lgkmcnt(4)
    v_mfma_f32_16x16x32_bf16 v[32:35], a[144:147], v[88:91], v[32:35]
    ds_read_b128 v[80:83], v4 offset:9216
    global_load_dword v19, v[16:17], off sc1
    v_mfma_f32_16x16x32_bf16 v[36:39], a[148:151], v[88:91], v[36:39]
    ds_read_b128 v[84:87], v5 offset:9216
    v_mfma_f32_16x16x32_bf16 v[44:47], a[148:151], v[92:95], v[44:47]
    v_mfma_f32_16x16x32_bf16 v[40:43], a[144:147], v[92:95], v[40:43]
    buffer_load_dwordx4 v2, s[8:11], s23 offen offset:3072 lds
    s_waitcnt lgkmcnt(4)
    v_mfma_f32_16x16x32_bf16 v[32:35], a[152:155], v[96:99], v[32:35]
    ds_read_b128 v[88:91], v4 offset:10240
    s_add_u32 s20, s20, 32768
    v_mfma_f32_16x16x32_bf16 v[36:39], a[156:159], v[96:99], v[36:39]
    ds_read_b128 v[92:95], v5 offset:10240
    s_cmp_ge_u32 s20, 163840
    v_mfma_f32_16x16x32_bf16 v[44:47], a[156:159], v[100:103], v[44:47]
    s_cselect_b32 s60, 163840, 0
    s_sub_u32 s20, s20, s60
    v_mfma_f32_16x16x32_bf16 v[40:43], a[152:155], v[100:103], v[40:43]
    s_lshl_b32 s61, s33, 13
    s_waitcnt lgkmcnt(4)
    v_mfma_f32_16x16x32_bf16 v[32:35], a[160:163], v[72:75], v[32:35]
    ds_read_b128 v[96:99], v4 offset:11264
    s_and_b32 s61, s61, 0x2000
    v_mfma_f32_16x16x32_bf16 v[36:39], a[164:167], v[72:75], v[36:39]
    ds_read_b128 v[100:103], v5 offset:11264
    s_xor_b32 s61, s61, s31
    v_mfma_f32_16x16x32_bf16 v[44:47], a[164:167], v[76:79], v[44:47]
    s_lshl_b32 s23, s33, 21
    s_add_u32 s23, s23, s61
    v_mfma_f32_16x16x32_bf16 v[40:43], a[160:163], v[76:79], v[40:43]
    s_cmp_gt_u32 s33, s35
    s_waitcnt lgkmcnt(4)
    v_mfma_f32_16x16x32_bf16 v[32:35], a[168:171], v[80:83], v[32:35]
    ds_read_b128 v[72:75], v4 offset:16384
    s_cselect_b32 s23, 0xc000000, s23
    v_mfma_f32_16x16x32_bf16 v[36:39], a[172:175], v[80:83], v[36:39]
    ds_read_b128 v[76:79], v5 offset:16384
    s_add_u32 m0, s20, 0
    v_mfma_f32_16x16x32_bf16 v[44:47], a[172:175], v[84:87], v[44:47]
    buffer_load_dwordx4 v1, s[8:11], s23 offen offset:0 lds
    v_mfma_f32_16x16x32_bf16 v[40:43], a[168:171], v[84:87], v[40:43]
    buffer_load_dwordx4 v1, s[8:11], s23 offen offset:1024 lds
    s_waitcnt lgkmcnt(4)
    v_mfma_f32_16x16x32_bf16 v[32:35], a[176:179], v[88:91], v[32:35]
    ds_read_b128 v[80:83], v4 offset:17408
    v_mfma_f32_16x16x32_bf16 v[36:39], a[180:183], v[88:91], v[36:39]
    ds_read_b128 v[84:87], v5 offset:17408
    v_mfma_f32_16x16x32_bf16 v[44:47], a[180:183], v[92:95], v[44:47]
    buffer_load_dwordx4 v1, s[8:11], s23 offen offset:2048 lds
    v_mfma_f32_16x16x32_bf16 v[40:43], a[176:179], v[92:95], v[40:43]
    s_waitcnt lgkmcnt(4)
    v_mfma_f32_16x16x32_bf16 v[32:35], a[184:187], v[96:99], v[32:35]
    ds_read_b128 v[88:91], v4 offset:18432
    v_mfma_f32_16x16x32_bf16 v[36:39], a[188:191], v[96:99], v[36:39]
    ds_read_b128 v[92:95], v5 offset:18432
    v_mfma_f32_16x16x32_bf16 v[44:47], a[188:191], v[100:103], v[44:47]
    v_mfma_f32_16x16x32_bf16 v[40:43], a[184:187], v[100:103], v[40:43]
    buffer_load_dwordx4 v1, s[8:11], s23 offen offset:3072 lds
    s_waitcnt lgkmcnt(4)
    v_mfma_f32_16x16x32_bf16 v[32:35], a[192:195], v[72:75], v[32:35]
    ds_read_b128 v[96:99], v4 offset:19456
    s_waitcnt vmcnt(5)
    v_cmp_lt_u32 vcc, v19, v18
    v_mfma_f32_16x16x32_bf16 v[36:39], a[196:199], v[72:75], v[36:39]
    ds_read_b128 v[100:103], v5 offset:19456
    v_mfma_f32_16x16x32_bf16 v[44:47], a[196:199], v[76:79], v[44:47]
    v_mfma_f32_16x16x32_bf16 v[40:43], a[192:195], v[76:79], v[40:43]
    s_cbranch_vccnz seg_pslow
seg_pok:
    s_waitcnt lgkmcnt(4)
    v_mfma_f32_16x16x32_bf16 v[32:35], a[200:203], v[80:83], v[32:35]
    ds_read_b128 v[72:75], v4 offset:24576
    buffer_load_dwordx4 v[104:107], v23, s[8:11], s24 offen offset:0 sc1
    v_mfma_f32_16x16x32_bf16 v[36:39], a[204:207], v[80:83], v[36:39]
    ds_read_b128 v[76:79], v5 offset:24576
    buffer_load_dwordx4 v[108:111], v23, s[8:11], s24 offen offset:1024 sc1
    v_mfma_f32_16x16x32_bf16 v[44:47], a[204:207], v[84:87], v[44:47]
    buffer_load_dwordx4 v[112:115], v23, s[8:11], s24 offen offset:2048 sc1
    v_mfma_f32_16x16x32_bf16 v[40:43], a[200:203], v[84:87], v[40:43]
    s_add_u32 m0, s20, 4096
    s_waitcnt lgkmcnt(4)
    v_mfma_f32_16x16x32_bf16 v[32:35], a[208:211], v[88:91], v[32:35]
    ds_read_b128 v[80:83], v4 offset:25600
    buffer_load_dwordx4 v2, s[8:11], s23 offen offset:0 lds
    v_mfma_f32_16x16x32_bf16 v[36:39], a[212:215], v[88:91], v[36:39]
    ds_read_b128 v[84:87], v5 offset:25600
    buffer_load_dwordx4 v2, s[8:11], s23 offen offset:1024 lds
    v_mfma_f32_16x16x32_bf16 v[44:47], a[212:215], v[92:95], v[44:47]
    v_mfma_f32_16x16x32_bf16 v[40:43], a[208:211], v[92:95], v[40:43]
    s_waitcnt lgkmcnt(4)
    v_mfma_f32_16x16x32_bf16 v[32:35], a[216:219], v[96:99], v[32:35]
    ds_read_b128 v[88:91], v4 offset:26624
    v_mfma_f32_16x16x32_bf16 v[36:39], a[220:223], v[96:99], v[36:39]
    ds_read_b128 v[92:95], v5 offset:26624
    v_mfma_f32_16x16x32_bf16 v[44:47], a[220:223], v[100:103], v[44:47]
    buffer_load_dwordx4 v2, s[8:11], s23 offen offset:2048 lds
    v_mfma_f32_16x16x32_bf16 v[40:43], a[216:219], v[100:103], v[40:43]
    s_waitcnt lgkmcnt(4)
    v_mfma_f32_16x16x32_bf16 v[32:35], a[224:227], v[72:75], v[32:35]
    ds_read_b128 v[96:99], v4 offset:27648
    v_mfma_f32_16x16x32_bf16 v[36:39], a[228:231], v[72:75], v[36:39]
    ds_read_b128 v[100:103], v5 offset:27648
    v_mfma_f32_16x16x32_bf16 v[44:47], a[228:231], v[76:79], v[44:47]
    v_add_u32 v4, s22, v4
    v_add_u32 v5, s22, v5
    v_mfma_f32_16x16x32_bf16 v[40:43], a[224:227], v[76:79], v[40:43]
    buffer_load_dwordx4 v2, s[8:11], s23 offen offset:3072 lds
    s_waitcnt vmcnt(26)
    s_barrier
    s_waitcnt lgkmcnt(4)
    v_mfma_f32_16x16x32_bf16 v[32:35], a[232:235], v[80:83], v[32:35]
    ds_read_b128 v[72:75], v4 offset:0
    s_add_u32 s20, s20, 32768
    s_cmp_ge_u32 s20, 163840
    v_mfma_f32_16x16x32_bf16 v[36:39], a[236:239], v[80:83], v[36:39]
    ds_read_b128 v[76:79], v5 offset:0
    s_cselect_b32 s60, 163840, 0
    s_sub_u32 s20, s20, s60
    v_mfma_f32_16x16x32_bf16 v[44:47], a[236:239], v[84:87], v[44:47]
    s_add_u32 s23, s23, 0x40000
    v_mfma_f32_16x16x32_bf16 v[40:43], a[232:235], v[84:87], v[40:43]
    s_waitcnt lgkmcnt(4)
    v_mfma_f32_16x16x32_bf16 v[32:35], a[240:243], v[88:91], v[32:35]
    ds_read_b128 v[80:83], v4 offset:1024
    v_mfma_f32_16x16x32_bf16 v[36:39], a[244:247], v[88:91], v[36:39]
    ds_read_b128 v[84:87], v5 offset:1024
    v_mfma_f32_16x16x32_bf16 v[44:47], a[244:247], v[92:95], v[44:47]
    v_mfma_f32_16x16x32_bf16 v[40:43], a[240:243], v[92:95], v[40:43]
    s_waitcnt lgkmcnt(4)
    v_mfma_f32_16x16x32_bf16 v[48:51], a[248:251], v[96:99], v[32:35]
    ds_read_b128 v[88:91], v4 offset:2048
    v_mfma_f32_16x16x32_bf16 v[52:55], a[252:255], v[96:99], v[36:39]
    ds_read_b128 v[92:95], v5 offset:2048
    v_mfma_f32_16x16x32_bf16 v[60:63], a[252:255], v[100:103], v[44:47]
    s_cmp_lt_u32 s26, s39
    v_mfma_f32_16x16x32_bf16 v[56:59], a[248:251], v[100:103], v[40:43]
    s_cbranch_scc1 seg_p
    s_xor_b32 s24, s24, 0x80000
    s_waitcnt vmcnt(0)
    v_pk_add_f32 v[104:105], v[104:105], v[64:65]
    v_pk_add_f32 v[106:107], v[106:107], v[66:67]
    v_pk_add_f32 v[108:109], v[108:109], v[112:113]
    v_pk_add_f32 v[110:111], v[110:111], v[114:115]
    v_pk_add_f32 v[104:105], v[104:105], v[108:109]
    v_pk_add_f32 v[106:107], v[106:107], v[110:111]
    v_cvt_pk_bf16_f32 v104, 0, v104
    v_cvt_pk_bf16_f32 v105, 0, v105
    v_cvt_pk_bf16_f32 v106, 0, v106
    v_cvt_pk_bf16_f32 v107, 0, v107
    buffer_store_dwordx4 v[104:107], v15, s[16:19], s25 offen
    buffer_store_dwordx4 v[48:51], v20, s[8:11], s24 offen
    buffer_store_dwordx4 v[52:55], v21, s[8:11], s24 offen
    buffer_store_dwordx4 v[56:59], v22, s[8:11], s24 offen
    s_lshl_b32 s25, s35, 18
    s_waitcnt vmcnt(0)
    s_barrier
    s_add_u32 s26, s26, 1
    v_mov_b32 v12, s26
    buffer_store_dword v12, v11, s[8:11], s27 offen
    v_mov_b32 v18, s26
    v_writelane_b32 v18, s34, 32
    v_writelane_b32 v18, s40, 33
L_sp_59:
    global_load_dword v19, v[16:17], off sc1
    s_add_u32 s30, s30, 1
    s_cmp_gt_u32 s30, 0x200000
    s_cbranch_scc1 chain_kernel_wabort
    s_waitcnt vmcnt(0)
    v_cmp_lt_u32 vcc, v19, v18
    s_cbranch_vccz L_spok_60
    s_branch L_sp_59
L_spok_60:
    buffer_load_dwordx4 v[104:107], v23, s[8:11], s24 offen offset:0 sc1
    buffer_load_dwordx4 v[108:111], v23, s[8:11], s24 offen offset:1024 sc1
    buffer_load_dwordx4 v[112:115], v23, s[8:11], s24 offen offset:2048 sc1
    s_waitcnt vmcnt(0) lgkmcnt(0)
    v_pk_add_f32 v[104:105], v[104:105], v[60:61]
    v_pk_add_f32 v[106:107], v[106:107], v[62:63]
    v_pk_add_f32 v[108:109], v[108:109], v[112:113]
    v_pk_add_f32 v[110:111], v[110:111], v[114:115]
    v_pk_add_f32 v[104:105], v[104:105], v[108:109]
    v_pk_add_f32 v[106:107], v[106:107], v[110:111]
    v_cvt_pk_bf16_f32 v104, 0, v104
    v_cvt_pk_bf16_f32 v105, 0, v105
    v_cvt_pk_bf16_f32 v106, 0, v106
    v_cvt_pk_bf16_f32 v107, 0, v107
    buffer_store_dwordx4 v[104:107], v15, s[16:19], s25 offen
seg_t0:
    s_mov_b32 s35, 63
    s_lshr_b32 s60, s57, 3
    s_lshl_b32 s60, s60, 8
    s_add_u32 s60, s60, 0xb201000
    s_add_u32 s37, s60, s100
    s_addc_u32 s38, s101, 0
seg_t:
    s_and_b32 s33, s36, 0xff
    s_cbranch_scc0 seg_end
    s_lshr_b32 s36, s36, 8
    s_lshl_b32 s20, s58, 13
    s_mov_b32 s21, 0
    s_lshr_b32 s60, s57, 4
    s_lshl_b32 s60, s60, 12
    v_add_u32 v5, s60, v1
    v_xor_b32 v4, 4096, v5
    s_lshl_b32 s61, s33, 13
    s_and_b32 s61, s61, 0x2000
    s_xor_b32 s61, s61, s31
    s_lshl_b32 s23, s33, 21
    s_add_u32 s23, s23, s61
    s_cmp_gt_u32 s33, s35
    s_cselect_b32 s23, 0xc000000, s23
    s_xor_b32 s24, s24, 0x80000
    s_lshl_b32 s25, s33, 18
    s_add_u32 s34, s33, 3
    s_min_u32 s34, s34, 64
    v_mov_b32 v18, s26
    v_writelane_b32 v18, s34, 32
    v_writelane_b32 v18, s40, 33
L_sp_61:
    global_load_dword v19, v[16:17], off sc1
    s_add_u32 s30, s30, 1
    s_cmp_gt_u32 s30, 0x200000
    s_cbranch_scc1 chain_kernel_wabort
    s_waitcnt vmcnt(0)
    v_cmp_lt_u32 vcc, v19, v18
    s_cbranch_vccz L_spok_62
    s_sleep 2
    s_branch L_sp_61
L_spok_62:
    s_cmp_lt_u32 s33, 62
    s_cbranch_scc1 L_tf_63
    v_writelane_b32 v16, s37, 33
    v_writelane_b32 v17, s38, 33
    s_mov_b32 s40, 32
    v_mov_b32 v18, s26
    v_writelane_b32 v18, s34, 32
    v_writelane_b32 v18, s40, 33
L_sp_64:
    global_load_dword v19, v[16:17], off sc1
    s_add_u32 s30, s30, 1
    s_cmp_gt_u32 s30, 0x200000
    s_cbranch_scc1 chain_kernel_wabort
    s_waitcnt vmcnt(0)
    v_cmp_lt_u32 vcc, v19, v18
    s_cbranch_vccz L_spok_65
    s_branch L_sp_64
L_spok_65:
L_tf_63:
    s_add_u32 m0, s20, 0
    s_nop 0
    buffer_load_dwordx4 v1, s[8:11], s23 offen offset:0 lds
    buffer_load_dwordx4 v1, s[8:11], s23 offen offset:1024 lds
    buffer_load_dwordx4 v1, s[8:11], s23 offen offset:2048 lds
    buffer_load_dwordx4 v1, s[8:11], s23 offen offset:3072 lds
    s_add_u32 m0, s20, 4096
    s_nop 0
    buffer_load_dwordx4 v2, s[8:11], s23 offen offset:0 lds
    buffer_load_dwordx4 v2, s[8:11], s23 offen offset:1024 lds
    buffer_load_dwordx4 v2, s[8:11], s23 offen offset:2048 lds
    buffer_load_dwordx4 v2, s[8:11], s23 offen offset:3072 lds
    s_add_u32 s20, s20, 32768
    s_cmp_ge_u32 s20, 163840
    s_cselect_b32 s60, 163840, 0
    s_sub_u32 s20, s20, s60
    s_add_u32 s23, s23, 0x40000
    s_add_u32 m0, s20, 0
    s_nop 0
    buffer_load_dwordx4 v1, s[8:11], s23 offen offset:0 lds
    buffer_load_dwordx4 v1, s[8:11], s23 offen offset:1024 lds
    buffer_load_dwordx4 v1, s[8:11], s23 offen offset:2048 lds
    buffer_load_dwordx4 v1, s[8:11], s23 offen offset:3072 lds
    s_add_u32 m0, s20, 4096
    s_nop 0
    buffer_load_dwordx4 v2, s[8:11], s23 offen offset:0 lds
    buffer_load_dwordx4 v2, s[8:11], s23 offen offset:1024 lds
    buffer_load_dwordx4 v2, s[8:11], s23 offen offset:2048 lds
    buffer_load_dwordx4 v2, s[8:11], s23 offen offset:3072 lds
    s_waitcnt vmcnt(8)
    s_barrier
    ds_read_b128 v[72:75], v4 offset:0
    ds_read_b128 v[76:79], v5 offset:0
    ds_read_b128 v[80:83], v4 offset:1024
    ds_read_b128 v[84:87], v5 offset:1024
    ds_read_b128 v[88:91], v4 offset:2048
    ds_read_b128 v[92:95], v5 offset:2048
    s_waitcnt lgkmcnt(4)
    v_mfma_f32_16x16x32_bf16 v[32:35], a[0:3], v[72:75], 0
    ds_read_b128 v[96:99], v4 offset:3072
    v_mfma_f32_16x16x32_bf16 v[36:39], a[4:7], v[72:75], 0
    ds_read_b128 v[100:103], v5 offset:3072
    v_mfma_f32_16x16x32_bf16 v[44:47], a[4:7], v[76:79], 0
    v_mfma_f32_16x16x32_bf16 v[40:43], a[0:3], v[76:79], 0
    s_waitcnt lgkmcnt(4)
    v_mfma_f32_16x16x32_bf16 v[32:35], a[8:11], v[80:83], v[32:35]
    ds_read_b128 v[72:75], v4 offset:8192
    v_mfma_f32_16x16x32_bf16 v[36:39], a[12:15], v[80:83], v[36:39]
    ds_read_b128 v[76:79], v5 offset:8192
    v_mfma_f32_16x16x32_bf16 v[44:47], a[12:15], v[84:87], v[44:47]
    v_mfma_f32_16x16x32_bf16 v[40:43], a[8:11], v[84:87], v[40:43]
    s_waitcnt lgkmcnt(4)
    v_mfma_f32_16x16x32_bf16 v[32:35], a[16:19], v[88:91], v[32:35]
    ds_read_b128 v[80:83], v4 offset:9216
    v_mfma_f32_16x16x32_bf16 v[36:39], a[20:23], v[88:91], v[36:39]
    ds_read_b128 v[84:87], v5 offset:9216
    v_mfma_f32_16x16x32_bf16 v[44:47], a[20:23], v[92:95], v[44:47]
    v_mfma_f32_16x16x32_bf16 v[40:43], a[16:19], v[92:95], v[40:43]
    s_waitcnt lgkmcnt(4)
    v_mfma_f32_16x16x32_bf16 v[32:35], a[24:27], v[96:99], v[32:35]
    ds_read_b128 v[88:91], v4 offset:10240
    v_mfma_f32_16x16x32_bf16 v[36:39], a[28:31], v[96:99], v[36:39]
    ds_read_b128 v[92:95], v5 offset:10240
    v_mfma_f32_16x16x32_bf16 v[44:47], a[28:31], v[100:103], v[44:47]
    v_mfma_f32_16x16x32_bf16 v[40:43], a[24:27], v[100:103], v[40:43]
    s_waitcnt lgkmcnt(4)
    v_mfma_f32_16x16x32_bf16 v[32:35], a[32:35], v[72:75], v[32:35]
    ds_read_b128 v[96:99], v4 offset:11264
    v_mfma_f32_16x16x32_bf16 v[36:39], a[36:39], v[72:75], v[36:39]
    ds_read_b128 v[100:103], v5 offset:11264
    v_mfma_f32_16x16x32_bf16 v[44:47], a[36:39], v[76:79], v[44:47]
    v_mfma_f32_16x16x32_bf16 v[40:43], a[32:35], v[76:79], v[40:43]
    s_waitcnt lgkmcnt(4)
    v_mfma_f32_16x16x32_bf16 v[32:35], a[40:43], v[80:83], v[32:35]
    ds_read_b128 v[72:75], v4 offset:16384
    v_mfma_f32_16x16x32_bf16 v[36:39], a[44:47], v[80:83], v[36:39]
    ds_read_b128 v[76:79], v5 offset:16384
    v_mfma_f32_16x16x32_bf16 v[44:47], a[44:47], v[84:87], v[44:47]
    v_mfma_f32_16x16x32_bf16 v[40:43], a[40:43], v[84:87], v[40:43]
    s_waitcnt lgkmcnt(4)
    v_mfma_f32_16x16x32_bf16 v[32:35], a[48:51], v[88:91], v[32:35]
    ds_read_b128 v[80:83], v4 offset:17408
    v_mfma_f32_16x16x32_bf16 v[36:39], a[52:55], v[88:91], v[36:39]
    ds_read_b128 v[84:87], v5 offset:17408
    v_mfma_f32_16x16x32_bf16 v[44:47], a[52:55], v[92:95], v[44:47]
    v_mfma_f32_16x16x32_bf16 v[40:43], a[48:51], v[92:95], v[40:43]
    s_waitcnt lgkmcnt(4)
    v_mfma_f32_16x16x32_bf16 v[32:35], a[56:59], v[96:99], v[32:35]
    ds_read_b128 v[88:91], v4 offset:18432
    v_mfma_f32_16x16x32_bf16 v[36:39], a[60:63], v[96:99], v[36:39]
    ds_read_b128 v[92:95], v5 offset:18432
    v_mfma_f32_16x16x32_bf16 v[44:47], a[60:63], v[100:103], v[44:47]
    v_mfma_f32_16x16x32_bf16 v[40:43], a[56:59], v[100:103], v[40:43]
    s_waitcnt lgkmcnt(4)
    v_mfma_f32_16x16x32_bf16 v[32:35], a[64:67], v[72:75], v[32:35]
    ds_read_b128 v[96:99], v4 offset:19456
    v_mfma_f32_16x16x32_bf16 v[36:39], a[68:71], v[72:75], v[36:39]
    ds_read_b128 v[100:103], v5 offset:19456
    v_mfma_f32_16x16x32_bf16 v[44:47], a[68:71], v[76:79], v[44:47]
    v_mfma_f32_16x16x32_bf16 v[40:43], a[64:67], v[76:79], v[40:43]
    s_waitcnt lgkmcnt(4)
    v_mfma_f32_16x16x32_bf16 v[32:35], a[72:75], v[80:83], v[32:35]
    ds_read_b128 v[72:75], v4 offset:24576
    v_mfma_f32_16x16x32_bf16 v[36:39], a[76:79], v[80:83], v[36:39]
    ds_read_b128 v[76:79], v5 offset:24576
    v_mfma_f32_16x16x32_bf16 v[44:47], a[76:79], v[84:87], v[44:47]
    v_mfma_f32_16x16x32_bf16 v[40:43], a[72:75], v[84:87], v[40:43]
    s_waitcnt lgkmcnt(4)
    v_mfma_f32_16x16x32_bf16 v[32:35], a[80:83], v[88:91], v[32:35]
    ds_read_b128 v[80:83], v4 offset:25600
    v_mfma_f32_16x16x32_bf16 v[36:39], a[84:87], v[88:91], v[36:39]
    ds_read_b128 v[84:87], v5 offset:25600
    v_mfma_f32_16x16x32_bf16 v[44:47], a[84:87], v[92:95], v[44:47]
    v_mfma_f32_16x16x32_bf16 v[40:43], a[80:83], v[92:95], v[40:43]
    s_waitcnt lgkmcnt(4)
    v_mfma_f32_16x16x32_bf16 v[32:35], a[88:91], v[96:99], v[32:35]
    ds_read_b128 v[88:91], v4 offset:26624
    v_mfma_f32_16x16x32_bf16 v[36:39], a[92:95], v[96:99], v[36:39]
    ds_read_b128 v[92:95], v5 offset:26624
    v_mfma_f32_16x16x32_bf16 v[44:47], a[92:95], v[100:103], v[44:47]
    v_mfma_f32_16x16x32_bf16 v[40:43], a[88:91], v[100:103], v[40:43]
    s_waitcnt lgkmcnt(4)
    v_mfma_f32_16x16x32_bf16 v[32:35], a[96:99], v[72:75], v[32:35]
    ds_read_b128 v[96:99], v4 offset:27648
    v_mfma_f32_16x16x32_bf16 v[36:39], a[100:103], v[72:75], v[36:39]
    ds_read_b128 v[100:103], v5 offset:27648
    v_mfma_f32_16x16x32_bf16 v[44:47], a[100:103], v[76:79], v[44:47]
    v_mfma_f32_16x16x32_bf16 v[40:43], a[96:99], v[76:79], v[40:43]
    s_waitcnt vmcnt(0)
    s_barrier
    s_waitcnt lgkmcnt(4)
    v_mfma_f32_16x16x32_bf16 v[32:35], a[104:107], v[80:83], v[32:35]
    ds_read_b128 v[72:75], v4 offset:32768
    v_mfma_f32_16x16x32_bf16 v[36:39], a[108:111], v[80:83], v[36:39]
    ds_read_b128 v[76:79], v5 offset:32768
    v_mfma_f32_16x16x32_bf16 v[44:47], a[108:111], v[84:87], v[44:47]
    v_mfma_f32_16x16x32_bf16 v[40:43], a[104:107], v[84:87], v[40:43]
    s_waitcnt lgkmcnt(4)
    v_mfma_f32_16x16x32_bf16 v[32:35], a[112:115], v[88:91], v[32:35]
    ds_read_b128 v[80:83], v4 offset:33792
    v_mfma_f32_16x16x32_bf16 v[36:39], a[116:119], v[88:91], v[36:39]
    ds_read_b128 v[84:87], v5 offset:33792
    v_mfma_f32_16x16x32_bf16 v[44:47], a[116:119], v[92:95], v[44:47]
    v_mfma_f32_16x16x32_bf16 v[40:43], a[112:115], v[92:95], v[40:43]
    s_waitcnt lgkmcnt(4)
    v_mfma_f32_16x16x32_bf16 v[32:35], a[120:123], v[96:99], v[32:35]
    ds_read_b128 v[88:91], v4 offset:34816
    v_mfma_f32_16x16x32_bf16 v[36:39], a[124:127], v[96:99], v[36:39]
    ds_read_b128 v[92:95], v5 offset:34816
    v_mfma_f32_16x16x32_bf16 v[44:47], a[124:127], v[100:103], v[44:47]
    v_mfma_f32_16x16x32_bf16 v[40:43], a[120:123], v[100:103], v[40:43]
    s_waitcnt lgkmcnt(4)
    v_mfma_f32_16x16x32_bf16 v[32:35], a[128:131], v[72:75], v[32:35]
    ds_read_b128 v[96:99], v4 offset:35840
    v_mfma_f32_16x16x32_bf16 v[36:39], a[132:135], v[72:75], v[36:39]
    ds_read_b128 v[100:103], v5 offset:35840
    v_mfma_f32_16x16x32_bf16 v[44:47], a[132:135], v[76:79], v[44:47]
    v_mfma_f32_16x16x32_bf16 v[40:43], a[128:131], v[76:79], v[40:43]
    s_waitcnt lgkmcnt(4)
    v_mfma_f32_16x16x32_bf16 v[32:35], a[136:139], v[80:83], v[32:35]
    ds_read_b128 v[72:75], v4 offset:40960
    v_mfma_f32_16x16x32_bf16 v[36:39], a[140:143], v[80:83], v[36:39]
    ds_read_b128 v[76:79], v5 offset:40960
    v_mfma_f32_16x16x32_bf16 v[44:47], a[140:143], v[84:87], v[44:47]
    v_mfma_f32_16x16x32_bf16 v[40:43], a[136:139], v[84:87], v[40:43]
    s_waitcnt lgkmcnt(4)
    v_mfma_f32_16x16x32_bf16 v[32:35], a[144:147], v[88:91], v[32:35]
    ds_read_b128 v[80:83], v4 offset:41984
    v_mfma_f32_16x16x32_bf16 v[36:39], a[148:151], v[88:91], v[36:39]
    ds_read_b128 v[84:87], v5 offset:41984
    v_mfma_f32_16x16x32_bf16 v[44:47], a[148:151], v[92:95], v[44:47]
    v_mfma_f32_16x16x32_bf16 v[40:43], a[144:147], v[92:95], v[40:43]
    s_waitcnt lgkmcnt(4)
    v_mfma_f32_16x16x32_bf16 v[32:35], a[152:155], v[96:99], v[32:35]
    ds_read_b128 v[88:91], v4 offset:43008
    v_mfma_f32_16x16x32_bf16 v[36:39], a[156:159], v[96:99], v[36:39]
    ds_read_b128 v[92:95], v5 offset:43008
    v_mfma_f32_16x16x32_bf16 v[44:47], a[156:159], v[100:103], v[44:47]
    v_mfma_f32_16x16x32_bf16 v[40:43], a[152:155], v[100:103], v[40:43]
    s_waitcnt lgkmcnt(4)
    v_mfma_f32_16x16x32_bf16 v[32:35], a[160:163], v[72:75], v[32:35]
    ds_read_b128 v[96:99], v4 offset:44032
    v_mfma_f32_16x16x32_bf16 v[36:39], a[164:167], v[72:75], v[36:39]
    ds_read_b128 v[100:103], v5 offset:44032
    v_mfma_f32_16x16x32_bf16 v[44:47], a[164:167], v[76:79], v[44:47]
    v_mfma_f32_16x16x32_bf16 v[40:43], a[160:163], v[76:79], v[40:43]
    s_waitcnt lgkmcnt(4)
    v_mfma_f32_16x16x32_bf16 v[32:35], a[168:171], v[80:83], v[32:35]
    ds_read_b128 v[72:75], v4 offset:49152
    v_mfma_f32_16x16x32_bf16 v[36:39], a[172:175], v[80:83], v[36:39]
    ds_read_b128 v[76:79], v5 offset:49152
    v_mfma_f32_16x16x32_bf16 v[44:47], a[172:175], v[84:87], v[44:47]
    v_mfma_f32_16x16x32_bf16 v[40:43], a[168:171], v[84:87], v[40:43]
    s_waitcnt lgkmcnt(4)
    v_mfma_f32_16x16x32_bf16 v[32:35], a[176:179], v[88:91], v[32:35]
    ds_read_b128 v[80:83], v4 offset:50176
    v_mfma_f32_16x16x32_bf16 v[36:39], a[180:183], v[88:91], v[36:39]
    ds_read_b128 v[84:87], v5 offset:50176
    v_mfma_f32_16x16x32_bf16 v[44:47], a[180:183], v[92:95], v[44:47]
    v_mfma_f32_16x16x32_bf16 v[40:43], a[176:179], v[92:95], v[40:43]
    s_waitcnt lgkmcnt(4)
    v_mfma_f32_16x16x32_bf16 v[32:35], a[184:187], v[96:99], v[32:35]
    ds_read_b128 v[88:91], v4 offset:51200
    v_mfma_f32_16x16x32_bf16 v[36:39], a[188:191], v[96:99], v[36:39]
    ds_read_b128 v[92:95], v5 offset:51200
    v_mfma_f32_16x16x32_bf16 v[44:47], a[188:191], v[100:103], v[44:47]
    v_mfma_f32_16x16x32_bf16 v[40:43], a[184:187], v[100:103], v[40:43]
    s_waitcnt lgkmcnt(4)
    v_mfma_f32_16x16x32_bf16 v[32:35], a[192:195], v[72:75], v[32:35]
    ds_read_b128 v[96:99], v4 offset:52224
    v_mfma_f32_16x16x32_bf16 v[36:39], a[196:199], v[72:75], v[36:39]
    ds_read_b128 v[100:103], v5 offset:52224
    v_mfma_f32_16x16x32_bf16 v[44:47], a[196:199], v[76:79], v[44:47]
    v_mfma_f32_16x16x32_bf16 v[40:43], a[192:195], v[76:79], v[40:43]
    s_waitcnt lgkmcnt(4)
    v_mfma_f32_16x16x32_bf16 v[32:35], a[200:203], v[80:83], v[32:35]
    ds_read_b128 v[72:75], v4 offset:57344
    v_mfma_f32_16x16x32_bf16 v[36:39], a[204:207], v[80:83], v[36:39]
    ds_read_b128 v[76:79], v5 offset:57344
    v_mfma_f32_16x16x32_bf16 v[44:47], a[204:207], v[84:87], v[44:47]
    v_mfma_f32_16x16x32_bf16 v[40:43], a[200:203], v[84:87], v[40:43]
    s_waitcnt lgkmcnt(4)
    v_mfma_f32_16x16x32_bf16 v[32:35], a[208:211], v[88:91], v[32:35]
    ds_read_b128 v[80:83], v4 offset:58368
    v_mfma_f32_16x16x32_bf16 v[36:39], a[212:215], v[88:91], v[36:39]
    ds_read_b128 v[84:87], v5 offset:58368
    v_mfma_f32_16x16x32_bf16 v[44:47], a[212:215], v[92:95], v[44:47]
    v_mfma_f32_16x16x32_bf16 v[40:43], a[208:211], v[92:95], v[40:43]
    s_waitcnt lgkmcnt(4)
    v_mfma_f32_16x16x32_bf16 v[32:35], a[216:219], v[96:99], v[32:35]
    ds_read_b128 v[88:91], v4 offset:59392
    v_mfma_f32_16x16x32_bf16 v[36:39], a[220:223], v[96:99], v[36:39]
    ds_read_b128 v[92:95], v5 offset:59392
    v_mfma_f32_16x16x32_bf16 v[44:47], a[220:223], v[100:103], v[44:47]
    v_mfma_f32_16x16x32_bf16 v[40:43], a[216:219], v[100:103], v[40:43]
    s_waitcnt lgkmcnt(4)
    v_mfma_f32_16x16x32_bf16 v[32:35], a[224:227], v[72:75], v[32:35]
    ds_read_b128 v[96:99], v4 offset:60416
    v_mfma_f32_16x16x32_bf16 v[36:39], a[228:231], v[72:75], v[36:39]
    ds_read_b128 v[100:103], v5 offset:60416
    v_mfma_f32_16x16x32_bf16 v[44:47], a[228:231], v[76:79], v[44:47]
    v_mfma_f32_16x16x32_bf16 v[40:43], a[224:227], v[76:79], v[40:43]
    s_waitcnt lgkmcnt(4)
    v_mfma_f32_16x16x32_bf16 v[32:35], a[232:235], v[80:83], v[32:35]
    v_mfma_f32_16x16x32_bf16 v[36:39], a[236:239], v[80:83], v[36:39]
    v_mfma_f32_16x16x32_bf16 v[44:47], a[236:239], v[84:87], v[44:47]
    v_mfma_f32_16x16x32_bf16 v[40:43], a[232:235], v[84:87], v[40:43]
    s_waitcnt lgkmcnt(2)
    v_mfma_f32_16x16x32_bf16 v[32:35], a[240:243], v[88:91], v[32:35]
    v_mfma_f32_16x16x32_bf16 v[36:39], a[244:247], v[88:91], v[36:39]
    v_mfma_f32_16x16x32_bf16 v[44:47], a[244:247], v[92:95], v[44:47]
    v_mfma_f32_16x16x32_bf16 v[40:43], a[240:243], v[92:95], v[40:43]
    s_waitcnt lgkmcnt(0)
    v_mfma_f32_16x16x32_bf16 v[48:51], a[248:251], v[96:99], v[32:35]
    v_mfma_f32_16x16x32_bf16 v[52:55], a[252:255], v[96:99], v[36:39]
    v_mfma_f32_16x16x32_bf16 v[60:63], a[252:255], v[100:103], v[44:47]
    v_mfma_f32_16x16x32_bf16 v[56:59], a[248:251], v[100:103], v[40:43]
    s_nop 7
    buffer_store_dwordx4 v[48:51], v20, s[8:11], s24 offen
    buffer_store_dwordx4 v[52:55], v21, s[8:11], s24 offen
    buffer_store_dwordx4 v[56:59], v22, s[8:11], s24 offen
    s_waitcnt vmcnt(0)
    s_barrier
    s_add_u32 s26, s26, 1
    v_mov_b32 v12, s26
    buffer_store_dword v12, v11, s[8:11], s27 offen
    v_mov_b32 v18, s26
    v_writelane_b32 v18, s34, 32
    v_writelane_b32 v18, s40, 33
L_sp_66:
    global_load_dword v19, v[16:17], off sc1
    s_add_u32 s30, s30, 1
    s_cmp_gt_u32 s30, 0x200000
    s_cbranch_scc1 chain_kernel_wabort
    s_waitcnt vmcnt(0)
    v_cmp_lt_u32 vcc, v19, v18
    s_cbranch_vccz L_spok_67
    s_branch L_sp_66
L_spok_67:
    buffer_load_dwordx4 v[104:107], v23, s[8:11], s24 offen offset:0 sc1
    buffer_load_dwordx4 v[108:111], v23, s[8:11], s24 offen offset:1024 sc1
    buffer_load_dwordx4 v[112:115], v23, s[8:11], s24 offen offset:2048 sc1
    s_waitcnt vmcnt(0)
    v_pk_add_f32 v[104:105], v[104:105], v[60:61]
    v_pk_add_f32 v[106:107], v[106:107], v[62:63]
    v_pk_add_f32 v[108:109], v[108:109], v[112:113]
    v_pk_add_f32 v[110:111], v[110:111], v[114:115]
    v_pk_add_f32 v[104:105], v[104:105], v[108:109]
    v_pk_add_f32 v[106:107], v[106:107], v[110:111]
    v_cvt_pk_bf16_f32 v104, 0, v104
    v_cvt_pk_bf16_f32 v105, 0, v105
    v_cvt_pk_bf16_f32 v106, 0, v106
    v_cvt_pk_bf16_f32 v107, 0, v107
    buffer_store_dwordx4 v[104:107], v15, s[16:19], s25 offen
    s_branch seg_t
seg_end:
    s_endpgm
seg_pslow:
L_sp_68:
    global_load_dword v19, v[16:17], off sc1
    s_add_u32 s30, s30, 1
    s_cmp_gt_u32 s30, 0x200000
    s_cbranch_scc1 chain_kernel_wabort
    s_waitcnt vmcnt(0)
    v_cmp_lt_u32 vcc, v19, v18
    s_cbranch_vccz L_spok_69
    s_sleep 2
    s_branch L_sp_68
L_spok_69:
    s_branch seg_pok
    s_endpgm
chain_kernel_wabort:
    s_mov_b64 exec, 1
    v_mov_b32 v1, 0xdeadbeef
    v_mov_b32 v2, 120
    global_store_dword v2, v1, s[98:99]
    s_endpgm
t_g2_c:
    s_mov_b32 s43, 0
    v_bfe_u32 v16, v0, 5, 1
    v_lshlrev_b32 v23, 13, v16
    v_bfe_u32 v16, v0, 7, 1
    v_lshl_add_u32 v23, v16, 12, v23
    v_bfe_u32 v16, v0, 1, 1
    v_lshl_add_u32 v23, v16, 8, v23
    v_bfe_u32 v16, v0, 1, 1
    v_lshl_add_u32 v23, v16, 6, v23
    v_bfe_u32 v16, v0, 4, 1
    v_lshl_add_u32 v23, v16, 7, v23
    v_bfe_u32 v16, v0, 2, 2
    v_lshl_add_u32 v23, v16, 4, v23
    v_bfe_u32 v16, v0, 0, 1
    v_lshl_add_u32 v23, v16, 3, v23
    v_add_u32 v14, s49, v23
    v_xor_b32 v15, 64, v14
    ds_read_b64_tr_b16 v[72:73], v14 offset:0
    ds_read_b64_tr_b16 v[74:75], v15 offset:0
    ds_read_b128 v[44:47], v12 offset:2048
    ds_read_b128 v[40:43], v12 offset:0
    ds_read_b64_tr_b16 v[76:77], v14 offset:512
    ds_read_b64_tr_b16 v[78:79], v15 offset:512
    ds_read_b128 v[52:55], v12 offset:6144
    ds_read_b128 v[48:51], v12 offset:4096
    ds_read_b128 v[60:63], v12 offset:10240
    ds_read_b128 v[56:59], v12 offset:8192
    ds_read_b128 v[68:71], v12 offset:14336
    ds_read_b128 v[64:67], v12 offset:12288
    s_branch t_g2_as
t_g2:
    s_mov_b32 s43, 0
    v_bfe_u32 v16, v0, 5, 1
    v_lshlrev_b32 v23, 13, v16
    v_bfe_u32 v16, v0, 7, 1
    v_lshl_add_u32 v23, v16, 12, v23
    v_bfe_u32 v16, v0, 1, 1
    v_lshl_add_u32 v23, v16, 8, v23
    v_bfe_u32 v16, v0, 1, 1
    v_lshl_add_u32 v23, v16, 6, v23
    v_bfe_u32 v16, v0, 4, 1
    v_lshl_add_u32 v23, v16, 7, v23
    v_bfe_u32 v16, v0, 2, 2
    v_lshl_add_u32 v23, v16, 4, v23
    v_bfe_u32 v16, v0, 0, 1
    v_lshl_add_u32 v23, v16, 3, v23
    v_add_u32 v14, s49, v23
    v_xor_b32 v15, 64, v14
    ds_read_b64_tr_b16 v[72:73], v14 offset:0
    ds_read_b64_tr_b16 v[74:75], v15 offset:0
    ds_read_b128 v[44:47], v12 offset:2048
    ds_read_b128 v[40:43], v12 offset:0
    ds_read_b64_tr_b16 v[76:77], v14 offset:512
    ds_read_b64_tr_b16 v[78:79], v15 offset:512
    ds_read_b128 v[52:55], v12 offset:6144
    ds_read_b128 v[48:51], v12 offset:4096
    ds_read_b128 v[60:63], v12 offset:10240
    ds_read_b128 v[56:59], v12 offset:8192
    ds_read_b128 v[68:71], v12 offset:14336
    ds_read_b128 v[64:67], v12 offset:12288
    s_waitcnt lgkmcnt(8)
    v_mfma_f32_16x16x32_bf16 a[0:3], v[40:43], v[72:75], 0
    s_xor_b32 m0, s44, 0
    v_mfma_f32_16x16x32_bf16 a[32:35], v[44:47], v[72:75], 0
    buffer_load_dwordx4 v4, s[8:11], s20 offen lds
    s_waitcnt lgkmcnt(6)
    v_mfma_f32_16x16x32_bf16 a[36:39], v[44:47], v[76:79], 0
    ds_read_b64_tr_b16 v[80:81], v14 offset:1024
    v_mfma_f32_16x16x32_bf16 a[4:7], v[40:43], v[76:79], 0
    s_waitcnt lgkmcnt(5)
    v_mfma_f32_16x16x32_bf16 a[64:67], v[48:51], v[72:75], 0
    ds_read_b64_tr_b16 v[82:83], v15 offset:1024
    s_xor_b32 m0, s44, 1024
    v_mfma_f32_16x16x32_bf16 a[96:99], v[52:55], v[72:75], 0
    buffer_load_dwordx4 v5, s[8:11], s20 offen lds
    v_mfma_f32_16x16x32_bf16 a[100:103], v[52:55], v[76:79], 0
    ds_read_b64_tr_b16 v[84:85], v14 offset:1536
    s_add_u32 s20, s20, 128
    v_mfma_f32_16x16x32_bf16 a[68:71], v[48:51], v[76:79], 0
    s_waitcnt lgkmcnt(5)
    v_mfma_f32_16x16x32_bf16 a[128:131], v[56:59], v[72:75], 0
    ds_read_b64_tr_b16 v[86:87], v15 offset:1536
    s_mov_b64 vcc, 0
    v_mfma_f32_16x16x32_bf16 a[160:163], v[60:63], v[72:75], 0
    s_xor_b32 m0, s44, 2048
    v_mfma_f32_16x16x32_bf16 a[164:167], v[60:63], v[76:79], 0
    buffer_load_dwordx4 v4, s[8:11], s21 offen lds
    v_mfma_f32_16x16x32_bf16 a[132:135], v[56:59], v[76:79], 0
    s_bitcmp1_b32 s43, 0
    s_waitcnt lgkmcnt(4)
    v_mfma_f32_16x16x32_bf16 a[192:195], v[64:67], v[72:75], 0
    s_cselect_b32 s61, s5, 0
    s_lshl1_add_u32 s53, s61, s50
    v_mfma_f32_16x16x32_bf16 a[224:227], v[68:71], v[72:75], 0
    s_bitcmp1_b32 s43, 1
    s_cselect_b32 s61, s51, 0
    v_mfma_f32_16x16x32_bf16 a[228:231], v[68:71], v[76:79], 0
    s_add_u32 s53, s53, s61
    s_bitcmp1_b32 s43, 2
    v_mfma_f32_16x16x32_bf16 a[196:199], v[64:67], v[76:79], 0
    s_cselect_b32 s61, s52, 0
    s_waitcnt lgkmcnt(2)
    v_mfma_f32_16x16x32_bf16 a[8:11], v[40:43], v[80:83], 0
    s_add_u32 s53, s53, s61
    s_lshl_b32 s29, s43, 4
    v_mfma_f32_16x16x32_bf16 a[40:43], v[44:47], v[80:83], 0
    s_mov_b64 vcc, -1
    s_waitcnt lgkmcnt(0)
    v_mfma_f32_16x16x32_bf16 a[44:47], v[44:47], v[84:87], 0
    ds_read_b64_tr_b16 v[72:73], v14 offset:2048
    s_xor_b32 m0, s44, 3072
    v_mfma_f32_16x16x32_bf16 a[12:15], v[40:43], v[84:87], 0
    buffer_load_dwordx4 v5, s[8:11], s21 offen lds
    v_mfma_f32_16x16x32_bf16 a[72:75], v[48:51], v[80:83], 0
    ds_read_b64_tr_b16 v[74:75], v15 offset:2048
    s_add_u32 s21, s21, 128
    v_mfma_f32_16x16x32_bf16 a[104:107], v[52:55], v[80:83], 0
    s_xor_b32 m0, s44, 16384
    v_mfma_f32_16x16x32_bf16 a[108:111], v[52:55], v[84:87], 0
    ds_read_b64_tr_b16 v[76:77], v14 offset:2560
    buffer_load_dwordx4 v4, s[8:11], s22 offen lds
    v_mfma_f32_16x16x32_bf16 a[76:79], v[48:51], v[84:87], 0
    s_xor_b32 m0, s44, 17408
    v_mfma_f32_16x16x32_bf16 a[136:139], v[56:59], v[80:83], 0
    ds_read_b64_tr_b16 v[78:79], v15 offset:2560
    buffer_load_dwordx4 v5, s[8:11], s22 offen lds
    v_mfma_f32_16x16x32_bf16 a[168:171], v[60:63], v[80:83], 0
    s_add_u32 s22, s22, 128
    s_xor_b32 m0, s44, 18432
    v_mfma_f32_16x16x32_bf16 a[172:175], v[60:63], v[84:87], 0
    buffer_load_dwordx4 v4, s[8:11], s23 offen lds
    v_mfma_f32_16x16x32_bf16 a[140:143], v[56:59], v[84:87], 0
    v_mfma_f32_16x16x32_bf16 a[200:203], v[64:67], v[80:83], 0
    s_xor_b32 m0, s44, 19456
    v_mfma_f32_16x16x32_bf16 a[232:235], v[68:71], v[80:83], 0
    buffer_load_dwordx4 v5, s[8:11], s23 offen lds
    v_mfma_f32_16x16x32_bf16 a[236:239], v[68:71], v[84:87], 0
    s_add_u32 s23, s23, 128
    s_cmp_ge_u32 s44, 98304
    v_mfma_f32_16x16x32_bf16 a[204:207], v[64:67], v[84:87], 0
    s_cselect_b32 s60, s6, s7
    s_waitcnt lgkmcnt(2)
    v_mfma_f32_16x16x32_bf16 a[16:19], v[40:43], v[72:75], 0
    s_add_u32 s44, s44, s60
    v_mfma_f32_16x16x32_bf16 a[48:51], v[44:47], v[72:75], 0
    s_waitcnt lgkmcnt(0)
    v_mfma_f32_16x16x32_bf16 a[52:55], v[44:47], v[76:79], 0
    ds_read_b64_tr_b16 v[80:81], v14 offset:3072
    v_mfma_f32_16x16x32_bf16 a[20:23], v[40:43], v[76:79], 0
    v_mfma_f32_16x16x32_bf16 a[80:83], v[48:51], v[72:75], 0
    ds_read_b64_tr_b16 v[82:83], v15 offset:3072
    s_set_gpr_idx_on s29, gpr_idx(SRC0)
    v_mov_b32 v24, v128
    v_mov_b32 v25, v129
    v_mov_b32 v26, v130
    v_mov_b32 v27, v131
    s_set_gpr_idx_off
    v_mfma_f32_16x16x32_bf16 a[112:115], v[52:55], v[72:75], 0
    v_mfma_f32_16x16x32_bf16 a[116:119], v[52:55], v[76:79], 0
    ds_read_b64_tr_b16 v[84:85], v14 offset:3584
    s_set_gpr_idx_on s29, gpr_idx(SRC0)
    v_mov_b32 v28, v132
    v_mov_b32 v29, v133
    v_mov_b32 v30, v134
    v_mov_b32 v31, v135
    s_set_gpr_idx_off
    v_mfma_f32_16x16x32_bf16 a[84:87], v[48:51], v[76:79], 0
    v_mfma_f32_16x16x32_bf16 a[144:147], v[56:59], v[72:75], 0
    ds_read_b64_tr_b16 v[86:87], v15 offset:3584
    s_set_gpr_idx_on s29, gpr_idx(SRC0)
    v_mov_b32 v32, v136
    v_mov_b32 v33, v137
    v_mov_b32 v34, v138
    v_mov_b32 v35, v139
    s_set_gpr_idx_off
    v_mfma_f32_16x16x32_bf16 a[176:179], v[60:63], v[72:75], 0
    v_mfma_f32_16x16x32_bf16 a[180:183], v[60:63], v[76:79], 0
    s_set_gpr_idx_on s29, gpr_idx(SRC0)
    v_mov_b32 v36, v140
    v_mov_b32 v37, v141
    v_mov_b32 v38, v142
    v_mov_b32 v39, v143
    s_set_gpr_idx_off
    v_mfma_f32_16x16x32_bf16 a[148:151], v[56:59], v[76:79], 0
    v_mfma_f32_16x16x32_bf16 a[208:211], v[64:67], v[72:75], 0
    buffer_store_dwordx4 v[24:27], v2, s[16:19], s53 offen sc1
    v_mfma_f32_16x16x32_bf16 a[240:243], v[68:71], v[72:75], 0
    v_mfma_f32_16x16x32_bf16 a[244:247], v[68:71], v[76:79], 0
    buffer_store_dwordx4 v[28:31], v3, s[16:19], s53 offen sc1
    v_mfma_f32_16x16x32_bf16 a[212:215], v[64:67], v[76:79], 0
    s_add_u32 s53, s53, s5
    s_waitcnt lgkmcnt(2)
    v_mfma_f32_16x16x32_bf16 a[24:27], v[40:43], v[80:83], 0
    ds_read_b64_tr_b16 v[72:73], v14 offset:16384
    buffer_store_dwordx4 v[32:35], v2, s[16:19], s53 offen sc1
    v_mfma_f32_16x16x32_bf16 a[56:59], v[44:47], v[80:83], 0
    ds_read_b64_tr_b16 v[74:75], v15 offset:16384
    s_waitcnt lgkmcnt(2)
    v_mfma_f32_16x16x32_bf16 a[60:63], v[44:47], v[84:87], 0
    ds_read_b128 v[44:47], v13 offset:2048
    buffer_store_dwordx4 v[36:39], v3, s[16:19], s53 offen sc1
    v_mfma_f32_16x16x32_bf16 a[28:31], v[40:43], v[84:87], 0
    ds_read_b128 v[40:43], v13 offset:0
    v_mfma_f32_16x16x32_bf16 a[88:91], v[48:51], v[80:83], 0
    ds_read_b64_tr_b16 v[76:77], v14 offset:16896
    v_mfma_f32_16x16x32_bf16 a[120:123], v[52:55], v[80:83], 0
    ds_read_b64_tr_b16 v[78:79], v15 offset:16896
    v_mfma_f32_16x16x32_bf16 a[124:127], v[52:55], v[84:87], 0
    ds_read_b128 v[52:55], v13 offset:6144
    v_mfma_f32_16x16x32_bf16 a[92:95], v[48:51], v[84:87], 0
    ds_read_b128 v[48:51], v13 offset:4096
    v_mfma_f32_16x16x32_bf16 a[152:155], v[56:59], v[80:83], 0
    v_mfma_f32_16x16x32_bf16 a[184:187], v[60:63], v[80:83], 0
    v_mfma_f32_16x16x32_bf16 a[188:191], v[60:63], v[84:87], 0
    ds_read_b128 v[60:63], v13 offset:10240
    v_mfma_f32_16x16x32_bf16 a[156:159], v[56:59], v[84:87], 0
    ds_read_b128 v[56:59], v13 offset:8192
    v_mfma_f32_16x16x32_bf16 a[216:219], v[64:67], v[80:83], 0
    v_mfma_f32_16x16x32_bf16 a[248:251], v[68:71], v[80:83], 0
    v_mfma_f32_16x16x32_bf16 a[252:255], v[68:71], v[84:87], 0
    ds_read_b128 v[68:71], v13 offset:14336
    v_mfma_f32_16x16x32_bf16 a[220:223], v[64:67], v[84:87], 0
    ds_read_b128 v[64:67], v13 offset:12288
    s_branch t_g2_b
t_g2_hook:
    s_cmp_eq_u32 s43, 1
    s_cbranch_scc1 t_g2_sig0
    s_cmp_eq_u32 s43, 6
    s_cbranch_scc1 t_g2_sws
    s_cmp_eq_u32 s43, 7
    s_cbranch_scc1 t_g2_swp
    s_cmp_lg_u32 s58, 0
    s_cbranch_scc1 t_g2_a
t_g2_wait:
    s_cmp_eq_u32 s3, 0
    s_cbranch_scc1 t_g2_a
    s_mov_b32 s62, 0
L_sw_70:
    s_load_dword s63, s[98:99], s3 glc
    s_add_u32 s62, s62, 1
    s_cmp_gt_u32 s62, 0x200000
    s_cbranch_scc1 chain_kernel_wabort
    s_waitcnt lgkmcnt(0)
    s_cmp_ge_u32 s63, 32
    s_cbranch_scc1 L_swok_71
    s_sleep 16
    s_branch L_sw_70
L_swok_71:
    s_branch t_g2_a
t_g2_sig0:
    s_cmp_eq_u32 s1, 0
    s_cbranch_scc1 t_g2_as
    v_mov_b32 v24, s1
    v_mov_b32 v25, 1
    s_mov_b64 exec, 1
    global_atomic_add v24, v25, s[98:99] sc1
    s_mov_b64 exec, -1
    s_mov_b32 s1, 0
    s_branch t_g2_as
t_g2_sws:
    s_mov_b32 s12, s36
    s_mov_b32 s13, s37
    s_mov_b32 s14, s38
    s_and_b32 s45, s45, 0xffffb7ff
    s_bitcmp1_b32 s0, 3
    s_cselect_b32 s24, s41, 0
    s_cselect_b32 s26, 0, s41
    s_cselect_b32 s60, 0x4000, 0
    s_or_b32 s45, s45, s60
    s_add_u32 s24, s24, s39
    s_add_u32 s26, s26, s39
    s_bitcmp1_b32 s0, 2
    s_cselect_b32 s61, s40, 0
    s_cselect_b32 s62, 0, s40
    s_cselect_b32 s60, 0x800, 0
    s_or_b32 s45, s45, s60
    s_add_u32 s25, s24, s62
    s_add_u32 s24, s24, s61
    s_add_u32 s27, s26, s62
    s_add_u32 s26, s26, s61
    s_mov_b32 s28, s42
    v_mov_b32 v6, v10
    v_mov_b32 v7, v11
    s_branch t_g2_a
t_g2_swp:
    s_mov_b32 s8, s30
    s_mov_b32 s9, s31
    s_mov_b32 s10, s32
    s_and_b32 s44, s44, 0xffffb7ff
    s_bitcmp1_b32 s0, 1
    s_cselect_b32 s20, s35, 0
    s_cselect_b32 s22, 0, s35
    s_cselect_b32 s60, 0x4000, 0
    s_or_b32 s44, s44, s60
    s_add_u32 s20, s20, s33
    s_add_u32 s22, s22, s33
    s_bitcmp1_b32 s0, 0
    s_cselect_b32 s61, s34, 0
    s_cselect_b32 s62, 0, s34
    s_cselect_b32 s60, 0x800, 0
    s_or_b32 s44, s44, s60
    s_add_u32 s21, s20, s62
    s_add_u32 s20, s20, s61
    s_add_u32 s23, s22, s62
    s_add_u32 s22, s22, s61
    v_mov_b32 v4, v8
    v_mov_b32 v5, v9
t_g2_a:
t_g2_as:
    s_waitcnt lgkmcnt(8)
    v_mfma_f32_16x16x32_bf16 a[0:3], v[40:43], v[72:75], a[0:3]
    s_xor_b32 m0, s44, 0
    v_mfma_f32_16x16x32_bf16 a[32:35], v[44:47], v[72:75], a[32:35]
    buffer_load_dwordx4 v4, s[8:11], s20 offen lds
    s_waitcnt lgkmcnt(6)
    v_mfma_f32_16x16x32_bf16 a[36:39], v[44:47], v[76:79], a[36:39]
    ds_read_b64_tr_b16 v[80:81], v14 offset:1024
    v_mfma_f32_16x16x32_bf16 a[4:7], v[40:43], v[76:79], a[4:7]
    s_waitcnt lgkmcnt(5)
    v_mfma_f32_16x16x32_bf16 a[64:67], v[48:51], v[72:75], a[64:67]
    ds_read_b64_tr_b16 v[82:83], v15 offset:1024
    s_xor_b32 m0, s44, 1024
    v_mfma_f32_16x16x32_bf16 a[96:99], v[52:55], v[72:75], a[96:99]
    buffer_load_dwordx4 v5, s[8:11], s20 offen lds
    v_mfma_f32_16x16x32_bf16 a[100:103], v[52:55], v[76:79], a[100:103]
    ds_read_b64_tr_b16 v[84:85], v14 offset:1536
    s_add_u32 s20, s20, 128
    v_mfma_f32_16x16x32_bf16 a[68:71], v[48:51], v[76:79], a[68:71]
    s_waitcnt lgkmcnt(5)
    v_mfma_f32_16x16x32_bf16 a[128:131], v[56:59], v[72:75], a[128:131]
    ds_read_b64_tr_b16 v[86:87], v15 offset:1536
    s_mov_b64 vcc, 0
    v_mfma_f32_16x16x32_bf16 a[160:163], v[60:63], v[72:75], a[160:163]
    s_xor_b32 m0, s44, 2048
    v_mfma_f32_16x16x32_bf16 a[164:167], v[60:63], v[76:79], a[164:167]
    buffer_load_dwordx4 v4, s[8:11], s21 offen lds
    v_mfma_f32_16x16x32_bf16 a[132:135], v[56:59], v[76:79], a[132:135]
    s_bitcmp1_b32 s43, 0
    s_waitcnt lgkmcnt(4)
    v_mfma_f32_16x16x32_bf16 a[192:195], v[64:67], v[72:75], a[192:195]
    s_cselect_b32 s61, s5, 0
    s_lshl1_add_u32 s53, s61, s50
    v_mfma_f32_16x16x32_bf16 a[224:227], v[68:71], v[72:75], a[224:227]
    s_bitcmp1_b32 s43, 1
    s_cselect_b32 s61, s51, 0
    v_mfma_f32_16x16x32_bf16 a[228:231], v[68:71], v[76:79], a[228:231]
    s_add_u32 s53, s53, s61
    s_bitcmp1_b32 s43, 2
    v_mfma_f32_16x16x32_bf16 a[196:199], v[64:67], v[76:79], a[196:199]
    s_cselect_b32 s61, s52, 0
    s_waitcnt lgkmcnt(2)
    v_mfma_f32_16x16x32_bf16 a[8:11], v[40:43], v[80:83], a[8:11]
    s_add_u32 s53, s53, s61
    s_lshl_b32 s29, s43, 4
    v_mfma_f32_16x16x32_bf16 a[40:43], v[44:47], v[80:83], a[40:43]
    s_mov_b64 vcc, -1
    s_waitcnt lgkmcnt(0)
    v_mfma_f32_16x16x32_bf16 a[44:47], v[44:47], v[84:87], a[44:47]
    ds_read_b64_tr_b16 v[72:73], v14 offset:2048
    s_xor_b32 m0, s44, 3072
    v_mfma_f32_16x16x32_bf16 a[12:15], v[40:43], v[84:87], a[12:15]
    buffer_load_dwordx4 v5, s[8:11], s21 offen lds
    v_mfma_f32_16x16x32_bf16 a[72:75], v[48:51], v[80:83], a[72:75]
    ds_read_b64_tr_b16 v[74:75], v15 offset:2048
    s_add_u32 s21, s21, 128
    v_mfma_f32_16x16x32_bf16 a[104:107], v[52:55], v[80:83], a[104:107]
    s_xor_b32 m0, s44, 16384
    v_mfma_f32_16x16x32_bf16 a[108:111], v[52:55], v[84:87], a[108:111]
    ds_read_b64_tr_b16 v[76:77], v14 offset:2560
    buffer_load_dwordx4 v4, s[8:11], s22 offen lds
    v_mfma_f32_16x16x32_bf16 a[76:79], v[48:51], v[84:87], a[76:79]
    s_xor_b32 m0, s44, 17408
    v_mfma_f32_16x16x32_bf16 a[136:139], v[56:59], v[80:83], a[136:139]
    ds_read_b64_tr_b16 v[78:79], v15 offset:2560
    buffer_load_dwordx4 v5, s[8:11], s22 offen lds
    v_mfma_f32_16x16x32_bf16 a[168:171], v[60:63], v[80:83], a[168:171]
    s_add_u32 s22, s22, 128
    s_xor_b32 m0, s44, 18432
    v_mfma_f32_16x16x32_bf16 a[172:175], v[60:63], v[84:87], a[172:175]
    buffer_load_dwordx4 v4, s[8:11], s23 offen lds
    v_mfma_f32_16x16x32_bf16 a[140:143], v[56:59], v[84:87], a[140:143]
    v_mfma_f32_16x16x32_bf16 a[200:203], v[64:67], v[80:83], a[200:203]
    s_xor_b32 m0, s44, 19456
    v_mfma_f32_16x16x32_bf16 a[232:235], v[68:71], v[80:83], a[232:235]
    buffer_load_dwordx4 v5, s[8:11], s23 offen lds
    v_mfma_f32_16x16x32_bf16 a[236:239], v[68:71], v[84:87], a[236:239]
    s_add_u32 s23, s23, 128
    s_cmp_ge_u32 s44, 98304
    v_mfma_f32_16x16x32_bf16 a[204:207], v[64:67], v[84:87], a[204:207]
    s_cselect_b32 s60, s6, s7
    s_waitcnt lgkmcnt(2)
    v_mfma_f32_16x16x32_bf16 a[16:19], v[40:43], v[72:75], a[16:19]
    s_add_u32 s44, s44, s60
    v_mfma_f32_16x16x32_bf16 a[48:51], v[44:47], v[72:75], a[48:51]
    s_waitcnt lgkmcnt(0)
    v_mfma_f32_16x16x32_bf16 a[52:55], v[44:47], v[76:79], a[52:55]
    ds_read_b64_tr_b16 v[80:81], v14 offset:3072
    v_mfma_f32_16x16x32_bf16 a[20:23], v[40:43], v[76:79], a[20:23]
    v_mfma_f32_16x16x32_bf16 a[80:83], v[48:51], v[72:75], a[80:83]
    ds_read_b64_tr_b16 v[82:83], v15 offset:3072
    s_set_gpr_idx_on s29, gpr_idx(SRC0)
    v_mov_b32 v24, v128
    v_mov_b32 v25, v129
    v_mov_b32 v26, v130
    v_mov_b32 v27, v131
    s_set_gpr_idx_off
    v_mfma_f32_16x16x32_bf16 a[112:115], v[52:55], v[72:75], a[112:115]
    v_mfma_f32_16x16x32_bf16 a[116:119], v[52:55], v[76:79], a[116:119]
    ds_read_b64_tr_b16 v[84:85], v14 offset:3584
    s_set_gpr_idx_on s29, gpr_idx(SRC0)
    v_mov_b32 v28, v132
    v_mov_b32 v29, v133
    v_mov_b32 v30, v134
    v_mov_b32 v31, v135
    s_set_gpr_idx_off
    v_mfma_f32_16x16x32_bf16 a[84:87], v[48:51], v[76:79], a[84:87]
    v_mfma_f32_16x16x32_bf16 a[144:147], v[56:59], v[72:75], a[144:147]
    ds_read_b64_tr_b16 v[86:87], v15 offset:3584
    s_set_gpr_idx_on s29, gpr_idx(SRC0)
    v_mov_b32 v32, v136
    v_mov_b32 v33, v137
    v_mov_b32 v34, v138
    v_mov_b32 v35, v139
    s_set_gpr_idx_off
    v_mfma_f32_16x16x32_bf16 a[176:179], v[60:63], v[72:75], a[176:179]
    v_mfma_f32_16x16x32_bf16 a[180:183], v[60:63], v[76:79], a[180:183]
    s_set_gpr_idx_on s29, gpr_idx(SRC0)
    v_mov_b32 v36, v140
    v_mov_b32 v37, v141
    v_mov_b32 v38, v142
    v_mov_b32 v39, v143
    s_set_gpr_idx_off
    v_mfma_f32_16x16x32_bf16 a[148:151], v[56:59], v[76:79], a[148:151]
    v_mfma_f32_16x16x32_bf16 a[208:211], v[64:67], v[72:75], a[208:211]
    buffer_store_dwordx4 v[24:27], v2, s[16:19], s53 offen sc1
    v_mfma_f32_16x16x32_bf16 a[240:243], v[68:71], v[72:75], a[240:243]
    v_mfma_f32_16x16x32_bf16 a[244:247], v[68:71], v[76:79], a[244:247]
    buffer_store_dwordx4 v[28:31], v3, s[16:19], s53 offen sc1
    v_mfma_f32_16x16x32_bf16 a[212:215], v[64:67], v[76:79], a[212:215]
    s_add_u32 s53, s53, s5
    s_waitcnt lgkmcnt(2)
    v_mfma_f32_16x16x32_bf16 a[24:27], v[40:43], v[80:83], a[24:27]
    ds_read_b64_tr_b16 v[72:73], v14 offset:16384
    buffer_store_dwordx4 v[32:35], v2, s[16:19], s53 offen sc1
    v_mfma_f32_16x16x32_bf16 a[56:59], v[44:47], v[80:83], a[56:59]
    ds_read_b64_tr_b16 v[74:75], v15 offset:16384
    s_waitcnt lgkmcnt(2)
    v_mfma_f32_16x16x32_bf16 a[60:63], v[44:47], v[84:87], a[60:63]
    ds_read_b128 v[44:47], v13 offset:2048
    buffer_store_dwordx4 v[36:39], v3, s[16:19], s53 offen sc1
    v_mfma_f32_16x16x32_bf16 a[28:31], v[40:43], v[84:87], a[28:31]
    ds_read_b128 v[40:43], v13 offset:0
    v_mfma_f32_16x16x32_bf16 a[88:91], v[48:51], v[80:83], a[88:91]
    ds_read_b64_tr_b16 v[76:77], v14 offset:16896
    v_mfma_f32_16x16x32_bf16 a[120:123], v[52:55], v[80:83], a[120:123]
    ds_read_b64_tr_b16 v[78:79], v15 offset:16896
    v_mfma_f32_16x16x32_bf16 a[124:127], v[52:55], v[84:87], a[124:127]
    ds_read_b128 v[52:55], v13 offset:6144
    v_mfma_f32_16x16x32_bf16 a[92:95], v[48:51], v[84:87], a[92:95]
    ds_read_b128 v[48:51], v13 offset:4096
    v_mfma_f32_16x16x32_bf16 a[152:155], v[56:59], v[80:83], a[152:155]
    v_mfma_f32_16x16x32_bf16 a[184:187], v[60:63], v[80:83], a[184:187]
    v_mfma_f32_16x16x32_bf16 a[188:191], v[60:63], v[84:87], a[188:191]
    ds_read_b128 v[60:63], v13 offset:10240
    v_mfma_f32_16x16x32_bf16 a[156:159], v[56:59], v[84:87], a[156:159]
    ds_read_b128 v[56:59], v13 offset:8192
    v_mfma_f32_16x16x32_bf16 a[216:219], v[64:67], v[80:83], a[216:219]
    v_mfma_f32_16x16x32_bf16 a[248:251], v[68:71], v[80:83], a[248:251]
    v_mfma_f32_16x16x32_bf16 a[252:255], v[68:71], v[84:87], a[252:255]
    ds_read_b128 v[68:71], v13 offset:14336
    v_mfma_f32_16x16x32_bf16 a[220:223], v[64:67], v[84:87], a[220:223]
    ds_read_b128 v[64:67], v13 offset:12288
t_g2_b:
    s_waitcnt lgkmcnt(8)
    v_mfma_f32_16x16x32_bf16 a[0:3], v[40:43], v[72:75], a[0:3]
    v_mfma_f32_16x16x32_bf16 a[32:35], v[44:47], v[72:75], a[32:35]
    s_waitcnt lgkmcnt(6)
    v_mfma_f32_16x16x32_bf16 a[36:39], v[44:47], v[76:79], a[36:39]
    ds_read_b64_tr_b16 v[80:81], v14 offset:17408
    v_mfma_f32_16x16x32_bf16 a[4:7], v[40:43], v[76:79], a[4:7]
    s_cmp_ge_u32 s48, 98304
    s_waitcnt lgkmcnt(5)
    v_mfma_f32_16x16x32_bf16 a[64:67], v[48:51], v[72:75], a[64:67]
    ds_read_b64_tr_b16 v[82:83], v15 offset:17408
    s_cselect_b32 s46, s6, s7
    v_mfma_f32_16x16x32_bf16 a[96:99], v[52:55], v[72:75], a[96:99]
    s_add_u32 s48, s48, s46
    v_mfma_f32_16x16x32_bf16 a[100:103], v[52:55], v[76:79], a[100:103]
    ds_read_b64_tr_b16 v[84:85], v14 offset:17920
    v_mfma_f32_16x16x32_bf16 a[68:71], v[48:51], v[76:79], a[68:71]
    s_cmp_ge_u32 s49, 98304
    s_waitcnt lgkmcnt(5)
    v_mfma_f32_16x16x32_bf16 a[128:131], v[56:59], v[72:75], a[128:131]
    ds_read_b64_tr_b16 v[86:87], v15 offset:17920
    s_cselect_b32 s47, s6, s7
    v_mfma_f32_16x16x32_bf16 a[160:163], v[60:63], v[72:75], a[160:163]
    s_add_u32 s49, s49, s47
    v_mfma_f32_16x16x32_bf16 a[164:167], v[60:63], v[76:79], a[164:167]
    v_mfma_f32_16x16x32_bf16 a[132:135], v[56:59], v[76:79], a[132:135]
    s_waitcnt lgkmcnt(4)
    v_mfma_f32_16x16x32_bf16 a[192:195], v[64:67], v[72:75], a[192:195]
    v_mfma_f32_16x16x32_bf16 a[224:227], v[68:71], v[72:75], a[224:227]
    v_mfma_f32_16x16x32_bf16 a[228:231], v[68:71], v[76:79], a[228:231]
    v_mfma_f32_16x16x32_bf16 a[196:199], v[64:67], v[76:79], a[196:199]
    s_waitcnt lgkmcnt(2)
    v_mfma_f32_16x16x32_bf16 a[8:11], v[40:43], v[80:83], a[8:11]
    s_xor_b32 m0, s45, 0
    v_mfma_f32_16x16x32_bf16 a[40:43], v[44:47], v[80:83], a[40:43]
    buffer_load_dwordx4 v6, s[12:15], s24 offen lds
    s_waitcnt lgkmcnt(0)
    v_mfma_f32_16x16x32_bf16 a[44:47], v[44:47], v[84:87], a[44:47]
    ds_read_b64_tr_b16 v[72:73], v14 offset:18432
    v_add_u32 v12, s46, v12
    v_mfma_f32_16x16x32_bf16 a[12:15], v[40:43], v[84:87], a[12:15]
    v_add_u32 v13, s46, v13
    v_mfma_f32_16x16x32_bf16 a[72:75], v[48:51], v[80:83], a[72:75]
    ds_read_b64_tr_b16 v[74:75], v15 offset:18432
    s_xor_b32 m0, s45, 1024
    v_mfma_f32_16x16x32_bf16 a[104:107], v[52:55], v[80:83], a[104:107]
    buffer_load_dwordx4 v7, s[12:15], s24 offen lds
    v_mfma_f32_16x16x32_bf16 a[108:111], v[52:55], v[84:87], a[108:111]
    ds_read_b64_tr_b16 v[76:77], v14 offset:18944
    s_add_u32 s24, s24, s28
    v_mfma_f32_16x16x32_bf16 a[76:79], v[48:51], v[84:87], a[76:79]
    v_mfma_f32_16x16x32_bf16 a[136:139], v[56:59], v[80:83], a[136:139]
    ds_read_b64_tr_b16 v[78:79], v15 offset:18944
    s_xor_b32 m0, s45, 2048
    v_mfma_f32_16x16x32_bf16 a[168:171], v[60:63], v[80:83], a[168:171]
    buffer_load_dwordx4 v6, s[12:15], s25 offen lds
    v_mfma_f32_16x16x32_bf16 a[172:175], v[60:63], v[84:87], a[172:175]
    v_mfma_f32_16x16x32_bf16 a[140:143], v[56:59], v[84:87], a[140:143]
    v_mfma_f32_16x16x32_bf16 a[200:203], v[64:67], v[80:83], a[200:203]
    s_xor_b32 m0, s45, 3072
    v_mfma_f32_16x16x32_bf16 a[232:235], v[68:71], v[80:83], a[232:235]
    buffer_load_dwordx4 v7, s[12:15], s25 offen lds
    v_mfma_f32_16x16x32_bf16 a[236:239], v[68:71], v[84:87], a[236:239]
    s_add_u32 s25, s25, s28
    v_mfma_f32_16x16x32_bf16 a[204:207], v[64:67], v[84:87], a[204:207]
    s_waitcnt lgkmcnt(2)
    v_mfma_f32_16x16x32_bf16 a[16:19], v[40:43], v[72:75], a[16:19]
    s_xor_b32 m0, s45, 16384
    v_mfma_f32_16x16x32_bf16 a[48:51], v[44:47], v[72:75], a[48:51]
    buffer_load_dwordx4 v6, s[12:15], s26 offen lds
    s_waitcnt lgkmcnt(0)
    v_mfma_f32_16x16x32_bf16 a[52:55], v[44:47], v[76:79], a[52:55]
    ds_read_b64_tr_b16 v[80:81], v14 offset:19456
    v_mfma_f32_16x16x32_bf16 a[20:23], v[40:43], v[76:79], a[20:23]
    s_xor_b32 m0, s45, 17408
    v_mfma_f32_16x16x32_bf16 a[80:83], v[48:51], v[72:75], a[80:83]
    ds_read_b64_tr_b16 v[82:83], v15 offset:19456
    buffer_load_dwordx4 v7, s[12:15], s26 offen lds
    v_mfma_f32_16x16x32_bf16 a[112:115], v[52:55], v[72:75], a[112:115]
    s_add_u32 s26, s26, s28
    s_xor_b32 m0, s45, 18432
    v_mfma_f32_16x16x32_bf16 a[116:119], v[52:55], v[76:79], a[116:119]
    ds_read_b64_tr_b16 v[84:85], v14 offset:19968
    buffer_load_dwordx4 v6, s[12:15], s27 offen lds
    v_mfma_f32_16x16x32_bf16 a[84:87], v[48:51], v[76:79], a[84:87]
    s_xor_b32 m0, s45, 19456
    v_mfma_f32_16x16x32_bf16 a[144:147], v[56:59], v[72:75], a[144:147]
    ds_read_b64_tr_b16 v[86:87], v15 offset:19968
    buffer_load_dwordx4 v7, s[12:15], s27 offen lds
    v_mfma_f32_16x16x32_bf16 a[176:179], v[60:63], v[72:75], a[176:179]
    s_add_u32 s27, s27, s28
    s_cmp_ge_u32 s45, 98304
    v_mfma_f32_16x16x32_bf16 a[180:183], v[60:63], v[76:79], a[180:183]
    s_cselect_b32 s60, s6, s7
    s_add_u32 s45, s45, s60
    v_mfma_f32_16x16x32_bf16 a[148:151], v[56:59], v[76:79], a[148:151]
    v_add_u32 v14, s47, v14
    v_add_u32 v15, s47, v15
    v_mfma_f32_16x16x32_bf16 a[208:211], v[64:67], v[72:75], a[208:211]
    s_add_u32 s43, s43, 1
    s_cmp_eq_u32 s43, 8
    v_mfma_f32_16x16x32_bf16 a[240:243], v[68:71], v[72:75], a[240:243]
    v_mfma_f32_16x16x32_bf16 a[244:247], v[68:71], v[76:79], a[244:247]
    v_mfma_f32_16x16x32_bf16 a[212:215], v[64:67], v[76:79], a[212:215]
    s_waitcnt vmcnt(12) lgkmcnt(0)
    s_cbranch_vccnz t_g2_bar
    s_waitcnt vmcnt(8)
t_g2_bar:
    s_barrier
    s_cbranch_scc1 t_g2_last
    v_mfma_f32_16x16x32_bf16 a[24:27], v[40:43], v[80:83], a[24:27]
    ds_read_b64_tr_b16 v[72:73], v14 offset:0
    v_mfma_f32_16x16x32_bf16 a[56:59], v[44:47], v[80:83], a[56:59]
    ds_read_b64_tr_b16 v[74:75], v15 offset:0
    v_mfma_f32_16x16x32_bf16 a[60:63], v[44:47], v[84:87], a[60:63]
    ds_read_b128 v[44:47], v12 offset:2048
    v_mfma_f32_16x16x32_bf16 a[28:31], v[40:43], v[84:87], a[28:31]
    ds_read_b128 v[40:43], v12 offset:0
    v_mfma_f32_16x16x32_bf16 a[88:91], v[48:51], v[80:83], a[88:91]
    ds_read_b64_tr_b16 v[76:77], v14 offset:512
    v_mfma_f32_16x16x32_bf16 a[120:123], v[52:55], v[80:83], a[120:123]
    ds_read_b64_tr_b16 v[78:79], v15 offset:512
    v_mfma_f32_16x16x32_bf16 a[124:127], v[52:55], v[84:87], a[124:127]
    ds_read_b128 v[52:55], v12 offset:6144
    v_mfma_f32_16x16x32_bf16 a[92:95], v[48:51], v[84:87], a[92:95]
    ds_read_b128 v[48:51], v12 offset:4096
    v_mfma_f32_16x16x32_bf16 a[152:155], v[56:59], v[80:83], a[152:155]
    v_mfma_f32_16x16x32_bf16 a[184:187], v[60:63], v[80:83], a[184:187]
    v_mfma_f32_16x16x32_bf16 a[188:191], v[60:63], v[84:87], a[188:191]
    ds_read_b128 v[60:63], v12 offset:10240
    v_mfma_f32_16x16x32_bf16 a[156:159], v[56:59], v[84:87], a[156:159]
    ds_read_b128 v[56:59], v12 offset:8192
    v_mfma_f32_16x16x32_bf16 a[216:219], v[64:67], v[80:83], a[216:219]
    s_sub_u32 s61, s43, 2
    s_cmp_lt_u32 s61, 3
    v_mfma_f32_16x16x32_bf16 a[248:251], v[68:71], v[80:83], a[248:251]
    v_mfma_f32_16x16x32_bf16 a[252:255], v[68:71], v[84:87], a[252:255]
    ds_read_b128 v[68:71], v12 offset:14336
    v_mfma_f32_16x16x32_bf16 a[220:223], v[64:67], v[84:87], a[220:223]
    ds_read_b128 v[64:67], v12 offset:12288
    s_cbranch_scc1 t_g2_a
    s_branch t_g2_hook
t_g2_last:
    v_mfma_f32_16x16x32_bf16 a[24:27], v[40:43], v[80:83], a[24:27]
    v_mfma_f32_16x16x32_bf16 a[56:59], v[44:47], v[80:83], a[56:59]
    v_mfma_f32_16x16x32_bf16 a[60:63], v[44:47], v[84:87], a[60:63]
    v_mfma_f32_16x16x32_bf16 a[28:31], v[40:43], v[84:87], a[28:31]
    v_mfma_f32_16x16x32_bf16 a[88:91], v[48:51], v[80:83], a[88:91]
    v_mfma_f32_16x16x32_bf16 a[120:123], v[52:55], v[80:83], a[120:123]
    v_mfma_f32_16x16x32_bf16 a[124:127], v[52:55], v[84:87], a[124:127]
    v_mfma_f32_16x16x32_bf16 a[92:95], v[48:51], v[84:87], a[92:95]
    v_mfma_f32_16x16x32_bf16 a[152:155], v[56:59], v[80:83], a[152:155]
    v_mfma_f32_16x16x32_bf16 a[184:187], v[60:63], v[80:83], a[184:187]
    v_mfma_f32_16x16x32_bf16 a[188:191], v[60:63], v[84:87], a[188:191]
    v_mfma_f32_16x16x32_bf16 a[156:159], v[56:59], v[84:87], a[156:159]
    v_mfma_f32_16x16x32_bf16 a[216:219], v[64:67], v[80:83], a[216:219]
    v_mfma_f32_16x16x32_bf16 a[248:251], v[68:71], v[80:83], a[248:251]
    v_mfma_f32_16x16x32_bf16 a[252:255], v[68:71], v[84:87], a[252:255]
    v_mfma_f32_16x16x32_bf16 a[220:223], v[64:67], v[84:87], a[220:223]
    s_setpc_b64 s[54:55]
t_g1:
    s_mov_b32 s43, 0
    v_add_u32 v14, s49, v23
    v_xor_b32 v15, 64, v14
    ds_read_b128 v[72:75], v14 offset:0
    ds_read_b128 v[76:79], v14 offset:2048
    ds_read_b128 v[44:47], v12 offset:2048
    ds_read_b128 v[40:43], v12 offset:0
    ds_read_b128 v[52:55], v12 offset:6144
    ds_read_b128 v[48:51], v12 offset:4096
    ds_read_b128 v[60:63], v12 offset:10240
    ds_read_b128 v[56:59], v12 offset:8192
    ds_read_b128 v[68:71], v12 offset:14336
    ds_read_b128 v[64:67], v12 offset:12288
    s_waitcnt lgkmcnt(6)
    v_mfma_f32_16x16x32_bf16 a[0:3], v[40:43], v[72:75], 0
    s_xor_b32 m0, s44, 0
    v_mfma_f32_16x16x32_bf16 a[32:35], v[44:47], v[72:75], 0
    buffer_load_dwordx4 v4, s[8:11], s20 offen lds
    v_mfma_f32_16x16x32_bf16 a[36:39], v[44:47], v[76:79], 0
    ds_read_b128 v[80:83], v14 offset:4096
    v_mfma_f32_16x16x32_bf16 a[4:7], v[40:43], v[76:79], 0
    s_waitcnt lgkmcnt(5)
    v_mfma_f32_16x16x32_bf16 a[64:67], v[48:51], v[72:75], 0
    ds_read_b128 v[84:87], v14 offset:6144
    s_xor_b32 m0, s44, 1024
    v_mfma_f32_16x16x32_bf16 a[96:99], v[52:55], v[72:75], 0
    buffer_load_dwordx4 v5, s[8:11], s20 offen lds
    v_mfma_f32_16x16x32_bf16 a[100:103], v[52:55], v[76:79], 0
    s_add_u32 s20, s20, 128
    v_mfma_f32_16x16x32_bf16 a[68:71], v[48:51], v[76:79], 0
    s_waitcnt lgkmcnt(4)
    v_mfma_f32_16x16x32_bf16 a[128:131], v[56:59], v[72:75], 0
    s_mov_b64 vcc, 0
    s_xor_b32 m0, s44, 2048
    v_mfma_f32_16x16x32_bf16 a[160:163], v[60:63], v[72:75], 0
    buffer_load_dwordx4 v4, s[8:11], s21 offen lds
    v_mfma_f32_16x16x32_bf16 a[164:167], v[60:63], v[76:79], 0
    s_bitcmp1_b32 s43, 0
    s_cselect_b32 s61, s5, 0
    v_mfma_f32_16x16x32_bf16 a[132:135], v[56:59], v[76:79], 0
    s_lshl1_add_u32 s53, s61, s50
    s_waitcnt lgkmcnt(2)
    v_mfma_f32_16x16x32_bf16 a[192:195], v[64:67], v[72:75], 0
    s_bitcmp1_b32 s43, 1
    s_cselect_b32 s61, s51, 0
    v_mfma_f32_16x16x32_bf16 a[224:227], v[68:71], v[72:75], 0
    s_add_u32 s53, s53, s61
    s_bitcmp1_b32 s43, 2
    v_mfma_f32_16x16x32_bf16 a[228:231], v[68:71], v[76:79], 0
    s_cselect_b32 s61, s52, 0
    s_add_u32 s53, s53, s61
    v_mfma_f32_16x16x32_bf16 a[196:199], v[64:67], v[76:79], 0
    s_lshl_b32 s29, s43, 4
    s_waitcnt lgkmcnt(1)
    v_mfma_f32_16x16x32_bf16 a[8:11], v[40:43], v[80:83], 0
    s_mov_b64 vcc, -1
    s_xor_b32 m0, s44, 3072
    v_mfma_f32_16x16x32_bf16 a[40:43], v[44:47], v[80:83], 0
    buffer_load_dwordx4 v5, s[8:11], s21 offen lds
    s_waitcnt lgkmcnt(0)
    v_mfma_f32_16x16x32_bf16 a[44:47], v[44:47], v[84:87], 0
    ds_read_b128 v[72:75], v14 offset:8192
    s_add_u32 s21, s21, 128
    v_mfma_f32_16x16x32_bf16 a[12:15], v[40:43], v[84:87], 0
    s_xor_b32 m0, s44, 16384
    v_mfma_f32_16x16x32_bf16 a[72:75], v[48:51], v[80:83], 0
    ds_read_b128 v[76:79], v14 offset:10240
    buffer_load_dwordx4 v4, s[8:11], s22 offen lds
    v_mfma_f32_16x16x32_bf16 a[104:107], v[52:55], v[80:83], 0
    s_xor_b32 m0, s44, 17408
    v_mfma_f32_16x16x32_bf16 a[108:111], v[52:55], v[84:87], 0
    buffer_load_dwordx4 v5, s[8:11], s22 offen lds
    v_mfma_f32_16x16x32_bf16 a[76:79], v[48:51], v[84:87], 0
    s_add_u32 s22, s22, 128
    v_mfma_f32_16x16x32_bf16 a[136:139], v[56:59], v[80:83], 0
    s_xor_b32 m0, s44, 18432
    v_mfma_f32_16x16x32_bf16 a[168:171], v[60:63], v[80:83], 0
    buffer_load_dwordx4 v4, s[8:11], s23 offen lds
    v_mfma_f32_16x16x32_bf16 a[172:175], v[60:63], v[84:87], 0
    v_mfma_f32_16x16x32_bf16 a[140:143], v[56:59], v[84:87], 0
    v_mfma_f32_16x16x32_bf16 a[200:203], v[64:67], v[80:83], 0
    s_xor_b32 m0, s44, 19456
    v_mfma_f32_16x16x32_bf16 a[232:235], v[68:71], v[80:83], 0
    buffer_load_dwordx4 v5, s[8:11], s23 offen lds
    v_mfma_f32_16x16x32_bf16 a[236:239], v[68:71], v[84:87], 0
    s_add_u32 s23, s23, 128
    s_cmp_ge_u32 s44, 98304
    v_mfma_f32_16x16x32_bf16 a[204:207], v[64:67], v[84:87], 0
    s_cselect_b32 s60, s6, s7
    s_waitcnt lgkmcnt(1)
    v_mfma_f32_16x16x32_bf16 a[16:19], v[40:43], v[72:75], 0
    s_add_u32 s44, s44, s60
    v_mfma_f32_16x16x32_bf16 a[48:51], v[44:47], v[72:75], 0
    s_waitcnt lgkmcnt(0)
    v_mfma_f32_16x16x32_bf16 a[52:55], v[44:47], v[76:79], 0
    ds_read_b128 v[80:83], v14 offset:12288
    v_mfma_f32_16x16x32_bf16 a[20:23], v[40:43], v[76:79], 0
    v_mfma_f32_16x16x32_bf16 a[80:83], v[48:51], v[72:75], 0
    ds_read_b128 v[84:87], v14 offset:14336
    s_set_gpr_idx_on s29, gpr_idx(SRC0)
    v_mov_b32 v24, v128
    v_mov_b32 v25, v129
    v_mov_b32 v26, v130
    v_mov_b32 v27, v131
    s_set_gpr_idx_off
    v_mfma_f32_16x16x32_bf16 a[112:115], v[52:55], v[72:75], 0
    v_mfma_f32_16x16x32_bf16 a[116:119], v[52:55], v[76:79], 0
    s_set_gpr_idx_on s29, gpr_idx(SRC0)
    v_mov_b32 v28, v132
    v_mov_b32 v29, v133
    v_mov_b32 v30, v134
    v_mov_b32 v31, v135
    s_set_gpr_idx_off
    v_mfma_f32_16x16x32_bf16 a[84:87], v[48:51], v[76:79], 0
    v_mfma_f32_16x16x32_bf16 a[144:147], v[56:59], v[72:75], 0
    s_set_gpr_idx_on s29, gpr_idx(SRC0)
    v_mov_b32 v32, v136
    v_mov_b32 v33, v137
    v_mov_b32 v34, v138
    v_mov_b32 v35, v139
    s_set_gpr_idx_off
    v_mfma_f32_16x16x32_bf16 a[176:179], v[60:63], v[72:75], 0
    v_mfma_f32_16x16x32_bf16 a[180:183], v[60:63], v[76:79], 0
    s_set_gpr_idx_on s29, gpr_idx(SRC0)
    v_mov_b32 v36, v140
    v_mov_b32 v37, v141
    v_mov_b32 v38, v142
    v_mov_b32 v39, v143
    s_set_gpr_idx_off
    v_mfma_f32_16x16x32_bf16 a[148:151], v[56:59], v[76:79], 0
    v_mfma_f32_16x16x32_bf16 a[208:211], v[64:67], v[72:75], 0
    buffer_store_dwordx4 v[24:27], v2, s[16:19], s53 offen sc1
    v_mfma_f32_16x16x32_bf16 a[240:243], v[68:71], v[72:75], 0
    v_mfma_f32_16x16x32_bf16 a[244:247], v[68:71], v[76:79], 0
    buffer_store_dwordx4 v[28:31], v3, s[16:19], s53 offen sc1
    v_mfma_f32_16x16x32_bf16 a[212:215], v[64:67], v[76:79], 0
    s_add_u32 s53, s53, s5
    s_waitcnt lgkmcnt(1)
    v_mfma_f32_16x16x32_bf16 a[24:27], v[40:43], v[80:83], 0
    ds_read_b128 v[72:75], v15 offset:0
    buffer_store_dwordx4 v[32:35], v2, s[16:19], s53 offen sc1
    v_mfma_f32_16x16x32_bf16 a[56:59], v[44:47], v[80:83], 0
    ds_read_b128 v[76:79], v15 offset:2048
    s_waitcnt lgkmcnt(2)
    v_mfma_f32_16x16x32_bf16 a[60:63], v[44:47], v[84:87], 0
    ds_read_b128 v[44:47], v13 offset:2048
    buffer_store_dwordx4 v[36:39], v3, s[16:19], s53 offen sc1
    v_mfma_f32_16x16x32_bf16 a[28:31], v[40:43], v[84:87], 0
    ds_read_b128 v[40:43], v13 offset:0
    v_mfma_f32_16x16x32_bf16 a[88:91], v[48:51], v[80:83], 0
    v_mfma_f32_16x16x32_bf16 a[120:123], v[52:55], v[80:83], 0
    v_mfma_f32_16x16x32_bf16 a[124:127], v[52:55], v[84:87], 0
    ds_read_b128 v[52:55], v13 offset:6144
    v_mfma_f32_16x16x32_bf16 a[92:95], v[48:51], v[84:87], 0
    ds_read_b128 v[48:51], v13 offset:4096
    v_mfma_f32_16x16x32_bf16 a[152:155], v[56:59], v[80:83], 0
    v_mfma_f32_16x16x32_bf16 a[184:187], v[60:63], v[80:83], 0
    v_mfma_f32_16x16x32_bf16 a[188:191], v[60:63], v[84:87], 0
    ds_read_b128 v[60:63], v13 offset:10240
    v_mfma_f32_16x16x32_bf16 a[156:159], v[56:59], v[84:87], 0
    ds_read_b128 v[56:59], v13 offset:8192
    v_mfma_f32_16x16x32_bf16 a[216:219], v[64:67], v[80:83], 0
    v_mfma_f32_16x16x32_bf16 a[248:251], v[68:71], v[80:83], 0
    v_mfma_f32_16x16x32_bf16 a[252:255], v[68:71], v[84:87], 0
    ds_read_b128 v[68:71], v13 offset:14336
    v_mfma_f32_16x16x32_bf16 a[220:223], v[64:67], v[84:87], 0
    ds_read_b128 v[64:67], v13 offset:12288
    s_branch t_g1_b
t_g1_as:
    s_waitcnt lgkmcnt(6)
    v_mfma_f32_16x16x32_bf16 a[0:3], v[40:43], v[72:75], a[0:3]
    s_xor_b32 m0, s44, 0
    v_mfma_f32_16x16x32_bf16 a[32:35], v[44:47], v[72:75], a[32:35]
    buffer_load_dwordx4 v4, s[8:11], s20 offen lds
    v_mfma_f32_16x16x32_bf16 a[36:39], v[44:47], v[76:79], a[36:39]
    ds_read_b128 v[80:83], v14 offset:4096
    v_mfma_f32_16x16x32_bf16 a[4:7], v[40:43], v[76:79], a[4:7]
    s_waitcnt lgkmcnt(5)
    v_mfma_f32_16x16x32_bf16 a[64:67], v[48:51], v[72:75], a[64:67]
    ds_read_b128 v[84:87], v14 offset:6144
    s_xor_b32 m0, s44, 1024
    v_mfma_f32_16x16x32_bf16 a[96:99], v[52:55], v[72:75], a[96:99]
    buffer_load_dwordx4 v5, s[8:11], s20 offen lds
    v_mfma_f32_16x16x32_bf16 a[100:103], v[52:55], v[76:79], a[100:103]
    s_add_u32 s20, s20, 128
    v_mfma_f32_16x16x32_bf16 a[68:71], v[48:51], v[76:79], a[68:71]
    s_waitcnt lgkmcnt(4)
    v_mfma_f32_16x16x32_bf16 a[128:131], v[56:59], v[72:75], a[128:131]
    s_mov_b64 vcc, 0
    s_xor_b32 m0, s44, 2048
    v_mfma_f32_16x16x32_bf16 a[160:163], v[60:63], v[72:75], a[160:163]
    buffer_load_dwordx4 v4, s[8:11], s21 offen lds
    v_mfma_f32_16x16x32_bf16 a[164:167], v[60:63], v[76:79], a[164:167]
    s_bitcmp1_b32 s43, 0
    s_cselect_b32 s61, s5, 0
    v_mfma_f32_16x16x32_bf16 a[132:135], v[56:59], v[76:79], a[132:135]
    s_lshl1_add_u32 s53, s61, s50
    s_waitcnt lgkmcnt(2)
    v_mfma_f32_16x16x32_bf16 a[192:195], v[64:67], v[72:75], a[192:195]
    s_bitcmp1_b32 s43, 1
    s_cselect_b32 s61, s51, 0
    v_mfma_f32_16x16x32_bf16 a[224:227], v[68:71], v[72:75], a[224:227]
    s_add_u32 s53, s53, s61
    s_bitcmp1_b32 s43, 2
    v_mfma_f32_16x16x32_bf16 a[228:231], v[68:71], v[76:79], a[228:231]
    s_cselect_b32 s61, s52, 0
    s_add_u32 s53, s53, s61
    v_mfma_f32_16x16x32_bf16 a[196:199], v[64:67], v[76:79], a[196:199]
    s_lshl_b32 s29, s43, 4
    s_waitcnt lgkmcnt(1)
    v_mfma_f32_16x16x32_bf16 a[8:11], v[40:43], v[80:83], a[8:11]
    s_mov_b64 vcc, -1
    s_xor_b32 m0, s44, 3072
    v_mfma_f32_16x16x32_bf16 a[40:43], v[44:47], v[80:83], a[40:43]
    buffer_load_dwordx4 v5, s[8:11], s21 offen lds
    s_waitcnt lgkmcnt(0)
    v_mfma_f32_16x16x32_bf16 a[44:47], v[44:47], v[84:87], a[44:47]
    ds_read_b128 v[72:75], v14 offset:8192
    s_add_u32 s21, s21, 128
    v_mfma_f32_16x16x32_bf16 a[12:15], v[40:43], v[84:87], a[12:15]
    s_xor_b32 m0, s44, 16384
    v_mfma_f32_16x16x32_bf16 a[72:75], v[48:51], v[80:83], a[72:75]
    ds_read_b128 v[76:79], v14 offset:10240
    buffer_load_dwordx4 v4, s[8:11], s22 offen lds
    v_mfma_f32_16x16x32_bf16 a[104:107], v[52:55], v[80:83], a[104:107]
    s_xor_b32 m0, s44, 17408
    v_mfma_f32_16x16x32_bf16 a[108:111], v[52:55], v[84:87], a[108:111]
    buffer_load_dwordx4 v5, s[8:11], s22 offen lds
    v_mfma_f32_16x16x32_bf16 a[76:79], v[48:51], v[84:87], a[76:79]
    s_add_u32 s22, s22, 128
    v_mfma_f32_16x16x32_bf16 a[136:139], v[56:59], v[80:83], a[136:139]
    s_xor_b32 m0, s44, 18432
    v_mfma_f32_16x16x32_bf16 a[168:171], v[60:63], v[80:83], a[168:171]
    buffer_load_dwordx4 v4, s[8:11], s23 offen lds
    v_mfma_f32_16x16x32_bf16 a[172:175], v[60:63], v[84:87], a[172:175]
    v_mfma_f32_16x16x32_bf16 a[140:143], v[56:59], v[84:87], a[140:143]
    v_mfma_f32_16x16x32_bf16 a[200:203], v[64:67], v[80:83], a[200:203]
    s_xor_b32 m0, s44, 19456
    v_mfma_f32_16x16x32_bf16 a[232:235], v[68:71], v[80:83], a[232:235]
    buffer_load_dwordx4 v5, s[8:11], s23 offen lds
    v_mfma_f32_16x16x32_bf16 a[236:239], v[68:71], v[84:87], a[236:239]
    s_add_u32 s23, s23, 128
    s_cmp_ge_u32 s44, 98304
    v_mfma_f32_16x16x32_bf16 a[204:207], v[64:67], v[84:87], a[204:207]
    s_cselect_b32 s60, s6, s7
    s_waitcnt lgkmcnt(1)
    v_mfma_f32_16x16x32_bf16 a[16:19], v[40:43], v[72:75], a[16:19]
    s_add_u32 s44, s44, s60
    v_mfma_f32_16x16x32_bf16 a[48:51], v[44:47], v[72:75], a[48:51]
    s_waitcnt lgkmcnt(0)
    v_mfma_f32_16x16x32_bf16 a[52:55], v[44:47], v[76:79], a[52:55]
    ds_read_b128 v[80:83], v14 offset:12288
    v_mfma_f32_16x16x32_bf16 a[20:23], v[40:43], v[76:79], a[20:23]
    v_mfma_f32_16x16x32_bf16 a[80:83], v[48:51], v[72:75], a[80:83]
    ds_read_b128 v[84:87], v14 offset:14336
    s_set_gpr_idx_on s29, gpr_idx(SRC0)
    v_mov_b32 v24, v128
    v_mov_b32 v25, v129
    v_mov_b32 v26, v130
    v_mov_b32 v27, v131
    s_set_gpr_idx_off
    v_mfma_f32_16x16x32_bf16 a[112:115], v[52:55], v[72:75], a[112:115]
    v_mfma_f32_16x16x32_bf16 a[116:119], v[52:55], v[76:79], a[116:119]
    s_set_gpr_idx_on s29, gpr_idx(SRC0)
    v_mov_b32 v28, v132
    v_mov_b32 v29, v133
    v_mov_b32 v30, v134
    v_mov_b32 v31, v135
    s_set_gpr_idx_off
    v_mfma_f32_16x16x32_bf16 a[84:87], v[48:51], v[76:79], a[84:87]
    v_mfma_f32_16x16x32_bf16 a[144:147], v[56:59], v[72:75], a[144:147]
    s_set_gpr_idx_on s29, gpr_idx(SRC0)
    v_mov_b32 v32, v136
    v_mov_b32 v33, v137
    v_mov_b32 v34, v138
    v_mov_b32 v35, v139
    s_set_gpr_idx_off
    v_mfma_f32_16x16x32_bf16 a[176:179], v[60:63], v[72:75], a[176:179]
    v_mfma_f32_16x16x32_bf16 a[180:183], v[60:63], v[76:79], a[180:183]
    s_set_gpr_idx_on s29, gpr_idx(SRC0)
    v_mov_b32 v36, v140
    v_mov_b32 v37, v141
    v_mov_b32 v38, v142
    v_mov_b32 v39, v143
    s_set_gpr_idx_off
    v_mfma_f32_16x16x32_bf16 a[148:151], v[56:59], v[76:79], a[148:151]
    v_mfma_f32_16x16x32_bf16 a[208:211], v[64:67], v[72:75], a[208:211]
    buffer_store_dwordx4 v[24:27], v2, s[16:19], s53 offen sc1
    v_mfma_f32_16x16x32_bf16 a[240:243], v[68:71], v[72:75], a[240:243]
    v_mfma_f32_16x16x32_bf16 a[244:247], v[68:71], v[76:79], a[244:247]
    buffer_store_dwordx4 v[28:31], v3, s[16:19], s53 offen sc1
    v_mfma_f32_16x16x32_bf16 a[212:215], v[64:67], v[76:79], a[212:215]
    s_add_u32 s53, s53, s5
    s_waitcnt lgkmcnt(1)
    v_mfma_f32_16x16x32_bf16 a[24:27], v[40:43], v[80:83], a[24:27]
    ds_read_b128 v[72:75], v15 offset:0
    buffer_store_dwordx4 v[32:35], v2, s[16:19], s53 offen sc1
    v_mfma_f32_16x16x32_bf16 a[56:59], v[44:47], v[80:83], a[56:59]
    ds_read_b128 v[76:79], v15 offset:2048
    s_waitcnt lgkmcnt(2)
    v_mfma_f32_16x16x32_bf16 a[60:63], v[44:47], v[84:87], a[60:63]
    ds_read_b128 v[44:47], v13 offset:2048
    buffer_store_dwordx4 v[36:39], v3, s[16:19], s53 offen sc1
    v_mfma_f32_16x16x32_bf16 a[28:31], v[40:43], v[84:87], a[28:31]
    ds_read_b128 v[40:43], v13 offset:0
    v_mfma_f32_16x16x32_bf16 a[88:91], v[48:51], v[80:83], a[88:91]
    v_mfma_f32_16x16x32_bf16 a[120:123], v[52:55], v[80:83], a[120:123]
    v_mfma_f32_16x16x32_bf16 a[124:127], v[52:55], v[84:87], a[124:127]
    ds_read_b128 v[52:55], v13 offset:6144
    v_mfma_f32_16x16x32_bf16 a[92:95], v[48:51], v[84:87], a[92:95]
    ds_read_b128 v[48:51], v13 offset:4096
    v_mfma_f32_16x16x32_bf16 a[152:155], v[56:59], v[80:83], a[152:155]
    v_mfma_f32_16x16x32_bf16 a[184:187], v[60:63], v[80:83], a[184:187]
    v_mfma_f32_16x16x32_bf16 a[188:191], v[60:63], v[84:87], a[188:191]
    ds_read_b128 v[60:63], v13 offset:10240
    v_mfma_f32_16x16x32_bf16 a[156:159], v[56:59], v[84:87], a[156:159]
    ds_read_b128 v[56:59], v13 offset:8192
    v_mfma_f32_16x16x32_bf16 a[216:219], v[64:67], v[80:83], a[216:219]
    v_mfma_f32_16x16x32_bf16 a[248:251], v[68:71], v[80:83], a[248:251]
    v_mfma_f32_16x16x32_bf16 a[252:255], v[68:71], v[84:87], a[252:255]
    ds_read_b128 v[68:71], v13 offset:14336
    v_mfma_f32_16x16x32_bf16 a[220:223], v[64:67], v[84:87], a[220:223]
    ds_read_b128 v[64:67], v13 offset:12288
    s_branch t_g1_b
t_g1_hook:
    s_cmp_eq_u32 s43, 1
    s_cbranch_scc1 t_g1_sig0
    s_cmp_lt_u32 s43, 8
    s_cbranch_scc1 t_g1_as
    s_cmp_eq_u32 s43, 14
    s_cbranch_scc1 t_g1_sws
    s_cmp_eq_u32 s43, 15
    s_cbranch_scc1 t_g1_swp
    s_cmp_lg_u32 s58, 0
    s_cbranch_scc1 t_g1_a
    s_cmp_eq_u32 s43, 13
    s_cbranch_scc1 t_g1_wait
    s_cmp_lg_u32 s43, 9
    s_cbranch_scc1 t_g1_a
    s_cmp_eq_u32 s4, 0
    s_cbranch_scc1 t_g1_a
    v_mov_b32 v24, s4
    v_mov_b32 v25, 1
    s_mov_b64 exec, 1
    global_atomic_add v24, v25, s[98:99] sc1
    s_mov_b64 exec, -1
    s_branch t_g1_a
t_g1_wait:
    s_cmp_eq_u32 s3, 0
    s_cbranch_scc1 t_g1_a
    s_mov_b32 s62, 0
L_sw_72:
    s_load_dword s63, s[98:99], s3 glc
    s_add_u32 s62, s62, 1
    s_cmp_gt_u32 s62, 0x200000
    s_cbranch_scc1 chain_kernel_wabort
    s_waitcnt lgkmcnt(0)
    s_cmp_ge_u32 s63, 32
    s_cbranch_scc1 L_swok_73
    s_sleep 16
    s_branch L_sw_72
L_swok_73:
    s_branch t_g1_a
t_g1_sig0:
    s_cmp_eq_u32 s1, 0
    s_cbranch_scc1 t_g1_as
    v_mov_b32 v24, s1
    v_mov_b32 v25, 1
    s_mov_b64 exec, 1
    global_atomic_add v24, v25, s[98:99] sc1
    s_mov_b64 exec, -1
    s_mov_b32 s1, 0
    s_branch t_g1_as
t_g1_sws:
    s_mov_b32 s12, s36
    s_mov_b32 s13, s37
    s_mov_b32 s14, s38
    s_and_b32 s45, s45, 0xffffb7ff
    s_bitcmp1_b32 s0, 3
    s_cselect_b32 s24, s41, 0
    s_cselect_b32 s26, 0, s41
    s_cselect_b32 s60, 0x4000, 0
    s_or_b32 s45, s45, s60
    s_add_u32 s24, s24, s39
    s_add_u32 s26, s26, s39
    s_bitcmp1_b32 s0, 2
    s_cselect_b32 s61, s40, 0
    s_cselect_b32 s62, 0, s40
    s_cselect_b32 s60, 0x800, 0
    s_or_b32 s45, s45, s60
    s_add_u32 s25, s24, s62
    s_add_u32 s24, s24, s61
    s_add_u32 s27, s26, s62
    s_add_u32 s26, s26, s61
    s_mov_b32 s28, s42
    v_mov_b32 v6, v10
    v_mov_b32 v7, v11
    s_branch t_g1_a
t_g1_swp:
    s_mov_b32 s8, s30
    s_mov_b32 s9, s31
    s_mov_b32 s10, s32
    s_and_b32 s44, s44, 0xffffb7ff
    s_bitcmp1_b32 s0, 1
    s_cselect_b32 s20, s35, 0
    s_cselect_b32 s22, 0, s35
    s_cselect_b32 s60, 0x4000, 0
    s_or_b32 s44, s44, s60
    s_add_u32 s20, s20, s33
    s_add_u32 s22, s22, s33
    s_bitcmp1_b32 s0, 0
    s_cselect_b32 s61, s34, 0
    s_cselect_b32 s62, 0, s34
    s_cselect_b32 s60, 0x800, 0
    s_or_b32 s44, s44, s60
    s_add_u32 s21, s20, s62
    s_add_u32 s20, s20, s61
    s_add_u32 s23, s22, s62
    s_add_u32 s22, s22, s61
    v_mov_b32 v4, v8
    v_mov_b32 v5, v9
t_g1_a:
    s_waitcnt lgkmcnt(6)
    v_mfma_f32_16x16x32_bf16 a[0:3], v[40:43], v[72:75], a[0:3]
    s_xor_b32 m0, s44, 0
    v_mfma_f32_16x16x32_bf16 a[32:35], v[44:47], v[72:75], a[32:35]
    buffer_load_dwordx4 v4, s[8:11], s20 offen lds
    v_mfma_f32_16x16x32_bf16 a[36:39], v[44:47], v[76:79], a[36:39]
    ds_read_b128 v[80:83], v14 offset:4096
    v_mfma_f32_16x16x32_bf16 a[4:7], v[40:43], v[76:79], a[4:7]
    s_waitcnt lgkmcnt(5)
    v_mfma_f32_16x16x32_bf16 a[64:67], v[48:51], v[72:75], a[64:67]
    ds_read_b128 v[84:87], v14 offset:6144
    s_xor_b32 m0, s44, 1024
    v_mfma_f32_16x16x32_bf16 a[96:99], v[52:55], v[72:75], a[96:99]
    buffer_load_dwordx4 v5, s[8:11], s20 offen lds
    v_mfma_f32_16x16x32_bf16 a[100:103], v[52:55], v[76:79], a[100:103]
    s_add_u32 s20, s20, 128
    v_mfma_f32_16x16x32_bf16 a[68:71], v[48:51], v[76:79], a[68:71]
    s_waitcnt lgkmcnt(4)
    v_mfma_f32_16x16x32_bf16 a[128:131], v[56:59], v[72:75], a[128:131]
    s_mov_b64 vcc, 0
    s_xor_b32 m0, s44, 2048
    v_mfma_f32_16x16x32_bf16 a[160:163], v[60:63], v[72:75], a[160:163]
    buffer_load_dwordx4 v4, s[8:11], s21 offen lds
    v_mfma_f32_16x16x32_bf16 a[164:167], v[60:63], v[76:79], a[164:167]
    v_mfma_f32_16x16x32_bf16 a[132:135], v[56:59], v[76:79], a[132:135]
    s_waitcnt lgkmcnt(2)
    v_mfma_f32_16x16x32_bf16 a[192:195], v[64:67], v[72:75], a[192:195]
    s_xor_b32 m0, s44, 3072
    v_mfma_f32_16x16x32_bf16 a[224:227], v[68:71], v[72:75], a[224:227]
    buffer_load_dwordx4 v5, s[8:11], s21 offen lds
    v_mfma_f32_16x16x32_bf16 a[228:231], v[68:71], v[76:79], a[228:231]
    s_add_u32 s21, s21, 128
    v_mfma_f32_16x16x32_bf16 a[196:199], v[64:67], v[76:79], a[196:199]
    s_waitcnt lgkmcnt(1)
    v_mfma_f32_16x16x32_bf16 a[8:11], v[40:43], v[80:83], a[8:11]
    s_xor_b32 m0, s44, 16384
    v_mfma_f32_16x16x32_bf16 a[40:43], v[44:47], v[80:83], a[40:43]
    buffer_load_dwordx4 v4, s[8:11], s22 offen lds
    s_waitcnt lgkmcnt(0)
    v_mfma_f32_16x16x32_bf16 a[44:47], v[44:47], v[84:87], a[44:47]
    ds_read_b128 v[72:75], v14 offset:8192
    v_mfma_f32_16x16x32_bf16 a[12:15], v[40:43], v[84:87], a[12:15]
    v_mfma_f32_16x16x32_bf16 a[72:75], v[48:51], v[80:83], a[72:75]
    ds_read_b128 v[76:79], v14 offset:10240
    s_xor_b32 m0, s44, 17408
    v_mfma_f32_16x16x32_bf16 a[104:107], v[52:55], v[80:83], a[104:107]
    buffer_load_dwordx4 v5, s[8:11], s22 offen lds
    v_mfma_f32_16x16x32_bf16 a[108:111], v[52:55], v[84:87], a[108:111]
    s_add_u32 s22, s22, 128
    v_mfma_f32_16x16x32_bf16 a[76:79], v[48:51], v[84:87], a[76:79]
    v_mfma_f32_16x16x32_bf16 a[136:139], v[56:59], v[80:83], a[136:139]
    s_xor_b32 m0, s44, 18432
    v_mfma_f32_16x16x32_bf16 a[168:171], v[60:63], v[80:83], a[168:171]
    buffer_load_dwordx4 v4, s[8:11], s23 offen lds
    v_mfma_f32_16x16x32_bf16 a[172:175], v[60:63], v[84:87], a[172:175]
    v_mfma_f32_16x16x32_bf16 a[140:143], v[56:59], v[84:87], a[140:143]
    v_mfma_f32_16x16x32_bf16 a[200:203], v[64:67], v[80:83], a[200:203]
    s_xor_b32 m0, s44, 19456
    v_mfma_f32_16x16x32_bf16 a[232:235], v[68:71], v[80:83], a[232:235]
    buffer_load_dwordx4 v5, s[8:11], s23 offen lds
    v_mfma_f32_16x16x32_bf16 a[236:239], v[68:71], v[84:87], a[236:239]
    s_add_u32 s23, s23, 128
    s_cmp_ge_u32 s44, 98304
    v_mfma_f32_16x16x32_bf16 a[204:207], v[64:67], v[84:87], a[204:207]
    s_cselect_b32 s60, s6, s7
    s_waitcnt lgkmcnt(1)
    v_mfma_f32_16x16x32_bf16 a[16:19], v[40:43], v[72:75], a[16:19]
    s_add_u32 s44, s44, s60
    v_mfma_f32_16x16x32_bf16 a[48:51], v[44:47], v[72:75], a[48:51]
    s_waitcnt lgkmcnt(0)
    v_mfma_f32_16x16x32_bf16 a[52:55], v[44:47], v[76:79], a[52:55]
    ds_read_b128 v[80:83], v14 offset:12288
    v_mfma_f32_16x16x32_bf16 a[20:23], v[40:43], v[76:79], a[20:23]
    v_mfma_f32_16x16x32_bf16 a[80:83], v[48:51], v[72:75], a[80:83]
    ds_read_b128 v[84:87], v14 offset:14336
    v_mfma_f32_16x16x32_bf16 a[112:115], v[52:55], v[72:75], a[112:115]
    v_mfma_f32_16x16x32_bf16 a[116:119], v[52:55], v[76:79], a[116:119]
    v_mfma_f32_16x16x32_bf16 a[84:87], v[48:51], v[76:79], a[84:87]
    v_mfma_f32_16x16x32_bf16 a[144:147], v[56:59], v[72:75], a[144:147]
    v_mfma_f32_16x16x32_bf16 a[176:179], v[60:63], v[72:75], a[176:179]
    v_mfma_f32_16x16x32_bf16 a[180:183], v[60:63], v[76:79], a[180:183]
    v_mfma_f32_16x16x32_bf16 a[148:151], v[56:59], v[76:79], a[148:151]
    v_mfma_f32_16x16x32_bf16 a[208:211], v[64:67], v[72:75], a[208:211]
    v_mfma_f32_16x16x32_bf16 a[240:243], v[68:71], v[72:75], a[240:243]
    v_mfma_f32_16x16x32_bf16 a[244:247], v[68:71], v[76:79], a[244:247]
    v_mfma_f32_16x16x32_bf16 a[212:215], v[64:67], v[76:79], a[212:215]
    s_waitcnt lgkmcnt(1)
    v_mfma_f32_16x16x32_bf16 a[24:27], v[40:43], v[80:83], a[24:27]
    ds_read_b128 v[72:75], v15 offset:0
    v_mfma_f32_16x16x32_bf16 a[56:59], v[44:47], v[80:83], a[56:59]
    ds_read_b128 v[76:79], v15 offset:2048
    s_waitcnt lgkmcnt(2)
    v_mfma_f32_16x16x32_bf16 a[60:63], v[44:47], v[84:87], a[60:63]
    ds_read_b128 v[44:47], v13 offset:2048
    v_mfma_f32_16x16x32_bf16 a[28:31], v[40:43], v[84:87], a[28:31]
    ds_read_b128 v[40:43], v13 offset:0
    v_mfma_f32_16x16x32_bf16 a[88:91], v[48:51], v[80:83], a[88:91]
    v_mfma_f32_16x16x32_bf16 a[120:123], v[52:55], v[80:83], a[120:123]
    v_mfma_f32_16x16x32_bf16 a[124:127], v[52:55], v[84:87], a[124:127]
    ds_read_b128 v[52:55], v13 offset:6144
    v_mfma_f32_16x16x32_bf16 a[92:95], v[48:51], v[84:87], a[92:95]
    ds_read_b128 v[48:51], v13 offset:4096
    v_mfma_f32_16x16x32_bf16 a[152:155], v[56:59], v[80:83], a[152:155]
    v_mfma_f32_16x16x32_bf16 a[184:187], v[60:63], v[80:83], a[184:187]
    v_mfma_f32_16x16x32_bf16 a[188:191], v[60:63], v[84:87], a[188:191]
    ds_read_b128 v[60:63], v13 offset:10240
    v_mfma_f32_16x16x32_bf16 a[156:159], v[56:59], v[84:87], a[156:159]
    ds_read_b128 v[56:59], v13 offset:8192
    v_mfma_f32_16x16x32_bf16 a[216:219], v[64:67], v[80:83], a[216:219]
    v_mfma_f32_16x16x32_bf16 a[248:251], v[68:71], v[80:83], a[248:251]
    v_mfma_f32_16x16x32_bf16 a[252:255], v[68:71], v[84:87], a[252:255]
    ds_read_b128 v[68:71], v13 offset:14336
    v_mfma_f32_16x16x32_bf16 a[220:223], v[64:67], v[84:87], a[220:223]
    ds_read_b128 v[64:67], v13 offset:12288
t_g1_b:
    s_waitcnt lgkmcnt(6)
    v_mfma_f32_16x16x32_bf16 a[0:3], v[40:43], v[72:75], a[0:3]
    v_mfma_f32_16x16x32_bf16 a[32:35], v[44:47], v[72:75], a[32:35]
    v_mfma_f32_16x16x32_bf16 a[36:39], v[44:47], v[76:79], a[36:39]
    ds_read_b128 v[80:83], v15 offset:4096
    v_mfma_f32_16x16x32_bf16 a[4:7], v[40:43], v[76:79], a[4:7]
    s_cmp_ge_u32 s48, 98304
    s_waitcnt lgkmcnt(5)
    v_mfma_f32_16x16x32_bf16 a[64:67], v[48:51], v[72:75], a[64:67]
    ds_read_b128 v[84:87], v15 offset:6144
    s_cselect_b32 s46, s6, s7
    v_mfma_f32_16x16x32_bf16 a[96:99], v[52:55], v[72:75], a[96:99]
    s_add_u32 s48, s48, s46
    v_mfma_f32_16x16x32_bf16 a[100:103], v[52:55], v[76:79], a[100:103]
    v_mfma_f32_16x16x32_bf16 a[68:71], v[48:51], v[76:79], a[68:71]
    s_cmp_ge_u32 s49, 98304
    s_waitcnt lgkmcnt(4)
    v_mfma_f32_16x16x32_bf16 a[128:131], v[56:59], v[72:75], a[128:131]
    s_cselect_b32 s47, s6, s7
    s_add_u32 s49, s49, s47
    v_mfma_f32_16x16x32_bf16 a[160:163], v[60:63], v[72:75], a[160:163]
    v_mfma_f32_16x16x32_bf16 a[164:167], v[60:63], v[76:79], a[164:167]
    v_mfma_f32_16x16x32_bf16 a[132:135], v[56:59], v[76:79], a[132:135]
    s_waitcnt lgkmcnt(2)
    v_mfma_f32_16x16x32_bf16 a[192:195], v[64:67], v[72:75], a[192:195]
    v_mfma_f32_16x16x32_bf16 a[224:227], v[68:71], v[72:75], a[224:227]
    v_mfma_f32_16x16x32_bf16 a[228:231], v[68:71], v[76:79], a[228:231]
    v_mfma_f32_16x16x32_bf16 a[196:199], v[64:67], v[76:79], a[196:199]
    s_waitcnt lgkmcnt(1)
    v_mfma_f32_16x16x32_bf16 a[8:11], v[40:43], v[80:83], a[8:11]
    s_xor_b32 m0, s45, 0
    v_mfma_f32_16x16x32_bf16 a[40:43], v[44:47], v[80:83], a[40:43]
    buffer_load_dwordx4 v6, s[12:15], s24 offen lds
    s_waitcnt lgkmcnt(0)
    v_mfma_f32_16x16x32_bf16 a[44:47], v[44:47], v[84:87], a[44:47]
    ds_read_b128 v[72:75], v15 offset:8192
    v_add_u32 v12, s46, v12
    v_mfma_f32_16x16x32_bf16 a[12:15], v[40:43], v[84:87], a[12:15]
    v_add_u32 v13, s46, v13
    v_add_u32 v14, s47, v14
    v_mfma_f32_16x16x32_bf16 a[72:75], v[48:51], v[80:83], a[72:75]
    ds_read_b128 v[76:79], v15 offset:10240
    s_xor_b32 m0, s45, 1024
    v_mfma_f32_16x16x32_bf16 a[104:107], v[52:55], v[80:83], a[104:107]
    buffer_load_dwordx4 v7, s[12:15], s24 offen lds
    v_mfma_f32_16x16x32_bf16 a[108:111], v[52:55], v[84:87], a[108:111]
    s_add_u32 s24, s24, s28
    v_mfma_f32_16x16x32_bf16 a[76:79], v[48:51], v[84:87], a[76:79]
    v_mfma_f32_16x16x32_bf16 a[136:139], v[56:59], v[80:83], a[136:139]
    s_xor_b32 m0, s45, 2048
    v_mfma_f32_16x16x32_bf16 a[168:171], v[60:63], v[80:83], a[168:171]
    buffer_load_dwordx4 v6, s[12:15], s25 offen lds
    v_mfma_f32_16x16x32_bf16 a[172:175], v[60:63], v[84:87], a[172:175]
    v_mfma_f32_16x16x32_bf16 a[140:143], v[56:59], v[84:87], a[140:143]
    v_mfma_f32_16x16x32_bf16 a[200:203], v[64:67], v[80:83], a[200:203]
    s_xor_b32 m0, s45, 3072
    v_mfma_f32_16x16x32_bf16 a[232:235], v[68:71], v[80:83], a[232:235]
    buffer_load_dwordx4 v7, s[12:15], s25 offen lds
    v_mfma_f32_16x16x32_bf16 a[236:239], v[68:71], v[84:87], a[236:239]
    s_add_u32 s25, s25, s28
    v_mfma_f32_16x16x32_bf16 a[204:207], v[64:67], v[84:87], a[204:207]
    s_waitcnt lgkmcnt(1)
    v_mfma_f32_16x16x32_bf16 a[16:19], v[40:43], v[72:75], a[16:19]
    s_xor_b32 m0, s45, 16384
    v_mfma_f32_16x16x32_bf16 a[48:51], v[44:47], v[72:75], a[48:51]
    buffer_load_dwordx4 v6, s[12:15], s26 offen lds
    s_waitcnt lgkmcnt(0)
    v_mfma_f32_16x16x32_bf16 a[52:55], v[44:47], v[76:79], a[52:55]
    ds_read_b128 v[80:83], v15 offset:12288
    v_mfma_f32_16x16x32_bf16 a[20:23], v[40:43], v[76:79], a[20:23]
    s_xor_b32 m0, s45, 17408
    v_mfma_f32_16x16x32_bf16 a[80:83], v[48:51], v[72:75], a[80:83]
    ds_read_b128 v[84:87], v15 offset:14336
    buffer_load_dwordx4 v7, s[12:15], s26 offen lds
    v_mfma_f32_16x16x32_bf16 a[112:115], v[52:55], v[72:75], a[112:115]
    s_add_u32 s26, s26, s28
    s_xor_b32 m0, s45, 18432
    v_mfma_f32_16x16x32_bf16 a[116:119], v[52:55], v[76:79], a[116:119]
    buffer_load_dwordx4 v6, s[12:15], s27 offen lds
    v_mfma_f32_16x16x32_bf16 a[84:87], v[48:51], v[76:79], a[84:87]
    s_xor_b32 m0, s45, 19456
    v_mfma_f32_16x16x32_bf16 a[144:147], v[56:59], v[72:75], a[144:147]
    buffer_load_dwordx4 v7, s[12:15], s27 offen lds
    v_mfma_f32_16x16x32_bf16 a[176:179], v[60:63], v[72:75], a[176:179]
    s_add_u32 s27, s27, s28
    s_cmp_ge_u32 s45, 98304
    v_mfma_f32_16x16x32_bf16 a[180:183], v[60:63], v[76:79], a[180:183]
    s_cselect_b32 s60, s6, s7
    s_add_u32 s45, s45, s60
    v_mfma_f32_16x16x32_bf16 a[148:151], v[56:59], v[76:79], a[148:151]
    v_add_u32 v15, s47, v15
    v_mfma_f32_16x16x32_bf16 a[208:211], v[64:67], v[72:75], a[208:211]
    s_add_u32 s43, s43, 1
    s_cmp_eq_u32 s43, 16
    v_mfma_f32_16x16x32_bf16 a[240:243], v[68:71], v[72:75], a[240:243]
    v_mfma_f32_16x16x32_bf16 a[244:247], v[68:71], v[76:79], a[244:247]
    v_mfma_f32_16x16x32_bf16 a[212:215], v[64:67], v[76:79], a[212:215]
    s_waitcnt vmcnt(12) lgkmcnt(0)
    s_cbranch_vccnz t_g1_bar
    s_waitcnt vmcnt(8)
t_g1_bar:
    s_barrier
    s_cbranch_scc1 t_g1_last
    v_mfma_f32_16x16x32_bf16 a[24:27], v[40:43], v[80:83], a[24:27]
    ds_read_b128 v[72:75], v14 offset:0
    v_mfma_f32_16x16x32_bf16 a[56:59], v[44:47], v[80:83], a[56:59]
    ds_read_b128 v[76:79], v14 offset:2048
    v_mfma_f32_16x16x32_bf16 a[60:63], v[44:47], v[84:87], a[60:63]
    ds_read_b128 v[44:47], v12 offset:2048
    v_mfma_f32_16x16x32_bf16 a[28:31], v[40:43], v[84:87], a[28:31]
    ds_read_b128 v[40:43], v12 offset:0
    v_mfma_f32_16x16x32_bf16 a[88:91], v[48:51], v[80:83], a[88:91]
    v_mfma_f32_16x16x32_bf16 a[120:123], v[52:55], v[80:83], a[120:123]
    v_mfma_f32_16x16x32_bf16 a[124:127], v[52:55], v[84:87], a[124:127]
    ds_read_b128 v[52:55], v12 offset:6144
    v_mfma_f32_16x16x32_bf16 a[92:95], v[48:51], v[84:87], a[92:95]
    ds_read_b128 v[48:51], v12 offset:4096
    v_mfma_f32_16x16x32_bf16 a[152:155], v[56:59], v[80:83], a[152:155]
    v_mfma_f32_16x16x32_bf16 a[184:187], v[60:63], v[80:83], a[184:187]
    v_mfma_f32_16x16x32_bf16 a[188:191], v[60:63], v[84:87], a[188:191]
    ds_read_b128 v[60:63], v12 offset:10240
    v_mfma_f32_16x16x32_bf16 a[156:159], v[56:59], v[84:87], a[156:159]
    ds_read_b128 v[56:59], v12 offset:8192
    v_mfma_f32_16x16x32_bf16 a[216:219], v[64:67], v[80:83], a[216:219]
    s_sub_u32 s61, s43, 10
    s_cmp_lt_u32 s61, 3
    v_mfma_f32_16x16x32_bf16 a[248:251], v[68:71], v[80:83], a[248:251]
    v_mfma_f32_16x16x32_bf16 a[252:255], v[68:71], v[84:87], a[252:255]
    ds_read_b128 v[68:71], v12 offset:14336
    v_mfma_f32_16x16x32_bf16 a[220:223], v[64:67], v[84:87], a[220:223]
    ds_read_b128 v[64:67], v12 offset:12288
    s_cbranch_scc1 t_g1_a
    s_branch t_g1_hook
t_g1_last:
    v_mfma_f32_16x16x32_bf16 a[24:27], v[40:43], v[80:83], a[24:27]
    v_mfma_f32_16x16x32_bf16 a[56:59], v[44:47], v[80:83], a[56:59]
    v_mfma_f32_16x16x32_bf16 a[60:63], v[44:47], v[84:87], a[60:63]
    v_mfma_f32_16x16x32_bf16 a[28:31], v[40:43], v[84:87], a[28:31]
    v_mfma_f32_16x16x32_bf16 a[88:91], v[48:51], v[80:83], a[88:91]
    v_mfma_f32_16x16x32_bf16 a[120:123], v[52:55], v[80:83], a[120:123]
    v_mfma_f32_16x16x32_bf16 a[124:127], v[52:55], v[84:87], a[124:127]
    v_mfma_f32_16x16x32_bf16 a[92:95], v[48:51], v[84:87], a[92:95]
    v_mfma_f32_16x16x32_bf16 a[152:155], v[56:59], v[80:83], a[152:155]
    v_mfma_f32_16x16x32_bf16 a[184:187], v[60:63], v[80:83], a[184:187]
    v_mfma_f32_16x16x32_bf16 a[188:191], v[60:63], v[84:87], a[188:191]
    v_mfma_f32_16x16x32_bf16 a[156:159], v[56:59], v[84:87], a[156:159]
    v_mfma_f32_16x16x32_bf16 a[216:219], v[64:67], v[80:83], a[216:219]
    v_mfma_f32_16x16x32_bf16 a[248:251], v[68:71], v[80:83], a[248:251]
    v_mfma_f32_16x16x32_bf16 a[252:255], v[68:71], v[84:87], a[252:255]
    v_mfma_f32_16x16x32_bf16 a[220:223], v[64:67], v[84:87], a[220:223]
    s_setpc_b64 s[54:55]
t_scan:
    s_nop 7
    v_accvgpr_read_b32 v40, a0
    v_accvgpr_read_b32 v42, a4
    v_accvgpr_read_b32 v44, a8
    v_accvgpr_read_b32 v46, a12
    v_accvgpr_read_b32 v41, a16
    v_accvgpr_read_b32 v43, a20
    v_accvgpr_read_b32 v45, a24
    v_accvgpr_read_b32 v47, a28
    v_accvgpr_read_b32 v48, a1
    v_accvgpr_read_b32 v50, a5
    v_accvgpr_read_b32 v52, a9
    v_accvgpr_read_b32 v54, a13
    v_accvgpr_read_b32 v49, a17
    v_accvgpr_read_b32 v51, a21
    v_accvgpr_read_b32 v53, a25
    v_accvgpr_read_b32 v55, a29
    v_pk_fma_f32 v[56:57], v[88:89], v[40:41], v[48:49] op_sel:[0,0,0] op_sel_hi:[0,1,1]
    v_pk_fma_f32 v[58:59], v[90:91], v[42:43], v[50:51] op_sel:[0,0,0] op_sel_hi:[0,1,1]
    v_pk_fma_f32 v[60:61], v[92:93], v[44:45], v[52:53] op_sel:[0,0,0] op_sel_hi:[0,1,1]
    v_pk_fma_f32 v[62:63], v[94:95], v[46:47], v[54:55] op_sel:[0,0,0] op_sel_hi:[0,1,1]
    v_pk_fma_f32 v[40:41], v[88:89], v[40:41], v[56:57] op_sel:[1,1,0] op_sel_hi:[1,0,1] neg_lo:[1,0,0]
    v_pk_fma_f32 v[42:43], v[90:91], v[42:43], v[58:59] op_sel:[1,1,0] op_sel_hi:[1,0,1] neg_lo:[1,0,0]
    v_pk_fma_f32 v[44:45], v[92:93], v[44:45], v[60:61] op_sel:[1,1,0] op_sel_hi:[1,0,1] neg_lo:[1,0,0]
    v_pk_fma_f32 v[46:47], v[94:95], v[46:47], v[62:63] op_sel:[1,1,0] op_sel_hi:[1,0,1] neg_lo:[1,0,0]
    v_accvgpr_read_b32 v64, a2
    v_accvgpr_read_b32 v66, a6
    v_accvgpr_read_b32 v68, a10
    v_accvgpr_read_b32 v70, a14
    v_accvgpr_read_b32 v65, a18
    v_accvgpr_read_b32 v67, a22
    v_accvgpr_read_b32 v69, a26
    v_accvgpr_read_b32 v71, a30
    v_pk_fma_f32 v[56:57], v[88:89], v[40:41], v[64:65] op_sel:[0,0,0] op_sel_hi:[0,1,1]
    v_pk_fma_f32 v[58:59], v[90:91], v[42:43], v[66:67] op_sel:[0,0,0] op_sel_hi:[0,1,1]
    v_pk_fma_f32 v[60:61], v[92:93], v[44:45], v[68:69] op_sel:[0,0,0] op_sel_hi:[0,1,1]
    v_pk_fma_f32 v[62:63], v[94:95], v[46:47], v[70:71] op_sel:[0,0,0] op_sel_hi:[0,1,1]
    v_pk_fma_f32 v[40:41], v[88:89], v[40:41], v[56:57] op_sel:[1,1,0] op_sel_hi:[1,0,1] neg_lo:[1,0,0]
    v_pk_fma_f32 v[42:43], v[90:91], v[42:43], v[58:59] op_sel:[1,1,0] op_sel_hi:[1,0,1] neg_lo:[1,0,0]
    v_pk_fma_f32 v[44:45], v[92:93], v[44:45], v[60:61] op_sel:[1,1,0] op_sel_hi:[1,0,1] neg_lo:[1,0,0]
    v_pk_fma_f32 v[46:47], v[94:95], v[46:47], v[62:63] op_sel:[1,1,0] op_sel_hi:[1,0,1] neg_lo:[1,0,0]
    v_accvgpr_read_b32 v48, a3
    v_accvgpr_read_b32 v50, a7
    v_accvgpr_read_b32 v52, a11
    v_accvgpr_read_b32 v54, a15
    v_accvgpr_read_b32 v49, a19
    v_accvgpr_read_b32 v51, a23
    v_accvgpr_read_b32 v53, a27
    v_accvgpr_read_b32 v55, a31
    v_pk_fma_f32 v[56:57], v[88:89], v[40:41], v[48:49] op_sel:[0,0,0] op_sel_hi:[0,1,1]
    v_pk_fma_f32 v[58:59], v[90:91], v[42:43], v[50:51] op_sel:[0,0,0] op_sel_hi:[0,1,1]
    v_pk_fma_f32 v[60:61], v[92:93], v[44:45], v[52:53] op_sel:[0,0,0] op_sel_hi:[0,1,1]
    v_pk_fma_f32 v[62:63], v[94:95], v[46:47], v[54:55] op_sel:[0,0,0] op_sel_hi:[0,1,1]
    v_pk_fma_f32 v[40:41], v[88:89], v[40:41], v[56:57] op_sel:[1,1,0] op_sel_hi:[1,0,1] neg_lo:[1,0,0]
    v_pk_fma_f32 v[42:43], v[90:91], v[42:43], v[58:59] op_sel:[1,1,0] op_sel_hi:[1,0,1] neg_lo:[1,0,0]
    v_pk_fma_f32 v[44:45], v[92:93], v[44:45], v[60:61] op_sel:[1,1,0] op_sel_hi:[1,0,1] neg_lo:[1,0,0]
    v_pk_fma_f32 v[46:47], v[94:95], v[46:47], v[62:63] op_sel:[1,1,0] op_sel_hi:[1,0,1] neg_lo:[1,0,0]
    v_accvgpr_read_b32 v64, a32
    v_accvgpr_read_b32 v66, a36
    v_accvgpr_read_b32 v68, a40
    v_accvgpr_read_b32 v70, a44
    v_accvgpr_read_b32 v65, a48
    v_accvgpr_read_b32 v67, a52
    v_accvgpr_read_b32 v69, a56
    v_accvgpr_read_b32 v71, a60
    v_pk_fma_f32 v[56:57], v[88:89], v[40:41], v[64:65] op_sel:[0,0,0] op_sel_hi:[0,1,1]
    v_pk_fma_f32 v[58:59], v[90:91], v[42:43], v[66:67] op_sel:[0,0,0] op_sel_hi:[0,1,1]
    v_pk_fma_f32 v[60:61], v[92:93], v[44:45], v[68:69] op_sel:[0,0,0] op_sel_hi:[0,1,1]
    v_pk_fma_f32 v[62:63], v[94:95], v[46:47], v[70:71] op_sel:[0,0,0] op_sel_hi:[0,1,1]
    v_pk_fma_f32 v[40:41], v[88:89], v[40:41], v[56:57] op_sel:[1,1,0] op_sel_hi:[1,0,1] neg_lo:[1,0,0]
    v_pk_fma_f32 v[42:43], v[90:91], v[42:43], v[58:59] op_sel:[1,1,0] op_sel_hi:[1,0,1] neg_lo:[1,0,0]
    v_pk_fma_f32 v[44:45], v[92:93], v[44:45], v[60:61] op_sel:[1,1,0] op_sel_hi:[1,0,1] neg_lo:[1,0,0]
    v_pk_fma_f32 v[46:47], v[94:95], v[46:47], v[62:63] op_sel:[1,1,0] op_sel_hi:[1,0,1] neg_lo:[1,0,0]
    v_accvgpr_read_b32 v48, a33
    v_accvgpr_read_b32 v50, a37
    v_accvgpr_read_b32 v52, a41
    v_accvgpr_read_b32 v54, a45
    v_accvgpr_read_b32 v49, a49
    v_accvgpr_read_b32 v51, a53
    v_accvgpr_read_b32 v53, a57
    v_accvgpr_read_b32 v55, a61
    v_pk_fma_f32 v[56:57], v[88:89], v[40:41], v[48:49] op_sel:[0,0,0] op_sel_hi:[0,1,1]
    v_pk_fma_f32 v[58:59], v[90:91], v[42:43], v[50:51] op_sel:[0,0,0] op_sel_hi:[0,1,1]
    v_pk_fma_f32 v[60:61], v[92:93], v[44:45], v[52:53] op_sel:[0,0,0] op_sel_hi:[0,1,1]
    v_pk_fma_f32 v[62:63], v[94:95], v[46:47], v[54:55] op_sel:[0,0,0] op_sel_hi:[0,1,1]
    v_pk_fma_f32 v[40:41], v[88:89], v[40:41], v[56:57] op_sel:[1,1,0] op_sel_hi:[1,0,1] neg_lo:[1,0,0]
    v_pk_fma_f32 v[42:43], v[90:91], v[42:43], v[58:59] op_sel:[1,1,0] op_sel_hi:[1,0,1] neg_lo:[1,0,0]
    v_pk_fma_f32 v[44:45], v[92:93], v[44:45], v[60:61] op_sel:[1,1,0] op_sel_hi:[1,0,1] neg_lo:[1,0,0]
    v_pk_fma_f32 v[46:47], v[94:95], v[46:47], v[62:63] op_sel:[1,1,0] op_sel_hi:[1,0,1] neg_lo:[1,0,0]
    v_accvgpr_read_b32 v64, a34
    v_accvgpr_read_b32 v66, a38
    v_accvgpr_read_b32 v68, a42
    v_accvgpr_read_b32 v70, a46
    v_accvgpr_read_b32 v65, a50
    v_accvgpr_read_b32 v67, a54
    v_accvgpr_read_b32 v69, a58
    v_accvgpr_read_b32 v71, a62
    v_pk_fma_f32 v[56:57], v[88:89], v[40:41], v[64:65] op_sel:[0,0,0] op_sel_hi:[0,1,1]
    v_pk_fma_f32 v[58:59], v[90:91], v[42:43], v[66:67] op_sel:[0,0,0] op_sel_hi:[0,1,1]
    v_pk_fma_f32 v[60:61], v[92:93], v[44:45], v[68:69] op_sel:[0,0,0] op_sel_hi:[0,1,1]
    v_pk_fma_f32 v[62:63], v[94:95], v[46:47], v[70:71] op_sel:[0,0,0] op_sel_hi:[0,1,1]
    v_pk_fma_f32 v[40:41], v[88:89], v[40:41], v[56:57] op_sel:[1,1,0] op_sel_hi:[1,0,1] neg_lo:[1,0,0]
    v_pk_fma_f32 v[42:43], v[90:91], v[42:43], v[58:59] op_sel:[1,1,0] op_sel_hi:[1,0,1] neg_lo:[1,0,0]
    v_pk_fma_f32 v[44:45], v[92:93], v[44:45], v[60:61] op_sel:[1,1,0] op_sel_hi:[1,0,1] neg_lo:[1,0,0]
    v_pk_fma_f32 v[46:47], v[94:95], v[46:47], v[62:63] op_sel:[1,1,0] op_sel_hi:[1,0,1] neg_lo:[1,0,0]
    v_accvgpr_read_b32 v48, a35
    v_accvgpr_read_b32 v50, a39
    v_accvgpr_read_b32 v52, a43
    v_accvgpr_read_b32 v54, a47
    v_accvgpr_read_b32 v49, a51
    v_accvgpr_read_b32 v51, a55
    v_accvgpr_read_b32 v53, a59
    v_accvgpr_read_b32 v55, a63
    v_pk_fma_f32 v[56:57], v[88:89], v[40:41], v[48:49] op_sel:[0,0,0] op_sel_hi:[0,1,1]
    v_pk_fma_f32 v[58:59], v[90:91], v[42:43], v[50:51] op_sel:[0,0,0] op_sel_hi:[0,1,1]
    v_pk_fma_f32 v[60:61], v[92:93], v[44:45], v[52:53] op_sel:[0,0,0] op_sel_hi:[0,1,1]
    v_pk_fma_f32 v[62:63], v[94:95], v[46:47], v[54:55] op_sel:[0,0,0] op_sel_hi:[0,1,1]
    v_pk_fma_f32 v[40:41], v[88:89], v[40:41], v[56:57] op_sel:[1,1,0] op_sel_hi:[1,0,1] neg_lo:[1,0,0]
    v_pk_fma_f32 v[42:43], v[90:91], v[42:43], v[58:59] op_sel:[1,1,0] op_sel_hi:[1,0,1] neg_lo:[1,0,0]
    v_pk_fma_f32 v[44:45], v[92:93], v[44:45], v[60:61] op_sel:[1,1,0] op_sel_hi:[1,0,1] neg_lo:[1,0,0]
    v_pk_fma_f32 v[46:47], v[94:95], v[46:47], v[62:63] op_sel:[1,1,0] op_sel_hi:[1,0,1] neg_lo:[1,0,0]
    v_accvgpr_read_b32 v64, a64
    v_accvgpr_read_b32 v66, a68
    v_accvgpr_read_b32 v68, a72
    v_accvgpr_read_b32 v70, a76
    v_accvgpr_read_b32 v65, a80
    v_accvgpr_read_b32 v67, a84
    v_accvgpr_read_b32 v69, a88
    v_accvgpr_read_b32 v71, a92
    v_pk_fma_f32 v[56:57], v[88:89], v[40:41], v[64:65] op_sel:[0,0,0] op_sel_hi:[0,1,1]
    v_pk_fma_f32 v[58:59], v[90:91], v[42:43], v[66:67] op_sel:[0,0,0] op_sel_hi:[0,1,1]
    v_pk_fma_f32 v[60:61], v[92:93], v[44:45], v[68:69] op_sel:[0,0,0] op_sel_hi:[0,1,1]
    v_pk_fma_f32 v[62:63], v[94:95], v[46:47], v[70:71] op_sel:[0,0,0] op_sel_hi:[0,1,1]
    v_pk_fma_f32 v[40:41], v[88:89], v[40:41], v[56:57] op_sel:[1,1,0] op_sel_hi:[1,0,1] neg_lo:[1,0,0]
    v_pk_fma_f32 v[42:43], v[90:91], v[42:43], v[58:59] op_sel:[1,1,0] op_sel_hi:[1,0,1] neg_lo:[1,0,0]
    v_pk_fma_f32 v[44:45], v[92:93], v[44:45], v[60:61] op_sel:[1,1,0] op_sel_hi:[1,0,1] neg_lo:[1,0,0]
    v_pk_fma_f32 v[46:47], v[94:95], v[46:47], v[62:63] op_sel:[1,1,0] op_sel_hi:[1,0,1] neg_lo:[1,0,0]
    v_accvgpr_read_b32 v48, a65
    v_accvgpr_read_b32 v50, a69
    v_accvgpr_read_b32 v52, a73
    v_accvgpr_read_b32 v54, a77
    v_accvgpr_read_b32 v49, a81
    v_accvgpr_read_b32 v51, a85
    v_accvgpr_read_b32 v53, a89
    v_accvgpr_read_b32 v55, a93
    v_pk_fma_f32 v[56:57], v[88:89], v[40:41], v[48:49] op_sel:[0,0,0] op_sel_hi:[0,1,1]
    v_pk_fma_f32 v[58:59], v[90:91], v[42:43], v[50:51] op_sel:[0,0,0] op_sel_hi:[0,1,1]
    v_pk_fma_f32 v[60:61], v[92:93], v[44:45], v[52:53] op_sel:[0,0,0] op_sel_hi:[0,1,1]
    v_pk_fma_f32 v[62:63], v[94:95], v[46:47], v[54:55] op_sel:[0,0,0] op_sel_hi:[0,1,1]
    v_pk_fma_f32 v[40:41], v[88:89], v[40:41], v[56:57] op_sel:[1,1,0] op_sel_hi:[1,0,1] neg_lo:[1,0,0]
    v_pk_fma_f32 v[42:43], v[90:91], v[42:43], v[58:59] op_sel:[1,1,0] op_sel_hi:[1,0,1] neg_lo:[1,0,0]
    v_pk_fma_f32 v[44:45], v[92:93], v[44:45], v[60:61] op_sel:[1,1,0] op_sel_hi:[1,0,1] neg_lo:[1,0,0]
    v_pk_fma_f32 v[46:47], v[94:95], v[46:47], v[62:63] op_sel:[1,1,0] op_sel_hi:[1,0,1] neg_lo:[1,0,0]
    v_accvgpr_read_b32 v64, a66
    v_accvgpr_read_b32 v66, a70
    v_accvgpr_read_b32 v68, a74
    v_accvgpr_read_b32 v70, a78
    v_accvgpr_read_b32 v65, a82
    v_accvgpr_read_b32 v67, a86
    v_accvgpr_read_b32 v69, a90
    v_accvgpr_read_b32 v71, a94
    v_pk_fma_f32 v[56:57], v[88:89], v[40:41], v[64:65] op_sel:[0,0,0] op_sel_hi:[0,1,1]
    v_pk_fma_f32 v[58:59], v[90:91], v[42:43], v[66:67] op_sel:[0,0,0] op_sel_hi:[0,1,1]
    v_pk_fma_f32 v[60:61], v[92:93], v[44:45], v[68:69] op_sel:[0,0,0] op_sel_hi:[0,1,1]
    v_pk_fma_f32 v[62:63], v[94:95], v[46:47], v[70:71] op_sel:[0,0,0] op_sel_hi:[0,1,1]
    v_pk_fma_f32 v[40:41], v[88:89], v[40:41], v[56:57] op_sel:[1,1,0] op_sel_hi:[1,0,1] neg_lo:[1,0,0]
    v_pk_fma_f32 v[42:43], v[90:91], v[42:43], v[58:59] op_sel:[1,1,0] op_sel_hi:[1,0,1] neg_lo:[1,0,0]
    v_pk_fma_f32 v[44:45], v[92:93], v[44:45], v[60:61] op_sel:[1,1,0] op_sel_hi:[1,0,1] neg_lo:[1,0,0]
    v_pk_fma_f32 v[46:47], v[94:95], v[46:47], v[62:63] op_sel:[1,1,0] op_sel_hi:[1,0,1] neg_lo:[1,0,0]
    v_accvgpr_read_b32 v48, a67
    v_accvgpr_read_b32 v50, a71
    v_accvgpr_read_b32 v52, a75
    v_accvgpr_read_b32 v54, a79
    v_accvgpr_read_b32 v49, a83
    v_accvgpr_read_b32 v51, a87
    v_accvgpr_read_b32 v53, a91
    v_accvgpr_read_b32 v55, a95
    v_pk_fma_f32 v[56:57], v[88:89], v[40:41], v[48:49] op_sel:[0,0,0] op_sel_hi:[0,1,1]
    v_pk_fma_f32 v[58:59], v[90:91], v[42:43], v[50:51] op_sel:[0,0,0] op_sel_hi:[0,1,1]
    v_pk_fma_f32 v[60:61], v[92:93], v[44:45], v[52:53] op_sel:[0,0,0] op_sel_hi:[0,1,1]
    v_pk_fma_f32 v[62:63], v[94:95], v[46:47], v[54:55] op_sel:[0,0,0] op_sel_hi:[0,1,1]
    v_pk_fma_f32 v[40:41], v[88:89], v[40:41], v[56:57] op_sel:[1,1,0] op_sel_hi:[1,0,1] neg_lo:[1,0,0]
    v_pk_fma_f32 v[42:43], v[90:91], v[42:43], v[58:59] op_sel:[1,1,0] op_sel_hi:[1,0,1] neg_lo:[1,0,0]
    v_pk_fma_f32 v[44:45], v[92:93], v[44:45], v[60:61] op_sel:[1,1,0] op_sel_hi:[1,0,1] neg_lo:[1,0,0]
    v_pk_fma_f32 v[46:47], v[94:95], v[46:47], v[62:63] op_sel:[1,1,0] op_sel_hi:[1,0,1] neg_lo:[1,0,0]
    v_accvgpr_read_b32 v64, a96
    v_accvgpr_read_b32 v66, a100
    v_accvgpr_read_b32 v68, a104
    v_accvgpr_read_b32 v70, a108
    v_accvgpr_read_b32 v65, a112
    v_accvgpr_read_b32 v67, a116
    v_accvgpr_read_b32 v69, a120
    v_accvgpr_read_b32 v71, a124
    v_pk_fma_f32 v[56:57], v[88:89], v[40:41], v[64:65] op_sel:[0,0,0] op_sel_hi:[0,1,1]
    v_pk_fma_f32 v[58:59], v[90:91], v[42:43], v[66:67] op_sel:[0,0,0] op_sel_hi:[0,1,1]
    v_pk_fma_f32 v[60:61], v[92:93], v[44:45], v[68:69] op_sel:[0,0,0] op_sel_hi:[0,1,1]
    v_pk_fma_f32 v[62:63], v[94:95], v[46:47], v[70:71] op_sel:[0,0,0] op_sel_hi:[0,1,1]
    v_pk_fma_f32 v[40:41], v[88:89], v[40:41], v[56:57] op_sel:[1,1,0] op_sel_hi:[1,0,1] neg_lo:[1,0,0]
    v_pk_fma_f32 v[42:43], v[90:91], v[42:43], v[58:59] op_sel:[1,1,0] op_sel_hi:[1,0,1] neg_lo:[1,0,0]
    v_pk_fma_f32 v[44:45], v[92:93], v[44:45], v[60:61] op_sel:[1,1,0] op_sel_hi:[1,0,1] neg_lo:[1,0,0]
    v_pk_fma_f32 v[46:47], v[94:95], v[46:47], v[62:63] op_sel:[1,1,0] op_sel_hi:[1,0,1] neg_lo:[1,0,0]
    v_accvgpr_read_b32 v48, a97
    v_accvgpr_read_b32 v50, a101
    v_accvgpr_read_b32 v52, a105
    v_accvgpr_read_b32 v54, a109
    v_accvgpr_read_b32 v49, a113
    v_accvgpr_read_b32 v51, a117
    v_accvgpr_read_b32 v53, a121
    v_accvgpr_read_b32 v55, a125
    v_pk_fma_f32 v[56:57], v[88:89], v[40:41], v[48:49] op_sel:[0,0,0] op_sel_hi:[0,1,1]
    v_pk_fma_f32 v[58:59], v[90:91], v[42:43], v[50:51] op_sel:[0,0,0] op_sel_hi:[0,1,1]
    v_pk_fma_f32 v[60:61], v[92:93], v[44:45], v[52:53] op_sel:[0,0,0] op_sel_hi:[0,1,1]
    v_pk_fma_f32 v[62:63], v[94:95], v[46:47], v[54:55] op_sel:[0,0,0] op_sel_hi:[0,1,1]
    v_pk_fma_f32 v[40:41], v[88:89], v[40:41], v[56:57] op_sel:[1,1,0] op_sel_hi:[1,0,1] neg_lo:[1,0,0]
    v_pk_fma_f32 v[42:43], v[90:91], v[42:43], v[58:59] op_sel:[1,1,0] op_sel_hi:[1,0,1] neg_lo:[1,0,0]
    v_pk_fma_f32 v[44:45], v[92:93], v[44:45], v[60:61] op_sel:[1,1,0] op_sel_hi:[1,0,1] neg_lo:[1,0,0]
    v_pk_fma_f32 v[46:47], v[94:95], v[46:47], v[62:63] op_sel:[1,1,0] op_sel_hi:[1,0,1] neg_lo:[1,0,0]
    v_accvgpr_read_b32 v64, a98
    v_accvgpr_read_b32 v66, a102
    v_accvgpr_read_b32 v68, a106
    v_accvgpr_read_b32 v70, a110
    v_accvgpr_read_b32 v65, a114
    v_accvgpr_read_b32 v67, a118
    v_accvgpr_read_b32 v69, a122
    v_accvgpr_read_b32 v71, a126
    v_pk_fma_f32 v[56:57], v[88:89], v[40:41], v[64:65] op_sel:[0,0,0] op_sel_hi:[0,1,1]
    v_pk_fma_f32 v[58:59], v[90:91], v[42:43], v[66:67] op_sel:[0,0,0] op_sel_hi:[0,1,1]
    v_pk_fma_f32 v[60:61], v[92:93], v[44:45], v[68:69] op_sel:[0,0,0] op_sel_hi:[0,1,1]
    v_pk_fma_f32 v[62:63], v[94:95], v[46:47], v[70:71] op_sel:[0,0,0] op_sel_hi:[0,1,1]
    v_pk_fma_f32 v[40:41], v[88:89], v[40:41], v[56:57] op_sel:[1,1,0] op_sel_hi:[1,0,1] neg_lo:[1,0,0]
    v_pk_fma_f32 v[42:43], v[90:91], v[42:43], v[58:59] op_sel:[1,1,0] op_sel_hi:[1,0,1] neg_lo:[1,0,0]
    v_pk_fma_f32 v[44:45], v[92:93], v[44:45], v[60:61] op_sel:[1,1,0] op_sel_hi:[1,0,1] neg_lo:[1,0,0]
    v_pk_fma_f32 v[46:47], v[94:95], v[46:47], v[62:63] op_sel:[1,1,0] op_sel_hi:[1,0,1] neg_lo:[1,0,0]
    v_accvgpr_read_b32 v48, a99
    v_accvgpr_read_b32 v50, a103
    v_accvgpr_read_b32 v52, a107
    v_accvgpr_read_b32 v54, a111
    v_accvgpr_read_b32 v49, a115
    v_accvgpr_read_b32 v51, a119
    v_accvgpr_read_b32 v53, a123
    v_accvgpr_read_b32 v55, a127
    v_pk_fma_f32 v[56:57], v[88:89], v[40:41], v[48:49] op_sel:[0,0,0] op_sel_hi:[0,1,1]
    v_pk_fma_f32 v[58:59], v[90:91], v[42:43], v[50:51] op_sel:[0,0,0] op_sel_hi:[0,1,1]
    v_pk_fma_f32 v[60:61], v[92:93], v[44:45], v[52:53] op_sel:[0,0,0] op_sel_hi:[0,1,1]
    v_pk_fma_f32 v[62:63], v[94:95], v[46:47], v[54:55] op_sel:[0,0,0] op_sel_hi:[0,1,1]
    v_pk_fma_f32 v[40:41], v[88:89], v[40:41], v[56:57] op_sel:[1,1,0] op_sel_hi:[1,0,1] neg_lo:[1,0,0]
    v_pk_fma_f32 v[42:43], v[90:91], v[42:43], v[58:59] op_sel:[1,1,0] op_sel_hi:[1,0,1] neg_lo:[1,0,0]
    v_pk_fma_f32 v[44:45], v[92:93], v[44:45], v[60:61] op_sel:[1,1,0] op_sel_hi:[1,0,1] neg_lo:[1,0,0]
    v_pk_fma_f32 v[46:47], v[94:95], v[46:47], v[62:63] op_sel:[1,1,0] op_sel_hi:[1,0,1] neg_lo:[1,0,0]
    v_accvgpr_read_b32 v64, a128
    v_accvgpr_read_b32 v66, a132
    v_accvgpr_read_b32 v68, a136
    v_accvgpr_read_b32 v70, a140
    v_accvgpr_read_b32 v65, a144
    v_accvgpr_read_b32 v67, a148
    v_accvgpr_read_b32 v69, a152
    v_accvgpr_read_b32 v71, a156
    v_pk_fma_f32 v[56:57], v[88:89], v[40:41], v[64:65] op_sel:[0,0,0] op_sel_hi:[0,1,1]
    v_pk_fma_f32 v[58:59], v[90:91], v[42:43], v[66:67] op_sel:[0,0,0] op_sel_hi:[0,1,1]
    v_pk_fma_f32 v[60:61], v[92:93], v[44:45], v[68:69] op_sel:[0,0,0] op_sel_hi:[0,1,1]
    v_pk_fma_f32 v[62:63], v[94:95], v[46:47], v[70:71] op_sel:[0,0,0] op_sel_hi:[0,1,1]
    v_pk_fma_f32 v[40:41], v[88:89], v[40:41], v[56:57] op_sel:[1,1,0] op_sel_hi:[1,0,1] neg_lo:[1,0,0]
    v_pk_fma_f32 v[42:43], v[90:91], v[42:43], v[58:59] op_sel:[1,1,0] op_sel_hi:[1,0,1] neg_lo:[1,0,0]
    v_pk_fma_f32 v[44:45], v[92:93], v[44:45], v[60:61] op_sel:[1,1,0] op_sel_hi:[1,0,1] neg_lo:[1,0,0]
    v_pk_fma_f32 v[46:47], v[94:95], v[46:47], v[62:63] op_sel:[1,1,0] op_sel_hi:[1,0,1] neg_lo:[1,0,0]
    v_accvgpr_read_b32 v48, a129
    v_accvgpr_read_b32 v50, a133
    v_accvgpr_read_b32 v52, a137
    v_accvgpr_read_b32 v54, a141
    v_accvgpr_read_b32 v49, a145
    v_accvgpr_read_b32 v51, a149
    v_accvgpr_read_b32 v53, a153
    v_accvgpr_read_b32 v55, a157
    v_pk_fma_f32 v[56:57], v[88:89], v[40:41], v[48:49] op_sel:[0,0,0] op_sel_hi:[0,1,1]
    v_pk_fma_f32 v[58:59], v[90:91], v[42:43], v[50:51] op_sel:[0,0,0] op_sel_hi:[0,1,1]
    v_pk_fma_f32 v[60:61], v[92:93], v[44:45], v[52:53] op_sel:[0,0,0] op_sel_hi:[0,1,1]
    v_pk_fma_f32 v[62:63], v[94:95], v[46:47], v[54:55] op_sel:[0,0,0] op_sel_hi:[0,1,1]
    v_pk_fma_f32 v[40:41], v[88:89], v[40:41], v[56:57] op_sel:[1,1,0] op_sel_hi:[1,0,1] neg_lo:[1,0,0]
    v_pk_fma_f32 v[42:43], v[90:91], v[42:43], v[58:59] op_sel:[1,1,0] op_sel_hi:[1,0,1] neg_lo:[1,0,0]
    v_pk_fma_f32 v[44:45], v[92:93], v[44:45], v[60:61] op_sel:[1,1,0] op_sel_hi:[1,0,1] neg_lo:[1,0,0]
    v_pk_fma_f32 v[46:47], v[94:95], v[46:47], v[62:63] op_sel:[1,1,0] op_sel_hi:[1,0,1] neg_lo:[1,0,0]
    v_accvgpr_read_b32 v64, a130
    v_accvgpr_read_b32 v66, a134
    v_accvgpr_read_b32 v68, a138
    v_accvgpr_read_b32 v70, a142
    v_accvgpr_read_b32 v65, a146
    v_accvgpr_read_b32 v67, a150
    v_accvgpr_read_b32 v69, a154
    v_accvgpr_read_b32 v71, a158
    v_pk_fma_f32 v[56:57], v[88:89], v[40:41], v[64:65] op_sel:[0,0,0] op_sel_hi:[0,1,1]
    v_pk_fma_f32 v[58:59], v[90:91], v[42:43], v[66:67] op_sel:[0,0,0] op_sel_hi:[0,1,1]
    v_pk_fma_f32 v[60:61], v[92:93], v[44:45], v[68:69] op_sel:[0,0,0] op_sel_hi:[0,1,1]
    v_pk_fma_f32 v[62:63], v[94:95], v[46:47], v[70:71] op_sel:[0,0,0] op_sel_hi:[0,1,1]
    v_pk_fma_f32 v[40:41], v[88:89], v[40:41], v[56:57] op_sel:[1,1,0] op_sel_hi:[1,0,1] neg_lo:[1,0,0]
    v_pk_fma_f32 v[42:43], v[90:91], v[42:43], v[58:59] op_sel:[1,1,0] op_sel_hi:[1,0,1] neg_lo:[1,0,0]
    v_pk_fma_f32 v[44:45], v[92:93], v[44:45], v[60:61] op_sel:[1,1,0] op_sel_hi:[1,0,1] neg_lo:[1,0,0]
    v_pk_fma_f32 v[46:47], v[94:95], v[46:47], v[62:63] op_sel:[1,1,0] op_sel_hi:[1,0,1] neg_lo:[1,0,0]
    v_accvgpr_read_b32 v48, a131
    v_accvgpr_read_b32 v50, a135
    v_accvgpr_read_b32 v52, a139
    v_accvgpr_read_b32 v54, a143
    v_accvgpr_read_b32 v49, a147
    v_accvgpr_read_b32 v51, a151
    v_accvgpr_read_b32 v53, a155
    v_accvgpr_read_b32 v55, a159
    v_pk_fma_f32 v[56:57], v[88:89], v[40:41], v[48:49] op_sel:[0,0,0] op_sel_hi:[0,1,1]
    v_pk_fma_f32 v[58:59], v[90:91], v[42:43], v[50:51] op_sel:[0,0,0] op_sel_hi:[0,1,1]
    v_pk_fma_f32 v[60:61], v[92:93], v[44:45], v[52:53] op_sel:[0,0,0] op_sel_hi:[0,1,1]
    v_pk_fma_f32 v[62:63], v[94:95], v[46:47], v[54:55] op_sel:[0,0,0] op_sel_hi:[0,1,1]
    v_pk_fma_f32 v[40:41], v[88:89], v[40:41], v[56:57] op_sel:[1,1,0] op_sel_hi:[1,0,1] neg_lo:[1,0,0]
    v_pk_fma_f32 v[42:43], v[90:91], v[42:43], v[58:59] op_sel:[1,1,0] op_sel_hi:[1,0,1] neg_lo:[1,0,0]
    v_pk_fma_f32 v[44:45], v[92:93], v[44:45], v[60:61] op_sel:[1,1,0] op_sel_hi:[1,0,1] neg_lo:[1,0,0]
    v_pk_fma_f32 v[46:47], v[94:95], v[46:47], v[62:63] op_sel:[1,1,0] op_sel_hi:[1,0,1] neg_lo:[1,0,0]
    v_accvgpr_read_b32 v64, a160
    v_accvgpr_read_b32 v66, a164
    v_accvgpr_read_b32 v68, a168
    v_accvgpr_read_b32 v70, a172
    v_accvgpr_read_b32 v65, a176
    v_accvgpr_read_b32 v67, a180
    v_accvgpr_read_b32 v69, a184
    v_accvgpr_read_b32 v71, a188
    v_pk_fma_f32 v[56:57], v[88:89], v[40:41], v[64:65] op_sel:[0,0,0] op_sel_hi:[0,1,1]
    v_pk_fma_f32 v[58:59], v[90:91], v[42:43], v[66:67] op_sel:[0,0,0] op_sel_hi:[0,1,1]
    v_pk_fma_f32 v[60:61], v[92:93], v[44:45], v[68:69] op_sel:[0,0,0] op_sel_hi:[0,1,1]
    v_pk_fma_f32 v[62:63], v[94:95], v[46:47], v[70:71] op_sel:[0,0,0] op_sel_hi:[0,1,1]
    v_pk_fma_f32 v[40:41], v[88:89], v[40:41], v[56:57] op_sel:[1,1,0] op_sel_hi:[1,0,1] neg_lo:[1,0,0]
    v_pk_fma_f32 v[42:43], v[90:91], v[42:43], v[58:59] op_sel:[1,1,0] op_sel_hi:[1,0,1] neg_lo:[1,0,0]
    v_pk_fma_f32 v[44:45], v[92:93], v[44:45], v[60:61] op_sel:[1,1,0] op_sel_hi:[1,0,1] neg_lo:[1,0,0]
    v_pk_fma_f32 v[46:47], v[94:95], v[46:47], v[62:63] op_sel:[1,1,0] op_sel_hi:[1,0,1] neg_lo:[1,0,0]
    v_accvgpr_read_b32 v48, a161
    v_accvgpr_read_b32 v50, a165
    v_accvgpr_read_b32 v52, a169
    v_accvgpr_read_b32 v54, a173
    v_accvgpr_read_b32 v49, a177
    v_accvgpr_read_b32 v51, a181
    v_accvgpr_read_b32 v53, a185
    v_accvgpr_read_b32 v55, a189
    v_pk_fma_f32 v[56:57], v[88:89], v[40:41], v[48:49] op_sel:[0,0,0] op_sel_hi:[0,1,1]
    v_pk_fma_f32 v[58:59], v[90:91], v[42:43], v[50:51] op_sel:[0,0,0] op_sel_hi:[0,1,1]
    v_pk_fma_f32 v[60:61], v[92:93], v[44:45], v[52:53] op_sel:[0,0,0] op_sel_hi:[0,1,1]
    v_pk_fma_f32 v[62:63], v[94:95], v[46:47], v[54:55] op_sel:[0,0,0] op_sel_hi:[0,1,1]
    v_pk_fma_f32 v[40:41], v[88:89], v[40:41], v[56:57] op_sel:[1,1,0] op_sel_hi:[1,0,1] neg_lo:[1,0,0]
    v_pk_fma_f32 v[42:43], v[90:91], v[42:43], v[58:59] op_sel:[1,1,0] op_sel_hi:[1,0,1] neg_lo:[1,0,0]
    v_pk_fma_f32 v[44:45], v[92:93], v[44:45], v[60:61] op_sel:[1,1,0] op_sel_hi:[1,0,1] neg_lo:[1,0,0]
    v_pk_fma_f32 v[46:47], v[94:95], v[46:47], v[62:63] op_sel:[1,1,0] op_sel_hi:[1,0,1] neg_lo:[1,0,0]
    v_accvgpr_read_b32 v64, a162
    v_accvgpr_read_b32 v66, a166
    v_accvgpr_read_b32 v68, a170
    v_accvgpr_read_b32 v70, a174
    v_accvgpr_read_b32 v65, a178
    v_accvgpr_read_b32 v67, a182
    v_accvgpr_read_b32 v69, a186
    v_accvgpr_read_b32 v71, a190
    v_pk_fma_f32 v[56:57], v[88:89], v[40:41], v[64:65] op_sel:[0,0,0] op_sel_hi:[0,1,1]
    v_pk_fma_f32 v[58:59], v[90:91], v[42:43], v[66:67] op_sel:[0,0,0] op_sel_hi:[0,1,1]
    v_pk_fma_f32 v[60:61], v[92:93], v[44:45], v[68:69] op_sel:[0,0,0] op_sel_hi:[0,1,1]
    v_pk_fma_f32 v[62:63], v[94:95], v[46:47], v[70:71] op_sel:[0,0,0] op_sel_hi:[0,1,1]
    v_pk_fma_f32 v[40:41], v[88:89], v[40:41], v[56:57] op_sel:[1,1,0] op_sel_hi:[1,0,1] neg_lo:[1,0,0]
    v_pk_fma_f32 v[42:43], v[90:91], v[42:43], v[58:59] op_sel:[1,1,0] op_sel_hi:[1,0,1] neg_lo:[1,0,0]
    v_pk_fma_f32 v[44:45], v[92:93], v[44:45], v[60:61] op_sel:[1,1,0] op_sel_hi:[1,0,1] neg_lo:[1,0,0]
    v_pk_fma_f32 v[46:47], v[94:95], v[46:47], v[62:63] op_sel:[1,1,0] op_sel_hi:[1,0,1] neg_lo:[1,0,0]
    v_accvgpr_read_b32 v48, a163
    v_accvgpr_read_b32 v50, a167
    v_accvgpr_read_b32 v52, a171
    v_accvgpr_read_b32 v54, a175
    v_accvgpr_read_b32 v49, a179
    v_accvgpr_read_b32 v51, a183
    v_accvgpr_read_b32 v53, a187
    v_accvgpr_read_b32 v55, a191
    v_pk_fma_f32 v[56:57], v[88:89], v[40:41], v[48:49] op_sel:[0,0,0] op_sel_hi:[0,1,1]
    v_pk_fma_f32 v[58:59], v[90:91], v[42:43], v[50:51] op_sel:[0,0,0] op_sel_hi:[0,1,1]
    v_pk_fma_f32 v[60:61], v[92:93], v[44:45], v[52:53] op_sel:[0,0,0] op_sel_hi:[0,1,1]
    v_pk_fma_f32 v[62:63], v[94:95], v[46:47], v[54:55] op_sel:[0,0,0] op_sel_hi:[0,1,1]
    v_pk_fma_f32 v[40:41], v[88:89], v[40:41], v[56:57] op_sel:[1,1,0] op_sel_hi:[1,0,1] neg_lo:[1,0,0]
    v_pk_fma_f32 v[42:43], v[90:91], v[42:43], v[58:59] op_sel:[1,1,0] op_sel_hi:[1,0,1] neg_lo:[1,0,0]
    v_pk_fma_f32 v[44:45], v[92:93], v[44:45], v[60:61] op_sel:[1,1,0] op_sel_hi:[1,0,1] neg_lo:[1,0,0]
    v_pk_fma_f32 v[46:47], v[94:95], v[46:47], v[62:63] op_sel:[1,1,0] op_sel_hi:[1,0,1] neg_lo:[1,0,0]
    v_accvgpr_read_b32 v64, a192
    v_accvgpr_read_b32 v66, a196
    v_accvgpr_read_b32 v68, a200
    v_accvgpr_read_b32 v70, a204
    v_accvgpr_read_b32 v65, a208
    v_accvgpr_read_b32 v67, a212
    v_accvgpr_read_b32 v69, a216
    v_accvgpr_read_b32 v71, a220
    v_pk_fma_f32 v[56:57], v[88:89], v[40:41], v[64:65] op_sel:[0,0,0] op_sel_hi:[0,1,1]
    v_pk_fma_f32 v[58:59], v[90:91], v[42:43], v[66:67] op_sel:[0,0,0] op_sel_hi:[0,1,1]
    v_pk_fma_f32 v[60:61], v[92:93], v[44:45], v[68:69] op_sel:[0,0,0] op_sel_hi:[0,1,1]
    v_pk_fma_f32 v[62:63], v[94:95], v[46:47], v[70:71] op_sel:[0,0,0] op_sel_hi:[0,1,1]
    v_pk_fma_f32 v[40:41], v[88:89], v[40:41], v[56:57] op_sel:[1,1,0] op_sel_hi:[1,0,1] neg_lo:[1,0,0]
    v_pk_fma_f32 v[42:43], v[90:91], v[42:43], v[58:59] op_sel:[1,1,0] op_sel_hi:[1,0,1] neg_lo:[1,0,0]
    v_pk_fma_f32 v[44:45], v[92:93], v[44:45], v[60:61] op_sel:[1,1,0] op_sel_hi:[1,0,1] neg_lo:[1,0,0]
    v_pk_fma_f32 v[46:47], v[94:95], v[46:47], v[62:63] op_sel:[1,1,0] op_sel_hi:[1,0,1] neg_lo:[1,0,0]
    v_accvgpr_read_b32 v48, a193
    v_accvgpr_read_b32 v50, a197
    v_accvgpr_read_b32 v52, a201
    v_accvgpr_read_b32 v54, a205
    v_accvgpr_read_b32 v49, a209
    v_accvgpr_read_b32 v51, a213
    v_accvgpr_read_b32 v53, a217
    v_accvgpr_read_b32 v55, a221
    v_pk_fma_f32 v[56:57], v[88:89], v[40:41], v[48:49] op_sel:[0,0,0] op_sel_hi:[0,1,1]
    v_pk_fma_f32 v[58:59], v[90:91], v[42:43], v[50:51] op_sel:[0,0,0] op_sel_hi:[0,1,1]
    v_pk_fma_f32 v[60:61], v[92:93], v[44:45], v[52:53] op_sel:[0,0,0] op_sel_hi:[0,1,1]
    v_pk_fma_f32 v[62:63], v[94:95], v[46:47], v[54:55] op_sel:[0,0,0] op_sel_hi:[0,1,1]
    v_pk_fma_f32 v[40:41], v[88:89], v[40:41], v[56:57] op_sel:[1,1,0] op_sel_hi:[1,0,1] neg_lo:[1,0,0]
    v_pk_fma_f32 v[42:43], v[90:91], v[42:43], v[58:59] op_sel:[1,1,0] op_sel_hi:[1,0,1] neg_lo:[1,0,0]
    v_pk_fma_f32 v[44:45], v[92:93], v[44:45], v[60:61] op_sel:[1,1,0] op_sel_hi:[1,0,1] neg_lo:[1,0,0]
    v_pk_fma_f32 v[46:47], v[94:95], v[46:47], v[62:63] op_sel:[1,1,0] op_sel_hi:[1,0,1] neg_lo:[1,0,0]
    v_accvgpr_read_b32 v64, a194
    v_accvgpr_read_b32 v66, a198
    v_accvgpr_read_b32 v68, a202
    v_accvgpr_read_b32 v70, a206
    v_accvgpr_read_b32 v65, a210
    v_accvgpr_read_b32 v67, a214
    v_accvgpr_read_b32 v69, a218
    v_accvgpr_read_b32 v71, a222
    v_pk_fma_f32 v[56:57], v[88:89], v[40:41], v[64:65] op_sel:[0,0,0] op_sel_hi:[0,1,1]
    v_pk_fma_f32 v[58:59], v[90:91], v[42:43], v[66:67] op_sel:[0,0,0] op_sel_hi:[0,1,1]
    v_pk_fma_f32 v[60:61], v[92:93], v[44:45], v[68:69] op_sel:[0,0,0] op_sel_hi:[0,1,1]
    v_pk_fma_f32 v[62:63], v[94:95], v[46:47], v[70:71] op_sel:[0,0,0] op_sel_hi:[0,1,1]
    v_pk_fma_f32 v[40:41], v[88:89], v[40:41], v[56:57] op_sel:[1,1,0] op_sel_hi:[1,0,1] neg_lo:[1,0,0]
    v_pk_fma_f32 v[42:43], v[90:91], v[42:43], v[58:59] op_sel:[1,1,0] op_sel_hi:[1,0,1] neg_lo:[1,0,0]
    v_pk_fma_f32 v[44:45], v[92:93], v[44:45], v[60:61] op_sel:[1,1,0] op_sel_hi:[1,0,1] neg_lo:[1,0,0]
    v_pk_fma_f32 v[46:47], v[94:95], v[46:47], v[62:63] op_sel:[1,1,0] op_sel_hi:[1,0,1] neg_lo:[1,0,0]
    v_accvgpr_read_b32 v48, a195
    v_accvgpr_read_b32 v50, a199
    v_accvgpr_read_b32 v52, a203
    v_accvgpr_read_b32 v54, a207
    v_accvgpr_read_b32 v49, a211
    v_accvgpr_read_b32 v51, a215
    v_accvgpr_read_b32 v53, a219
    v_accvgpr_read_b32 v55, a223
    v_pk_fma_f32 v[56:57], v[88:89], v[40:41], v[48:49] op_sel:[0,0,0] op_sel_hi:[0,1,1]
    v_pk_fma_f32 v[58:59], v[90:91], v[42:43], v[50:51] op_sel:[0,0,0] op_sel_hi:[0,1,1]
    v_pk_fma_f32 v[60:61], v[92:93], v[44:45], v[52:53] op_sel:[0,0,0] op_sel_hi:[0,1,1]
    v_pk_fma_f32 v[62:63], v[94:95], v[46:47], v[54:55] op_sel:[0,0,0] op_sel_hi:[0,1,1]
    v_pk_fma_f32 v[40:41], v[88:89], v[40:41], v[56:57] op_sel:[1,1,0] op_sel_hi:[1,0,1] neg_lo:[1,0,0]
    v_pk_fma_f32 v[42:43], v[90:91], v[42:43], v[58:59] op_sel:[1,1,0] op_sel_hi:[1,0,1] neg_lo:[1,0,0]
    v_pk_fma_f32 v[44:45], v[92:93], v[44:45], v[60:61] op_sel:[1,1,0] op_sel_hi:[1,0,1] neg_lo:[1,0,0]
    v_pk_fma_f32 v[46:47], v[94:95], v[46:47], v[62:63] op_sel:[1,1,0] op_sel_hi:[1,0,1] neg_lo:[1,0,0]
    v_accvgpr_read_b32 v64, a224
    v_accvgpr_read_b32 v66, a228
    v_accvgpr_read_b32 v68, a232
    v_accvgpr_read_b32 v70, a236
    v_accvgpr_read_b32 v65, a240
    v_accvgpr_read_b32 v67, a244
    v_accvgpr_read_b32 v69, a248
    v_accvgpr_read_b32 v71, a252
    v_pk_fma_f32 v[56:57], v[88:89], v[40:41], v[64:65] op_sel:[0,0,0] op_sel_hi:[0,1,1]
    v_pk_fma_f32 v[58:59], v[90:91], v[42:43], v[66:67] op_sel:[0,0,0] op_sel_hi:[0,1,1]
    v_pk_fma_f32 v[60:61], v[92:93], v[44:45], v[68:69] op_sel:[0,0,0] op_sel_hi:[0,1,1]
    v_pk_fma_f32 v[62:63], v[94:95], v[46:47], v[70:71] op_sel:[0,0,0] op_sel_hi:[0,1,1]
    v_pk_fma_f32 v[40:41], v[88:89], v[40:41], v[56:57] op_sel:[1,1,0] op_sel_hi:[1,0,1] neg_lo:[1,0,0]
    v_pk_fma_f32 v[42:43], v[90:91], v[42:43], v[58:59] op_sel:[1,1,0] op_sel_hi:[1,0,1] neg_lo:[1,0,0]
    v_pk_fma_f32 v[44:45], v[92:93], v[44:45], v[60:61] op_sel:[1,1,0] op_sel_hi:[1,0,1] neg_lo:[1,0,0]
    v_pk_fma_f32 v[46:47], v[94:95], v[46:47], v[62:63] op_sel:[1,1,0] op_sel_hi:[1,0,1] neg_lo:[1,0,0]
    v_accvgpr_read_b32 v48, a225
    v_accvgpr_read_b32 v50, a229
    v_accvgpr_read_b32 v52, a233
    v_accvgpr_read_b32 v54, a237
    v_accvgpr_read_b32 v49, a241
    v_accvgpr_read_b32 v51, a245
    v_accvgpr_read_b32 v53, a249
    v_accvgpr_read_b32 v55, a253
    v_pk_fma_f32 v[56:57], v[88:89], v[40:41], v[48:49] op_sel:[0,0,0] op_sel_hi:[0,1,1]
    v_pk_fma_f32 v[58:59], v[90:91], v[42:43], v[50:51] op_sel:[0,0,0] op_sel_hi:[0,1,1]
    v_pk_fma_f32 v[60:61], v[92:93], v[44:45], v[52:53] op_sel:[0,0,0] op_sel_hi:[0,1,1]
    v_pk_fma_f32 v[62:63], v[94:95], v[46:47], v[54:55] op_sel:[0,0,0] op_sel_hi:[0,1,1]
    v_pk_fma_f32 v[40:41], v[88:89], v[40:41], v[56:57] op_sel:[1,1,0] op_sel_hi:[1,0,1] neg_lo:[1,0,0]
    v_pk_fma_f32 v[42:43], v[90:91], v[42:43], v[58:59] op_sel:[1,1,0] op_sel_hi:[1,0,1] neg_lo:[1,0,0]
    v_pk_fma_f32 v[44:45], v[92:93], v[44:45], v[60:61] op_sel:[1,1,0] op_sel_hi:[1,0,1] neg_lo:[1,0,0]
    v_pk_fma_f32 v[46:47], v[94:95], v[46:47], v[62:63] op_sel:[1,1,0] op_sel_hi:[1,0,1] neg_lo:[1,0,0]
    v_accvgpr_read_b32 v64, a226
    v_accvgpr_read_b32 v66, a230
    v_accvgpr_read_b32 v68, a234
    v_accvgpr_read_b32 v70, a238
    v_accvgpr_read_b32 v65, a242
    v_accvgpr_read_b32 v67, a246
    v_accvgpr_read_b32 v69, a250
    v_accvgpr_read_b32 v71, a254
    v_pk_fma_f32 v[56:57], v[88:89], v[40:41], v[64:65] op_sel:[0,0,0] op_sel_hi:[0,1,1]
    v_pk_fma_f32 v[58:59], v[90:91], v[42:43], v[66:67] op_sel:[0,0,0] op_sel_hi:[0,1,1]
    v_pk_fma_f32 v[60:61], v[92:93], v[44:45], v[68:69] op_sel:[0,0,0] op_sel_hi:[0,1,1]
    v_pk_fma_f32 v[62:63], v[94:95], v[46:47], v[70:71] op_sel:[0,0,0] op_sel_hi:[0,1,1]
    v_pk_fma_f32 v[40:41], v[88:89], v[40:41], v[56:57] op_sel:[1,1,0] op_sel_hi:[1,0,1] neg_lo:[1,0,0]
    v_pk_fma_f32 v[42:43], v[90:91], v[42:43], v[58:59] op_sel:[1,1,0] op_sel_hi:[1,0,1] neg_lo:[1,0,0]
    v_pk_fma_f32 v[44:45], v[92:93], v[44:45], v[60:61] op_sel:[1,1,0] op_sel_hi:[1,0,1] neg_lo:[1,0,0]
    v_pk_fma_f32 v[46:47], v[94:95], v[46:47], v[62:63] op_sel:[1,1,0] op_sel_hi:[1,0,1] neg_lo:[1,0,0]
    v_accvgpr_read_b32 v48, a227
    v_accvgpr_read_b32 v50, a231
    v_accvgpr_read_b32 v52, a235
    v_accvgpr_read_b32 v54, a239
    v_accvgpr_read_b32 v49, a243
    v_accvgpr_read_b32 v51, a247
    v_accvgpr_read_b32 v53, a251
    v_accvgpr_read_b32 v55, a255
    v_pk_fma_f32 v[56:57], v[88:89], v[40:41], v[48:49] op_sel:[0,0,0] op_sel_hi:[0,1,1]
    v_pk_fma_f32 v[58:59], v[90:91], v[42:43], v[50:51] op_sel:[0,0,0] op_sel_hi:[0,1,1]
    v_pk_fma_f32 v[60:61], v[92:93], v[44:45], v[52:53] op_sel:[0,0,0] op_sel_hi:[0,1,1]
    v_pk_fma_f32 v[62:63], v[94:95], v[46:47], v[54:55] op_sel:[0,0,0] op_sel_hi:[0,1,1]
    v_pk_fma_f32 v[40:41], v[88:89], v[40:41], v[56:57] op_sel:[1,1,0] op_sel_hi:[1,0,1] neg_lo:[1,0,0]
    v_pk_fma_f32 v[42:43], v[90:91], v[42:43], v[58:59] op_sel:[1,1,0] op_sel_hi:[1,0,1] neg_lo:[1,0,0]
    v_pk_fma_f32 v[44:45], v[92:93], v[44:45], v[60:61] op_sel:[1,1,0] op_sel_hi:[1,0,1] neg_lo:[1,0,0]
    v_pk_fma_f32 v[46:47], v[94:95], v[46:47], v[62:63] op_sel:[1,1,0] op_sel_hi:[1,0,1] neg_lo:[1,0,0]
    v_mov_b32 v64, v40
    v_mov_b32 v72, v40
    v_mov_b32 v65, v41
    v_mov_b32 v73, v41
    v_mov_b32 v66, v42
    v_mov_b32 v74, v42
    v_mov_b32 v67, v43
    v_mov_b32 v75, v43
    v_mov_b32 v68, v44
    v_mov_b32 v76, v44
    v_mov_b32 v69, v45
    v_mov_b32 v77, v45
    v_mov_b32 v70, v46
    v_mov_b32 v78, v46
    v_mov_b32 v71, v47
    v_mov_b32 v79, v47
    s_nop 1
    v_permlane16_swap_b32 v64, v72
    v_permlane16_swap_b32 v65, v73
    v_permlane16_swap_b32 v66, v74
    v_permlane16_swap_b32 v67, v75
    v_permlane16_swap_b32 v68, v76
    v_permlane16_swap_b32 v69, v77
    v_permlane16_swap_b32 v70, v78
    v_permlane16_swap_b32 v71, v79
    v_pk_fma_f32 v[56:57], v[104:105], v[64:65], v[72:73] op_sel:[0,0,0] op_sel_hi:[0,1,1]
    v_pk_fma_f32 v[58:59], v[106:107], v[66:67], v[74:75] op_sel:[0,0,0] op_sel_hi:[0,1,1]
    v_pk_fma_f32 v[60:61], v[108:109], v[68:69], v[76:77] op_sel:[0,0,0] op_sel_hi:[0,1,1]
    v_pk_fma_f32 v[62:63], v[110:111], v[70:71], v[78:79] op_sel:[0,0,0] op_sel_hi:[0,1,1]
    v_pk_fma_f32 v[80:81], v[104:105], v[64:65], v[56:57] op_sel:[1,1,0] op_sel_hi:[1,0,1] neg_lo:[1,0,0]
    v_pk_fma_f32 v[82:83], v[106:107], v[66:67], v[58:59] op_sel:[1,1,0] op_sel_hi:[1,0,1] neg_lo:[1,0,0]
    v_pk_fma_f32 v[84:85], v[108:109], v[68:69], v[60:61] op_sel:[1,1,0] op_sel_hi:[1,0,1] neg_lo:[1,0,0]
    v_pk_fma_f32 v[86:87], v[110:111], v[70:71], v[62:63] op_sel:[1,1,0] op_sel_hi:[1,0,1] neg_lo:[1,0,0]
    v_mov_b32 v24, v80
    v_mov_b32 v25, v81
    v_mov_b32 v26, v82
    v_mov_b32 v27, v83
    v_mov_b32 v28, v84
    v_mov_b32 v29, v85
    v_mov_b32 v30, v86
    v_mov_b32 v31, v87
    s_nop 1
    v_permlane32_swap_b32 v80, v24
    v_permlane32_swap_b32 v81, v25
    v_permlane32_swap_b32 v82, v26
    v_permlane32_swap_b32 v83, v27
    v_permlane32_swap_b32 v84, v28
    v_permlane32_swap_b32 v85, v29
    v_permlane32_swap_b32 v86, v30
    v_permlane32_swap_b32 v87, v31
    v_pk_fma_f32 v[56:57], v[112:113], v[80:81], v[24:25] op_sel:[0,0,0] op_sel_hi:[0,1,1]
    v_pk_fma_f32 v[58:59], v[114:115], v[82:83], v[26:27] op_sel:[0,0,0] op_sel_hi:[0,1,1]
    v_pk_fma_f32 v[60:61], v[116:117], v[84:85], v[28:29] op_sel:[0,0,0] op_sel_hi:[0,1,1]
    v_pk_fma_f32 v[62:63], v[118:119], v[86:87], v[30:31] op_sel:[0,0,0] op_sel_hi:[0,1,1]
    v_pk_fma_f32 v[40:41], v[112:113], v[80:81], v[56:57] op_sel:[1,1,0] op_sel_hi:[1,0,1] neg_lo:[1,0,0]
    v_pk_fma_f32 v[42:43], v[114:115], v[82:83], v[58:59] op_sel:[1,1,0] op_sel_hi:[1,0,1] neg_lo:[1,0,0]
    v_pk_fma_f32 v[44:45], v[116:117], v[84:85], v[60:61] op_sel:[1,1,0] op_sel_hi:[1,0,1] neg_lo:[1,0,0]
    v_pk_fma_f32 v[46:47], v[118:119], v[86:87], v[62:63] op_sel:[1,1,0] op_sel_hi:[1,0,1] neg_lo:[1,0,0]
    s_mov_b32 exec_lo, 0xffffffff
    s_mov_b32 exec_hi, 0xffffffff
    v_mov_b32 v122, v40
    v_mov_b32 v123, v41
    s_mov_b32 exec_lo, 0xffff0000
    s_mov_b32 exec_hi, 0xffffffff
    v_mov_b32 v122, v42
    v_mov_b32 v123, v43
    s_mov_b32 exec_lo, 0x0
    s_mov_b32 exec_hi, 0xffffffff
    v_mov_b32 v122, v44
    v_mov_b32 v123, v45
    s_mov_b32 exec_lo, 0x0
    s_mov_b32 exec_hi, 0xffff0000
    v_mov_b32 v122, v46
    v_mov_b32 v123, v47
    s_mov_b64 exec, -1
    s_and_b32 s53, s58, 1
    s_lshl1_add_u32 s53, s85, s53
    s_lshl_b32 s53, s53, 13
    s_lshr_b32 s29, s58, 1
    s_lshl1_add_u32 s29, s82, s29
    s_lshl_b32 s29, s29, 9
    s_add_u32 s53, s53, s29
    v_lshrrev_b32 v126, 1, v1
    v_add_u32 v126, s53, v126
    s_add_u32 s60, s100, 0xb100000
    s_addc_u32 s61, s101, 0
    s_and_b32 s61, s61, 0xffff
    s_mov_b32 s62, 0x20000
    s_mov_b32 s63, 0x00020000
    buffer_store_dwordx2 v[122:123], v126, s[60:63], 0 offen
    v_subrev_u32 v160, 8192, v126
    v_subrev_u32 v161, 16384, v126
    v_subrev_u32 v162, 24576, v126
    v_subrev_u32 v163, 32768, v126
    v_subrev_u32 v164, 40960, v126
    v_subrev_u32 v165, 49152, v126
    v_subrev_u32 v166, 57344, v126
    v_subrev_u32 v167, 65536, v126
    v_subrev_u32 v168, 73728, v126
    v_subrev_u32 v169, 81920, v126
    v_subrev_u32 v170, 90112, v126
    v_subrev_u32 v171, 98304, v126
    v_subrev_u32 v172, 106496, v126
    v_subrev_u32 v173, 114688, v126
    v_subrev_u32 v174, 122880, v126
    s_lshr_b32 s53, s82, 2
    s_add_u32 s53, s53, 1
    v_mov_b32 v177, s53
    s_lshl_b32 s50, s57, 2
    s_add_u32 s50, s50, 0xb200480
    v_mov_b32 v176, s50
    s_waitcnt vmcnt(0)
    s_barrier
    global_store_dword v176, v177, s[100:101]
    v_and_b32 v178, 7, v0
    v_min_u32 v178, s85, v178
    v_lshlrev_b32 v178, 4, v178
    v_sub_u32 v176, v176, v178
    s_mov_b32 s50, 0
L_lb_74:
    global_load_dword v178, v176, s[100:101] sc1
    s_add_u32 s50, s50, 1
    s_cmp_gt_u32 s50, 0x200000
    s_cbranch_scc1 chain_kernel_wabort
    s_waitcnt vmcnt(0)
    v_cmp_lt_u32 vcc, v178, v177
    s_cbranch_vccnz L_lb_74
    buffer_load_dwordx2 v[128:129], v160, s[60:63], 0 offen sc1
    buffer_load_dwordx2 v[130:131], v161, s[60:63], 0 offen sc1
    buffer_load_dwordx2 v[132:133], v162, s[60:63], 0 offen sc1
    buffer_load_dwordx2 v[134:135], v163, s[60:63], 0 offen sc1
    buffer_load_dwordx2 v[136:137], v164, s[60:63], 0 offen sc1
    buffer_load_dwordx2 v[138:139], v165, s[60:63], 0 offen sc1
    buffer_load_dwordx2 v[140:141], v166, s[60:63], 0 offen sc1
    buffer_load_dwordx2 v[142:143], v167, s[60:63], 0 offen sc1
    buffer_load_dwordx2 v[144:145], v168, s[60:63], 0 offen sc1
    buffer_load_dwordx2 v[146:147], v169, s[60:63], 0 offen sc1
    buffer_load_dwordx2 v[148:149], v170, s[60:63], 0 offen sc1
    buffer_load_dwordx2 v[150:151], v171, s[60:63], 0 offen sc1
    buffer_load_dwordx2 v[152:153], v172, s[60:63], 0 offen sc1
    buffer_load_dwordx2 v[154:155], v173, s[60:63], 0 offen sc1
    buffer_load_dwordx2 v[156:157], v174, s[60:63], 0 offen sc1
    s_waitcnt vmcnt(0)
    v_pk_fma_f32 v[56:57], v[120:121], v[156:157], v[154:155] op_sel:[0,0,0] op_sel_hi:[0,1,1]
    v_pk_fma_f32 v[154:155], v[120:121], v[156:157], v[56:57] op_sel:[1,1,0] op_sel_hi:[1,0,1] neg_lo:[1,0,0]
    v_pk_fma_f32 v[56:57], v[120:121], v[154:155], v[152:153] op_sel:[0,0,0] op_sel_hi:[0,1,1]
    v_pk_fma_f32 v[152:153], v[120:121], v[154:155], v[56:57] op_sel:[1,1,0] op_sel_hi:[1,0,1] neg_lo:[1,0,0]
    v_pk_fma_f32 v[56:57], v[120:121], v[152:153], v[150:151] op_sel:[0,0,0] op_sel_hi:[0,1,1]
    v_pk_fma_f32 v[150:151], v[120:121], v[152:153], v[56:57] op_sel:[1,1,0] op_sel_hi:[1,0,1] neg_lo:[1,0,0]
    v_pk_fma_f32 v[56:57], v[120:121], v[150:151], v[148:149] op_sel:[0,0,0] op_sel_hi:[0,1,1]
    v_pk_fma_f32 v[148:149], v[120:121], v[150:151], v[56:57] op_sel:[1,1,0] op_sel_hi:[1,0,1] neg_lo:[1,0,0]
    v_pk_fma_f32 v[56:57], v[120:121], v[148:149], v[146:147] op_sel:[0,0,0] op_sel_hi:[0,1,1]
    v_pk_fma_f32 v[146:147], v[120:121], v[148:149], v[56:57] op_sel:[1,1,0] op_sel_hi:[1,0,1] neg_lo:[1,0,0]
    v_pk_fma_f32 v[56:57], v[120:121], v[146:147], v[144:145] op_sel:[0,0,0] op_sel_hi:[0,1,1]
    v_pk_fma_f32 v[144:145], v[120:121], v[146:147], v[56:57] op_sel:[1,1,0] op_sel_hi:[1,0,1] neg_lo:[1,0,0]
    v_pk_fma_f32 v[56:57], v[120:121], v[144:145], v[142:143] op_sel:[0,0,0] op_sel_hi:[0,1,1]
    v_pk_fma_f32 v[142:143], v[120:121], v[144:145], v[56:57] op_sel:[1,1,0] op_sel_hi:[1,0,1] neg_lo:[1,0,0]
    v_pk_fma_f32 v[56:57], v[120:121], v[142:143], v[140:141] op_sel:[0,0,0] op_sel_hi:[0,1,1]
    v_pk_fma_f32 v[140:141], v[120:121], v[142:143], v[56:57] op_sel:[1,1,0] op_sel_hi:[1,0,1] neg_lo:[1,0,0]
    v_pk_fma_f32 v[56:57], v[120:121], v[140:141], v[138:139] op_sel:[0,0,0] op_sel_hi:[0,1,1]
    v_pk_fma_f32 v[138:139], v[120:121], v[140:141], v[56:57] op_sel:[1,1,0] op_sel_hi:[1,0,1] neg_lo:[1,0,0]
    v_pk_fma_f32 v[56:57], v[120:121], v[138:139], v[136:137] op_sel:[0,0,0] op_sel_hi:[0,1,1]
    v_pk_fma_f32 v[136:137], v[120:121], v[138:139], v[56:57] op_sel:[1,1,0] op_sel_hi:[1,0,1] neg_lo:[1,0,0]
    v_pk_fma_f32 v[56:57], v[120:121], v[136:137], v[134:135] op_sel:[0,0,0] op_sel_hi:[0,1,1]
    v_pk_fma_f32 v[134:135], v[120:121], v[136:137], v[56:57] op_sel:[1,1,0] op_sel_hi:[1,0,1] neg_lo:[1,0,0]
    v_pk_fma_f32 v[56:57], v[120:121], v[134:135], v[132:133] op_sel:[0,0,0] op_sel_hi:[0,1,1]
    v_pk_fma_f32 v[132:133], v[120:121], v[134:135], v[56:57] op_sel:[1,1,0] op_sel_hi:[1,0,1] neg_lo:[1,0,0]
    v_pk_fma_f32 v[56:57], v[120:121], v[132:133], v[130:131] op_sel:[0,0,0] op_sel_hi:[0,1,1]
    v_pk_fma_f32 v[130:131], v[120:121], v[132:133], v[56:57] op_sel:[1,1,0] op_sel_hi:[1,0,1] neg_lo:[1,0,0]
    v_pk_fma_f32 v[56:57], v[120:121], v[130:131], v[128:129] op_sel:[0,0,0] op_sel_hi:[0,1,1]
    v_pk_fma_f32 v[128:129], v[120:121], v[130:131], v[56:57] op_sel:[1,1,0] op_sel_hi:[1,0,1] neg_lo:[1,0,0]
    v_mov_b32 v32, v128
    v_mov_b32 v34, v128
    v_mov_b32 v33, v129
    v_mov_b32 v35, v129
    s_nop 1
    v_permlane16_swap_b32 v32, v34
    v_permlane16_swap_b32 v33, v35
    v_mov_b32 v36, v32
    v_mov_b32 v37, v33
    v_mov_b32 v38, v34
    v_mov_b32 v39, v35
    s_nop 1
    v_permlane32_swap_b32 v32, v36
    v_permlane32_swap_b32 v33, v37
    v_permlane32_swap_b32 v34, v38
    v_permlane32_swap_b32 v35, v39
    s_mov_b32 exec_lo, 0
    v_pk_fma_f32 v[56:57], v[112:113], v[32:33], v[80:81] op_sel:[0,0,0] op_sel_hi:[0,1,1]
    v_pk_fma_f32 v[58:59], v[114:115], v[34:35], v[82:83] op_sel:[0,0,0] op_sel_hi:[0,1,1]
    v_pk_fma_f32 v[60:61], v[116:117], v[36:37], v[84:85] op_sel:[0,0,0] op_sel_hi:[0,1,1]
    v_pk_fma_f32 v[62:63], v[118:119], v[38:39], v[86:87] op_sel:[0,0,0] op_sel_hi:[0,1,1]
    v_pk_fma_f32 v[32:33], v[112:113], v[32:33], v[56:57] op_sel:[1,1,0] op_sel_hi:[1,0,1] neg_lo:[1,0,0]
    v_pk_fma_f32 v[34:35], v[114:115], v[34:35], v[58:59] op_sel:[1,1,0] op_sel_hi:[1,0,1] neg_lo:[1,0,0]
    v_pk_fma_f32 v[36:37], v[116:117], v[36:37], v[60:61] op_sel:[1,1,0] op_sel_hi:[1,0,1] neg_lo:[1,0,0]
    v_pk_fma_f32 v[38:39], v[118:119], v[38:39], v[62:63] op_sel:[1,1,0] op_sel_hi:[1,0,1] neg_lo:[1,0,0]
    s_mov_b32 exec_lo, 0xffff0000
    s_mov_b32 exec_hi, 0xffff0000
    v_pk_fma_f32 v[56:57], v[104:105], v[32:33], v[64:65] op_sel:[0,0,0] op_sel_hi:[0,1,1]
    v_pk_fma_f32 v[58:59], v[106:107], v[34:35], v[66:67] op_sel:[0,0,0] op_sel_hi:[0,1,1]
    v_pk_fma_f32 v[60:61], v[108:109], v[36:37], v[68:69] op_sel:[0,0,0] op_sel_hi:[0,1,1]
    v_pk_fma_f32 v[62:63], v[110:111], v[38:39], v[70:71] op_sel:[0,0,0] op_sel_hi:[0,1,1]
    v_pk_fma_f32 v[32:33], v[104:105], v[32:33], v[56:57] op_sel:[1,1,0] op_sel_hi:[1,0,1] neg_lo:[1,0,0]
    v_pk_fma_f32 v[34:35], v[106:107], v[34:35], v[58:59] op_sel:[1,1,0] op_sel_hi:[1,0,1] neg_lo:[1,0,0]
    v_pk_fma_f32 v[36:37], v[108:109], v[36:37], v[60:61] op_sel:[1,1,0] op_sel_hi:[1,0,1] neg_lo:[1,0,0]
    v_pk_fma_f32 v[38:39], v[110:111], v[38:39], v[62:63] op_sel:[1,1,0] op_sel_hi:[1,0,1] neg_lo:[1,0,0]
    s_mov_b64 exec, -1
    v_accvgpr_read_b32 v64, a0
    v_accvgpr_read_b32 v66, a4
    v_accvgpr_read_b32 v68, a8
    v_accvgpr_read_b32 v70, a12
    v_accvgpr_read_b32 v65, a16
    v_accvgpr_read_b32 v67, a20
    v_accvgpr_read_b32 v69, a24
    v_accvgpr_read_b32 v71, a28
    v_pk_fma_f32 v[56:57], v[88:89], v[32:33], v[64:65] op_sel:[0,0,0] op_sel_hi:[0,1,1]
    v_pk_fma_f32 v[58:59], v[90:91], v[34:35], v[66:67] op_sel:[0,0,0] op_sel_hi:[0,1,1]
    v_pk_fma_f32 v[60:61], v[92:93], v[36:37], v[68:69] op_sel:[0,0,0] op_sel_hi:[0,1,1]
    v_pk_fma_f32 v[62:63], v[94:95], v[38:39], v[70:71] op_sel:[0,0,0] op_sel_hi:[0,1,1]
    v_pk_fma_f32 v[32:33], v[88:89], v[32:33], v[56:57] op_sel:[1,1,0] op_sel_hi:[1,0,1] neg_lo:[1,0,0]
    v_pk_fma_f32 v[34:35], v[90:91], v[34:35], v[58:59] op_sel:[1,1,0] op_sel_hi:[1,0,1] neg_lo:[1,0,0]
    v_pk_fma_f32 v[36:37], v[92:93], v[36:37], v[60:61] op_sel:[1,1,0] op_sel_hi:[1,0,1] neg_lo:[1,0,0]
    v_pk_fma_f32 v[38:39], v[94:95], v[38:39], v[62:63] op_sel:[1,1,0] op_sel_hi:[1,0,1] neg_lo:[1,0,0]
    v_pk_mul_f32 v[40:41], v[96:97], v[32:33] op_sel:[0,0] op_sel_hi:[0,1]
    v_pk_mul_f32 v[42:43], v[98:99], v[34:35] op_sel:[0,0] op_sel_hi:[0,1]
    v_pk_mul_f32 v[44:45], v[100:101], v[36:37] op_sel:[0,0] op_sel_hi:[0,1]
    v_pk_mul_f32 v[46:47], v[102:103], v[38:39] op_sel:[0,0] op_sel_hi:[0,1]
    v_pk_fma_f32 v[72:73], v[96:97], v[32:33], v[40:41] op_sel:[1,1,0] op_sel_hi:[1,0,1] neg_lo:[1,0,0] neg_hi:[1,0,1]
    v_pk_fma_f32 v[74:75], v[98:99], v[34:35], v[42:43] op_sel:[1,1,0] op_sel_hi:[1,0,1] neg_lo:[1,0,0] neg_hi:[1,0,1]
    v_pk_fma_f32 v[76:77], v[100:101], v[36:37], v[44:45] op_sel:[1,1,0] op_sel_hi:[1,0,1] neg_lo:[1,0,0] neg_hi:[1,0,1]
    v_pk_fma_f32 v[78:79], v[102:103], v[38:39], v[46:47] op_sel:[1,1,0] op_sel_hi:[1,0,1] neg_lo:[1,0,0] neg_hi:[1,0,1]
    v_accvgpr_read_b32 v48, a1
    v_accvgpr_read_b32 v50, a5
    v_accvgpr_read_b32 v52, a9
    v_accvgpr_read_b32 v54, a13
    v_accvgpr_read_b32 v49, a17
    v_accvgpr_read_b32 v51, a21
    v_accvgpr_read_b32 v53, a25
    v_accvgpr_read_b32 v55, a29
    v_pk_fma_f32 v[56:57], v[88:89], v[32:33], v[48:49] op_sel:[0,0,0] op_sel_hi:[0,1,1]
    v_pk_fma_f32 v[58:59], v[90:91], v[34:35], v[50:51] op_sel:[0,0,0] op_sel_hi:[0,1,1]
    v_pk_fma_f32 v[60:61], v[92:93], v[36:37], v[52:53] op_sel:[0,0,0] op_sel_hi:[0,1,1]
    v_pk_fma_f32 v[62:63], v[94:95], v[38:39], v[54:55] op_sel:[0,0,0] op_sel_hi:[0,1,1]
    v_pk_fma_f32 v[32:33], v[88:89], v[32:33], v[56:57] op_sel:[1,1,0] op_sel_hi:[1,0,1] neg_lo:[1,0,0]
    v_pk_fma_f32 v[34:35], v[90:91], v[34:35], v[58:59] op_sel:[1,1,0] op_sel_hi:[1,0,1] neg_lo:[1,0,0]
    v_pk_fma_f32 v[36:37], v[92:93], v[36:37], v[60:61] op_sel:[1,1,0] op_sel_hi:[1,0,1] neg_lo:[1,0,0]
    v_pk_fma_f32 v[38:39], v[94:95], v[38:39], v[62:63] op_sel:[1,1,0] op_sel_hi:[1,0,1] neg_lo:[1,0,0]
    v_pk_mul_f32 v[40:41], v[96:97], v[32:33] op_sel:[0,0] op_sel_hi:[0,1]
    v_pk_mul_f32 v[42:43], v[98:99], v[34:35] op_sel:[0,0] op_sel_hi:[0,1]
    v_pk_mul_f32 v[44:45], v[100:101], v[36:37] op_sel:[0,0] op_sel_hi:[0,1]
    v_pk_mul_f32 v[46:47], v[102:103], v[38:39] op_sel:[0,0] op_sel_hi:[0,1]
    v_pk_fma_f32 v[80:81], v[96:97], v[32:33], v[40:41] op_sel:[1,1,0] op_sel_hi:[1,0,1] neg_lo:[1,0,0] neg_hi:[1,0,1]
    v_pk_fma_f32 v[82:83], v[98:99], v[34:35], v[42:43] op_sel:[1,1,0] op_sel_hi:[1,0,1] neg_lo:[1,0,0] neg_hi:[1,0,1]
    v_pk_fma_f32 v[84:85], v[100:101], v[36:37], v[44:45] op_sel:[1,1,0] op_sel_hi:[1,0,1] neg_lo:[1,0,0] neg_hi:[1,0,1]
    v_pk_fma_f32 v[86:87], v[102:103], v[38:39], v[46:47] op_sel:[1,1,0] op_sel_hi:[1,0,1] neg_lo:[1,0,0] neg_hi:[1,0,1]
    v_cvt_pk_bf16_f32 v128, v72, v80
    v_cvt_pk_bf16_f32 v136, v74, v82
    v_cvt_pk_bf16_f32 v144, v76, v84
    v_cvt_pk_bf16_f32 v152, v78, v86
    v_cvt_pk_bf16_f32 v192, v73, v81
    v_cvt_pk_bf16_f32 v200, v75, v83
    v_cvt_pk_bf16_f32 v208, v77, v85
    v_cvt_pk_bf16_f32 v216, v79, v87
    v_accvgpr_read_b32 v64, a2
    v_accvgpr_read_b32 v66, a6
    v_accvgpr_read_b32 v68, a10
    v_accvgpr_read_b32 v70, a14
    v_accvgpr_read_b32 v65, a18
    v_accvgpr_read_b32 v67, a22
    v_accvgpr_read_b32 v69, a26
    v_accvgpr_read_b32 v71, a30
    v_pk_fma_f32 v[56:57], v[88:89], v[32:33], v[64:65] op_sel:[0,0,0] op_sel_hi:[0,1,1]
    v_pk_fma_f32 v[58:59], v[90:91], v[34:35], v[66:67] op_sel:[0,0,0] op_sel_hi:[0,1,1]
    v_pk_fma_f32 v[60:61], v[92:93], v[36:37], v[68:69] op_sel:[0,0,0] op_sel_hi:[0,1,1]
    v_pk_fma_f32 v[62:63], v[94:95], v[38:39], v[70:71] op_sel:[0,0,0] op_sel_hi:[0,1,1]
    v_pk_fma_f32 v[32:33], v[88:89], v[32:33], v[56:57] op_sel:[1,1,0] op_sel_hi:[1,0,1] neg_lo:[1,0,0]
    v_pk_fma_f32 v[34:35], v[90:91], v[34:35], v[58:59] op_sel:[1,1,0] op_sel_hi:[1,0,1] neg_lo:[1,0,0]
    v_pk_fma_f32 v[36:37], v[92:93], v[36:37], v[60:61] op_sel:[1,1,0] op_sel_hi:[1,0,1] neg_lo:[1,0,0]
    v_pk_fma_f32 v[38:39], v[94:95], v[38:39], v[62:63] op_sel:[1,1,0] op_sel_hi:[1,0,1] neg_lo:[1,0,0]
    v_pk_mul_f32 v[40:41], v[96:97], v[32:33] op_sel:[0,0] op_sel_hi:[0,1]
    v_pk_mul_f32 v[42:43], v[98:99], v[34:35] op_sel:[0,0] op_sel_hi:[0,1]
    v_pk_mul_f32 v[44:45], v[100:101], v[36:37] op_sel:[0,0] op_sel_hi:[0,1]
    v_pk_mul_f32 v[46:47], v[102:103], v[38:39] op_sel:[0,0] op_sel_hi:[0,1]
    v_pk_fma_f32 v[72:73], v[96:97], v[32:33], v[40:41] op_sel:[1,1,0] op_sel_hi:[1,0,1] neg_lo:[1,0,0] neg_hi:[1,0,1]
    v_pk_fma_f32 v[74:75], v[98:99], v[34:35], v[42:43] op_sel:[1,1,0] op_sel_hi:[1,0,1] neg_lo:[1,0,0] neg_hi:[1,0,1]
    v_pk_fma_f32 v[76:77], v[100:101], v[36:37], v[44:45] op_sel:[1,1,0] op_sel_hi:[1,0,1] neg_lo:[1,0,0] neg_hi:[1,0,1]
    v_pk_fma_f32 v[78:79], v[102:103], v[38:39], v[46:47] op_sel:[1,1,0] op_sel_hi:[1,0,1] neg_lo:[1,0,0] neg_hi:[1,0,1]
    v_accvgpr_read_b32 v48, a3
    v_accvgpr_read_b32 v50, a7
    v_accvgpr_read_b32 v52, a11
    v_accvgpr_read_b32 v54, a15
    v_accvgpr_read_b32 v49, a19
    v_accvgpr_read_b32 v51, a23
    v_accvgpr_read_b32 v53, a27
    v_accvgpr_read_b32 v55, a31
    v_pk_fma_f32 v[56:57], v[88:89], v[32:33], v[48:49] op_sel:[0,0,0] op_sel_hi:[0,1,1]
    v_pk_fma_f32 v[58:59], v[90:91], v[34:35], v[50:51] op_sel:[0,0,0] op_sel_hi:[0,1,1]
    v_pk_fma_f32 v[60:61], v[92:93], v[36:37], v[52:53] op_sel:[0,0,0] op_sel_hi:[0,1,1]
    v_pk_fma_f32 v[62:63], v[94:95], v[38:39], v[54:55] op_sel:[0,0,0] op_sel_hi:[0,1,1]
    v_pk_fma_f32 v[32:33], v[88:89], v[32:33], v[56:57] op_sel:[1,1,0] op_sel_hi:[1,0,1] neg_lo:[1,0,0]
    v_pk_fma_f32 v[34:35], v[90:91], v[34:35], v[58:59] op_sel:[1,1,0] op_sel_hi:[1,0,1] neg_lo:[1,0,0]
    v_pk_fma_f32 v[36:37], v[92:93], v[36:37], v[60:61] op_sel:[1,1,0] op_sel_hi:[1,0,1] neg_lo:[1,0,0]
    v_pk_fma_f32 v[38:39], v[94:95], v[38:39], v[62:63] op_sel:[1,1,0] op_sel_hi:[1,0,1] neg_lo:[1,0,0]
    v_pk_mul_f32 v[40:41], v[96:97], v[32:33] op_sel:[0,0] op_sel_hi:[0,1]
    v_pk_mul_f32 v[42:43], v[98:99], v[34:35] op_sel:[0,0] op_sel_hi:[0,1]
    v_pk_mul_f32 v[44:45], v[100:101], v[36:37] op_sel:[0,0] op_sel_hi:[0,1]
    v_pk_mul_f32 v[46:47], v[102:103], v[38:39] op_sel:[0,0] op_sel_hi:[0,1]
    v_pk_fma_f32 v[80:81], v[96:97], v[32:33], v[40:41] op_sel:[1,1,0] op_sel_hi:[1,0,1] neg_lo:[1,0,0] neg_hi:[1,0,1]
    v_pk_fma_f32 v[82:83], v[98:99], v[34:35], v[42:43] op_sel:[1,1,0] op_sel_hi:[1,0,1] neg_lo:[1,0,0] neg_hi:[1,0,1]
    v_pk_fma_f32 v[84:85], v[100:101], v[36:37], v[44:45] op_sel:[1,1,0] op_sel_hi:[1,0,1] neg_lo:[1,0,0] neg_hi:[1,0,1]
    v_pk_fma_f32 v[86:87], v[102:103], v[38:39], v[46:47] op_sel:[1,1,0] op_sel_hi:[1,0,1] neg_lo:[1,0,0] neg_hi:[1,0,1]
    v_cvt_pk_bf16_f32 v129, v72, v80
    v_cvt_pk_bf16_f32 v137, v74, v82
    v_cvt_pk_bf16_f32 v145, v76, v84
    v_cvt_pk_bf16_f32 v153, v78, v86
    v_cvt_pk_bf16_f32 v193, v73, v81
    v_cvt_pk_bf16_f32 v201, v75, v83
    v_cvt_pk_bf16_f32 v209, v77, v85
    v_cvt_pk_bf16_f32 v217, v79, v87
    v_accvgpr_read_b32 v64, a32
    v_accvgpr_read_b32 v66, a36
    v_accvgpr_read_b32 v68, a40
    v_accvgpr_read_b32 v70, a44
    v_accvgpr_read_b32 v65, a48
    v_accvgpr_read_b32 v67, a52
    v_accvgpr_read_b32 v69, a56
    v_accvgpr_read_b32 v71, a60
    v_pk_fma_f32 v[56:57], v[88:89], v[32:33], v[64:65] op_sel:[0,0,0] op_sel_hi:[0,1,1]
    v_pk_fma_f32 v[58:59], v[90:91], v[34:35], v[66:67] op_sel:[0,0,0] op_sel_hi:[0,1,1]
    v_pk_fma_f32 v[60:61], v[92:93], v[36:37], v[68:69] op_sel:[0,0,0] op_sel_hi:[0,1,1]
    v_pk_fma_f32 v[62:63], v[94:95], v[38:39], v[70:71] op_sel:[0,0,0] op_sel_hi:[0,1,1]
    v_pk_fma_f32 v[32:33], v[88:89], v[32:33], v[56:57] op_sel:[1,1,0] op_sel_hi:[1,0,1] neg_lo:[1,0,0]
    v_pk_fma_f32 v[34:35], v[90:91], v[34:35], v[58:59] op_sel:[1,1,0] op_sel_hi:[1,0,1] neg_lo:[1,0,0]
    v_pk_fma_f32 v[36:37], v[92:93], v[36:37], v[60:61] op_sel:[1,1,0] op_sel_hi:[1,0,1] neg_lo:[1,0,0]
    v_pk_fma_f32 v[38:39], v[94:95], v[38:39], v[62:63] op_sel:[1,1,0] op_sel_hi:[1,0,1] neg_lo:[1,0,0]
    v_pk_mul_f32 v[40:41], v[96:97], v[32:33] op_sel:[0,0] op_sel_hi:[0,1]
    v_pk_mul_f32 v[42:43], v[98:99], v[34:35] op_sel:[0,0] op_sel_hi:[0,1]
    v_pk_mul_f32 v[44:45], v[100:101], v[36:37] op_sel:[0,0] op_sel_hi:[0,1]
    v_pk_mul_f32 v[46:47], v[102:103], v[38:39] op_sel:[0,0] op_sel_hi:[0,1]
    v_pk_fma_f32 v[72:73], v[96:97], v[32:33], v[40:41] op_sel:[1,1,0] op_sel_hi:[1,0,1] neg_lo:[1,0,0] neg_hi:[1,0,1]
    v_pk_fma_f32 v[74:75], v[98:99], v[34:35], v[42:43] op_sel:[1,1,0] op_sel_hi:[1,0,1] neg_lo:[1,0,0] neg_hi:[1,0,1]
    v_pk_fma_f32 v[76:77], v[100:101], v[36:37], v[44:45] op_sel:[1,1,0] op_sel_hi:[1,0,1] neg_lo:[1,0,0] neg_hi:[1,0,1]
    v_pk_fma_f32 v[78:79], v[102:103], v[38:39], v[46:47] op_sel:[1,1,0] op_sel_hi:[1,0,1] neg_lo:[1,0,0] neg_hi:[1,0,1]
    v_accvgpr_read_b32 v48, a33
    v_accvgpr_read_b32 v50, a37
    v_accvgpr_read_b32 v52, a41
    v_accvgpr_read_b32 v54, a45
    v_accvgpr_read_b32 v49, a49
    v_accvgpr_read_b32 v51, a53
    v_accvgpr_read_b32 v53, a57
    v_accvgpr_read_b32 v55, a61
    v_pk_fma_f32 v[56:57], v[88:89], v[32:33], v[48:49] op_sel:[0,0,0] op_sel_hi:[0,1,1]
    v_pk_fma_f32 v[58:59], v[90:91], v[34:35], v[50:51] op_sel:[0,0,0] op_sel_hi:[0,1,1]
    v_pk_fma_f32 v[60:61], v[92:93], v[36:37], v[52:53] op_sel:[0,0,0] op_sel_hi:[0,1,1]
    v_pk_fma_f32 v[62:63], v[94:95], v[38:39], v[54:55] op_sel:[0,0,0] op_sel_hi:[0,1,1]
    v_pk_fma_f32 v[32:33], v[88:89], v[32:33], v[56:57] op_sel:[1,1,0] op_sel_hi:[1,0,1] neg_lo:[1,0,0]
    v_pk_fma_f32 v[34:35], v[90:91], v[34:35], v[58:59] op_sel:[1,1,0] op_sel_hi:[1,0,1] neg_lo:[1,0,0]
    v_pk_fma_f32 v[36:37], v[92:93], v[36:37], v[60:61] op_sel:[1,1,0] op_sel_hi:[1,0,1] neg_lo:[1,0,0]
    v_pk_fma_f32 v[38:39], v[94:95], v[38:39], v[62:63] op_sel:[1,1,0] op_sel_hi:[1,0,1] neg_lo:[1,0,0]
    v_pk_mul_f32 v[40:41], v[96:97], v[32:33] op_sel:[0,0] op_sel_hi:[0,1]
    v_pk_mul_f32 v[42:43], v[98:99], v[34:35] op_sel:[0,0] op_sel_hi:[0,1]
    v_pk_mul_f32 v[44:45], v[100:101], v[36:37] op_sel:[0,0] op_sel_hi:[0,1]
    v_pk_mul_f32 v[46:47], v[102:103], v[38:39] op_sel:[0,0] op_sel_hi:[0,1]
    v_pk_fma_f32 v[80:81], v[96:97], v[32:33], v[40:41] op_sel:[1,1,0] op_sel_hi:[1,0,1] neg_lo:[1,0,0] neg_hi:[1,0,1]
    v_pk_fma_f32 v[82:83], v[98:99], v[34:35], v[42:43] op_sel:[1,1,0] op_sel_hi:[1,0,1] neg_lo:[1,0,0] neg_hi:[1,0,1]
    v_pk_fma_f32 v[84:85], v[100:101], v[36:37], v[44:45] op_sel:[1,1,0] op_sel_hi:[1,0,1] neg_lo:[1,0,0] neg_hi:[1,0,1]
    v_pk_fma_f32 v[86:87], v[102:103], v[38:39], v[46:47] op_sel:[1,1,0] op_sel_hi:[1,0,1] neg_lo:[1,0,0] neg_hi:[1,0,1]
    v_cvt_pk_bf16_f32 v130, v72, v80
    v_cvt_pk_bf16_f32 v138, v74, v82
    v_cvt_pk_bf16_f32 v146, v76, v84
    v_cvt_pk_bf16_f32 v154, v78, v86
    v_cvt_pk_bf16_f32 v194, v73, v81
    v_cvt_pk_bf16_f32 v202, v75, v83
    v_cvt_pk_bf16_f32 v210, v77, v85
    v_cvt_pk_bf16_f32 v218, v79, v87
    v_accvgpr_read_b32 v64, a34
    v_accvgpr_read_b32 v66, a38
    v_accvgpr_read_b32 v68, a42
    v_accvgpr_read_b32 v70, a46
    v_accvgpr_read_b32 v65, a50
    v_accvgpr_read_b32 v67, a54
    v_accvgpr_read_b32 v69, a58
    v_accvgpr_read_b32 v71, a62
    v_pk_fma_f32 v[56:57], v[88:89], v[32:33], v[64:65] op_sel:[0,0,0] op_sel_hi:[0,1,1]
    v_pk_fma_f32 v[58:59], v[90:91], v[34:35], v[66:67] op_sel:[0,0,0] op_sel_hi:[0,1,1]
    v_pk_fma_f32 v[60:61], v[92:93], v[36:37], v[68:69] op_sel:[0,0,0] op_sel_hi:[0,1,1]
    v_pk_fma_f32 v[62:63], v[94:95], v[38:39], v[70:71] op_sel:[0,0,0] op_sel_hi:[0,1,1]
    v_pk_fma_f32 v[32:33], v[88:89], v[32:33], v[56:57] op_sel:[1,1,0] op_sel_hi:[1,0,1] neg_lo:[1,0,0]
    v_pk_fma_f32 v[34:35], v[90:91], v[34:35], v[58:59] op_sel:[1,1,0] op_sel_hi:[1,0,1] neg_lo:[1,0,0]
    v_pk_fma_f32 v[36:37], v[92:93], v[36:37], v[60:61] op_sel:[1,1,0] op_sel_hi:[1,0,1] neg_lo:[1,0,0]
    v_pk_fma_f32 v[38:39], v[94:95], v[38:39], v[62:63] op_sel:[1,1,0] op_sel_hi:[1,0,1] neg_lo:[1,0,0]
    v_pk_mul_f32 v[40:41], v[96:97], v[32:33] op_sel:[0,0] op_sel_hi:[0,1]
    v_pk_mul_f32 v[42:43], v[98:99], v[34:35] op_sel:[0,0] op_sel_hi:[0,1]
    v_pk_mul_f32 v[44:45], v[100:101], v[36:37] op_sel:[0,0] op_sel_hi:[0,1]
    v_pk_mul_f32 v[46:47], v[102:103], v[38:39] op_sel:[0,0] op_sel_hi:[0,1]
    v_pk_fma_f32 v[72:73], v[96:97], v[32:33], v[40:41] op_sel:[1,1,0] op_sel_hi:[1,0,1] neg_lo:[1,0,0] neg_hi:[1,0,1]
    v_pk_fma_f32 v[74:75], v[98:99], v[34:35], v[42:43] op_sel:[1,1,0] op_sel_hi:[1,0,1] neg_lo:[1,0,0] neg_hi:[1,0,1]
    v_pk_fma_f32 v[76:77], v[100:101], v[36:37], v[44:45] op_sel:[1,1,0] op_sel_hi:[1,0,1] neg_lo:[1,0,0] neg_hi:[1,0,1]
    v_pk_fma_f32 v[78:79], v[102:103], v[38:39], v[46:47] op_sel:[1,1,0] op_sel_hi:[1,0,1] neg_lo:[1,0,0] neg_hi:[1,0,1]
    v_accvgpr_read_b32 v48, a35
    v_accvgpr_read_b32 v50, a39
    v_accvgpr_read_b32 v52, a43
    v_accvgpr_read_b32 v54, a47
    v_accvgpr_read_b32 v49, a51
    v_accvgpr_read_b32 v51, a55
    v_accvgpr_read_b32 v53, a59
    v_accvgpr_read_b32 v55, a63
    v_pk_fma_f32 v[56:57], v[88:89], v[32:33], v[48:49] op_sel:[0,0,0] op_sel_hi:[0,1,1]
    v_pk_fma_f32 v[58:59], v[90:91], v[34:35], v[50:51] op_sel:[0,0,0] op_sel_hi:[0,1,1]
    v_pk_fma_f32 v[60:61], v[92:93], v[36:37], v[52:53] op_sel:[0,0,0] op_sel_hi:[0,1,1]
    v_pk_fma_f32 v[62:63], v[94:95], v[38:39], v[54:55] op_sel:[0,0,0] op_sel_hi:[0,1,1]
    v_pk_fma_f32 v[32:33], v[88:89], v[32:33], v[56:57] op_sel:[1,1,0] op_sel_hi:[1,0,1] neg_lo:[1,0,0]
    v_pk_fma_f32 v[34:35], v[90:91], v[34:35], v[58:59] op_sel:[1,1,0] op_sel_hi:[1,0,1] neg_lo:[1,0,0]
    v_pk_fma_f32 v[36:37], v[92:93], v[36:37], v[60:61] op_sel:[1,1,0] op_sel_hi:[1,0,1] neg_lo:[1,0,0]
    v_pk_fma_f32 v[38:39], v[94:95], v[38:39], v[62:63] op_sel:[1,1,0] op_sel_hi:[1,0,1] neg_lo:[1,0,0]
    v_pk_mul_f32 v[40:41], v[96:97], v[32:33] op_sel:[0,0] op_sel_hi:[0,1]
    v_pk_mul_f32 v[42:43], v[98:99], v[34:35] op_sel:[0,0] op_sel_hi:[0,1]
    v_pk_mul_f32 v[44:45], v[100:101], v[36:37] op_sel:[0,0] op_sel_hi:[0,1]
    v_pk_mul_f32 v[46:47], v[102:103], v[38:39] op_sel:[0,0] op_sel_hi:[0,1]
    v_pk_fma_f32 v[80:81], v[96:97], v[32:33], v[40:41] op_sel:[1,1,0] op_sel_hi:[1,0,1] neg_lo:[1,0,0] neg_hi:[1,0,1]
    v_pk_fma_f32 v[82:83], v[98:99], v[34:35], v[42:43] op_sel:[1,1,0] op_sel_hi:[1,0,1] neg_lo:[1,0,0] neg_hi:[1,0,1]
    v_pk_fma_f32 v[84:85], v[100:101], v[36:37], v[44:45] op_sel:[1,1,0] op_sel_hi:[1,0,1] neg_lo:[1,0,0] neg_hi:[1,0,1]
    v_pk_fma_f32 v[86:87], v[102:103], v[38:39], v[46:47] op_sel:[1,1,0] op_sel_hi:[1,0,1] neg_lo:[1,0,0] neg_hi:[1,0,1]
    v_cvt_pk_bf16_f32 v131, v72, v80
    v_cvt_pk_bf16_f32 v139, v74, v82
    v_cvt_pk_bf16_f32 v147, v76, v84
    v_cvt_pk_bf16_f32 v155, v78, v86
    v_cvt_pk_bf16_f32 v195, v73, v81
    v_cvt_pk_bf16_f32 v203, v75, v83
    v_cvt_pk_bf16_f32 v211, v77, v85
    v_cvt_pk_bf16_f32 v219, v79, v87
    v_accvgpr_read_b32 v64, a64
    v_accvgpr_read_b32 v66, a68
    v_accvgpr_read_b32 v68, a72
    v_accvgpr_read_b32 v70, a76
    v_accvgpr_read_b32 v65, a80
    v_accvgpr_read_b32 v67, a84
    v_accvgpr_read_b32 v69, a88
    v_accvgpr_read_b32 v71, a92
    v_pk_fma_f32 v[56:57], v[88:89], v[32:33], v[64:65] op_sel:[0,0,0] op_sel_hi:[0,1,1]
    v_pk_fma_f32 v[58:59], v[90:91], v[34:35], v[66:67] op_sel:[0,0,0] op_sel_hi:[0,1,1]
    v_pk_fma_f32 v[60:61], v[92:93], v[36:37], v[68:69] op_sel:[0,0,0] op_sel_hi:[0,1,1]
    v_pk_fma_f32 v[62:63], v[94:95], v[38:39], v[70:71] op_sel:[0,0,0] op_sel_hi:[0,1,1]
    v_pk_fma_f32 v[32:33], v[88:89], v[32:33], v[56:57] op_sel:[1,1,0] op_sel_hi:[1,0,1] neg_lo:[1,0,0]
    v_pk_fma_f32 v[34:35], v[90:91], v[34:35], v[58:59] op_sel:[1,1,0] op_sel_hi:[1,0,1] neg_lo:[1,0,0]
    v_pk_fma_f32 v[36:37], v[92:93], v[36:37], v[60:61] op_sel:[1,1,0] op_sel_hi:[1,0,1] neg_lo:[1,0,0]
    v_pk_fma_f32 v[38:39], v[94:95], v[38:39], v[62:63] op_sel:[1,1,0] op_sel_hi:[1,0,1] neg_lo:[1,0,0]
    v_pk_mul_f32 v[40:41], v[96:97], v[32:33] op_sel:[0,0] op_sel_hi:[0,1]
    v_pk_mul_f32 v[42:43], v[98:99], v[34:35] op_sel:[0,0] op_sel_hi:[0,1]
    v_pk_mul_f32 v[44:45], v[100:101], v[36:37] op_sel:[0,0] op_sel_hi:[0,1]
    v_pk_mul_f32 v[46:47], v[102:103], v[38:39] op_sel:[0,0] op_sel_hi:[0,1]
    v_pk_fma_f32 v[72:73], v[96:97], v[32:33], v[40:41] op_sel:[1,1,0] op_sel_hi:[1,0,1] neg_lo:[1,0,0] neg_hi:[1,0,1]
    v_pk_fma_f32 v[74:75], v[98:99], v[34:35], v[42:43] op_sel:[1,1,0] op_sel_hi:[1,0,1] neg_lo:[1,0,0] neg_hi:[1,0,1]
    v_pk_fma_f32 v[76:77], v[100:101], v[36:37], v[44:45] op_sel:[1,1,0] op_sel_hi:[1,0,1] neg_lo:[1,0,0] neg_hi:[1,0,1]
    v_pk_fma_f32 v[78:79], v[102:103], v[38:39], v[46:47] op_sel:[1,1,0] op_sel_hi:[1,0,1] neg_lo:[1,0,0] neg_hi:[1,0,1]
    v_accvgpr_read_b32 v48, a65
    v_accvgpr_read_b32 v50, a69
    v_accvgpr_read_b32 v52, a73
    v_accvgpr_read_b32 v54, a77
    v_accvgpr_read_b32 v49, a81
    v_accvgpr_read_b32 v51, a85
    v_accvgpr_read_b32 v53, a89
    v_accvgpr_read_b32 v55, a93
    v_pk_fma_f32 v[56:57], v[88:89], v[32:33], v[48:49] op_sel:[0,0,0] op_sel_hi:[0,1,1]
    v_pk_fma_f32 v[58:59], v[90:91], v[34:35], v[50:51] op_sel:[0,0,0] op_sel_hi:[0,1,1]
    v_pk_fma_f32 v[60:61], v[92:93], v[36:37], v[52:53] op_sel:[0,0,0] op_sel_hi:[0,1,1]
    v_pk_fma_f32 v[62:63], v[94:95], v[38:39], v[54:55] op_sel:[0,0,0] op_sel_hi:[0,1,1]
    v_pk_fma_f32 v[32:33], v[88:89], v[32:33], v[56:57] op_sel:[1,1,0] op_sel_hi:[1,0,1] neg_lo:[1,0,0]
    v_pk_fma_f32 v[34:35], v[90:91], v[34:35], v[58:59] op_sel:[1,1,0] op_sel_hi:[1,0,1] neg_lo:[1,0,0]
    v_pk_fma_f32 v[36:37], v[92:93], v[36:37], v[60:61] op_sel:[1,1,0] op_sel_hi:[1,0,1] neg_lo:[1,0,0]
    v_pk_fma_f32 v[38:39], v[94:95], v[38:39], v[62:63] op_sel:[1,1,0] op_sel_hi:[1,0,1] neg_lo:[1,0,0]
    v_pk_mul_f32 v[40:41], v[96:97], v[32:33] op_sel:[0,0] op_sel_hi:[0,1]
    v_pk_mul_f32 v[42:43], v[98:99], v[34:35] op_sel:[0,0] op_sel_hi:[0,1]
    v_pk_mul_f32 v[44:45], v[100:101], v[36:37] op_sel:[0,0] op_sel_hi:[0,1]
    v_pk_mul_f32 v[46:47], v[102:103], v[38:39] op_sel:[0,0] op_sel_hi:[0,1]
    v_pk_fma_f32 v[80:81], v[96:97], v[32:33], v[40:41] op_sel:[1,1,0] op_sel_hi:[1,0,1] neg_lo:[1,0,0] neg_hi:[1,0,1]
    v_pk_fma_f32 v[82:83], v[98:99], v[34:35], v[42:43] op_sel:[1,1,0] op_sel_hi:[1,0,1] neg_lo:[1,0,0] neg_hi:[1,0,1]
    v_pk_fma_f32 v[84:85], v[100:101], v[36:37], v[44:45] op_sel:[1,1,0] op_sel_hi:[1,0,1] neg_lo:[1,0,0] neg_hi:[1,0,1]
    v_pk_fma_f32 v[86:87], v[102:103], v[38:39], v[46:47] op_sel:[1,1,0] op_sel_hi:[1,0,1] neg_lo:[1,0,0] neg_hi:[1,0,1]
    v_cvt_pk_bf16_f32 v132, v72, v80
    v_cvt_pk_bf16_f32 v140, v74, v82
    v_cvt_pk_bf16_f32 v148, v76, v84
    v_cvt_pk_bf16_f32 v156, v78, v86
    v_cvt_pk_bf16_f32 v196, v73, v81
    v_cvt_pk_bf16_f32 v204, v75, v83
    v_cvt_pk_bf16_f32 v212, v77, v85
    v_cvt_pk_bf16_f32 v220, v79, v87
    v_accvgpr_read_b32 v64, a66
    v_accvgpr_read_b32 v66, a70
    v_accvgpr_read_b32 v68, a74
    v_accvgpr_read_b32 v70, a78
    v_accvgpr_read_b32 v65, a82
    v_accvgpr_read_b32 v67, a86
    v_accvgpr_read_b32 v69, a90
    v_accvgpr_read_b32 v71, a94
    v_pk_fma_f32 v[56:57], v[88:89], v[32:33], v[64:65] op_sel:[0,0,0] op_sel_hi:[0,1,1]
    v_pk_fma_f32 v[58:59], v[90:91], v[34:35], v[66:67] op_sel:[0,0,0] op_sel_hi:[0,1,1]
    v_pk_fma_f32 v[60:61], v[92:93], v[36:37], v[68:69] op_sel:[0,0,0] op_sel_hi:[0,1,1]
    v_pk_fma_f32 v[62:63], v[94:95], v[38:39], v[70:71] op_sel:[0,0,0] op_sel_hi:[0,1,1]
    v_pk_fma_f32 v[32:33], v[88:89], v[32:33], v[56:57] op_sel:[1,1,0] op_sel_hi:[1,0,1] neg_lo:[1,0,0]
    v_pk_fma_f32 v[34:35], v[90:91], v[34:35], v[58:59] op_sel:[1,1,0] op_sel_hi:[1,0,1] neg_lo:[1,0,0]
    v_pk_fma_f32 v[36:37], v[92:93], v[36:37], v[60:61] op_sel:[1,1,0] op_sel_hi:[1,0,1] neg_lo:[1,0,0]
    v_pk_fma_f32 v[38:39], v[94:95], v[38:39], v[62:63] op_sel:[1,1,0] op_sel_hi:[1,0,1] neg_lo:[1,0,0]
    v_pk_mul_f32 v[40:41], v[96:97], v[32:33] op_sel:[0,0] op_sel_hi:[0,1]
    v_pk_mul_f32 v[42:43], v[98:99], v[34:35] op_sel:[0,0] op_sel_hi:[0,1]
    v_pk_mul_f32 v[44:45], v[100:101], v[36:37] op_sel:[0,0] op_sel_hi:[0,1]
    v_pk_mul_f32 v[46:47], v[102:103], v[38:39] op_sel:[0,0] op_sel_hi:[0,1]
    v_pk_fma_f32 v[72:73], v[96:97], v[32:33], v[40:41] op_sel:[1,1,0] op_sel_hi:[1,0,1] neg_lo:[1,0,0] neg_hi:[1,0,1]
    v_pk_fma_f32 v[74:75], v[98:99], v[34:35], v[42:43] op_sel:[1,1,0] op_sel_hi:[1,0,1] neg_lo:[1,0,0] neg_hi:[1,0,1]
    v_pk_fma_f32 v[76:77], v[100:101], v[36:37], v[44:45] op_sel:[1,1,0] op_sel_hi:[1,0,1] neg_lo:[1,0,0] neg_hi:[1,0,1]
    v_pk_fma_f32 v[78:79], v[102:103], v[38:39], v[46:47] op_sel:[1,1,0] op_sel_hi:[1,0,1] neg_lo:[1,0,0] neg_hi:[1,0,1]
    v_accvgpr_read_b32 v48, a67
    v_accvgpr_read_b32 v50, a71
    v_accvgpr_read_b32 v52, a75
    v_accvgpr_read_b32 v54, a79
    v_accvgpr_read_b32 v49, a83
    v_accvgpr_read_b32 v51, a87
    v_accvgpr_read_b32 v53, a91
    v_accvgpr_read_b32 v55, a95
    v_pk_fma_f32 v[56:57], v[88:89], v[32:33], v[48:49] op_sel:[0,0,0] op_sel_hi:[0,1,1]
    v_pk_fma_f32 v[58:59], v[90:91], v[34:35], v[50:51] op_sel:[0,0,0] op_sel_hi:[0,1,1]
    v_pk_fma_f32 v[60:61], v[92:93], v[36:37], v[52:53] op_sel:[0,0,0] op_sel_hi:[0,1,1]
    v_pk_fma_f32 v[62:63], v[94:95], v[38:39], v[54:55] op_sel:[0,0,0] op_sel_hi:[0,1,1]
    v_pk_fma_f32 v[32:33], v[88:89], v[32:33], v[56:57] op_sel:[1,1,0] op_sel_hi:[1,0,1] neg_lo:[1,0,0]
    v_pk_fma_f32 v[34:35], v[90:91], v[34:35], v[58:59] op_sel:[1,1,0] op_sel_hi:[1,0,1] neg_lo:[1,0,0]
    v_pk_fma_f32 v[36:37], v[92:93], v[36:37], v[60:61] op_sel:[1,1,0] op_sel_hi:[1,0,1] neg_lo:[1,0,0]
    v_pk_fma_f32 v[38:39], v[94:95], v[38:39], v[62:63] op_sel:[1,1,0] op_sel_hi:[1,0,1] neg_lo:[1,0,0]
    v_pk_mul_f32 v[40:41], v[96:97], v[32:33] op_sel:[0,0] op_sel_hi:[0,1]
    v_pk_mul_f32 v[42:43], v[98:99], v[34:35] op_sel:[0,0] op_sel_hi:[0,1]
    v_pk_mul_f32 v[44:45], v[100:101], v[36:37] op_sel:[0,0] op_sel_hi:[0,1]
    v_pk_mul_f32 v[46:47], v[102:103], v[38:39] op_sel:[0,0] op_sel_hi:[0,1]
    v_pk_fma_f32 v[80:81], v[96:97], v[32:33], v[40:41] op_sel:[1,1,0] op_sel_hi:[1,0,1] neg_lo:[1,0,0] neg_hi:[1,0,1]
    v_pk_fma_f32 v[82:83], v[98:99], v[34:35], v[42:43] op_sel:[1,1,0] op_sel_hi:[1,0,1] neg_lo:[1,0,0] neg_hi:[1,0,1]
    v_pk_fma_f32 v[84:85], v[100:101], v[36:37], v[44:45] op_sel:[1,1,0] op_sel_hi:[1,0,1] neg_lo:[1,0,0] neg_hi:[1,0,1]
    v_pk_fma_f32 v[86:87], v[102:103], v[38:39], v[46:47] op_sel:[1,1,0] op_sel_hi:[1,0,1] neg_lo:[1,0,0] neg_hi:[1,0,1]
    v_cvt_pk_bf16_f32 v133, v72, v80
    v_cvt_pk_bf16_f32 v141, v74, v82
    v_cvt_pk_bf16_f32 v149, v76, v84
    v_cvt_pk_bf16_f32 v157, v78, v86
    v_cvt_pk_bf16_f32 v197, v73, v81
    v_cvt_pk_bf16_f32 v205, v75, v83
    v_cvt_pk_bf16_f32 v213, v77, v85
    v_cvt_pk_bf16_f32 v221, v79, v87
    v_accvgpr_read_b32 v64, a96
    v_accvgpr_read_b32 v66, a100
    v_accvgpr_read_b32 v68, a104
    v_accvgpr_read_b32 v70, a108
    v_accvgpr_read_b32 v65, a112
    v_accvgpr_read_b32 v67, a116
    v_accvgpr_read_b32 v69, a120
    v_accvgpr_read_b32 v71, a124
    v_pk_fma_f32 v[56:57], v[88:89], v[32:33], v[64:65] op_sel:[0,0,0] op_sel_hi:[0,1,1]
    v_pk_fma_f32 v[58:59], v[90:91], v[34:35], v[66:67] op_sel:[0,0,0] op_sel_hi:[0,1,1]
    v_pk_fma_f32 v[60:61], v[92:93], v[36:37], v[68:69] op_sel:[0,0,0] op_sel_hi:[0,1,1]
    v_pk_fma_f32 v[62:63], v[94:95], v[38:39], v[70:71] op_sel:[0,0,0] op_sel_hi:[0,1,1]
    v_pk_fma_f32 v[32:33], v[88:89], v[32:33], v[56:57] op_sel:[1,1,0] op_sel_hi:[1,0,1] neg_lo:[1,0,0]
    v_pk_fma_f32 v[34:35], v[90:91], v[34:35], v[58:59] op_sel:[1,1,0] op_sel_hi:[1,0,1] neg_lo:[1,0,0]
    v_pk_fma_f32 v[36:37], v[92:93], v[36:37], v[60:61] op_sel:[1,1,0] op_sel_hi:[1,0,1] neg_lo:[1,0,0]
    v_pk_fma_f32 v[38:39], v[94:95], v[38:39], v[62:63] op_sel:[1,1,0] op_sel_hi:[1,0,1] neg_lo:[1,0,0]
    v_pk_mul_f32 v[40:41], v[96:97], v[32:33] op_sel:[0,0] op_sel_hi:[0,1]
    v_pk_mul_f32 v[42:43], v[98:99], v[34:35] op_sel:[0,0] op_sel_hi:[0,1]
    v_pk_mul_f32 v[44:45], v[100:101], v[36:37] op_sel:[0,0] op_sel_hi:[0,1]
    v_pk_mul_f32 v[46:47], v[102:103], v[38:39] op_sel:[0,0] op_sel_hi:[0,1]
    v_pk_fma_f32 v[72:73], v[96:97], v[32:33], v[40:41] op_sel:[1,1,0] op_sel_hi:[1,0,1] neg_lo:[1,0,0] neg_hi:[1,0,1]
    v_pk_fma_f32 v[74:75], v[98:99], v[34:35], v[42:43] op_sel:[1,1,0] op_sel_hi:[1,0,1] neg_lo:[1,0,0] neg_hi:[1,0,1]
    v_pk_fma_f32 v[76:77], v[100:101], v[36:37], v[44:45] op_sel:[1,1,0] op_sel_hi:[1,0,1] neg_lo:[1,0,0] neg_hi:[1,0,1]
    v_pk_fma_f32 v[78:79], v[102:103], v[38:39], v[46:47] op_sel:[1,1,0] op_sel_hi:[1,0,1] neg_lo:[1,0,0] neg_hi:[1,0,1]
    v_accvgpr_read_b32 v48, a97
    v_accvgpr_read_b32 v50, a101
    v_accvgpr_read_b32 v52, a105
    v_accvgpr_read_b32 v54, a109
    v_accvgpr_read_b32 v49, a113
    v_accvgpr_read_b32 v51, a117
    v_accvgpr_read_b32 v53, a121
    v_accvgpr_read_b32 v55, a125
    v_pk_fma_f32 v[56:57], v[88:89], v[32:33], v[48:49] op_sel:[0,0,0] op_sel_hi:[0,1,1]
    v_pk_fma_f32 v[58:59], v[90:91], v[34:35], v[50:51] op_sel:[0,0,0] op_sel_hi:[0,1,1]
    v_pk_fma_f32 v[60:61], v[92:93], v[36:37], v[52:53] op_sel:[0,0,0] op_sel_hi:[0,1,1]
    v_pk_fma_f32 v[62:63], v[94:95], v[38:39], v[54:55] op_sel:[0,0,0] op_sel_hi:[0,1,1]
    v_pk_fma_f32 v[32:33], v[88:89], v[32:33], v[56:57] op_sel:[1,1,0] op_sel_hi:[1,0,1] neg_lo:[1,0,0]
    v_pk_fma_f32 v[34:35], v[90:91], v[34:35], v[58:59] op_sel:[1,1,0] op_sel_hi:[1,0,1] neg_lo:[1,0,0]
    v_pk_fma_f32 v[36:37], v[92:93], v[36:37], v[60:61] op_sel:[1,1,0] op_sel_hi:[1,0,1] neg_lo:[1,0,0]
    v_pk_fma_f32 v[38:39], v[94:95], v[38:39], v[62:63] op_sel:[1,1,0] op_sel_hi:[1,0,1] neg_lo:[1,0,0]
    v_pk_mul_f32 v[40:41], v[96:97], v[32:33] op_sel:[0,0] op_sel_hi:[0,1]
    v_pk_mul_f32 v[42:43], v[98:99], v[34:35] op_sel:[0,0] op_sel_hi:[0,1]
    v_pk_mul_f32 v[44:45], v[100:101], v[36:37] op_sel:[0,0] op_sel_hi:[0,1]
    v_pk_mul_f32 v[46:47], v[102:103], v[38:39] op_sel:[0,0] op_sel_hi:[0,1]
    v_pk_fma_f32 v[80:81], v[96:97], v[32:33], v[40:41] op_sel:[1,1,0] op_sel_hi:[1,0,1] neg_lo:[1,0,0] neg_hi:[1,0,1]
    v_pk_fma_f32 v[82:83], v[98:99], v[34:35], v[42:43] op_sel:[1,1,0] op_sel_hi:[1,0,1] neg_lo:[1,0,0] neg_hi:[1,0,1]
    v_pk_fma_f32 v[84:85], v[100:101], v[36:37], v[44:45] op_sel:[1,1,0] op_sel_hi:[1,0,1] neg_lo:[1,0,0] neg_hi:[1,0,1]
    v_pk_fma_f32 v[86:87], v[102:103], v[38:39], v[46:47] op_sel:[1,1,0] op_sel_hi:[1,0,1] neg_lo:[1,0,0] neg_hi:[1,0,1]
    v_cvt_pk_bf16_f32 v134, v72, v80
    v_cvt_pk_bf16_f32 v142, v74, v82
    v_cvt_pk_bf16_f32 v150, v76, v84
    v_cvt_pk_bf16_f32 v158, v78, v86
    v_cvt_pk_bf16_f32 v198, v73, v81
    v_cvt_pk_bf16_f32 v206, v75, v83
    v_cvt_pk_bf16_f32 v214, v77, v85
    v_cvt_pk_bf16_f32 v222, v79, v87
    v_accvgpr_read_b32 v64, a98
    v_accvgpr_read_b32 v66, a102
    v_accvgpr_read_b32 v68, a106
    v_accvgpr_read_b32 v70, a110
    v_accvgpr_read_b32 v65, a114
    v_accvgpr_read_b32 v67, a118
    v_accvgpr_read_b32 v69, a122
    v_accvgpr_read_b32 v71, a126
    v_pk_fma_f32 v[56:57], v[88:89], v[32:33], v[64:65] op_sel:[0,0,0] op_sel_hi:[0,1,1]
    v_pk_fma_f32 v[58:59], v[90:91], v[34:35], v[66:67] op_sel:[0,0,0] op_sel_hi:[0,1,1]
    v_pk_fma_f32 v[60:61], v[92:93], v[36:37], v[68:69] op_sel:[0,0,0] op_sel_hi:[0,1,1]
    v_pk_fma_f32 v[62:63], v[94:95], v[38:39], v[70:71] op_sel:[0,0,0] op_sel_hi:[0,1,1]
    v_pk_fma_f32 v[32:33], v[88:89], v[32:33], v[56:57] op_sel:[1,1,0] op_sel_hi:[1,0,1] neg_lo:[1,0,0]
    v_pk_fma_f32 v[34:35], v[90:91], v[34:35], v[58:59] op_sel:[1,1,0] op_sel_hi:[1,0,1] neg_lo:[1,0,0]
    v_pk_fma_f32 v[36:37], v[92:93], v[36:37], v[60:61] op_sel:[1,1,0] op_sel_hi:[1,0,1] neg_lo:[1,0,0]
    v_pk_fma_f32 v[38:39], v[94:95], v[38:39], v[62:63] op_sel:[1,1,0] op_sel_hi:[1,0,1] neg_lo:[1,0,0]
    v_pk_mul_f32 v[40:41], v[96:97], v[32:33] op_sel:[0,0] op_sel_hi:[0,1]
    v_pk_mul_f32 v[42:43], v[98:99], v[34:35] op_sel:[0,0] op_sel_hi:[0,1]
    v_pk_mul_f32 v[44:45], v[100:101], v[36:37] op_sel:[0,0] op_sel_hi:[0,1]
    v_pk_mul_f32 v[46:47], v[102:103], v[38:39] op_sel:[0,0] op_sel_hi:[0,1]
    v_pk_fma_f32 v[72:73], v[96:97], v[32:33], v[40:41] op_sel:[1,1,0] op_sel_hi:[1,0,1] neg_lo:[1,0,0] neg_hi:[1,0,1]
    v_pk_fma_f32 v[74:75], v[98:99], v[34:35], v[42:43] op_sel:[1,1,0] op_sel_hi:[1,0,1] neg_lo:[1,0,0] neg_hi:[1,0,1]
    v_pk_fma_f32 v[76:77], v[100:101], v[36:37], v[44:45] op_sel:[1,1,0] op_sel_hi:[1,0,1] neg_lo:[1,0,0] neg_hi:[1,0,1]
    v_pk_fma_f32 v[78:79], v[102:103], v[38:39], v[46:47] op_sel:[1,1,0] op_sel_hi:[1,0,1] neg_lo:[1,0,0] neg_hi:[1,0,1]
    v_accvgpr_read_b32 v48, a99
    v_accvgpr_read_b32 v50, a103
    v_accvgpr_read_b32 v52, a107
    v_accvgpr_read_b32 v54, a111
    v_accvgpr_read_b32 v49, a115
    v_accvgpr_read_b32 v51, a119
    v_accvgpr_read_b32 v53, a123
    v_accvgpr_read_b32 v55, a127
    v_pk_fma_f32 v[56:57], v[88:89], v[32:33], v[48:49] op_sel:[0,0,0] op_sel_hi:[0,1,1]
    v_pk_fma_f32 v[58:59], v[90:91], v[34:35], v[50:51] op_sel:[0,0,0] op_sel_hi:[0,1,1]
    v_pk_fma_f32 v[60:61], v[92:93], v[36:37], v[52:53] op_sel:[0,0,0] op_sel_hi:[0,1,1]
    v_pk_fma_f32 v[62:63], v[94:95], v[38:39], v[54:55] op_sel:[0,0,0] op_sel_hi:[0,1,1]
    v_pk_fma_f32 v[32:33], v[88:89], v[32:33], v[56:57] op_sel:[1,1,0] op_sel_hi:[1,0,1] neg_lo:[1,0,0]
    v_pk_fma_f32 v[34:35], v[90:91], v[34:35], v[58:59] op_sel:[1,1,0] op_sel_hi:[1,0,1] neg_lo:[1,0,0]
    v_pk_fma_f32 v[36:37], v[92:93], v[36:37], v[60:61] op_sel:[1,1,0] op_sel_hi:[1,0,1] neg_lo:[1,0,0]
    v_pk_fma_f32 v[38:39], v[94:95], v[38:39], v[62:63] op_sel:[1,1,0] op_sel_hi:[1,0,1] neg_lo:[1,0,0]
    v_pk_mul_f32 v[40:41], v[96:97], v[32:33] op_sel:[0,0] op_sel_hi:[0,1]
    v_pk_mul_f32 v[42:43], v[98:99], v[34:35] op_sel:[0,0] op_sel_hi:[0,1]
    v_pk_mul_f32 v[44:45], v[100:101], v[36:37] op_sel:[0,0] op_sel_hi:[0,1]
    v_pk_mul_f32 v[46:47], v[102:103], v[38:39] op_sel:[0,0] op_sel_hi:[0,1]
    v_pk_fma_f32 v[80:81], v[96:97], v[32:33], v[40:41] op_sel:[1,1,0] op_sel_hi:[1,0,1] neg_lo:[1,0,0] neg_hi:[1,0,1]
    v_pk_fma_f32 v[82:83], v[98:99], v[34:35], v[42:43] op_sel:[1,1,0] op_sel_hi:[1,0,1] neg_lo:[1,0,0] neg_hi:[1,0,1]
    v_pk_fma_f32 v[84:85], v[100:101], v[36:37], v[44:45] op_sel:[1,1,0] op_sel_hi:[1,0,1] neg_lo:[1,0,0] neg_hi:[1,0,1]
    v_pk_fma_f32 v[86:87], v[102:103], v[38:39], v[46:47] op_sel:[1,1,0] op_sel_hi:[1,0,1] neg_lo:[1,0,0] neg_hi:[1,0,1]
    v_cvt_pk_bf16_f32 v135, v72, v80
    v_cvt_pk_bf16_f32 v143, v74, v82
    v_cvt_pk_bf16_f32 v151, v76, v84
    v_cvt_pk_bf16_f32 v159, v78, v86
    v_cvt_pk_bf16_f32 v199, v73, v81
    v_cvt_pk_bf16_f32 v207, v75, v83
    v_cvt_pk_bf16_f32 v215, v77, v85
    v_cvt_pk_bf16_f32 v223, v79, v87
    v_accvgpr_read_b32 v64, a128
    v_accvgpr_read_b32 v66, a132
    v_accvgpr_read_b32 v68, a136
    v_accvgpr_read_b32 v70, a140
    v_accvgpr_read_b32 v65, a144
    v_accvgpr_read_b32 v67, a148
    v_accvgpr_read_b32 v69, a152
    v_accvgpr_read_b32 v71, a156
    v_pk_fma_f32 v[56:57], v[88:89], v[32:33], v[64:65] op_sel:[0,0,0] op_sel_hi:[0,1,1]
    v_pk_fma_f32 v[58:59], v[90:91], v[34:35], v[66:67] op_sel:[0,0,0] op_sel_hi:[0,1,1]
    v_pk_fma_f32 v[60:61], v[92:93], v[36:37], v[68:69] op_sel:[0,0,0] op_sel_hi:[0,1,1]
    v_pk_fma_f32 v[62:63], v[94:95], v[38:39], v[70:71] op_sel:[0,0,0] op_sel_hi:[0,1,1]
    v_pk_fma_f32 v[32:33], v[88:89], v[32:33], v[56:57] op_sel:[1,1,0] op_sel_hi:[1,0,1] neg_lo:[1,0,0]
    v_pk_fma_f32 v[34:35], v[90:91], v[34:35], v[58:59] op_sel:[1,1,0] op_sel_hi:[1,0,1] neg_lo:[1,0,0]
    v_pk_fma_f32 v[36:37], v[92:93], v[36:37], v[60:61] op_sel:[1,1,0] op_sel_hi:[1,0,1] neg_lo:[1,0,0]
    v_pk_fma_f32 v[38:39], v[94:95], v[38:39], v[62:63] op_sel:[1,1,0] op_sel_hi:[1,0,1] neg_lo:[1,0,0]
    v_pk_mul_f32 v[40:41], v[96:97], v[32:33] op_sel:[0,0] op_sel_hi:[0,1]
    v_pk_mul_f32 v[42:43], v[98:99], v[34:35] op_sel:[0,0] op_sel_hi:[0,1]
    v_pk_mul_f32 v[44:45], v[100:101], v[36:37] op_sel:[0,0] op_sel_hi:[0,1]
    v_pk_mul_f32 v[46:47], v[102:103], v[38:39] op_sel:[0,0] op_sel_hi:[0,1]
    v_pk_fma_f32 v[72:73], v[96:97], v[32:33], v[40:41] op_sel:[1,1,0] op_sel_hi:[1,0,1] neg_lo:[1,0,0] neg_hi:[1,0,1]
    v_pk_fma_f32 v[74:75], v[98:99], v[34:35], v[42:43] op_sel:[1,1,0] op_sel_hi:[1,0,1] neg_lo:[1,0,0] neg_hi:[1,0,1]
    v_pk_fma_f32 v[76:77], v[100:101], v[36:37], v[44:45] op_sel:[1,1,0] op_sel_hi:[1,0,1] neg_lo:[1,0,0] neg_hi:[1,0,1]
    v_pk_fma_f32 v[78:79], v[102:103], v[38:39], v[46:47] op_sel:[1,1,0] op_sel_hi:[1,0,1] neg_lo:[1,0,0] neg_hi:[1,0,1]
    v_accvgpr_read_b32 v48, a129
    v_accvgpr_read_b32 v50, a133
    v_accvgpr_read_b32 v52, a137
    v_accvgpr_read_b32 v54, a141
    v_accvgpr_read_b32 v49, a145
    v_accvgpr_read_b32 v51, a149
    v_accvgpr_read_b32 v53, a153
    v_accvgpr_read_b32 v55, a157
    v_pk_fma_f32 v[56:57], v[88:89], v[32:33], v[48:49] op_sel:[0,0,0] op_sel_hi:[0,1,1]
    v_pk_fma_f32 v[58:59], v[90:91], v[34:35], v[50:51] op_sel:[0,0,0] op_sel_hi:[0,1,1]
    v_pk_fma_f32 v[60:61], v[92:93], v[36:37], v[52:53] op_sel:[0,0,0] op_sel_hi:[0,1,1]
    v_pk_fma_f32 v[62:63], v[94:95], v[38:39], v[54:55] op_sel:[0,0,0] op_sel_hi:[0,1,1]
    v_pk_fma_f32 v[32:33], v[88:89], v[32:33], v[56:57] op_sel:[1,1,0] op_sel_hi:[1,0,1] neg_lo:[1,0,0]
    v_pk_fma_f32 v[34:35], v[90:91], v[34:35], v[58:59] op_sel:[1,1,0] op_sel_hi:[1,0,1] neg_lo:[1,0,0]
    v_pk_fma_f32 v[36:37], v[92:93], v[36:37], v[60:61] op_sel:[1,1,0] op_sel_hi:[1,0,1] neg_lo:[1,0,0]
    v_pk_fma_f32 v[38:39], v[94:95], v[38:39], v[62:63] op_sel:[1,1,0] op_sel_hi:[1,0,1] neg_lo:[1,0,0]
    v_pk_mul_f32 v[40:41], v[96:97], v[32:33] op_sel:[0,0] op_sel_hi:[0,1]
    v_pk_mul_f32 v[42:43], v[98:99], v[34:35] op_sel:[0,0] op_sel_hi:[0,1]
    v_pk_mul_f32 v[44:45], v[100:101], v[36:37] op_sel:[0,0] op_sel_hi:[0,1]
    v_pk_mul_f32 v[46:47], v[102:103], v[38:39] op_sel:[0,0] op_sel_hi:[0,1]
    v_pk_fma_f32 v[80:81], v[96:97], v[32:33], v[40:41] op_sel:[1,1,0] op_sel_hi:[1,0,1] neg_lo:[1,0,0] neg_hi:[1,0,1]
    v_pk_fma_f32 v[82:83], v[98:99], v[34:35], v[42:43] op_sel:[1,1,0] op_sel_hi:[1,0,1] neg_lo:[1,0,0] neg_hi:[1,0,1]
    v_pk_fma_f32 v[84:85], v[100:101], v[36:37], v[44:45] op_sel:[1,1,0] op_sel_hi:[1,0,1] neg_lo:[1,0,0] neg_hi:[1,0,1]
    v_pk_fma_f32 v[86:87], v[102:103], v[38:39], v[46:47] op_sel:[1,1,0] op_sel_hi:[1,0,1] neg_lo:[1,0,0] neg_hi:[1,0,1]
    v_cvt_pk_bf16_f32 v160, v72, v80
    v_cvt_pk_bf16_f32 v168, v74, v82
    v_cvt_pk_bf16_f32 v176, v76, v84
    v_cvt_pk_bf16_f32 v184, v78, v86
    v_cvt_pk_bf16_f32 v224, v73, v81
    v_cvt_pk_bf16_f32 v232, v75, v83
    v_cvt_pk_bf16_f32 v240, v77, v85
    v_cvt_pk_bf16_f32 v248, v79, v87
    v_accvgpr_read_b32 v64, a130
    v_accvgpr_read_b32 v66, a134
    v_accvgpr_read_b32 v68, a138
    v_accvgpr_read_b32 v70, a142
    v_accvgpr_read_b32 v65, a146
    v_accvgpr_read_b32 v67, a150
    v_accvgpr_read_b32 v69, a154
    v_accvgpr_read_b32 v71, a158
    v_pk_fma_f32 v[56:57], v[88:89], v[32:33], v[64:65] op_sel:[0,0,0] op_sel_hi:[0,1,1]
    v_pk_fma_f32 v[58:59], v[90:91], v[34:35], v[66:67] op_sel:[0,0,0] op_sel_hi:[0,1,1]
    v_pk_fma_f32 v[60:61], v[92:93], v[36:37], v[68:69] op_sel:[0,0,0] op_sel_hi:[0,1,1]
    v_pk_fma_f32 v[62:63], v[94:95], v[38:39], v[70:71] op_sel:[0,0,0] op_sel_hi:[0,1,1]
    v_pk_fma_f32 v[32:33], v[88:89], v[32:33], v[56:57] op_sel:[1,1,0] op_sel_hi:[1,0,1] neg_lo:[1,0,0]
    v_pk_fma_f32 v[34:35], v[90:91], v[34:35], v[58:59] op_sel:[1,1,0] op_sel_hi:[1,0,1] neg_lo:[1,0,0]
    v_pk_fma_f32 v[36:37], v[92:93], v[36:37], v[60:61] op_sel:[1,1,0] op_sel_hi:[1,0,1] neg_lo:[1,0,0]
    v_pk_fma_f32 v[38:39], v[94:95], v[38:39], v[62:63] op_sel:[1,1,0] op_sel_hi:[1,0,1] neg_lo:[1,0,0]
    v_pk_mul_f32 v[40:41], v[96:97], v[32:33] op_sel:[0,0] op_sel_hi:[0,1]
    v_pk_mul_f32 v[42:43], v[98:99], v[34:35] op_sel:[0,0] op_sel_hi:[0,1]
    v_pk_mul_f32 v[44:45], v[100:101], v[36:37] op_sel:[0,0] op_sel_hi:[0,1]
    v_pk_mul_f32 v[46:47], v[102:103], v[38:39] op_sel:[0,0] op_sel_hi:[0,1]
    v_pk_fma_f32 v[72:73], v[96:97], v[32:33], v[40:41] op_sel:[1,1,0] op_sel_hi:[1,0,1] neg_lo:[1,0,0] neg_hi:[1,0,1]
    v_pk_fma_f32 v[74:75], v[98:99], v[34:35], v[42:43] op_sel:[1,1,0] op_sel_hi:[1,0,1] neg_lo:[1,0,0] neg_hi:[1,0,1]
    v_pk_fma_f32 v[76:77], v[100:101], v[36:37], v[44:45] op_sel:[1,1,0] op_sel_hi:[1,0,1] neg_lo:[1,0,0] neg_hi:[1,0,1]
    v_pk_fma_f32 v[78:79], v[102:103], v[38:39], v[46:47] op_sel:[1,1,0] op_sel_hi:[1,0,1] neg_lo:[1,0,0] neg_hi:[1,0,1]
    v_accvgpr_read_b32 v48, a131
    v_accvgpr_read_b32 v50, a135
    v_accvgpr_read_b32 v52, a139
    v_accvgpr_read_b32 v54, a143
    v_accvgpr_read_b32 v49, a147
    v_accvgpr_read_b32 v51, a151
    v_accvgpr_read_b32 v53, a155
    v_accvgpr_read_b32 v55, a159
    v_pk_fma_f32 v[56:57], v[88:89], v[32:33], v[48:49] op_sel:[0,0,0] op_sel_hi:[0,1,1]
    v_pk_fma_f32 v[58:59], v[90:91], v[34:35], v[50:51] op_sel:[0,0,0] op_sel_hi:[0,1,1]
    v_pk_fma_f32 v[60:61], v[92:93], v[36:37], v[52:53] op_sel:[0,0,0] op_sel_hi:[0,1,1]
    v_pk_fma_f32 v[62:63], v[94:95], v[38:39], v[54:55] op_sel:[0,0,0] op_sel_hi:[0,1,1]
    v_pk_fma_f32 v[32:33], v[88:89], v[32:33], v[56:57] op_sel:[1,1,0] op_sel_hi:[1,0,1] neg_lo:[1,0,0]
    v_pk_fma_f32 v[34:35], v[90:91], v[34:35], v[58:59] op_sel:[1,1,0] op_sel_hi:[1,0,1] neg_lo:[1,0,0]
    v_pk_fma_f32 v[36:37], v[92:93], v[36:37], v[60:61] op_sel:[1,1,0] op_sel_hi:[1,0,1] neg_lo:[1,0,0]
    v_pk_fma_f32 v[38:39], v[94:95], v[38:39], v[62:63] op_sel:[1,1,0] op_sel_hi:[1,0,1] neg_lo:[1,0,0]
    v_pk_mul_f32 v[40:41], v[96:97], v[32:33] op_sel:[0,0] op_sel_hi:[0,1]
    v_pk_mul_f32 v[42:43], v[98:99], v[34:35] op_sel:[0,0] op_sel_hi:[0,1]
    v_pk_mul_f32 v[44:45], v[100:101], v[36:37] op_sel:[0,0] op_sel_hi:[0,1]
    v_pk_mul_f32 v[46:47], v[102:103], v[38:39] op_sel:[0,0] op_sel_hi:[0,1]
    v_pk_fma_f32 v[80:81], v[96:97], v[32:33], v[40:41] op_sel:[1,1,0] op_sel_hi:[1,0,1] neg_lo:[1,0,0] neg_hi:[1,0,1]
    v_pk_fma_f32 v[82:83], v[98:99], v[34:35], v[42:43] op_sel:[1,1,0] op_sel_hi:[1,0,1] neg_lo:[1,0,0] neg_hi:[1,0,1]
    v_pk_fma_f32 v[84:85], v[100:101], v[36:37], v[44:45] op_sel:[1,1,0] op_sel_hi:[1,0,1] neg_lo:[1,0,0] neg_hi:[1,0,1]
    v_pk_fma_f32 v[86:87], v[102:103], v[38:39], v[46:47] op_sel:[1,1,0] op_sel_hi:[1,0,1] neg_lo:[1,0,0] neg_hi:[1,0,1]
    v_cvt_pk_bf16_f32 v161, v72, v80
    v_cvt_pk_bf16_f32 v169, v74, v82
    v_cvt_pk_bf16_f32 v177, v76, v84
    v_cvt_pk_bf16_f32 v185, v78, v86
    v_cvt_pk_bf16_f32 v225, v73, v81
    v_cvt_pk_bf16_f32 v233, v75, v83
    v_cvt_pk_bf16_f32 v241, v77, v85
    v_cvt_pk_bf16_f32 v249, v79, v87
    v_accvgpr_read_b32 v64, a160
    v_accvgpr_read_b32 v66, a164
    v_accvgpr_read_b32 v68, a168
    v_accvgpr_read_b32 v70, a172
    v_accvgpr_read_b32 v65, a176
    v_accvgpr_read_b32 v67, a180
    v_accvgpr_read_b32 v69, a184
    v_accvgpr_read_b32 v71, a188
    v_pk_fma_f32 v[56:57], v[88:89], v[32:33], v[64:65] op_sel:[0,0,0] op_sel_hi:[0,1,1]
    v_pk_fma_f32 v[58:59], v[90:91], v[34:35], v[66:67] op_sel:[0,0,0] op_sel_hi:[0,1,1]
    v_pk_fma_f32 v[60:61], v[92:93], v[36:37], v[68:69] op_sel:[0,0,0] op_sel_hi:[0,1,1]
    v_pk_fma_f32 v[62:63], v[94:95], v[38:39], v[70:71] op_sel:[0,0,0] op_sel_hi:[0,1,1]
    v_pk_fma_f32 v[32:33], v[88:89], v[32:33], v[56:57] op_sel:[1,1,0] op_sel_hi:[1,0,1] neg_lo:[1,0,0]
    v_pk_fma_f32 v[34:35], v[90:91], v[34:35], v[58:59] op_sel:[1,1,0] op_sel_hi:[1,0,1] neg_lo:[1,0,0]
    v_pk_fma_f32 v[36:37], v[92:93], v[36:37], v[60:61] op_sel:[1,1,0] op_sel_hi:[1,0,1] neg_lo:[1,0,0]
    v_pk_fma_f32 v[38:39], v[94:95], v[38:39], v[62:63] op_sel:[1,1,0] op_sel_hi:[1,0,1] neg_lo:[1,0,0]
    v_pk_mul_f32 v[40:41], v[96:97], v[32:33] op_sel:[0,0] op_sel_hi:[0,1]
    v_pk_mul_f32 v[42:43], v[98:99], v[34:35] op_sel:[0,0] op_sel_hi:[0,1]
    v_pk_mul_f32 v[44:45], v[100:101], v[36:37] op_sel:[0,0] op_sel_hi:[0,1]
    v_pk_mul_f32 v[46:47], v[102:103], v[38:39] op_sel:[0,0] op_sel_hi:[0,1]
    v_pk_fma_f32 v[72:73], v[96:97], v[32:33], v[40:41] op_sel:[1,1,0] op_sel_hi:[1,0,1] neg_lo:[1,0,0] neg_hi:[1,0,1]
    v_pk_fma_f32 v[74:75], v[98:99], v[34:35], v[42:43] op_sel:[1,1,0] op_sel_hi:[1,0,1] neg_lo:[1,0,0] neg_hi:[1,0,1]
    v_pk_fma_f32 v[76:77], v[100:101], v[36:37], v[44:45] op_sel:[1,1,0] op_sel_hi:[1,0,1] neg_lo:[1,0,0] neg_hi:[1,0,1]
    v_pk_fma_f32 v[78:79], v[102:103], v[38:39], v[46:47] op_sel:[1,1,0] op_sel_hi:[1,0,1] neg_lo:[1,0,0] neg_hi:[1,0,1]
    v_accvgpr_read_b32 v48, a161
    v_accvgpr_read_b32 v50, a165
    v_accvgpr_read_b32 v52, a169
    v_accvgpr_read_b32 v54, a173
    v_accvgpr_read_b32 v49, a177
    v_accvgpr_read_b32 v51, a181
    v_accvgpr_read_b32 v53, a185
    v_accvgpr_read_b32 v55, a189
    v_pk_fma_f32 v[56:57], v[88:89], v[32:33], v[48:49] op_sel:[0,0,0] op_sel_hi:[0,1,1]
    v_pk_fma_f32 v[58:59], v[90:91], v[34:35], v[50:51] op_sel:[0,0,0] op_sel_hi:[0,1,1]
    v_pk_fma_f32 v[60:61], v[92:93], v[36:37], v[52:53] op_sel:[0,0,0] op_sel_hi:[0,1,1]
    v_pk_fma_f32 v[62:63], v[94:95], v[38:39], v[54:55] op_sel:[0,0,0] op_sel_hi:[0,1,1]
    v_pk_fma_f32 v[32:33], v[88:89], v[32:33], v[56:57] op_sel:[1,1,0] op_sel_hi:[1,0,1] neg_lo:[1,0,0]
    v_pk_fma_f32 v[34:35], v[90:91], v[34:35], v[58:59] op_sel:[1,1,0] op_sel_hi:[1,0,1] neg_lo:[1,0,0]
    v_pk_fma_f32 v[36:37], v[92:93], v[36:37], v[60:61] op_sel:[1,1,0] op_sel_hi:[1,0,1] neg_lo:[1,0,0]
    v_pk_fma_f32 v[38:39], v[94:95], v[38:39], v[62:63] op_sel:[1,1,0] op_sel_hi:[1,0,1] neg_lo:[1,0,0]
    v_pk_mul_f32 v[40:41], v[96:97], v[32:33] op_sel:[0,0] op_sel_hi:[0,1]
    v_pk_mul_f32 v[42:43], v[98:99], v[34:35] op_sel:[0,0] op_sel_hi:[0,1]
    v_pk_mul_f32 v[44:45], v[100:101], v[36:37] op_sel:[0,0] op_sel_hi:[0,1]
    v_pk_mul_f32 v[46:47], v[102:103], v[38:39] op_sel:[0,0] op_sel_hi:[0,1]
    v_pk_fma_f32 v[80:81], v[96:97], v[32:33], v[40:41] op_sel:[1,1,0] op_sel_hi:[1,0,1] neg_lo:[1,0,0] neg_hi:[1,0,1]
    v_pk_fma_f32 v[82:83], v[98:99], v[34:35], v[42:43] op_sel:[1,1,0] op_sel_hi:[1,0,1] neg_lo:[1,0,0] neg_hi:[1,0,1]
    v_pk_fma_f32 v[84:85], v[100:101], v[36:37], v[44:45] op_sel:[1,1,0] op_sel_hi:[1,0,1] neg_lo:[1,0,0] neg_hi:[1,0,1]
    v_pk_fma_f32 v[86:87], v[102:103], v[38:39], v[46:47] op_sel:[1,1,0] op_sel_hi:[1,0,1] neg_lo:[1,0,0] neg_hi:[1,0,1]
    v_cvt_pk_bf16_f32 v162, v72, v80
    v_cvt_pk_bf16_f32 v170, v74, v82
    v_cvt_pk_bf16_f32 v178, v76, v84
    v_cvt_pk_bf16_f32 v186, v78, v86
    v_cvt_pk_bf16_f32 v226, v73, v81
    v_cvt_pk_bf16_f32 v234, v75, v83
    v_cvt_pk_bf16_f32 v242, v77, v85
    v_cvt_pk_bf16_f32 v250, v79, v87
    v_accvgpr_read_b32 v64, a162
    v_accvgpr_read_b32 v66, a166
    v_accvgpr_read_b32 v68, a170
    v_accvgpr_read_b32 v70, a174
    v_accvgpr_read_b32 v65, a178
    v_accvgpr_read_b32 v67, a182
    v_accvgpr_read_b32 v69, a186
    v_accvgpr_read_b32 v71, a190
    v_pk_fma_f32 v[56:57], v[88:89], v[32:33], v[64:65] op_sel:[0,0,0] op_sel_hi:[0,1,1]
    v_pk_fma_f32 v[58:59], v[90:91], v[34:35], v[66:67] op_sel:[0,0,0] op_sel_hi:[0,1,1]
    v_pk_fma_f32 v[60:61], v[92:93], v[36:37], v[68:69] op_sel:[0,0,0] op_sel_hi:[0,1,1]
    v_pk_fma_f32 v[62:63], v[94:95], v[38:39], v[70:71] op_sel:[0,0,0] op_sel_hi:[0,1,1]
    v_pk_fma_f32 v[32:33], v[88:89], v[32:33], v[56:57] op_sel:[1,1,0] op_sel_hi:[1,0,1] neg_lo:[1,0,0]
    v_pk_fma_f32 v[34:35], v[90:91], v[34:35], v[58:59] op_sel:[1,1,0] op_sel_hi:[1,0,1] neg_lo:[1,0,0]
    v_pk_fma_f32 v[36:37], v[92:93], v[36:37], v[60:61] op_sel:[1,1,0] op_sel_hi:[1,0,1] neg_lo:[1,0,0]
    v_pk_fma_f32 v[38:39], v[94:95], v[38:39], v[62:63] op_sel:[1,1,0] op_sel_hi:[1,0,1] neg_lo:[1,0,0]
    v_pk_mul_f32 v[40:41], v[96:97], v[32:33] op_sel:[0,0] op_sel_hi:[0,1]
    v_pk_mul_f32 v[42:43], v[98:99], v[34:35] op_sel:[0,0] op_sel_hi:[0,1]
    v_pk_mul_f32 v[44:45], v[100:101], v[36:37] op_sel:[0,0] op_sel_hi:[0,1]
    v_pk_mul_f32 v[46:47], v[102:103], v[38:39] op_sel:[0,0] op_sel_hi:[0,1]
    v_pk_fma_f32 v[72:73], v[96:97], v[32:33], v[40:41] op_sel:[1,1,0] op_sel_hi:[1,0,1] neg_lo:[1,0,0] neg_hi:[1,0,1]
    v_pk_fma_f32 v[74:75], v[98:99], v[34:35], v[42:43] op_sel:[1,1,0] op_sel_hi:[1,0,1] neg_lo:[1,0,0] neg_hi:[1,0,1]
    v_pk_fma_f32 v[76:77], v[100:101], v[36:37], v[44:45] op_sel:[1,1,0] op_sel_hi:[1,0,1] neg_lo:[1,0,0] neg_hi:[1,0,1]
    v_pk_fma_f32 v[78:79], v[102:103], v[38:39], v[46:47] op_sel:[1,1,0] op_sel_hi:[1,0,1] neg_lo:[1,0,0] neg_hi:[1,0,1]
    v_accvgpr_read_b32 v48, a163
    v_accvgpr_read_b32 v50, a167
    v_accvgpr_read_b32 v52, a171
    v_accvgpr_read_b32 v54, a175
    v_accvgpr_read_b32 v49, a179
    v_accvgpr_read_b32 v51, a183
    v_accvgpr_read_b32 v53, a187
    v_accvgpr_read_b32 v55, a191
    v_pk_fma_f32 v[56:57], v[88:89], v[32:33], v[48:49] op_sel:[0,0,0] op_sel_hi:[0,1,1]
    v_pk_fma_f32 v[58:59], v[90:91], v[34:35], v[50:51] op_sel:[0,0,0] op_sel_hi:[0,1,1]
    v_pk_fma_f32 v[60:61], v[92:93], v[36:37], v[52:53] op_sel:[0,0,0] op_sel_hi:[0,1,1]
    v_pk_fma_f32 v[62:63], v[94:95], v[38:39], v[54:55] op_sel:[0,0,0] op_sel_hi:[0,1,1]
    v_pk_fma_f32 v[32:33], v[88:89], v[32:33], v[56:57] op_sel:[1,1,0] op_sel_hi:[1,0,1] neg_lo:[1,0,0]
    v_pk_fma_f32 v[34:35], v[90:91], v[34:35], v[58:59] op_sel:[1,1,0] op_sel_hi:[1,0,1] neg_lo:[1,0,0]
    v_pk_fma_f32 v[36:37], v[92:93], v[36:37], v[60:61] op_sel:[1,1,0] op_sel_hi:[1,0,1] neg_lo:[1,0,0]
    v_pk_fma_f32 v[38:39], v[94:95], v[38:39], v[62:63] op_sel:[1,1,0] op_sel_hi:[1,0,1] neg_lo:[1,0,0]
    v_pk_mul_f32 v[40:41], v[96:97], v[32:33] op_sel:[0,0] op_sel_hi:[0,1]
    v_pk_mul_f32 v[42:43], v[98:99], v[34:35] op_sel:[0,0] op_sel_hi:[0,1]
    v_pk_mul_f32 v[44:45], v[100:101], v[36:37] op_sel:[0,0] op_sel_hi:[0,1]
    v_pk_mul_f32 v[46:47], v[102:103], v[38:39] op_sel:[0,0] op_sel_hi:[0,1]
    v_pk_fma_f32 v[80:81], v[96:97], v[32:33], v[40:41] op_sel:[1,1,0] op_sel_hi:[1,0,1] neg_lo:[1,0,0] neg_hi:[1,0,1]
    v_pk_fma_f32 v[82:83], v[98:99], v[34:35], v[42:43] op_sel:[1,1,0] op_sel_hi:[1,0,1] neg_lo:[1,0,0] neg_hi:[1,0,1]
    v_pk_fma_f32 v[84:85], v[100:101], v[36:37], v[44:45] op_sel:[1,1,0] op_sel_hi:[1,0,1] neg_lo:[1,0,0] neg_hi:[1,0,1]
    v_pk_fma_f32 v[86:87], v[102:103], v[38:39], v[46:47] op_sel:[1,1,0] op_sel_hi:[1,0,1] neg_lo:[1,0,0] neg_hi:[1,0,1]
    v_cvt_pk_bf16_f32 v163, v72, v80
    v_cvt_pk_bf16_f32 v171, v74, v82
    v_cvt_pk_bf16_f32 v179, v76, v84
    v_cvt_pk_bf16_f32 v187, v78, v86
    v_cvt_pk_bf16_f32 v227, v73, v81
    v_cvt_pk_bf16_f32 v235, v75, v83
    v_cvt_pk_bf16_f32 v243, v77, v85
    v_cvt_pk_bf16_f32 v251, v79, v87
    v_accvgpr_read_b32 v64, a192
    v_accvgpr_read_b32 v66, a196
    v_accvgpr_read_b32 v68, a200
    v_accvgpr_read_b32 v70, a204
    v_accvgpr_read_b32 v65, a208
    v_accvgpr_read_b32 v67, a212
    v_accvgpr_read_b32 v69, a216
    v_accvgpr_read_b32 v71, a220
    v_pk_fma_f32 v[56:57], v[88:89], v[32:33], v[64:65] op_sel:[0,0,0] op_sel_hi:[0,1,1]
    v_pk_fma_f32 v[58:59], v[90:91], v[34:35], v[66:67] op_sel:[0,0,0] op_sel_hi:[0,1,1]
    v_pk_fma_f32 v[60:61], v[92:93], v[36:37], v[68:69] op_sel:[0,0,0] op_sel_hi:[0,1,1]
    v_pk_fma_f32 v[62:63], v[94:95], v[38:39], v[70:71] op_sel:[0,0,0] op_sel_hi:[0,1,1]
    v_pk_fma_f32 v[32:33], v[88:89], v[32:33], v[56:57] op_sel:[1,1,0] op_sel_hi:[1,0,1] neg_lo:[1,0,0]
    v_pk_fma_f32 v[34:35], v[90:91], v[34:35], v[58:59] op_sel:[1,1,0] op_sel_hi:[1,0,1] neg_lo:[1,0,0]
    v_pk_fma_f32 v[36:37], v[92:93], v[36:37], v[60:61] op_sel:[1,1,0] op_sel_hi:[1,0,1] neg_lo:[1,0,0]
    v_pk_fma_f32 v[38:39], v[94:95], v[38:39], v[62:63] op_sel:[1,1,0] op_sel_hi:[1,0,1] neg_lo:[1,0,0]
    v_pk_mul_f32 v[40:41], v[96:97], v[32:33] op_sel:[0,0] op_sel_hi:[0,1]
    v_pk_mul_f32 v[42:43], v[98:99], v[34:35] op_sel:[0,0] op_sel_hi:[0,1]
    v_pk_mul_f32 v[44:45], v[100:101], v[36:37] op_sel:[0,0] op_sel_hi:[0,1]
    v_pk_mul_f32 v[46:47], v[102:103], v[38:39] op_sel:[0,0] op_sel_hi:[0,1]
    v_pk_fma_f32 v[72:73], v[96:97], v[32:33], v[40:41] op_sel:[1,1,0] op_sel_hi:[1,0,1] neg_lo:[1,0,0] neg_hi:[1,0,1]
    v_pk_fma_f32 v[74:75], v[98:99], v[34:35], v[42:43] op_sel:[1,1,0] op_sel_hi:[1,0,1] neg_lo:[1,0,0] neg_hi:[1,0,1]
    v_pk_fma_f32 v[76:77], v[100:101], v[36:37], v[44:45] op_sel:[1,1,0] op_sel_hi:[1,0,1] neg_lo:[1,0,0] neg_hi:[1,0,1]
    v_pk_fma_f32 v[78:79], v[102:103], v[38:39], v[46:47] op_sel:[1,1,0] op_sel_hi:[1,0,1] neg_lo:[1,0,0] neg_hi:[1,0,1]
    v_accvgpr_read_b32 v48, a193
    v_accvgpr_read_b32 v50, a197
    v_accvgpr_read_b32 v52, a201
    v_accvgpr_read_b32 v54, a205
    v_accvgpr_read_b32 v49, a209
    v_accvgpr_read_b32 v51, a213
    v_accvgpr_read_b32 v53, a217
    v_accvgpr_read_b32 v55, a221
    v_pk_fma_f32 v[56:57], v[88:89], v[32:33], v[48:49] op_sel:[0,0,0] op_sel_hi:[0,1,1]
    v_pk_fma_f32 v[58:59], v[90:91], v[34:35], v[50:51] op_sel:[0,0,0] op_sel_hi:[0,1,1]
    v_pk_fma_f32 v[60:61], v[92:93], v[36:37], v[52:53] op_sel:[0,0,0] op_sel_hi:[0,1,1]
    v_pk_fma_f32 v[62:63], v[94:95], v[38:39], v[54:55] op_sel:[0,0,0] op_sel_hi:[0,1,1]
    v_pk_fma_f32 v[32:33], v[88:89], v[32:33], v[56:57] op_sel:[1,1,0] op_sel_hi:[1,0,1] neg_lo:[1,0,0]
    v_pk_fma_f32 v[34:35], v[90:91], v[34:35], v[58:59] op_sel:[1,1,0] op_sel_hi:[1,0,1] neg_lo:[1,0,0]
    v_pk_fma_f32 v[36:37], v[92:93], v[36:37], v[60:61] op_sel:[1,1,0] op_sel_hi:[1,0,1] neg_lo:[1,0,0]
    v_pk_fma_f32 v[38:39], v[94:95], v[38:39], v[62:63] op_sel:[1,1,0] op_sel_hi:[1,0,1] neg_lo:[1,0,0]
    v_pk_mul_f32 v[40:41], v[96:97], v[32:33] op_sel:[0,0] op_sel_hi:[0,1]
    v_pk_mul_f32 v[42:43], v[98:99], v[34:35] op_sel:[0,0] op_sel_hi:[0,1]
    v_pk_mul_f32 v[44:45], v[100:101], v[36:37] op_sel:[0,0] op_sel_hi:[0,1]
    v_pk_mul_f32 v[46:47], v[102:103], v[38:39] op_sel:[0,0] op_sel_hi:[0,1]
    v_pk_fma_f32 v[80:81], v[96:97], v[32:33], v[40:41] op_sel:[1,1,0] op_sel_hi:[1,0,1] neg_lo:[1,0,0] neg_hi:[1,0,1]
    v_pk_fma_f32 v[82:83], v[98:99], v[34:35], v[42:43] op_sel:[1,1,0] op_sel_hi:[1,0,1] neg_lo:[1,0,0] neg_hi:[1,0,1]
    v_pk_fma_f32 v[84:85], v[100:101], v[36:37], v[44:45] op_sel:[1,1,0] op_sel_hi:[1,0,1] neg_lo:[1,0,0] neg_hi:[1,0,1]
    v_pk_fma_f32 v[86:87], v[102:103], v[38:39], v[46:47] op_sel:[1,1,0] op_sel_hi:[1,0,1] neg_lo:[1,0,0] neg_hi:[1,0,1]
    v_cvt_pk_bf16_f32 v164, v72, v80
    v_cvt_pk_bf16_f32 v172, v74, v82
    v_cvt_pk_bf16_f32 v180, v76, v84
    v_cvt_pk_bf16_f32 v188, v78, v86
    v_cvt_pk_bf16_f32 v228, v73, v81
    v_cvt_pk_bf16_f32 v236, v75, v83
    v_cvt_pk_bf16_f32 v244, v77, v85
    v_cvt_pk_bf16_f32 v252, v79, v87
    v_accvgpr_read_b32 v64, a194
    v_accvgpr_read_b32 v66, a198
    v_accvgpr_read_b32 v68, a202
    v_accvgpr_read_b32 v70, a206
    v_accvgpr_read_b32 v65, a210
    v_accvgpr_read_b32 v67, a214
    v_accvgpr_read_b32 v69, a218
    v_accvgpr_read_b32 v71, a222
    v_pk_fma_f32 v[56:57], v[88:89], v[32:33], v[64:65] op_sel:[0,0,0] op_sel_hi:[0,1,1]
    v_pk_fma_f32 v[58:59], v[90:91], v[34:35], v[66:67] op_sel:[0,0,0] op_sel_hi:[0,1,1]
    v_pk_fma_f32 v[60:61], v[92:93], v[36:37], v[68:69] op_sel:[0,0,0] op_sel_hi:[0,1,1]
    v_pk_fma_f32 v[62:63], v[94:95], v[38:39], v[70:71] op_sel:[0,0,0] op_sel_hi:[0,1,1]
    v_pk_fma_f32 v[32:33], v[88:89], v[32:33], v[56:57] op_sel:[1,1,0] op_sel_hi:[1,0,1] neg_lo:[1,0,0]
    v_pk_fma_f32 v[34:35], v[90:91], v[34:35], v[58:59] op_sel:[1,1,0] op_sel_hi:[1,0,1] neg_lo:[1,0,0]
    v_pk_fma_f32 v[36:37], v[92:93], v[36:37], v[60:61] op_sel:[1,1,0] op_sel_hi:[1,0,1] neg_lo:[1,0,0]
    v_pk_fma_f32 v[38:39], v[94:95], v[38:39], v[62:63] op_sel:[1,1,0] op_sel_hi:[1,0,1] neg_lo:[1,0,0]
    v_pk_mul_f32 v[40:41], v[96:97], v[32:33] op_sel:[0,0] op_sel_hi:[0,1]
    v_pk_mul_f32 v[42:43], v[98:99], v[34:35] op_sel:[0,0] op_sel_hi:[0,1]
    v_pk_mul_f32 v[44:45], v[100:101], v[36:37] op_sel:[0,0] op_sel_hi:[0,1]
    v_pk_mul_f32 v[46:47], v[102:103], v[38:39] op_sel:[0,0] op_sel_hi:[0,1]
    v_pk_fma_f32 v[72:73], v[96:97], v[32:33], v[40:41] op_sel:[1,1,0] op_sel_hi:[1,0,1] neg_lo:[1,0,0] neg_hi:[1,0,1]
    v_pk_fma_f32 v[74:75], v[98:99], v[34:35], v[42:43] op_sel:[1,1,0] op_sel_hi:[1,0,1] neg_lo:[1,0,0] neg_hi:[1,0,1]
    v_pk_fma_f32 v[76:77], v[100:101], v[36:37], v[44:45] op_sel:[1,1,0] op_sel_hi:[1,0,1] neg_lo:[1,0,0] neg_hi:[1,0,1]
    v_pk_fma_f32 v[78:79], v[102:103], v[38:39], v[46:47] op_sel:[1,1,0] op_sel_hi:[1,0,1] neg_lo:[1,0,0] neg_hi:[1,0,1]
    v_accvgpr_read_b32 v48, a195
    v_accvgpr_read_b32 v50, a199
    v_accvgpr_read_b32 v52, a203
    v_accvgpr_read_b32 v54, a207
    v_accvgpr_read_b32 v49, a211
    v_accvgpr_read_b32 v51, a215
    v_accvgpr_read_b32 v53, a219
    v_accvgpr_read_b32 v55, a223
    v_pk_fma_f32 v[56:57], v[88:89], v[32:33], v[48:49] op_sel:[0,0,0] op_sel_hi:[0,1,1]
    v_pk_fma_f32 v[58:59], v[90:91], v[34:35], v[50:51] op_sel:[0,0,0] op_sel_hi:[0,1,1]
    v_pk_fma_f32 v[60:61], v[92:93], v[36:37], v[52:53] op_sel:[0,0,0] op_sel_hi:[0,1,1]
    v_pk_fma_f32 v[62:63], v[94:95], v[38:39], v[54:55] op_sel:[0,0,0] op_sel_hi:[0,1,1]
    v_pk_fma_f32 v[32:33], v[88:89], v[32:33], v[56:57] op_sel:[1,1,0] op_sel_hi:[1,0,1] neg_lo:[1,0,0]
    v_pk_fma_f32 v[34:35], v[90:91], v[34:35], v[58:59] op_sel:[1,1,0] op_sel_hi:[1,0,1] neg_lo:[1,0,0]
    v_pk_fma_f32 v[36:37], v[92:93], v[36:37], v[60:61] op_sel:[1,1,0] op_sel_hi:[1,0,1] neg_lo:[1,0,0]
    v_pk_fma_f32 v[38:39], v[94:95], v[38:39], v[62:63] op_sel:[1,1,0] op_sel_hi:[1,0,1] neg_lo:[1,0,0]
    v_pk_mul_f32 v[40:41], v[96:97], v[32:33] op_sel:[0,0] op_sel_hi:[0,1]
    v_pk_mul_f32 v[42:43], v[98:99], v[34:35] op_sel:[0,0] op_sel_hi:[0,1]
    v_pk_mul_f32 v[44:45], v[100:101], v[36:37] op_sel:[0,0] op_sel_hi:[0,1]
    v_pk_mul_f32 v[46:47], v[102:103], v[38:39] op_sel:[0,0] op_sel_hi:[0,1]
    v_pk_fma_f32 v[80:81], v[96:97], v[32:33], v[40:41] op_sel:[1,1,0] op_sel_hi:[1,0,1] neg_lo:[1,0,0] neg_hi:[1,0,1]
    v_pk_fma_f32 v[82:83], v[98:99], v[34:35], v[42:43] op_sel:[1,1,0] op_sel_hi:[1,0,1] neg_lo:[1,0,0] neg_hi:[1,0,1]
    v_pk_fma_f32 v[84:85], v[100:101], v[36:37], v[44:45] op_sel:[1,1,0] op_sel_hi:[1,0,1] neg_lo:[1,0,0] neg_hi:[1,0,1]
    v_pk_fma_f32 v[86:87], v[102:103], v[38:39], v[46:47] op_sel:[1,1,0] op_sel_hi:[1,0,1] neg_lo:[1,0,0] neg_hi:[1,0,1]
    v_cvt_pk_bf16_f32 v165, v72, v80
    v_cvt_pk_bf16_f32 v173, v74, v82
    v_cvt_pk_bf16_f32 v181, v76, v84
    v_cvt_pk_bf16_f32 v189, v78, v86
    v_cvt_pk_bf16_f32 v229, v73, v81
    v_cvt_pk_bf16_f32 v237, v75, v83
    v_cvt_pk_bf16_f32 v245, v77, v85
    v_cvt_pk_bf16_f32 v253, v79, v87
    v_accvgpr_read_b32 v64, a224
    v_accvgpr_read_b32 v66, a228
    v_accvgpr_read_b32 v68, a232
    v_accvgpr_read_b32 v70, a236
    v_accvgpr_read_b32 v65, a240
    v_accvgpr_read_b32 v67, a244
    v_accvgpr_read_b32 v69, a248
    v_accvgpr_read_b32 v71, a252
    v_pk_fma_f32 v[56:57], v[88:89], v[32:33], v[64:65] op_sel:[0,0,0] op_sel_hi:[0,1,1]
    v_pk_fma_f32 v[58:59], v[90:91], v[34:35], v[66:67] op_sel:[0,0,0] op_sel_hi:[0,1,1]
    v_pk_fma_f32 v[60:61], v[92:93], v[36:37], v[68:69] op_sel:[0,0,0] op_sel_hi:[0,1,1]
    v_pk_fma_f32 v[62:63], v[94:95], v[38:39], v[70:71] op_sel:[0,0,0] op_sel_hi:[0,1,1]
    v_pk_fma_f32 v[32:33], v[88:89], v[32:33], v[56:57] op_sel:[1,1,0] op_sel_hi:[1,0,1] neg_lo:[1,0,0]
    v_pk_fma_f32 v[34:35], v[90:91], v[34:35], v[58:59] op_sel:[1,1,0] op_sel_hi:[1,0,1] neg_lo:[1,0,0]
    v_pk_fma_f32 v[36:37], v[92:93], v[36:37], v[60:61] op_sel:[1,1,0] op_sel_hi:[1,0,1] neg_lo:[1,0,0]
    v_pk_fma_f32 v[38:39], v[94:95], v[38:39], v[62:63] op_sel:[1,1,0] op_sel_hi:[1,0,1] neg_lo:[1,0,0]
    v_pk_mul_f32 v[40:41], v[96:97], v[32:33] op_sel:[0,0] op_sel_hi:[0,1]
    v_pk_mul_f32 v[42:43], v[98:99], v[34:35] op_sel:[0,0] op_sel_hi:[0,1]
    v_pk_mul_f32 v[44:45], v[100:101], v[36:37] op_sel:[0,0] op_sel_hi:[0,1]
    v_pk_mul_f32 v[46:47], v[102:103], v[38:39] op_sel:[0,0] op_sel_hi:[0,1]
    v_pk_fma_f32 v[72:73], v[96:97], v[32:33], v[40:41] op_sel:[1,1,0] op_sel_hi:[1,0,1] neg_lo:[1,0,0] neg_hi:[1,0,1]
    v_pk_fma_f32 v[74:75], v[98:99], v[34:35], v[42:43] op_sel:[1,1,0] op_sel_hi:[1,0,1] neg_lo:[1,0,0] neg_hi:[1,0,1]
    v_pk_fma_f32 v[76:77], v[100:101], v[36:37], v[44:45] op_sel:[1,1,0] op_sel_hi:[1,0,1] neg_lo:[1,0,0] neg_hi:[1,0,1]
    v_pk_fma_f32 v[78:79], v[102:103], v[38:39], v[46:47] op_sel:[1,1,0] op_sel_hi:[1,0,1] neg_lo:[1,0,0] neg_hi:[1,0,1]
    v_accvgpr_read_b32 v48, a225
    v_accvgpr_read_b32 v50, a229
    v_accvgpr_read_b32 v52, a233
    v_accvgpr_read_b32 v54, a237
    v_accvgpr_read_b32 v49, a241
    v_accvgpr_read_b32 v51, a245
    v_accvgpr_read_b32 v53, a249
    v_accvgpr_read_b32 v55, a253
    v_pk_fma_f32 v[56:57], v[88:89], v[32:33], v[48:49] op_sel:[0,0,0] op_sel_hi:[0,1,1]
    v_pk_fma_f32 v[58:59], v[90:91], v[34:35], v[50:51] op_sel:[0,0,0] op_sel_hi:[0,1,1]
    v_pk_fma_f32 v[60:61], v[92:93], v[36:37], v[52:53] op_sel:[0,0,0] op_sel_hi:[0,1,1]
    v_pk_fma_f32 v[62:63], v[94:95], v[38:39], v[54:55] op_sel:[0,0,0] op_sel_hi:[0,1,1]
    v_pk_fma_f32 v[32:33], v[88:89], v[32:33], v[56:57] op_sel:[1,1,0] op_sel_hi:[1,0,1] neg_lo:[1,0,0]
    v_pk_fma_f32 v[34:35], v[90:91], v[34:35], v[58:59] op_sel:[1,1,0] op_sel_hi:[1,0,1] neg_lo:[1,0,0]
    v_pk_fma_f32 v[36:37], v[92:93], v[36:37], v[60:61] op_sel:[1,1,0] op_sel_hi:[1,0,1] neg_lo:[1,0,0]
    v_pk_fma_f32 v[38:39], v[94:95], v[38:39], v[62:63] op_sel:[1,1,0] op_sel_hi:[1,0,1] neg_lo:[1,0,0]
    v_pk_mul_f32 v[40:41], v[96:97], v[32:33] op_sel:[0,0] op_sel_hi:[0,1]
    v_pk_mul_f32 v[42:43], v[98:99], v[34:35] op_sel:[0,0] op_sel_hi:[0,1]
    v_pk_mul_f32 v[44:45], v[100:101], v[36:37] op_sel:[0,0] op_sel_hi:[0,1]
    v_pk_mul_f32 v[46:47], v[102:103], v[38:39] op_sel:[0,0] op_sel_hi:[0,1]
    v_pk_fma_f32 v[80:81], v[96:97], v[32:33], v[40:41] op_sel:[1,1,0] op_sel_hi:[1,0,1] neg_lo:[1,0,0] neg_hi:[1,0,1]
    v_pk_fma_f32 v[82:83], v[98:99], v[34:35], v[42:43] op_sel:[1,1,0] op_sel_hi:[1,0,1] neg_lo:[1,0,0] neg_hi:[1,0,1]
    v_pk_fma_f32 v[84:85], v[100:101], v[36:37], v[44:45] op_sel:[1,1,0] op_sel_hi:[1,0,1] neg_lo:[1,0,0] neg_hi:[1,0,1]
    v_pk_fma_f32 v[86:87], v[102:103], v[38:39], v[46:47] op_sel:[1,1,0] op_sel_hi:[1,0,1] neg_lo:[1,0,0] neg_hi:[1,0,1]
    v_cvt_pk_bf16_f32 v166, v72, v80
    v_cvt_pk_bf16_f32 v174, v74, v82
    v_cvt_pk_bf16_f32 v182, v76, v84
    v_cvt_pk_bf16_f32 v190, v78, v86
    v_cvt_pk_bf16_f32 v230, v73, v81
    v_cvt_pk_bf16_f32 v238, v75, v83
    v_cvt_pk_bf16_f32 v246, v77, v85
    v_cvt_pk_bf16_f32 v254, v79, v87
    v_accvgpr_read_b32 v64, a226
    v_accvgpr_read_b32 v66, a230
    v_accvgpr_read_b32 v68, a234
    v_accvgpr_read_b32 v70, a238
    v_accvgpr_read_b32 v65, a242
    v_accvgpr_read_b32 v67, a246
    v_accvgpr_read_b32 v69, a250
    v_accvgpr_read_b32 v71, a254
    v_pk_fma_f32 v[56:57], v[88:89], v[32:33], v[64:65] op_sel:[0,0,0] op_sel_hi:[0,1,1]
    v_pk_fma_f32 v[58:59], v[90:91], v[34:35], v[66:67] op_sel:[0,0,0] op_sel_hi:[0,1,1]
    v_pk_fma_f32 v[60:61], v[92:93], v[36:37], v[68:69] op_sel:[0,0,0] op_sel_hi:[0,1,1]
    v_pk_fma_f32 v[62:63], v[94:95], v[38:39], v[70:71] op_sel:[0,0,0] op_sel_hi:[0,1,1]
    v_pk_fma_f32 v[32:33], v[88:89], v[32:33], v[56:57] op_sel:[1,1,0] op_sel_hi:[1,0,1] neg_lo:[1,0,0]
    v_pk_fma_f32 v[34:35], v[90:91], v[34:35], v[58:59] op_sel:[1,1,0] op_sel_hi:[1,0,1] neg_lo:[1,0,0]
    v_pk_fma_f32 v[36:37], v[92:93], v[36:37], v[60:61] op_sel:[1,1,0] op_sel_hi:[1,0,1] neg_lo:[1,0,0]
    v_pk_fma_f32 v[38:39], v[94:95], v[38:39], v[62:63] op_sel:[1,1,0] op_sel_hi:[1,0,1] neg_lo:[1,0,0]
    v_pk_mul_f32 v[40:41], v[96:97], v[32:33] op_sel:[0,0] op_sel_hi:[0,1]
    v_pk_mul_f32 v[42:43], v[98:99], v[34:35] op_sel:[0,0] op_sel_hi:[0,1]
    v_pk_mul_f32 v[44:45], v[100:101], v[36:37] op_sel:[0,0] op_sel_hi:[0,1]
    v_pk_mul_f32 v[46:47], v[102:103], v[38:39] op_sel:[0,0] op_sel_hi:[0,1]
    v_pk_fma_f32 v[72:73], v[96:97], v[32:33], v[40:41] op_sel:[1,1,0] op_sel_hi:[1,0,1] neg_lo:[1,0,0] neg_hi:[1,0,1]
    v_pk_fma_f32 v[74:75], v[98:99], v[34:35], v[42:43] op_sel:[1,1,0] op_sel_hi:[1,0,1] neg_lo:[1,0,0] neg_hi:[1,0,1]
    v_pk_fma_f32 v[76:77], v[100:101], v[36:37], v[44:45] op_sel:[1,1,0] op_sel_hi:[1,0,1] neg_lo:[1,0,0] neg_hi:[1,0,1]
    v_pk_fma_f32 v[78:79], v[102:103], v[38:39], v[46:47] op_sel:[1,1,0] op_sel_hi:[1,0,1] neg_lo:[1,0,0] neg_hi:[1,0,1]
    v_accvgpr_read_b32 v48, a227
    v_accvgpr_read_b32 v50, a231
    v_accvgpr_read_b32 v52, a235
    v_accvgpr_read_b32 v54, a239
    v_accvgpr_read_b32 v49, a243
    v_accvgpr_read_b32 v51, a247
    v_accvgpr_read_b32 v53, a251
    v_accvgpr_read_b32 v55, a255
    v_pk_fma_f32 v[56:57], v[88:89], v[32:33], v[48:49] op_sel:[0,0,0] op_sel_hi:[0,1,1]
    v_pk_fma_f32 v[58:59], v[90:91], v[34:35], v[50:51] op_sel:[0,0,0] op_sel_hi:[0,1,1]
    v_pk_fma_f32 v[60:61], v[92:93], v[36:37], v[52:53] op_sel:[0,0,0] op_sel_hi:[0,1,1]
    v_pk_fma_f32 v[62:63], v[94:95], v[38:39], v[54:55] op_sel:[0,0,0] op_sel_hi:[0,1,1]
    v_pk_fma_f32 v[32:33], v[88:89], v[32:33], v[56:57] op_sel:[1,1,0] op_sel_hi:[1,0,1] neg_lo:[1,0,0]
    v_pk_fma_f32 v[34:35], v[90:91], v[34:35], v[58:59] op_sel:[1,1,0] op_sel_hi:[1,0,1] neg_lo:[1,0,0]
    v_pk_fma_f32 v[36:37], v[92:93], v[36:37], v[60:61] op_sel:[1,1,0] op_sel_hi:[1,0,1] neg_lo:[1,0,0]
    v_pk_fma_f32 v[38:39], v[94:95], v[38:39], v[62:63] op_sel:[1,1,0] op_sel_hi:[1,0,1] neg_lo:[1,0,0]
    v_pk_mul_f32 v[40:41], v[96:97], v[32:33] op_sel:[0,0] op_sel_hi:[0,1]
    v_pk_mul_f32 v[42:43], v[98:99], v[34:35] op_sel:[0,0] op_sel_hi:[0,1]
    v_pk_mul_f32 v[44:45], v[100:101], v[36:37] op_sel:[0,0] op_sel_hi:[0,1]
    v_pk_mul_f32 v[46:47], v[102:103], v[38:39] op_sel:[0,0] op_sel_hi:[0,1]
    v_pk_fma_f32 v[80:81], v[96:97], v[32:33], v[40:41] op_sel:[1,1,0] op_sel_hi:[1,0,1] neg_lo:[1,0,0] neg_hi:[1,0,1]
    v_pk_fma_f32 v[82:83], v[98:99], v[34:35], v[42:43] op_sel:[1,1,0] op_sel_hi:[1,0,1] neg_lo:[1,0,0] neg_hi:[1,0,1]
    v_pk_fma_f32 v[84:85], v[100:101], v[36:37], v[44:45] op_sel:[1,1,0] op_sel_hi:[1,0,1] neg_lo:[1,0,0] neg_hi:[1,0,1]
    v_pk_fma_f32 v[86:87], v[102:103], v[38:39], v[46:47] op_sel:[1,1,0] op_sel_hi:[1,0,1] neg_lo:[1,0,0] neg_hi:[1,0,1]
    v_cvt_pk_bf16_f32 v167, v72, v80
    v_cvt_pk_bf16_f32 v175, v74, v82
    v_cvt_pk_bf16_f32 v183, v76, v84
    v_cvt_pk_bf16_f32 v191, v78, v86
    v_cvt_pk_bf16_f32 v231, v73, v81
    v_cvt_pk_bf16_f32 v239, v75, v83
    v_cvt_pk_bf16_f32 v247, v77, v85
    v_cvt_pk_bf16_f32 v255, v79, v87
    s_lshl_b32 s61, s85, 13
    s_andn2_b32 s61, 0x2000, s61
    s_xor_b32 s61, s61, s59
    s_lshl_b32 s50, s85, 21
    s_add_u32 s50, s50, s61
    s_lshr_b32 s60, s82, 2
    s_lshl_b32 s60, s60, 20
    s_add_u32 s50, s50, s60
    s_lshl_b32 s29, s29, 7
    s_and_b32 s29, s29, 0x7ffff
    s_add_u32 s50, s50, s29
    s_and_b32 s60, s58, 1
    s_lshl_b32 s60, s60, 12
    s_add_u32 s50, s50, s60
    s_add_u32 s50, s50, 0xa000000
    s_mov_b32 s5, 16384
    s_mov_b32 s51, 2048
    s_mov_b32 s52, 0x80000
    v_bfe_u32 v2, v0, 4, 1
    v_lshlrev_b32 v2, 6, v2
    v_xor_b32 v2, v2, v1
    v_add_u32 v3, 1024, v2
    s_setpc_b64 s[54:55]
.section .rodata,"a"
.p2align 6
.amdhsa_kernel chain_kernel
  .amdhsa_next_free_vgpr 512
  .amdhsa_next_free_sgpr 102
  .amdhsa_accum_offset 256
  .amdhsa_group_segment_fixed_size 0
  .amdhsa_kernarg_size 152
  .amdhsa_user_sgpr_count 2
  .amdhsa_user_sgpr_kernarg_segment_ptr 1
  .amdhsa_system_sgpr_workgroup_id_x 1
  .amdhsa_float_denorm_mode_32 3
  .amdhsa_float_denorm_mode_16_64 3
.end_amdhsa_kernel
```

```asm
; @launch kernel=chain_kernel grid=(256,1,1) block=(256,1,1) lds=163840
.amdgcn_target "amdgcn-amd-amdhsa--gfx950"
.text
.globl chain_kernel
.p2align 8
.type chain_kernel,@function
chain_kernel:
    s_cmp_ge_u32 s2, 256
    s_cbranch_scc1 chain_kernel_end
    s_load_dwordx4 s[96:99], s[0:1], 128
    s_load_dwordx2 s[100:101], s[0:1], 144
    s_load_dwordx16 s[64:79], s[0:1], 0
    s_load_dwordx16 s[80:95], s[0:1], 64
    s_getpc_b64 s[8:9]
code_base:
    s_and_b32 s9, s9, 0xffff
    s_mov_b32 s10, code_end - code_base
    s_mov_b32 s11, 0x00020000
    s_bfe_u32 s12, s2, 0x20003
    s_lshl_b32 s12, s12, 15
    v_lshlrev_b32 v1, 7, v0
    buffer_load_dword v255, v1, s[8:11], s12 offen
    s_getreg_b32 s16, hwreg(HW_REG_XCC_ID)
    s_and_b32 s16, s16, 7
    v_lshrrev_b32 v1, 6, v0
    s_nop 0
    v_readfirstlane_b32 s18, v1
    s_waitcnt lgkmcnt(0)
    s_lshr_b32 s17, s2, 3
    s_mov_b32 s2, 0
    s_cmp_lg_u32 s18, 0
    s_cbranch_scc1 L_role_1
    s_lshl_b32 s12, s16, 8
    s_add_u32 s12, s12, 0xd200000
    v_lshl_add_u32 v1, v0, 2, s12
    v_mov_b32 v2, 0
    global_store_dword v1, v2, s[100:101]
    s_lshl_b32 s12, s16, 3
    s_add_u32 s12, s12, 128
    s_lshl_b32 s94, 1, s17
    s_mov_b32 s95, 0x100
    s_waitcnt vmcnt(0)
    s_atomic_add_x2 s[94:95], s[98:99], s12 glc
L_role_1:
    s_cmp_ge_u32 s16, 4
    s_cbranch_scc1 chain_kernel_worker
chain_start:
    s_mov_b32 s8, s100
    s_and_b32 s9, s101, 0xffff
    s_mov_b32 s10, 0x10000000
    s_mov_b32 s11, 0x00020000
    s_mov_b32 s33, 0
    s_xor_b32 s29, s17, 8
    s_and_b32 s28, s17, 1
    s_bfe_u32 s20, s17, 0x10001
    s_xor_b32 s20, s20, 1
    s_lshl1_add_u32 s28, s28, s20
    s_lshl_b32 s20, s16, 10
    s_lshr_b32 s21, s17, 2
    s_lshl_b32 s21, s21, 7
    s_add_u32 s20, s20, s21
    v_bfe_u32 v160, v0, 5, 1
    v_lshlrev_b32 v162, 1, v160
    v_bfe_u32 v160, v0, 3, 1
    v_add_u32 v162, v162, v160
    v_bfe_u32 v160, v0, 4, 1
    v_lshl_add_u32 v162, v160, 3, v162
    v_lshrrev_b32 v160, 6, v0
    v_lshl_add_u32 v162, v160, 8, v162
    v_and_b32 v161, 7, v0
    v_lshlrev_b32 v163, 13, v162
    v_lshl_add_u32 v163, v161, 4, v163
    s_and_b32 s21, s28, 1
    s_lshl_b32 s21, s21, 6
    s_add_u32 s21, s21, s20
    s_lshl_b32 s21, s21, 1
    v_add_u32 v163, s21, v163
    v_add_u32 v164, 0x8000, v163
    v_bfe_u32 v160, v0, 4, 2
    v_lshlrev_b32 v162, 1, v160
    v_bfe_u32 v160, v0, 2, 1
    v_add_u32 v162, v162, v160
    v_bfe_u32 v160, v0, 3, 1
    v_lshl_add_u32 v162, v160, 3, v162
    v_lshrrev_b32 v160, 6, v0
    v_lshl_add_u32 v162, v160, 8, v162
    v_and_b32 v161, 3, v0
    v_lshlrev_b32 v165, 13, v162
    v_lshl_add_u32 v165, v161, 4, v165
    s_and_b32 s21, s17, 3
    s_lshl_b32 s21, s21, 5
    s_add_u32 s21, s21, s20
    s_lshl_b32 s21, s21, 1
    v_add_u32 v165, s21, v165
    v_bfe_u32 v166, v0, 2, 1
    v_bfe_u32 v160, v0, 4, 1
    v_lshl_add_u32 v166, v160, 1, v166
    v_bfe_u32 v160, v0, 3, 1
    v_lshl_add_u32 v166, v160, 2, v166
    v_bfe_u32 v160, v0, 5, 1
    v_lshl_add_u32 v166, v160, 4, v166
    v_lshrrev_b32 v160, 6, v0
    v_lshl_add_u32 v166, v160, 8, v166
    s_lshl_b32 s21, s16, 10
    v_add_u32 v166, s21, v166
    v_lshlrev_b32 v166, 11, v166
    v_lshl_add_u32 v166, v161, 4, v166
    s_lshl_b32 s21, s29, 6
    v_add_u32 v166, s21, v166
    s_lshl_b32 s80, s18, 15
    s_add_u32 s80, s80, 32768
    s_bitcmp1_b32 s28, 1
    s_cselect_b32 s12, s88, s86
    s_cselect_b32 s13, s89, s87
    s_and_b32 s13, s13, 0xffff
    s_mov_b32 s14, 0x800000
    s_mov_b32 s15, 0x00020000
    s_mov_b32 s4, s90
    s_and_b32 s5, s91, 0xffff
    s_mov_b32 s6, 0x800000
    s_mov_b32 s7, 0x00020000
    s_mov_b32 s40, s92
    s_and_b32 s41, s93, 0xffff
    s_mov_b32 s42, 0x800000
    s_mov_b32 s43, 0x00020000
    s_add_u32 m0, s80, 0
    s_mov_b32 s81, 0
    buffer_load_dwordx4 v163, s[12:15], s81 offen nt lds
    s_add_u32 m0, s80, 1024
    s_mov_b32 s81, 0
    buffer_load_dwordx4 v164, s[12:15], s81 offen nt lds
    s_add_u32 m0, s80, 2048
    s_mov_b32 s81, 131072
    buffer_load_dwordx4 v163, s[12:15], s81 offen nt lds
    s_add_u32 m0, s80, 3072
    s_mov_b32 s81, 131072
    buffer_load_dwordx4 v164, s[12:15], s81 offen nt lds
    s_mov_b32 s81, 0
    buffer_load_dwordx4 v[32:35], v165, s[4:7], s81 offen nt
    s_mov_b32 s81, 0
    buffer_load_dwordx4 v[96:99], v166, s[40:43], s81 offen nt
    s_mov_b32 s81, 131072
    buffer_load_dwordx4 v[36:39], v165, s[4:7], s81 offen nt
    s_mov_b32 s81, 16384
    buffer_load_dwordx4 v[100:103], v166, s[40:43], s81 offen nt
    s_mov_b32 s24, 0x00ff00ff
    s_mov_b32 s25, 0x00ff00ff
    s_mov_b32 s26, 0x55555555
    s_mov_b32 s27, 0x55555555
    s_mov_b32 s56, 0x3fb8aa3b
    s_mov_b32 s57, 0x3fb8aa3b
    s_mov_b32 s58, 0x3db504f3
    s_mov_b32 s59, 0x3db504f3
    s_lshl_b32 s53, s16, 16
    s_add_u32 s53, s53, 0xd000000
    s_lshl_b32 s47, s16, 5
    s_add_u32 s47, s47, s17
    s_mov_b64 s[60:61], s[98:99]
    v_mov_b32 v28, -1
    v_mov_b32 v29, -1
    v_mov_b32 v30, -1
    v_mov_b32 v31, -1
    v_and_b32 v210, 63, v0
    v_and_b32 v208, 15, v0
    v_bfe_u32 v209, v0, 4, 2
    v_lshlrev_b32 v1, 4, v210
    v_lshlrev_b32 v26, 3, v210
    s_lshl_b32 s21, s18, 12
    v_add_u32 v2, s21, v1
    s_xor_b32 s22, s18, 3
    s_lshl_b32 s22, s22, 4
    v_xor_b32 v3, s22, v2
    v_add_u32 v3, 16384, v3
    s_and_b32 s22, s22, 16
    s_lshl_b32 s22, s22, 1
    v_xor_b32 v2, s22, v2
    v_mov_b32 v19, 0xeeeeeeee
    v_mov_b32 v212, 0x44444444
    v_cndmask_b32 v19, v19, v212, s[24:25]
    v_mov_b32 v18, 0x03020706
    v_mov_b32 v212, 0x05040100
    v_cndmask_b32 v18, v18, v212, s[26:27]
    s_lshr_b32 s21, s17, 2
    s_lshl_b32 s21, s21, 12
    s_add_u32 s21, s21, 32768
    v_add_u32 v5, s21, v1
    s_and_b32 s22, s28, 1
    s_lshl_b32 s22, s22, 11
    s_add_u32 s21, s21, s22
    s_bfe_u32 s22, s28, 0x10001
    s_lshl_b32 s22, s22, 7
    s_add_u32 s23, s21, s22
    s_add_u32 m0, s80, 4096
    s_mov_b32 s81, 262144
    buffer_load_dwordx4 v163, s[12:15], s81 offen nt lds
    s_add_u32 m0, s80, 5120
    s_mov_b32 s81, 262144
    buffer_load_dwordx4 v164, s[12:15], s81 offen nt lds
    s_add_u32 m0, s80, 6144
    s_mov_b32 s81, 393216
    buffer_load_dwordx4 v163, s[12:15], s81 offen nt lds
    s_add_u32 m0, s80, 7168
    s_mov_b32 s81, 393216
    buffer_load_dwordx4 v164, s[12:15], s81 offen nt lds
    s_mov_b32 s81, 262144
    buffer_load_dwordx4 v[40:43], v165, s[4:7], s81 offen nt
    s_mov_b32 s81, 65536
    buffer_load_dwordx4 v[104:107], v166, s[40:43], s81 offen nt
    s_mov_b32 s81, 393216
    buffer_load_dwordx4 v[44:47], v165, s[4:7], s81 offen nt
    s_mov_b32 s81, 81920
    buffer_load_dwordx4 v[108:111], v166, s[40:43], s81 offen nt
    v_and_b32 v212, 1, v209
    v_lshlrev_b32 v234, 6, v212
    v_and_b32 v212, 1, v208
    v_lshl_add_u32 v234, v212, 4, v234
    v_bfe_u32 v212, v208, 1, 2
    v_lshl_add_u32 v234, v212, 2, v234
    s_and_b32 s22, s18, 1
    s_lshl_b32 s22, s22, 5
    v_add_u32 v234, s22, v234
    v_lshrrev_b32 v212, 3, v208
    v_and_b32 v213, 2, v209
    v_add_u32 v212, v212, v213
    s_and_b32 s22, s18, 2
    s_lshl_b32 s22, s22, 1
    v_add_u32 v212, s22, v212
    v_lshl_add_u32 v4, v212, 8, v234
    v_lshl_add_u32 v234, v212, 7, v234
    v_add_u32 v4, s23, v4
    v_lshrrev_b32 v212, 3, v210
    v_and_b32 v213, 7, v210
    v_lshlrev_b32 v22, 8, v212
    v_lshl_add_u32 v22, v213, 4, v22
    v_add_u32 v22, s23, v22
    s_lshr_b32 s20, s47, 2
    s_or_b32 s76, s16, s18
    s_or_b32 s76, s76, s2
    s_cbranch_scc1 L_cal_2
    s_waitcnt lgkmcnt(0)
    s_lshr_b32 s74, s95, 8
    s_cmp_ge_u32 s74, 15
    s_cbranch_scc1 L_cal_2
    s_lshl_b32 s76, s74, 14
    s_add_u32 s76, s76, 0xd400000
    s_add_u32 s64, s100, s76
    s_addc_u32 s65, s101, 0
    s_mov_b32 s76, 0
    s_atomic_or s76, s[64:65], 0
    s_atomic_or s76, s[64:65], 0x2000
    s_waitcnt lgkmcnt(0)
    s_mov_b32 s77, -1
    s_mov_b32 s78, -1
    s_memtime s[66:67]
    s_atomic_or s76, s[64:65], 0
    s_waitcnt lgkmcnt(0)
    s_memtime s[68:69]
    s_atomic_or s76, s[64:65], 0x2000
    s_waitcnt lgkmcnt(0)
    s_sub_u32 s79, s68, s66
    s_memtime s[66:67]
    s_min_u32 s77, s77, s79
    s_waitcnt lgkmcnt(0)
    s_sub_u32 s79, s66, s68
    s_min_u32 s78, s78, s79
    s_memtime s[66:67]
    s_atomic_or s76, s[64:65], 0
    s_waitcnt lgkmcnt(0)
    s_memtime s[68:69]
    s_atomic_or s76, s[64:65], 0x2000
    s_waitcnt lgkmcnt(0)
    s_sub_u32 s79, s68, s66
    s_memtime s[66:67]
    s_min_u32 s77, s77, s79
    s_waitcnt lgkmcnt(0)
    s_sub_u32 s79, s66, s68
    s_min_u32 s78, s78, s79
    s_memtime s[66:67]
    s_atomic_or s76, s[64:65], 0
    s_waitcnt lgkmcnt(0)
    s_memtime s[68:69]
    s_atomic_or s76, s[64:65], 0x2000
    s_waitcnt lgkmcnt(0)
    s_sub_u32 s79, s68, s66
    s_memtime s[66:67]
    s_min_u32 s77, s77, s79
    s_waitcnt lgkmcnt(0)
    s_sub_u32 s79, s66, s68
    s_min_u32 s78, s78, s79
    s_memtime s[66:67]
    s_atomic_or s76, s[64:65], 0
    s_waitcnt lgkmcnt(0)
    s_memtime s[68:69]
    s_atomic_or s76, s[64:65], 0x2000
    s_waitcnt lgkmcnt(0)
    s_sub_u32 s79, s68, s66
    s_memtime s[66:67]
    s_min_u32 s77, s77, s79
    s_waitcnt lgkmcnt(0)
    s_sub_u32 s79, s66, s68
    s_min_u32 s78, s78, s79
    s_cmp_lt_u32 s78, s77
    s_cselect_b32 s76, 0x101, 1
    s_atomic_add s76, s[98:99], 4
    s_waitcnt lgkmcnt(0)
L_cal_2:
    s_add_u32 m0, s80, 8192
    s_mov_b32 s81, 524288
    buffer_load_dwordx4 v163, s[12:15], s81 offen nt lds
    s_add_u32 m0, s80, 9216
    s_mov_b32 s81, 524288
    buffer_load_dwordx4 v164, s[12:15], s81 offen nt lds
    s_add_u32 m0, s80, 10240
    s_mov_b32 s81, 655360
    buffer_load_dwordx4 v163, s[12:15], s81 offen nt lds
    s_add_u32 m0, s80, 11264
    s_mov_b32 s81, 655360
    buffer_load_dwordx4 v164, s[12:15], s81 offen nt lds
    s_mov_b32 s81, 524288
    buffer_load_dwordx4 v[48:51], v165, s[4:7], s81 offen nt
    s_mov_b32 s81, 131072
    buffer_load_dwordx4 v[112:115], v166, s[40:43], s81 offen nt
    s_mov_b32 s81, 655360
    buffer_load_dwordx4 v[52:55], v165, s[4:7], s81 offen nt
    s_mov_b32 s81, 147456
    buffer_load_dwordx4 v[116:119], v166, s[40:43], s81 offen nt
    s_lshl_b32 s48, s20, 16
    s_and_b32 s21, s17, 3
    s_lshl_b32 s22, s21, 11
    s_add_u32 s22, s22, 0x4000
    v_add_u32 v237, s22, v1
    v_lshlrev_b32 v236, 7, v208
    v_and_b32 v212, 1, v209
    v_lshl_add_u32 v236, v212, 15, v236
    s_lshl_b32 s22, s21, 11
    v_add_u32 v236, s22, v236
    v_mov_b32 v25, v236
    s_cmp_lt_u32 s18, 2
    s_cselect_b32 s38, 0xf0000000, 0
    s_cmp_lg_u32 s18, 1
    s_cselect_b32 s39, 0xf0000000, 0
    s_lshr_b32 s22, s18, 1
    s_mul_i32 s54, s22, 10240
    s_lshl_b32 s22, s22, 15
    s_and_b32 s23, s18, 1
    s_lshl_b32 s23, s23, 12
    s_add_u32 s54, s54, s23
    s_add_u32 s54, s54, 32768
    s_add_u32 s22, s22, s23
    v_add_u32 v235, s22, v1
    s_add_u32 m0, s80, 12288
    s_mov_b32 s81, 786432
    buffer_load_dwordx4 v163, s[12:15], s81 offen nt lds
    s_add_u32 m0, s80, 13312
    s_mov_b32 s81, 786432
    buffer_load_dwordx4 v164, s[12:15], s81 offen nt lds
    s_add_u32 m0, s80, 14336
    s_mov_b32 s81, 917504
    buffer_load_dwordx4 v163, s[12:15], s81 offen nt lds
    s_add_u32 m0, s80, 15360
    s_mov_b32 s81, 917504
    buffer_load_dwordx4 v164, s[12:15], s81 offen nt lds
    s_mov_b32 s81, 786432
    buffer_load_dwordx4 v[56:59], v165, s[4:7], s81 offen nt
    s_mov_b32 s81, 196608
    buffer_load_dwordx4 v[120:123], v166, s[40:43], s81 offen nt
    s_mov_b32 s81, 917504
    buffer_load_dwordx4 v[60:63], v165, s[4:7], s81 offen nt
    s_mov_b32 s81, 212992
    buffer_load_dwordx4 v[124:127], v166, s[40:43], s81 offen nt
    s_lshl_b32 s51, s18, 11
    v_add_u32 v243, s51, v1
    v_add_u32 v244, 0x8000, v243
    v_lshrrev_b32 v212, 3, v210
    v_lshl_add_u32 v24, v212, 7, v5
    v_add_u32 v24, 128, v24
    s_and_b32 s22, s18, 1
    s_lshl_b32 s22, s22, 12
    v_add_u32 v242, s22, v1
    s_lshl_b32 s21, s21, 10
    s_add_u32 s21, s21, 0xc000
    v_add_u32 v23, s21, v242
    v_lshlrev_b32 v241, 7, v209
    v_bfe_u32 v212, v0, 2, 1
    v_lshl_add_u32 v241, v212, 6, v241
    v_bfe_u32 v212, v0, 3, 1
    v_lshl_add_u32 v241, v212, 5, v241
    v_bfe_u32 v212, v0, 0, 1
    v_lshl_add_u32 v241, v212, 4, v241
    v_and_b32 v212, 7, v208
    v_lshlrev_b32 v6, 4, v212
    v_lshl_add_u32 v6, v209, 7, v6
    s_lshl_b32 s21, s17, 9
    s_add_u32 s22, s21, 16384
    s_add_u32 m0, s80, 16384
    s_mov_b32 s81, 1048576
    buffer_load_dwordx4 v163, s[12:15], s81 offen nt lds
    s_add_u32 m0, s80, 17408
    s_mov_b32 s81, 1048576
    buffer_load_dwordx4 v164, s[12:15], s81 offen nt lds
    s_add_u32 m0, s80, 18432
    s_mov_b32 s81, 1179648
    buffer_load_dwordx4 v163, s[12:15], s81 offen nt lds
    s_add_u32 m0, s80, 19456
    s_mov_b32 s81, 1179648
    buffer_load_dwordx4 v164, s[12:15], s81 offen nt lds
    s_mov_b32 s81, 1048576
    buffer_load_dwordx4 v[64:67], v165, s[4:7], s81 offen nt
    s_mov_b32 s81, 262144
    buffer_load_dwordx4 v[128:131], v166, s[40:43], s81 offen nt
    s_mov_b32 s81, 1179648
    buffer_load_dwordx4 v[68:71], v165, s[4:7], s81 offen nt
    s_mov_b32 s81, 278528
    buffer_load_dwordx4 v[132:135], v166, s[40:43], s81 offen nt
    v_add_u32 v6, s22, v6
    v_lshrrev_b32 v212, 3, v208
    v_and_b32 v213, 2, v209
    v_add_u32 v212, v212, v213
    v_lshlrev_b32 v7, 7, v212
    v_and_b32 v212, 1, v209
    v_lshl_add_u32 v7, v212, 6, v7
    v_bfe_u32 v212, v208, 1, 2
    v_lshl_add_u32 v7, v212, 2, v7
    s_lshl_b32 s21, s29, 9
    s_lshl_b32 s22, s18, 4
    s_add_u32 s21, s21, s22
    v_add_u32 v7, s21, v7
    v_bfe_u32 v212, v210, 1, 3
    v_and_b32 v213, 1, v210
    v_lshlrev_b32 v27, 11, v212
    v_lshl_add_u32 v27, v213, 3, v27
    v_lshl_add_u32 v27, v209, 4, v27
    s_lshl_b32 s21, s29, 6
    v_add_u32 v27, s21, v27
    v_lshlrev_b32 v212, 2, v210
    s_xor_b32 s21, s18, 3
    s_mul_i32 s21, s21, 768
    s_add_u32 s21, s21, 0
    s_add_u32 m0, s80, 20480
    s_mov_b32 s81, 1310720
    buffer_load_dwordx4 v163, s[12:15], s81 offen nt lds
    s_add_u32 m0, s80, 21504
    s_mov_b32 s81, 1310720
    buffer_load_dwordx4 v164, s[12:15], s81 offen nt lds
    s_add_u32 m0, s80, 22528
    s_mov_b32 s81, 1441792
    buffer_load_dwordx4 v163, s[12:15], s81 offen nt lds
    s_add_u32 m0, s80, 23552
    s_mov_b32 s81, 1441792
    buffer_load_dwordx4 v164, s[12:15], s81 offen nt lds
    s_mov_b32 s81, 1310720
    buffer_load_dwordx4 v[72:75], v165, s[4:7], s81 offen nt
    s_mov_b32 s81, 327680
    buffer_load_dwordx4 v[136:139], v166, s[40:43], s81 offen nt
    s_mov_b32 s81, 1441792
    buffer_load_dwordx4 v[76:79], v165, s[4:7], s81 offen nt
    s_mov_b32 s81, 344064
    buffer_load_dwordx4 v[140:143], v166, s[40:43], s81 offen nt
    v_add_u32 v238, s21, v212
    v_lshlrev_b32 v12, 1, v238
    s_xor_b32 s21, s18, 2
    s_mul_i32 s21, s21, 768
    s_add_u32 s21, s21, 256
    v_add_u32 v239, s21, v212
    v_lshlrev_b32 v13, 1, v239
    s_xor_b32 s21, s18, 1
    s_mul_i32 s21, s21, 768
    s_add_u32 s21, s21, 512
    v_add_u32 v240, s21, v212
    v_lshlrev_b32 v14, 1, v240
    s_mul_i32 s21, s18, 768
    v_add_u32 v17, s21, v212
    v_lshlrev_b32 v15, 1, v17
    s_lshl_b32 s21, s18, 10
    v_add_u32 v16, s21, v1
    global_load_dwordx2 v[246:247], v27, s[84:85]
    v_and_b32 v208, 15, v0
    v_bfe_u32 v209, v0, 6, 1
    v_lshl_add_u32 v208, v209, 4, v208
    v_bfe_u32 v209, v0, 4, 2
    v_lshlrev_b32 v209, 2, v209
    v_sub_u32 v208, v208, v209
    s_or_b32 s76, s2, s18
    s_cbranch_scc1 L_rw_3
    s_lshl_b32 s78, s16, 3
    s_add_u32 s78, s78, 128
    s_mov_b32 s79, 0
L_rp_4:
    s_load_dwordx2 s[76:77], s[98:99], s78 glc
    s_add_u32 s79, s79, 1
    s_cmp_gt_u32 s79, 0x100000
    s_cbranch_scc1 chain_kernel_abort
    s_waitcnt lgkmcnt(0)
    s_cmp_lt_u32 s77, 0x2000
    s_cbranch_scc1 L_rp_4
    s_lshr_b32 s77, s95, 8
    s_cmp_eq_u32 s76, -1
    s_cselect_b32 s94, -1, s77
L_rw_3:
    s_waitcnt vmcnt(44)
    s_add_u32 m0, s80, 24576
    s_mov_b32 s81, 1572864
    buffer_load_dwordx4 v163, s[12:15], s81 offen nt lds
    s_add_u32 m0, s80, 25600
    s_mov_b32 s81, 1572864
    buffer_load_dwordx4 v164, s[12:15], s81 offen nt lds
    s_add_u32 m0, s80, 26624
    s_mov_b32 s81, 1703936
    buffer_load_dwordx4 v163, s[12:15], s81 offen nt lds
    s_add_u32 m0, s80, 27648
    s_mov_b32 s81, 1703936
    buffer_load_dwordx4 v164, s[12:15], s81 offen nt lds
    s_mov_b32 s81, 1572864
    buffer_load_dwordx4 v[80:83], v165, s[4:7], s81 offen nt
    s_mov_b32 s81, 393216
    buffer_load_dwordx4 v[144:147], v166, s[40:43], s81 offen nt
    s_mov_b32 s81, 1703936
    buffer_load_dwordx4 v[84:87], v165, s[4:7], s81 offen nt
    s_mov_b32 s81, 409600
    buffer_load_dwordx4 v[148:151], v166, s[40:43], s81 offen nt
    v_mov_b32 v209, 0xff800000
    v_cmp_gt_i32 vcc, 0, v208
    s_nop 1
    v_cndmask_b32 v226, 0, v209, vcc
    v_cmp_gt_i32 vcc, 1, v208
    s_nop 1
    v_cndmask_b32 v227, 0, v209, vcc
    v_cmp_gt_i32 vcc, 2, v208
    s_nop 1
    v_cndmask_b32 v228, 0, v209, vcc
    v_cmp_gt_i32 vcc, 3, v208
    s_nop 1
    v_cndmask_b32 v229, 0, v209, vcc
    v_cmp_gt_i32 vcc, 16, v208
    s_nop 1
    v_cndmask_b32 v230, 0, v209, vcc
    v_cmp_gt_i32 vcc, 17, v208
    s_nop 1
    v_cndmask_b32 v231, 0, v209, vcc
    v_cmp_gt_i32 vcc, 18, v208
    s_nop 1
    v_cndmask_b32 v232, 0, v209, vcc
    v_cmp_gt_i32 vcc, 19, v208
    s_nop 1
    v_cndmask_b32 v233, 0, v209, vcc
    s_waitcnt vmcnt(44)
    s_add_u32 m0, s80, 28672
    s_mov_b32 s81, 1835008
    buffer_load_dwordx4 v163, s[12:15], s81 offen nt lds
    s_add_u32 m0, s80, 29696
    s_mov_b32 s81, 1835008
    buffer_load_dwordx4 v164, s[12:15], s81 offen nt lds
    s_add_u32 m0, s80, 30720
    s_mov_b32 s81, 1966080
    buffer_load_dwordx4 v163, s[12:15], s81 offen nt lds
    s_add_u32 m0, s80, 31744
    s_mov_b32 s81, 1966080
    buffer_load_dwordx4 v164, s[12:15], s81 offen nt lds
    s_mov_b32 s81, 1835008
    buffer_load_dwordx4 v[88:91], v165, s[4:7], s81 offen nt
    s_mov_b32 s81, 458752
    buffer_load_dwordx4 v[152:155], v166, s[40:43], s81 offen nt
    s_mov_b32 s81, 1966080
    buffer_load_dwordx4 v[92:95], v165, s[4:7], s81 offen nt
    s_mov_b32 s81, 475136
    buffer_load_dwordx4 v[156:159], v166, s[40:43], s81 offen nt
    s_cmp_lg_u32 s2, 0
    s_cbranch_scc1 L_rok_5
    v_mov_b32 v208, 31744
    s_cmp_lg_u32 s18, 0
    s_cbranch_scc1 L_rw_6
    v_mov_b32 v209, s94
    ds_write_b32 v208, v209
    s_waitcnt lgkmcnt(0)
L_rw_6:
    s_barrier
    ds_read_b32 v209, v208
    s_waitcnt lgkmcnt(0)
    v_readfirstlane_b32 s20, v209
    s_mov_b32 s2, 1
    s_cmp_eq_u32 s20, -1
    s_cbranch_scc1 L_rok_5
    s_mov_b32 s17, s20
    s_waitcnt vmcnt(0)
    s_barrier
    s_cmp_ge_u32 s17, 32
    s_cbranch_scc1 chain_kernel_end
    s_branch chain_start
L_rok_5:
    s_lshl_b32 s42, s18, 18
    s_add_u32 s42, s42, s53
    buffer_store_dwordx4 v[28:31], v22, s[8:11], s42 offen
    s_lshl_b32 s21, s29, 9
    s_add_u32 s21, s21, s42
    buffer_store_dwordx2 v[28:29], v26, s[8:11], s21 offen
    s_xor_b32 s21, s21, 20480
    buffer_store_dwordx2 v[28:29], v26, s[8:11], s21 offen
    s_lshl_b32 s62, s16, 8
    s_add_u32 s62, s62, 0xd200000
    s_cmp_eq_u32 s17, 1
    s_cselect_b32 s21, s62, 0x10000000
    v_mov_b32 v248, 0
    s_add_u32 s21, s21, 4096
    buffer_store_dword v248, v248, s[8:11], s21 offen sc1
    v_mov_b32 v249, 4
    global_load_dword v249, v249, s[60:61] sc1
    v_bfe_u32 v160, v0, 4, 2
    v_lshlrev_b32 v160, 3, v160
    v_bfe_u32 v162, v0, 2, 2
    v_add_u32 v160, v160, v162
    v_and_b32 v161, 3, v0
    v_bfe_u32 v163, v0, 3, 1
    v_lshlrev_b32 v162, 7, v160
    v_and_b32 v164, 1, v0
    v_lshl_add_u32 v162, v164, 5, v162
    v_bfe_u32 v164, v0, 1, 1
    v_lshl_add_u32 v162, v164, 3, v162
    v_lshl_add_u32 v162, v163, 4, v162
    s_lshr_b32 s21, s18, 1
    s_xor_b32 s21, s21, 1
    s_lshl_b32 s21, s21, 6
    s_add_u32 s21, s21, s80
    v_add_u32 v167, s21, v162
    v_xor_b32 v168, 256, v167
    s_lshr_b32 s21, s18, 1
    s_xor_b32 s21, s21, 0
    s_lshl_b32 s21, s21, 6
    s_add_u32 s21, s21, s80
    v_add_u32 v169, s21, v162
    v_xor_b32 v170, 256, v169
    s_waitcnt vmcnt(44)
    ds_read_b64_tr_b16 a[0:1], v167 offset:0
    ds_read_b64_tr_b16 a[2:3], v167 offset:512
    ds_read_b64_tr_b16 a[4:5], v167 offset:4096
    ds_read_b64_tr_b16 a[6:7], v167 offset:4608
    ds_read_b64_tr_b16 a[32:33], v168 offset:0
    ds_read_b64_tr_b16 a[34:35], v168 offset:512
    ds_read_b64_tr_b16 a[36:37], v168 offset:4096
    ds_read_b64_tr_b16 a[38:39], v168 offset:4608
    s_waitcnt lgkmcnt(0)
    ds_read_b64_tr_b16 a[64:65], v169 offset:0
    ds_read_b64_tr_b16 a[66:67], v169 offset:512
    ds_read_b64_tr_b16 a[68:69], v169 offset:4096
    ds_read_b64_tr_b16 a[70:71], v169 offset:4608
    ds_read_b64_tr_b16 a[96:97], v170 offset:0
    ds_read_b64_tr_b16 a[98:99], v170 offset:512
    ds_read_b64_tr_b16 a[100:101], v170 offset:4096
    ds_read_b64_tr_b16 a[102:103], v170 offset:4608
    s_waitcnt lgkmcnt(0)
    s_waitcnt vmcnt(41)
    ds_read_b64_tr_b16 a[8:9], v167 offset:8192
    ds_read_b64_tr_b16 a[10:11], v167 offset:8704
    ds_read_b64_tr_b16 a[12:13], v167 offset:12288
    ds_read_b64_tr_b16 a[14:15], v167 offset:12800
    ds_read_b64_tr_b16 a[40:41], v168 offset:8192
    ds_read_b64_tr_b16 a[42:43], v168 offset:8704
    ds_read_b64_tr_b16 a[44:45], v168 offset:12288
    ds_read_b64_tr_b16 a[46:47], v168 offset:12800
    s_waitcnt lgkmcnt(0)
    ds_read_b64_tr_b16 a[72:73], v169 offset:8192
    ds_read_b64_tr_b16 a[74:75], v169 offset:8704
    ds_read_b64_tr_b16 a[76:77], v169 offset:12288
    ds_read_b64_tr_b16 a[78:79], v169 offset:12800
    ds_read_b64_tr_b16 a[104:105], v170 offset:8192
    ds_read_b64_tr_b16 a[106:107], v170 offset:8704
    ds_read_b64_tr_b16 a[108:109], v170 offset:12288
    ds_read_b64_tr_b16 a[110:111], v170 offset:12800
    s_waitcnt lgkmcnt(0)
    s_waitcnt vmcnt(25)
    ds_read_b64_tr_b16 a[16:17], v167 offset:16384
    ds_read_b64_tr_b16 a[18:19], v167 offset:16896
    ds_read_b64_tr_b16 a[20:21], v167 offset:20480
    ds_read_b64_tr_b16 a[22:23], v167 offset:20992
    ds_read_b64_tr_b16 a[48:49], v168 offset:16384
    ds_read_b64_tr_b16 a[50:51], v168 offset:16896
    ds_read_b64_tr_b16 a[52:53], v168 offset:20480
    ds_read_b64_tr_b16 a[54:55], v168 offset:20992
    s_waitcnt lgkmcnt(0)
    ds_read_b64_tr_b16 a[80:81], v169 offset:16384
    ds_read_b64_tr_b16 a[82:83], v169 offset:16896
    ds_read_b64_tr_b16 a[84:85], v169 offset:20480
    ds_read_b64_tr_b16 a[86:87], v169 offset:20992
    ds_read_b64_tr_b16 a[112:113], v170 offset:16384
    ds_read_b64_tr_b16 a[114:115], v170 offset:16896
    ds_read_b64_tr_b16 a[116:117], v170 offset:20480
    ds_read_b64_tr_b16 a[118:119], v170 offset:20992
    s_waitcnt lgkmcnt(0)
    s_waitcnt vmcnt(9)
    ds_read_b64_tr_b16 a[24:25], v167 offset:24576
    ds_read_b64_tr_b16 a[26:27], v167 offset:25088
    ds_read_b64_tr_b16 a[28:29], v167 offset:28672
    ds_read_b64_tr_b16 a[30:31], v167 offset:29184
    ds_read_b64_tr_b16 a[56:57], v168 offset:24576
    ds_read_b64_tr_b16 a[58:59], v168 offset:25088
    ds_read_b64_tr_b16 a[60:61], v168 offset:28672
    ds_read_b64_tr_b16 a[62:63], v168 offset:29184
    s_waitcnt lgkmcnt(0)
    ds_read_b64_tr_b16 a[88:89], v169 offset:24576
    ds_read_b64_tr_b16 a[90:91], v169 offset:25088
    ds_read_b64_tr_b16 a[92:93], v169 offset:28672
    ds_read_b64_tr_b16 a[94:95], v169 offset:29184
    ds_read_b64_tr_b16 a[120:121], v170 offset:24576
    ds_read_b64_tr_b16 a[122:123], v170 offset:25088
    ds_read_b64_tr_b16 a[124:125], v170 offset:28672
    ds_read_b64_tr_b16 a[126:127], v170 offset:29184
    s_waitcnt lgkmcnt(0)
    v_add_u32 v171, s80, v1
    v_lshlrev_b32 v162, 6, v160
    v_add_u32 v162, s80, v162
    v_lshl_add_u32 v169, v161, 3, v162
    v_lshl_add_u32 v169, v163, 5, v169
    v_xor_b32 v170, 128, v169
    s_waitcnt vmcnt(0)
    s_barrier
    s_load_dwordx16 s[64:79], s[0:1], 0
    v_lshlrev_b32 v208, 3, v1
    s_lshl2_add_u32 s20, s47, s18
    s_lshl_b32 s20, s20, 13
    s_and_b32 s21, s20, 0x1fffff
    s_waitcnt lgkmcnt(0)
    s_bitcmp1_b32 s20, 21
    s_cselect_b64 s[22:23], s[72:73], s[70:71]
    s_mov_b32 s12, s22
    s_and_b32 s13, s23, 0xffff
    s_mov_b32 s14, 0x200000
    s_mov_b32 s15, 0x00020000
    buffer_load_dword v250, v208, s[12:15], s21 offen
    s_bitcmp1_b32 s20, 21
    s_cselect_b64 s[22:23], s[76:77], s[74:75]
    s_mov_b32 s12, s22
    s_and_b32 s13, s23, 0xffff
    s_mov_b32 s14, 0x200000
    s_mov_b32 s15, 0x00020000
    buffer_load_dword v250, v208, s[12:15], s21 offen
    s_mov_b32 s12, s82
    s_and_b32 s13, s83, 0xffff
    s_mov_b32 s14, 0x400000
    s_mov_b32 s15, 0x00020000
    buffer_load_dword v250, v208, s[12:15], s20 offen
    v_and_b32 v208, 15, v0
    v_lshlrev_b32 v208, 7, v208
    s_lshl_b32 s21, s17, 11
    s_add_u32 s21, s21, s42
    buffer_load_dword v250, v208, s[8:11], s21 offen sc1
    s_cmp_lg_u32 s18, 0
    s_cbranch_scc1 L_m0_7
    s_lshl2_add_u32 s21, s17, s62
    buffer_store_dword v28, v248, s[8:11], s21 offen
    s_lshl_b32 s21, s29, 9
    s_add_u32 s21, s21, s53
    v_min_u32 v246, 0xfffffffe, v246
    v_min_u32 v247, 0xfffffffe, v247
    buffer_store_dwordx2 v[246:247], v26, s[8:11], s21 offen
L_m0_7:
    ds_write_b128 v171, v[32:35] offset:0
    ds_write_b128 v171, v[36:39] offset:1024
    ds_write_b128 v171, v[40:43] offset:2048
    ds_write_b128 v171, v[44:47] offset:3072
    ds_write_b128 v171, v[48:51] offset:4096
    ds_write_b128 v171, v[52:55] offset:5120
    ds_write_b128 v171, v[56:59] offset:6144
    ds_write_b128 v171, v[60:63] offset:7168
    ds_write_b128 v171, v[64:67] offset:8192
    ds_write_b128 v171, v[68:71] offset:9216
    ds_write_b128 v171, v[72:75] offset:10240
    ds_write_b128 v171, v[76:79] offset:11264
    ds_write_b128 v171, v[80:83] offset:12288
    ds_write_b128 v171, v[84:87] offset:13312
    ds_write_b128 v171, v[88:91] offset:14336
    ds_write_b128 v171, v[92:95] offset:15360
    s_waitcnt lgkmcnt(0)
    ds_read_b64_tr_b16 a[128:129], v169 offset:0
    ds_read_b64_tr_b16 a[130:131], v169 offset:256
    ds_read_b64_tr_b16 a[132:133], v169 offset:2048
    ds_read_b64_tr_b16 a[134:135], v169 offset:2304
    ds_read_b64_tr_b16 a[160:161], v170 offset:0
    ds_read_b64_tr_b16 a[162:163], v170 offset:256
    ds_read_b64_tr_b16 a[164:165], v170 offset:2048
    ds_read_b64_tr_b16 a[166:167], v170 offset:2304
    s_waitcnt lgkmcnt(0)
    ds_read_b64_tr_b16 a[136:137], v169 offset:4096
    ds_read_b64_tr_b16 a[138:139], v169 offset:4352
    ds_read_b64_tr_b16 a[140:141], v169 offset:6144
    ds_read_b64_tr_b16 a[142:143], v169 offset:6400
    ds_read_b64_tr_b16 a[168:169], v170 offset:4096
    ds_read_b64_tr_b16 a[170:171], v170 offset:4352
    ds_read_b64_tr_b16 a[172:173], v170 offset:6144
    ds_read_b64_tr_b16 a[174:175], v170 offset:6400
    s_waitcnt lgkmcnt(0)
    ds_read_b64_tr_b16 a[144:145], v169 offset:8192
    ds_read_b64_tr_b16 a[146:147], v169 offset:8448
    ds_read_b64_tr_b16 a[148:149], v169 offset:10240
    ds_read_b64_tr_b16 a[150:151], v169 offset:10496
    ds_read_b64_tr_b16 a[176:177], v170 offset:8192
    ds_read_b64_tr_b16 a[178:179], v170 offset:8448
    ds_read_b64_tr_b16 a[180:181], v170 offset:10240
    ds_read_b64_tr_b16 a[182:183], v170 offset:10496
    s_waitcnt lgkmcnt(0)
    ds_read_b64_tr_b16 a[152:153], v169 offset:12288
    ds_read_b64_tr_b16 a[154:155], v169 offset:12544
    ds_read_b64_tr_b16 a[156:157], v169 offset:14336
    ds_read_b64_tr_b16 a[158:159], v169 offset:14592
    ds_read_b64_tr_b16 a[184:185], v170 offset:12288
    ds_read_b64_tr_b16 a[186:187], v170 offset:12544
    ds_read_b64_tr_b16 a[188:189], v170 offset:14336
    ds_read_b64_tr_b16 a[190:191], v170 offset:14592
    s_waitcnt lgkmcnt(0)
    ds_write_b128 v171, v[96:99] offset:16384
    ds_write_b128 v171, v[100:103] offset:17408
    ds_write_b128 v171, v[104:107] offset:18432
    ds_write_b128 v171, v[108:111] offset:19456
    ds_write_b128 v171, v[112:115] offset:20480
    ds_write_b128 v171, v[116:119] offset:21504
    ds_write_b128 v171, v[120:123] offset:22528
    ds_write_b128 v171, v[124:127] offset:23552
    ds_write_b128 v171, v[128:131] offset:24576
    ds_write_b128 v171, v[132:135] offset:25600
    ds_write_b128 v171, v[136:139] offset:26624
    ds_write_b128 v171, v[140:143] offset:27648
    ds_write_b128 v171, v[144:147] offset:28672
    ds_write_b128 v171, v[148:151] offset:29696
    ds_write_b128 v171, v[152:155] offset:30720
    ds_write_b128 v171, v[156:159] offset:31744
    s_waitcnt lgkmcnt(0)
    ds_read_b64_tr_b16 a[192:193], v169 offset:16384
    ds_read_b64_tr_b16 a[194:195], v169 offset:16640
    ds_read_b64_tr_b16 a[196:197], v169 offset:18432
    ds_read_b64_tr_b16 a[198:199], v169 offset:18688
    ds_read_b64_tr_b16 a[224:225], v170 offset:16384
    ds_read_b64_tr_b16 a[226:227], v170 offset:16640
    ds_read_b64_tr_b16 a[228:229], v170 offset:18432
    ds_read_b64_tr_b16 a[230:231], v170 offset:18688
    s_waitcnt lgkmcnt(0)
    ds_read_b64_tr_b16 a[200:201], v169 offset:20480
    ds_read_b64_tr_b16 a[202:203], v169 offset:20736
    ds_read_b64_tr_b16 a[204:205], v169 offset:22528
    ds_read_b64_tr_b16 a[206:207], v169 offset:22784
    ds_read_b64_tr_b16 a[232:233], v170 offset:20480
    ds_read_b64_tr_b16 a[234:235], v170 offset:20736
    ds_read_b64_tr_b16 a[236:237], v170 offset:22528
    ds_read_b64_tr_b16 a[238:239], v170 offset:22784
    s_waitcnt lgkmcnt(0)
    ds_read_b64_tr_b16 a[208:209], v169 offset:24576
    ds_read_b64_tr_b16 a[210:211], v169 offset:24832
    ds_read_b64_tr_b16 a[212:213], v169 offset:26624
    ds_read_b64_tr_b16 a[214:215], v169 offset:26880
    ds_read_b64_tr_b16 a[240:241], v170 offset:24576
    ds_read_b64_tr_b16 a[242:243], v170 offset:24832
    ds_read_b64_tr_b16 a[244:245], v170 offset:26624
    ds_read_b64_tr_b16 a[246:247], v170 offset:26880
    s_waitcnt lgkmcnt(0)
    ds_read_b64_tr_b16 a[216:217], v169 offset:28672
    ds_read_b64_tr_b16 a[218:219], v169 offset:28928
    ds_read_b64_tr_b16 a[220:221], v169 offset:30720
    ds_read_b64_tr_b16 a[222:223], v169 offset:30976
    ds_read_b64_tr_b16 a[248:249], v170 offset:28672
    ds_read_b64_tr_b16 a[250:251], v170 offset:28928
    ds_read_b64_tr_b16 a[252:253], v170 offset:30720
    ds_read_b64_tr_b16 a[254:255], v170 offset:30976
    s_waitcnt lgkmcnt(0)
    s_mov_b32 s19, 0
    s_mov_b32 s55, 0
    s_mov_b32 s30, 0xc0000
    s_mov_b32 s41, s53
    v_mov_b32 v197, 0
    v_mov_b32 v198, 0
    v_mov_b32 v216, 0x3f803f80
    v_mov_b32 v217, 0x3f803f80
    v_mov_b32 v218, 0x3f803f80
    v_mov_b32 v219, 0x3f803f80
    v_mov_b32 v64, 0
    v_mov_b32 v65, 0
    v_mov_b32 v66, 0
    v_mov_b32 v67, 0
    v_mov_b32 v68, 0
    v_mov_b32 v69, 0
    v_mov_b32 v70, 0
    v_mov_b32 v71, 0
    v_mov_b32 v72, 0
    v_mov_b32 v73, 0
    v_mov_b32 v74, 0
    v_mov_b32 v75, 0
    v_mov_b32 v76, 0
    v_mov_b32 v77, 0
    v_mov_b32 v78, 0
    v_mov_b32 v79, 0
    v_mov_b32 v248, 4
    s_branch L_kvw_8_c
L_kvw_8:
    global_load_dword v249, v248, s[60:61] sc1
    s_add_u32 s33, s33, 1
    s_cmp_gt_u32 s33, 0x100000
    s_cbranch_scc1 chain_kernel_abort
    s_waitcnt vmcnt(0)
L_kvw_8_c:
    v_readfirstlane_b32 s20, v249
    s_and_b32 s21, s20, 0xff
    s_cmp_ge_u32 s21, 15
    s_cbranch_scc1 L_kvok_9
    s_sleep 16
    s_branch L_kvw_8
L_kvok_9:
    s_cmp_ge_u32 s20, 0x800
    s_cselect_b32 s50, 0x2000, 0
    s_add_u32 s52, s50, 0x8000000
    s_add_u32 s48, s48, s50
    v_and_b32 v208, 63, v0
    v_lshlrev_b32 v208, 1, v208
    s_lshr_b32 s22, s17, 4
    s_lshl_b32 s22, s22, 14
    s_and_b32 s23, s17, 15
    s_lshl2_add_u32 s23, s23, s18
    s_lshl_b32 s23, s23, 7
    s_add_u32 s22, s22, s23
    s_xor_b32 s21, s16, 0
    s_lshl_b32 s21, s21, 15
    s_add_u32 s21, s21, s22
    v_add_u32 v8, s21, v208
    s_xor_b32 s21, s16, 1
    s_lshl_b32 s21, s21, 15
    s_add_u32 s21, s21, s22
    v_add_u32 v9, s21, v208
    s_xor_b32 s21, s16, 2
    s_lshl_b32 s21, s21, 15
    s_add_u32 s21, s21, s22
    v_add_u32 v10, s21, v208
    s_xor_b32 s21, s16, 3
    s_lshl_b32 s21, s21, 15
    s_add_u32 s21, s21, s22
    v_add_u32 v11, s21, v208
    s_barrier
    s_add_u32 s21, s19, 0
    s_min_u32 s21, s21, 63
    s_lshl_b32 s31, s21, 21
    s_lshl_b32 s21, s21, 13
    s_and_b32 s21, s21, 0x2000
    s_xor_b32 s21, s21, s48
    s_add_u32 s31, s31, s21
    s_cmp_lg_u32 s18, 1
    s_cbranch_scc1 L_init0_10
    v_mov_b32 v248, 0
    s_lshl2_add_u32 s20, s17, s18
    s_cmp_lg_u32 s20, 5
    s_cbranch_scc1 L_rlo_12
L_rl_11:
    s_load_dword s20, s[60:61], 64 glc
    s_add_u32 s33, s33, 1
    s_cmp_gt_u32 s33, 0x100000
    s_cbranch_scc1 chain_kernel_abort
    s_waitcnt lgkmcnt(0)
    s_cmp_lt_u32 s20, 96
    s_cbranch_scc1 L_rl_11
    v_mov_b32 v249, 1
    buffer_store_dword v249, v248, s[8:11], s62 offen offset:128
    s_branch L_rlok_13
L_rlo_12:
    buffer_load_dword v249, v248, s[8:11], s62 offen offset:128 sc1
    s_add_u32 s33, s33, 1
    s_cmp_gt_u32 s33, 0x100000
    s_cbranch_scc1 chain_kernel_abort
    s_waitcnt vmcnt(0)
    v_readfirstlane_b32 s20, v249
    s_cmp_ge_u32 s20, 1
    s_cbranch_scc1 L_rlok_13
    s_sleep 1
    s_branch L_rlo_12
L_rlok_13:
    s_mov_b32 m0, 40960
    s_nop 0
    buffer_load_dwordx4 v237, s[8:11], s31 offen offset:0 lds
    buffer_load_dwordx4 v237, s[8:11], s31 offen offset:1024 lds
L_init0_10:
    s_cmp_lg_u32 s18, 2
    s_cbranch_scc1 L_init2_14
    v_and_b32 v248, 31, v0
    v_lshlrev_b32 v248, 2, v248
L_initp_15:
    buffer_load_dword v249, v248, s[8:11], s62 offen sc1
    s_add_u32 s33, s33, 1
    s_cmp_gt_u32 s33, 0x100000
    s_cbranch_scc1 chain_kernel_abort
    s_waitcnt vmcnt(0)
    v_cmp_eq_u32 vcc, 0, v249
    s_cbranch_vccz L_init2_14
    s_sleep 2
    s_branch L_initp_15
L_init2_14:
    s_barrier
    s_mov_b32 m0, s54
    s_nop 0
    buffer_load_dwordx4 v235, s[8:11], s31 offen offset:0 lds
    buffer_load_dwordx4 v235, s[8:11], s31 offen offset:1024 lds
    buffer_load_dwordx4 v235, s[8:11], s31 offen offset:2048 lds
    buffer_load_dwordx4 v235, s[8:11], s31 offen offset:3072 lds
    s_waitcnt vmcnt(0) lgkmcnt(0)
    s_barrier
chain_kernel_loop:
    s_mov_b32 s40, s41
    v_mov_b32 v64, 0
    v_mov_b32 v65, 0
    v_mov_b32 v66, 0
    v_mov_b32 v67, 0
    v_mov_b32 v68, 0
    v_mov_b32 v69, 0
    v_mov_b32 v70, 0
    v_mov_b32 v71, 0
    v_mov_b32 v72, 0
    v_mov_b32 v73, 0
    v_mov_b32 v74, 0
    v_mov_b32 v75, 0
    v_mov_b32 v76, 0
    v_mov_b32 v77, 0
    v_mov_b32 v78, 0
    v_mov_b32 v79, 0
    s_add_u32 s30, s30, 0x40000
    s_and_b32 s30, s30, 0xc0000
    s_xor_b32 s20, s30, 0x80000
    s_add_u32 s42, s53, s20
    s_lshl_b32 s43, s19, 18
    s_lshl_b32 s20, s19, 10
    s_and_b32 s20, s20, 0x2000
    s_xor_b32 s20, s20, s52
    s_add_u32 s43, s43, s20
    s_add_u32 s44, s43, 0x20000
    s_add_u32 s20, s30, 0x40000
    s_and_b32 s20, s20, 0xc0000
    s_add_u32 s41, s53, s20
    s_nop 13
    buffer_load_dwordx4 v[32:35], v2, s[8:11], s40 offen offset:0 sc1
    s_nop 13
    buffer_load_dwordx4 v[36:39], v2, s[8:11], s40 offen offset:1024 sc1
    s_nop 13
    buffer_load_dwordx4 v[40:43], v2, s[8:11], s40 offen offset:2048 sc1
    s_nop 13
    buffer_load_dwordx4 v[44:47], v2, s[8:11], s40 offen offset:3072 sc1
Gq_18_s0123:
    s_waitcnt vmcnt(3)
    v_cmp_eq_u32 vcc, -1, v32
    v_mov_b32_dpp v48, v32 row_ror:8 row_mask:0xf bank_mask:0xf
    v_mov_b32_dpp v49, v33 row_ror:8 row_mask:0xf bank_mask:0xf
    v_mov_b32_dpp v50, v34 row_ror:8 row_mask:0xf bank_mask:0xf
    v_mov_b32_dpp v51, v35 row_ror:8 row_mask:0xf bank_mask:0xf
    s_cbranch_vccnz Gq_18_f0123
    v_smfmac_f32_16x16x64_bf16 v[64:67], v[32:35], a[0:7], v19
    v_smfmac_f32_16x16x64_bf16 v[68:71], v[32:35], a[64:71], v19
Gq_18_s123p0:
    s_waitcnt vmcnt(2)
    v_cmp_eq_u32 vcc, -1, v36
    v_smfmac_f32_16x16x64_bf16 v[64:67], v[48:51], a[32:39], v19
    v_mov_b32_dpp v52, v36 row_ror:8 row_mask:0xf bank_mask:0xf
    v_mov_b32_dpp v53, v37 row_ror:8 row_mask:0xf bank_mask:0xf
    v_smfmac_f32_16x16x64_bf16 v[68:71], v[48:51], a[96:103], v19
    v_mov_b32_dpp v54, v38 row_ror:8 row_mask:0xf bank_mask:0xf
    v_mov_b32_dpp v55, v39 row_ror:8 row_mask:0xf bank_mask:0xf
    s_cbranch_vccnz Gq_18_f123p0
    v_smfmac_f32_16x16x64_bf16 v[64:67], v[36:39], a[8:15], v19
    v_smfmac_f32_16x16x64_bf16 v[68:71], v[36:39], a[72:79], v19
Gq_18_s23p1:
    s_waitcnt vmcnt(1)
    v_cmp_eq_u32 vcc, -1, v40
    v_smfmac_f32_16x16x64_bf16 v[64:67], v[52:55], a[40:47], v19
    v_mov_b32_dpp v56, v40 row_ror:8 row_mask:0xf bank_mask:0xf
    v_mov_b32_dpp v57, v41 row_ror:8 row_mask:0xf bank_mask:0xf
    v_smfmac_f32_16x16x64_bf16 v[68:71], v[52:55], a[104:111], v19
    v_mov_b32_dpp v58, v42 row_ror:8 row_mask:0xf bank_mask:0xf
    v_mov_b32_dpp v59, v43 row_ror:8 row_mask:0xf bank_mask:0xf
    s_cbranch_vccnz Gq_18_f23p1
    v_smfmac_f32_16x16x64_bf16 v[64:67], v[40:43], a[16:23], v19
    v_smfmac_f32_16x16x64_bf16 v[68:71], v[40:43], a[80:87], v19
Gq_18_s3p2:
    s_waitcnt vmcnt(0)
    v_cmp_eq_u32 vcc, -1, v44
    v_smfmac_f32_16x16x64_bf16 v[64:67], v[56:59], a[48:55], v19
    v_mov_b32_dpp v60, v44 row_ror:8 row_mask:0xf bank_mask:0xf
    v_mov_b32_dpp v61, v45 row_ror:8 row_mask:0xf bank_mask:0xf
    v_smfmac_f32_16x16x64_bf16 v[68:71], v[56:59], a[112:119], v19
    v_mov_b32_dpp v62, v46 row_ror:8 row_mask:0xf bank_mask:0xf
    v_mov_b32_dpp v63, v47 row_ror:8 row_mask:0xf bank_mask:0xf
    s_cbranch_vccnz Gq_18_f3p2
    v_smfmac_f32_16x16x64_bf16 v[64:67], v[44:47], a[24:31], v19
    v_smfmac_f32_16x16x64_bf16 v[68:71], v[44:47], a[88:95], v19
    v_smfmac_f32_16x16x64_bf16 v[64:67], v[60:63], a[56:63], v19
    v_smfmac_f32_16x16x64_bf16 v[68:71], v[60:63], a[120:127], v19
Gq_18_done:
    v_max3_u32 v20, v33, v34, v35
    v_max3_u32 v208, v37, v38, v39
    v_max3_u32 v209, v41, v42, v43
    v_max3_u32 v210, v45, v46, v47
    ds_write_b64 v12, v[64:65] offset:0
    ds_write_b64 v13, v[66:67] offset:0
    v_max_u32 v20, v20, v208
    v_max3_u32 v20, v20, v209, v210
    ds_write_b64 v14, v[68:69] offset:0
    s_add_u32 m0, s51, 32768
    v_cmp_eq_u32 vcc, -1, v20
    buffer_load_dwordx4 v243, s[8:11], s31 offen offset:0 lds
    buffer_load_dwordx4 v243, s[8:11], s31 offen offset:1024 lds
    v_smfmac_f32_16x16x64_bf16 v[72:75], v[32:35], a[128:135], v19
    v_smfmac_f32_16x16x64_bf16 v[72:75], v[48:51], a[160:167], v19
    s_cbranch_vccnz Gq_18_redo
    s_waitcnt lgkmcnt(0)
    s_barrier
    ds_read_b64 v[80:81], v15 offset:0
    ds_read_b64 v[82:83], v15 offset:512
    ds_read_b64 v[84:85], v15 offset:1024
    v_smfmac_f32_16x16x64_bf16 v[72:75], v[36:39], a[136:143], v19
    v_smfmac_f32_16x16x64_bf16 v[72:75], v[52:55], a[168:175], v19
    s_waitcnt lgkmcnt(2)
    v_pk_add_f32 v[70:71], v[70:71], v[80:81]
    s_waitcnt lgkmcnt(0)
    v_pk_add_f32 v[82:83], v[82:83], v[84:85]
    v_pk_add_f32 v[70:71], v[70:71], v[82:83]
    v_cvt_pk_bf16_f32 v70, v70, v71
    s_cmp_lg_u32 s18, 0
    s_nop 0
    v_mov_b32_dpp v71, v70 quad_perm:[1,0,3,2] row_mask:0xf bank_mask:0xf
    v_perm_b32 v70, v71, v70, v18
    v_min_u32 v70, 0xfffffffe, v70
    buffer_store_dword v70, v4, s[8:11], s40 offen
    v_smfmac_f32_16x16x64_bf16 v[72:75], v[40:43], a[144:151], v19
    v_smfmac_f32_16x16x64_bf16 v[72:75], v[56:59], a[176:183], v19
    v_smfmac_f32_16x16x64_bf16 v[72:75], v[44:47], a[152:159], v19
    v_smfmac_f32_16x16x64_bf16 v[72:75], v[60:63], a[184:191], v19
    s_nop 7
    ds_write_b128 v16, v[72:75] offset:12288
    s_cbranch_scc1 L_help_16
    s_waitcnt vmcnt(1) lgkmcnt(0)
    s_barrier
    ds_read_b128 v[104:107], v1 offset:32768
    ds_read_b128 v[108:111], v1 offset:33792
    ds_read_b128 v[112:115], v1 offset:34816
    ds_read_b128 v[116:119], v1 offset:35840
    buffer_load_dwordx4 v[148:151], v5, s[8:11], s40 offen offset:0 sc1
    buffer_load_dwordx4 v[152:155], v5, s[8:11], s40 offen offset:1024 sc1
    buffer_load_dwordx4 v[156:159], v5, s[8:11], s40 offen offset:2048 sc1
    buffer_load_dwordx4 v[160:163], v5, s[8:11], s40 offen offset:3072 sc1
    ds_read_b128 v[120:123], v1 offset:36864
    ds_read_b128 v[124:127], v1 offset:37888
    ds_read_b128 v[128:131], v1 offset:38912
    ds_read_b128 v[132:135], v1 offset:39936
    ds_read_b128 v[136:139], v1 offset:40960
    ds_read_b128 v[140:143], v1 offset:41984
    s_nop 7
    buffer_load_dwordx4 v[164:167], v5, s[8:11], s40 offen offset:0 sc1
    buffer_load_dwordx4 v[168:171], v5, s[8:11], s40 offen offset:1024 sc1
    buffer_load_dwordx4 v[172:175], v5, s[8:11], s40 offen offset:2048 sc1
    buffer_load_dwordx4 v[176:179], v5, s[8:11], s40 offen offset:3072 sc1
    s_nop 13
    buffer_load_dwordx4 v[32:35], v5, s[8:11], s40 offen offset:0 sc1
    buffer_load_dwordx4 v[36:39], v5, s[8:11], s40 offen offset:1024 sc1
    buffer_load_dwordx4 v[40:43], v5, s[8:11], s40 offen offset:2048 sc1
    buffer_load_dwordx4 v[44:47], v5, s[8:11], s40 offen offset:3072 sc1
    s_waitcnt lgkmcnt(0)
L_sd_19_0_0:
    s_waitcnt vmcnt(11)
    v_max3_u32 v20, v148, v149, v150
    v_mfma_f32_16x16x32_bf16 v[88:91], v[148:151], v[148:151], 0
    v_max_u32 v20, v20, v151
    v_cmp_eq_u32 vcc, -1, v20
    v_mfma_f32_16x16x32_bf16 v[84:87], v[120:123], v[148:151], 0
    v_mfma_f32_16x16x32_bf16 v[80:83], v[104:107], v[148:151], 0
    s_cbranch_vccnz L_sd_19_1_0
L_sd_19_0_1:
    s_waitcnt vmcnt(10)
    v_max3_u32 v20, v152, v153, v154
    v_mfma_f32_16x16x32_bf16 v[100:103], v[152:155], v[152:155], v[88:91]
    v_max_u32 v20, v20, v155
    v_cmp_eq_u32 vcc, -1, v20
    v_mfma_f32_16x16x32_bf16 v[96:99], v[124:127], v[152:155], v[84:87]
    v_mfma_f32_16x16x32_bf16 v[92:95], v[108:111], v[152:155], v[80:83]
    s_cbranch_vccnz L_sd_19_1_1
L_sd_19_0_2:
    s_waitcnt vmcnt(9)
    v_max3_u32 v20, v156, v157, v158
    v_mfma_f32_16x16x32_bf16 v[228:231], v[156:159], v[156:159], v[100:103]
    v_max_u32 v20, v20, v159
    v_cmp_eq_u32 vcc, -1, v20
    v_mfma_f32_16x16x32_bf16 v[224:227], v[128:131], v[156:159], v[96:99]
    v_mfma_f32_16x16x32_bf16 v[220:223], v[112:115], v[156:159], v[92:95]
    s_cbranch_vccnz L_sd_19_1_2
L_sd_19_0_3:
    s_waitcnt vmcnt(8)
    v_max3_u32 v20, v160, v161, v162
    v_mfma_f32_16x16x32_bf16 v[188:191], v[160:163], v[160:163], v[228:231]
    v_max_u32 v20, v20, v163
    v_cmp_eq_u32 vcc, -1, v20
    v_mfma_f32_16x16x32_bf16 v[184:187], v[132:135], v[160:163], v[224:227]
    v_mfma_f32_16x16x32_bf16 v[180:183], v[116:119], v[160:163], v[220:223]
    v_mov_b32_dpp v188, v189 row_ror:8 row_mask:0xf bank_mask:0xc
    v_mov_b32_dpp v190, v191 row_ror:8 row_mask:0xf bank_mask:0xc
    s_cbranch_vccnz L_sd_19_1_3
L_sd_19:
    s_barrier
    v_permlane32_swap_b32 v188, v190
    ds_read_b64 v[144:145], v26 offset:28672
    s_cmp_eq_u32 s19, 63
    s_cbranch_scc1 chain_kernel_fin
    v_mov_b32_dpp v180, v184 row_ror:8 row_mask:0xf bank_mask:0xc
    v_mov_b32_dpp v181, v185 row_ror:8 row_mask:0xf bank_mask:0xc
    v_mov_b32_dpp v182, v186 row_ror:8 row_mask:0xf bank_mask:0xc
    v_mov_b32_dpp v183, v187 row_ror:8 row_mask:0xf bank_mask:0xc
    v_max3_f32 v208, v190, v180, v181
    v_max3_f32 v208, v208, v182, v183
    v_cvt_pk_bf16_f32 v180, 0, v180
    v_cvt_pk_bf16_f32 v181, 0, v181
    v_max_f32_dpp v208, v208, v208 row_ror:8 row_mask:0xf bank_mask:0xf
    v_mov_b32 v209, v208
    v_cvt_pk_bf16_f32 v182, 0, v182
    v_cvt_pk_bf16_f32 v183, 0, v183
    v_permlane16_swap_b32 v208, v209
    v_cvt_pk_bf16_f32 v190, 0, v190
    v_max_f32 v208, v208, v209
    v_mov_b32 v209, v208
    v_pk_mul_f32 v[180:181], v[180:181], s[58:59]
    v_pk_mul_f32 v[182:183], v[182:183], s[58:59]
    v_permlane32_swap_b32 v208, v209
    v_mul_f32 v190, s58, v190
    v_max_f32 v208, v208, v209
    v_cvt_pk_bf16_f32 v190, 0, v190
    v_cvt_pk_bf16_f32 v208, 0, v208
    v_cvt_pk_bf16_f32 v180, 0, v180
    v_mul_f32 v208, s58, v208
    v_cvt_pk_bf16_f32 v181, 0, v181
    v_cvt_pk_bf16_f32 v208, 0, v208
    v_cvt_pk_bf16_f32 v182, 0, v182
    v_mul_f32 v208, s56, v208
    v_cvt_pk_bf16_f32 v183, 0, v183
    v_fma_f32 v190, v190, s56, -v208
    v_pk_fma_f32 v[180:181], v[180:181], s[56:57], v[208:209] op_sel_hi:[1,1,0] neg_lo:[0,0,1] neg_hi:[0,0,1]
    v_exp_f32 v190, v190
    v_pk_fma_f32 v[182:183], v[182:183], s[56:57], v[208:209] op_sel_hi:[1,1,0] neg_lo:[0,0,1] neg_hi:[0,0,1]
    v_exp_f32 v180, v180
    v_mov_b32_dpp v209, v190 row_ror:8 row_mask:0xf bank_mask:0xf
    v_exp_f32 v181, v181
    v_cvt_pk_bf16_f32 v196, v190, v209
    v_cvt_pk_bf16_f32 v199, v190, v209
    v_exp_f32 v182, v182
    v_mfma_f32_16x16x16_bf16 v[184:187], v[216:217], v[196:197], 0
    v_exp_f32 v183, v183
    s_waitcnt lgkmcnt(0)
    v_mfma_f32_16x16x16_bf16 v[200:203], v[144:145], v[196:197], 0
    v_cvt_pk_bf16_f32 v192, v180, v181
    v_cvt_pk_bf16_f32 v193, v182, v183
    v_mfma_f32_16x16x16_bf16 v[204:207], v[144:145], v[198:199], 0
    v_mov_b32_dpp v194, v192 row_ror:8 row_mask:0xf bank_mask:0xf
    v_mov_b32_dpp v195, v193 row_ror:8 row_mask:0xf bank_mask:0xf
    s_mov_b64 exec, s[24:25]
    s_nop 0
    v_mfma_f32_16x16x32_bf16 v[184:187], v[216:219], v[192:195], v[184:187]
    v_mfma_f32_16x16x32_bf16 v[200:203], v[136:139], v[192:195], v[200:203]
    v_mfma_f32_16x16x32_bf16 v[204:207], v[140:143], v[192:195], v[204:207]
    s_nop 0
    v_rcp_f32 v184, v184
    s_nop 1
    v_pk_mul_f32 v[200:201], v[200:201], v[184:185] op_sel_hi:[1,0]
    v_pk_mul_f32 v[202:203], v[202:203], v[184:185] op_sel_hi:[1,0]
    v_cvt_pk_bf16_f32 v200, v200, v201
    v_cvt_pk_bf16_f32 v201, v202, v203
    v_pk_mul_f32 v[204:205], v[204:205], v[184:185] op_sel_hi:[1,0]
    v_pk_mul_f32 v[206:207], v[206:207], v[184:185] op_sel_hi:[1,0]
    v_cvt_pk_bf16_f32 v202, v204, v205
    v_cvt_pk_bf16_f32 v203, v206, v207
    v_min_u32 v200, 0xfffffffe, v200
    v_min_u32 v201, 0xfffffffe, v201
    v_min_u32 v202, 0xfffffffe, v202
    v_min_u32 v203, 0xfffffffe, v203
    buffer_store_dwordx4 v[200:203], v6, s[8:11], s40 offen
    s_mov_b64 exec, -1
L_b4_17:
    s_barrier
    s_add_u32 s21, s19, 1
    s_min_u32 s21, s21, 63
    s_lshl_b32 s31, s21, 21
    s_lshl_b32 s21, s21, 13
    s_and_b32 s21, s21, 0x2000
    s_xor_b32 s21, s21, s48
    s_add_u32 s31, s31, s21
    s_add_u32 s19, s19, 1
    s_nop 15
    s_nop 11
    buffer_load_dwordx4 v[32:35], v3, s[8:11], s40 offen offset:0 sc1
    s_nop 13
    buffer_load_dwordx4 v[36:39], v3, s[8:11], s40 offen offset:1024 sc1
    s_nop 13
    buffer_load_dwordx4 v[40:43], v3, s[8:11], s40 offen offset:2048 sc1
    s_nop 13
    buffer_load_dwordx4 v[44:47], v3, s[8:11], s40 offen offset:3072 sc1
Go_20_s0123:
    s_waitcnt vmcnt(3)
    v_cmp_eq_u32 vcc, -1, v32
    v_mov_b32_dpp v48, v32 row_ror:8 row_mask:0xf bank_mask:0xf
    v_mov_b32_dpp v49, v33 row_ror:8 row_mask:0xf bank_mask:0xf
    v_mov_b32_dpp v50, v34 row_ror:8 row_mask:0xf bank_mask:0xf
    v_mov_b32_dpp v51, v35 row_ror:8 row_mask:0xf bank_mask:0xf
    s_cbranch_vccnz Go_20_f0123
    v_smfmac_f32_16x16x64_bf16 v[76:79], v[32:35], a[192:199], v19
    v_smfmac_f32_16x16x64_bf16 v[76:79], v[48:51], a[224:231], v19
Go_20_s123:
    s_waitcnt vmcnt(2)
    v_cmp_eq_u32 vcc, -1, v36
    v_mov_b32_dpp v52, v36 row_ror:8 row_mask:0xf bank_mask:0xf
    v_mov_b32_dpp v53, v37 row_ror:8 row_mask:0xf bank_mask:0xf
    v_mov_b32_dpp v54, v38 row_ror:8 row_mask:0xf bank_mask:0xf
    v_mov_b32_dpp v55, v39 row_ror:8 row_mask:0xf bank_mask:0xf
    s_cbranch_vccnz Go_20_f123
    v_smfmac_f32_16x16x64_bf16 v[76:79], v[36:39], a[200:207], v19
    v_smfmac_f32_16x16x64_bf16 v[76:79], v[52:55], a[232:239], v19
Go_20_s23:
    s_waitcnt vmcnt(1)
    v_cmp_eq_u32 vcc, -1, v40
    v_mov_b32_dpp v56, v40 row_ror:8 row_mask:0xf bank_mask:0xf
    v_mov_b32_dpp v57, v41 row_ror:8 row_mask:0xf bank_mask:0xf
    v_mov_b32_dpp v58, v42 row_ror:8 row_mask:0xf bank_mask:0xf
    v_mov_b32_dpp v59, v43 row_ror:8 row_mask:0xf bank_mask:0xf
    s_cbranch_vccnz Go_20_f23
    v_smfmac_f32_16x16x64_bf16 v[76:79], v[40:43], a[208:215], v19
    v_smfmac_f32_16x16x64_bf16 v[76:79], v[56:59], a[240:247], v19
Go_20_s3:
    s_waitcnt vmcnt(0)
    v_cmp_eq_u32 vcc, -1, v44
    v_mov_b32_dpp v60, v44 row_ror:8 row_mask:0xf bank_mask:0xf
    v_mov_b32_dpp v61, v45 row_ror:8 row_mask:0xf bank_mask:0xf
    v_mov_b32_dpp v62, v46 row_ror:8 row_mask:0xf bank_mask:0xf
    v_mov_b32_dpp v63, v47 row_ror:8 row_mask:0xf bank_mask:0xf
    s_cbranch_vccnz Go_20_f3
    v_smfmac_f32_16x16x64_bf16 v[76:79], v[44:47], a[216:223], v19
    v_smfmac_f32_16x16x64_bf16 v[76:79], v[60:63], a[248:255], v19
Go_20_done:
    v_max3_u32 v20, v33, v34, v35
    v_max3_u32 v208, v37, v38, v39
    v_max3_u32 v209, v41, v42, v43
    v_max3_u32 v210, v45, v46, v47
    v_max_u32 v20, v20, v208
    v_max3_u32 v20, v20, v209, v210
    v_cmp_eq_u32 vcc, -1, v20
    s_nop 0
    ds_write_b32 v238, v76 offset:20480
    ds_write_b32 v239, v77 offset:20480
    ds_write_b32 v240, v78 offset:20480
    s_cbranch_vccnz Go_20_redo
    s_waitcnt lgkmcnt(0)
    s_barrier
    ds_read_b32 v80, v17 offset:20480
    ds_read_b32 v81, v17 offset:20736
    ds_read_b32 v82, v17 offset:20992
    s_cmp_lt_u32 s18, 2
    s_waitcnt lgkmcnt(2)
    v_add_f32 v80, v80, v79
    s_waitcnt lgkmcnt(0)
    v_add_f32 v81, v81, v82
    v_add_f32 v80, v80, v81
    v_cvt_pk_bf16_f32 v80, 0, v80
    v_min_u32 v80, 0xfffe0000, v80
    buffer_store_short_d16_hi v80, v8, s[8:11], s43 offen sc1
    buffer_store_short_d16_hi v80, v8, s[8:11], s44 offen sc1
    ds_read_b128 v[164:167], v241 offset:51200
    ds_read_b128 v[168:171], v241 offset:51712
    ds_read_b128 v[172:175], v241 offset:52224
    v_mov_b32 v220, 0
    v_mov_b32 v221, 0
    v_mov_b32 v222, 0
    v_mov_b32 v223, 0
    v_mov_b32 v224, 0
    v_mov_b32 v225, 0
    ds_read_b128 v[176:179], v241 offset:52736
    s_waitcnt lgkmcnt(3)
    v_mfma_f32_16x16x32_bf16 v[188:191], v[164:167], v[148:151], 0
    s_waitcnt lgkmcnt(2)
    v_mfma_f32_16x16x32_bf16 v[188:191], v[168:171], v[152:155], v[188:191]
    s_waitcnt lgkmcnt(1)
    v_mfma_f32_16x16x32_bf16 v[188:191], v[172:175], v[156:159], v[188:191]
    s_waitcnt lgkmcnt(0)
    v_mfma_f32_16x16x32_bf16 v[188:191], v[176:179], v[160:163], v[188:191]
    s_nop 7
    v_cvt_pk_bf16_f32 v188, 0, v188
    v_cvt_pk_bf16_f32 v189, 0, v189
    v_pk_mul_f32 v[188:189], v[188:189], s[58:59]
    v_cvt_pk_bf16_f32 v188, 0, v188
    v_cvt_pk_bf16_f32 v189, 0, v189
    v_max3_f32 v86, v86, v188, v189
    v_mov_b32 v87, v86
    buffer_load_short_d16_hi v220, v9, s[8:11], s43 offen sc1
    buffer_load_short_d16_hi v221, v10, s[8:11], s43 offen sc1
    buffer_load_short_d16_hi v222, v11, s[8:11], s43 offen sc1
    s_nop 1
    v_permlane16_swap_b32 v86, v87
    v_max_f32 v86, v86, v87
    v_mov_b32 v87, v86
    s_nop 1
    v_permlane32_swap_b32 v86, v87
    v_max_f32 v86, v86, v87
    v_mul_f32 v86, s56, v86
    v_pk_fma_f32 v[180:181], v[180:181], s[56:57], v[86:87] op_sel_hi:[1,1,0] neg_lo:[0,0,1] neg_hi:[0,0,1]
    v_pk_fma_f32 v[182:183], v[182:183], s[56:57], v[86:87] op_sel_hi:[1,1,0] neg_lo:[0,0,1] neg_hi:[0,0,1]
    v_pk_fma_f32 v[184:185], v[184:185], s[56:57], v[86:87] op_sel_hi:[1,1,0] neg_lo:[0,0,1] neg_hi:[0,0,1]
    v_pk_fma_f32 v[186:187], v[186:187], s[56:57], v[86:87] op_sel_hi:[1,1,0] neg_lo:[0,0,1] neg_hi:[0,0,1]
    v_pk_fma_f32 v[188:189], v[188:189], s[56:57], v[86:87] op_sel_hi:[1,1,0] neg_lo:[0,0,1] neg_hi:[0,0,1]
    v_exp_f32 v180, v180
    v_exp_f32 v181, v181
    v_exp_f32 v182, v182
    v_exp_f32 v183, v183
    v_exp_f32 v184, v184
    v_exp_f32 v185, v185
    v_exp_f32 v186, v186
    v_exp_f32 v187, v187
    v_exp_f32 v188, v188
    buffer_load_short_d16_hi v223, v9, s[8:11], s44 offen sc1
    buffer_load_short_d16_hi v224, v10, s[8:11], s44 offen sc1
    buffer_load_short_d16_hi v225, v11, s[8:11], s44 offen sc1
    s_add_u32 m0, s51, 43008
    v_exp_f32 v189, v189
    v_pk_add_f32 v[88:89], v[180:181], v[182:183]
    v_pk_add_f32 v[90:91], v[184:185], v[186:187]
    v_pk_add_f32 v[88:89], v[88:89], v[188:189]
    v_pk_add_f32 v[88:89], v[88:89], v[90:91]
    v_add_f32 v88, v88, v89
    buffer_load_dwordx4 v244, s[8:11], s31 offen offset:0 lds
    v_mov_b32 v87, v88
    s_nop 1
    v_permlane16_swap_b32 v88, v87
    v_add_f32 v88, v88, v87
    v_mov_b32 v87, v88
    s_nop 1
    buffer_load_dwordx4 v244, s[8:11], s31 offen offset:1024 lds
    v_permlane32_swap_b32 v88, v87
    v_add_f32 v88, v88, v87
    v_rcp_f32 v88, v88
    s_nop 0
    v_pk_mul_f32 v[180:181], v[180:181], v[88:89] op_sel_hi:[1,0]
    v_pk_mul_f32 v[182:183], v[182:183], v[88:89] op_sel_hi:[1,0]
    v_pk_mul_f32 v[184:185], v[184:185], v[88:89] op_sel_hi:[1,0]
    v_pk_mul_f32 v[186:187], v[186:187], v[88:89] op_sel_hi:[1,0]
    v_pk_mul_f32 v[188:189], v[188:189], v[88:89] op_sel_hi:[1,0]
    v_cvt_pk_bf16_f32 v192, v180, v181
    v_cvt_pk_bf16_f32 v193, v182, v183
    v_cvt_pk_bf16_f32 v194, v184, v185
    v_cvt_pk_bf16_f32 v195, v186, v187
    v_cvt_pk_bf16_f32 v196, v188, v189
    v_cvt_pk_bf16_f32 v199, v188, v189
    v_mfma_f32_16x16x32_bf16 v[200:203], v[136:139], v[192:195], 0
    v_mfma_f32_16x16x32_bf16 v[204:207], v[140:143], v[192:195], 0
    v_mfma_f32_16x16x16_bf16 v[200:203], v[144:145], v[196:197], v[200:203]
    v_mfma_f32_16x16x16_bf16 v[204:207], v[144:145], v[198:199], v[204:207]
    s_waitcnt vmcnt(7)
    v_add_f32 v208, v80, v220
    s_waitcnt vmcnt(5)
    v_max3_u32 v20, v220, v221, v222
    v_add_f32 v209, v221, v222
    v_cmp_eq_u32 vcc, 0xffff0000, v20
    v_add_f32 v208, v208, v209
    s_nop 1
    v_mov_b32_dpp v209, v208 quad_perm:[1,0,3,2] row_mask:0xf bank_mask:0xf
    s_mov_b64 exec, s[26:27]
    v_cvt_pk_bf16_f32 v208, v208, v209
    v_min_u32 v208, 0xfffffffe, v208
    s_cbranch_vccnz L_pf_22
L_pd_21:
    buffer_store_dword v208, v7, s[8:11], s41 offen
    s_mov_b64 exec, -1
    s_branch chain_kernel_loop
L_help_16:
    s_waitcnt vmcnt(1) lgkmcnt(0)
    s_barrier
    s_cmp_ge_u32 s18, 2
    s_cbranch_scc1 L_w2_26
    ds_read_b128 v[80:83], v1 offset:12288
    ds_read_b128 v[84:87], v1 offset:14336
    ds_read_b128 v[88:91], v1 offset:15360
    s_waitcnt lgkmcnt(2)
    v_pk_add_f32 v[72:73], v[72:73], v[82:83]
    v_pk_add_f32 v[74:75], v[74:75], v[80:81]
    s_waitcnt lgkmcnt(1)
    v_pk_add_f32 v[72:73], v[72:73], v[86:87]
    v_pk_add_f32 v[74:75], v[74:75], v[84:85]
    s_waitcnt lgkmcnt(0)
    v_pk_add_f32 v[72:73], v[72:73], v[88:89]
    v_pk_add_f32 v[74:75], v[74:75], v[90:91]
    v_cvt_pk_bf16_f32 v144, v72, v73
    v_cvt_pk_bf16_f32 v145, v74, v75
    s_nop 1
    v_permlane32_swap_b32 v144, v145
    s_nop 1
    ds_write_b64 v26, v[144:145] offset:28672
    s_add_u32 s21, s19, 1
    s_min_u32 s21, s21, 63
    s_lshl_b32 s63, s21, 21
    s_lshl_b32 s21, s21, 13
    s_and_b32 s21, s21, 0x2000
    s_xor_b32 s21, s21, s48
    s_add_u32 s63, s63, s21
    s_nop 15
    s_nop 15
    s_nop 0
    buffer_load_dword v250, v25, s[8:11], s63 offen sc1
    s_add_u32 s20, s19, 2
    s_min_u32 s20, s20, 63
    s_bfm_b64 s[22:23], s20, 0
    s_and_b32 s22, s22, 0x204225f
    s_and_b32 s23, s23, 0x80004004
    s_bcnt1_i32_b64 s32, s[22:23]
    s_lshl_b32 s32, s32, 2
    s_add_u32 s32, s32, 64
    s_cmp_eq_u32 s47, 1
    s_cselect_b32 s32, s32, s55
    s_add_u32 s21, s19, 1
    s_min_u32 s21, s21, 63
    s_lshl_b32 s31, s21, 21
    s_lshl_b32 s21, s21, 13
    s_and_b32 s21, s21, 0x2000
    s_xor_b32 s21, s21, s48
    s_add_u32 s31, s31, s21
    s_waitcnt lgkmcnt(0)
    s_cmp_eq_u32 s32, s55
    s_cbranch_scc1 L_nog_29
    s_load_dword s22, s[60:61], s32 glc
L_nog_29:
    s_mov_b32 s23, 1
    s_barrier
    s_cmp_lg_u32 s19, 0
    s_cbranch_scc1 L_ns0_32
    v_mov_b32 v248, 0
    s_lshl2_add_u32 s20, s17, s18
    s_cmp_lg_u32 s20, 5
    s_cbranch_scc1 L_rlo_34
L_rl_33:
    s_load_dword s20, s[60:61], 68 glc
    s_add_u32 s33, s33, 1
    s_cmp_gt_u32 s33, 0x100000
    s_cbranch_scc1 chain_kernel_abort
    s_waitcnt lgkmcnt(0)
    s_cmp_lt_u32 s20, 96
    s_cbranch_scc1 L_rl_33
    v_mov_b32 v249, 2
    buffer_store_dword v249, v248, s[8:11], s62 offen offset:128
    s_branch L_rlok_35
L_rlo_34:
    buffer_load_dword v249, v248, s[8:11], s62 offen offset:128 sc1
    s_add_u32 s33, s33, 1
    s_cmp_gt_u32 s33, 0x100000
    s_cbranch_scc1 chain_kernel_abort
    s_waitcnt vmcnt(0)
    v_readfirstlane_b32 s20, v249
    s_cmp_ge_u32 s20, 2
    s_cbranch_scc1 L_rlok_35
    s_sleep 1
    s_branch L_rlo_34
L_rlok_35:
L_ns0_32:
    s_mov_b32 m0, 40960
    s_nop 0
    buffer_load_dwordx4 v237, s[8:11], s31 offen offset:0 lds
    buffer_load_dwordx4 v237, s[8:11], s31 offen offset:1024 lds
    s_cmp_lg_u32 s47, 0
    s_cbranch_scc1 L_nof_31
    s_atomic_add s23, s[60:61], 208
L_nof_31:
    buffer_store_dwordx4 v[28:31], v22, s[8:11], s42 offen
    s_lshl_b32 s21, s29, 9
    s_add_u32 s21, s21, s42
    buffer_store_dwordx2 v[28:29], v26, s[8:11], s21 offen
    s_xor_b32 s21, s21, 20480
    buffer_store_dwordx2 v[28:29], v26, s[8:11], s21 offen
    s_cmp_eq_u32 s32, s55
    s_cbranch_scc1 L_he_28
    s_mov_b32 s55, s32
L_gr_30:
    s_waitcnt lgkmcnt(0)
    s_cmp_ge_u32 s22, 96
    s_cbranch_scc1 L_he_28
    s_add_u32 s33, s33, 1
    s_cmp_gt_u32 s33, 0x100000
    s_cbranch_scc1 chain_kernel_abort
    s_load_dword s22, s[60:61], s32 glc
    s_branch L_gr_30
L_w2_26:
    ds_read_b128 v[148:151], v242 offset:43008
    ds_read_b128 v[104:107], v1 offset:32768
    ds_read_b128 v[108:111], v1 offset:36864
    ds_read_b128 v[152:155], v242 offset:44032
    ds_read_b128 v[112:115], v1 offset:33792
    ds_read_b128 v[116:119], v1 offset:37888
    ds_read_b128 v[156:159], v242 offset:45056
    ds_read_b128 v[120:123], v1 offset:34816
    ds_read_b128 v[124:127], v1 offset:38912
    ds_read_b128 v[160:163], v242 offset:46080
    ds_read_b128 v[128:131], v1 offset:35840
    ds_read_b128 v[132:135], v1 offset:39936
    ds_read_b128 v[136:139], v1 offset:40960
    ds_read_b128 v[140:143], v1 offset:41984
    v_cvt_pk_bf16_f32 v200, v200, v201
    v_cvt_pk_bf16_f32 v201, v202, v203
    v_cvt_pk_bf16_f32 v202, v204, v205
    v_cvt_pk_bf16_f32 v203, v206, v207
    s_add_u32 s21, s19, -1
    s_lshl_b32 s32, s21, 21
    s_lshl_b32 s21, s21, 13
    s_and_b32 s21, s21, 0x2000
    s_xor_b32 s21, s21, s48
    s_add_u32 s32, s32, s21
    s_waitcnt lgkmcnt(11)
    v_mfma_f32_16x16x32_bf16 v[180:183], v[104:107], v[148:151], 0
    v_mfma_f32_16x16x32_bf16 v[184:187], v[108:111], v[148:151], 0
    s_waitcnt lgkmcnt(8)
    v_mfma_f32_16x16x32_bf16 v[180:183], v[112:115], v[152:155], v[180:183]
    v_mfma_f32_16x16x32_bf16 v[184:187], v[116:119], v[152:155], v[184:187]
    s_waitcnt lgkmcnt(5)
    v_mfma_f32_16x16x32_bf16 v[180:183], v[120:123], v[156:159], v[180:183]
    v_mfma_f32_16x16x32_bf16 v[184:187], v[124:127], v[156:159], v[184:187]
    s_waitcnt lgkmcnt(2)
    v_mfma_f32_16x16x32_bf16 v[180:183], v[128:131], v[160:163], v[180:183]
    v_mfma_f32_16x16x32_bf16 v[184:187], v[132:135], v[160:163], v[184:187]
    buffer_store_dwordx4 v[200:203], v23, s[8:11], s32 offen sc1
    s_nop 6
    v_cvt_pk_bf16_f32 v180, 0, v180
    v_cvt_pk_bf16_f32 v181, 0, v181
    v_cvt_pk_bf16_f32 v182, 0, v182
    v_cvt_pk_bf16_f32 v183, 0, v183
    v_cvt_pk_bf16_f32 v184, 0, v184
    v_cvt_pk_bf16_f32 v185, 0, v185
    v_cvt_pk_bf16_f32 v186, 0, v186
    v_cvt_pk_bf16_f32 v187, 0, v187
    v_pk_mul_f32 v[180:181], v[180:181], s[58:59]
    v_pk_mul_f32 v[182:183], v[182:183], s[58:59]
    v_pk_mul_f32 v[184:185], v[184:185], s[58:59]
    v_pk_mul_f32 v[186:187], v[186:187], s[58:59]
    v_cvt_pk_bf16_f32 v180, 0, v180
    v_cvt_pk_bf16_f32 v181, 0, v181
    v_cvt_pk_bf16_f32 v182, 0, v182
    v_cvt_pk_bf16_f32 v183, 0, v183
    v_cvt_pk_bf16_f32 v184, 0, v184
    v_cvt_pk_bf16_f32 v185, 0, v185
    v_cvt_pk_bf16_f32 v186, 0, v186
    v_cvt_pk_bf16_f32 v187, 0, v187
    v_pk_add_f32 v[180:181], v[180:181], v[226:227]
    v_pk_add_f32 v[182:183], v[182:183], v[228:229]
    v_pk_add_f32 v[184:185], v[184:185], v[230:231]
    v_pk_add_f32 v[186:187], v[186:187], v[232:233]
    v_max3_f32 v86, v180, v181, v182
    v_max3_f32 v87, v183, v184, v185
    v_max3_f32 v86, v86, v186, v187
    v_max_f32 v86, v86, v87
    s_cmp_eq_u32 s18, 3
    s_waitcnt lgkmcnt(0)
    s_barrier
    ds_read_b64 v[144:145], v26 offset:28672
    s_cbranch_scc0 L_w3_27
    s_mov_b32 m0, 51200
    s_nop 0
    buffer_load_dwordx4 v24, s[8:11], s40 offen offset:0 sc1 lds
    s_mov_b32 m0, 50176
    s_nop 0
    buffer_load_dwordx4 v24, s[8:11], s40 offen offset:2048 sc1 lds
L_w3_27:
L_he_28:
    s_cmp_lg_u32 s19, 63
    s_cbranch_scc1 L_b4_17
chain_kernel_fin:
    s_waitcnt vmcnt(0) lgkmcnt(0)
    s_barrier
    s_cmp_lt_u32 s18, 2
    s_cbranch_scc1 L_f2_36
    ds_read_b128 v[164:167], v241 offset:51200
    ds_read_b128 v[168:171], v241 offset:51712
    ds_read_b128 v[172:175], v241 offset:52224
    ds_read_b128 v[176:179], v241 offset:52736
    s_waitcnt lgkmcnt(3)
    v_mfma_f32_16x16x32_bf16 v[188:191], v[164:167], v[148:151], 0
    s_waitcnt lgkmcnt(2)
    v_mfma_f32_16x16x32_bf16 v[188:191], v[168:171], v[152:155], v[188:191]
    s_waitcnt lgkmcnt(1)
    v_mfma_f32_16x16x32_bf16 v[188:191], v[172:175], v[156:159], v[188:191]
    s_waitcnt lgkmcnt(0)
    v_mfma_f32_16x16x32_bf16 v[188:191], v[176:179], v[160:163], v[188:191]
    s_nop 7
    v_cvt_pk_bf16_f32 v188, 0, v188
    v_cvt_pk_bf16_f32 v189, 0, v189
    v_pk_mul_f32 v[188:189], v[188:189], s[58:59]
    v_cvt_pk_bf16_f32 v188, 0, v188
    v_cvt_pk_bf16_f32 v189, 0, v189
    v_max3_f32 v86, v86, v188, v189
    v_mov_b32 v87, v86
    s_nop 1
    v_permlane16_swap_b32 v86, v87
    v_max_f32 v86, v86, v87
    v_mov_b32 v87, v86
    s_nop 1
    v_permlane32_swap_b32 v86, v87
    v_max_f32 v86, v86, v87
    v_mul_f32 v86, s56, v86
    v_pk_fma_f32 v[180:181], v[180:181], s[56:57], v[86:87] op_sel_hi:[1,1,0] neg_lo:[0,0,1] neg_hi:[0,0,1]
    v_pk_fma_f32 v[182:183], v[182:183], s[56:57], v[86:87] op_sel_hi:[1,1,0] neg_lo:[0,0,1] neg_hi:[0,0,1]
    v_pk_fma_f32 v[184:185], v[184:185], s[56:57], v[86:87] op_sel_hi:[1,1,0] neg_lo:[0,0,1] neg_hi:[0,0,1]
    v_pk_fma_f32 v[186:187], v[186:187], s[56:57], v[86:87] op_sel_hi:[1,1,0] neg_lo:[0,0,1] neg_hi:[0,0,1]
    v_pk_fma_f32 v[188:189], v[188:189], s[56:57], v[86:87] op_sel_hi:[1,1,0] neg_lo:[0,0,1] neg_hi:[0,0,1]
    v_exp_f32 v180, v180
    v_exp_f32 v181, v181
    v_exp_f32 v182, v182
    v_exp_f32 v183, v183
    v_exp_f32 v184, v184
    v_exp_f32 v185, v185
    v_exp_f32 v186, v186
    v_exp_f32 v187, v187
    v_exp_f32 v188, v188
    v_exp_f32 v189, v189
    v_pk_add_f32 v[88:89], v[180:181], v[182:183]
    v_pk_add_f32 v[90:91], v[184:185], v[186:187]
    v_pk_add_f32 v[88:89], v[88:89], v[188:189]
    v_pk_add_f32 v[88:89], v[88:89], v[90:91]
    v_add_f32 v88, v88, v89
    v_mov_b32 v87, v88
    s_nop 1
    v_permlane16_swap_b32 v88, v87
    v_add_f32 v88, v88, v87
    v_mov_b32 v87, v88
    s_nop 1
    v_permlane32_swap_b32 v88, v87
    v_add_f32 v88, v88, v87
    v_rcp_f32 v88, v88
    s_nop 0
    v_pk_mul_f32 v[180:181], v[180:181], v[88:89] op_sel_hi:[1,0]
    v_pk_mul_f32 v[182:183], v[182:183], v[88:89] op_sel_hi:[1,0]
    v_pk_mul_f32 v[184:185], v[184:185], v[88:89] op_sel_hi:[1,0]
    v_pk_mul_f32 v[186:187], v[186:187], v[88:89] op_sel_hi:[1,0]
    v_pk_mul_f32 v[188:189], v[188:189], v[88:89] op_sel_hi:[1,0]
    v_cvt_pk_bf16_f32 v192, v180, v181
    v_cvt_pk_bf16_f32 v193, v182, v183
    v_cvt_pk_bf16_f32 v194, v184, v185
    v_cvt_pk_bf16_f32 v195, v186, v187
    v_cvt_pk_bf16_f32 v196, v188, v189
    v_cvt_pk_bf16_f32 v199, v188, v189
    v_mfma_f32_16x16x32_bf16 v[200:203], v[136:139], v[192:195], 0
    v_mfma_f32_16x16x32_bf16 v[204:207], v[140:143], v[192:195], 0
    v_mfma_f32_16x16x16_bf16 v[200:203], v[144:145], v[196:197], v[200:203]
    v_mfma_f32_16x16x16_bf16 v[204:207], v[144:145], v[198:199], v[204:207]
    s_add_u32 s21, s19, 0
    s_min_u32 s21, s21, 63
    s_lshl_b32 s32, s21, 21
    s_lshl_b32 s21, s21, 13
    s_and_b32 s21, s21, 0x2000
    s_xor_b32 s21, s21, s48
    s_add_u32 s32, s32, s21
    s_nop 1
    v_cvt_pk_bf16_f32 v200, v200, v201
    v_cvt_pk_bf16_f32 v201, v202, v203
    v_cvt_pk_bf16_f32 v202, v204, v205
    v_cvt_pk_bf16_f32 v203, v206, v207
    buffer_store_dwordx4 v[200:203], v23, s[8:11], s32 offen sc1
    s_waitcnt vmcnt(0)
L_f2_36:
    s_barrier
    s_cmp_lg_u32 s18, 0
    s_cbranch_scc1 chain_kernel_done
    s_add_u32 s20, s62, 4096
    s_mov_b32 s21, 1
    s_atomic_add s21, s[100:101], s20
    s_branch chain_kernel_done
Gq_18_f0123:
    buffer_load_dwordx4 v[32:35], v2, s[8:11], s40 offen offset:0 sc1
    s_branch Gq_18_s1230
Gq_18_f123p0:
    buffer_load_dwordx4 v[36:39], v2, s[8:11], s40 offen offset:1024 sc1
    s_add_u32 s33, s33, 1
    s_cmp_gt_u32 s33, 0x100000
    s_cbranch_scc1 chain_kernel_abort
    s_branch Gq_18_s231
Gq_18_f23p1:
    buffer_load_dwordx4 v[40:43], v2, s[8:11], s40 offen offset:2048 sc1
    s_add_u32 s33, s33, 1
    s_cmp_gt_u32 s33, 0x100000
    s_cbranch_scc1 chain_kernel_abort
    s_branch Gq_18_s32
Gq_18_f3p2:
    buffer_load_dwordx4 v[44:47], v2, s[8:11], s40 offen offset:3072 sc1
    s_add_u32 s33, s33, 1
    s_cmp_gt_u32 s33, 0x100000
    s_cbranch_scc1 chain_kernel_abort
    s_branch Gq_18_s3
Gq_18_redo:
    buffer_load_dwordx4 v[32:35], v2, s[8:11], s40 offen offset:0 sc1
    buffer_load_dwordx4 v[36:39], v2, s[8:11], s40 offen offset:1024 sc1
    buffer_load_dwordx4 v[40:43], v2, s[8:11], s40 offen offset:2048 sc1
    buffer_load_dwordx4 v[44:47], v2, s[8:11], s40 offen offset:3072 sc1
    s_add_u32 s33, s33, 1
    s_cmp_gt_u32 s33, 0x100000
    s_cbranch_scc1 chain_kernel_abort
    s_nop 5
    v_mov_b32 v64, 0
    v_mov_b32 v65, 0
    v_mov_b32 v66, 0
    v_mov_b32 v67, 0
    v_mov_b32 v68, 0
    v_mov_b32 v69, 0
    v_mov_b32 v70, 0
    v_mov_b32 v71, 0
    v_mov_b32 v72, 0
    v_mov_b32 v73, 0
    v_mov_b32 v74, 0
    v_mov_b32 v75, 0
    s_branch Gq_18_s0123
Gq_18_s1230:
    s_waitcnt vmcnt(3)
    v_cmp_eq_u32 vcc, -1, v36
    v_mov_b32_dpp v52, v36 row_ror:8 row_mask:0xf bank_mask:0xf
    v_mov_b32_dpp v53, v37 row_ror:8 row_mask:0xf bank_mask:0xf
    v_mov_b32_dpp v54, v38 row_ror:8 row_mask:0xf bank_mask:0xf
    v_mov_b32_dpp v55, v39 row_ror:8 row_mask:0xf bank_mask:0xf
    s_cbranch_vccnz Gq_18_f1230
    v_smfmac_f32_16x16x64_bf16 v[64:67], v[36:39], a[8:15], v19
    v_smfmac_f32_16x16x64_bf16 v[68:71], v[36:39], a[72:79], v19
Gq_18_s230p1:
    s_waitcnt vmcnt(2)
    v_cmp_eq_u32 vcc, -1, v40
    v_smfmac_f32_16x16x64_bf16 v[64:67], v[52:55], a[40:47], v19
    v_mov_b32_dpp v56, v40 row_ror:8 row_mask:0xf bank_mask:0xf
    v_mov_b32_dpp v57, v41 row_ror:8 row_mask:0xf bank_mask:0xf
    v_smfmac_f32_16x16x64_bf16 v[68:71], v[52:55], a[104:111], v19
    v_mov_b32_dpp v58, v42 row_ror:8 row_mask:0xf bank_mask:0xf
    v_mov_b32_dpp v59, v43 row_ror:8 row_mask:0xf bank_mask:0xf
    s_cbranch_vccnz Gq_18_f230p1
    v_smfmac_f32_16x16x64_bf16 v[64:67], v[40:43], a[16:23], v19
    v_smfmac_f32_16x16x64_bf16 v[68:71], v[40:43], a[80:87], v19
Gq_18_s30p2:
    s_waitcnt vmcnt(1)
    v_cmp_eq_u32 vcc, -1, v44
    v_smfmac_f32_16x16x64_bf16 v[64:67], v[56:59], a[48:55], v19
    v_mov_b32_dpp v60, v44 row_ror:8 row_mask:0xf bank_mask:0xf
    v_mov_b32_dpp v61, v45 row_ror:8 row_mask:0xf bank_mask:0xf
    v_smfmac_f32_16x16x64_bf16 v[68:71], v[56:59], a[112:119], v19
    v_mov_b32_dpp v62, v46 row_ror:8 row_mask:0xf bank_mask:0xf
    v_mov_b32_dpp v63, v47 row_ror:8 row_mask:0xf bank_mask:0xf
    s_cbranch_vccnz Gq_18_f30p2
    v_smfmac_f32_16x16x64_bf16 v[64:67], v[44:47], a[24:31], v19
    v_smfmac_f32_16x16x64_bf16 v[68:71], v[44:47], a[88:95], v19
Gq_18_s0p3:
    s_waitcnt vmcnt(0)
    v_cmp_eq_u32 vcc, -1, v32
    v_smfmac_f32_16x16x64_bf16 v[64:67], v[60:63], a[56:63], v19
    v_mov_b32_dpp v48, v32 row_ror:8 row_mask:0xf bank_mask:0xf
    v_mov_b32_dpp v49, v33 row_ror:8 row_mask:0xf bank_mask:0xf
    v_smfmac_f32_16x16x64_bf16 v[68:71], v[60:63], a[120:127], v19
    v_mov_b32_dpp v50, v34 row_ror:8 row_mask:0xf bank_mask:0xf
    v_mov_b32_dpp v51, v35 row_ror:8 row_mask:0xf bank_mask:0xf
    s_cbranch_vccnz Gq_18_f0p3
    v_smfmac_f32_16x16x64_bf16 v[64:67], v[32:35], a[0:7], v19
    v_smfmac_f32_16x16x64_bf16 v[68:71], v[32:35], a[64:71], v19
    v_smfmac_f32_16x16x64_bf16 v[64:67], v[48:51], a[32:39], v19
    v_smfmac_f32_16x16x64_bf16 v[68:71], v[48:51], a[96:103], v19
    s_branch Gq_18_done
Gq_18_f1230:
    buffer_load_dwordx4 v[36:39], v2, s[8:11], s40 offen offset:1024 sc1
    s_add_u32 s33, s33, 1
    s_cmp_gt_u32 s33, 0x100000
    s_cbranch_scc1 chain_kernel_abort
    s_branch Gq_18_s2301
Gq_18_f230p1:
    buffer_load_dwordx4 v[40:43], v2, s[8:11], s40 offen offset:2048 sc1
    s_add_u32 s33, s33, 1
    s_cmp_gt_u32 s33, 0x100000
    s_cbranch_scc1 chain_kernel_abort
    s_branch Gq_18_s302
Gq_18_f30p2:
    buffer_load_dwordx4 v[44:47], v2, s[8:11], s40 offen offset:3072 sc1
    s_add_u32 s33, s33, 1
    s_cmp_gt_u32 s33, 0x100000
    s_cbranch_scc1 chain_kernel_abort
    s_branch Gq_18_s03
Gq_18_f0p3:
    buffer_load_dwordx4 v[32:35], v2, s[8:11], s40 offen offset:0 sc1
    s_add_u32 s33, s33, 1
    s_cmp_gt_u32 s33, 0x100000
    s_cbranch_scc1 chain_kernel_abort
    s_branch Gq_18_s0
Gq_18_s231:
    s_waitcnt vmcnt(2)
    v_cmp_eq_u32 vcc, -1, v40
    v_mov_b32_dpp v56, v40 row_ror:8 row_mask:0xf bank_mask:0xf
    v_mov_b32_dpp v57, v41 row_ror:8 row_mask:0xf bank_mask:0xf
    v_mov_b32_dpp v58, v42 row_ror:8 row_mask:0xf bank_mask:0xf
    v_mov_b32_dpp v59, v43 row_ror:8 row_mask:0xf bank_mask:0xf
    s_cbranch_vccnz Gq_18_f231
    v_smfmac_f32_16x16x64_bf16 v[64:67], v[40:43], a[16:23], v19
    v_smfmac_f32_16x16x64_bf16 v[68:71], v[40:43], a[80:87], v19
Gq_18_s31p2:
    s_waitcnt vmcnt(1)
    v_cmp_eq_u32 vcc, -1, v44
    v_smfmac_f32_16x16x64_bf16 v[64:67], v[56:59], a[48:55], v19
    v_mov_b32_dpp v60, v44 row_ror:8 row_mask:0xf bank_mask:0xf
    v_mov_b32_dpp v61, v45 row_ror:8 row_mask:0xf bank_mask:0xf
    v_smfmac_f32_16x16x64_bf16 v[68:71], v[56:59], a[112:119], v19
    v_mov_b32_dpp v62, v46 row_ror:8 row_mask:0xf bank_mask:0xf
    v_mov_b32_dpp v63, v47 row_ror:8 row_mask:0xf bank_mask:0xf
    s_cbranch_vccnz Gq_18_f31p2
    v_smfmac_f32_16x16x64_bf16 v[64:67], v[44:47], a[24:31], v19
    v_smfmac_f32_16x16x64_bf16 v[68:71], v[44:47], a[88:95], v19
Gq_18_s1p3:
    s_waitcnt vmcnt(0)
    v_cmp_eq_u32 vcc, -1, v36
    v_smfmac_f32_16x16x64_bf16 v[64:67], v[60:63], a[56:63], v19
    v_mov_b32_dpp v52, v36 row_ror:8 row_mask:0xf bank_mask:0xf
    v_mov_b32_dpp v53, v37 row_ror:8 row_mask:0xf bank_mask:0xf
    v_smfmac_f32_16x16x64_bf16 v[68:71], v[60:63], a[120:127], v19
    v_mov_b32_dpp v54, v38 row_ror:8 row_mask:0xf bank_mask:0xf
    v_mov_b32_dpp v55, v39 row_ror:8 row_mask:0xf bank_mask:0xf
    s_cbranch_vccnz Gq_18_f1p3
    v_smfmac_f32_16x16x64_bf16 v[64:67], v[36:39], a[8:15], v19
    v_smfmac_f32_16x16x64_bf16 v[68:71], v[36:39], a[72:79], v19
    v_smfmac_f32_16x16x64_bf16 v[64:67], v[52:55], a[40:47], v19
    v_smfmac_f32_16x16x64_bf16 v[68:71], v[52:55], a[104:111], v19
    s_branch Gq_18_done
Gq_18_f231:
    buffer_load_dwordx4 v[40:43], v2, s[8:11], s40 offen offset:2048 sc1
    s_add_u32 s33, s33, 1
    s_cmp_gt_u32 s33, 0x100000
    s_cbranch_scc1 chain_kernel_abort
    s_branch Gq_18_s312
Gq_18_f31p2:
    buffer_load_dwordx4 v[44:47], v2, s[8:11], s40 offen offset:3072 sc1
    s_add_u32 s33, s33, 1
    s_cmp_gt_u32 s33, 0x100000
    s_cbranch_scc1 chain_kernel_abort
    s_branch Gq_18_s13
Gq_18_f1p3:
    buffer_load_dwordx4 v[36:39], v2, s[8:11], s40 offen offset:1024 sc1
    s_add_u32 s33, s33, 1
    s_cmp_gt_u32 s33, 0x100000
    s_cbranch_scc1 chain_kernel_abort
    s_branch Gq_18_s1
Gq_18_s32:
    s_waitcnt vmcnt(1)
    v_cmp_eq_u32 vcc, -1, v44
    v_mov_b32_dpp v60, v44 row_ror:8 row_mask:0xf bank_mask:0xf
    v_mov_b32_dpp v61, v45 row_ror:8 row_mask:0xf bank_mask:0xf
    v_mov_b32_dpp v62, v46 row_ror:8 row_mask:0xf bank_mask:0xf
    v_mov_b32_dpp v63, v47 row_ror:8 row_mask:0xf bank_mask:0xf
    s_cbranch_vccnz Gq_18_f32
    v_smfmac_f32_16x16x64_bf16 v[64:67], v[44:47], a[24:31], v19
    v_smfmac_f32_16x16x64_bf16 v[68:71], v[44:47], a[88:95], v19
Gq_18_s2p3:
    s_waitcnt vmcnt(0)
    v_cmp_eq_u32 vcc, -1, v40
    v_smfmac_f32_16x16x64_bf16 v[64:67], v[60:63], a[56:63], v19
    v_mov_b32_dpp v56, v40 row_ror:8 row_mask:0xf bank_mask:0xf
    v_mov_b32_dpp v57, v41 row_ror:8 row_mask:0xf bank_mask:0xf
    v_smfmac_f32_16x16x64_bf16 v[68:71], v[60:63], a[120:127], v19
    v_mov_b32_dpp v58, v42 row_ror:8 row_mask:0xf bank_mask:0xf
    v_mov_b32_dpp v59, v43 row_ror:8 row_mask:0xf bank_mask:0xf
    s_cbranch_vccnz Gq_18_f2p3
    v_smfmac_f32_16x16x64_bf16 v[64:67], v[40:43], a[16:23], v19
    v_smfmac_f32_16x16x64_bf16 v[68:71], v[40:43], a[80:87], v19
    v_smfmac_f32_16x16x64_bf16 v[64:67], v[56:59], a[48:55], v19
    v_smfmac_f32_16x16x64_bf16 v[68:71], v[56:59], a[112:119], v19
    s_branch Gq_18_done
Gq_18_f32:
    buffer_load_dwordx4 v[44:47], v2, s[8:11], s40 offen offset:3072 sc1
    s_add_u32 s33, s33, 1
    s_cmp_gt_u32 s33, 0x100000
    s_cbranch_scc1 chain_kernel_abort
    s_branch Gq_18_s23
Gq_18_f2p3:
    buffer_load_dwordx4 v[40:43], v2, s[8:11], s40 offen offset:2048 sc1
    s_add_u32 s33, s33, 1
    s_cmp_gt_u32 s33, 0x100000
    s_cbranch_scc1 chain_kernel_abort
    s_branch Gq_18_s2
Gq_18_s3:
    s_waitcnt vmcnt(0)
    v_cmp_eq_u32 vcc, -1, v44
    v_mov_b32_dpp v60, v44 row_ror:8 row_mask:0xf bank_mask:0xf
    v_mov_b32_dpp v61, v45 row_ror:8 row_mask:0xf bank_mask:0xf
    v_mov_b32_dpp v62, v46 row_ror:8 row_mask:0xf bank_mask:0xf
    v_mov_b32_dpp v63, v47 row_ror:8 row_mask:0xf bank_mask:0xf
    s_cbranch_vccnz Gq_18_f3
    v_smfmac_f32_16x16x64_bf16 v[64:67], v[44:47], a[24:31], v19
    v_smfmac_f32_16x16x64_bf16 v[68:71], v[44:47], a[88:95], v19
    v_smfmac_f32_16x16x64_bf16 v[64:67], v[60:63], a[56:63], v19
    v_smfmac_f32_16x16x64_bf16 v[68:71], v[60:63], a[120:127], v19
    s_branch Gq_18_done
Gq_18_f3:
    buffer_load_dwordx4 v[44:47], v2, s[8:11], s40 offen offset:3072 sc1
    s_add_u32 s33, s33, 1
    s_cmp_gt_u32 s33, 0x100000
    s_cbranch_scc1 chain_kernel_abort
    s_branch Gq_18_s3
Gq_18_s2301:
    s_waitcnt vmcnt(3)
    v_cmp_eq_u32 vcc, -1, v40
    v_mov_b32_dpp v56, v40 row_ror:8 row_mask:0xf bank_mask:0xf
    v_mov_b32_dpp v57, v41 row_ror:8 row_mask:0xf bank_mask:0xf
    v_mov_b32_dpp v58, v42 row_ror:8 row_mask:0xf bank_mask:0xf
    v_mov_b32_dpp v59, v43 row_ror:8 row_mask:0xf bank_mask:0xf
    s_cbranch_vccnz Gq_18_f2301
    v_smfmac_f32_16x16x64_bf16 v[64:67], v[40:43], a[16:23], v19
    v_smfmac_f32_16x16x64_bf16 v[68:71], v[40:43], a[80:87], v19
Gq_18_s301p2:
    s_waitcnt vmcnt(2)
    v_cmp_eq_u32 vcc, -1, v44
    v_smfmac_f32_16x16x64_bf16 v[64:67], v[56:59], a[48:55], v19
    v_mov_b32_dpp v60, v44 row_ror:8 row_mask:0xf bank_mask:0xf
    v_mov_b32_dpp v61, v45 row_ror:8 row_mask:0xf bank_mask:0xf
    v_smfmac_f32_16x16x64_bf16 v[68:71], v[56:59], a[112:119], v19
    v_mov_b32_dpp v62, v46 row_ror:8 row_mask:0xf bank_mask:0xf
    v_mov_b32_dpp v63, v47 row_ror:8 row_mask:0xf bank_mask:0xf
    s_cbranch_vccnz Gq_18_f301p2
    v_smfmac_f32_16x16x64_bf16 v[64:67], v[44:47], a[24:31], v19
    v_smfmac_f32_16x16x64_bf16 v[68:71], v[44:47], a[88:95], v19
Gq_18_s01p3:
    s_waitcnt vmcnt(1)
    v_cmp_eq_u32 vcc, -1, v32
    v_smfmac_f32_16x16x64_bf16 v[64:67], v[60:63], a[56:63], v19
    v_mov_b32_dpp v48, v32 row_ror:8 row_mask:0xf bank_mask:0xf
    v_mov_b32_dpp v49, v33 row_ror:8 row_mask:0xf bank_mask:0xf
    v_smfmac_f32_16x16x64_bf16 v[68:71], v[60:63], a[120:127], v19
    v_mov_b32_dpp v50, v34 row_ror:8 row_mask:0xf bank_mask:0xf
    v_mov_b32_dpp v51, v35 row_ror:8 row_mask:0xf bank_mask:0xf
    s_cbranch_vccnz Gq_18_f01p3
    v_smfmac_f32_16x16x64_bf16 v[64:67], v[32:35], a[0:7], v19
    v_smfmac_f32_16x16x64_bf16 v[68:71], v[32:35], a[64:71], v19
Gq_18_s1p0:
    s_waitcnt vmcnt(0)
    v_cmp_eq_u32 vcc, -1, v36
    v_smfmac_f32_16x16x64_bf16 v[64:67], v[48:51], a[32:39], v19
    v_mov_b32_dpp v52, v36 row_ror:8 row_mask:0xf bank_mask:0xf
    v_mov_b32_dpp v53, v37 row_ror:8 row_mask:0xf bank_mask:0xf
    v_smfmac_f32_16x16x64_bf16 v[68:71], v[48:51], a[96:103], v19
    v_mov_b32_dpp v54, v38 row_ror:8 row_mask:0xf bank_mask:0xf
    v_mov_b32_dpp v55, v39 row_ror:8 row_mask:0xf bank_mask:0xf
    s_cbranch_vccnz Gq_18_f1p0
    v_smfmac_f32_16x16x64_bf16 v[64:67], v[36:39], a[8:15], v19
    v_smfmac_f32_16x16x64_bf16 v[68:71], v[36:39], a[72:79], v19
    v_smfmac_f32_16x16x64_bf16 v[64:67], v[52:55], a[40:47], v19
    v_smfmac_f32_16x16x64_bf16 v[68:71], v[52:55], a[104:111], v19
    s_branch Gq_18_done
Gq_18_f2301:
    buffer_load_dwordx4 v[40:43], v2, s[8:11], s40 offen offset:2048 sc1
    s_add_u32 s33, s33, 1
    s_cmp_gt_u32 s33, 0x100000
    s_cbranch_scc1 chain_kernel_abort
    s_branch Gq_18_s3012
Gq_18_f301p2:
    buffer_load_dwordx4 v[44:47], v2, s[8:11], s40 offen offset:3072 sc1
    s_add_u32 s33, s33, 1
    s_cmp_gt_u32 s33, 0x100000
    s_cbranch_scc1 chain_kernel_abort
    s_branch Gq_18_s013
Gq_18_f01p3:
    buffer_load_dwordx4 v[32:35], v2, s[8:11], s40 offen offset:0 sc1
    s_add_u32 s33, s33, 1
    s_cmp_gt_u32 s33, 0x100000
    s_cbranch_scc1 chain_kernel_abort
    s_branch Gq_18_s10
Gq_18_f1p0:
    buffer_load_dwordx4 v[36:39], v2, s[8:11], s40 offen offset:1024 sc1
    s_add_u32 s33, s33, 1
    s_cmp_gt_u32 s33, 0x100000
    s_cbranch_scc1 chain_kernel_abort
    s_branch Gq_18_s1
Gq_18_s302:
    s_waitcnt vmcnt(2)
    v_cmp_eq_u32 vcc, -1, v44
    v_mov_b32_dpp v60, v44 row_ror:8 row_mask:0xf bank_mask:0xf
    v_mov_b32_dpp v61, v45 row_ror:8 row_mask:0xf bank_mask:0xf
    v_mov_b32_dpp v62, v46 row_ror:8 row_mask:0xf bank_mask:0xf
    v_mov_b32_dpp v63, v47 row_ror:8 row_mask:0xf bank_mask:0xf
    s_cbranch_vccnz Gq_18_f302
    v_smfmac_f32_16x16x64_bf16 v[64:67], v[44:47], a[24:31], v19
    v_smfmac_f32_16x16x64_bf16 v[68:71], v[44:47], a[88:95], v19
Gq_18_s02p3:
    s_waitcnt vmcnt(1)
    v_cmp_eq_u32 vcc, -1, v32
    v_smfmac_f32_16x16x64_bf16 v[64:67], v[60:63], a[56:63], v19
    v_mov_b32_dpp v48, v32 row_ror:8 row_mask:0xf bank_mask:0xf
    v_mov_b32_dpp v49, v33 row_ror:8 row_mask:0xf bank_mask:0xf
    v_smfmac_f32_16x16x64_bf16 v[68:71], v[60:63], a[120:127], v19
    v_mov_b32_dpp v50, v34 row_ror:8 row_mask:0xf bank_mask:0xf
    v_mov_b32_dpp v51, v35 row_ror:8 row_mask:0xf bank_mask:0xf
    s_cbranch_vccnz Gq_18_f02p3
    v_smfmac_f32_16x16x64_bf16 v[64:67], v[32:35], a[0:7], v19
    v_smfmac_f32_16x16x64_bf16 v[68:71], v[32:35], a[64:71], v19
Gq_18_s2p0:
    s_waitcnt vmcnt(0)
    v_cmp_eq_u32 vcc, -1, v40
    v_smfmac_f32_16x16x64_bf16 v[64:67], v[48:51], a[32:39], v19
    v_mov_b32_dpp v56, v40 row_ror:8 row_mask:0xf bank_mask:0xf
    v_mov_b32_dpp v57, v41 row_ror:8 row_mask:0xf bank_mask:0xf
    v_smfmac_f32_16x16x64_bf16 v[68:71], v[48:51], a[96:103], v19
    v_mov_b32_dpp v58, v42 row_ror:8 row_mask:0xf bank_mask:0xf
    v_mov_b32_dpp v59, v43 row_ror:8 row_mask:0xf bank_mask:0xf
    s_cbranch_vccnz Gq_18_f2p0
    v_smfmac_f32_16x16x64_bf16 v[64:67], v[40:43], a[16:23], v19
    v_smfmac_f32_16x16x64_bf16 v[68:71], v[40:43], a[80:87], v19
    v_smfmac_f32_16x16x64_bf16 v[64:67], v[56:59], a[48:55], v19
    v_smfmac_f32_16x16x64_bf16 v[68:71], v[56:59], a[112:119], v19
    s_branch Gq_18_done
Gq_18_f302:
    buffer_load_dwordx4 v[44:47], v2, s[8:11], s40 offen offset:3072 sc1
    s_add_u32 s33, s33, 1
    s_cmp_gt_u32 s33, 0x100000
    s_cbranch_scc1 chain_kernel_abort
    s_branch Gq_18_s023
Gq_18_f02p3:
    buffer_load_dwordx4 v[32:35], v2, s[8:11], s40 offen offset:0 sc1
    s_add_u32 s33, s33, 1
    s_cmp_gt_u32 s33, 0x100000
    s_cbranch_scc1 chain_kernel_abort
    s_branch Gq_18_s20
Gq_18_f2p0:
    buffer_load_dwordx4 v[40:43], v2, s[8:11], s40 offen offset:2048 sc1
    s_add_u32 s33, s33, 1
    s_cmp_gt_u32 s33, 0x100000
    s_cbranch_scc1 chain_kernel_abort
    s_branch Gq_18_s2
Gq_18_s03:
    s_waitcnt vmcnt(1)
    v_cmp_eq_u32 vcc, -1, v32
    v_mov_b32_dpp v48, v32 row_ror:8 row_mask:0xf bank_mask:0xf
    v_mov_b32_dpp v49, v33 row_ror:8 row_mask:0xf bank_mask:0xf
    v_mov_b32_dpp v50, v34 row_ror:8 row_mask:0xf bank_mask:0xf
    v_mov_b32_dpp v51, v35 row_ror:8 row_mask:0xf bank_mask:0xf
    s_cbranch_vccnz Gq_18_f03
    v_smfmac_f32_16x16x64_bf16 v[64:67], v[32:35], a[0:7], v19
    v_smfmac_f32_16x16x64_bf16 v[68:71], v[32:35], a[64:71], v19
Gq_18_s3p0:
    s_waitcnt vmcnt(0)
    v_cmp_eq_u32 vcc, -1, v44
    v_smfmac_f32_16x16x64_bf16 v[64:67], v[48:51], a[32:39], v19
    v_mov_b32_dpp v60, v44 row_ror:8 row_mask:0xf bank_mask:0xf
    v_mov_b32_dpp v61, v45 row_ror:8 row_mask:0xf bank_mask:0xf
    v_smfmac_f32_16x16x64_bf16 v[68:71], v[48:51], a[96:103], v19
    v_mov_b32_dpp v62, v46 row_ror:8 row_mask:0xf bank_mask:0xf
    v_mov_b32_dpp v63, v47 row_ror:8 row_mask:0xf bank_mask:0xf
    s_cbranch_vccnz Gq_18_f3p0
    v_smfmac_f32_16x16x64_bf16 v[64:67], v[44:47], a[24:31], v19
    v_smfmac_f32_16x16x64_bf16 v[68:71], v[44:47], a[88:95], v19
    v_smfmac_f32_16x16x64_bf16 v[64:67], v[60:63], a[56:63], v19
    v_smfmac_f32_16x16x64_bf16 v[68:71], v[60:63], a[120:127], v19
    s_branch Gq_18_done
Gq_18_f03:
    buffer_load_dwordx4 v[32:35], v2, s[8:11], s40 offen offset:0 sc1
    s_add_u32 s33, s33, 1
    s_cmp_gt_u32 s33, 0x100000
    s_cbranch_scc1 chain_kernel_abort
    s_branch Gq_18_s30
Gq_18_f3p0:
    buffer_load_dwordx4 v[44:47], v2, s[8:11], s40 offen offset:3072 sc1
    s_add_u32 s33, s33, 1
    s_cmp_gt_u32 s33, 0x100000
    s_cbranch_scc1 chain_kernel_abort
    s_branch Gq_18_s3
Gq_18_s0:
    s_waitcnt vmcnt(0)
    v_cmp_eq_u32 vcc, -1, v32
    v_mov_b32_dpp v48, v32 row_ror:8 row_mask:0xf bank_mask:0xf
    v_mov_b32_dpp v49, v33 row_ror:8 row_mask:0xf bank_mask:0xf
    v_mov_b32_dpp v50, v34 row_ror:8 row_mask:0xf bank_mask:0xf
    v_mov_b32_dpp v51, v35 row_ror:8 row_mask:0xf bank_mask:0xf
    s_cbranch_vccnz Gq_18_f0
    v_smfmac_f32_16x16x64_bf16 v[64:67], v[32:35], a[0:7], v19
    v_smfmac_f32_16x16x64_bf16 v[68:71], v[32:35], a[64:71], v19
    v_smfmac_f32_16x16x64_bf16 v[64:67], v[48:51], a[32:39], v19
    v_smfmac_f32_16x16x64_bf16 v[68:71], v[48:51], a[96:103], v19
    s_branch Gq_18_done
Gq_18_f0:
    buffer_load_dwordx4 v[32:35], v2, s[8:11], s40 offen offset:0 sc1
    s_add_u32 s33, s33, 1
    s_cmp_gt_u32 s33, 0x100000
    s_cbranch_scc1 chain_kernel_abort
    s_branch Gq_18_s0
Gq_18_s312:
    s_waitcnt vmcnt(2)
    v_cmp_eq_u32 vcc, -1, v44
    v_mov_b32_dpp v60, v44 row_ror:8 row_mask:0xf bank_mask:0xf
    v_mov_b32_dpp v61, v45 row_ror:8 row_mask:0xf bank_mask:0xf
    v_mov_b32_dpp v62, v46 row_ror:8 row_mask:0xf bank_mask:0xf
    v_mov_b32_dpp v63, v47 row_ror:8 row_mask:0xf bank_mask:0xf
    s_cbranch_vccnz Gq_18_f312
    v_smfmac_f32_16x16x64_bf16 v[64:67], v[44:47], a[24:31], v19
    v_smfmac_f32_16x16x64_bf16 v[68:71], v[44:47], a[88:95], v19
Gq_18_s12p3:
    s_waitcnt vmcnt(1)
    v_cmp_eq_u32 vcc, -1, v36
    v_smfmac_f32_16x16x64_bf16 v[64:67], v[60:63], a[56:63], v19
    v_mov_b32_dpp v52, v36 row_ror:8 row_mask:0xf bank_mask:0xf
    v_mov_b32_dpp v53, v37 row_ror:8 row_mask:0xf bank_mask:0xf
    v_smfmac_f32_16x16x64_bf16 v[68:71], v[60:63], a[120:127], v19
    v_mov_b32_dpp v54, v38 row_ror:8 row_mask:0xf bank_mask:0xf
    v_mov_b32_dpp v55, v39 row_ror:8 row_mask:0xf bank_mask:0xf
    s_cbranch_vccnz Gq_18_f12p3
    v_smfmac_f32_16x16x64_bf16 v[64:67], v[36:39], a[8:15], v19
    v_smfmac_f32_16x16x64_bf16 v[68:71], v[36:39], a[72:79], v19
Gq_18_s2p1:
    s_waitcnt vmcnt(0)
    v_cmp_eq_u32 vcc, -1, v40
    v_smfmac_f32_16x16x64_bf16 v[64:67], v[52:55], a[40:47], v19
    v_mov_b32_dpp v56, v40 row_ror:8 row_mask:0xf bank_mask:0xf
    v_mov_b32_dpp v57, v41 row_ror:8 row_mask:0xf bank_mask:0xf
    v_smfmac_f32_16x16x64_bf16 v[68:71], v[52:55], a[104:111], v19
    v_mov_b32_dpp v58, v42 row_ror:8 row_mask:0xf bank_mask:0xf
    v_mov_b32_dpp v59, v43 row_ror:8 row_mask:0xf bank_mask:0xf
    s_cbranch_vccnz Gq_18_f2p1
    v_smfmac_f32_16x16x64_bf16 v[64:67], v[40:43], a[16:23], v19
    v_smfmac_f32_16x16x64_bf16 v[68:71], v[40:43], a[80:87], v19
    v_smfmac_f32_16x16x64_bf16 v[64:67], v[56:59], a[48:55], v19
    v_smfmac_f32_16x16x64_bf16 v[68:71], v[56:59], a[112:119], v19
    s_branch Gq_18_done
Gq_18_f312:
    buffer_load_dwordx4 v[44:47], v2, s[8:11], s40 offen offset:3072 sc1
    s_add_u32 s33, s33, 1
    s_cmp_gt_u32 s33, 0x100000
    s_cbranch_scc1 chain_kernel_abort
    s_branch Gq_18_s123
Gq_18_f12p3:
    buffer_load_dwordx4 v[36:39], v2, s[8:11], s40 offen offset:1024 sc1
    s_add_u32 s33, s33, 1
    s_cmp_gt_u32 s33, 0x100000
    s_cbranch_scc1 chain_kernel_abort
    s_branch Gq_18_s21
Gq_18_f2p1:
    buffer_load_dwordx4 v[40:43], v2, s[8:11], s40 offen offset:2048 sc1
    s_add_u32 s33, s33, 1
    s_cmp_gt_u32 s33, 0x100000
    s_cbranch_scc1 chain_kernel_abort
    s_branch Gq_18_s2
Gq_18_s13:
    s_waitcnt vmcnt(1)
    v_cmp_eq_u32 vcc, -1, v36
    v_mov_b32_dpp v52, v36 row_ror:8 row_mask:0xf bank_mask:0xf
    v_mov_b32_dpp v53, v37 row_ror:8 row_mask:0xf bank_mask:0xf
    v_mov_b32_dpp v54, v38 row_ror:8 row_mask:0xf bank_mask:0xf
    v_mov_b32_dpp v55, v39 row_ror:8 row_mask:0xf bank_mask:0xf
    s_cbranch_vccnz Gq_18_f13
    v_smfmac_f32_16x16x64_bf16 v[64:67], v[36:39], a[8:15], v19
    v_smfmac_f32_16x16x64_bf16 v[68:71], v[36:39], a[72:79], v19
Gq_18_s3p1:
    s_waitcnt vmcnt(0)
    v_cmp_eq_u32 vcc, -1, v44
    v_smfmac_f32_16x16x64_bf16 v[64:67], v[52:55], a[40:47], v19
    v_mov_b32_dpp v60, v44 row_ror:8 row_mask:0xf bank_mask:0xf
    v_mov_b32_dpp v61, v45 row_ror:8 row_mask:0xf bank_mask:0xf
    v_smfmac_f32_16x16x64_bf16 v[68:71], v[52:55], a[104:111], v19
    v_mov_b32_dpp v62, v46 row_ror:8 row_mask:0xf bank_mask:0xf
    v_mov_b32_dpp v63, v47 row_ror:8 row_mask:0xf bank_mask:0xf
    s_cbranch_vccnz Gq_18_f3p1
    v_smfmac_f32_16x16x64_bf16 v[64:67], v[44:47], a[24:31], v19
    v_smfmac_f32_16x16x64_bf16 v[68:71], v[44:47], a[88:95], v19
    v_smfmac_f32_16x16x64_bf16 v[64:67], v[60:63], a[56:63], v19
    v_smfmac_f32_16x16x64_bf16 v[68:71], v[60:63], a[120:127], v19
    s_branch Gq_18_done
Gq_18_f13:
    buffer_load_dwordx4 v[36:39], v2, s[8:11], s40 offen offset:1024 sc1
    s_add_u32 s33, s33, 1
    s_cmp_gt_u32 s33, 0x100000
    s_cbranch_scc1 chain_kernel_abort
    s_branch Gq_18_s31
Gq_18_f3p1:
    buffer_load_dwordx4 v[44:47], v2, s[8:11], s40 offen offset:3072 sc1
    s_add_u32 s33, s33, 1
    s_cmp_gt_u32 s33, 0x100000
    s_cbranch_scc1 chain_kernel_abort
    s_branch Gq_18_s3
Gq_18_s1:
    s_waitcnt vmcnt(0)
    v_cmp_eq_u32 vcc, -1, v36
    v_mov_b32_dpp v52, v36 row_ror:8 row_mask:0xf bank_mask:0xf
    v_mov_b32_dpp v53, v37 row_ror:8 row_mask:0xf bank_mask:0xf
    v_mov_b32_dpp v54, v38 row_ror:8 row_mask:0xf bank_mask:0xf
    v_mov_b32_dpp v55, v39 row_ror:8 row_mask:0xf bank_mask:0xf
    s_cbranch_vccnz Gq_18_f1
    v_smfmac_f32_16x16x64_bf16 v[64:67], v[36:39], a[8:15], v19
    v_smfmac_f32_16x16x64_bf16 v[68:71], v[36:39], a[72:79], v19
    v_smfmac_f32_16x16x64_bf16 v[64:67], v[52:55], a[40:47], v19
    v_smfmac_f32_16x16x64_bf16 v[68:71], v[52:55], a[104:111], v19
    s_branch Gq_18_done
Gq_18_f1:
    buffer_load_dwordx4 v[36:39], v2, s[8:11], s40 offen offset:1024 sc1
    s_add_u32 s33, s33, 1
    s_cmp_gt_u32 s33, 0x100000
    s_cbranch_scc1 chain_kernel_abort
    s_branch Gq_18_s1
Gq_18_s23:
    s_waitcnt vmcnt(1)
    v_cmp_eq_u32 vcc, -1, v40
    v_mov_b32_dpp v56, v40 row_ror:8 row_mask:0xf bank_mask:0xf
    v_mov_b32_dpp v57, v41 row_ror:8 row_mask:0xf bank_mask:0xf
    v_mov_b32_dpp v58, v42 row_ror:8 row_mask:0xf bank_mask:0xf
    v_mov_b32_dpp v59, v43 row_ror:8 row_mask:0xf bank_mask:0xf
    s_cbranch_vccnz Gq_18_f23
    v_smfmac_f32_16x16x64_bf16 v[64:67], v[40:43], a[16:23], v19
    v_smfmac_f32_16x16x64_bf16 v[68:71], v[40:43], a[80:87], v19
    s_branch Gq_18_s3p2
Gq_18_f23:
    buffer_load_dwordx4 v[40:43], v2, s[8:11], s40 offen offset:2048 sc1
    s_add_u32 s33, s33, 1
    s_cmp_gt_u32 s33, 0x100000
    s_cbranch_scc1 chain_kernel_abort
    s_branch Gq_18_s32
Gq_18_s2:
    s_waitcnt vmcnt(0)
    v_cmp_eq_u32 vcc, -1, v40
    v_mov_b32_dpp v56, v40 row_ror:8 row_mask:0xf bank_mask:0xf
    v_mov_b32_dpp v57, v41 row_ror:8 row_mask:0xf bank_mask:0xf
    v_mov_b32_dpp v58, v42 row_ror:8 row_mask:0xf bank_mask:0xf
    v_mov_b32_dpp v59, v43 row_ror:8 row_mask:0xf bank_mask:0xf
    s_cbranch_vccnz Gq_18_f2
    v_smfmac_f32_16x16x64_bf16 v[64:67], v[40:43], a[16:23], v19
    v_smfmac_f32_16x16x64_bf16 v[68:71], v[40:43], a[80:87], v19
    v_smfmac_f32_16x16x64_bf16 v[64:67], v[56:59], a[48:55], v19
    v_smfmac_f32_16x16x64_bf16 v[68:71], v[56:59], a[112:119], v19
    s_branch Gq_18_done
Gq_18_f2:
    buffer_load_dwordx4 v[40:43], v2, s[8:11], s40 offen offset:2048 sc1
    s_add_u32 s33, s33, 1
    s_cmp_gt_u32 s33, 0x100000
    s_cbranch_scc1 chain_kernel_abort
    s_branch Gq_18_s2
Gq_18_s3012:
    s_waitcnt vmcnt(3)
    v_cmp_eq_u32 vcc, -1, v44
    v_mov_b32_dpp v60, v44 row_ror:8 row_mask:0xf bank_mask:0xf
    v_mov_b32_dpp v61, v45 row_ror:8 row_mask:0xf bank_mask:0xf
    v_mov_b32_dpp v62, v46 row_ror:8 row_mask:0xf bank_mask:0xf
    v_mov_b32_dpp v63, v47 row_ror:8 row_mask:0xf bank_mask:0xf
    s_cbranch_vccnz Gq_18_f3012
    v_smfmac_f32_16x16x64_bf16 v[64:67], v[44:47], a[24:31], v19
    v_smfmac_f32_16x16x64_bf16 v[68:71], v[44:47], a[88:95], v19
Gq_18_s012p3:
    s_waitcnt vmcnt(2)
    v_cmp_eq_u32 vcc, -1, v32
    v_smfmac_f32_16x16x64_bf16 v[64:67], v[60:63], a[56:63], v19
    v_mov_b32_dpp v48, v32 row_ror:8 row_mask:0xf bank_mask:0xf
    v_mov_b32_dpp v49, v33 row_ror:8 row_mask:0xf bank_mask:0xf
    v_smfmac_f32_16x16x64_bf16 v[68:71], v[60:63], a[120:127], v19
    v_mov_b32_dpp v50, v34 row_ror:8 row_mask:0xf bank_mask:0xf
    v_mov_b32_dpp v51, v35 row_ror:8 row_mask:0xf bank_mask:0xf
    s_cbranch_vccnz Gq_18_f012p3
    v_smfmac_f32_16x16x64_bf16 v[64:67], v[32:35], a[0:7], v19
    v_smfmac_f32_16x16x64_bf16 v[68:71], v[32:35], a[64:71], v19
Gq_18_s12p0:
    s_waitcnt vmcnt(1)
    v_cmp_eq_u32 vcc, -1, v36
    v_smfmac_f32_16x16x64_bf16 v[64:67], v[48:51], a[32:39], v19
    v_mov_b32_dpp v52, v36 row_ror:8 row_mask:0xf bank_mask:0xf
    v_mov_b32_dpp v53, v37 row_ror:8 row_mask:0xf bank_mask:0xf
    v_smfmac_f32_16x16x64_bf16 v[68:71], v[48:51], a[96:103], v19
    v_mov_b32_dpp v54, v38 row_ror:8 row_mask:0xf bank_mask:0xf
    v_mov_b32_dpp v55, v39 row_ror:8 row_mask:0xf bank_mask:0xf
    s_cbranch_vccnz Gq_18_f12p0
    v_smfmac_f32_16x16x64_bf16 v[64:67], v[36:39], a[8:15], v19
    v_smfmac_f32_16x16x64_bf16 v[68:71], v[36:39], a[72:79], v19
    s_branch Gq_18_s2p1
Gq_18_f3012:
    buffer_load_dwordx4 v[44:47], v2, s[8:11], s40 offen offset:3072 sc1
    s_add_u32 s33, s33, 1
    s_cmp_gt_u32 s33, 0x100000
    s_cbranch_scc1 chain_kernel_abort
    s_branch Gq_18_s0123
Gq_18_f012p3:
    buffer_load_dwordx4 v[32:35], v2, s[8:11], s40 offen offset:0 sc1
    s_add_u32 s33, s33, 1
    s_cmp_gt_u32 s33, 0x100000
    s_cbranch_scc1 chain_kernel_abort
    s_branch Gq_18_s120
Gq_18_f12p0:
    buffer_load_dwordx4 v[36:39], v2, s[8:11], s40 offen offset:1024 sc1
    s_add_u32 s33, s33, 1
    s_cmp_gt_u32 s33, 0x100000
    s_cbranch_scc1 chain_kernel_abort
    s_branch Gq_18_s21
Gq_18_s013:
    s_waitcnt vmcnt(2)
    v_cmp_eq_u32 vcc, -1, v32
    v_mov_b32_dpp v48, v32 row_ror:8 row_mask:0xf bank_mask:0xf
    v_mov_b32_dpp v49, v33 row_ror:8 row_mask:0xf bank_mask:0xf
    v_mov_b32_dpp v50, v34 row_ror:8 row_mask:0xf bank_mask:0xf
    v_mov_b32_dpp v51, v35 row_ror:8 row_mask:0xf bank_mask:0xf
    s_cbranch_vccnz Gq_18_f013
    v_smfmac_f32_16x16x64_bf16 v[64:67], v[32:35], a[0:7], v19
    v_smfmac_f32_16x16x64_bf16 v[68:71], v[32:35], a[64:71], v19
Gq_18_s13p0:
    s_waitcnt vmcnt(1)
    v_cmp_eq_u32 vcc, -1, v36
    v_smfmac_f32_16x16x64_bf16 v[64:67], v[48:51], a[32:39], v19
    v_mov_b32_dpp v52, v36 row_ror:8 row_mask:0xf bank_mask:0xf
    v_mov_b32_dpp v53, v37 row_ror:8 row_mask:0xf bank_mask:0xf
    v_smfmac_f32_16x16x64_bf16 v[68:71], v[48:51], a[96:103], v19
    v_mov_b32_dpp v54, v38 row_ror:8 row_mask:0xf bank_mask:0xf
    v_mov_b32_dpp v55, v39 row_ror:8 row_mask:0xf bank_mask:0xf
    s_cbranch_vccnz Gq_18_f13p0
    v_smfmac_f32_16x16x64_bf16 v[64:67], v[36:39], a[8:15], v19
    v_smfmac_f32_16x16x64_bf16 v[68:71], v[36:39], a[72:79], v19
    s_branch Gq_18_s3p1
Gq_18_f013:
    buffer_load_dwordx4 v[32:35], v2, s[8:11], s40 offen offset:0 sc1
    s_add_u32 s33, s33, 1
    s_cmp_gt_u32 s33, 0x100000
    s_cbranch_scc1 chain_kernel_abort
    s_branch Gq_18_s130
Gq_18_f13p0:
    buffer_load_dwordx4 v[36:39], v2, s[8:11], s40 offen offset:1024 sc1
    s_add_u32 s33, s33, 1
    s_cmp_gt_u32 s33, 0x100000
    s_cbranch_scc1 chain_kernel_abort
    s_branch Gq_18_s31
Gq_18_s10:
    s_waitcnt vmcnt(1)
    v_cmp_eq_u32 vcc, -1, v36
    v_mov_b32_dpp v52, v36 row_ror:8 row_mask:0xf bank_mask:0xf
    v_mov_b32_dpp v53, v37 row_ror:8 row_mask:0xf bank_mask:0xf
    v_mov_b32_dpp v54, v38 row_ror:8 row_mask:0xf bank_mask:0xf
    v_mov_b32_dpp v55, v39 row_ror:8 row_mask:0xf bank_mask:0xf
    s_cbranch_vccnz Gq_18_f10
    v_smfmac_f32_16x16x64_bf16 v[64:67], v[36:39], a[8:15], v19
    v_smfmac_f32_16x16x64_bf16 v[68:71], v[36:39], a[72:79], v19
Gq_18_s0p1:
    s_waitcnt vmcnt(0)
    v_cmp_eq_u32 vcc, -1, v32
    v_smfmac_f32_16x16x64_bf16 v[64:67], v[52:55], a[40:47], v19
    v_mov_b32_dpp v48, v32 row_ror:8 row_mask:0xf bank_mask:0xf
    v_mov_b32_dpp v49, v33 row_ror:8 row_mask:0xf bank_mask:0xf
    v_smfmac_f32_16x16x64_bf16 v[68:71], v[52:55], a[104:111], v19
    v_mov_b32_dpp v50, v34 row_ror:8 row_mask:0xf bank_mask:0xf
    v_mov_b32_dpp v51, v35 row_ror:8 row_mask:0xf bank_mask:0xf
    s_cbranch_vccnz Gq_18_f0p1
    v_smfmac_f32_16x16x64_bf16 v[64:67], v[32:35], a[0:7], v19
    v_smfmac_f32_16x16x64_bf16 v[68:71], v[32:35], a[64:71], v19
    v_smfmac_f32_16x16x64_bf16 v[64:67], v[48:51], a[32:39], v19
    v_smfmac_f32_16x16x64_bf16 v[68:71], v[48:51], a[96:103], v19
    s_branch Gq_18_done
Gq_18_f10:
    buffer_load_dwordx4 v[36:39], v2, s[8:11], s40 offen offset:1024 sc1
    s_add_u32 s33, s33, 1
    s_cmp_gt_u32 s33, 0x100000
    s_cbranch_scc1 chain_kernel_abort
    s_branch Gq_18_s01
Gq_18_f0p1:
    buffer_load_dwordx4 v[32:35], v2, s[8:11], s40 offen offset:0 sc1
    s_add_u32 s33, s33, 1
    s_cmp_gt_u32 s33, 0x100000
    s_cbranch_scc1 chain_kernel_abort
    s_branch Gq_18_s0
Gq_18_s023:
    s_waitcnt vmcnt(2)
    v_cmp_eq_u32 vcc, -1, v32
    v_mov_b32_dpp v48, v32 row_ror:8 row_mask:0xf bank_mask:0xf
    v_mov_b32_dpp v49, v33 row_ror:8 row_mask:0xf bank_mask:0xf
    v_mov_b32_dpp v50, v34 row_ror:8 row_mask:0xf bank_mask:0xf
    v_mov_b32_dpp v51, v35 row_ror:8 row_mask:0xf bank_mask:0xf
    s_cbranch_vccnz Gq_18_f023
    v_smfmac_f32_16x16x64_bf16 v[64:67], v[32:35], a[0:7], v19
    v_smfmac_f32_16x16x64_bf16 v[68:71], v[32:35], a[64:71], v19
Gq_18_s23p0:
    s_waitcnt vmcnt(1)
    v_cmp_eq_u32 vcc, -1, v40
    v_smfmac_f32_16x16x64_bf16 v[64:67], v[48:51], a[32:39], v19
    v_mov_b32_dpp v56, v40 row_ror:8 row_mask:0xf bank_mask:0xf
    v_mov_b32_dpp v57, v41 row_ror:8 row_mask:0xf bank_mask:0xf
    v_smfmac_f32_16x16x64_bf16 v[68:71], v[48:51], a[96:103], v19
    v_mov_b32_dpp v58, v42 row_ror:8 row_mask:0xf bank_mask:0xf
    v_mov_b32_dpp v59, v43 row_ror:8 row_mask:0xf bank_mask:0xf
    s_cbranch_vccnz Gq_18_f23p0
    v_smfmac_f32_16x16x64_bf16 v[64:67], v[40:43], a[16:23], v19
    v_smfmac_f32_16x16x64_bf16 v[68:71], v[40:43], a[80:87], v19
    s_branch Gq_18_s3p2
Gq_18_f023:
    buffer_load_dwordx4 v[32:35], v2, s[8:11], s40 offen offset:0 sc1
    s_add_u32 s33, s33, 1
    s_cmp_gt_u32 s33, 0x100000
    s_cbranch_scc1 chain_kernel_abort
    s_branch Gq_18_s230
Gq_18_f23p0:
    buffer_load_dwordx4 v[40:43], v2, s[8:11], s40 offen offset:2048 sc1
    s_add_u32 s33, s33, 1
    s_cmp_gt_u32 s33, 0x100000
    s_cbranch_scc1 chain_kernel_abort
    s_branch Gq_18_s32
Gq_18_s20:
    s_waitcnt vmcnt(1)
    v_cmp_eq_u32 vcc, -1, v40
    v_mov_b32_dpp v56, v40 row_ror:8 row_mask:0xf bank_mask:0xf
    v_mov_b32_dpp v57, v41 row_ror:8 row_mask:0xf bank_mask:0xf
    v_mov_b32_dpp v58, v42 row_ror:8 row_mask:0xf bank_mask:0xf
    v_mov_b32_dpp v59, v43 row_ror:8 row_mask:0xf bank_mask:0xf
    s_cbranch_vccnz Gq_18_f20
    v_smfmac_f32_16x16x64_bf16 v[64:67], v[40:43], a[16:23], v19
    v_smfmac_f32_16x16x64_bf16 v[68:71], v[40:43], a[80:87], v19
Gq_18_s0p2:
    s_waitcnt vmcnt(0)
    v_cmp_eq_u32 vcc, -1, v32
    v_smfmac_f32_16x16x64_bf16 v[64:67], v[56:59], a[48:55], v19
    v_mov_b32_dpp v48, v32 row_ror:8 row_mask:0xf bank_mask:0xf
    v_mov_b32_dpp v49, v33 row_ror:8 row_mask:0xf bank_mask:0xf
    v_smfmac_f32_16x16x64_bf16 v[68:71], v[56:59], a[112:119], v19
    v_mov_b32_dpp v50, v34 row_ror:8 row_mask:0xf bank_mask:0xf
    v_mov_b32_dpp v51, v35 row_ror:8 row_mask:0xf bank_mask:0xf
    s_cbranch_vccnz Gq_18_f0p2
    v_smfmac_f32_16x16x64_bf16 v[64:67], v[32:35], a[0:7], v19
    v_smfmac_f32_16x16x64_bf16 v[68:71], v[32:35], a[64:71], v19
    v_smfmac_f32_16x16x64_bf16 v[64:67], v[48:51], a[32:39], v19
    v_smfmac_f32_16x16x64_bf16 v[68:71], v[48:51], a[96:103], v19
    s_branch Gq_18_done
Gq_18_f20:
    buffer_load_dwordx4 v[40:43], v2, s[8:11], s40 offen offset:2048 sc1
    s_add_u32 s33, s33, 1
    s_cmp_gt_u32 s33, 0x100000
    s_cbranch_scc1 chain_kernel_abort
    s_branch Gq_18_s02
Gq_18_f0p2:
    buffer_load_dwordx4 v[32:35], v2, s[8:11], s40 offen offset:0 sc1
    s_add_u32 s33, s33, 1
    s_cmp_gt_u32 s33, 0x100000
    s_cbranch_scc1 chain_kernel_abort
    s_branch Gq_18_s0
Gq_18_s30:
    s_waitcnt vmcnt(1)
    v_cmp_eq_u32 vcc, -1, v44
    v_mov_b32_dpp v60, v44 row_ror:8 row_mask:0xf bank_mask:0xf
    v_mov_b32_dpp v61, v45 row_ror:8 row_mask:0xf bank_mask:0xf
    v_mov_b32_dpp v62, v46 row_ror:8 row_mask:0xf bank_mask:0xf
    v_mov_b32_dpp v63, v47 row_ror:8 row_mask:0xf bank_mask:0xf
    s_cbranch_vccnz Gq_18_f30
    v_smfmac_f32_16x16x64_bf16 v[64:67], v[44:47], a[24:31], v19
    v_smfmac_f32_16x16x64_bf16 v[68:71], v[44:47], a[88:95], v19
    s_branch Gq_18_s0p3
Gq_18_f30:
    buffer_load_dwordx4 v[44:47], v2, s[8:11], s40 offen offset:3072 sc1
    s_add_u32 s33, s33, 1
    s_cmp_gt_u32 s33, 0x100000
    s_cbranch_scc1 chain_kernel_abort
    s_branch Gq_18_s03
Gq_18_s123:
    s_waitcnt vmcnt(2)
    v_cmp_eq_u32 vcc, -1, v36
    v_mov_b32_dpp v52, v36 row_ror:8 row_mask:0xf bank_mask:0xf
    v_mov_b32_dpp v53, v37 row_ror:8 row_mask:0xf bank_mask:0xf
    v_mov_b32_dpp v54, v38 row_ror:8 row_mask:0xf bank_mask:0xf
    v_mov_b32_dpp v55, v39 row_ror:8 row_mask:0xf bank_mask:0xf
    s_cbranch_vccnz Gq_18_f123
    v_smfmac_f32_16x16x64_bf16 v[64:67], v[36:39], a[8:15], v19
    v_smfmac_f32_16x16x64_bf16 v[68:71], v[36:39], a[72:79], v19
    s_branch Gq_18_s23p1
Gq_18_f123:
    buffer_load_dwordx4 v[36:39], v2, s[8:11], s40 offen offset:1024 sc1
    s_add_u32 s33, s33, 1
    s_cmp_gt_u32 s33, 0x100000
    s_cbranch_scc1 chain_kernel_abort
    s_branch Gq_18_s231
Gq_18_s21:
    s_waitcnt vmcnt(1)
    v_cmp_eq_u32 vcc, -1, v40
    v_mov_b32_dpp v56, v40 row_ror:8 row_mask:0xf bank_mask:0xf
    v_mov_b32_dpp v57, v41 row_ror:8 row_mask:0xf bank_mask:0xf
    v_mov_b32_dpp v58, v42 row_ror:8 row_mask:0xf bank_mask:0xf
    v_mov_b32_dpp v59, v43 row_ror:8 row_mask:0xf bank_mask:0xf
    s_cbranch_vccnz Gq_18_f21
    v_smfmac_f32_16x16x64_bf16 v[64:67], v[40:43], a[16:23], v19
    v_smfmac_f32_16x16x64_bf16 v[68:71], v[40:43], a[80:87], v19
Gq_18_s1p2:
    s_waitcnt vmcnt(0)
    v_cmp_eq_u32 vcc, -1, v36
    v_smfmac_f32_16x16x64_bf16 v[64:67], v[56:59], a[48:55], v19
    v_mov_b32_dpp v52, v36 row_ror:8 row_mask:0xf bank_mask:0xf
    v_mov_b32_dpp v53, v37 row_ror:8 row_mask:0xf bank_mask:0xf
    v_smfmac_f32_16x16x64_bf16 v[68:71], v[56:59], a[112:119], v19
    v_mov_b32_dpp v54, v38 row_ror:8 row_mask:0xf bank_mask:0xf
    v_mov_b32_dpp v55, v39 row_ror:8 row_mask:0xf bank_mask:0xf
    s_cbranch_vccnz Gq_18_f1p2
    v_smfmac_f32_16x16x64_bf16 v[64:67], v[36:39], a[8:15], v19
    v_smfmac_f32_16x16x64_bf16 v[68:71], v[36:39], a[72:79], v19
    v_smfmac_f32_16x16x64_bf16 v[64:67], v[52:55], a[40:47], v19
    v_smfmac_f32_16x16x64_bf16 v[68:71], v[52:55], a[104:111], v19
    s_branch Gq_18_done
Gq_18_f21:
    buffer_load_dwordx4 v[40:43], v2, s[8:11], s40 offen offset:2048 sc1
    s_add_u32 s33, s33, 1
    s_cmp_gt_u32 s33, 0x100000
    s_cbranch_scc1 chain_kernel_abort
    s_branch Gq_18_s12
Gq_18_f1p2:
    buffer_load_dwordx4 v[36:39], v2, s[8:11], s40 offen offset:1024 sc1
    s_add_u32 s33, s33, 1
    s_cmp_gt_u32 s33, 0x100000
    s_cbranch_scc1 chain_kernel_abort
    s_branch Gq_18_s1
Gq_18_s31:
    s_waitcnt vmcnt(1)
    v_cmp_eq_u32 vcc, -1, v44
    v_mov_b32_dpp v60, v44 row_ror:8 row_mask:0xf bank_mask:0xf
    v_mov_b32_dpp v61, v45 row_ror:8 row_mask:0xf bank_mask:0xf
    v_mov_b32_dpp v62, v46 row_ror:8 row_mask:0xf bank_mask:0xf
    v_mov_b32_dpp v63, v47 row_ror:8 row_mask:0xf bank_mask:0xf
    s_cbranch_vccnz Gq_18_f31
    v_smfmac_f32_16x16x64_bf16 v[64:67], v[44:47], a[24:31], v19
    v_smfmac_f32_16x16x64_bf16 v[68:71], v[44:47], a[88:95], v19
    s_branch Gq_18_s1p3
Gq_18_f31:
    buffer_load_dwordx4 v[44:47], v2, s[8:11], s40 offen offset:3072 sc1
    s_add_u32 s33, s33, 1
    s_cmp_gt_u32 s33, 0x100000
    s_cbranch_scc1 chain_kernel_abort
    s_branch Gq_18_s13
Gq_18_s120:
    s_waitcnt vmcnt(2)
    v_cmp_eq_u32 vcc, -1, v36
    v_mov_b32_dpp v52, v36 row_ror:8 row_mask:0xf bank_mask:0xf
    v_mov_b32_dpp v53, v37 row_ror:8 row_mask:0xf bank_mask:0xf
    v_mov_b32_dpp v54, v38 row_ror:8 row_mask:0xf bank_mask:0xf
    v_mov_b32_dpp v55, v39 row_ror:8 row_mask:0xf bank_mask:0xf
    s_cbranch_vccnz Gq_18_f120
    v_smfmac_f32_16x16x64_bf16 v[64:67], v[36:39], a[8:15], v19
    v_smfmac_f32_16x16x64_bf16 v[68:71], v[36:39], a[72:79], v19
Gq_18_s20p1:
    s_waitcnt vmcnt(1)
    v_cmp_eq_u32 vcc, -1, v40
    v_smfmac_f32_16x16x64_bf16 v[64:67], v[52:55], a[40:47], v19
    v_mov_b32_dpp v56, v40 row_ror:8 row_mask:0xf bank_mask:0xf
    v_mov_b32_dpp v57, v41 row_ror:8 row_mask:0xf bank_mask:0xf
    v_smfmac_f32_16x16x64_bf16 v[68:71], v[52:55], a[104:111], v19
    v_mov_b32_dpp v58, v42 row_ror:8 row_mask:0xf bank_mask:0xf
    v_mov_b32_dpp v59, v43 row_ror:8 row_mask:0xf bank_mask:0xf
    s_cbranch_vccnz Gq_18_f20p1
    v_smfmac_f32_16x16x64_bf16 v[64:67], v[40:43], a[16:23], v19
    v_smfmac_f32_16x16x64_bf16 v[68:71], v[40:43], a[80:87], v19
    s_branch Gq_18_s0p2
Gq_18_f120:
    buffer_load_dwordx4 v[36:39], v2, s[8:11], s40 offen offset:1024 sc1
    s_add_u32 s33, s33, 1
    s_cmp_gt_u32 s33, 0x100000
    s_cbranch_scc1 chain_kernel_abort
    s_branch Gq_18_s201
Gq_18_f20p1:
    buffer_load_dwordx4 v[40:43], v2, s[8:11], s40 offen offset:2048 sc1
    s_add_u32 s33, s33, 1
    s_cmp_gt_u32 s33, 0x100000
    s_cbranch_scc1 chain_kernel_abort
    s_branch Gq_18_s02
Gq_18_s130:
    s_waitcnt vmcnt(2)
    v_cmp_eq_u32 vcc, -1, v36
    v_mov_b32_dpp v52, v36 row_ror:8 row_mask:0xf bank_mask:0xf
    v_mov_b32_dpp v53, v37 row_ror:8 row_mask:0xf bank_mask:0xf
    v_mov_b32_dpp v54, v38 row_ror:8 row_mask:0xf bank_mask:0xf
    v_mov_b32_dpp v55, v39 row_ror:8 row_mask:0xf bank_mask:0xf
    s_cbranch_vccnz Gq_18_f130
    v_smfmac_f32_16x16x64_bf16 v[64:67], v[36:39], a[8:15], v19
    v_smfmac_f32_16x16x64_bf16 v[68:71], v[36:39], a[72:79], v19
Gq_18_s30p1:
    s_waitcnt vmcnt(1)
    v_cmp_eq_u32 vcc, -1, v44
    v_smfmac_f32_16x16x64_bf16 v[64:67], v[52:55], a[40:47], v19
    v_mov_b32_dpp v60, v44 row_ror:8 row_mask:0xf bank_mask:0xf
    v_mov_b32_dpp v61, v45 row_ror:8 row_mask:0xf bank_mask:0xf
    v_smfmac_f32_16x16x64_bf16 v[68:71], v[52:55], a[104:111], v19
    v_mov_b32_dpp v62, v46 row_ror:8 row_mask:0xf bank_mask:0xf
    v_mov_b32_dpp v63, v47 row_ror:8 row_mask:0xf bank_mask:0xf
    s_cbranch_vccnz Gq_18_f30p1
    v_smfmac_f32_16x16x64_bf16 v[64:67], v[44:47], a[24:31], v19
    v_smfmac_f32_16x16x64_bf16 v[68:71], v[44:47], a[88:95], v19
    s_branch Gq_18_s0p3
Gq_18_f130:
    buffer_load_dwordx4 v[36:39], v2, s[8:11], s40 offen offset:1024 sc1
    s_add_u32 s33, s33, 1
    s_cmp_gt_u32 s33, 0x100000
    s_cbranch_scc1 chain_kernel_abort
    s_branch Gq_18_s301
Gq_18_f30p1:
    buffer_load_dwordx4 v[44:47], v2, s[8:11], s40 offen offset:3072 sc1
    s_add_u32 s33, s33, 1
    s_cmp_gt_u32 s33, 0x100000
    s_cbranch_scc1 chain_kernel_abort
    s_branch Gq_18_s03
Gq_18_s01:
    s_waitcnt vmcnt(1)
    v_cmp_eq_u32 vcc, -1, v32
    v_mov_b32_dpp v48, v32 row_ror:8 row_mask:0xf bank_mask:0xf
    v_mov_b32_dpp v49, v33 row_ror:8 row_mask:0xf bank_mask:0xf
    v_mov_b32_dpp v50, v34 row_ror:8 row_mask:0xf bank_mask:0xf
    v_mov_b32_dpp v51, v35 row_ror:8 row_mask:0xf bank_mask:0xf
    s_cbranch_vccnz Gq_18_f01
    v_smfmac_f32_16x16x64_bf16 v[64:67], v[32:35], a[0:7], v19
    v_smfmac_f32_16x16x64_bf16 v[68:71], v[32:35], a[64:71], v19
    s_branch Gq_18_s1p0
Gq_18_f01:
    buffer_load_dwordx4 v[32:35], v2, s[8:11], s40 offen offset:0 sc1
    s_add_u32 s33, s33, 1
    s_cmp_gt_u32 s33, 0x100000
    s_cbranch_scc1 chain_kernel_abort
    s_branch Gq_18_s10
Gq_18_s230:
    s_waitcnt vmcnt(2)
    v_cmp_eq_u32 vcc, -1, v40
    v_mov_b32_dpp v56, v40 row_ror:8 row_mask:0xf bank_mask:0xf
    v_mov_b32_dpp v57, v41 row_ror:8 row_mask:0xf bank_mask:0xf
    v_mov_b32_dpp v58, v42 row_ror:8 row_mask:0xf bank_mask:0xf
    v_mov_b32_dpp v59, v43 row_ror:8 row_mask:0xf bank_mask:0xf
    s_cbranch_vccnz Gq_18_f230
    v_smfmac_f32_16x16x64_bf16 v[64:67], v[40:43], a[16:23], v19
    v_smfmac_f32_16x16x64_bf16 v[68:71], v[40:43], a[80:87], v19
    s_branch Gq_18_s30p2
Gq_18_f230:
    buffer_load_dwordx4 v[40:43], v2, s[8:11], s40 offen offset:2048 sc1
    s_add_u32 s33, s33, 1
    s_cmp_gt_u32 s33, 0x100000
    s_cbranch_scc1 chain_kernel_abort
    s_branch Gq_18_s302
Gq_18_s02:
    s_waitcnt vmcnt(1)
    v_cmp_eq_u32 vcc, -1, v32
    v_mov_b32_dpp v48, v32 row_ror:8 row_mask:0xf bank_mask:0xf
    v_mov_b32_dpp v49, v33 row_ror:8 row_mask:0xf bank_mask:0xf
    v_mov_b32_dpp v50, v34 row_ror:8 row_mask:0xf bank_mask:0xf
    v_mov_b32_dpp v51, v35 row_ror:8 row_mask:0xf bank_mask:0xf
    s_cbranch_vccnz Gq_18_f02
    v_smfmac_f32_16x16x64_bf16 v[64:67], v[32:35], a[0:7], v19
    v_smfmac_f32_16x16x64_bf16 v[68:71], v[32:35], a[64:71], v19
    s_branch Gq_18_s2p0
Gq_18_f02:
    buffer_load_dwordx4 v[32:35], v2, s[8:11], s40 offen offset:0 sc1
    s_add_u32 s33, s33, 1
    s_cmp_gt_u32 s33, 0x100000
    s_cbranch_scc1 chain_kernel_abort
    s_branch Gq_18_s20
Gq_18_s12:
    s_waitcnt vmcnt(1)
    v_cmp_eq_u32 vcc, -1, v36
    v_mov_b32_dpp v52, v36 row_ror:8 row_mask:0xf bank_mask:0xf
    v_mov_b32_dpp v53, v37 row_ror:8 row_mask:0xf bank_mask:0xf
    v_mov_b32_dpp v54, v38 row_ror:8 row_mask:0xf bank_mask:0xf
    v_mov_b32_dpp v55, v39 row_ror:8 row_mask:0xf bank_mask:0xf
    s_cbranch_vccnz Gq_18_f12
    v_smfmac_f32_16x16x64_bf16 v[64:67], v[36:39], a[8:15], v19
    v_smfmac_f32_16x16x64_bf16 v[68:71], v[36:39], a[72:79], v19
    s_branch Gq_18_s2p1
Gq_18_f12:
    buffer_load_dwordx4 v[36:39], v2, s[8:11], s40 offen offset:1024 sc1
    s_add_u32 s33, s33, 1
    s_cmp_gt_u32 s33, 0x100000
    s_cbranch_scc1 chain_kernel_abort
    s_branch Gq_18_s21
Gq_18_s201:
    s_waitcnt vmcnt(2)
    v_cmp_eq_u32 vcc, -1, v40
    v_mov_b32_dpp v56, v40 row_ror:8 row_mask:0xf bank_mask:0xf
    v_mov_b32_dpp v57, v41 row_ror:8 row_mask:0xf bank_mask:0xf
    v_mov_b32_dpp v58, v42 row_ror:8 row_mask:0xf bank_mask:0xf
    v_mov_b32_dpp v59, v43 row_ror:8 row_mask:0xf bank_mask:0xf
    s_cbranch_vccnz Gq_18_f201
    v_smfmac_f32_16x16x64_bf16 v[64:67], v[40:43], a[16:23], v19
    v_smfmac_f32_16x16x64_bf16 v[68:71], v[40:43], a[80:87], v19
Gq_18_s01p2:
    s_waitcnt vmcnt(1)
    v_cmp_eq_u32 vcc, -1, v32
    v_smfmac_f32_16x16x64_bf16 v[64:67], v[56:59], a[48:55], v19
    v_mov_b32_dpp v48, v32 row_ror:8 row_mask:0xf bank_mask:0xf
    v_mov_b32_dpp v49, v33 row_ror:8 row_mask:0xf bank_mask:0xf
    v_smfmac_f32_16x16x64_bf16 v[68:71], v[56:59], a[112:119], v19
    v_mov_b32_dpp v50, v34 row_ror:8 row_mask:0xf bank_mask:0xf
    v_mov_b32_dpp v51, v35 row_ror:8 row_mask:0xf bank_mask:0xf
    s_cbranch_vccnz Gq_18_f01p2
    v_smfmac_f32_16x16x64_bf16 v[64:67], v[32:35], a[0:7], v19
    v_smfmac_f32_16x16x64_bf16 v[68:71], v[32:35], a[64:71], v19
    s_branch Gq_18_s1p0
Gq_18_f201:
    buffer_load_dwordx4 v[40:43], v2, s[8:11], s40 offen offset:2048 sc1
    s_add_u32 s33, s33, 1
    s_cmp_gt_u32 s33, 0x100000
    s_cbranch_scc1 chain_kernel_abort
    s_branch Gq_18_s012
Gq_18_f01p2:
    buffer_load_dwordx4 v[32:35], v2, s[8:11], s40 offen offset:0 sc1
    s_add_u32 s33, s33, 1
    s_cmp_gt_u32 s33, 0x100000
    s_cbranch_scc1 chain_kernel_abort
    s_branch Gq_18_s10
Gq_18_s301:
    s_waitcnt vmcnt(2)
    v_cmp_eq_u32 vcc, -1, v44
    v_mov_b32_dpp v60, v44 row_ror:8 row_mask:0xf bank_mask:0xf
    v_mov_b32_dpp v61, v45 row_ror:8 row_mask:0xf bank_mask:0xf
    v_mov_b32_dpp v62, v46 row_ror:8 row_mask:0xf bank_mask:0xf
    v_mov_b32_dpp v63, v47 row_ror:8 row_mask:0xf bank_mask:0xf
    s_cbranch_vccnz Gq_18_f301
    v_smfmac_f32_16x16x64_bf16 v[64:67], v[44:47], a[24:31], v19
    v_smfmac_f32_16x16x64_bf16 v[68:71], v[44:47], a[88:95], v19
    s_branch Gq_18_s01p3
Gq_18_f301:
    buffer_load_dwordx4 v[44:47], v2, s[8:11], s40 offen offset:3072 sc1
    s_add_u32 s33, s33, 1
    s_cmp_gt_u32 s33, 0x100000
    s_cbranch_scc1 chain_kernel_abort
    s_branch Gq_18_s013
Gq_18_s012:
    s_waitcnt vmcnt(2)
    v_cmp_eq_u32 vcc, -1, v32
    v_mov_b32_dpp v48, v32 row_ror:8 row_mask:0xf bank_mask:0xf
    v_mov_b32_dpp v49, v33 row_ror:8 row_mask:0xf bank_mask:0xf
    v_mov_b32_dpp v50, v34 row_ror:8 row_mask:0xf bank_mask:0xf
    v_mov_b32_dpp v51, v35 row_ror:8 row_mask:0xf bank_mask:0xf
    s_cbranch_vccnz Gq_18_f012
    v_smfmac_f32_16x16x64_bf16 v[64:67], v[32:35], a[0:7], v19
    v_smfmac_f32_16x16x64_bf16 v[68:71], v[32:35], a[64:71], v19
    s_branch Gq_18_s12p0
Gq_18_f012:
    buffer_load_dwordx4 v[32:35], v2, s[8:11], s40 offen offset:0 sc1
    s_add_u32 s33, s33, 1
    s_cmp_gt_u32 s33, 0x100000
    s_cbranch_scc1 chain_kernel_abort
    s_branch Gq_18_s120
L_sd_19_0_0f:
    s_branch L_sd_19_1_0
L_sd_19_0_1f:
    s_branch L_sd_19_1_1
L_sd_19_0_2f:
    s_branch L_sd_19_1_2
L_sd_19_0_3f:
    s_branch L_sd_19_1_3
L_sd_19_1_0:
    s_waitcnt vmcnt(7)
    v_max3_u32 v20, v164, v165, v166
    v_mfma_f32_16x16x32_bf16 v[88:91], v[164:167], v[164:167], 0
    v_max_u32 v20, v20, v167
    v_cmp_eq_u32 vcc, -1, v20
    v_mfma_f32_16x16x32_bf16 v[84:87], v[120:123], v[164:167], 0
    v_mfma_f32_16x16x32_bf16 v[80:83], v[104:107], v[164:167], 0
    s_cbranch_vccnz L_sd_19_2_0
L_sd_19_1_1:
    s_waitcnt vmcnt(6)
    v_max3_u32 v20, v168, v169, v170
    v_mfma_f32_16x16x32_bf16 v[100:103], v[168:171], v[168:171], v[88:91]
    v_max_u32 v20, v20, v171
    v_cmp_eq_u32 vcc, -1, v20
    v_mfma_f32_16x16x32_bf16 v[96:99], v[124:127], v[168:171], v[84:87]
    v_mfma_f32_16x16x32_bf16 v[92:95], v[108:111], v[168:171], v[80:83]
    s_cbranch_vccnz L_sd_19_2_1
L_sd_19_1_2:
    s_waitcnt vmcnt(5)
    v_max3_u32 v20, v172, v173, v174
    v_mfma_f32_16x16x32_bf16 v[228:231], v[172:175], v[172:175], v[100:103]
    v_max_u32 v20, v20, v175
    v_cmp_eq_u32 vcc, -1, v20
    v_mfma_f32_16x16x32_bf16 v[224:227], v[128:131], v[172:175], v[96:99]
    v_mfma_f32_16x16x32_bf16 v[220:223], v[112:115], v[172:175], v[92:95]
    s_cbranch_vccnz L_sd_19_2_2
L_sd_19_1_3:
    s_waitcnt vmcnt(4)
    v_max3_u32 v20, v176, v177, v178
    v_mfma_f32_16x16x32_bf16 v[188:191], v[176:179], v[176:179], v[228:231]
    v_max_u32 v20, v20, v179
    v_cmp_eq_u32 vcc, -1, v20
    v_mfma_f32_16x16x32_bf16 v[184:187], v[132:135], v[176:179], v[224:227]
    v_mfma_f32_16x16x32_bf16 v[180:183], v[116:119], v[176:179], v[220:223]
    v_mov_b32_dpp v188, v189 row_ror:8 row_mask:0xf bank_mask:0xc
    v_mov_b32_dpp v190, v191 row_ror:8 row_mask:0xf bank_mask:0xc
    s_cbranch_vccnz L_sd_19_2_3
    s_branch L_sd_19
L_sd_19_1_0f:
    s_branch L_sd_19_2_0
L_sd_19_1_1f:
    s_branch L_sd_19_2_1
L_sd_19_1_2f:
    s_branch L_sd_19_2_2
L_sd_19_1_3f:
    s_branch L_sd_19_2_3
L_sd_19_2_0:
    s_waitcnt vmcnt(3)
    v_max3_u32 v20, v32, v33, v34
    v_mfma_f32_16x16x32_bf16 v[88:91], v[32:35], v[32:35], 0
    v_max_u32 v20, v20, v35
    v_cmp_eq_u32 vcc, -1, v20
    v_mfma_f32_16x16x32_bf16 v[84:87], v[120:123], v[32:35], 0
    v_mfma_f32_16x16x32_bf16 v[80:83], v[104:107], v[32:35], 0
    s_cbranch_vccnz L_sd_19_2_0f
L_sd_19_2_1:
    s_waitcnt vmcnt(2)
    v_max3_u32 v20, v36, v37, v38
    v_mfma_f32_16x16x32_bf16 v[100:103], v[36:39], v[36:39], v[88:91]
    v_max_u32 v20, v20, v39
    v_cmp_eq_u32 vcc, -1, v20
    v_mfma_f32_16x16x32_bf16 v[96:99], v[124:127], v[36:39], v[84:87]
    v_mfma_f32_16x16x32_bf16 v[92:95], v[108:111], v[36:39], v[80:83]
    s_cbranch_vccnz L_sd_19_2_1f
L_sd_19_2_2:
    s_waitcnt vmcnt(1)
    v_max3_u32 v20, v40, v41, v42
    v_mfma_f32_16x16x32_bf16 v[228:231], v[40:43], v[40:43], v[100:103]
    v_max_u32 v20, v20, v43
    v_cmp_eq_u32 vcc, -1, v20
    v_mfma_f32_16x16x32_bf16 v[224:227], v[128:131], v[40:43], v[96:99]
    v_mfma_f32_16x16x32_bf16 v[220:223], v[112:115], v[40:43], v[92:95]
    s_cbranch_vccnz L_sd_19_2_2f
L_sd_19_2_3:
    s_waitcnt vmcnt(0)
    v_max3_u32 v20, v44, v45, v46
    v_mfma_f32_16x16x32_bf16 v[188:191], v[44:47], v[44:47], v[228:231]
    v_max_u32 v20, v20, v47
    v_cmp_eq_u32 vcc, -1, v20
    v_mfma_f32_16x16x32_bf16 v[184:187], v[132:135], v[44:47], v[224:227]
    v_mfma_f32_16x16x32_bf16 v[180:183], v[116:119], v[44:47], v[220:223]
    v_mov_b32_dpp v188, v189 row_ror:8 row_mask:0xf bank_mask:0xc
    v_mov_b32_dpp v190, v191 row_ror:8 row_mask:0xf bank_mask:0xc
    s_cbranch_vccnz L_sd_19_2_3f
    s_branch L_sd_19
L_sd_19_2_0f:
    buffer_load_dwordx4 v[148:151], v5, s[8:11], s40 offen offset:0 sc1
    buffer_load_dwordx4 v[152:155], v5, s[8:11], s40 offen offset:1024 sc1
    buffer_load_dwordx4 v[156:159], v5, s[8:11], s40 offen offset:2048 sc1
    buffer_load_dwordx4 v[160:163], v5, s[8:11], s40 offen offset:3072 sc1
    s_add_u32 s33, s33, 1
    s_cmp_gt_u32 s33, 0x100000
    s_cbranch_scc1 chain_kernel_abort
    s_branch L_sd_19_3_0
L_sd_19_2_1f:
    buffer_load_dwordx4 v[152:155], v5, s[8:11], s40 offen offset:1024 sc1
    buffer_load_dwordx4 v[156:159], v5, s[8:11], s40 offen offset:2048 sc1
    buffer_load_dwordx4 v[160:163], v5, s[8:11], s40 offen offset:3072 sc1
    s_add_u32 s33, s33, 1
    s_cmp_gt_u32 s33, 0x100000
    s_cbranch_scc1 chain_kernel_abort
    s_branch L_sd_19_3_1
L_sd_19_2_2f:
    buffer_load_dwordx4 v[156:159], v5, s[8:11], s40 offen offset:2048 sc1
    buffer_load_dwordx4 v[160:163], v5, s[8:11], s40 offen offset:3072 sc1
    s_add_u32 s33, s33, 1
    s_cmp_gt_u32 s33, 0x100000
    s_cbranch_scc1 chain_kernel_abort
    s_branch L_sd_19_3_2
L_sd_19_2_3f:
    buffer_load_dwordx4 v[160:163], v5, s[8:11], s40 offen offset:3072 sc1
    s_add_u32 s33, s33, 1
    s_cmp_gt_u32 s33, 0x100000
    s_cbranch_scc1 chain_kernel_abort
    s_branch L_sd_19_3_3
L_sd_19_3_0:
    s_waitcnt vmcnt(3)
    v_max3_u32 v20, v148, v149, v150
    v_mfma_f32_16x16x32_bf16 v[88:91], v[148:151], v[148:151], 0
    v_max_u32 v20, v20, v151
    v_cmp_eq_u32 vcc, -1, v20
    v_mfma_f32_16x16x32_bf16 v[84:87], v[120:123], v[148:151], 0
    v_mfma_f32_16x16x32_bf16 v[80:83], v[104:107], v[148:151], 0
    s_cbranch_vccnz L_sd_19_3_0f
L_sd_19_3_1:
    s_waitcnt vmcnt(2)
    v_max3_u32 v20, v152, v153, v154
    v_mfma_f32_16x16x32_bf16 v[100:103], v[152:155], v[152:155], v[88:91]
    v_max_u32 v20, v20, v155
    v_cmp_eq_u32 vcc, -1, v20
    v_mfma_f32_16x16x32_bf16 v[96:99], v[124:127], v[152:155], v[84:87]
    v_mfma_f32_16x16x32_bf16 v[92:95], v[108:111], v[152:155], v[80:83]
    s_cbranch_vccnz L_sd_19_3_1f
L_sd_19_3_2:
    s_waitcnt vmcnt(1)
    v_max3_u32 v20, v156, v157, v158
    v_mfma_f32_16x16x32_bf16 v[228:231], v[156:159], v[156:159], v[100:103]
    v_max_u32 v20, v20, v159
    v_cmp_eq_u32 vcc, -1, v20
    v_mfma_f32_16x16x32_bf16 v[224:227], v[128:131], v[156:159], v[96:99]
    v_mfma_f32_16x16x32_bf16 v[220:223], v[112:115], v[156:159], v[92:95]
    s_cbranch_vccnz L_sd_19_3_2f
L_sd_19_3_3:
    s_waitcnt vmcnt(0)
    v_max3_u32 v20, v160, v161, v162
    v_mfma_f32_16x16x32_bf16 v[188:191], v[160:163], v[160:163], v[228:231]
    v_max_u32 v20, v20, v163
    v_cmp_eq_u32 vcc, -1, v20
    v_mfma_f32_16x16x32_bf16 v[184:187], v[132:135], v[160:163], v[224:227]
    v_mfma_f32_16x16x32_bf16 v[180:183], v[116:119], v[160:163], v[220:223]
    v_mov_b32_dpp v188, v189 row_ror:8 row_mask:0xf bank_mask:0xc
    v_mov_b32_dpp v190, v191 row_ror:8 row_mask:0xf bank_mask:0xc
    s_cbranch_vccnz L_sd_19_3_3f
    s_branch L_sd_19
L_sd_19_3_0f:
    buffer_load_dwordx4 v[148:151], v5, s[8:11], s40 offen offset:0 sc1
    buffer_load_dwordx4 v[152:155], v5, s[8:11], s40 offen offset:1024 sc1
    buffer_load_dwordx4 v[156:159], v5, s[8:11], s40 offen offset:2048 sc1
    buffer_load_dwordx4 v[160:163], v5, s[8:11], s40 offen offset:3072 sc1
    s_add_u32 s33, s33, 1
    s_cmp_gt_u32 s33, 0x100000
    s_cbranch_scc1 chain_kernel_abort
    s_branch L_sd_19_3_0
L_sd_19_3_1f:
    buffer_load_dwordx4 v[152:155], v5, s[8:11], s40 offen offset:1024 sc1
    buffer_load_dwordx4 v[156:159], v5, s[8:11], s40 offen offset:2048 sc1
    buffer_load_dwordx4 v[160:163], v5, s[8:11], s40 offen offset:3072 sc1
    s_add_u32 s33, s33, 1
    s_cmp_gt_u32 s33, 0x100000
    s_cbranch_scc1 chain_kernel_abort
    s_branch L_sd_19_3_1
L_sd_19_3_2f:
    buffer_load_dwordx4 v[156:159], v5, s[8:11], s40 offen offset:2048 sc1
    buffer_load_dwordx4 v[160:163], v5, s[8:11], s40 offen offset:3072 sc1
    s_add_u32 s33, s33, 1
    s_cmp_gt_u32 s33, 0x100000
    s_cbranch_scc1 chain_kernel_abort
    s_branch L_sd_19_3_2
L_sd_19_3_3f:
    buffer_load_dwordx4 v[160:163], v5, s[8:11], s40 offen offset:3072 sc1
    s_add_u32 s33, s33, 1
    s_cmp_gt_u32 s33, 0x100000
    s_cbranch_scc1 chain_kernel_abort
    s_branch L_sd_19_3_3
Go_20_f0123:
    buffer_load_dwordx4 v[32:35], v3, s[8:11], s40 offen offset:0 sc1
    s_branch Go_20_s1230
Go_20_f123:
    buffer_load_dwordx4 v[36:39], v3, s[8:11], s40 offen offset:1024 sc1
    s_add_u32 s33, s33, 1
    s_cmp_gt_u32 s33, 0x100000
    s_cbranch_scc1 chain_kernel_abort
    s_branch Go_20_s231
Go_20_f23:
    buffer_load_dwordx4 v[40:43], v3, s[8:11], s40 offen offset:2048 sc1
    s_add_u32 s33, s33, 1
    s_cmp_gt_u32 s33, 0x100000
    s_cbranch_scc1 chain_kernel_abort
    s_branch Go_20_s32
Go_20_f3:
    buffer_load_dwordx4 v[44:47], v3, s[8:11], s40 offen offset:3072 sc1
    s_add_u32 s33, s33, 1
    s_cmp_gt_u32 s33, 0x100000
    s_cbranch_scc1 chain_kernel_abort
    s_branch Go_20_s3
Go_20_redo:
    buffer_load_dwordx4 v[32:35], v3, s[8:11], s40 offen offset:0 sc1
    buffer_load_dwordx4 v[36:39], v3, s[8:11], s40 offen offset:1024 sc1
    buffer_load_dwordx4 v[40:43], v3, s[8:11], s40 offen offset:2048 sc1
    buffer_load_dwordx4 v[44:47], v3, s[8:11], s40 offen offset:3072 sc1
    s_add_u32 s33, s33, 1
    s_cmp_gt_u32 s33, 0x100000
    s_cbranch_scc1 chain_kernel_abort
    s_nop 5
    v_mov_b32 v76, 0
    v_mov_b32 v77, 0
    v_mov_b32 v78, 0
    v_mov_b32 v79, 0
    s_branch Go_20_s0123
Go_20_s1230:
    s_waitcnt vmcnt(3)
    v_cmp_eq_u32 vcc, -1, v36
    v_mov_b32_dpp v52, v36 row_ror:8 row_mask:0xf bank_mask:0xf
    v_mov_b32_dpp v53, v37 row_ror:8 row_mask:0xf bank_mask:0xf
    v_mov_b32_dpp v54, v38 row_ror:8 row_mask:0xf bank_mask:0xf
    v_mov_b32_dpp v55, v39 row_ror:8 row_mask:0xf bank_mask:0xf
    s_cbranch_vccnz Go_20_f1230
    v_smfmac_f32_16x16x64_bf16 v[76:79], v[36:39], a[200:207], v19
    v_smfmac_f32_16x16x64_bf16 v[76:79], v[52:55], a[232:239], v19
Go_20_s230:
    s_waitcnt vmcnt(2)
    v_cmp_eq_u32 vcc, -1, v40
    v_mov_b32_dpp v56, v40 row_ror:8 row_mask:0xf bank_mask:0xf
    v_mov_b32_dpp v57, v41 row_ror:8 row_mask:0xf bank_mask:0xf
    v_mov_b32_dpp v58, v42 row_ror:8 row_mask:0xf bank_mask:0xf
    v_mov_b32_dpp v59, v43 row_ror:8 row_mask:0xf bank_mask:0xf
    s_cbranch_vccnz Go_20_f230
    v_smfmac_f32_16x16x64_bf16 v[76:79], v[40:43], a[208:215], v19
    v_smfmac_f32_16x16x64_bf16 v[76:79], v[56:59], a[240:247], v19
Go_20_s30:
    s_waitcnt vmcnt(1)
    v_cmp_eq_u32 vcc, -1, v44
    v_mov_b32_dpp v60, v44 row_ror:8 row_mask:0xf bank_mask:0xf
    v_mov_b32_dpp v61, v45 row_ror:8 row_mask:0xf bank_mask:0xf
    v_mov_b32_dpp v62, v46 row_ror:8 row_mask:0xf bank_mask:0xf
    v_mov_b32_dpp v63, v47 row_ror:8 row_mask:0xf bank_mask:0xf
    s_cbranch_vccnz Go_20_f30
    v_smfmac_f32_16x16x64_bf16 v[76:79], v[44:47], a[216:223], v19
    v_smfmac_f32_16x16x64_bf16 v[76:79], v[60:63], a[248:255], v19
Go_20_s0:
    s_waitcnt vmcnt(0)
    v_cmp_eq_u32 vcc, -1, v32
    v_mov_b32_dpp v48, v32 row_ror:8 row_mask:0xf bank_mask:0xf
    v_mov_b32_dpp v49, v33 row_ror:8 row_mask:0xf bank_mask:0xf
    v_mov_b32_dpp v50, v34 row_ror:8 row_mask:0xf bank_mask:0xf
    v_mov_b32_dpp v51, v35 row_ror:8 row_mask:0xf bank_mask:0xf
    s_cbranch_vccnz Go_20_f0
    v_smfmac_f32_16x16x64_bf16 v[76:79], v[32:35], a[192:199], v19
    v_smfmac_f32_16x16x64_bf16 v[76:79], v[48:51], a[224:231], v19
    s_branch Go_20_done
Go_20_f1230:
    buffer_load_dwordx4 v[36:39], v3, s[8:11], s40 offen offset:1024 sc1
    s_add_u32 s33, s33, 1
    s_cmp_gt_u32 s33, 0x100000
    s_cbranch_scc1 chain_kernel_abort
    s_branch Go_20_s2301
Go_20_f230:
    buffer_load_dwordx4 v[40:43], v3, s[8:11], s40 offen offset:2048 sc1
    s_add_u32 s33, s33, 1
    s_cmp_gt_u32 s33, 0x100000
    s_cbranch_scc1 chain_kernel_abort
    s_branch Go_20_s302
Go_20_f30:
    buffer_load_dwordx4 v[44:47], v3, s[8:11], s40 offen offset:3072 sc1
    s_add_u32 s33, s33, 1
    s_cmp_gt_u32 s33, 0x100000
    s_cbranch_scc1 chain_kernel_abort
    s_branch Go_20_s03
Go_20_f0:
    buffer_load_dwordx4 v[32:35], v3, s[8:11], s40 offen offset:0 sc1
    s_add_u32 s33, s33, 1
    s_cmp_gt_u32 s33, 0x100000
    s_cbranch_scc1 chain_kernel_abort
    s_branch Go_20_s0
Go_20_s231:
    s_waitcnt vmcnt(2)
    v_cmp_eq_u32 vcc, -1, v40
    v_mov_b32_dpp v56, v40 row_ror:8 row_mask:0xf bank_mask:0xf
    v_mov_b32_dpp v57, v41 row_ror:8 row_mask:0xf bank_mask:0xf
    v_mov_b32_dpp v58, v42 row_ror:8 row_mask:0xf bank_mask:0xf
    v_mov_b32_dpp v59, v43 row_ror:8 row_mask:0xf bank_mask:0xf
    s_cbranch_vccnz Go_20_f231
    v_smfmac_f32_16x16x64_bf16 v[76:79], v[40:43], a[208:215], v19
    v_smfmac_f32_16x16x64_bf16 v[76:79], v[56:59], a[240:247], v19
Go_20_s31:
    s_waitcnt vmcnt(1)
    v_cmp_eq_u32 vcc, -1, v44
    v_mov_b32_dpp v60, v44 row_ror:8 row_mask:0xf bank_mask:0xf
    v_mov_b32_dpp v61, v45 row_ror:8 row_mask:0xf bank_mask:0xf
    v_mov_b32_dpp v62, v46 row_ror:8 row_mask:0xf bank_mask:0xf
    v_mov_b32_dpp v63, v47 row_ror:8 row_mask:0xf bank_mask:0xf
    s_cbranch_vccnz Go_20_f31
    v_smfmac_f32_16x16x64_bf16 v[76:79], v[44:47], a[216:223], v19
    v_smfmac_f32_16x16x64_bf16 v[76:79], v[60:63], a[248:255], v19
Go_20_s1:
    s_waitcnt vmcnt(0)
    v_cmp_eq_u32 vcc, -1, v36
    v_mov_b32_dpp v52, v36 row_ror:8 row_mask:0xf bank_mask:0xf
    v_mov_b32_dpp v53, v37 row_ror:8 row_mask:0xf bank_mask:0xf
    v_mov_b32_dpp v54, v38 row_ror:8 row_mask:0xf bank_mask:0xf
    v_mov_b32_dpp v55, v39 row_ror:8 row_mask:0xf bank_mask:0xf
    s_cbranch_vccnz Go_20_f1
    v_smfmac_f32_16x16x64_bf16 v[76:79], v[36:39], a[200:207], v19
    v_smfmac_f32_16x16x64_bf16 v[76:79], v[52:55], a[232:239], v19
    s_branch Go_20_done
Go_20_f231:
    buffer_load_dwordx4 v[40:43], v3, s[8:11], s40 offen offset:2048 sc1
    s_add_u32 s33, s33, 1
    s_cmp_gt_u32 s33, 0x100000
    s_cbranch_scc1 chain_kernel_abort
    s_branch Go_20_s312
Go_20_f31:
    buffer_load_dwordx4 v[44:47], v3, s[8:11], s40 offen offset:3072 sc1
    s_add_u32 s33, s33, 1
    s_cmp_gt_u32 s33, 0x100000
    s_cbranch_scc1 chain_kernel_abort
    s_branch Go_20_s13
Go_20_f1:
    buffer_load_dwordx4 v[36:39], v3, s[8:11], s40 offen offset:1024 sc1
    s_add_u32 s33, s33, 1
    s_cmp_gt_u32 s33, 0x100000
    s_cbranch_scc1 chain_kernel_abort
    s_branch Go_20_s1
Go_20_s32:
    s_waitcnt vmcnt(1)
    v_cmp_eq_u32 vcc, -1, v44
    v_mov_b32_dpp v60, v44 row_ror:8 row_mask:0xf bank_mask:0xf
    v_mov_b32_dpp v61, v45 row_ror:8 row_mask:0xf bank_mask:0xf
    v_mov_b32_dpp v62, v46 row_ror:8 row_mask:0xf bank_mask:0xf
    v_mov_b32_dpp v63, v47 row_ror:8 row_mask:0xf bank_mask:0xf
    s_cbranch_vccnz Go_20_f32
    v_smfmac_f32_16x16x64_bf16 v[76:79], v[44:47], a[216:223], v19
    v_smfmac_f32_16x16x64_bf16 v[76:79], v[60:63], a[248:255], v19
Go_20_s2:
    s_waitcnt vmcnt(0)
    v_cmp_eq_u32 vcc, -1, v40
    v_mov_b32_dpp v56, v40 row_ror:8 row_mask:0xf bank_mask:0xf
    v_mov_b32_dpp v57, v41 row_ror:8 row_mask:0xf bank_mask:0xf
    v_mov_b32_dpp v58, v42 row_ror:8 row_mask:0xf bank_mask:0xf
    v_mov_b32_dpp v59, v43 row_ror:8 row_mask:0xf bank_mask:0xf
    s_cbranch_vccnz Go_20_f2
    v_smfmac_f32_16x16x64_bf16 v[76:79], v[40:43], a[208:215], v19
    v_smfmac_f32_16x16x64_bf16 v[76:79], v[56:59], a[240:247], v19
    s_branch Go_20_done
Go_20_f32:
    buffer_load_dwordx4 v[44:47], v3, s[8:11], s40 offen offset:3072 sc1
    s_add_u32 s33, s33, 1
    s_cmp_gt_u32 s33, 0x100000
    s_cbranch_scc1 chain_kernel_abort
    s_branch Go_20_s23
Go_20_f2:
    buffer_load_dwordx4 v[40:43], v3, s[8:11], s40 offen offset:2048 sc1
    s_add_u32 s33, s33, 1
    s_cmp_gt_u32 s33, 0x100000
    s_cbranch_scc1 chain_kernel_abort
    s_branch Go_20_s2
Go_20_s2301:
    s_waitcnt vmcnt(3)
    v_cmp_eq_u32 vcc, -1, v40
    v_mov_b32_dpp v56, v40 row_ror:8 row_mask:0xf bank_mask:0xf
    v_mov_b32_dpp v57, v41 row_ror:8 row_mask:0xf bank_mask:0xf
    v_mov_b32_dpp v58, v42 row_ror:8 row_mask:0xf bank_mask:0xf
    v_mov_b32_dpp v59, v43 row_ror:8 row_mask:0xf bank_mask:0xf
    s_cbranch_vccnz Go_20_f2301
    v_smfmac_f32_16x16x64_bf16 v[76:79], v[40:43], a[208:215], v19
    v_smfmac_f32_16x16x64_bf16 v[76:79], v[56:59], a[240:247], v19
Go_20_s301:
    s_waitcnt vmcnt(2)
    v_cmp_eq_u32 vcc, -1, v44
    v_mov_b32_dpp v60, v44 row_ror:8 row_mask:0xf bank_mask:0xf
    v_mov_b32_dpp v61, v45 row_ror:8 row_mask:0xf bank_mask:0xf
    v_mov_b32_dpp v62, v46 row_ror:8 row_mask:0xf bank_mask:0xf
    v_mov_b32_dpp v63, v47 row_ror:8 row_mask:0xf bank_mask:0xf
    s_cbranch_vccnz Go_20_f301
    v_smfmac_f32_16x16x64_bf16 v[76:79], v[44:47], a[216:223], v19
    v_smfmac_f32_16x16x64_bf16 v[76:79], v[60:63], a[248:255], v19
Go_20_s01:
    s_waitcnt vmcnt(1)
    v_cmp_eq_u32 vcc, -1, v32
    v_mov_b32_dpp v48, v32 row_ror:8 row_mask:0xf bank_mask:0xf
    v_mov_b32_dpp v49, v33 row_ror:8 row_mask:0xf bank_mask:0xf
    v_mov_b32_dpp v50, v34 row_ror:8 row_mask:0xf bank_mask:0xf
    v_mov_b32_dpp v51, v35 row_ror:8 row_mask:0xf bank_mask:0xf
    s_cbranch_vccnz Go_20_f01
    v_smfmac_f32_16x16x64_bf16 v[76:79], v[32:35], a[192:199], v19
    v_smfmac_f32_16x16x64_bf16 v[76:79], v[48:51], a[224:231], v19
    s_branch Go_20_s1
Go_20_f2301:
    buffer_load_dwordx4 v[40:43], v3, s[8:11], s40 offen offset:2048 sc1
    s_add_u32 s33, s33, 1
    s_cmp_gt_u32 s33, 0x100000
    s_cbranch_scc1 chain_kernel_abort
    s_branch Go_20_s3012
Go_20_f301:
    buffer_load_dwordx4 v[44:47], v3, s[8:11], s40 offen offset:3072 sc1
    s_add_u32 s33, s33, 1
    s_cmp_gt_u32 s33, 0x100000
    s_cbranch_scc1 chain_kernel_abort
    s_branch Go_20_s013
Go_20_f01:
    buffer_load_dwordx4 v[32:35], v3, s[8:11], s40 offen offset:0 sc1
    s_add_u32 s33, s33, 1
    s_cmp_gt_u32 s33, 0x100000
    s_cbranch_scc1 chain_kernel_abort
    s_branch Go_20_s10
Go_20_s302:
    s_waitcnt vmcnt(2)
    v_cmp_eq_u32 vcc, -1, v44
    v_mov_b32_dpp v60, v44 row_ror:8 row_mask:0xf bank_mask:0xf
    v_mov_b32_dpp v61, v45 row_ror:8 row_mask:0xf bank_mask:0xf
    v_mov_b32_dpp v62, v46 row_ror:8 row_mask:0xf bank_mask:0xf
    v_mov_b32_dpp v63, v47 row_ror:8 row_mask:0xf bank_mask:0xf
    s_cbranch_vccnz Go_20_f302
    v_smfmac_f32_16x16x64_bf16 v[76:79], v[44:47], a[216:223], v19
    v_smfmac_f32_16x16x64_bf16 v[76:79], v[60:63], a[248:255], v19
Go_20_s02:
    s_waitcnt vmcnt(1)
    v_cmp_eq_u32 vcc, -1, v32
    v_mov_b32_dpp v48, v32 row_ror:8 row_mask:0xf bank_mask:0xf
    v_mov_b32_dpp v49, v33 row_ror:8 row_mask:0xf bank_mask:0xf
    v_mov_b32_dpp v50, v34 row_ror:8 row_mask:0xf bank_mask:0xf
    v_mov_b32_dpp v51, v35 row_ror:8 row_mask:0xf bank_mask:0xf
    s_cbranch_vccnz Go_20_f02
    v_smfmac_f32_16x16x64_bf16 v[76:79], v[32:35], a[192:199], v19
    v_smfmac_f32_16x16x64_bf16 v[76:79], v[48:51], a[224:231], v19
    s_branch Go_20_s2
Go_20_f302:
    buffer_load_dwordx4 v[44:47], v3, s[8:11], s40 offen offset:3072 sc1
    s_add_u32 s33, s33, 1
    s_cmp_gt_u32 s33, 0x100000
    s_cbranch_scc1 chain_kernel_abort
    s_branch Go_20_s023
Go_20_f02:
    buffer_load_dwordx4 v[32:35], v3, s[8:11], s40 offen offset:0 sc1
    s_add_u32 s33, s33, 1
    s_cmp_gt_u32 s33, 0x100000
    s_cbranch_scc1 chain_kernel_abort
    s_branch Go_20_s20
Go_20_s03:
    s_waitcnt vmcnt(1)
    v_cmp_eq_u32 vcc, -1, v32
    v_mov_b32_dpp v48, v32 row_ror:8 row_mask:0xf bank_mask:0xf
    v_mov_b32_dpp v49, v33 row_ror:8 row_mask:0xf bank_mask:0xf
    v_mov_b32_dpp v50, v34 row_ror:8 row_mask:0xf bank_mask:0xf
    v_mov_b32_dpp v51, v35 row_ror:8 row_mask:0xf bank_mask:0xf
    s_cbranch_vccnz Go_20_f03
    v_smfmac_f32_16x16x64_bf16 v[76:79], v[32:35], a[192:199], v19
    v_smfmac_f32_16x16x64_bf16 v[76:79], v[48:51], a[224:231], v19
    s_branch Go_20_s3
Go_20_f03:
    buffer_load_dwordx4 v[32:35], v3, s[8:11], s40 offen offset:0 sc1
    s_add_u32 s33, s33, 1
    s_cmp_gt_u32 s33, 0x100000
    s_cbranch_scc1 chain_kernel_abort
    s_branch Go_20_s30
Go_20_s312:
    s_waitcnt vmcnt(2)
    v_cmp_eq_u32 vcc, -1, v44
    v_mov_b32_dpp v60, v44 row_ror:8 row_mask:0xf bank_mask:0xf
    v_mov_b32_dpp v61, v45 row_ror:8 row_mask:0xf bank_mask:0xf
    v_mov_b32_dpp v62, v46 row_ror:8 row_mask:0xf bank_mask:0xf
    v_mov_b32_dpp v63, v47 row_ror:8 row_mask:0xf bank_mask:0xf
    s_cbranch_vccnz Go_20_f312
    v_smfmac_f32_16x16x64_bf16 v[76:79], v[44:47], a[216:223], v19
    v_smfmac_f32_16x16x64_bf16 v[76:79], v[60:63], a[248:255], v19
Go_20_s12:
    s_waitcnt vmcnt(1)
    v_cmp_eq_u32 vcc, -1, v36
    v_mov_b32_dpp v52, v36 row_ror:8 row_mask:0xf bank_mask:0xf
    v_mov_b32_dpp v53, v37 row_ror:8 row_mask:0xf bank_mask:0xf
    v_mov_b32_dpp v54, v38 row_ror:8 row_mask:0xf bank_mask:0xf
    v_mov_b32_dpp v55, v39 row_ror:8 row_mask:0xf bank_mask:0xf
    s_cbranch_vccnz Go_20_f12
    v_smfmac_f32_16x16x64_bf16 v[76:79], v[36:39], a[200:207], v19
    v_smfmac_f32_16x16x64_bf16 v[76:79], v[52:55], a[232:239], v19
    s_branch Go_20_s2
Go_20_f312:
    buffer_load_dwordx4 v[44:47], v3, s[8:11], s40 offen offset:3072 sc1
    s_add_u32 s33, s33, 1
    s_cmp_gt_u32 s33, 0x100000
    s_cbranch_scc1 chain_kernel_abort
    s_branch Go_20_s123
Go_20_f12:
    buffer_load_dwordx4 v[36:39], v3, s[8:11], s40 offen offset:1024 sc1
    s_add_u32 s33, s33, 1
    s_cmp_gt_u32 s33, 0x100000
    s_cbranch_scc1 chain_kernel_abort
    s_branch Go_20_s21
Go_20_s13:
    s_waitcnt vmcnt(1)
    v_cmp_eq_u32 vcc, -1, v36
    v_mov_b32_dpp v52, v36 row_ror:8 row_mask:0xf bank_mask:0xf
    v_mov_b32_dpp v53, v37 row_ror:8 row_mask:0xf bank_mask:0xf
    v_mov_b32_dpp v54, v38 row_ror:8 row_mask:0xf bank_mask:0xf
    v_mov_b32_dpp v55, v39 row_ror:8 row_mask:0xf bank_mask:0xf
    s_cbranch_vccnz Go_20_f13
    v_smfmac_f32_16x16x64_bf16 v[76:79], v[36:39], a[200:207], v19
    v_smfmac_f32_16x16x64_bf16 v[76:79], v[52:55], a[232:239], v19
    s_branch Go_20_s3
Go_20_f13:
    buffer_load_dwordx4 v[36:39], v3, s[8:11], s40 offen offset:1024 sc1
    s_add_u32 s33, s33, 1
    s_cmp_gt_u32 s33, 0x100000
    s_cbranch_scc1 chain_kernel_abort
    s_branch Go_20_s31
Go_20_s3012:
    s_waitcnt vmcnt(3)
    v_cmp_eq_u32 vcc, -1, v44
    v_mov_b32_dpp v60, v44 row_ror:8 row_mask:0xf bank_mask:0xf
    v_mov_b32_dpp v61, v45 row_ror:8 row_mask:0xf bank_mask:0xf
    v_mov_b32_dpp v62, v46 row_ror:8 row_mask:0xf bank_mask:0xf
    v_mov_b32_dpp v63, v47 row_ror:8 row_mask:0xf bank_mask:0xf
    s_cbranch_vccnz Go_20_f3012
    v_smfmac_f32_16x16x64_bf16 v[76:79], v[44:47], a[216:223], v19
    v_smfmac_f32_16x16x64_bf16 v[76:79], v[60:63], a[248:255], v19
Go_20_s012:
    s_waitcnt vmcnt(2)
    v_cmp_eq_u32 vcc, -1, v32
    v_mov_b32_dpp v48, v32 row_ror:8 row_mask:0xf bank_mask:0xf
    v_mov_b32_dpp v49, v33 row_ror:8 row_mask:0xf bank_mask:0xf
    v_mov_b32_dpp v50, v34 row_ror:8 row_mask:0xf bank_mask:0xf
    v_mov_b32_dpp v51, v35 row_ror:8 row_mask:0xf bank_mask:0xf
    s_cbranch_vccnz Go_20_f012
    v_smfmac_f32_16x16x64_bf16 v[76:79], v[32:35], a[192:199], v19
    v_smfmac_f32_16x16x64_bf16 v[76:79], v[48:51], a[224:231], v19
    s_branch Go_20_s12
Go_20_f3012:
    buffer_load_dwordx4 v[44:47], v3, s[8:11], s40 offen offset:3072 sc1
    s_add_u32 s33, s33, 1
    s_cmp_gt_u32 s33, 0x100000
    s_cbranch_scc1 chain_kernel_abort
    s_branch Go_20_s0123
Go_20_f012:
    buffer_load_dwordx4 v[32:35], v3, s[8:11], s40 offen offset:0 sc1
    s_add_u32 s33, s33, 1
    s_cmp_gt_u32 s33, 0x100000
    s_cbranch_scc1 chain_kernel_abort
    s_branch Go_20_s120
Go_20_s013:
    s_waitcnt vmcnt(2)
    v_cmp_eq_u32 vcc, -1, v32
    v_mov_b32_dpp v48, v32 row_ror:8 row_mask:0xf bank_mask:0xf
    v_mov_b32_dpp v49, v33 row_ror:8 row_mask:0xf bank_mask:0xf
    v_mov_b32_dpp v50, v34 row_ror:8 row_mask:0xf bank_mask:0xf
    v_mov_b32_dpp v51, v35 row_ror:8 row_mask:0xf bank_mask:0xf
    s_cbranch_vccnz Go_20_f013
    v_smfmac_f32_16x16x64_bf16 v[76:79], v[32:35], a[192:199], v19
    v_smfmac_f32_16x16x64_bf16 v[76:79], v[48:51], a[224:231], v19
    s_branch Go_20_s13
Go_20_f013:
    buffer_load_dwordx4 v[32:35], v3, s[8:11], s40 offen offset:0 sc1
    s_add_u32 s33, s33, 1
    s_cmp_gt_u32 s33, 0x100000
    s_cbranch_scc1 chain_kernel_abort
    s_branch Go_20_s130
Go_20_s10:
    s_waitcnt vmcnt(1)
    v_cmp_eq_u32 vcc, -1, v36
    v_mov_b32_dpp v52, v36 row_ror:8 row_mask:0xf bank_mask:0xf
    v_mov_b32_dpp v53, v37 row_ror:8 row_mask:0xf bank_mask:0xf
    v_mov_b32_dpp v54, v38 row_ror:8 row_mask:0xf bank_mask:0xf
    v_mov_b32_dpp v55, v39 row_ror:8 row_mask:0xf bank_mask:0xf
    s_cbranch_vccnz Go_20_f10
    v_smfmac_f32_16x16x64_bf16 v[76:79], v[36:39], a[200:207], v19
    v_smfmac_f32_16x16x64_bf16 v[76:79], v[52:55], a[232:239], v19
    s_branch Go_20_s0
Go_20_f10:
    buffer_load_dwordx4 v[36:39], v3, s[8:11], s40 offen offset:1024 sc1
    s_add_u32 s33, s33, 1
    s_cmp_gt_u32 s33, 0x100000
    s_cbranch_scc1 chain_kernel_abort
    s_branch Go_20_s01
Go_20_s023:
    s_waitcnt vmcnt(2)
    v_cmp_eq_u32 vcc, -1, v32
    v_mov_b32_dpp v48, v32 row_ror:8 row_mask:0xf bank_mask:0xf
    v_mov_b32_dpp v49, v33 row_ror:8 row_mask:0xf bank_mask:0xf
    v_mov_b32_dpp v50, v34 row_ror:8 row_mask:0xf bank_mask:0xf
    v_mov_b32_dpp v51, v35 row_ror:8 row_mask:0xf bank_mask:0xf
    s_cbranch_vccnz Go_20_f023
    v_smfmac_f32_16x16x64_bf16 v[76:79], v[32:35], a[192:199], v19
    v_smfmac_f32_16x16x64_bf16 v[76:79], v[48:51], a[224:231], v19
    s_branch Go_20_s23
Go_20_f023:
    buffer_load_dwordx4 v[32:35], v3, s[8:11], s40 offen offset:0 sc1
    s_add_u32 s33, s33, 1
    s_cmp_gt_u32 s33, 0x100000
    s_cbranch_scc1 chain_kernel_abort
    s_branch Go_20_s230
Go_20_s20:
    s_waitcnt vmcnt(1)
    v_cmp_eq_u32 vcc, -1, v40
    v_mov_b32_dpp v56, v40 row_ror:8 row_mask:0xf bank_mask:0xf
    v_mov_b32_dpp v57, v41 row_ror:8 row_mask:0xf bank_mask:0xf
    v_mov_b32_dpp v58, v42 row_ror:8 row_mask:0xf bank_mask:0xf
    v_mov_b32_dpp v59, v43 row_ror:8 row_mask:0xf bank_mask:0xf
    s_cbranch_vccnz Go_20_f20
    v_smfmac_f32_16x16x64_bf16 v[76:79], v[40:43], a[208:215], v19
    v_smfmac_f32_16x16x64_bf16 v[76:79], v[56:59], a[240:247], v19
    s_branch Go_20_s0
Go_20_f20:
    buffer_load_dwordx4 v[40:43], v3, s[8:11], s40 offen offset:2048 sc1
    s_add_u32 s33, s33, 1
    s_cmp_gt_u32 s33, 0x100000
    s_cbranch_scc1 chain_kernel_abort
    s_branch Go_20_s02
Go_20_s21:
    s_waitcnt vmcnt(1)
    v_cmp_eq_u32 vcc, -1, v40
    v_mov_b32_dpp v56, v40 row_ror:8 row_mask:0xf bank_mask:0xf
    v_mov_b32_dpp v57, v41 row_ror:8 row_mask:0xf bank_mask:0xf
    v_mov_b32_dpp v58, v42 row_ror:8 row_mask:0xf bank_mask:0xf
    v_mov_b32_dpp v59, v43 row_ror:8 row_mask:0xf bank_mask:0xf
    s_cbranch_vccnz Go_20_f21
    v_smfmac_f32_16x16x64_bf16 v[76:79], v[40:43], a[208:215], v19
    v_smfmac_f32_16x16x64_bf16 v[76:79], v[56:59], a[240:247], v19
    s_branch Go_20_s1
Go_20_f21:
    buffer_load_dwordx4 v[40:43], v3, s[8:11], s40 offen offset:2048 sc1
    s_add_u32 s33, s33, 1
    s_cmp_gt_u32 s33, 0x100000
    s_cbranch_scc1 chain_kernel_abort
    s_branch Go_20_s12
Go_20_s120:
    s_waitcnt vmcnt(2)
    v_cmp_eq_u32 vcc, -1, v36
    v_mov_b32_dpp v52, v36 row_ror:8 row_mask:0xf bank_mask:0xf
    v_mov_b32_dpp v53, v37 row_ror:8 row_mask:0xf bank_mask:0xf
    v_mov_b32_dpp v54, v38 row_ror:8 row_mask:0xf bank_mask:0xf
    v_mov_b32_dpp v55, v39 row_ror:8 row_mask:0xf bank_mask:0xf
    s_cbranch_vccnz Go_20_f120
    v_smfmac_f32_16x16x64_bf16 v[76:79], v[36:39], a[200:207], v19
    v_smfmac_f32_16x16x64_bf16 v[76:79], v[52:55], a[232:239], v19
    s_branch Go_20_s20
Go_20_f120:
    buffer_load_dwordx4 v[36:39], v3, s[8:11], s40 offen offset:1024 sc1
    s_add_u32 s33, s33, 1
    s_cmp_gt_u32 s33, 0x100000
    s_cbranch_scc1 chain_kernel_abort
    s_branch Go_20_s201
Go_20_s130:
    s_waitcnt vmcnt(2)
    v_cmp_eq_u32 vcc, -1, v36
    v_mov_b32_dpp v52, v36 row_ror:8 row_mask:0xf bank_mask:0xf
    v_mov_b32_dpp v53, v37 row_ror:8 row_mask:0xf bank_mask:0xf
    v_mov_b32_dpp v54, v38 row_ror:8 row_mask:0xf bank_mask:0xf
    v_mov_b32_dpp v55, v39 row_ror:8 row_mask:0xf bank_mask:0xf
    s_cbranch_vccnz Go_20_f130
    v_smfmac_f32_16x16x64_bf16 v[76:79], v[36:39], a[200:207], v19
    v_smfmac_f32_16x16x64_bf16 v[76:79], v[52:55], a[232:239], v19
    s_branch Go_20_s30
Go_20_f130:
    buffer_load_dwordx4 v[36:39], v3, s[8:11], s40 offen offset:1024 sc1
    s_add_u32 s33, s33, 1
    s_cmp_gt_u32 s33, 0x100000
    s_cbranch_scc1 chain_kernel_abort
    s_branch Go_20_s301
Go_20_s201:
    s_waitcnt vmcnt(2)
    v_cmp_eq_u32 vcc, -1, v40
    v_mov_b32_dpp v56, v40 row_ror:8 row_mask:0xf bank_mask:0xf
    v_mov_b32_dpp v57, v41 row_ror:8 row_mask:0xf bank_mask:0xf
    v_mov_b32_dpp v58, v42 row_ror:8 row_mask:0xf bank_mask:0xf
    v_mov_b32_dpp v59, v43 row_ror:8 row_mask:0xf bank_mask:0xf
    s_cbranch_vccnz Go_20_f201
    v_smfmac_f32_16x16x64_bf16 v[76:79], v[40:43], a[208:215], v19
    v_smfmac_f32_16x16x64_bf16 v[76:79], v[56:59], a[240:247], v19
    s_branch Go_20_s01
Go_20_f201:
    buffer_load_dwordx4 v[40:43], v3, s[8:11], s40 offen offset:2048 sc1
    s_add_u32 s33, s33, 1
    s_cmp_gt_u32 s33, 0x100000
    s_cbranch_scc1 chain_kernel_abort
    s_branch Go_20_s012
L_pf_22:
    s_mov_b64 exec, -1
    buffer_load_short_d16_hi v220, v9, s[8:11], s43 offen sc1
    buffer_load_short_d16_hi v221, v10, s[8:11], s43 offen sc1
    buffer_load_short_d16_hi v222, v11, s[8:11], s43 offen sc1
    s_add_u32 s33, s33, 1
    s_cmp_gt_u32 s33, 0x100000
    s_cbranch_scc1 chain_kernel_abort
    s_branch L_pd_21_1
L_pd_21_1:
    s_waitcnt vmcnt(7)
    v_add_f32 v208, v80, v223
    s_waitcnt vmcnt(5)
    v_max3_u32 v20, v223, v224, v225
    v_add_f32 v209, v224, v225
    v_cmp_eq_u32 vcc, 0xffff0000, v20
    v_add_f32 v208, v208, v209
    s_nop 1
    v_mov_b32_dpp v209, v208 quad_perm:[1,0,3,2] row_mask:0xf bank_mask:0xf
    s_mov_b64 exec, s[26:27]
    v_cvt_pk_bf16_f32 v208, v208, v209
    v_min_u32 v208, 0xfffffffe, v208
    s_cbranch_vccnz L_pf_23
    s_branch L_pd_21
L_pf_23:
    s_mov_b64 exec, -1
    buffer_load_short_d16_hi v223, v9, s[8:11], s44 offen sc1
    buffer_load_short_d16_hi v224, v10, s[8:11], s44 offen sc1
    buffer_load_short_d16_hi v225, v11, s[8:11], s44 offen sc1
    s_add_u32 s33, s33, 1
    s_cmp_gt_u32 s33, 0x100000
    s_cbranch_scc1 chain_kernel_abort
    s_branch L_pd_21_2
L_pd_21_2:
    s_waitcnt vmcnt(5)
    v_add_f32 v208, v80, v220
    s_waitcnt vmcnt(3)
    v_max3_u32 v20, v220, v221, v222
    v_add_f32 v209, v221, v222
    v_cmp_eq_u32 vcc, 0xffff0000, v20
    v_add_f32 v208, v208, v209
    s_nop 1
    v_mov_b32_dpp v209, v208 quad_perm:[1,0,3,2] row_mask:0xf bank_mask:0xf
    s_mov_b64 exec, s[26:27]
    v_cvt_pk_bf16_f32 v208, v208, v209
    v_min_u32 v208, 0xfffffffe, v208
    s_cbranch_vccnz L_pf_24
    s_branch L_pd_21
L_pf_24:
    s_mov_b64 exec, -1
    buffer_load_short_d16_hi v220, v9, s[8:11], s43 offen sc1
    buffer_load_short_d16_hi v221, v10, s[8:11], s43 offen sc1
    buffer_load_short_d16_hi v222, v11, s[8:11], s43 offen sc1
    s_add_u32 s33, s33, 1
    s_cmp_gt_u32 s33, 0x100000
    s_cbranch_scc1 chain_kernel_abort
    s_branch L_pd_21_3
L_pd_21_3:
    s_waitcnt vmcnt(5)
    v_add_f32 v208, v80, v223
    s_waitcnt vmcnt(3)
    v_max3_u32 v20, v223, v224, v225
    v_add_f32 v209, v224, v225
    v_cmp_eq_u32 vcc, 0xffff0000, v20
    v_add_f32 v208, v208, v209
    s_nop 1
    v_mov_b32_dpp v209, v208 quad_perm:[1,0,3,2] row_mask:0xf bank_mask:0xf
    s_mov_b64 exec, s[26:27]
    v_cvt_pk_bf16_f32 v208, v208, v209
    v_min_u32 v208, 0xfffffffe, v208
    s_cbranch_vccnz L_pf_25
    s_branch L_pd_21
L_pf_25:
    s_mov_b64 exec, -1
    buffer_load_short_d16_hi v223, v9, s[8:11], s44 offen sc1
    buffer_load_short_d16_hi v224, v10, s[8:11], s44 offen sc1
    buffer_load_short_d16_hi v225, v11, s[8:11], s44 offen sc1
    s_add_u32 s33, s33, 1
    s_cmp_gt_u32 s33, 0x100000
    s_cbranch_scc1 chain_kernel_abort
    s_branch L_pd_21_2
chain_kernel_abort:
    s_mov_b32 s12, s98
    s_and_b32 s13, s99, 0xffff
    s_mov_b32 s14, 0x100
    s_mov_b32 s15, 0x00020000
    s_mov_b64 exec, 1
    v_mov_b32 v1, s19
    v_or_b32 v1, 0xdead0000, v1
    v_mov_b32 v2, 124
    buffer_store_dword v1, v2, s[12:15], 0 offen
chain_kernel_done:
    s_endpgm
chain_kernel_end:
    s_endpgm
chain_kernel_worker:
    s_sub_u32 s56, s16, 4
    s_mov_b32 s57, s17
    s_mov_b32 s58, s18
    s_cmp_eq_u32 s56, 0
    s_cbranch_scc1 L_big_37
kvs_start:
    s_cmp_eq_u32 s56, 3
    s_cselect_b64 s[12:13], s[90:91], s[88:89]
    s_cmp_eq_u32 s56, 1
    s_cselect_b64 s[12:13], s[86:87], s[12:13]
    s_and_b32 s13, s13, 0xffff
    s_mov_b32 s14, 0x800000
    s_mov_b32 s15, 0x00020000
    s_lshl_b32 s28, s57, 8
    v_bfe_u32 v24, v0, 4, 3
    v_lshlrev_b32 v24, 1, v24
    v_and_b32 v25, 15, v0
    v_xor_b32 v24, v24, v25
    v_lshlrev_b32 v6, 4, v24
    v_bfe_u32 v24, v0, 4, 2
    v_lshl_add_u32 v6, v24, 13, v6
    v_bfe_u32 v24, v0, 6, 1
    v_lshl_add_u32 v6, v24, 16, v6
    v_bfe_u32 v24, v0, 7, 1
    v_lshl_add_u32 v6, v24, 15, v6
    s_and_b32 s60, s58, 1
    s_lshl_b32 s61, s60, 11
    s_lshr_b32 s60, s58, 1
    s_lshl_b32 s60, s60, 10
    s_add_u32 s32, s60, s61
    s_add_u32 m0, s32, 0
    s_add_u32 s61, s28, 0x0
    buffer_load_dwordx4 v6, s[12:15], s61 offen nt lds
    s_add_u32 m0, s32, 4096
    s_add_u32 s61, s28, 0x20000
    buffer_load_dwordx4 v6, s[12:15], s61 offen nt lds
    s_add_u32 m0, s32, 8192
    s_add_u32 s61, s28, 0x40000
    buffer_load_dwordx4 v6, s[12:15], s61 offen nt lds
    s_add_u32 m0, s32, 12288
    s_add_u32 s61, s28, 0x60000
    buffer_load_dwordx4 v6, s[12:15], s61 offen nt lds
    s_add_u32 m0, s32, 16384
    s_add_u32 s61, s28, 0x80000
    buffer_load_dwordx4 v6, s[12:15], s61 offen nt lds
    s_add_u32 m0, s32, 20480
    s_add_u32 s61, s28, 0xa0000
    buffer_load_dwordx4 v6, s[12:15], s61 offen nt lds
    s_add_u32 m0, s32, 24576
    s_add_u32 s61, s28, 0xc0000
    buffer_load_dwordx4 v6, s[12:15], s61 offen nt lds
    s_add_u32 m0, s32, 28672
    s_add_u32 s61, s28, 0xe0000
    buffer_load_dwordx4 v6, s[12:15], s61 offen nt lds
    s_mov_b32 s8, s82
    s_and_b32 s9, s83, 0xffff
    s_mov_b32 s10, 0x400000
    s_mov_b32 s11, 0x00020000
    s_mov_b32 s16, s100
    s_and_b32 s17, s101, 0xffff
    s_mov_b32 s18, 0xc000000
    s_mov_b32 s19, 0x00020000
    v_and_b32 v24, 63, v0
    v_lshlrev_b32 v1, 4, v24
    v_add_u32 v12, 4096, v1
    v_lshlrev_b32 v10, 7, v24
    s_lshl_b32 s27, s57, 13
    s_add_u32 m0, s32, 32768
    s_add_u32 s61, s28, 0x100000
    buffer_load_dwordx4 v6, s[12:15], s61 offen nt lds
    s_add_u32 m0, s32, 36864
    s_add_u32 s61, s28, 0x120000
    buffer_load_dwordx4 v6, s[12:15], s61 offen nt lds
    s_add_u32 m0, s32, 40960
    s_add_u32 s61, s28, 0x140000
    buffer_load_dwordx4 v6, s[12:15], s61 offen nt lds
    s_add_u32 m0, s32, 45056
    s_add_u32 s61, s28, 0x160000
    buffer_load_dwordx4 v6, s[12:15], s61 offen nt lds
    s_add_u32 m0, s32, 49152
    s_add_u32 s61, s28, 0x180000
    buffer_load_dwordx4 v6, s[12:15], s61 offen nt lds
    s_add_u32 m0, s32, 53248
    s_add_u32 s61, s28, 0x1a0000
    buffer_load_dwordx4 v6, s[12:15], s61 offen nt lds
    s_add_u32 m0, s32, 57344
    s_add_u32 s61, s28, 0x1c0000
    buffer_load_dwordx4 v6, s[12:15], s61 offen nt lds
    s_add_u32 m0, s32, 61440
    s_add_u32 s61, s28, 0x1e0000
    buffer_load_dwordx4 v6, s[12:15], s61 offen nt lds
    v_bfe_u32 v24, v0, 4, 3
    v_and_b32 v25, 7, v0
    v_xor_b32 v24, v24, v25
    v_lshlrev_b32 v2, 4, v24
    v_lshrrev_b32 v24, 3, v0
    v_lshl_add_u32 v2, v24, 11, v2
    v_bfe_u32 v24, v0, 1, 3
    v_bfe_u32 v25, v0, 4, 2
    v_xor_b32 v24, v24, v25
    v_lshlrev_b32 v4, 4, v24
    v_and_b32 v25, 15, v0
    v_lshl_add_u32 v4, v25, 7, v4
    v_add_u32 v4, 98304, v4
    v_xor_b32 v5, 64, v4
    s_add_u32 m0, s32, 65536
    s_add_u32 s61, s28, 0x200000
    buffer_load_dwordx4 v6, s[12:15], s61 offen nt lds
    s_add_u32 m0, s32, 69632
    s_add_u32 s61, s28, 0x220000
    buffer_load_dwordx4 v6, s[12:15], s61 offen nt lds
    s_add_u32 m0, s32, 73728
    s_add_u32 s61, s28, 0x240000
    buffer_load_dwordx4 v6, s[12:15], s61 offen nt lds
    s_add_u32 m0, s32, 77824
    s_add_u32 s61, s28, 0x260000
    buffer_load_dwordx4 v6, s[12:15], s61 offen nt lds
    s_add_u32 m0, s32, 81920
    s_add_u32 s61, s28, 0x280000
    buffer_load_dwordx4 v6, s[12:15], s61 offen nt lds
    s_add_u32 m0, s32, 86016
    s_add_u32 s61, s28, 0x2a0000
    buffer_load_dwordx4 v6, s[12:15], s61 offen nt lds
    s_add_u32 m0, s32, 90112
    s_add_u32 s61, s28, 0x2c0000
    buffer_load_dwordx4 v6, s[12:15], s61 offen nt lds
    s_add_u32 m0, s32, 94208
    s_add_u32 s61, s28, 0x2e0000
    buffer_load_dwordx4 v6, s[12:15], s61 offen nt lds
    v_bfe_u32 v24, v0, 2, 3
    v_lshrrev_b32 v25, 6, v0
    v_lshlrev_b32 v25, 1, v25
    v_xor_b32 v24, v24, v25
    v_lshlrev_b32 v8, 5, v24
    v_bfe_u32 v24, v0, 0, 2
    v_lshl_add_u32 v8, v24, 3, v8
    v_bfe_u32 v24, v0, 2, 2
    v_lshl_add_u32 v8, v24, 8, v8
    v_bfe_u32 v24, v0, 4, 2
    v_lshl_add_u32 v8, v24, 11, v8
    v_xor_b32 v9, 32, v8
    v_mov_b32 v28, -1
    v_mov_b32 v29, -1
    v_mov_b32 v30, -1
    v_mov_b32 v31, -1
    s_lshl_b32 s20, s58, 10
    s_add_u32 s20, s20, 98304
    s_mov_b32 s21, 98304
    s_mov_b32 s23, 0
    s_mov_b32 s29, 32768
    s_add_u32 m0, s32, 98304
    s_add_u32 s61, s28, 0x300000
    buffer_load_dwordx4 v6, s[12:15], s61 offen nt lds
    s_add_u32 m0, s32, 102400
    s_add_u32 s61, s28, 0x320000
    buffer_load_dwordx4 v6, s[12:15], s61 offen nt lds
    s_add_u32 m0, s32, 106496
    s_add_u32 s61, s28, 0x340000
    buffer_load_dwordx4 v6, s[12:15], s61 offen nt lds
    s_add_u32 m0, s32, 110592
    s_add_u32 s61, s28, 0x360000
    buffer_load_dwordx4 v6, s[12:15], s61 offen nt lds
    s_add_u32 m0, s32, 114688
    s_add_u32 s61, s28, 0x380000
    buffer_load_dwordx4 v6, s[12:15], s61 offen nt lds
    s_add_u32 m0, s32, 118784
    s_add_u32 s61, s28, 0x3a0000
    buffer_load_dwordx4 v6, s[12:15], s61 offen nt lds
    s_add_u32 m0, s32, 122880
    s_add_u32 s61, s28, 0x3c0000
    buffer_load_dwordx4 v6, s[12:15], s61 offen nt lds
    s_add_u32 m0, s32, 126976
    s_add_u32 s61, s28, 0x3e0000
    buffer_load_dwordx4 v6, s[12:15], s61 offen nt lds
    s_lshl_b32 s30, s57, 16
    s_cmp_eq_u32 s56, 3
    s_cselect_b32 s60, 11, 10
    s_cselect_b32 s61, 0x4000, 0
    s_lshl_b32 s60, s58, s60
    s_add_u32 s30, s30, s60
    s_add_u32 s30, s30, s61
    s_lshr_b32 s31, s57, 1
    s_lshl_b32 s31, s31, 14
    s_and_b32 s61, s57, 1
    s_lshl2_add_u32 s60, s61, s58
    s_lshl_b32 s60, s60, 10
    s_add_u32 s31, s31, s60
    s_mov_b32 s61, 0xc000000
    s_cmp_eq_u32 s56, 1
    s_cmov_b32 s61, 0x8000000
    s_add_u32 s31, s31, s61
    s_cmp_eq_u32 s56, 1
    s_cselect_b32 s60, 0x8000, 0
    s_add_u32 s30, s30, s60
    s_add_u32 m0, s32, 131072
    s_add_u32 s61, s28, 0x400000
    buffer_load_dwordx4 v6, s[12:15], s61 offen nt lds
    s_add_u32 m0, s32, 135168
    s_add_u32 s61, s28, 0x420000
    buffer_load_dwordx4 v6, s[12:15], s61 offen nt lds
    s_add_u32 m0, s32, 139264
    s_add_u32 s61, s28, 0x440000
    buffer_load_dwordx4 v6, s[12:15], s61 offen nt lds
    s_add_u32 m0, s32, 143360
    s_add_u32 s61, s28, 0x460000
    buffer_load_dwordx4 v6, s[12:15], s61 offen nt lds
    s_add_u32 m0, s32, 147456
    s_add_u32 s61, s28, 0x480000
    buffer_load_dwordx4 v6, s[12:15], s61 offen nt lds
    s_add_u32 m0, s32, 151552
    s_add_u32 s61, s28, 0x4a0000
    buffer_load_dwordx4 v6, s[12:15], s61 offen nt lds
    s_add_u32 m0, s32, 155648
    s_add_u32 s61, s28, 0x4c0000
    buffer_load_dwordx4 v6, s[12:15], s61 offen nt lds
    s_add_u32 m0, s32, 159744
    s_add_u32 s61, s28, 0x4e0000
    buffer_load_dwordx4 v6, s[12:15], s61 offen nt lds
    s_waitcnt vmcnt(32)
    s_barrier
    ds_read_b64_tr_b16 a[0:1], v8 offset:0
    ds_read_b64_tr_b16 a[2:3], v8 offset:1024
    ds_read_b64_tr_b16 a[4:5], v9 offset:0
    ds_read_b64_tr_b16 a[6:7], v9 offset:1024
    ds_read_b64_tr_b16 a[8:9], v8 offset:8192
    ds_read_b64_tr_b16 a[10:11], v8 offset:9216
    ds_read_b64_tr_b16 a[12:13], v9 offset:8192
    ds_read_b64_tr_b16 a[14:15], v9 offset:9216
    s_waitcnt lgkmcnt(0)
    ds_read_b64_tr_b16 a[16:17], v8 offset:16384
    ds_read_b64_tr_b16 a[18:19], v8 offset:17408
    ds_read_b64_tr_b16 a[20:21], v9 offset:16384
    ds_read_b64_tr_b16 a[22:23], v9 offset:17408
    ds_read_b64_tr_b16 a[24:25], v8 offset:24576
    ds_read_b64_tr_b16 a[26:27], v8 offset:25600
    ds_read_b64_tr_b16 a[28:29], v9 offset:24576
    ds_read_b64_tr_b16 a[30:31], v9 offset:25600
    s_waitcnt lgkmcnt(0)
    s_waitcnt vmcnt(24)
    s_barrier
    s_add_u32 m0, s32, 0
    s_add_u32 s61, s28, 0x500000
    buffer_load_dwordx4 v6, s[12:15], s61 offen nt lds
    s_add_u32 m0, s32, 4096
    s_add_u32 s61, s28, 0x520000
    buffer_load_dwordx4 v6, s[12:15], s61 offen nt lds
    s_add_u32 m0, s32, 8192
    s_add_u32 s61, s28, 0x540000
    buffer_load_dwordx4 v6, s[12:15], s61 offen nt lds
    s_add_u32 m0, s32, 12288
    s_add_u32 s61, s28, 0x560000
    buffer_load_dwordx4 v6, s[12:15], s61 offen nt lds
    s_add_u32 m0, s32, 16384
    s_add_u32 s61, s28, 0x580000
    buffer_load_dwordx4 v6, s[12:15], s61 offen nt lds
    s_add_u32 m0, s32, 20480
    s_add_u32 s61, s28, 0x5a0000
    buffer_load_dwordx4 v6, s[12:15], s61 offen nt lds
    s_add_u32 m0, s32, 24576
    s_add_u32 s61, s28, 0x5c0000
    buffer_load_dwordx4 v6, s[12:15], s61 offen nt lds
    s_add_u32 m0, s32, 28672
    s_add_u32 s61, s28, 0x5e0000
    buffer_load_dwordx4 v6, s[12:15], s61 offen nt lds
    ds_read_b64_tr_b16 a[32:33], v8 offset:32768
    ds_read_b64_tr_b16 a[34:35], v8 offset:33792
    ds_read_b64_tr_b16 a[36:37], v9 offset:32768
    ds_read_b64_tr_b16 a[38:39], v9 offset:33792
    ds_read_b64_tr_b16 a[40:41], v8 offset:40960
    ds_read_b64_tr_b16 a[42:43], v8 offset:41984
    ds_read_b64_tr_b16 a[44:45], v9 offset:40960
    ds_read_b64_tr_b16 a[46:47], v9 offset:41984
    s_waitcnt lgkmcnt(0)
    ds_read_b64_tr_b16 a[48:49], v8 offset:49152
    ds_read_b64_tr_b16 a[50:51], v8 offset:50176
    ds_read_b64_tr_b16 a[52:53], v9 offset:49152
    ds_read_b64_tr_b16 a[54:55], v9 offset:50176
    ds_read_b64_tr_b16 a[56:57], v8 offset:57344
    ds_read_b64_tr_b16 a[58:59], v8 offset:58368
    ds_read_b64_tr_b16 a[60:61], v9 offset:57344
    ds_read_b64_tr_b16 a[62:63], v9 offset:58368
    s_waitcnt lgkmcnt(0)
    s_waitcnt vmcnt(24)
    s_barrier
    s_add_u32 m0, s32, 32768
    s_add_u32 s61, s28, 0x600000
    buffer_load_dwordx4 v6, s[12:15], s61 offen nt lds
    s_add_u32 m0, s32, 36864
    s_add_u32 s61, s28, 0x620000
    buffer_load_dwordx4 v6, s[12:15], s61 offen nt lds
    s_add_u32 m0, s32, 40960
    s_add_u32 s61, s28, 0x640000
    buffer_load_dwordx4 v6, s[12:15], s61 offen nt lds
    s_add_u32 m0, s32, 45056
    s_add_u32 s61, s28, 0x660000
    buffer_load_dwordx4 v6, s[12:15], s61 offen nt lds
    s_add_u32 m0, s32, 49152
    s_add_u32 s61, s28, 0x680000
    buffer_load_dwordx4 v6, s[12:15], s61 offen nt lds
    s_add_u32 m0, s32, 53248
    s_add_u32 s61, s28, 0x6a0000
    buffer_load_dwordx4 v6, s[12:15], s61 offen nt lds
    s_add_u32 m0, s32, 57344
    s_add_u32 s61, s28, 0x6c0000
    buffer_load_dwordx4 v6, s[12:15], s61 offen nt lds
    s_add_u32 m0, s32, 61440
    s_add_u32 s61, s28, 0x6e0000
    buffer_load_dwordx4 v6, s[12:15], s61 offen nt lds
    s_and_b32 s60, s58, 1
    s_lshl_b32 s60, s60, 18
    s_add_u32 s60, s60, s27
    buffer_load_dword v13, v10, s[8:11], s60 offen
    s_add_u32 s27, s27, 0x80000
    v_add_u32 v8, 0x10000, v8
    v_add_u32 v9, 0x10000, v9
    ds_read_b64_tr_b16 a[64:65], v8 offset:0
    ds_read_b64_tr_b16 a[66:67], v8 offset:1024
    ds_read_b64_tr_b16 a[68:69], v9 offset:0
    ds_read_b64_tr_b16 a[70:71], v9 offset:1024
    ds_read_b64_tr_b16 a[72:73], v8 offset:8192
    ds_read_b64_tr_b16 a[74:75], v8 offset:9216
    ds_read_b64_tr_b16 a[76:77], v9 offset:8192
    ds_read_b64_tr_b16 a[78:79], v9 offset:9216
    s_waitcnt lgkmcnt(0)
    ds_read_b64_tr_b16 a[80:81], v8 offset:16384
    ds_read_b64_tr_b16 a[82:83], v8 offset:17408
    ds_read_b64_tr_b16 a[84:85], v9 offset:16384
    ds_read_b64_tr_b16 a[86:87], v9 offset:17408
    ds_read_b64_tr_b16 a[88:89], v8 offset:24576
    ds_read_b64_tr_b16 a[90:91], v8 offset:25600
    ds_read_b64_tr_b16 a[92:93], v9 offset:24576
    ds_read_b64_tr_b16 a[94:95], v9 offset:25600
    s_waitcnt lgkmcnt(0)
    s_waitcnt vmcnt(24)
    s_barrier
    s_add_u32 m0, s32, 65536
    s_add_u32 s61, s28, 0x700000
    buffer_load_dwordx4 v6, s[12:15], s61 offen nt lds
    s_add_u32 m0, s32, 69632
    s_add_u32 s61, s28, 0x720000
    buffer_load_dwordx4 v6, s[12:15], s61 offen nt lds
    s_add_u32 m0, s32, 73728
    s_add_u32 s61, s28, 0x740000
    buffer_load_dwordx4 v6, s[12:15], s61 offen nt lds
    s_add_u32 m0, s32, 77824
    s_add_u32 s61, s28, 0x760000
    buffer_load_dwordx4 v6, s[12:15], s61 offen nt lds
    s_add_u32 m0, s32, 81920
    s_add_u32 s61, s28, 0x780000
    buffer_load_dwordx4 v6, s[12:15], s61 offen nt lds
    s_add_u32 m0, s32, 86016
    s_add_u32 s61, s28, 0x7a0000
    buffer_load_dwordx4 v6, s[12:15], s61 offen nt lds
    s_add_u32 m0, s32, 90112
    s_add_u32 s61, s28, 0x7c0000
    buffer_load_dwordx4 v6, s[12:15], s61 offen nt lds
    s_add_u32 m0, s32, 94208
    s_add_u32 s61, s28, 0x7e0000
    buffer_load_dwordx4 v6, s[12:15], s61 offen nt lds
    v_mov_b32 v24, 4
    global_load_dword v11, v24, s[98:99] sc1
    s_or_b32 s60, s2, s58
    s_cbranch_scc1 L_rw_38
    s_lshl_b32 s62, s56, 3
    s_add_u32 s62, s62, 160
    s_mov_b32 s63, 0
L_rp_39:
    s_load_dwordx2 s[60:61], s[98:99], s62 glc
    s_add_u32 s63, s63, 1
    s_cmp_gt_u32 s63, 0x100000
    s_cbranch_scc1 chain_kernel_wabort
    s_waitcnt lgkmcnt(0)
    s_cmp_lt_u32 s61, 0x2000
    s_cbranch_scc1 L_rp_39
    s_lshr_b32 s61, s95, 8
    s_cmp_eq_u32 s60, -1
    s_cselect_b32 s94, -1, s61
L_rw_38:
    ds_read_b64_tr_b16 a[96:97], v8 offset:32768
    ds_read_b64_tr_b16 a[98:99], v8 offset:33792
    ds_read_b64_tr_b16 a[100:101], v9 offset:32768
    ds_read_b64_tr_b16 a[102:103], v9 offset:33792
    ds_read_b64_tr_b16 a[104:105], v8 offset:40960
    ds_read_b64_tr_b16 a[106:107], v8 offset:41984
    ds_read_b64_tr_b16 a[108:109], v9 offset:40960
    ds_read_b64_tr_b16 a[110:111], v9 offset:41984
    s_waitcnt lgkmcnt(0)
    ds_read_b64_tr_b16 a[112:113], v8 offset:49152
    ds_read_b64_tr_b16 a[114:115], v8 offset:50176
    ds_read_b64_tr_b16 a[116:117], v9 offset:49152
    ds_read_b64_tr_b16 a[118:119], v9 offset:50176
    ds_read_b64_tr_b16 a[120:121], v8 offset:57344
    ds_read_b64_tr_b16 a[122:123], v8 offset:58368
    ds_read_b64_tr_b16 a[124:125], v9 offset:57344
    ds_read_b64_tr_b16 a[126:127], v9 offset:58368
    s_waitcnt lgkmcnt(0)
    s_waitcnt vmcnt(24)
    s_barrier
    s_add_u32 m0, s20, 0
    s_nop 0
    buffer_load_dwordx4 v2, s[8:11], s23 offen offset:0 lds
    s_add_u32 m0, s20, 3968
    s_nop 0
    buffer_load_dwordx4 v2, s[8:11], s23 offen offset:128 lds
    s_add_u32 m0, s20, 7936
    s_nop 0
    buffer_load_dwordx4 v2, s[8:11], s23 offen offset:256 lds
    s_add_u32 m0, s20, 11904
    s_nop 0
    buffer_load_dwordx4 v2, s[8:11], s23 offen offset:384 lds
    s_add_u32 m0, s20, 15872
    s_nop 0
    buffer_load_dwordx4 v2, s[8:11], s23 offen offset:512 lds
    s_add_u32 m0, s20, 19840
    s_nop 0
    buffer_load_dwordx4 v2, s[8:11], s23 offen offset:640 lds
    s_add_u32 m0, s20, 23808
    s_nop 0
    buffer_load_dwordx4 v2, s[8:11], s23 offen offset:768 lds
    s_add_u32 m0, s20, 27776
    s_nop 0
    buffer_load_dwordx4 v2, s[8:11], s23 offen offset:896 lds
    s_add_u32 s23, s23, 1024
    s_bitcmp1_b32 s23, 11
    s_cselect_b32 s60, 0xf800, 0
    s_add_u32 s23, s23, s60
    s_add_u32 s20, s20, 32768
    s_cmp_ge_u32 s20, 163840
    s_cselect_b32 s60, 163840, 0
    s_sub_u32 s20, s20, s60
    v_add_u32 v8, 0x10000, v8
    v_add_u32 v9, 0x10000, v9
    ds_read_b64_tr_b16 a[128:129], v8 offset:0
    ds_read_b64_tr_b16 a[130:131], v8 offset:1024
    ds_read_b64_tr_b16 a[132:133], v9 offset:0
    ds_read_b64_tr_b16 a[134:135], v9 offset:1024
    ds_read_b64_tr_b16 a[136:137], v8 offset:8192
    ds_read_b64_tr_b16 a[138:139], v8 offset:9216
    ds_read_b64_tr_b16 a[140:141], v9 offset:8192
    ds_read_b64_tr_b16 a[142:143], v9 offset:9216
    s_waitcnt lgkmcnt(0)
    ds_read_b64_tr_b16 a[144:145], v8 offset:16384
    ds_read_b64_tr_b16 a[146:147], v8 offset:17408
    ds_read_b64_tr_b16 a[148:149], v9 offset:16384
    ds_read_b64_tr_b16 a[150:151], v9 offset:17408
    ds_read_b64_tr_b16 a[152:153], v8 offset:24576
    ds_read_b64_tr_b16 a[154:155], v8 offset:25600
    ds_read_b64_tr_b16 a[156:157], v9 offset:24576
    ds_read_b64_tr_b16 a[158:159], v9 offset:25600
    s_waitcnt lgkmcnt(0)
    s_waitcnt vmcnt(24)
    s_barrier
    s_add_u32 m0, s20, 0
    s_nop 0
    buffer_load_dwordx4 v2, s[8:11], s23 offen offset:0 lds
    s_add_u32 m0, s20, 3968
    s_nop 0
    buffer_load_dwordx4 v2, s[8:11], s23 offen offset:128 lds
    s_add_u32 m0, s20, 7936
    s_nop 0
    buffer_load_dwordx4 v2, s[8:11], s23 offen offset:256 lds
    s_add_u32 m0, s20, 11904
    s_nop 0
    buffer_load_dwordx4 v2, s[8:11], s23 offen offset:384 lds
    s_add_u32 m0, s20, 15872
    s_nop 0
    buffer_load_dwordx4 v2, s[8:11], s23 offen offset:512 lds
    s_add_u32 m0, s20, 19840
    s_nop 0
    buffer_load_dwordx4 v2, s[8:11], s23 offen offset:640 lds
    s_add_u32 m0, s20, 23808
    s_nop 0
    buffer_load_dwordx4 v2, s[8:11], s23 offen offset:768 lds
    s_add_u32 m0, s20, 27776
    s_nop 0
    buffer_load_dwordx4 v2, s[8:11], s23 offen offset:896 lds
    s_add_u32 s23, s23, 1024
    s_bitcmp1_b32 s23, 11
    s_cselect_b32 s60, 0xf800, 0
    s_add_u32 s23, s23, s60
    s_add_u32 s20, s20, 32768
    s_cmp_ge_u32 s20, 163840
    s_cselect_b32 s60, 163840, 0
    s_sub_u32 s20, s20, s60
    v_add_u32 v8, 0xfffe0000, v8
    v_add_u32 v9, 0xfffe0000, v9
    ds_read_b64_tr_b16 a[160:161], v8 offset:0
    ds_read_b64_tr_b16 a[162:163], v8 offset:1024
    ds_read_b64_tr_b16 a[164:165], v9 offset:0
    ds_read_b64_tr_b16 a[166:167], v9 offset:1024
    ds_read_b64_tr_b16 a[168:169], v8 offset:8192
    ds_read_b64_tr_b16 a[170:171], v8 offset:9216
    ds_read_b64_tr_b16 a[172:173], v9 offset:8192
    ds_read_b64_tr_b16 a[174:175], v9 offset:9216
    s_waitcnt lgkmcnt(0)
    ds_read_b64_tr_b16 a[176:177], v8 offset:16384
    ds_read_b64_tr_b16 a[178:179], v8 offset:17408
    ds_read_b64_tr_b16 a[180:181], v9 offset:16384
    ds_read_b64_tr_b16 a[182:183], v9 offset:17408
    ds_read_b64_tr_b16 a[184:185], v8 offset:24576
    ds_read_b64_tr_b16 a[186:187], v8 offset:25600
    ds_read_b64_tr_b16 a[188:189], v9 offset:24576
    ds_read_b64_tr_b16 a[190:191], v9 offset:25600
    s_waitcnt lgkmcnt(0)
    s_waitcnt vmcnt(24)
    s_barrier
    s_add_u32 m0, s20, 0
    s_nop 0
    buffer_load_dwordx4 v2, s[8:11], s23 offen offset:0 lds
    s_add_u32 m0, s20, 3968
    s_nop 0
    buffer_load_dwordx4 v2, s[8:11], s23 offen offset:128 lds
    s_add_u32 m0, s20, 7936
    s_nop 0
    buffer_load_dwordx4 v2, s[8:11], s23 offen offset:256 lds
    s_add_u32 m0, s20, 11904
    s_nop 0
    buffer_load_dwordx4 v2, s[8:11], s23 offen offset:384 lds
    s_add_u32 m0, s20, 15872
    s_nop 0
    buffer_load_dwordx4 v2, s[8:11], s23 offen offset:512 lds
    s_add_u32 m0, s20, 19840
    s_nop 0
    buffer_load_dwordx4 v2, s[8:11], s23 offen offset:640 lds
    s_add_u32 m0, s20, 23808
    s_nop 0
    buffer_load_dwordx4 v2, s[8:11], s23 offen offset:768 lds
    s_add_u32 m0, s20, 27776
    s_nop 0
    buffer_load_dwordx4 v2, s[8:11], s23 offen offset:896 lds
    s_add_u32 s23, s23, 1024
    s_bitcmp1_b32 s23, 11
    s_cselect_b32 s60, 0xf800, 0
    s_add_u32 s23, s23, s60
    s_add_u32 s20, s20, 32768
    s_cmp_ge_u32 s20, 163840
    s_cselect_b32 s60, 163840, 0
    s_sub_u32 s20, s20, s60
    ds_read_b64_tr_b16 a[192:193], v8 offset:32768
    ds_read_b64_tr_b16 a[194:195], v8 offset:33792
    ds_read_b64_tr_b16 a[196:197], v9 offset:32768
    ds_read_b64_tr_b16 a[198:199], v9 offset:33792
    ds_read_b64_tr_b16 a[200:201], v8 offset:40960
    ds_read_b64_tr_b16 a[202:203], v8 offset:41984
    ds_read_b64_tr_b16 a[204:205], v9 offset:40960
    ds_read_b64_tr_b16 a[206:207], v9 offset:41984
    s_waitcnt lgkmcnt(0)
    ds_read_b64_tr_b16 a[208:209], v8 offset:49152
    ds_read_b64_tr_b16 a[210:211], v8 offset:50176
    ds_read_b64_tr_b16 a[212:213], v9 offset:49152
    ds_read_b64_tr_b16 a[214:215], v9 offset:50176
    ds_read_b64_tr_b16 a[216:217], v8 offset:57344
    ds_read_b64_tr_b16 a[218:219], v8 offset:58368
    ds_read_b64_tr_b16 a[220:221], v9 offset:57344
    ds_read_b64_tr_b16 a[222:223], v9 offset:58368
    s_waitcnt lgkmcnt(0)
    s_waitcnt vmcnt(24)
    s_barrier
    s_cmp_lg_u32 s2, 0
    s_cbranch_scc1 L_rok_40
    v_mov_b32 v24, 32768
    s_cmp_lg_u32 s58, 0
    s_cbranch_scc1 L_rw_41
    v_mov_b32 v25, s94
    ds_write_b32 v24, v25
    s_waitcnt lgkmcnt(0)
L_rw_41:
    s_barrier
    ds_read_b32 v25, v24
    s_waitcnt lgkmcnt(0)
    v_readfirstlane_b32 s60, v25
    s_mov_b32 s2, 1
    s_cmp_eq_u32 s60, -1
    s_cbranch_scc1 L_rok_40
    s_mov_b32 s57, s60
    s_waitcnt vmcnt(0)
    s_barrier
    s_cmp_ge_u32 s57, 32
    s_cbranch_scc1 chain_kernel_end
    s_branch kvs_start
L_rok_40:
    v_add_u32 v8, 0x10000, v8
    v_add_u32 v9, 0x10000, v9
    ds_read_b64_tr_b16 a[224:225], v8 offset:0
    ds_read_b64_tr_b16 a[226:227], v8 offset:1024
    ds_read_b64_tr_b16 a[228:229], v9 offset:0
    ds_read_b64_tr_b16 a[230:231], v9 offset:1024
    ds_read_b64_tr_b16 a[232:233], v8 offset:8192
    ds_read_b64_tr_b16 a[234:235], v8 offset:9216
    ds_read_b64_tr_b16 a[236:237], v9 offset:8192
    ds_read_b64_tr_b16 a[238:239], v9 offset:9216
    s_waitcnt lgkmcnt(0)
    ds_read_b64_tr_b16 a[240:241], v8 offset:16384
    ds_read_b64_tr_b16 a[242:243], v8 offset:17408
    ds_read_b64_tr_b16 a[244:245], v9 offset:16384
    ds_read_b64_tr_b16 a[246:247], v9 offset:17408
    ds_read_b64_tr_b16 a[248:249], v8 offset:24576
    ds_read_b64_tr_b16 a[250:251], v8 offset:25600
    ds_read_b64_tr_b16 a[252:253], v9 offset:24576
    ds_read_b64_tr_b16 a[254:255], v9 offset:25600
    s_waitcnt lgkmcnt(0)
    s_waitcnt vmcnt(16)
    s_barrier
    s_mov_b32 s62, 0
L_pp_42:
    v_readfirstlane_b32 s59, v11
    s_and_b32 s60, s59, 0xff
    s_cmp_ge_u32 s60, 15
    s_cbranch_scc1 L_pok_43
    v_mov_b32 v24, 4
    global_load_dword v11, v24, s[98:99] sc1
    s_add_u32 s62, s62, 1
    s_cmp_gt_u32 s62, 0x200000
    s_cbranch_scc1 chain_kernel_wabort
    s_waitcnt vmcnt(0)
    s_branch L_pp_42
L_pok_43:
    s_cmp_ge_u32 s59, 0x800
    s_cselect_b32 s59, 0x2000, 0
    s_xor_b32 s31, s31, s59
    s_xor_b32 s30, s30, s59
    s_mov_b32 s24, 0
    s_mov_b32 s18, 0
    s_cmp_eq_u32 s56, 3
    s_cbranch_scc1 L_kvv_44
    ds_read_b128 v[72:75], v4 offset:0
    ds_read_b128 v[76:79], v4 offset:2048
    ds_read_b128 v[80:83], v5 offset:0
    ds_read_b128 v[84:87], v5 offset:2048
    ds_read_b128 v[88:91], v4 offset:4096
    ds_read_b128 v[92:95], v4 offset:6144
    s_mov_b32 s34, 0x2042258
    s_mov_b32 s35, 0x40004004
    s_cmp_eq_u32 s58, 0
    s_cselect_b32 s33, s27, 0x400000
    s_mov_b32 s25, 0
    s_mov_b32 s26, 0
kvsk:
    s_waitcnt lgkmcnt(4)
    v_mfma_f32_16x16x32_bf16 v[32:35], a[0:3], v[72:75], 0
    ds_read_b128 v[96:99], v5 offset:4096
    v_mfma_f32_16x16x32_bf16 v[36:39], a[4:7], v[72:75], 0
    ds_read_b128 v[100:103], v5 offset:6144
    v_mfma_f32_16x16x32_bf16 v[44:47], a[4:7], v[76:79], 0
    v_mfma_f32_16x16x32_bf16 v[40:43], a[0:3], v[76:79], 0
    v_cvt_pk_bf16_f32 v64, v48, v49
    s_waitcnt lgkmcnt(4)
    v_mfma_f32_16x16x32_bf16 v[32:35], a[8:11], v[80:83], v[32:35]
    ds_read_b128 v[72:75], v4 offset:8192
    v_cvt_pk_bf16_f32 v65, v50, v51
    v_mfma_f32_16x16x32_bf16 v[36:39], a[12:15], v[80:83], v[36:39]
    ds_read_b128 v[76:79], v4 offset:10240
    v_cvt_pk_bf16_f32 v66, v52, v53
    v_mfma_f32_16x16x32_bf16 v[44:47], a[12:15], v[84:87], v[44:47]
    v_cvt_pk_bf16_f32 v67, v54, v55
    v_cvt_pk_bf16_f32 v68, v56, v57
    v_mfma_f32_16x16x32_bf16 v[40:43], a[8:11], v[84:87], v[40:43]
    v_cvt_pk_bf16_f32 v69, v58, v59
    s_waitcnt lgkmcnt(4)
    v_mfma_f32_16x16x32_bf16 v[32:35], a[16:19], v[88:91], v[32:35]
    ds_read_b128 v[80:83], v5 offset:8192
    v_cvt_pk_bf16_f32 v70, v60, v61
    v_mfma_f32_16x16x32_bf16 v[36:39], a[20:23], v[88:91], v[36:39]
    ds_read_b128 v[84:87], v5 offset:10240
    v_cvt_pk_bf16_f32 v71, v62, v63
    v_mfma_f32_16x16x32_bf16 v[44:47], a[20:23], v[92:95], v[44:47]
    buffer_store_dwordx4 v[64:67], v1, s[16:19], s25 offen sc1
    v_mfma_f32_16x16x32_bf16 v[40:43], a[16:19], v[92:95], v[40:43]
    buffer_store_dwordx4 v[68:71], v12, s[16:19], s25 offen sc1
    s_waitcnt lgkmcnt(4)
    v_mfma_f32_16x16x32_bf16 v[32:35], a[24:27], v[96:99], v[32:35]
    ds_read_b128 v[88:91], v4 offset:12288
    buffer_store_dwordx4 v[28:31], v1, s[16:19], s26 offen sc1
    v_mfma_f32_16x16x32_bf16 v[36:39], a[28:31], v[96:99], v[36:39]
    ds_read_b128 v[92:95], v4 offset:14336
    v_mfma_f32_16x16x32_bf16 v[44:47], a[28:31], v[100:103], v[44:47]
    v_mfma_f32_16x16x32_bf16 v[40:43], a[24:27], v[100:103], v[40:43]
    buffer_load_dword v13, v10, s[8:11], s33 offen
    s_waitcnt lgkmcnt(4)
    v_mfma_f32_16x16x32_bf16 v[32:35], a[32:35], v[72:75], v[32:35]
    ds_read_b128 v[96:99], v5 offset:12288
    v_mfma_f32_16x16x32_bf16 v[36:39], a[36:39], v[72:75], v[36:39]
    ds_read_b128 v[100:103], v5 offset:14336
    v_mfma_f32_16x16x32_bf16 v[44:47], a[36:39], v[76:79], v[44:47]
    s_mov_b32 s18, 0xc000000
    s_lshl_b32 s25, s24, 21
    v_mfma_f32_16x16x32_bf16 v[40:43], a[32:35], v[76:79], v[40:43]
    s_lshl_b32 s62, s24, 13
    s_waitcnt lgkmcnt(4)
    v_mfma_f32_16x16x32_bf16 v[32:35], a[40:43], v[80:83], v[32:35]
    ds_read_b128 v[72:75], v4 offset:16384
    s_and_b32 s62, s62, 0x2000
    v_mfma_f32_16x16x32_bf16 v[36:39], a[44:47], v[80:83], v[36:39]
    ds_read_b128 v[76:79], v4 offset:18432
    s_xor_b32 s62, s62, s30
    v_mfma_f32_16x16x32_bf16 v[44:47], a[44:47], v[84:87], v[44:47]
    s_add_u32 s25, s25, s62
    s_lshl_b32 s26, s24, 18
    v_mfma_f32_16x16x32_bf16 v[40:43], a[40:43], v[84:87], v[40:43]
    s_lshl_b32 s62, s24, 10
    s_waitcnt lgkmcnt(4)
    v_mfma_f32_16x16x32_bf16 v[32:35], a[48:51], v[88:91], v[32:35]
    ds_read_b128 v[80:83], v5 offset:16384
    s_and_b32 s62, s62, 0x2000
    v_mfma_f32_16x16x32_bf16 v[36:39], a[52:55], v[88:91], v[36:39]
    ds_read_b128 v[84:87], v5 offset:18432
    s_xor_b32 s62, s62, s31
    v_mfma_f32_16x16x32_bf16 v[44:47], a[52:55], v[92:95], v[44:47]
    s_add_u32 s26, s26, s62
    s_cmp_ge_u32 s21, 131072
    v_mfma_f32_16x16x32_bf16 v[40:43], a[48:51], v[92:95], v[40:43]
    s_cselect_b32 s22, 0xfffe0000, s29
    s_waitcnt lgkmcnt(4)
    v_mfma_f32_16x16x32_bf16 v[32:35], a[56:59], v[96:99], v[32:35]
    ds_read_b128 v[88:91], v4 offset:20480
    s_add_u32 s21, s21, s22
    v_mfma_f32_16x16x32_bf16 v[36:39], a[60:63], v[96:99], v[36:39]
    ds_read_b128 v[92:95], v4 offset:22528
    s_add_u32 s27, s27, 0x10000
    v_mfma_f32_16x16x32_bf16 v[44:47], a[60:63], v[100:103], v[44:47]
    s_andn2_b32 s61, 3, s24
    s_or_b32 s61, s61, s58
    v_mfma_f32_16x16x32_bf16 v[40:43], a[56:59], v[100:103], v[40:43]
    s_cselect_b32 s33, 0x400000, s27
    s_waitcnt lgkmcnt(4)
    v_mfma_f32_16x16x32_bf16 v[32:35], a[64:67], v[72:75], v[32:35]
    ds_read_b128 v[96:99], v5 offset:20480
    s_cmp_lt_u32 s24, 4
    v_mfma_f32_16x16x32_bf16 v[36:39], a[68:71], v[72:75], v[36:39]
    ds_read_b128 v[100:103], v5 offset:22528
    s_cselect_b64 vcc, -1, 0
    v_mfma_f32_16x16x32_bf16 v[44:47], a[68:71], v[76:79], v[44:47]
    v_mfma_f32_16x16x32_bf16 v[40:43], a[64:67], v[76:79], v[40:43]
    s_waitcnt lgkmcnt(4)
    v_mfma_f32_16x16x32_bf16 v[32:35], a[72:75], v[80:83], v[32:35]
    ds_read_b128 v[72:75], v4 offset:24576
    v_mfma_f32_16x16x32_bf16 v[36:39], a[76:79], v[80:83], v[36:39]
    ds_read_b128 v[76:79], v4 offset:26624
    v_mfma_f32_16x16x32_bf16 v[44:47], a[76:79], v[84:87], v[44:47]
    v_mfma_f32_16x16x32_bf16 v[40:43], a[72:75], v[84:87], v[40:43]
    s_waitcnt lgkmcnt(4)
    v_mfma_f32_16x16x32_bf16 v[32:35], a[80:83], v[88:91], v[32:35]
    ds_read_b128 v[80:83], v5 offset:24576
    s_add_u32 m0, s20, 0
    v_mfma_f32_16x16x32_bf16 v[36:39], a[84:87], v[88:91], v[36:39]
    ds_read_b128 v[84:87], v5 offset:26624
    buffer_load_dwordx4 v2, s[8:11], s23 offen offset:0 lds
    v_mfma_f32_16x16x32_bf16 v[44:47], a[84:87], v[92:95], v[44:47]
    v_mfma_f32_16x16x32_bf16 v[40:43], a[80:83], v[92:95], v[40:43]
    s_waitcnt lgkmcnt(4)
    v_mfma_f32_16x16x32_bf16 v[32:35], a[88:91], v[96:99], v[32:35]
    ds_read_b128 v[88:91], v4 offset:28672
    v_mfma_f32_16x16x32_bf16 v[36:39], a[92:95], v[96:99], v[36:39]
    ds_read_b128 v[92:95], v4 offset:30720
    s_add_u32 m0, s20, 3968
    v_mfma_f32_16x16x32_bf16 v[44:47], a[92:95], v[100:103], v[44:47]
    buffer_load_dwordx4 v2, s[8:11], s23 offen offset:128 lds
    v_mfma_f32_16x16x32_bf16 v[40:43], a[88:91], v[100:103], v[40:43]
    v_add_u32 v4, s22, v4
    s_waitcnt lgkmcnt(4)
    v_mfma_f32_16x16x32_bf16 v[32:35], a[96:99], v[72:75], v[32:35]
    ds_read_b128 v[96:99], v5 offset:28672
    v_mfma_f32_16x16x32_bf16 v[36:39], a[100:103], v[72:75], v[36:39]
    ds_read_b128 v[100:103], v5 offset:30720
    v_mfma_f32_16x16x32_bf16 v[44:47], a[100:103], v[76:79], v[44:47]
    v_add_u32 v5, s22, v5
    s_add_u32 m0, s20, 7936
    v_mfma_f32_16x16x32_bf16 v[40:43], a[96:99], v[76:79], v[40:43]
    buffer_load_dwordx4 v2, s[8:11], s23 offen offset:256 lds
    s_waitcnt vmcnt(15)
    s_cbranch_vccnz kvsk_early
    s_barrier
kvsk_mid:
    s_waitcnt lgkmcnt(4)
    v_mfma_f32_16x16x32_bf16 v[32:35], a[104:107], v[80:83], v[32:35]
    ds_read_b128 v[72:75], v4 offset:0
    v_mfma_f32_16x16x32_bf16 v[36:39], a[108:111], v[80:83], v[36:39]
    ds_read_b128 v[76:79], v4 offset:2048
    v_mfma_f32_16x16x32_bf16 v[44:47], a[108:111], v[84:87], v[44:47]
    v_mfma_f32_16x16x32_bf16 v[40:43], a[104:107], v[84:87], v[40:43]
    s_add_u32 m0, s20, 11904
    s_waitcnt lgkmcnt(4)
    v_mfma_f32_16x16x32_bf16 v[32:35], a[112:115], v[88:91], v[32:35]
    ds_read_b128 v[80:83], v5 offset:0
    buffer_load_dwordx4 v2, s[8:11], s23 offen offset:384 lds
    v_mfma_f32_16x16x32_bf16 v[36:39], a[116:119], v[88:91], v[36:39]
    ds_read_b128 v[84:87], v5 offset:2048
    v_mfma_f32_16x16x32_bf16 v[44:47], a[116:119], v[92:95], v[44:47]
    v_mfma_f32_16x16x32_bf16 v[40:43], a[112:115], v[92:95], v[40:43]
    s_waitcnt lgkmcnt(4)
    v_mfma_f32_16x16x32_bf16 v[32:35], a[120:123], v[96:99], v[32:35]
    ds_read_b128 v[88:91], v4 offset:4096
    s_add_u32 m0, s20, 15872
    v_mfma_f32_16x16x32_bf16 v[36:39], a[124:127], v[96:99], v[36:39]
    ds_read_b128 v[92:95], v4 offset:6144
    buffer_load_dwordx4 v2, s[8:11], s23 offen offset:512 lds
    v_mfma_f32_16x16x32_bf16 v[44:47], a[124:127], v[100:103], v[44:47]
    s_cmp_ge_u32 s21, 131072
    s_cselect_b32 s22, 0xfffe0000, s29
    v_mfma_f32_16x16x32_bf16 v[40:43], a[120:123], v[100:103], v[40:43]
    s_add_u32 s21, s21, s22
    s_waitcnt lgkmcnt(4)
    v_mfma_f32_16x16x32_bf16 v[32:35], a[128:131], v[72:75], v[32:35]
    ds_read_b128 v[96:99], v5 offset:4096
    v_mfma_f32_16x16x32_bf16 v[36:39], a[132:135], v[72:75], v[36:39]
    ds_read_b128 v[100:103], v5 offset:6144
    s_add_u32 m0, s20, 19840
    v_mfma_f32_16x16x32_bf16 v[44:47], a[132:135], v[76:79], v[44:47]
    buffer_load_dwordx4 v2, s[8:11], s23 offen offset:640 lds
    v_mfma_f32_16x16x32_bf16 v[40:43], a[128:131], v[76:79], v[40:43]
    s_waitcnt lgkmcnt(4)
    v_mfma_f32_16x16x32_bf16 v[32:35], a[136:139], v[80:83], v[32:35]
    ds_read_b128 v[72:75], v4 offset:8192
    v_mfma_f32_16x16x32_bf16 v[36:39], a[140:143], v[80:83], v[36:39]
    ds_read_b128 v[76:79], v4 offset:10240
    v_mfma_f32_16x16x32_bf16 v[44:47], a[140:143], v[84:87], v[44:47]
    s_add_u32 m0, s20, 23808
    v_mfma_f32_16x16x32_bf16 v[40:43], a[136:139], v[84:87], v[40:43]
    buffer_load_dwordx4 v2, s[8:11], s23 offen offset:768 lds
    s_waitcnt lgkmcnt(4)
    v_mfma_f32_16x16x32_bf16 v[32:35], a[144:147], v[88:91], v[32:35]
    ds_read_b128 v[80:83], v5 offset:8192
    v_mfma_f32_16x16x32_bf16 v[36:39], a[148:151], v[88:91], v[36:39]
    ds_read_b128 v[84:87], v5 offset:10240
    v_mfma_f32_16x16x32_bf16 v[44:47], a[148:151], v[92:95], v[44:47]
    v_mfma_f32_16x16x32_bf16 v[40:43], a[144:147], v[92:95], v[40:43]
    s_add_u32 m0, s20, 27776
    s_waitcnt lgkmcnt(4)
    v_mfma_f32_16x16x32_bf16 v[32:35], a[152:155], v[96:99], v[32:35]
    ds_read_b128 v[88:91], v4 offset:12288
    buffer_load_dwordx4 v2, s[8:11], s23 offen offset:896 lds
    v_mfma_f32_16x16x32_bf16 v[36:39], a[156:159], v[96:99], v[36:39]
    ds_read_b128 v[92:95], v4 offset:14336
    s_add_u32 s23, s23, 1024
    v_mfma_f32_16x16x32_bf16 v[44:47], a[156:159], v[100:103], v[44:47]
    s_bitcmp1_b32 s23, 11
    s_cselect_b32 s60, 0xf800, 0
    v_mfma_f32_16x16x32_bf16 v[40:43], a[152:155], v[100:103], v[40:43]
    s_add_u32 s23, s23, s60
    s_waitcnt lgkmcnt(4)
    v_mfma_f32_16x16x32_bf16 v[32:35], a[160:163], v[72:75], v[32:35]
    ds_read_b128 v[96:99], v5 offset:12288
    s_add_u32 s20, s20, 32768
    v_mfma_f32_16x16x32_bf16 v[36:39], a[164:167], v[72:75], v[36:39]
    ds_read_b128 v[100:103], v5 offset:14336
    s_cmp_ge_u32 s20, 163840
    v_mfma_f32_16x16x32_bf16 v[44:47], a[164:167], v[76:79], v[44:47]
    s_cselect_b32 s60, 163840, 0
    s_sub_u32 s20, s20, s60
    v_mfma_f32_16x16x32_bf16 v[40:43], a[160:163], v[76:79], v[40:43]
    s_add_u32 m0, s20, 0
    s_waitcnt lgkmcnt(4)
    v_mfma_f32_16x16x32_bf16 v[32:35], a[168:171], v[80:83], v[32:35]
    ds_read_b128 v[72:75], v4 offset:16384
    buffer_load_dwordx4 v2, s[8:11], s23 offen offset:0 lds
    v_mfma_f32_16x16x32_bf16 v[36:39], a[172:175], v[80:83], v[36:39]
    ds_read_b128 v[76:79], v4 offset:18432
    s_add_u32 m0, s20, 3968
    v_mfma_f32_16x16x32_bf16 v[44:47], a[172:175], v[84:87], v[44:47]
    buffer_load_dwordx4 v2, s[8:11], s23 offen offset:128 lds
    v_mfma_f32_16x16x32_bf16 v[40:43], a[168:171], v[84:87], v[40:43]
    s_waitcnt lgkmcnt(4)
    v_mfma_f32_16x16x32_bf16 v[32:35], a[176:179], v[88:91], v[32:35]
    ds_read_b128 v[80:83], v5 offset:16384
    v_mfma_f32_16x16x32_bf16 v[36:39], a[180:183], v[88:91], v[36:39]
    ds_read_b128 v[84:87], v5 offset:18432
    v_mfma_f32_16x16x32_bf16 v[44:47], a[180:183], v[92:95], v[44:47]
    s_add_u32 m0, s20, 7936
    v_mfma_f32_16x16x32_bf16 v[40:43], a[176:179], v[92:95], v[40:43]
    buffer_load_dwordx4 v2, s[8:11], s23 offen offset:256 lds
    s_waitcnt lgkmcnt(4)
    v_mfma_f32_16x16x32_bf16 v[32:35], a[184:187], v[96:99], v[32:35]
    ds_read_b128 v[88:91], v4 offset:20480
    v_mfma_f32_16x16x32_bf16 v[36:39], a[188:191], v[96:99], v[36:39]
    ds_read_b128 v[92:95], v4 offset:22528
    v_mfma_f32_16x16x32_bf16 v[44:47], a[188:191], v[100:103], v[44:47]
    v_mfma_f32_16x16x32_bf16 v[40:43], a[184:187], v[100:103], v[40:43]
    s_add_u32 m0, s20, 11904
    s_waitcnt lgkmcnt(4)
    v_mfma_f32_16x16x32_bf16 v[32:35], a[192:195], v[72:75], v[32:35]
    ds_read_b128 v[96:99], v5 offset:20480
    buffer_load_dwordx4 v2, s[8:11], s23 offen offset:384 lds
    v_mfma_f32_16x16x32_bf16 v[36:39], a[196:199], v[72:75], v[36:39]
    ds_read_b128 v[100:103], v5 offset:22528
    v_mfma_f32_16x16x32_bf16 v[44:47], a[196:199], v[76:79], v[44:47]
    v_mfma_f32_16x16x32_bf16 v[40:43], a[192:195], v[76:79], v[40:43]
    s_waitcnt lgkmcnt(4)
    v_mfma_f32_16x16x32_bf16 v[32:35], a[200:203], v[80:83], v[32:35]
    ds_read_b128 v[72:75], v4 offset:24576
    s_add_u32 m0, s20, 15872
    v_mfma_f32_16x16x32_bf16 v[36:39], a[204:207], v[80:83], v[36:39]
    ds_read_b128 v[76:79], v4 offset:26624
    buffer_load_dwordx4 v2, s[8:11], s23 offen offset:512 lds
    v_mfma_f32_16x16x32_bf16 v[44:47], a[204:207], v[84:87], v[44:47]
    v_mfma_f32_16x16x32_bf16 v[40:43], a[200:203], v[84:87], v[40:43]
    s_waitcnt lgkmcnt(4)
    v_mfma_f32_16x16x32_bf16 v[32:35], a[208:211], v[88:91], v[32:35]
    ds_read_b128 v[80:83], v5 offset:24576
    v_mfma_f32_16x16x32_bf16 v[36:39], a[212:215], v[88:91], v[36:39]
    ds_read_b128 v[84:87], v5 offset:26624
    s_add_u32 m0, s20, 19840
    v_mfma_f32_16x16x32_bf16 v[44:47], a[212:215], v[92:95], v[44:47]
    buffer_load_dwordx4 v2, s[8:11], s23 offen offset:640 lds
    v_mfma_f32_16x16x32_bf16 v[40:43], a[208:211], v[92:95], v[40:43]
    s_waitcnt lgkmcnt(4)
    v_mfma_f32_16x16x32_bf16 v[32:35], a[216:219], v[96:99], v[32:35]
    ds_read_b128 v[88:91], v4 offset:28672
    v_mfma_f32_16x16x32_bf16 v[36:39], a[220:223], v[96:99], v[36:39]
    ds_read_b128 v[92:95], v4 offset:30720
    v_mfma_f32_16x16x32_bf16 v[44:47], a[220:223], v[100:103], v[44:47]
    v_add_u32 v4, s22, v4
    s_add_u32 m0, s20, 23808
    v_mfma_f32_16x16x32_bf16 v[40:43], a[216:219], v[100:103], v[40:43]
    buffer_load_dwordx4 v2, s[8:11], s23 offen offset:768 lds
    s_waitcnt lgkmcnt(4)
    v_mfma_f32_16x16x32_bf16 v[32:35], a[224:227], v[72:75], v[32:35]
    ds_read_b128 v[96:99], v5 offset:28672
    v_mfma_f32_16x16x32_bf16 v[36:39], a[228:231], v[72:75], v[36:39]
    ds_read_b128 v[100:103], v5 offset:30720
    v_mfma_f32_16x16x32_bf16 v[44:47], a[228:231], v[76:79], v[44:47]
    v_add_u32 v5, s22, v5
    v_mfma_f32_16x16x32_bf16 v[40:43], a[224:227], v[76:79], v[40:43]
    s_add_u32 m0, s20, 27776
    s_waitcnt vmcnt(16)
    s_barrier
    s_waitcnt lgkmcnt(4)
    v_mfma_f32_16x16x32_bf16 v[32:35], a[232:235], v[80:83], v[32:35]
    ds_read_b128 v[72:75], v4 offset:0
    buffer_load_dwordx4 v2, s[8:11], s23 offen offset:896 lds
    v_mfma_f32_16x16x32_bf16 v[36:39], a[236:239], v[80:83], v[36:39]
    ds_read_b128 v[76:79], v4 offset:2048
    s_add_u32 s23, s23, 1024
    v_mfma_f32_16x16x32_bf16 v[44:47], a[236:239], v[84:87], v[44:47]
    s_bitcmp1_b32 s23, 11
    s_cselect_b32 s60, 0xf800, 0
    v_mfma_f32_16x16x32_bf16 v[40:43], a[232:235], v[84:87], v[40:43]
    s_add_u32 s23, s23, s60
    s_waitcnt lgkmcnt(4)
    v_mfma_f32_16x16x32_bf16 v[32:35], a[240:243], v[88:91], v[32:35]
    ds_read_b128 v[80:83], v5 offset:0
    s_add_u32 s20, s20, 32768
    s_cmp_ge_u32 s20, 163840
    v_mfma_f32_16x16x32_bf16 v[36:39], a[244:247], v[88:91], v[36:39]
    ds_read_b128 v[84:87], v5 offset:2048
    s_cselect_b32 s60, 163840, 0
    s_sub_u32 s20, s20, s60
    v_mfma_f32_16x16x32_bf16 v[44:47], a[244:247], v[92:95], v[44:47]
    v_mfma_f32_16x16x32_bf16 v[40:43], a[240:243], v[92:95], v[40:43]
    s_waitcnt lgkmcnt(4)
    v_mfma_f32_16x16x32_bf16 v[48:51], a[248:251], v[96:99], v[32:35]
    ds_read_b128 v[88:91], v4 offset:4096
    s_add_u32 s24, s24, 1
    s_sub_u32 s61, s24, 2
    v_mfma_f32_16x16x32_bf16 v[52:55], a[252:255], v[96:99], v[36:39]
    ds_read_b128 v[92:95], v4 offset:6144
    s_bitcmp1_b64 s[34:35], s61
    v_mfma_f32_16x16x32_bf16 v[60:63], a[252:255], v[100:103], v[44:47]
    v_mfma_f32_16x16x32_bf16 v[56:59], a[248:251], v[100:103], v[40:43]
    s_cbranch_scc0 kvsk
    s_cmp_eq_u32 s24, 64
    s_cbranch_scc1 kvsk_fin
    s_cmp_lg_u32 s58, 0
    s_cbranch_scc1 kvsk
    s_bfm_b64 s[62:63], s61, 0
    s_and_b32 s62, s62, 0x204225f
    s_and_b32 s63, s63, 0x80004004
    s_bcnt1_i32_b64 s60, s[62:63]
    s_lshl_b32 s60, s60, 2
    s_add_u32 s60, s60, 64
    v_mov_b32 v24, s60
    v_mov_b32 v25, 1
    s_mov_b64 exec, 1
    global_atomic_add v24, v25, s[98:99] sc1
    s_mov_b64 exec, -1
    s_branch kvsk
kvsk_early:
    s_waitcnt vmcnt(4)
    s_barrier
    s_cmp_eq_u32 s24, 0
    s_cbranch_scc1 kvsk_mid
    s_cmp_lg_u32 s58, 0
    s_cbranch_scc1 kvsk_mid
    s_lshl_b32 s60, s24, 2
    s_add_u32 s60, s60, 60
    v_mov_b32 v24, s60
    v_mov_b32 v25, 1
    s_mov_b64 exec, 1
    global_atomic_add v24, v25, s[98:99] sc1
    s_mov_b64 exec, -1
    s_branch kvsk_mid
kvsk_fin:
    s_nop 7
    v_cvt_pk_bf16_f32 v64, v48, v49
    v_cvt_pk_bf16_f32 v65, v50, v51
    v_cvt_pk_bf16_f32 v66, v52, v53
    v_cvt_pk_bf16_f32 v67, v54, v55
    v_cvt_pk_bf16_f32 v68, v56, v57
    v_cvt_pk_bf16_f32 v69, v58, v59
    v_cvt_pk_bf16_f32 v70, v60, v61
    v_cvt_pk_bf16_f32 v71, v62, v63
    buffer_store_dwordx4 v[64:67], v1, s[16:19], s25 offen sc1
    buffer_store_dwordx4 v[68:71], v12, s[16:19], s25 offen sc1
    buffer_store_dwordx4 v[28:31], v1, s[16:19], s26 offen sc1
    s_waitcnt vmcnt(0) lgkmcnt(0)
    s_barrier
    s_cmp_lg_u32 s58, 0
    s_cbranch_scc1 L_kve_45
    s_mov_b32 s60, 112
    v_mov_b32 v24, s60
    v_mov_b32 v25, 1
    s_mov_b64 exec, 1
    global_atomic_add v24, v25, s[98:99] sc1
    s_mov_b64 exec, -1
    s_branch L_kve_45
L_kvv_44:
    ds_read_b128 v[72:75], v4 offset:0
    ds_read_b128 v[76:79], v4 offset:2048
    ds_read_b128 v[80:83], v5 offset:0
    ds_read_b128 v[84:87], v5 offset:2048
    ds_read_b128 v[88:91], v4 offset:4096
    ds_read_b128 v[92:95], v4 offset:6144
    s_mov_b32 s34, 0x2042258
    s_mov_b32 s35, 0x40004004
    s_cmp_eq_u32 s58, 0
    s_cselect_b32 s33, s27, 0x400000
    s_mov_b32 s25, 0
    s_mov_b32 s26, 0
kvsv:
    s_waitcnt lgkmcnt(4)
    v_mfma_f32_16x16x32_bf16 v[32:35], v[72:75], a[0:3], 0
    ds_read_b128 v[96:99], v5 offset:4096
    v_mfma_f32_16x16x32_bf16 v[40:43], v[72:75], a[4:7], 0
    ds_read_b128 v[100:103], v5 offset:6144
    v_mfma_f32_16x16x32_bf16 v[44:47], v[76:79], a[4:7], 0
    v_mfma_f32_16x16x32_bf16 v[36:39], v[76:79], a[0:3], 0
    v_cvt_pk_bf16_f32 v64, v48, v49
    s_waitcnt lgkmcnt(4)
    v_mfma_f32_16x16x32_bf16 v[32:35], v[80:83], a[8:11], v[32:35]
    ds_read_b128 v[72:75], v4 offset:8192
    v_cvt_pk_bf16_f32 v65, v50, v51
    v_mfma_f32_16x16x32_bf16 v[40:43], v[80:83], a[12:15], v[40:43]
    ds_read_b128 v[76:79], v4 offset:10240
    v_cvt_pk_bf16_f32 v66, v52, v53
    v_mfma_f32_16x16x32_bf16 v[44:47], v[84:87], a[12:15], v[44:47]
    v_cvt_pk_bf16_f32 v67, v54, v55
    v_cvt_pk_bf16_f32 v68, v56, v57
    v_mfma_f32_16x16x32_bf16 v[36:39], v[84:87], a[8:11], v[36:39]
    v_cvt_pk_bf16_f32 v69, v58, v59
    s_waitcnt lgkmcnt(4)
    v_mfma_f32_16x16x32_bf16 v[32:35], v[88:91], a[16:19], v[32:35]
    ds_read_b128 v[80:83], v5 offset:8192
    v_cvt_pk_bf16_f32 v70, v60, v61
    v_mfma_f32_16x16x32_bf16 v[40:43], v[88:91], a[20:23], v[40:43]
    ds_read_b128 v[84:87], v5 offset:10240
    v_cvt_pk_bf16_f32 v71, v62, v63
    v_mfma_f32_16x16x32_bf16 v[44:47], v[92:95], a[20:23], v[44:47]
    buffer_store_dwordx4 v[64:67], v1, s[16:19], s25 offen sc1
    v_mfma_f32_16x16x32_bf16 v[36:39], v[92:95], a[16:19], v[36:39]
    buffer_store_dwordx4 v[68:71], v1, s[16:19], s25 offen offset:1024 sc1
    s_waitcnt lgkmcnt(4)
    v_mfma_f32_16x16x32_bf16 v[32:35], v[96:99], a[24:27], v[32:35]
    ds_read_b128 v[88:91], v4 offset:12288
    buffer_store_dwordx4 v[28:31], v1, s[16:19], s26 offen sc1
    v_mfma_f32_16x16x32_bf16 v[40:43], v[96:99], a[28:31], v[40:43]
    ds_read_b128 v[92:95], v4 offset:14336
    v_mfma_f32_16x16x32_bf16 v[44:47], v[100:103], a[28:31], v[44:47]
    v_mfma_f32_16x16x32_bf16 v[36:39], v[100:103], a[24:27], v[36:39]
    buffer_load_dword v13, v10, s[8:11], s33 offen
    s_waitcnt lgkmcnt(4)
    v_mfma_f32_16x16x32_bf16 v[32:35], v[72:75], a[32:35], v[32:35]
    ds_read_b128 v[96:99], v5 offset:12288
    v_mfma_f32_16x16x32_bf16 v[40:43], v[72:75], a[36:39], v[40:43]
    ds_read_b128 v[100:103], v5 offset:14336
    v_mfma_f32_16x16x32_bf16 v[44:47], v[76:79], a[36:39], v[44:47]
    s_mov_b32 s18, 0xc000000
    s_lshl_b32 s25, s24, 21
    v_mfma_f32_16x16x32_bf16 v[36:39], v[76:79], a[32:35], v[36:39]
    s_lshl_b32 s62, s24, 13
    s_waitcnt lgkmcnt(4)
    v_mfma_f32_16x16x32_bf16 v[32:35], v[80:83], a[40:43], v[32:35]
    ds_read_b128 v[72:75], v4 offset:16384
    s_and_b32 s62, s62, 0x2000
    v_mfma_f32_16x16x32_bf16 v[40:43], v[80:83], a[44:47], v[40:43]
    ds_read_b128 v[76:79], v4 offset:18432
    s_xor_b32 s62, s62, s30
    v_mfma_f32_16x16x32_bf16 v[44:47], v[84:87], a[44:47], v[44:47]
    s_add_u32 s25, s25, s62
    s_lshl_b32 s26, s24, 18
    v_mfma_f32_16x16x32_bf16 v[36:39], v[84:87], a[40:43], v[36:39]
    s_lshl_b32 s62, s24, 10
    s_waitcnt lgkmcnt(4)
    v_mfma_f32_16x16x32_bf16 v[32:35], v[88:91], a[48:51], v[32:35]
    ds_read_b128 v[80:83], v5 offset:16384
    s_and_b32 s62, s62, 0x2000
    v_mfma_f32_16x16x32_bf16 v[40:43], v[88:91], a[52:55], v[40:43]
    ds_read_b128 v[84:87], v5 offset:18432
    s_xor_b32 s62, s62, s31
    v_mfma_f32_16x16x32_bf16 v[44:47], v[92:95], a[52:55], v[44:47]
    s_add_u32 s26, s26, s62
    s_cmp_ge_u32 s21, 131072
    v_mfma_f32_16x16x32_bf16 v[36:39], v[92:95], a[48:51], v[36:39]
    s_cselect_b32 s22, 0xfffe0000, s29
    s_waitcnt lgkmcnt(4)
    v_mfma_f32_16x16x32_bf16 v[32:35], v[96:99], a[56:59], v[32:35]
    ds_read_b128 v[88:91], v4 offset:20480
    s_add_u32 s21, s21, s22
    v_mfma_f32_16x16x32_bf16 v[40:43], v[96:99], a[60:63], v[40:43]
    ds_read_b128 v[92:95], v4 offset:22528
    s_add_u32 s27, s27, 0x10000
    v_mfma_f32_16x16x32_bf16 v[44:47], v[100:103], a[60:63], v[44:47]
    s_andn2_b32 s61, 3, s24
    s_or_b32 s61, s61, s58
    v_mfma_f32_16x16x32_bf16 v[36:39], v[100:103], a[56:59], v[36:39]
    s_cselect_b32 s33, 0x400000, s27
    s_waitcnt lgkmcnt(4)
    v_mfma_f32_16x16x32_bf16 v[32:35], v[72:75], a[64:67], v[32:35]
    ds_read_b128 v[96:99], v5 offset:20480
    s_cmp_lt_u32 s24, 4
    v_mfma_f32_16x16x32_bf16 v[40:43], v[72:75], a[68:71], v[40:43]
    ds_read_b128 v[100:103], v5 offset:22528
    s_cselect_b64 vcc, -1, 0
    v_mfma_f32_16x16x32_bf16 v[44:47], v[76:79], a[68:71], v[44:47]
    v_mfma_f32_16x16x32_bf16 v[36:39], v[76:79], a[64:67], v[36:39]
    s_waitcnt lgkmcnt(4)
    v_mfma_f32_16x16x32_bf16 v[32:35], v[80:83], a[72:75], v[32:35]
    ds_read_b128 v[72:75], v4 offset:24576
    v_mfma_f32_16x16x32_bf16 v[40:43], v[80:83], a[76:79], v[40:43]
    ds_read_b128 v[76:79], v4 offset:26624
    v_mfma_f32_16x16x32_bf16 v[44:47], v[84:87], a[76:79], v[44:47]
    v_mfma_f32_16x16x32_bf16 v[36:39], v[84:87], a[72:75], v[36:39]
    s_waitcnt lgkmcnt(4)
    v_mfma_f32_16x16x32_bf16 v[32:35], v[88:91], a[80:83], v[32:35]
    ds_read_b128 v[80:83], v5 offset:24576
    s_add_u32 m0, s20, 0
    v_mfma_f32_16x16x32_bf16 v[40:43], v[88:91], a[84:87], v[40:43]
    ds_read_b128 v[84:87], v5 offset:26624
    buffer_load_dwordx4 v2, s[8:11], s23 offen offset:0 lds
    v_mfma_f32_16x16x32_bf16 v[44:47], v[92:95], a[84:87], v[44:47]
    v_mfma_f32_16x16x32_bf16 v[36:39], v[92:95], a[80:83], v[36:39]
    s_waitcnt lgkmcnt(4)
    v_mfma_f32_16x16x32_bf16 v[32:35], v[96:99], a[88:91], v[32:35]
    ds_read_b128 v[88:91], v4 offset:28672
    v_mfma_f32_16x16x32_bf16 v[40:43], v[96:99], a[92:95], v[40:43]
    ds_read_b128 v[92:95], v4 offset:30720
    s_add_u32 m0, s20, 3968
    v_mfma_f32_16x16x32_bf16 v[44:47], v[100:103], a[92:95], v[44:47]
    buffer_load_dwordx4 v2, s[8:11], s23 offen offset:128 lds
    v_mfma_f32_16x16x32_bf16 v[36:39], v[100:103], a[88:91], v[36:39]
    v_add_u32 v4, s22, v4
    s_waitcnt lgkmcnt(4)
    v_mfma_f32_16x16x32_bf16 v[32:35], v[72:75], a[96:99], v[32:35]
    ds_read_b128 v[96:99], v5 offset:28672
    v_mfma_f32_16x16x32_bf16 v[40:43], v[72:75], a[100:103], v[40:43]
    ds_read_b128 v[100:103], v5 offset:30720
    v_mfma_f32_16x16x32_bf16 v[44:47], v[76:79], a[100:103], v[44:47]
    v_add_u32 v5, s22, v5
    s_add_u32 m0, s20, 7936
    v_mfma_f32_16x16x32_bf16 v[36:39], v[76:79], a[96:99], v[36:39]
    buffer_load_dwordx4 v2, s[8:11], s23 offen offset:256 lds
    s_waitcnt vmcnt(15)
    s_cbranch_vccnz kvsv_early
    s_barrier
kvsv_mid:
    s_waitcnt lgkmcnt(4)
    v_mfma_f32_16x16x32_bf16 v[32:35], v[80:83], a[104:107], v[32:35]
    ds_read_b128 v[72:75], v4 offset:0
    v_mfma_f32_16x16x32_bf16 v[40:43], v[80:83], a[108:111], v[40:43]
    ds_read_b128 v[76:79], v4 offset:2048
    v_mfma_f32_16x16x32_bf16 v[44:47], v[84:87], a[108:111], v[44:47]
    v_mfma_f32_16x16x32_bf16 v[36:39], v[84:87], a[104:107], v[36:39]
    s_add_u32 m0, s20, 11904
    s_waitcnt lgkmcnt(4)
    v_mfma_f32_16x16x32_bf16 v[32:35], v[88:91], a[112:115], v[32:35]
    ds_read_b128 v[80:83], v5 offset:0
    buffer_load_dwordx4 v2, s[8:11], s23 offen offset:384 lds
    v_mfma_f32_16x16x32_bf16 v[40:43], v[88:91], a[116:119], v[40:43]
    ds_read_b128 v[84:87], v5 offset:2048
    v_mfma_f32_16x16x32_bf16 v[44:47], v[92:95], a[116:119], v[44:47]
    v_mfma_f32_16x16x32_bf16 v[36:39], v[92:95], a[112:115], v[36:39]
    s_waitcnt lgkmcnt(4)
    v_mfma_f32_16x16x32_bf16 v[32:35], v[96:99], a[120:123], v[32:35]
    ds_read_b128 v[88:91], v4 offset:4096
    s_add_u32 m0, s20, 15872
    v_mfma_f32_16x16x32_bf16 v[40:43], v[96:99], a[124:127], v[40:43]
    ds_read_b128 v[92:95], v4 offset:6144
    buffer_load_dwordx4 v2, s[8:11], s23 offen offset:512 lds
    v_mfma_f32_16x16x32_bf16 v[44:47], v[100:103], a[124:127], v[44:47]
    s_cmp_ge_u32 s21, 131072
    s_cselect_b32 s22, 0xfffe0000, s29
    v_mfma_f32_16x16x32_bf16 v[36:39], v[100:103], a[120:123], v[36:39]
    s_add_u32 s21, s21, s22
    s_waitcnt lgkmcnt(4)
    v_mfma_f32_16x16x32_bf16 v[32:35], v[72:75], a[128:131], v[32:35]
    ds_read_b128 v[96:99], v5 offset:4096
    v_mfma_f32_16x16x32_bf16 v[40:43], v[72:75], a[132:135], v[40:43]
    ds_read_b128 v[100:103], v5 offset:6144
    s_add_u32 m0, s20, 19840
    v_mfma_f32_16x16x32_bf16 v[44:47], v[76:79], a[132:135], v[44:47]
    buffer_load_dwordx4 v2, s[8:11], s23 offen offset:640 lds
    v_mfma_f32_16x16x32_bf16 v[36:39], v[76:79], a[128:131], v[36:39]
    s_waitcnt lgkmcnt(4)
    v_mfma_f32_16x16x32_bf16 v[32:35], v[80:83], a[136:139], v[32:35]
    ds_read_b128 v[72:75], v4 offset:8192
    v_mfma_f32_16x16x32_bf16 v[40:43], v[80:83], a[140:143], v[40:43]
    ds_read_b128 v[76:79], v4 offset:10240
    v_mfma_f32_16x16x32_bf16 v[44:47], v[84:87], a[140:143], v[44:47]
    s_add_u32 m0, s20, 23808
    v_mfma_f32_16x16x32_bf16 v[36:39], v[84:87], a[136:139], v[36:39]
    buffer_load_dwordx4 v2, s[8:11], s23 offen offset:768 lds
    s_waitcnt lgkmcnt(4)
    v_mfma_f32_16x16x32_bf16 v[32:35], v[88:91], a[144:147], v[32:35]
    ds_read_b128 v[80:83], v5 offset:8192
    v_mfma_f32_16x16x32_bf16 v[40:43], v[88:91], a[148:151], v[40:43]
    ds_read_b128 v[84:87], v5 offset:10240
    v_mfma_f32_16x16x32_bf16 v[44:47], v[92:95], a[148:151], v[44:47]
    v_mfma_f32_16x16x32_bf16 v[36:39], v[92:95], a[144:147], v[36:39]
    s_add_u32 m0, s20, 27776
    s_waitcnt lgkmcnt(4)
    v_mfma_f32_16x16x32_bf16 v[32:35], v[96:99], a[152:155], v[32:35]
    ds_read_b128 v[88:91], v4 offset:12288
    buffer_load_dwordx4 v2, s[8:11], s23 offen offset:896 lds
    v_mfma_f32_16x16x32_bf16 v[40:43], v[96:99], a[156:159], v[40:43]
    ds_read_b128 v[92:95], v4 offset:14336
    s_add_u32 s23, s23, 1024
    v_mfma_f32_16x16x32_bf16 v[44:47], v[100:103], a[156:159], v[44:47]
    s_bitcmp1_b32 s23, 11
    s_cselect_b32 s60, 0xf800, 0
    v_mfma_f32_16x16x32_bf16 v[36:39], v[100:103], a[152:155], v[36:39]
    s_add_u32 s23, s23, s60
    s_waitcnt lgkmcnt(4)
    v_mfma_f32_16x16x32_bf16 v[32:35], v[72:75], a[160:163], v[32:35]
    ds_read_b128 v[96:99], v5 offset:12288
    s_add_u32 s20, s20, 32768
    v_mfma_f32_16x16x32_bf16 v[40:43], v[72:75], a[164:167], v[40:43]
    ds_read_b128 v[100:103], v5 offset:14336
    s_cmp_ge_u32 s20, 163840
    v_mfma_f32_16x16x32_bf16 v[44:47], v[76:79], a[164:167], v[44:47]
    s_cselect_b32 s60, 163840, 0
    s_sub_u32 s20, s20, s60
    v_mfma_f32_16x16x32_bf16 v[36:39], v[76:79], a[160:163], v[36:39]
    s_add_u32 m0, s20, 0
    s_waitcnt lgkmcnt(4)
    v_mfma_f32_16x16x32_bf16 v[32:35], v[80:83], a[168:171], v[32:35]
    ds_read_b128 v[72:75], v4 offset:16384
    buffer_load_dwordx4 v2, s[8:11], s23 offen offset:0 lds
    v_mfma_f32_16x16x32_bf16 v[40:43], v[80:83], a[172:175], v[40:43]
    ds_read_b128 v[76:79], v4 offset:18432
    s_add_u32 m0, s20, 3968
    v_mfma_f32_16x16x32_bf16 v[44:47], v[84:87], a[172:175], v[44:47]
    buffer_load_dwordx4 v2, s[8:11], s23 offen offset:128 lds
    v_mfma_f32_16x16x32_bf16 v[36:39], v[84:87], a[168:171], v[36:39]
    s_waitcnt lgkmcnt(4)
    v_mfma_f32_16x16x32_bf16 v[32:35], v[88:91], a[176:179], v[32:35]
    ds_read_b128 v[80:83], v5 offset:16384
    v_mfma_f32_16x16x32_bf16 v[40:43], v[88:91], a[180:183], v[40:43]
    ds_read_b128 v[84:87], v5 offset:18432
    v_mfma_f32_16x16x32_bf16 v[44:47], v[92:95], a[180:183], v[44:47]
    s_add_u32 m0, s20, 7936
    v_mfma_f32_16x16x32_bf16 v[36:39], v[92:95], a[176:179], v[36:39]
    buffer_load_dwordx4 v2, s[8:11], s23 offen offset:256 lds
    s_waitcnt lgkmcnt(4)
    v_mfma_f32_16x16x32_bf16 v[32:35], v[96:99], a[184:187], v[32:35]
    ds_read_b128 v[88:91], v4 offset:20480
    v_mfma_f32_16x16x32_bf16 v[40:43], v[96:99], a[188:191], v[40:43]
    ds_read_b128 v[92:95], v4 offset:22528
    v_mfma_f32_16x16x32_bf16 v[44:47], v[100:103], a[188:191], v[44:47]
    v_mfma_f32_16x16x32_bf16 v[36:39], v[100:103], a[184:187], v[36:39]
    s_add_u32 m0, s20, 11904
    s_waitcnt lgkmcnt(4)
    v_mfma_f32_16x16x32_bf16 v[32:35], v[72:75], a[192:195], v[32:35]
    ds_read_b128 v[96:99], v5 offset:20480
    buffer_load_dwordx4 v2, s[8:11], s23 offen offset:384 lds
    v_mfma_f32_16x16x32_bf16 v[40:43], v[72:75], a[196:199], v[40:43]
    ds_read_b128 v[100:103], v5 offset:22528
    v_mfma_f32_16x16x32_bf16 v[44:47], v[76:79], a[196:199], v[44:47]
    v_mfma_f32_16x16x32_bf16 v[36:39], v[76:79], a[192:195], v[36:39]
    s_waitcnt lgkmcnt(4)
    v_mfma_f32_16x16x32_bf16 v[32:35], v[80:83], a[200:203], v[32:35]
    ds_read_b128 v[72:75], v4 offset:24576
    s_add_u32 m0, s20, 15872
    v_mfma_f32_16x16x32_bf16 v[40:43], v[80:83], a[204:207], v[40:43]
    ds_read_b128 v[76:79], v4 offset:26624
    buffer_load_dwordx4 v2, s[8:11], s23 offen offset:512 lds
    v_mfma_f32_16x16x32_bf16 v[44:47], v[84:87], a[204:207], v[44:47]
    v_mfma_f32_16x16x32_bf16 v[36:39], v[84:87], a[200:203], v[36:39]
    s_waitcnt lgkmcnt(4)
    v_mfma_f32_16x16x32_bf16 v[32:35], v[88:91], a[208:211], v[32:35]
    ds_read_b128 v[80:83], v5 offset:24576
    v_mfma_f32_16x16x32_bf16 v[40:43], v[88:91], a[212:215], v[40:43]
    ds_read_b128 v[84:87], v5 offset:26624
    s_add_u32 m0, s20, 19840
    v_mfma_f32_16x16x32_bf16 v[44:47], v[92:95], a[212:215], v[44:47]
    buffer_load_dwordx4 v2, s[8:11], s23 offen offset:640 lds
    v_mfma_f32_16x16x32_bf16 v[36:39], v[92:95], a[208:211], v[36:39]
    s_waitcnt lgkmcnt(4)
    v_mfma_f32_16x16x32_bf16 v[32:35], v[96:99], a[216:219], v[32:35]
    ds_read_b128 v[88:91], v4 offset:28672
    v_mfma_f32_16x16x32_bf16 v[40:43], v[96:99], a[220:223], v[40:43]
    ds_read_b128 v[92:95], v4 offset:30720
    v_mfma_f32_16x16x32_bf16 v[44:47], v[100:103], a[220:223], v[44:47]
    v_add_u32 v4, s22, v4
    s_add_u32 m0, s20, 23808
    v_mfma_f32_16x16x32_bf16 v[36:39], v[100:103], a[216:219], v[36:39]
    buffer_load_dwordx4 v2, s[8:11], s23 offen offset:768 lds
    s_waitcnt lgkmcnt(4)
    v_mfma_f32_16x16x32_bf16 v[32:35], v[72:75], a[224:227], v[32:35]
    ds_read_b128 v[96:99], v5 offset:28672
    v_mfma_f32_16x16x32_bf16 v[40:43], v[72:75], a[228:231], v[40:43]
    ds_read_b128 v[100:103], v5 offset:30720
    v_mfma_f32_16x16x32_bf16 v[44:47], v[76:79], a[228:231], v[44:47]
    v_add_u32 v5, s22, v5
    v_mfma_f32_16x16x32_bf16 v[36:39], v[76:79], a[224:227], v[36:39]
    s_add_u32 m0, s20, 27776
    s_waitcnt vmcnt(16)
    s_barrier
    s_waitcnt lgkmcnt(4)
    v_mfma_f32_16x16x32_bf16 v[32:35], v[80:83], a[232:235], v[32:35]
    ds_read_b128 v[72:75], v4 offset:0
    buffer_load_dwordx4 v2, s[8:11], s23 offen offset:896 lds
    v_mfma_f32_16x16x32_bf16 v[40:43], v[80:83], a[236:239], v[40:43]
    ds_read_b128 v[76:79], v4 offset:2048
    s_add_u32 s23, s23, 1024
    v_mfma_f32_16x16x32_bf16 v[44:47], v[84:87], a[236:239], v[44:47]
    s_bitcmp1_b32 s23, 11
    s_cselect_b32 s60, 0xf800, 0
    v_mfma_f32_16x16x32_bf16 v[36:39], v[84:87], a[232:235], v[36:39]
    s_add_u32 s23, s23, s60
    s_waitcnt lgkmcnt(4)
    v_mfma_f32_16x16x32_bf16 v[32:35], v[88:91], a[240:243], v[32:35]
    ds_read_b128 v[80:83], v5 offset:0
    s_add_u32 s20, s20, 32768
    s_cmp_ge_u32 s20, 163840
    v_mfma_f32_16x16x32_bf16 v[40:43], v[88:91], a[244:247], v[40:43]
    ds_read_b128 v[84:87], v5 offset:2048
    s_cselect_b32 s60, 163840, 0
    s_sub_u32 s20, s20, s60
    v_mfma_f32_16x16x32_bf16 v[44:47], v[92:95], a[244:247], v[44:47]
    v_mfma_f32_16x16x32_bf16 v[36:39], v[92:95], a[240:243], v[36:39]
    s_waitcnt lgkmcnt(4)
    v_mfma_f32_16x16x32_bf16 v[48:51], v[96:99], a[248:251], v[32:35]
    ds_read_b128 v[88:91], v4 offset:4096
    s_add_u32 s24, s24, 1
    s_sub_u32 s61, s24, 2
    v_mfma_f32_16x16x32_bf16 v[56:59], v[96:99], a[252:255], v[40:43]
    ds_read_b128 v[92:95], v4 offset:6144
    s_bitcmp1_b64 s[34:35], s61
    v_mfma_f32_16x16x32_bf16 v[60:63], v[100:103], a[252:255], v[44:47]
    v_mfma_f32_16x16x32_bf16 v[52:55], v[100:103], a[248:251], v[36:39]
    s_cbranch_scc0 kvsv
    s_cmp_eq_u32 s24, 64
    s_cbranch_scc1 kvsv_fin
    s_cmp_lg_u32 s58, 0
    s_cbranch_scc1 kvsv
    s_bfm_b64 s[62:63], s61, 0
    s_and_b32 s62, s62, 0x204225f
    s_and_b32 s63, s63, 0x80004004
    s_bcnt1_i32_b64 s60, s[62:63]
    s_lshl_b32 s60, s60, 2
    s_add_u32 s60, s60, 64
    v_mov_b32 v24, s60
    v_mov_b32 v25, 1
    s_mov_b64 exec, 1
    global_atomic_add v24, v25, s[98:99] sc1
    s_mov_b64 exec, -1
    s_branch kvsv
kvsv_early:
    s_waitcnt vmcnt(4)
    s_barrier
    s_cmp_eq_u32 s24, 0
    s_cbranch_scc1 kvsv_mid
    s_cmp_lg_u32 s58, 0
    s_cbranch_scc1 kvsv_mid
    s_lshl_b32 s60, s24, 2
    s_add_u32 s60, s60, 60
    v_mov_b32 v24, s60
    v_mov_b32 v25, 1
    s_mov_b64 exec, 1
    global_atomic_add v24, v25, s[98:99] sc1
    s_mov_b64 exec, -1
    s_branch kvsv_mid
kvsv_fin:
    s_nop 7
    v_cvt_pk_bf16_f32 v64, v48, v49
    v_cvt_pk_bf16_f32 v65, v50, v51
    v_cvt_pk_bf16_f32 v66, v52, v53
    v_cvt_pk_bf16_f32 v67, v54, v55
    v_cvt_pk_bf16_f32 v68, v56, v57
    v_cvt_pk_bf16_f32 v69, v58, v59
    v_cvt_pk_bf16_f32 v70, v60, v61
    v_cvt_pk_bf16_f32 v71, v62, v63
    buffer_store_dwordx4 v[64:67], v1, s[16:19], s25 offen sc1
    buffer_store_dwordx4 v[68:71], v1, s[16:19], s25 offen offset:1024 sc1
    buffer_store_dwordx4 v[28:31], v1, s[16:19], s26 offen sc1
    s_waitcnt vmcnt(0) lgkmcnt(0)
    s_barrier
    s_cmp_lg_u32 s58, 0
    s_cbranch_scc1 L_kve_45
    s_mov_b32 s60, 112
    v_mov_b32 v24, s60
    v_mov_b32 v25, 1
    s_mov_b64 exec, 1
    global_atomic_add v24, v25, s[98:99] sc1
    s_mov_b64 exec, -1
    s_branch L_kve_45
L_kve_45:
    s_branch chain_kernel_seg
L_big_37:
    v_and_b32 v24, 63, v0
    v_lshlrev_b32 v1, 4, v24
    v_mov_b32 v2, v1
    v_add_u32 v3, 1024, v1
    v_bfe_u32 v24, v0, 1, 3
    v_bfe_u32 v25, v0, 4, 2
    v_xor_b32 v24, v24, v25
    v_lshlrev_b32 v24, 4, v24
    v_and_b32 v25, 15, v0
    v_lshl_add_u32 v24, v25, 7, v24
    s_lshr_b32 s60, s58, 1
    s_lshl_b32 s60, s60, 14
    v_add_u32 v23, s60, v24
    s_and_b32 s60, s58, 1
    s_lshl_b32 s60, s60, 14
    s_add_u32 s60, s60, 32768
    v_add_u32 v12, s60, v24
    v_xor_b32 v13, 64, v12
    v_bfe_u32 v24, v0, 2, 3
    v_lshlrev_b32 v22, 5, v24
    v_and_b32 v24, 3, v0
    v_lshl_add_u32 v22, v24, 3, v22
    v_bfe_u32 v24, v0, 2, 2
    v_lshl_add_u32 v22, v24, 9, v22
    v_bfe_u32 v24, v0, 4, 2
    v_lshl_add_u32 v22, v24, 12, v22
    v_bfe_u32 v24, v0, 7, 1
    v_lshl_add_u32 v22, v24, 8, v22
    s_mov_b32 s49, 0
    s_mov_b32 s48, 32768
    s_lshl_b32 s45, s58, 12
    s_add_u32 s44, s45, 32768
    s_mov_b32 s11, 0x00020000
    s_mov_b32 s15, 0x00020000
    s_mov_b32 s19, 0x00020000
    s_mov_b32 s91, 0x00020000
    s_mov_b32 s90, 0x200000
    v_bfe_u32 v24, v0, 2, 3
    v_lshlrev_b32 v125, 11, v24
    v_and_b32 v24, 3, v0
    v_lshl_add_u32 v125, v24, 7, v125
    s_and_b32 s82, s57, 3
    s_lshr_b32 s85, s57, 2
    s_and_b32 s0, s82, 3
    s_lshl2_add_u32 s0, s85, s0
    s_lshl_b32 s60, s85, 19
    s_mov_b32 s30, s64
    s_and_b32 s31, s65, 0xffff
    s_mov_b32 s32, 0x400000
    s_mov_b32 s33, s60
    s_mov_b32 s34, 0x2000
    s_mov_b32 s35, 0x40000
    s_lshl_b32 s60, s82, 18
    s_mov_b32 s36, s70
    s_and_b32 s37, s71, 0xffff
    s_mov_b32 s38, 0x200000
    s_mov_b32 s39, s60
    s_mov_b32 s40, 0x8000
    s_mov_b32 s41, 0x20000
    s_mov_b32 s42, 0x80
    s_cmp_ge_u32 s58, 2
    s_cselect_b32 s36, s72, s70
    s_cselect_b32 s37, s73, s71
    s_and_b32 s37, s37, 0xffff
    v_bfe_u32 v24, v0, 4, 2
    v_and_b32 v25, 7, v0
    v_xor_b32 v24, v24, v25
    v_lshlrev_b32 v8, 4, v24
    v_bfe_u32 v24, v0, 3, 2
    v_lshl_add_u32 v8, v24, 11, v8
    v_bfe_u32 v24, v0, 5, 1
    v_lshl_add_u32 v8, v24, 16, v8
    v_lshrrev_b32 v24, 6, v0
    v_lshl_add_u32 v8, v24, 14, v8
    v_xor_b32 v9, 64, v8
    v_add_u32 v9, 0x20000, v9
    v_bfe_u32 v24, v0, 4, 2
    v_and_b32 v25, 7, v0
    v_xor_b32 v24, v24, v25
    v_lshlrev_b32 v10, 4, v24
    v_bfe_u32 v24, v0, 3, 3
    v_lshl_add_u32 v10, v24, 11, v10
    v_bfe_u32 v24, v0, 6, 1
    v_lshl_add_u32 v10, v24, 16, v10
    v_xor_b32 v11, 64, v10
    v_add_u32 v11, 0x4000, v11
    v_and_b32 v24, 15, v0
    v_bfe_u32 v25, v0, 7, 1
    v_lshl_add_u32 v24, v25, 6, v24
    v_lshlrev_b32 v24, 1, v24
    s_lshl_b32 s53, s82, 8
    s_mov_b32 s60, s66
    s_and_b32 s61, s67, 0xffff
    s_mov_b32 s62, 0x800
    s_mov_b32 s63, 0x00020000
    buffer_load_ushort v192, v24, s[60:63], s53 offen offset:0
    buffer_load_ushort v200, v24, s[60:63], s53 offen offset:32
    buffer_load_ushort v208, v24, s[60:63], s53 offen offset:64
    buffer_load_ushort v216, v24, s[60:63], s53 offen offset:96
    s_mov_b32 s60, s68
    s_and_b32 s61, s69, 0xffff
    s_mov_b32 s62, 0x800
    s_mov_b32 s63, 0x00020000
    buffer_load_ushort v193, v24, s[60:63], s53 offen offset:0
    buffer_load_ushort v201, v24, s[60:63], s53 offen offset:32
    buffer_load_ushort v209, v24, s[60:63], s53 offen offset:64
    buffer_load_ushort v217, v24, s[60:63], s53 offen offset:96
    s_mov_b32 s60, s78
    s_and_b32 s61, s79, 0xffff
    s_mov_b32 s62, 0x800
    s_mov_b32 s63, 0x00020000
    buffer_load_ushort v194, v24, s[60:63], s53 offen offset:0
    buffer_load_ushort v202, v24, s[60:63], s53 offen offset:32
    buffer_load_ushort v210, v24, s[60:63], s53 offen offset:64
    buffer_load_ushort v218, v24, s[60:63], s53 offen offset:96
    s_mov_b32 s6, 0xfffe8000
    s_mov_b32 s7, 65536
    s_mov_b32 s12, s36
    s_mov_b32 s13, s37
    s_mov_b32 s14, s38
    s_and_b32 s45, s45, 0xffffb7ff
    s_bitcmp1_b32 s0, 3
    s_cselect_b32 s24, s41, 0
    s_cselect_b32 s26, 0, s41
    s_cselect_b32 s60, 0x4000, 0
    s_or_b32 s45, s45, s60
    s_add_u32 s24, s24, s39
    s_add_u32 s26, s26, s39
    s_bitcmp1_b32 s0, 2
    s_cselect_b32 s61, s40, 0
    s_cselect_b32 s62, 0, s40
    s_cselect_b32 s60, 0x800, 0
    s_or_b32 s45, s45, s60
    s_add_u32 s25, s24, s62
    s_add_u32 s24, s24, s61
    s_add_u32 s27, s26, s62
    s_add_u32 s26, s26, s61
    s_mov_b32 s28, s42
    v_mov_b32 v6, v10
    v_mov_b32 v7, v11
    s_mov_b32 s8, s30
    s_mov_b32 s9, s31
    s_mov_b32 s10, s32
    s_and_b32 s44, s44, 0xffffb7ff
    s_bitcmp1_b32 s0, 1
    s_cselect_b32 s20, s35, 0
    s_cselect_b32 s22, 0, s35
    s_cselect_b32 s60, 0x4000, 0
    s_or_b32 s44, s44, s60
    s_add_u32 s20, s20, s33
    s_add_u32 s22, s22, s33
    s_bitcmp1_b32 s0, 0
    s_cselect_b32 s61, s34, 0
    s_cselect_b32 s62, 0, s34
    s_cselect_b32 s60, 0x800, 0
    s_or_b32 s44, s44, s60
    s_add_u32 s21, s20, s62
    s_add_u32 s20, s20, s61
    s_add_u32 s23, s22, s62
    s_add_u32 s22, s22, s61
    v_mov_b32 v4, v8
    v_mov_b32 v5, v9
    s_xor_b32 m0, s45, 0
    s_nop 0
    buffer_load_dwordx4 v6, s[12:15], s24 offen lds
    s_xor_b32 m0, s45, 1024
    s_nop 0
    buffer_load_dwordx4 v7, s[12:15], s24 offen lds
    s_xor_b32 m0, s45, 2048
    s_nop 0
    buffer_load_dwordx4 v6, s[12:15], s25 offen lds
    s_xor_b32 m0, s45, 3072
    s_nop 0
    buffer_load_dwordx4 v7, s[12:15], s25 offen lds
    s_xor_b32 m0, s45, 16384
    s_nop 0
    buffer_load_dwordx4 v6, s[12:15], s26 offen lds
    s_xor_b32 m0, s45, 17408
    s_nop 0
    buffer_load_dwordx4 v7, s[12:15], s26 offen lds
    s_xor_b32 m0, s45, 18432
    s_nop 0
    buffer_load_dwordx4 v6, s[12:15], s27 offen lds
    s_xor_b32 m0, s45, 19456
    s_nop 0
    buffer_load_dwordx4 v7, s[12:15], s27 offen lds
    s_add_u32 s24, s24, s28
    s_add_u32 s25, s25, s28
    s_add_u32 s26, s26, s28
    s_add_u32 s27, s27, s28
    s_cmp_ge_u32 s45, 98304
    s_cselect_b32 s60, s6, s7
    s_add_u32 s45, s45, s60
    s_xor_b32 m0, s44, 0
    s_nop 0
    buffer_load_dwordx4 v4, s[8:11], s20 offen lds
    s_xor_b32 m0, s44, 1024
    s_nop 0
    buffer_load_dwordx4 v5, s[8:11], s20 offen lds
    s_xor_b32 m0, s44, 2048
    s_nop 0
    buffer_load_dwordx4 v4, s[8:11], s21 offen lds
    s_xor_b32 m0, s44, 3072
    s_nop 0
    buffer_load_dwordx4 v5, s[8:11], s21 offen lds
    s_xor_b32 m0, s44, 16384
    s_nop 0
    buffer_load_dwordx4 v4, s[8:11], s22 offen lds
    s_xor_b32 m0, s44, 17408
    s_nop 0
    buffer_load_dwordx4 v5, s[8:11], s22 offen lds
    s_xor_b32 m0, s44, 18432
    s_nop 0
    buffer_load_dwordx4 v4, s[8:11], s23 offen lds
    s_xor_b32 m0, s44, 19456
    s_nop 0
    buffer_load_dwordx4 v5, s[8:11], s23 offen lds
    s_add_u32 s20, s20, 128
    s_add_u32 s21, s21, 128
    s_add_u32 s22, s22, 128
    s_add_u32 s23, s23, 128
    s_cmp_ge_u32 s44, 98304
    s_cselect_b32 s60, s6, s7
    s_add_u32 s44, s44, s60
    s_xor_b32 m0, s45, 0
    s_nop 0
    buffer_load_dwordx4 v6, s[12:15], s24 offen lds
    s_xor_b32 m0, s45, 1024
    s_nop 0
    buffer_load_dwordx4 v7, s[12:15], s24 offen lds
    s_xor_b32 m0, s45, 2048
    s_nop 0
    buffer_load_dwordx4 v6, s[12:15], s25 offen lds
    s_xor_b32 m0, s45, 3072
    s_nop 0
    buffer_load_dwordx4 v7, s[12:15], s25 offen lds
    s_xor_b32 m0, s45, 16384
    s_nop 0
    buffer_load_dwordx4 v6, s[12:15], s26 offen lds
    s_xor_b32 m0, s45, 17408
    s_nop 0
    buffer_load_dwordx4 v7, s[12:15], s26 offen lds
    s_xor_b32 m0, s45, 18432
    s_nop 0
    buffer_load_dwordx4 v6, s[12:15], s27 offen lds
    s_xor_b32 m0, s45, 19456
    s_nop 0
    buffer_load_dwordx4 v7, s[12:15], s27 offen lds
    s_add_u32 s24, s24, s28
    s_add_u32 s25, s25, s28
    s_add_u32 s26, s26, s28
    s_add_u32 s27, s27, s28
    s_cmp_ge_u32 s45, 98304
    s_cselect_b32 s60, s6, s7
    s_add_u32 s45, s45, s60
    s_add_u32 s39, s39, 0x100000
    s_mov_b32 s16, s100
    s_and_b32 s17, s101, 0xffff
    s_mov_b32 s18, 0x0
    s_mov_b32 s19, 0x00020000
    s_lshr_b32 s60, s85, 2
    s_lshl_b32 s60, s60, 21
    s_add_u32 s86, s64, s60
    s_addc_u32 s87, s65, 0
    s_and_b32 s60, s57, 15
    s_lshl1_add_u32 s60, s60, s58
    s_lshl_b32 s84, s60, 16
    s_bitcmp1_b32 s85, 0
    s_cselect_b64 s[62:63], s[72:73], s[70:71]
    s_lshr_b32 s60, s85, 1
    s_lshl2_add_u32 s60, s82, s60
    s_add_u32 s60, s60, 0
    s_lshl_b32 s60, s60, 16
    s_cmp_eq_u32 s58, 2
    s_cselect_b64 s[86:87], s[62:63], s[86:87]
    s_cselect_b32 s84, s60, s84
    s_cmp_eq_u32 s58, 3
    s_cselect_b32 s84, 0x40000000, s84
    s_and_b32 s87, s87, 0xffff
    s_mov_b64 s[88:89], s[86:87]
    s_add_u32 s83, s84, 512
    s_lshr_b32 s60, s85, 2
    s_lshl_b32 s60, s60, 21
    s_add_u32 s86, s64, s60
    s_addc_u32 s87, s65, 0
    s_and_b32 s60, s57, 15
    s_lshl1_add_u32 s60, s60, s58
    s_lshl_b32 s84, s60, 16
    s_bitcmp1_b32 s85, 0
    s_cselect_b64 s[62:63], s[72:73], s[70:71]
    s_lshr_b32 s60, s85, 1
    s_lshl2_add_u32 s60, s82, s60
    s_add_u32 s60, s60, 16
    s_lshl_b32 s60, s60, 16
    s_cmp_eq_u32 s58, 2
    s_cselect_b64 s[86:87], s[62:63], s[86:87]
    s_cselect_b32 s84, s60, s84
    s_cmp_eq_u32 s58, 3
    s_cselect_b32 s84, 0x40000000, s84
    s_and_b32 s87, s87, 0xffff
    s_waitcnt vmcnt(24)
    v_lshlrev_b32 v192, 16, v192
    v_lshlrev_b32 v200, 16, v200
    v_lshlrev_b32 v208, 16, v208
    v_lshlrev_b32 v216, 16, v216
    v_lshlrev_b32 v193, 16, v193
    v_lshlrev_b32 v201, 16, v201
    v_lshlrev_b32 v209, 16, v209
    v_lshlrev_b32 v217, 16, v217
    v_lshlrev_b32 v194, 16, v194
    v_lshlrev_b32 v202, 16, v202
    v_lshlrev_b32 v210, 16, v210
    v_lshlrev_b32 v218, 16, v218
    v_mul_f32 v194, 0x3fb8aa3b, v194
    v_mul_f32 v202, 0x3fb8aa3b, v202
    v_mul_f32 v210, 0x3fb8aa3b, v210
    v_mul_f32 v218, 0x3fb8aa3b, v218
    v_exp_f32 v194, v194
    v_exp_f32 v202, v202
    v_exp_f32 v210, v210
    v_exp_f32 v218, v218
    v_cvt_pk_bf16_f32 v194, 0, v194
    v_cvt_pk_bf16_f32 v202, 0, v202
    v_cvt_pk_bf16_f32 v210, 0, v210
    v_cvt_pk_bf16_f32 v218, 0, v218
    v_mul_f32 v195, v194, v192
    v_mul_f32 v203, v202, v200
    v_mul_f32 v211, v210, v208
    v_mul_f32 v219, v218, v216
    v_mul_f32 v196, v194, v193
    v_mul_f32 v204, v202, v201
    v_mul_f32 v212, v210, v209
    v_mul_f32 v220, v218, v217
    v_mul_f32 v195, 0x3fb8aa3b, v195
    v_mul_f32 v203, 0x3fb8aa3b, v203
    v_mul_f32 v211, 0x3fb8aa3b, v211
    v_mul_f32 v219, 0x3fb8aa3b, v219
    v_exp_f32 v195, v195
    v_exp_f32 v203, v203
    v_exp_f32 v211, v211
    v_exp_f32 v219, v219
    v_mul_f32 v196, 0x3e22f983, v196
    v_mul_f32 v204, 0x3e22f983, v204
    v_mul_f32 v212, 0x3e22f983, v212
    v_mul_f32 v220, 0x3e22f983, v220
    v_fract_f32 v196, v196
    v_fract_f32 v204, v204
    v_fract_f32 v212, v212
    v_fract_f32 v220, v220
    v_cos_f32 v197, v196
    v_cos_f32 v205, v204
    v_cos_f32 v213, v212
    v_cos_f32 v221, v220
    v_sin_f32 v198, v196
    v_sin_f32 v206, v204
    v_sin_f32 v214, v212
    v_sin_f32 v222, v220
    v_mul_f32 v88, v195, v197
    v_mul_f32 v90, v203, v205
    v_mul_f32 v92, v211, v213
    v_mul_f32 v94, v219, v221
    v_mul_f32 v89, v195, v198
    v_mul_f32 v91, v203, v206
    v_mul_f32 v93, v211, v214
    v_mul_f32 v95, v219, v222
    v_add_f32 v197, -1.0, v88
    v_add_f32 v205, -1.0, v90
    v_add_f32 v213, -1.0, v92
    v_add_f32 v221, -1.0, v94
    v_mul_f32 v198, v197, v192
    v_mul_f32 v206, v205, v200
    v_mul_f32 v214, v213, v208
    v_mul_f32 v222, v221, v216
    v_fma_f32 v198, v89, v193, v198
    v_fma_f32 v206, v91, v201, v206
    v_fma_f32 v214, v93, v209, v214
    v_fma_f32 v222, v95, v217, v222
    v_mul_f32 v199, v89, v192
    v_mul_f32 v207, v91, v200
    v_mul_f32 v215, v93, v208
    v_mul_f32 v223, v95, v216
    v_fma_f32 v199, -v197, v193, v199
    v_fma_f32 v207, -v205, v201, v207
    v_fma_f32 v215, -v213, v209, v215
    v_fma_f32 v223, -v221, v217, v223
    v_mul_f32 v195, v192, v192
    v_mul_f32 v203, v200, v200
    v_mul_f32 v211, v208, v208
    v_mul_f32 v219, v216, v216
    v_fma_f32 v195, v193, v193, v195
    v_fma_f32 v203, v201, v201, v203
    v_fma_f32 v211, v209, v209, v211
    v_fma_f32 v219, v217, v217, v219
    v_rcp_f32 v195, v195
    v_rcp_f32 v203, v203
    v_rcp_f32 v211, v211
    v_rcp_f32 v219, v219
    v_add_f32 v195, v195, v195
    v_add_f32 v203, v203, v203
    v_add_f32 v211, v211, v211
    v_add_f32 v219, v219, v219
    v_mul_f32 v96, v198, v195
    v_mul_f32 v98, v206, v203
    v_mul_f32 v100, v214, v211
    v_mul_f32 v102, v222, v219
    v_mul_f32 v97, v199, v195
    v_mul_f32 v99, v207, v203
    v_mul_f32 v101, v215, v211
    v_mul_f32 v103, v223, v219
    v_pk_mul_f32 v[192:193], v[88:89], v[88:89] op_sel:[0,0] op_sel_hi:[0,1]
    v_pk_mul_f32 v[200:201], v[90:91], v[90:91] op_sel:[0,0] op_sel_hi:[0,1]
    v_pk_mul_f32 v[208:209], v[92:93], v[92:93] op_sel:[0,0] op_sel_hi:[0,1]
    v_pk_mul_f32 v[216:217], v[94:95], v[94:95] op_sel:[0,0] op_sel_hi:[0,1]
    v_pk_fma_f32 v[104:105], v[88:89], v[88:89], v[192:193] op_sel:[1,1,0] op_sel_hi:[1,0,1] neg_lo:[1,0,0]
    v_pk_fma_f32 v[106:107], v[90:91], v[90:91], v[200:201] op_sel:[1,1,0] op_sel_hi:[1,0,1] neg_lo:[1,0,0]
    v_pk_fma_f32 v[108:109], v[92:93], v[92:93], v[208:209] op_sel:[1,1,0] op_sel_hi:[1,0,1] neg_lo:[1,0,0]
    v_pk_fma_f32 v[110:111], v[94:95], v[94:95], v[216:217] op_sel:[1,1,0] op_sel_hi:[1,0,1] neg_lo:[1,0,0]
    v_pk_mul_f32 v[192:193], v[104:105], v[104:105] op_sel:[0,0] op_sel_hi:[0,1]
    v_pk_mul_f32 v[200:201], v[106:107], v[106:107] op_sel:[0,0] op_sel_hi:[0,1]
    v_pk_mul_f32 v[208:209], v[108:109], v[108:109] op_sel:[0,0] op_sel_hi:[0,1]
    v_pk_mul_f32 v[216:217], v[110:111], v[110:111] op_sel:[0,0] op_sel_hi:[0,1]
    v_pk_fma_f32 v[104:105], v[104:105], v[104:105], v[192:193] op_sel:[1,1,0] op_sel_hi:[1,0,1] neg_lo:[1,0,0]
    v_pk_fma_f32 v[106:107], v[106:107], v[106:107], v[200:201] op_sel:[1,1,0] op_sel_hi:[1,0,1] neg_lo:[1,0,0]
    v_pk_fma_f32 v[108:109], v[108:109], v[108:109], v[208:209] op_sel:[1,1,0] op_sel_hi:[1,0,1] neg_lo:[1,0,0]
    v_pk_fma_f32 v[110:111], v[110:111], v[110:111], v[216:217] op_sel:[1,1,0] op_sel_hi:[1,0,1] neg_lo:[1,0,0]
    v_pk_mul_f32 v[192:193], v[104:105], v[104:105] op_sel:[0,0] op_sel_hi:[0,1]
    v_pk_mul_f32 v[200:201], v[106:107], v[106:107] op_sel:[0,0] op_sel_hi:[0,1]
    v_pk_mul_f32 v[208:209], v[108:109], v[108:109] op_sel:[0,0] op_sel_hi:[0,1]
    v_pk_mul_f32 v[216:217], v[110:111], v[110:111] op_sel:[0,0] op_sel_hi:[0,1]
    v_pk_fma_f32 v[104:105], v[104:105], v[104:105], v[192:193] op_sel:[1,1,0] op_sel_hi:[1,0,1] neg_lo:[1,0,0]
    v_pk_fma_f32 v[106:107], v[106:107], v[106:107], v[200:201] op_sel:[1,1,0] op_sel_hi:[1,0,1] neg_lo:[1,0,0]
    v_pk_fma_f32 v[108:109], v[108:109], v[108:109], v[208:209] op_sel:[1,1,0] op_sel_hi:[1,0,1] neg_lo:[1,0,0]
    v_pk_fma_f32 v[110:111], v[110:111], v[110:111], v[216:217] op_sel:[1,1,0] op_sel_hi:[1,0,1] neg_lo:[1,0,0]
    v_pk_mul_f32 v[192:193], v[104:105], v[104:105] op_sel:[0,0] op_sel_hi:[0,1]
    v_pk_mul_f32 v[200:201], v[106:107], v[106:107] op_sel:[0,0] op_sel_hi:[0,1]
    v_pk_mul_f32 v[208:209], v[108:109], v[108:109] op_sel:[0,0] op_sel_hi:[0,1]
    v_pk_mul_f32 v[216:217], v[110:111], v[110:111] op_sel:[0,0] op_sel_hi:[0,1]
    v_pk_fma_f32 v[104:105], v[104:105], v[104:105], v[192:193] op_sel:[1,1,0] op_sel_hi:[1,0,1] neg_lo:[1,0,0]
    v_pk_fma_f32 v[106:107], v[106:107], v[106:107], v[200:201] op_sel:[1,1,0] op_sel_hi:[1,0,1] neg_lo:[1,0,0]
    v_pk_fma_f32 v[108:109], v[108:109], v[108:109], v[208:209] op_sel:[1,1,0] op_sel_hi:[1,0,1] neg_lo:[1,0,0]
    v_pk_fma_f32 v[110:111], v[110:111], v[110:111], v[216:217] op_sel:[1,1,0] op_sel_hi:[1,0,1] neg_lo:[1,0,0]
    v_pk_mul_f32 v[192:193], v[104:105], v[104:105] op_sel:[0,0] op_sel_hi:[0,1]
    v_pk_mul_f32 v[200:201], v[106:107], v[106:107] op_sel:[0,0] op_sel_hi:[0,1]
    v_pk_mul_f32 v[208:209], v[108:109], v[108:109] op_sel:[0,0] op_sel_hi:[0,1]
    v_pk_mul_f32 v[216:217], v[110:111], v[110:111] op_sel:[0,0] op_sel_hi:[0,1]
    v_pk_fma_f32 v[104:105], v[104:105], v[104:105], v[192:193] op_sel:[1,1,0] op_sel_hi:[1,0,1] neg_lo:[1,0,0]
    v_pk_fma_f32 v[106:107], v[106:107], v[106:107], v[200:201] op_sel:[1,1,0] op_sel_hi:[1,0,1] neg_lo:[1,0,0]
    v_pk_fma_f32 v[108:109], v[108:109], v[108:109], v[208:209] op_sel:[1,1,0] op_sel_hi:[1,0,1] neg_lo:[1,0,0]
    v_pk_fma_f32 v[110:111], v[110:111], v[110:111], v[216:217] op_sel:[1,1,0] op_sel_hi:[1,0,1] neg_lo:[1,0,0]
    v_pk_mul_f32 v[192:193], v[104:105], v[104:105] op_sel:[0,0] op_sel_hi:[0,1]
    v_pk_mul_f32 v[200:201], v[106:107], v[106:107] op_sel:[0,0] op_sel_hi:[0,1]
    v_pk_mul_f32 v[208:209], v[108:109], v[108:109] op_sel:[0,0] op_sel_hi:[0,1]
    v_pk_mul_f32 v[216:217], v[110:111], v[110:111] op_sel:[0,0] op_sel_hi:[0,1]
    v_pk_fma_f32 v[112:113], v[104:105], v[104:105], v[192:193] op_sel:[1,1,0] op_sel_hi:[1,0,1] neg_lo:[1,0,0]
    v_pk_fma_f32 v[114:115], v[106:107], v[106:107], v[200:201] op_sel:[1,1,0] op_sel_hi:[1,0,1] neg_lo:[1,0,0]
    v_pk_fma_f32 v[116:117], v[108:109], v[108:109], v[208:209] op_sel:[1,1,0] op_sel_hi:[1,0,1] neg_lo:[1,0,0]
    v_pk_fma_f32 v[118:119], v[110:111], v[110:111], v[216:217] op_sel:[1,1,0] op_sel_hi:[1,0,1] neg_lo:[1,0,0]
    v_pk_mul_f32 v[192:193], v[112:113], v[112:113] op_sel:[0,0] op_sel_hi:[0,1]
    v_pk_mul_f32 v[200:201], v[114:115], v[114:115] op_sel:[0,0] op_sel_hi:[0,1]
    v_pk_mul_f32 v[208:209], v[116:117], v[116:117] op_sel:[0,0] op_sel_hi:[0,1]
    v_pk_mul_f32 v[216:217], v[118:119], v[118:119] op_sel:[0,0] op_sel_hi:[0,1]
    v_pk_fma_f32 v[196:197], v[112:113], v[112:113], v[192:193] op_sel:[1,1,0] op_sel_hi:[1,0,1] neg_lo:[1,0,0]
    v_pk_fma_f32 v[204:205], v[114:115], v[114:115], v[200:201] op_sel:[1,1,0] op_sel_hi:[1,0,1] neg_lo:[1,0,0]
    v_pk_fma_f32 v[212:213], v[116:117], v[116:117], v[208:209] op_sel:[1,1,0] op_sel_hi:[1,0,1] neg_lo:[1,0,0]
    v_pk_fma_f32 v[220:221], v[118:119], v[118:119], v[216:217] op_sel:[1,1,0] op_sel_hi:[1,0,1] neg_lo:[1,0,0]
    s_mov_b32 exec_lo, 0xffffffff
    s_mov_b32 exec_hi, 0xffffffff
    v_mov_b32 v120, v196
    v_mov_b32 v121, v197
    s_mov_b32 exec_lo, 0xffff0000
    s_mov_b32 exec_hi, 0xffffffff
    v_mov_b32 v120, v204
    v_mov_b32 v121, v205
    s_mov_b32 exec_lo, 0x0
    s_mov_b32 exec_hi, 0xffffffff
    v_mov_b32 v120, v212
    v_mov_b32 v121, v213
    s_mov_b32 exec_lo, 0x0
    s_mov_b32 exec_hi, 0xffff0000
    v_mov_b32 v120, v220
    v_mov_b32 v121, v221
    s_mov_b64 exec, -1
    s_mov_b32 s1, 0
    s_mov_b32 s4, 0
    s_mov_b32 s3, 0
    s_mov_b32 s50, 0
    s_mov_b32 s5, 0
    s_mov_b32 s51, 0
    s_mov_b32 s52, 0
    s_waitcnt vmcnt(8)
    s_barrier
    s_call_b64 s[54:55], t_g1
    v_mov_b32 v24, 4
    global_load_dword v123, v24, s[98:99] sc1
    s_or_b32 s60, s2, s58
    s_cbranch_scc1 L_rw_46
    s_lshl_b32 s62, s56, 3
    s_add_u32 s62, s62, 160
    s_mov_b32 s63, 0
L_rp_47:
    s_load_dwordx2 s[60:61], s[98:99], s62 glc
    s_add_u32 s63, s63, 1
    s_cmp_gt_u32 s63, 0x100000
    s_cbranch_scc1 chain_kernel_wabort
    s_waitcnt lgkmcnt(0)
    s_cmp_lt_u32 s61, 0x2000
    s_cbranch_scc1 L_rp_47
    s_lshr_b32 s61, s95, 8
    s_cmp_eq_u32 s60, -1
    s_cselect_b32 s94, -1, s61
L_rw_46:
    s_cmp_lg_u32 s2, 0
    s_cbranch_scc1 L_rok_48
    v_mov_b32 v24, 0
    s_cmp_lg_u32 s58, 0
    s_cbranch_scc1 L_rw_49
    v_mov_b32 v25, s94
    ds_write_b32 v24, v25
    s_waitcnt lgkmcnt(0)
L_rw_49:
    s_barrier
    ds_read_b32 v25, v24
    s_waitcnt lgkmcnt(0)
    v_readfirstlane_b32 s60, v25
    s_mov_b32 s2, 1
    s_cmp_eq_u32 s60, -1
    s_cbranch_scc1 L_rok_48
    s_mov_b32 s57, s60
    s_waitcnt vmcnt(0)
    s_barrier
    s_cmp_ge_u32 s57, 32
    s_cbranch_scc1 chain_kernel_end
    s_branch L_big_37
L_rok_48:
    s_waitcnt vmcnt(0)
    s_mov_b32 s62, 0
L_pp_50:
    v_readfirstlane_b32 s59, v123
    s_and_b32 s60, s59, 0xff
    s_cmp_ge_u32 s60, 15
    s_cbranch_scc1 L_pok_51
    v_mov_b32 v24, 4
    global_load_dword v123, v24, s[98:99] sc1
    s_add_u32 s62, s62, 1
    s_cmp_gt_u32 s62, 0x200000
    s_cbranch_scc1 chain_kernel_wabort
    s_waitcnt vmcnt(0)
    s_branch L_pp_50
L_pok_51:
    s_cmp_ge_u32 s59, 0x800
    s_cselect_b32 s59, 0x2000, 0
    s_call_b64 s[54:55], t_scan
    s_add_u32 s82, s82, 4
    v_and_b32 v24, 15, v0
    v_bfe_u32 v25, v0, 7, 1
    v_lshl_add_u32 v24, v25, 6, v24
    v_lshlrev_b32 v24, 1, v24
    s_lshl_b32 s53, s82, 8
    s_mov_b32 s60, s66
    s_and_b32 s61, s67, 0xffff
    s_mov_b32 s62, 0x800
    s_mov_b32 s63, 0x00020000
    buffer_load_ushort v40, v24, s[60:63], s53 offen offset:0
    buffer_load_ushort v48, v24, s[60:63], s53 offen offset:32
    buffer_load_ushort v56, v24, s[60:63], s53 offen offset:64
    buffer_load_ushort v64, v24, s[60:63], s53 offen offset:96
    s_mov_b32 s60, s68
    s_and_b32 s61, s69, 0xffff
    s_mov_b32 s62, 0x800
    s_mov_b32 s63, 0x00020000
    buffer_load_ushort v41, v24, s[60:63], s53 offen offset:0
    buffer_load_ushort v49, v24, s[60:63], s53 offen offset:32
    buffer_load_ushort v57, v24, s[60:63], s53 offen offset:64
    buffer_load_ushort v65, v24, s[60:63], s53 offen offset:96
    s_mov_b32 s60, s78
    s_and_b32 s61, s79, 0xffff
    s_mov_b32 s62, 0x800
    s_mov_b32 s63, 0x00020000
    buffer_load_ushort v42, v24, s[60:63], s53 offen offset:0
    buffer_load_ushort v50, v24, s[60:63], s53 offen offset:32
    buffer_load_ushort v58, v24, s[60:63], s53 offen offset:64
    buffer_load_ushort v66, v24, s[60:63], s53 offen offset:96
    s_and_b32 s62, s57, 7
    s_lshr_b32 s63, s57, 3
    s_lshl_b32 s60, s63, 19
    s_add_u32 s60, s60, 0
    s_mov_b32 s30, s74
    s_and_b32 s31, s75, 0xffff
    s_mov_b32 s32, 0x200000
    s_mov_b32 s33, s60
    s_mov_b32 s34, 0x8000
    s_mov_b32 s35, 0x40000
    s_lshl_b32 s61, s62, 13
    s_andn2_b32 s61, 0x2000, s61
    s_xor_b32 s61, s61, s59
    s_lshl_b32 s60, s62, 21
    s_add_u32 s60, s60, s61
    s_add_u32 s60, s60, 0x0
    s_add_u32 s36, s100, 0xc000000
    s_addc_u32 s37, s101, 0
    s_and_b32 s37, s37, 0xffff
    s_mov_b32 s38, 0x1000000
    s_mov_b32 s39, s60
    s_mov_b32 s40, 0x800
    s_mov_b32 s41, 0x8000
    s_mov_b32 s42, 0x10000
    s_and_b32 s0, s62, 3
    s_lshl2_add_u32 s0, s63, s0
    s_mov_b64 s[86:87], s[30:31]
    s_lshl_b32 s62, s62, 16
    s_add_u32 s84, s33, s62
    s_cmp_eq_u32 s58, 0
    s_cselect_b32 s84, s84, 0x40000000
    v_bfe_u32 v24, v0, 4, 2
    v_and_b32 v25, 7, v0
    v_xor_b32 v24, v24, v25
    v_lshlrev_b32 v8, 4, v24
    v_bfe_u32 v24, v0, 3, 3
    v_lshl_add_u32 v8, v24, 11, v8
    v_bfe_u32 v24, v0, 6, 2
    v_lshl_add_u32 v8, v24, 16, v8
    v_xor_b32 v9, 64, v8
    v_add_u32 v9, 0x4000, v9
    s_lshr_b32 s61, s58, 1
    s_lshl_b32 s61, s61, 14
    v_add_u32 v10, s61, v1
    s_and_b32 s61, s58, 1
    s_lshl_b32 s61, s61, 12
    v_add_u32 v10, s61, v10
    v_add_u32 v11, 1024, v10
    s_mov_b32 s18, 0xe000000
    s_mov_b32 s4, 12
    s_mov_b32 s3, 12
    s_waitcnt vmcnt(0)
    v_lshlrev_b32 v40, 16, v40
    v_lshlrev_b32 v48, 16, v48
    v_lshlrev_b32 v56, 16, v56
    v_lshlrev_b32 v64, 16, v64
    v_lshlrev_b32 v41, 16, v41
    v_lshlrev_b32 v49, 16, v49
    v_lshlrev_b32 v57, 16, v57
    v_lshlrev_b32 v65, 16, v65
    v_lshlrev_b32 v42, 16, v42
    v_lshlrev_b32 v50, 16, v50
    v_lshlrev_b32 v58, 16, v58
    v_lshlrev_b32 v66, 16, v66
    v_mul_f32 v42, 0x3fb8aa3b, v42
    v_mul_f32 v50, 0x3fb8aa3b, v50
    v_mul_f32 v58, 0x3fb8aa3b, v58
    v_mul_f32 v66, 0x3fb8aa3b, v66
    v_exp_f32 v42, v42
    v_exp_f32 v50, v50
    v_exp_f32 v58, v58
    v_exp_f32 v66, v66
    v_cvt_pk_bf16_f32 v42, 0, v42
    v_cvt_pk_bf16_f32 v50, 0, v50
    v_cvt_pk_bf16_f32 v58, 0, v58
    v_cvt_pk_bf16_f32 v66, 0, v66
    v_mul_f32 v43, v42, v40
    v_mul_f32 v51, v50, v48
    v_mul_f32 v59, v58, v56
    v_mul_f32 v67, v66, v64
    v_mul_f32 v44, v42, v41
    v_mul_f32 v52, v50, v49
    v_mul_f32 v60, v58, v57
    v_mul_f32 v68, v66, v65
    v_mul_f32 v43, 0x3fb8aa3b, v43
    v_mul_f32 v51, 0x3fb8aa3b, v51
    v_mul_f32 v59, 0x3fb8aa3b, v59
    v_mul_f32 v67, 0x3fb8aa3b, v67
    v_exp_f32 v43, v43
    v_exp_f32 v51, v51
    v_exp_f32 v59, v59
    v_exp_f32 v67, v67
    v_mul_f32 v44, 0x3e22f983, v44
    v_mul_f32 v52, 0x3e22f983, v52
    v_mul_f32 v60, 0x3e22f983, v60
    v_mul_f32 v68, 0x3e22f983, v68
    v_fract_f32 v44, v44
    v_fract_f32 v52, v52
    v_fract_f32 v60, v60
    v_fract_f32 v68, v68
    v_cos_f32 v45, v44
    v_cos_f32 v53, v52
    v_cos_f32 v61, v60
    v_cos_f32 v69, v68
    v_sin_f32 v46, v44
    v_sin_f32 v54, v52
    v_sin_f32 v62, v60
    v_sin_f32 v70, v68
    v_mul_f32 v88, v43, v45
    v_mul_f32 v90, v51, v53
    v_mul_f32 v92, v59, v61
    v_mul_f32 v94, v67, v69
    v_mul_f32 v89, v43, v46
    v_mul_f32 v91, v51, v54
    v_mul_f32 v93, v59, v62
    v_mul_f32 v95, v67, v70
    v_add_f32 v45, -1.0, v88
    v_add_f32 v53, -1.0, v90
    v_add_f32 v61, -1.0, v92
    v_add_f32 v69, -1.0, v94
    v_mul_f32 v46, v45, v40
    v_mul_f32 v54, v53, v48
    v_mul_f32 v62, v61, v56
    v_mul_f32 v70, v69, v64
    v_fma_f32 v46, v89, v41, v46
    v_fma_f32 v54, v91, v49, v54
    v_fma_f32 v62, v93, v57, v62
    v_fma_f32 v70, v95, v65, v70
    v_mul_f32 v47, v89, v40
    v_mul_f32 v55, v91, v48
    v_mul_f32 v63, v93, v56
    v_mul_f32 v71, v95, v64
    v_fma_f32 v47, -v45, v41, v47
    v_fma_f32 v55, -v53, v49, v55
    v_fma_f32 v63, -v61, v57, v63
    v_fma_f32 v71, -v69, v65, v71
    v_mul_f32 v43, v40, v40
    v_mul_f32 v51, v48, v48
    v_mul_f32 v59, v56, v56
    v_mul_f32 v67, v64, v64
    v_fma_f32 v43, v41, v41, v43
    v_fma_f32 v51, v49, v49, v51
    v_fma_f32 v59, v57, v57, v59
    v_fma_f32 v67, v65, v65, v67
    v_rcp_f32 v43, v43
    v_rcp_f32 v51, v51
    v_rcp_f32 v59, v59
    v_rcp_f32 v67, v67
    v_add_f32 v43, v43, v43
    v_add_f32 v51, v51, v51
    v_add_f32 v59, v59, v59
    v_add_f32 v67, v67, v67
    v_mul_f32 v96, v46, v43
    v_mul_f32 v98, v54, v51
    v_mul_f32 v100, v62, v59
    v_mul_f32 v102, v70, v67
    v_mul_f32 v97, v47, v43
    v_mul_f32 v99, v55, v51
    v_mul_f32 v101, v63, v59
    v_mul_f32 v103, v71, v67
    v_pk_mul_f32 v[40:41], v[88:89], v[88:89] op_sel:[0,0] op_sel_hi:[0,1]
    v_pk_mul_f32 v[48:49], v[90:91], v[90:91] op_sel:[0,0] op_sel_hi:[0,1]
    v_pk_mul_f32 v[56:57], v[92:93], v[92:93] op_sel:[0,0] op_sel_hi:[0,1]
    v_pk_mul_f32 v[64:65], v[94:95], v[94:95] op_sel:[0,0] op_sel_hi:[0,1]
    v_pk_fma_f32 v[104:105], v[88:89], v[88:89], v[40:41] op_sel:[1,1,0] op_sel_hi:[1,0,1] neg_lo:[1,0,0]
    v_pk_fma_f32 v[106:107], v[90:91], v[90:91], v[48:49] op_sel:[1,1,0] op_sel_hi:[1,0,1] neg_lo:[1,0,0]
    v_pk_fma_f32 v[108:109], v[92:93], v[92:93], v[56:57] op_sel:[1,1,0] op_sel_hi:[1,0,1] neg_lo:[1,0,0]
    v_pk_fma_f32 v[110:111], v[94:95], v[94:95], v[64:65] op_sel:[1,1,0] op_sel_hi:[1,0,1] neg_lo:[1,0,0]
    v_pk_mul_f32 v[40:41], v[104:105], v[104:105] op_sel:[0,0] op_sel_hi:[0,1]
    v_pk_mul_f32 v[48:49], v[106:107], v[106:107] op_sel:[0,0] op_sel_hi:[0,1]
    v_pk_mul_f32 v[56:57], v[108:109], v[108:109] op_sel:[0,0] op_sel_hi:[0,1]
    v_pk_mul_f32 v[64:65], v[110:111], v[110:111] op_sel:[0,0] op_sel_hi:[0,1]
    v_pk_fma_f32 v[104:105], v[104:105], v[104:105], v[40:41] op_sel:[1,1,0] op_sel_hi:[1,0,1] neg_lo:[1,0,0]
    v_pk_fma_f32 v[106:107], v[106:107], v[106:107], v[48:49] op_sel:[1,1,0] op_sel_hi:[1,0,1] neg_lo:[1,0,0]
    v_pk_fma_f32 v[108:109], v[108:109], v[108:109], v[56:57] op_sel:[1,1,0] op_sel_hi:[1,0,1] neg_lo:[1,0,0]
    v_pk_fma_f32 v[110:111], v[110:111], v[110:111], v[64:65] op_sel:[1,1,0] op_sel_hi:[1,0,1] neg_lo:[1,0,0]
    v_pk_mul_f32 v[40:41], v[104:105], v[104:105] op_sel:[0,0] op_sel_hi:[0,1]
    v_pk_mul_f32 v[48:49], v[106:107], v[106:107] op_sel:[0,0] op_sel_hi:[0,1]
    v_pk_mul_f32 v[56:57], v[108:109], v[108:109] op_sel:[0,0] op_sel_hi:[0,1]
    v_pk_mul_f32 v[64:65], v[110:111], v[110:111] op_sel:[0,0] op_sel_hi:[0,1]
    v_pk_fma_f32 v[104:105], v[104:105], v[104:105], v[40:41] op_sel:[1,1,0] op_sel_hi:[1,0,1] neg_lo:[1,0,0]
    v_pk_fma_f32 v[106:107], v[106:107], v[106:107], v[48:49] op_sel:[1,1,0] op_sel_hi:[1,0,1] neg_lo:[1,0,0]
    v_pk_fma_f32 v[108:109], v[108:109], v[108:109], v[56:57] op_sel:[1,1,0] op_sel_hi:[1,0,1] neg_lo:[1,0,0]
    v_pk_fma_f32 v[110:111], v[110:111], v[110:111], v[64:65] op_sel:[1,1,0] op_sel_hi:[1,0,1] neg_lo:[1,0,0]
    v_pk_mul_f32 v[40:41], v[104:105], v[104:105] op_sel:[0,0] op_sel_hi:[0,1]
    v_pk_mul_f32 v[48:49], v[106:107], v[106:107] op_sel:[0,0] op_sel_hi:[0,1]
    v_pk_mul_f32 v[56:57], v[108:109], v[108:109] op_sel:[0,0] op_sel_hi:[0,1]
    v_pk_mul_f32 v[64:65], v[110:111], v[110:111] op_sel:[0,0] op_sel_hi:[0,1]
    v_pk_fma_f32 v[104:105], v[104:105], v[104:105], v[40:41] op_sel:[1,1,0] op_sel_hi:[1,0,1] neg_lo:[1,0,0]
    v_pk_fma_f32 v[106:107], v[106:107], v[106:107], v[48:49] op_sel:[1,1,0] op_sel_hi:[1,0,1] neg_lo:[1,0,0]
    v_pk_fma_f32 v[108:109], v[108:109], v[108:109], v[56:57] op_sel:[1,1,0] op_sel_hi:[1,0,1] neg_lo:[1,0,0]
    v_pk_fma_f32 v[110:111], v[110:111], v[110:111], v[64:65] op_sel:[1,1,0] op_sel_hi:[1,0,1] neg_lo:[1,0,0]
    v_pk_mul_f32 v[40:41], v[104:105], v[104:105] op_sel:[0,0] op_sel_hi:[0,1]
    v_pk_mul_f32 v[48:49], v[106:107], v[106:107] op_sel:[0,0] op_sel_hi:[0,1]
    v_pk_mul_f32 v[56:57], v[108:109], v[108:109] op_sel:[0,0] op_sel_hi:[0,1]
    v_pk_mul_f32 v[64:65], v[110:111], v[110:111] op_sel:[0,0] op_sel_hi:[0,1]
    v_pk_fma_f32 v[104:105], v[104:105], v[104:105], v[40:41] op_sel:[1,1,0] op_sel_hi:[1,0,1] neg_lo:[1,0,0]
    v_pk_fma_f32 v[106:107], v[106:107], v[106:107], v[48:49] op_sel:[1,1,0] op_sel_hi:[1,0,1] neg_lo:[1,0,0]
    v_pk_fma_f32 v[108:109], v[108:109], v[108:109], v[56:57] op_sel:[1,1,0] op_sel_hi:[1,0,1] neg_lo:[1,0,0]
    v_pk_fma_f32 v[110:111], v[110:111], v[110:111], v[64:65] op_sel:[1,1,0] op_sel_hi:[1,0,1] neg_lo:[1,0,0]
    v_pk_mul_f32 v[40:41], v[104:105], v[104:105] op_sel:[0,0] op_sel_hi:[0,1]
    v_pk_mul_f32 v[48:49], v[106:107], v[106:107] op_sel:[0,0] op_sel_hi:[0,1]
    v_pk_mul_f32 v[56:57], v[108:109], v[108:109] op_sel:[0,0] op_sel_hi:[0,1]
    v_pk_mul_f32 v[64:65], v[110:111], v[110:111] op_sel:[0,0] op_sel_hi:[0,1]
    v_pk_fma_f32 v[112:113], v[104:105], v[104:105], v[40:41] op_sel:[1,1,0] op_sel_hi:[1,0,1] neg_lo:[1,0,0]
    v_pk_fma_f32 v[114:115], v[106:107], v[106:107], v[48:49] op_sel:[1,1,0] op_sel_hi:[1,0,1] neg_lo:[1,0,0]
    v_pk_fma_f32 v[116:117], v[108:109], v[108:109], v[56:57] op_sel:[1,1,0] op_sel_hi:[1,0,1] neg_lo:[1,0,0]
    v_pk_fma_f32 v[118:119], v[110:111], v[110:111], v[64:65] op_sel:[1,1,0] op_sel_hi:[1,0,1] neg_lo:[1,0,0]
    v_pk_mul_f32 v[40:41], v[112:113], v[112:113] op_sel:[0,0] op_sel_hi:[0,1]
    v_pk_mul_f32 v[48:49], v[114:115], v[114:115] op_sel:[0,0] op_sel_hi:[0,1]
    v_pk_mul_f32 v[56:57], v[116:117], v[116:117] op_sel:[0,0] op_sel_hi:[0,1]
    v_pk_mul_f32 v[64:65], v[118:119], v[118:119] op_sel:[0,0] op_sel_hi:[0,1]
    v_pk_fma_f32 v[44:45], v[112:113], v[112:113], v[40:41] op_sel:[1,1,0] op_sel_hi:[1,0,1] neg_lo:[1,0,0]
    v_pk_fma_f32 v[52:53], v[114:115], v[114:115], v[48:49] op_sel:[1,1,0] op_sel_hi:[1,0,1] neg_lo:[1,0,0]
    v_pk_fma_f32 v[60:61], v[116:117], v[116:117], v[56:57] op_sel:[1,1,0] op_sel_hi:[1,0,1] neg_lo:[1,0,0]
    v_pk_fma_f32 v[68:69], v[118:119], v[118:119], v[64:65] op_sel:[1,1,0] op_sel_hi:[1,0,1] neg_lo:[1,0,0]
    s_mov_b32 exec_lo, 0xffffffff
    s_mov_b32 exec_hi, 0xffffffff
    v_mov_b32 v120, v44
    v_mov_b32 v121, v45
    s_mov_b32 exec_lo, 0xffff0000
    s_mov_b32 exec_hi, 0xffffffff
    v_mov_b32 v120, v52
    v_mov_b32 v121, v53
    s_mov_b32 exec_lo, 0x0
    s_mov_b32 exec_hi, 0xffffffff
    v_mov_b32 v120, v60
    v_mov_b32 v121, v61
    s_mov_b32 exec_lo, 0x0
    s_mov_b32 exec_hi, 0xffff0000
    v_mov_b32 v120, v68
    v_mov_b32 v121, v69
    s_mov_b64 exec, -1
    s_call_b64 s[54:55], t_g1
    s_call_b64 s[54:55], t_scan
    s_and_b32 s62, s57, 7
    s_lshr_b32 s63, s57, 3
    s_lshl_b32 s60, s63, 19
    s_add_u32 s60, s60, 0
    s_mov_b32 s30, s76
    s_and_b32 s31, s77, 0xffff
    s_mov_b32 s32, 0x200000
    s_mov_b32 s33, s60
    s_mov_b32 s34, 0x8000
    s_mov_b32 s35, 0x40000
    s_lshl_b32 s61, s62, 13
    s_andn2_b32 s61, 0x2000, s61
    s_xor_b32 s61, s61, s59
    s_lshl_b32 s60, s62, 21
    s_add_u32 s60, s60, s61
    s_add_u32 s60, s60, 0x80000
    s_add_u32 s36, s100, 0xc000000
    s_addc_u32 s37, s101, 0
    s_and_b32 s37, s37, 0xffff
    s_mov_b32 s38, 0x1000000
    s_mov_b32 s39, s60
    s_mov_b32 s40, 0x800
    s_mov_b32 s41, 0x8000
    s_mov_b32 s42, 0x10000
    s_and_b32 s0, s62, 3
    s_lshl2_add_u32 s0, s63, s0
    s_mov_b64 s[86:87], s[30:31]
    s_lshl_b32 s62, s62, 16
    s_add_u32 s84, s33, s62
    s_cmp_eq_u32 s58, 0
    s_cselect_b32 s84, s84, 0x40000000
    s_mov_b32 s3, 0
    s_call_b64 s[54:55], t_g2
    s_and_b32 s62, s57, 7
    s_lshr_b32 s63, s57, 3
    s_lshl_b32 s60, s63, 19
    s_add_u32 s60, s60, 1024
    s_mov_b32 s30, s74
    s_and_b32 s31, s75, 0xffff
    s_mov_b32 s32, 0x200000
    s_mov_b32 s33, s60
    s_mov_b32 s34, 0x8000
    s_mov_b32 s35, 0x40000
    s_lshl_b32 s61, s62, 13
    s_andn2_b32 s61, 0x2000, s61
    s_xor_b32 s61, s61, s59
    s_lshl_b32 s60, s62, 21
    s_add_u32 s60, s60, s61
    s_add_u32 s60, s60, 0x100000
    s_add_u32 s36, s100, 0xc000000
    s_addc_u32 s37, s101, 0
    s_and_b32 s37, s37, 0xffff
    s_mov_b32 s38, 0x1000000
    s_mov_b32 s39, s60
    s_mov_b32 s40, 0x800
    s_mov_b32 s41, 0x8000
    s_mov_b32 s42, 0x10000
    s_and_b32 s0, s62, 3
    s_lshl2_add_u32 s0, s63, s0
    s_mov_b64 s[86:87], s[30:31]
    s_lshl_b32 s62, s62, 16
    s_add_u32 s84, s33, s62
    s_cmp_eq_u32 s58, 0
    s_cselect_b32 s84, s84, 0x40000000
    s_mov_b32 s18, 0
    s_cmp_eq_u32 s58, 0
    s_cselect_b32 s1, 16, 0
    s_mov_b32 s3, 16
    s_call_b64 s[54:55], t_g2_c
    s_and_b32 s62, s57, 7
    s_lshr_b32 s63, s57, 3
    s_lshl_b32 s60, s63, 19
    s_add_u32 s60, s60, 1024
    s_mov_b32 s30, s76
    s_and_b32 s31, s77, 0xffff
    s_mov_b32 s32, 0x200000
    s_mov_b32 s33, s60
    s_mov_b32 s34, 0x8000
    s_mov_b32 s35, 0x40000
    s_lshl_b32 s61, s62, 13
    s_andn2_b32 s61, 0x2000, s61
    s_xor_b32 s61, s61, s59
    s_lshl_b32 s60, s62, 21
    s_add_u32 s60, s60, s61
    s_add_u32 s60, s60, 0x180000
    s_add_u32 s36, s100, 0xc000000
    s_addc_u32 s37, s101, 0
    s_and_b32 s37, s37, 0xffff
    s_mov_b32 s38, 0x1000000
    s_mov_b32 s39, s60
    s_mov_b32 s40, 0x800
    s_mov_b32 s41, 0x8000
    s_mov_b32 s42, 0x10000
    s_and_b32 s0, s62, 3
    s_lshl2_add_u32 s0, s63, s0
    s_mov_b64 s[86:87], s[30:31]
    s_lshl_b32 s62, s62, 16
    s_add_u32 s84, s33, s62
    s_cmp_eq_u32 s58, 0
    s_cselect_b32 s84, s84, 0x40000000
    s_mov_b32 s3, 0
    s_call_b64 s[54:55], t_g2_c
    s_mov_b32 s32, 0
    s_mov_b32 s38, 0
    s_mov_b32 s84, 0x40000000
    s_call_b64 s[54:55], t_g2_c
    s_and_b32 s85, s57, 7
    s_lshr_b32 s82, s57, 3
    s_waitcnt vmcnt(0)
    s_barrier
    v_and_b32 v26, 31, v0
    v_bfe_u32 v25, v0, 6, 1
    v_lshl_add_u32 v27, v25, 5, v26
    v_bfe_u32 v28, v0, 5, 1
    v_bfe_u32 v24, v0, 7, 1
    v_lshl_add_u32 v24, v24, 7, v28
    v_lshlrev_b32 v25, 13, v24
    v_lshl_add_u32 v25, v27, 4, v25
    v_lshlrev_b32 v24, 11, v24
    v_lshl_add_u32 v24, v27, 3, v24
    v_lshlrev_b32 v27, 3, v27
    s_mov_b32 s60, s80
    s_and_b32 s61, s81, 0xffff
    s_mov_b32 s62, 0x800
    s_mov_b32 s63, 0x00020000
    s_lshl_b32 s53, s82, 9
    buffer_load_dwordx2 v[44:45], v27, s[60:63], s53 offen
    s_mov_b32 s8, s64
    s_and_b32 s9, s65, 0xffff
    s_mov_b32 s10, 0x400000
    s_mov_b32 s11, 0x00020000
    s_mov_b32 s12, s96
    s_and_b32 s13, s97, 0xffff
    s_mov_b32 s14, 0x1000000
    s_mov_b32 s15, 0x00020000
    s_lshl_b32 s50, s85, 19
    s_add_u32 s50, s50, s53
    s_add_u32 s53, s50, 0x0
    buffer_load_dwordx2 v[128:129], v24, s[8:11], s53 offen
    s_add_u32 s53, s50, 0x1000
    buffer_load_dwordx2 v[130:131], v24, s[8:11], s53 offen
    s_add_u32 s53, s50, 0x2000
    buffer_load_dwordx2 v[132:133], v24, s[8:11], s53 offen
    s_add_u32 s53, s50, 0x3000
    buffer_load_dwordx2 v[134:135], v24, s[8:11], s53 offen
    s_add_u32 s53, s50, 0x10000
    buffer_load_dwordx2 v[136:137], v24, s[8:11], s53 offen
    s_add_u32 s53, s50, 0x11000
    buffer_load_dwordx2 v[138:139], v24, s[8:11], s53 offen
    s_add_u32 s53, s50, 0x12000
    buffer_load_dwordx2 v[140:141], v24, s[8:11], s53 offen
    s_add_u32 s53, s50, 0x13000
    buffer_load_dwordx2 v[142:143], v24, s[8:11], s53 offen
    s_add_u32 s53, s50, 0x20000
    buffer_load_dwordx2 v[144:145], v24, s[8:11], s53 offen
    s_add_u32 s53, s50, 0x21000
    buffer_load_dwordx2 v[146:147], v24, s[8:11], s53 offen
    s_add_u32 s53, s50, 0x22000
    buffer_load_dwordx2 v[148:149], v24, s[8:11], s53 offen
    s_add_u32 s53, s50, 0x23000
    buffer_load_dwordx2 v[150:151], v24, s[8:11], s53 offen
    s_add_u32 s53, s50, 0x30000
    buffer_load_dwordx2 v[152:153], v24, s[8:11], s53 offen
    s_add_u32 s53, s50, 0x31000
    buffer_load_dwordx2 v[154:155], v24, s[8:11], s53 offen
    s_add_u32 s53, s50, 0x32000
    buffer_load_dwordx2 v[156:157], v24, s[8:11], s53 offen
    s_add_u32 s53, s50, 0x33000
    buffer_load_dwordx2 v[158:159], v24, s[8:11], s53 offen
    s_add_u32 s53, s50, 0x4000
    buffer_load_dwordx2 v[160:161], v24, s[8:11], s53 offen
    s_add_u32 s53, s50, 0x5000
    buffer_load_dwordx2 v[162:163], v24, s[8:11], s53 offen
    s_add_u32 s53, s50, 0x6000
    buffer_load_dwordx2 v[164:165], v24, s[8:11], s53 offen
    s_add_u32 s53, s50, 0x7000
    buffer_load_dwordx2 v[166:167], v24, s[8:11], s53 offen
    s_add_u32 s53, s50, 0x14000
    buffer_load_dwordx2 v[168:169], v24, s[8:11], s53 offen
    s_add_u32 s53, s50, 0x15000
    buffer_load_dwordx2 v[170:171], v24, s[8:11], s53 offen
    s_add_u32 s53, s50, 0x16000
    buffer_load_dwordx2 v[172:173], v24, s[8:11], s53 offen
    s_add_u32 s53, s50, 0x17000
    buffer_load_dwordx2 v[174:175], v24, s[8:11], s53 offen
    s_add_u32 s53, s50, 0x24000
    buffer_load_dwordx2 v[176:177], v24, s[8:11], s53 offen
    s_add_u32 s53, s50, 0x25000
    buffer_load_dwordx2 v[178:179], v24, s[8:11], s53 offen
    s_add_u32 s53, s50, 0x26000
    buffer_load_dwordx2 v[180:181], v24, s[8:11], s53 offen
    s_add_u32 s53, s50, 0x27000
    buffer_load_dwordx2 v[182:183], v24, s[8:11], s53 offen
    s_add_u32 s53, s50, 0x34000
    buffer_load_dwordx2 v[184:185], v24, s[8:11], s53 offen
    s_add_u32 s53, s50, 0x35000
    buffer_load_dwordx2 v[186:187], v24, s[8:11], s53 offen
    s_add_u32 s53, s50, 0x36000
    buffer_load_dwordx2 v[188:189], v24, s[8:11], s53 offen
    s_add_u32 s53, s50, 0x37000
    buffer_load_dwordx2 v[190:191], v24, s[8:11], s53 offen
    s_mul_i32 s60, s58, 33792
    v_mul_u32_u24 v28, 528, v28
    v_lshl_add_u32 v28, v26, 4, v28
    v_add_u32 v28, s60, v28
    v_and_b32 v27, 15, v0
    v_mul_u32_u24 v27, 528, v27
    v_bfe_u32 v26, v0, 4, 2
    v_lshl_add_u32 v27, v26, 4, v27
    v_add_u32 v27, s60, v27
    s_lshl_b32 s51, s85, 21
    s_lshl_b32 s52, s82, 10
    s_add_u32 s51, s51, s52
    ds_write_b128 v27, a[0:3] offset:0
    ds_write_b128 v27, a[32:35] offset:64
    ds_write_b128 v27, a[64:67] offset:128
    ds_write_b128 v27, a[96:99] offset:192
    ds_write_b128 v27, a[128:131] offset:256
    ds_write_b128 v27, a[160:163] offset:320
    ds_write_b128 v27, a[192:195] offset:384
    ds_write_b128 v27, a[224:227] offset:448
    ds_read_b128 v[48:51], v28 offset:0
    ds_read_b128 v[52:55], v28 offset:1056
    ds_read_b128 v[56:59], v28 offset:2112
    ds_read_b128 v[60:63], v28 offset:3168
    ds_read_b128 v[64:67], v28 offset:4224
    ds_read_b128 v[68:71], v28 offset:5280
    ds_read_b128 v[72:75], v28 offset:6336
    ds_read_b128 v[76:79], v28 offset:7392
    ds_write_b128 v27, a[4:7] offset:8448
    ds_write_b128 v27, a[36:39] offset:8512
    ds_write_b128 v27, a[68:71] offset:8576
    ds_write_b128 v27, a[100:103] offset:8640
    ds_write_b128 v27, a[132:135] offset:8704
    ds_write_b128 v27, a[164:167] offset:8768
    ds_write_b128 v27, a[196:199] offset:8832
    ds_write_b128 v27, a[228:231] offset:8896
    s_waitcnt vmcnt(32)
    v_lshlrev_b32 v40, 16, v44
    v_and_b32 v41, 0xffff0000, v44
    v_lshlrev_b32 v42, 16, v45
    v_and_b32 v43, 0xffff0000, v45
    s_waitcnt vmcnt(24) lgkmcnt(8)
    ds_read_b128 v[80:83], v28 offset:8448
    ds_read_b128 v[84:87], v28 offset:9504
    ds_read_b128 v[88:91], v28 offset:10560
    ds_read_b128 v[92:95], v28 offset:11616
    ds_read_b128 v[96:99], v28 offset:12672
    ds_read_b128 v[100:103], v28 offset:13728
    ds_read_b128 v[104:107], v28 offset:14784
    ds_read_b128 v[108:111], v28 offset:15840
    ds_write_b128 v27, a[8:11] offset:16896
    ds_write_b128 v27, a[40:43] offset:16960
    ds_write_b128 v27, a[72:75] offset:17024
    ds_write_b128 v27, a[104:107] offset:17088
    ds_write_b128 v27, a[136:139] offset:17152
    ds_write_b128 v27, a[168:171] offset:17216
    ds_write_b128 v27, a[200:203] offset:17280
    ds_write_b128 v27, a[232:235] offset:17344
    v_lshlrev_b32 v112, 16, v128
    v_and_b32 v113, 0xffff0000, v128
    v_lshlrev_b32 v114, 16, v129
    v_and_b32 v115, 0xffff0000, v129
    v_pk_mul_f32 v[112:113], v[112:113], v[40:41]
    v_pk_mul_f32 v[114:115], v[114:115], v[42:43]
    s_add_u32 s52, s51, 0x0
    v_cvt_pk_bf16_f32 v112, 0, v112
    v_cvt_pk_bf16_f32 v113, 0, v113
    v_cvt_pk_bf16_f32 v114, 0, v114
    v_cvt_pk_bf16_f32 v115, 0, v115
    v_pk_add_f32 v[48:49], v[48:49], v[112:113]
    v_pk_add_f32 v[50:51], v[50:51], v[114:115]
    buffer_store_dwordx4 v[48:51], v25, s[12:15], s52 offen
    v_lshlrev_b32 v116, 16, v130
    v_and_b32 v117, 0xffff0000, v130
    v_lshlrev_b32 v118, 16, v131
    v_and_b32 v119, 0xffff0000, v131
    v_pk_mul_f32 v[116:117], v[116:117], v[40:41]
    v_pk_mul_f32 v[118:119], v[118:119], v[42:43]
    s_add_u32 s52, s51, 0x4000
    v_cvt_pk_bf16_f32 v116, 0, v116
    v_cvt_pk_bf16_f32 v117, 0, v117
    v_cvt_pk_bf16_f32 v118, 0, v118
    v_cvt_pk_bf16_f32 v119, 0, v119
    v_pk_add_f32 v[52:53], v[52:53], v[116:117]
    v_pk_add_f32 v[54:55], v[54:55], v[118:119]
    buffer_store_dwordx4 v[52:55], v25, s[12:15], s52 offen
    v_lshlrev_b32 v112, 16, v132
    v_and_b32 v113, 0xffff0000, v132
    v_lshlrev_b32 v114, 16, v133
    v_and_b32 v115, 0xffff0000, v133
    v_pk_mul_f32 v[112:113], v[112:113], v[40:41]
    v_pk_mul_f32 v[114:115], v[114:115], v[42:43]
    s_add_u32 s52, s51, 0x8000
    v_cvt_pk_bf16_f32 v112, 0, v112
    v_cvt_pk_bf16_f32 v113, 0, v113
    v_cvt_pk_bf16_f32 v114, 0, v114
    v_cvt_pk_bf16_f32 v115, 0, v115
    v_pk_add_f32 v[56:57], v[56:57], v[112:113]
    v_pk_add_f32 v[58:59], v[58:59], v[114:115]
    buffer_store_dwordx4 v[56:59], v25, s[12:15], s52 offen
    v_lshlrev_b32 v116, 16, v134
    v_and_b32 v117, 0xffff0000, v134
    v_lshlrev_b32 v118, 16, v135
    v_and_b32 v119, 0xffff0000, v135
    v_pk_mul_f32 v[116:117], v[116:117], v[40:41]
    v_pk_mul_f32 v[118:119], v[118:119], v[42:43]
    s_add_u32 s52, s51, 0xc000
    v_cvt_pk_bf16_f32 v116, 0, v116
    v_cvt_pk_bf16_f32 v117, 0, v117
    v_cvt_pk_bf16_f32 v118, 0, v118
    v_cvt_pk_bf16_f32 v119, 0, v119
    v_pk_add_f32 v[60:61], v[60:61], v[116:117]
    v_pk_add_f32 v[62:63], v[62:63], v[118:119]
    buffer_store_dwordx4 v[60:63], v25, s[12:15], s52 offen
    v_lshlrev_b32 v112, 16, v136
    v_and_b32 v113, 0xffff0000, v136
    v_lshlrev_b32 v114, 16, v137
    v_and_b32 v115, 0xffff0000, v137
    v_pk_mul_f32 v[112:113], v[112:113], v[40:41]
    v_pk_mul_f32 v[114:115], v[114:115], v[42:43]
    s_add_u32 s52, s51, 0x40000
    v_cvt_pk_bf16_f32 v112, 0, v112
    v_cvt_pk_bf16_f32 v113, 0, v113
    v_cvt_pk_bf16_f32 v114, 0, v114
    v_cvt_pk_bf16_f32 v115, 0, v115
    v_pk_add_f32 v[64:65], v[64:65], v[112:113]
    v_pk_add_f32 v[66:67], v[66:67], v[114:115]
    buffer_store_dwordx4 v[64:67], v25, s[12:15], s52 offen
    v_lshlrev_b32 v116, 16, v138
    v_and_b32 v117, 0xffff0000, v138
    v_lshlrev_b32 v118, 16, v139
    v_and_b32 v119, 0xffff0000, v139
    v_pk_mul_f32 v[116:117], v[116:117], v[40:41]
    v_pk_mul_f32 v[118:119], v[118:119], v[42:43]
    s_add_u32 s52, s51, 0x44000
    v_cvt_pk_bf16_f32 v116, 0, v116
    v_cvt_pk_bf16_f32 v117, 0, v117
    v_cvt_pk_bf16_f32 v118, 0, v118
    v_cvt_pk_bf16_f32 v119, 0, v119
    v_pk_add_f32 v[68:69], v[68:69], v[116:117]
    v_pk_add_f32 v[70:71], v[70:71], v[118:119]
    buffer_store_dwordx4 v[68:71], v25, s[12:15], s52 offen
    v_lshlrev_b32 v112, 16, v140
    v_and_b32 v113, 0xffff0000, v140
    v_lshlrev_b32 v114, 16, v141
    v_and_b32 v115, 0xffff0000, v141
    v_pk_mul_f32 v[112:113], v[112:113], v[40:41]
    v_pk_mul_f32 v[114:115], v[114:115], v[42:43]
    s_add_u32 s52, s51, 0x48000
    v_cvt_pk_bf16_f32 v112, 0, v112
    v_cvt_pk_bf16_f32 v113, 0, v113
    v_cvt_pk_bf16_f32 v114, 0, v114
    v_cvt_pk_bf16_f32 v115, 0, v115
    v_pk_add_f32 v[72:73], v[72:73], v[112:113]
    v_pk_add_f32 v[74:75], v[74:75], v[114:115]
    buffer_store_dwordx4 v[72:75], v25, s[12:15], s52 offen
    v_lshlrev_b32 v116, 16, v142
    v_and_b32 v117, 0xffff0000, v142
    v_lshlrev_b32 v118, 16, v143
    v_and_b32 v119, 0xffff0000, v143
    v_pk_mul_f32 v[116:117], v[116:117], v[40:41]
    v_pk_mul_f32 v[118:119], v[118:119], v[42:43]
    s_add_u32 s52, s51, 0x4c000
    v_cvt_pk_bf16_f32 v116, 0, v116
    v_cvt_pk_bf16_f32 v117, 0, v117
    v_cvt_pk_bf16_f32 v118, 0, v118
    v_cvt_pk_bf16_f32 v119, 0, v119
    v_pk_add_f32 v[76:77], v[76:77], v[116:117]
    v_pk_add_f32 v[78:79], v[78:79], v[118:119]
    buffer_store_dwordx4 v[76:79], v25, s[12:15], s52 offen
    s_add_u32 s53, s50, 0x8000
    buffer_load_dwordx2 v[192:193], v24, s[8:11], s53 offen
    s_add_u32 s53, s50, 0x9000
    buffer_load_dwordx2 v[194:195], v24, s[8:11], s53 offen
    s_add_u32 s53, s50, 0xa000
    buffer_load_dwordx2 v[196:197], v24, s[8:11], s53 offen
    s_add_u32 s53, s50, 0xb000
    buffer_load_dwordx2 v[198:199], v24, s[8:11], s53 offen
    s_add_u32 s53, s50, 0x18000
    buffer_load_dwordx2 v[200:201], v24, s[8:11], s53 offen
    s_add_u32 s53, s50, 0x19000
    buffer_load_dwordx2 v[202:203], v24, s[8:11], s53 offen
    s_add_u32 s53, s50, 0x1a000
    buffer_load_dwordx2 v[204:205], v24, s[8:11], s53 offen
    s_add_u32 s53, s50, 0x1b000
    buffer_load_dwordx2 v[206:207], v24, s[8:11], s53 offen
    s_waitcnt vmcnt(32) lgkmcnt(8)
    ds_read_b128 v[48:51], v28 offset:16896
    ds_read_b128 v[52:55], v28 offset:17952
    ds_read_b128 v[56:59], v28 offset:19008
    ds_read_b128 v[60:63], v28 offset:20064
    ds_read_b128 v[64:67], v28 offset:21120
    ds_read_b128 v[68:71], v28 offset:22176
    ds_read_b128 v[72:75], v28 offset:23232
    ds_read_b128 v[76:79], v28 offset:24288
    ds_write_b128 v27, a[12:15] offset:25344
    ds_write_b128 v27, a[44:47] offset:25408
    ds_write_b128 v27, a[76:79] offset:25472
    ds_write_b128 v27, a[108:111] offset:25536
    ds_write_b128 v27, a[140:143] offset:25600
    ds_write_b128 v27, a[172:175] offset:25664
    ds_write_b128 v27, a[204:207] offset:25728
    ds_write_b128 v27, a[236:239] offset:25792
    v_lshlrev_b32 v112, 16, v144
    v_and_b32 v113, 0xffff0000, v144
    v_lshlrev_b32 v114, 16, v145
    v_and_b32 v115, 0xffff0000, v145
    v_pk_mul_f32 v[112:113], v[112:113], v[40:41]
    v_pk_mul_f32 v[114:115], v[114:115], v[42:43]
    s_add_u32 s52, s51, 0x80000
    v_cvt_pk_bf16_f32 v112, 0, v112
    v_cvt_pk_bf16_f32 v113, 0, v113
    v_cvt_pk_bf16_f32 v114, 0, v114
    v_cvt_pk_bf16_f32 v115, 0, v115
    v_pk_add_f32 v[80:81], v[80:81], v[112:113]
    v_pk_add_f32 v[82:83], v[82:83], v[114:115]
    buffer_store_dwordx4 v[80:83], v25, s[12:15], s52 offen
    v_lshlrev_b32 v116, 16, v146
    v_and_b32 v117, 0xffff0000, v146
    v_lshlrev_b32 v118, 16, v147
    v_and_b32 v119, 0xffff0000, v147
    v_pk_mul_f32 v[116:117], v[116:117], v[40:41]
    v_pk_mul_f32 v[118:119], v[118:119], v[42:43]
    s_add_u32 s52, s51, 0x84000
    v_cvt_pk_bf16_f32 v116, 0, v116
    v_cvt_pk_bf16_f32 v117, 0, v117
    v_cvt_pk_bf16_f32 v118, 0, v118
    v_cvt_pk_bf16_f32 v119, 0, v119
    v_pk_add_f32 v[84:85], v[84:85], v[116:117]
    v_pk_add_f32 v[86:87], v[86:87], v[118:119]
    buffer_store_dwordx4 v[84:87], v25, s[12:15], s52 offen
    v_lshlrev_b32 v112, 16, v148
    v_and_b32 v113, 0xffff0000, v148
    v_lshlrev_b32 v114, 16, v149
    v_and_b32 v115, 0xffff0000, v149
    v_pk_mul_f32 v[112:113], v[112:113], v[40:41]
    v_pk_mul_f32 v[114:115], v[114:115], v[42:43]
    s_add_u32 s52, s51, 0x88000
    v_cvt_pk_bf16_f32 v112, 0, v112
    v_cvt_pk_bf16_f32 v113, 0, v113
    v_cvt_pk_bf16_f32 v114, 0, v114
    v_cvt_pk_bf16_f32 v115, 0, v115
    v_pk_add_f32 v[88:89], v[88:89], v[112:113]
    v_pk_add_f32 v[90:91], v[90:91], v[114:115]
    buffer_store_dwordx4 v[88:91], v25, s[12:15], s52 offen
    v_lshlrev_b32 v116, 16, v150
    v_and_b32 v117, 0xffff0000, v150
    v_lshlrev_b32 v118, 16, v151
    v_and_b32 v119, 0xffff0000, v151
    v_pk_mul_f32 v[116:117], v[116:117], v[40:41]
    v_pk_mul_f32 v[118:119], v[118:119], v[42:43]
    s_add_u32 s52, s51, 0x8c000
    v_cvt_pk_bf16_f32 v116, 0, v116
    v_cvt_pk_bf16_f32 v117, 0, v117
    v_cvt_pk_bf16_f32 v118, 0, v118
    v_cvt_pk_bf16_f32 v119, 0, v119
    v_pk_add_f32 v[92:93], v[92:93], v[116:117]
    v_pk_add_f32 v[94:95], v[94:95], v[118:119]
    buffer_store_dwordx4 v[92:95], v25, s[12:15], s52 offen
    v_lshlrev_b32 v112, 16, v152
    v_and_b32 v113, 0xffff0000, v152
    v_lshlrev_b32 v114, 16, v153
    v_and_b32 v115, 0xffff0000, v153
    v_pk_mul_f32 v[112:113], v[112:113], v[40:41]
    v_pk_mul_f32 v[114:115], v[114:115], v[42:43]
    s_add_u32 s52, s51, 0xc0000
    v_cvt_pk_bf16_f32 v112, 0, v112
    v_cvt_pk_bf16_f32 v113, 0, v113
    v_cvt_pk_bf16_f32 v114, 0, v114
    v_cvt_pk_bf16_f32 v115, 0, v115
    v_pk_add_f32 v[96:97], v[96:97], v[112:113]
    v_pk_add_f32 v[98:99], v[98:99], v[114:115]
    buffer_store_dwordx4 v[96:99], v25, s[12:15], s52 offen
    v_lshlrev_b32 v116, 16, v154
    v_and_b32 v117, 0xffff0000, v154
    v_lshlrev_b32 v118, 16, v155
    v_and_b32 v119, 0xffff0000, v155
    v_pk_mul_f32 v[116:117], v[116:117], v[40:41]
    v_pk_mul_f32 v[118:119], v[118:119], v[42:43]
    s_add_u32 s52, s51, 0xc4000
    v_cvt_pk_bf16_f32 v116, 0, v116
    v_cvt_pk_bf16_f32 v117, 0, v117
    v_cvt_pk_bf16_f32 v118, 0, v118
    v_cvt_pk_bf16_f32 v119, 0, v119
    v_pk_add_f32 v[100:101], v[100:101], v[116:117]
    v_pk_add_f32 v[102:103], v[102:103], v[118:119]
    buffer_store_dwordx4 v[100:103], v25, s[12:15], s52 offen
    v_lshlrev_b32 v112, 16, v156
    v_and_b32 v113, 0xffff0000, v156
    v_lshlrev_b32 v114, 16, v157
    v_and_b32 v115, 0xffff0000, v157
    v_pk_mul_f32 v[112:113], v[112:113], v[40:41]
    v_pk_mul_f32 v[114:115], v[114:115], v[42:43]
    s_add_u32 s52, s51, 0xc8000
    v_cvt_pk_bf16_f32 v112, 0, v112
    v_cvt_pk_bf16_f32 v113, 0, v113
    v_cvt_pk_bf16_f32 v114, 0, v114
    v_cvt_pk_bf16_f32 v115, 0, v115
    v_pk_add_f32 v[104:105], v[104:105], v[112:113]
    v_pk_add_f32 v[106:107], v[106:107], v[114:115]
    buffer_store_dwordx4 v[104:107], v25, s[12:15], s52 offen
    v_lshlrev_b32 v116, 16, v158
    v_and_b32 v117, 0xffff0000, v158
    v_lshlrev_b32 v118, 16, v159
    v_and_b32 v119, 0xffff0000, v159
    v_pk_mul_f32 v[116:117], v[116:117], v[40:41]
    v_pk_mul_f32 v[118:119], v[118:119], v[42:43]
    s_add_u32 s52, s51, 0xcc000
    v_cvt_pk_bf16_f32 v116, 0, v116
    v_cvt_pk_bf16_f32 v117, 0, v117
    v_cvt_pk_bf16_f32 v118, 0, v118
    v_cvt_pk_bf16_f32 v119, 0, v119
    v_pk_add_f32 v[108:109], v[108:109], v[116:117]
    v_pk_add_f32 v[110:111], v[110:111], v[118:119]
    buffer_store_dwordx4 v[108:111], v25, s[12:15], s52 offen
    s_add_u32 s53, s50, 0x28000
    buffer_load_dwordx2 v[208:209], v24, s[8:11], s53 offen
    s_add_u32 s53, s50, 0x29000
    buffer_load_dwordx2 v[210:211], v24, s[8:11], s53 offen
    s_add_u32 s53, s50, 0x2a000
    buffer_load_dwordx2 v[212:213], v24, s[8:11], s53 offen
    s_add_u32 s53, s50, 0x2b000
    buffer_load_dwordx2 v[214:215], v24, s[8:11], s53 offen
    s_add_u32 s53, s50, 0x38000
    buffer_load_dwordx2 v[216:217], v24, s[8:11], s53 offen
    s_add_u32 s53, s50, 0x39000
    buffer_load_dwordx2 v[218:219], v24, s[8:11], s53 offen
    s_add_u32 s53, s50, 0x3a000
    buffer_load_dwordx2 v[220:221], v24, s[8:11], s53 offen
    s_add_u32 s53, s50, 0x3b000
    buffer_load_dwordx2 v[222:223], v24, s[8:11], s53 offen
    s_waitcnt vmcnt(40) lgkmcnt(8)
    ds_read_b128 v[80:83], v28 offset:25344
    ds_read_b128 v[84:87], v28 offset:26400
    ds_read_b128 v[88:91], v28 offset:27456
    ds_read_b128 v[92:95], v28 offset:28512
    ds_read_b128 v[96:99], v28 offset:29568
    ds_read_b128 v[100:103], v28 offset:30624
    ds_read_b128 v[104:107], v28 offset:31680
    ds_read_b128 v[108:111], v28 offset:32736
    ds_write_b128 v27, a[16:19] offset:0
    ds_write_b128 v27, a[48:51] offset:64
    ds_write_b128 v27, a[80:83] offset:128
    ds_write_b128 v27, a[112:115] offset:192
    ds_write_b128 v27, a[144:147] offset:256
    ds_write_b128 v27, a[176:179] offset:320
    ds_write_b128 v27, a[208:211] offset:384
    ds_write_b128 v27, a[240:243] offset:448
    v_lshlrev_b32 v112, 16, v160
    v_and_b32 v113, 0xffff0000, v160
    v_lshlrev_b32 v114, 16, v161
    v_and_b32 v115, 0xffff0000, v161
    v_pk_mul_f32 v[112:113], v[112:113], v[40:41]
    v_pk_mul_f32 v[114:115], v[114:115], v[42:43]
    s_add_u32 s52, s51, 0x10000
    v_cvt_pk_bf16_f32 v112, 0, v112
    v_cvt_pk_bf16_f32 v113, 0, v113
    v_cvt_pk_bf16_f32 v114, 0, v114
    v_cvt_pk_bf16_f32 v115, 0, v115
    v_pk_add_f32 v[48:49], v[48:49], v[112:113]
    v_pk_add_f32 v[50:51], v[50:51], v[114:115]
    buffer_store_dwordx4 v[48:51], v25, s[12:15], s52 offen
    v_lshlrev_b32 v116, 16, v162
    v_and_b32 v117, 0xffff0000, v162
    v_lshlrev_b32 v118, 16, v163
    v_and_b32 v119, 0xffff0000, v163
    v_pk_mul_f32 v[116:117], v[116:117], v[40:41]
    v_pk_mul_f32 v[118:119], v[118:119], v[42:43]
    s_add_u32 s52, s51, 0x14000
    v_cvt_pk_bf16_f32 v116, 0, v116
    v_cvt_pk_bf16_f32 v117, 0, v117
    v_cvt_pk_bf16_f32 v118, 0, v118
    v_cvt_pk_bf16_f32 v119, 0, v119
    v_pk_add_f32 v[52:53], v[52:53], v[116:117]
    v_pk_add_f32 v[54:55], v[54:55], v[118:119]
    buffer_store_dwordx4 v[52:55], v25, s[12:15], s52 offen
    v_lshlrev_b32 v112, 16, v164
    v_and_b32 v113, 0xffff0000, v164
    v_lshlrev_b32 v114, 16, v165
    v_and_b32 v115, 0xffff0000, v165
    v_pk_mul_f32 v[112:113], v[112:113], v[40:41]
    v_pk_mul_f32 v[114:115], v[114:115], v[42:43]
    s_add_u32 s52, s51, 0x18000
    v_cvt_pk_bf16_f32 v112, 0, v112
    v_cvt_pk_bf16_f32 v113, 0, v113
    v_cvt_pk_bf16_f32 v114, 0, v114
    v_cvt_pk_bf16_f32 v115, 0, v115
    v_pk_add_f32 v[56:57], v[56:57], v[112:113]
    v_pk_add_f32 v[58:59], v[58:59], v[114:115]
    buffer_store_dwordx4 v[56:59], v25, s[12:15], s52 offen
    v_lshlrev_b32 v116, 16, v166
    v_and_b32 v117, 0xffff0000, v166
    v_lshlrev_b32 v118, 16, v167
    v_and_b32 v119, 0xffff0000, v167
    v_pk_mul_f32 v[116:117], v[116:117], v[40:41]
    v_pk_mul_f32 v[118:119], v[118:119], v[42:43]
    s_add_u32 s52, s51, 0x1c000
    v_cvt_pk_bf16_f32 v116, 0, v116
    v_cvt_pk_bf16_f32 v117, 0, v117
    v_cvt_pk_bf16_f32 v118, 0, v118
    v_cvt_pk_bf16_f32 v119, 0, v119
    v_pk_add_f32 v[60:61], v[60:61], v[116:117]
    v_pk_add_f32 v[62:63], v[62:63], v[118:119]
    buffer_store_dwordx4 v[60:63], v25, s[12:15], s52 offen
    v_lshlrev_b32 v112, 16, v168
    v_and_b32 v113, 0xffff0000, v168
    v_lshlrev_b32 v114, 16, v169
    v_and_b32 v115, 0xffff0000, v169
    v_pk_mul_f32 v[112:113], v[112:113], v[40:41]
    v_pk_mul_f32 v[114:115], v[114:115], v[42:43]
    s_add_u32 s52, s51, 0x50000
    v_cvt_pk_bf16_f32 v112, 0, v112
    v_cvt_pk_bf16_f32 v113, 0, v113
    v_cvt_pk_bf16_f32 v114, 0, v114
    v_cvt_pk_bf16_f32 v115, 0, v115
    v_pk_add_f32 v[64:65], v[64:65], v[112:113]
    v_pk_add_f32 v[66:67], v[66:67], v[114:115]
    buffer_store_dwordx4 v[64:67], v25, s[12:15], s52 offen
    v_lshlrev_b32 v116, 16, v170
    v_and_b32 v117, 0xffff0000, v170
    v_lshlrev_b32 v118, 16, v171
    v_and_b32 v119, 0xffff0000, v171
    v_pk_mul_f32 v[116:117], v[116:117], v[40:41]
    v_pk_mul_f32 v[118:119], v[118:119], v[42:43]
    s_add_u32 s52, s51, 0x54000
    v_cvt_pk_bf16_f32 v116, 0, v116
    v_cvt_pk_bf16_f32 v117, 0, v117
    v_cvt_pk_bf16_f32 v118, 0, v118
    v_cvt_pk_bf16_f32 v119, 0, v119
    v_pk_add_f32 v[68:69], v[68:69], v[116:117]
    v_pk_add_f32 v[70:71], v[70:71], v[118:119]
    buffer_store_dwordx4 v[68:71], v25, s[12:15], s52 offen
    v_lshlrev_b32 v112, 16, v172
    v_and_b32 v113, 0xffff0000, v172
    v_lshlrev_b32 v114, 16, v173
    v_and_b32 v115, 0xffff0000, v173
    v_pk_mul_f32 v[112:113], v[112:113], v[40:41]
    v_pk_mul_f32 v[114:115], v[114:115], v[42:43]
    s_add_u32 s52, s51, 0x58000
    v_cvt_pk_bf16_f32 v112, 0, v112
    v_cvt_pk_bf16_f32 v113, 0, v113
    v_cvt_pk_bf16_f32 v114, 0, v114
    v_cvt_pk_bf16_f32 v115, 0, v115
    v_pk_add_f32 v[72:73], v[72:73], v[112:113]
    v_pk_add_f32 v[74:75], v[74:75], v[114:115]
    buffer_store_dwordx4 v[72:75], v25, s[12:15], s52 offen
    v_lshlrev_b32 v116, 16, v174
    v_and_b32 v117, 0xffff0000, v174
    v_lshlrev_b32 v118, 16, v175
    v_and_b32 v119, 0xffff0000, v175
    v_pk_mul_f32 v[116:117], v[116:117], v[40:41]
    v_pk_mul_f32 v[118:119], v[118:119], v[42:43]
    s_add_u32 s52, s51, 0x5c000
    v_cvt_pk_bf16_f32 v116, 0, v116
    v_cvt_pk_bf16_f32 v117, 0, v117
    v_cvt_pk_bf16_f32 v118, 0, v118
    v_cvt_pk_bf16_f32 v119, 0, v119
    v_pk_add_f32 v[76:77], v[76:77], v[116:117]
    v_pk_add_f32 v[78:79], v[78:79], v[118:119]
    buffer_store_dwordx4 v[76:79], v25, s[12:15], s52 offen
    s_add_u32 s53, s50, 0xc000
    buffer_load_dwordx2 v[224:225], v24, s[8:11], s53 offen
    s_add_u32 s53, s50, 0xd000
    buffer_load_dwordx2 v[226:227], v24, s[8:11], s53 offen
    s_add_u32 s53, s50, 0xe000
    buffer_load_dwordx2 v[228:229], v24, s[8:11], s53 offen
    s_add_u32 s53, s50, 0xf000
    buffer_load_dwordx2 v[230:231], v24, s[8:11], s53 offen
    s_add_u32 s53, s50, 0x1c000
    buffer_load_dwordx2 v[232:233], v24, s[8:11], s53 offen
    s_add_u32 s53, s50, 0x1d000
    buffer_load_dwordx2 v[234:235], v24, s[8:11], s53 offen
    s_add_u32 s53, s50, 0x1e000
    buffer_load_dwordx2 v[236:237], v24, s[8:11], s53 offen
    s_add_u32 s53, s50, 0x1f000
    buffer_load_dwordx2 v[238:239], v24, s[8:11], s53 offen
    s_waitcnt vmcnt(48) lgkmcnt(8)
    ds_read_b128 v[48:51], v28 offset:0
    ds_read_b128 v[52:55], v28 offset:1056
    ds_read_b128 v[56:59], v28 offset:2112
    ds_read_b128 v[60:63], v28 offset:3168
    ds_read_b128 v[64:67], v28 offset:4224
    ds_read_b128 v[68:71], v28 offset:5280
    ds_read_b128 v[72:75], v28 offset:6336
    ds_read_b128 v[76:79], v28 offset:7392
    ds_write_b128 v27, a[20:23] offset:8448
    ds_write_b128 v27, a[52:55] offset:8512
    ds_write_b128 v27, a[84:87] offset:8576
    ds_write_b128 v27, a[116:119] offset:8640
    ds_write_b128 v27, a[148:151] offset:8704
    ds_write_b128 v27, a[180:183] offset:8768
    ds_write_b128 v27, a[212:215] offset:8832
    ds_write_b128 v27, a[244:247] offset:8896
    v_lshlrev_b32 v112, 16, v176
    v_and_b32 v113, 0xffff0000, v176
    v_lshlrev_b32 v114, 16, v177
    v_and_b32 v115, 0xffff0000, v177
    v_pk_mul_f32 v[112:113], v[112:113], v[40:41]
    v_pk_mul_f32 v[114:115], v[114:115], v[42:43]
    s_add_u32 s52, s51, 0x90000
    v_cvt_pk_bf16_f32 v112, 0, v112
    v_cvt_pk_bf16_f32 v113, 0, v113
    v_cvt_pk_bf16_f32 v114, 0, v114
    v_cvt_pk_bf16_f32 v115, 0, v115
    v_pk_add_f32 v[80:81], v[80:81], v[112:113]
    v_pk_add_f32 v[82:83], v[82:83], v[114:115]
    buffer_store_dwordx4 v[80:83], v25, s[12:15], s52 offen
    v_lshlrev_b32 v116, 16, v178
    v_and_b32 v117, 0xffff0000, v178
    v_lshlrev_b32 v118, 16, v179
    v_and_b32 v119, 0xffff0000, v179
    v_pk_mul_f32 v[116:117], v[116:117], v[40:41]
    v_pk_mul_f32 v[118:119], v[118:119], v[42:43]
    s_add_u32 s52, s51, 0x94000
    v_cvt_pk_bf16_f32 v116, 0, v116
    v_cvt_pk_bf16_f32 v117, 0, v117
    v_cvt_pk_bf16_f32 v118, 0, v118
    v_cvt_pk_bf16_f32 v119, 0, v119
    v_pk_add_f32 v[84:85], v[84:85], v[116:117]
    v_pk_add_f32 v[86:87], v[86:87], v[118:119]
    buffer_store_dwordx4 v[84:87], v25, s[12:15], s52 offen
    v_lshlrev_b32 v112, 16, v180
    v_and_b32 v113, 0xffff0000, v180
    v_lshlrev_b32 v114, 16, v181
    v_and_b32 v115, 0xffff0000, v181
    v_pk_mul_f32 v[112:113], v[112:113], v[40:41]
    v_pk_mul_f32 v[114:115], v[114:115], v[42:43]
    s_add_u32 s52, s51, 0x98000
    v_cvt_pk_bf16_f32 v112, 0, v112
    v_cvt_pk_bf16_f32 v113, 0, v113
    v_cvt_pk_bf16_f32 v114, 0, v114
    v_cvt_pk_bf16_f32 v115, 0, v115
    v_pk_add_f32 v[88:89], v[88:89], v[112:113]
    v_pk_add_f32 v[90:91], v[90:91], v[114:115]
    buffer_store_dwordx4 v[88:91], v25, s[12:15], s52 offen
    v_lshlrev_b32 v116, 16, v182
    v_and_b32 v117, 0xffff0000, v182
    v_lshlrev_b32 v118, 16, v183
    v_and_b32 v119, 0xffff0000, v183
    v_pk_mul_f32 v[116:117], v[116:117], v[40:41]
    v_pk_mul_f32 v[118:119], v[118:119], v[42:43]
    s_add_u32 s52, s51, 0x9c000
    v_cvt_pk_bf16_f32 v116, 0, v116
    v_cvt_pk_bf16_f32 v117, 0, v117
    v_cvt_pk_bf16_f32 v118, 0, v118
    v_cvt_pk_bf16_f32 v119, 0, v119
    v_pk_add_f32 v[92:93], v[92:93], v[116:117]
    v_pk_add_f32 v[94:95], v[94:95], v[118:119]
    buffer_store_dwordx4 v[92:95], v25, s[12:15], s52 offen
    v_lshlrev_b32 v112, 16, v184
    v_and_b32 v113, 0xffff0000, v184
    v_lshlrev_b32 v114, 16, v185
    v_and_b32 v115, 0xffff0000, v185
    v_pk_mul_f32 v[112:113], v[112:113], v[40:41]
    v_pk_mul_f32 v[114:115], v[114:115], v[42:43]
    s_add_u32 s52, s51, 0xd0000
    v_cvt_pk_bf16_f32 v112, 0, v112
    v_cvt_pk_bf16_f32 v113, 0, v113
    v_cvt_pk_bf16_f32 v114, 0, v114
    v_cvt_pk_bf16_f32 v115, 0, v115
    v_pk_add_f32 v[96:97], v[96:97], v[112:113]
    v_pk_add_f32 v[98:99], v[98:99], v[114:115]
    buffer_store_dwordx4 v[96:99], v25, s[12:15], s52 offen
    v_lshlrev_b32 v116, 16, v186
    v_and_b32 v117, 0xffff0000, v186
    v_lshlrev_b32 v118, 16, v187
    v_and_b32 v119, 0xffff0000, v187
    v_pk_mul_f32 v[116:117], v[116:117], v[40:41]
    v_pk_mul_f32 v[118:119], v[118:119], v[42:43]
    s_add_u32 s52, s51, 0xd4000
    v_cvt_pk_bf16_f32 v116, 0, v116
    v_cvt_pk_bf16_f32 v117, 0, v117
    v_cvt_pk_bf16_f32 v118, 0, v118
    v_cvt_pk_bf16_f32 v119, 0, v119
    v_pk_add_f32 v[100:101], v[100:101], v[116:117]
    v_pk_add_f32 v[102:103], v[102:103], v[118:119]
    buffer_store_dwordx4 v[100:103], v25, s[12:15], s52 offen
    v_lshlrev_b32 v112, 16, v188
    v_and_b32 v113, 0xffff0000, v188
    v_lshlrev_b32 v114, 16, v189
    v_and_b32 v115, 0xffff0000, v189
    v_pk_mul_f32 v[112:113], v[112:113], v[40:41]
    v_pk_mul_f32 v[114:115], v[114:115], v[42:43]
    s_add_u32 s52, s51, 0xd8000
    v_cvt_pk_bf16_f32 v112, 0, v112
    v_cvt_pk_bf16_f32 v113, 0, v113
    v_cvt_pk_bf16_f32 v114, 0, v114
    v_cvt_pk_bf16_f32 v115, 0, v115
    v_pk_add_f32 v[104:105], v[104:105], v[112:113]
    v_pk_add_f32 v[106:107], v[106:107], v[114:115]
    buffer_store_dwordx4 v[104:107], v25, s[12:15], s52 offen
    v_lshlrev_b32 v116, 16, v190
    v_and_b32 v117, 0xffff0000, v190
    v_lshlrev_b32 v118, 16, v191
    v_and_b32 v119, 0xffff0000, v191
    v_pk_mul_f32 v[116:117], v[116:117], v[40:41]
    v_pk_mul_f32 v[118:119], v[118:119], v[42:43]
    s_add_u32 s52, s51, 0xdc000
    v_cvt_pk_bf16_f32 v116, 0, v116
    v_cvt_pk_bf16_f32 v117, 0, v117
    v_cvt_pk_bf16_f32 v118, 0, v118
    v_cvt_pk_bf16_f32 v119, 0, v119
    v_pk_add_f32 v[108:109], v[108:109], v[116:117]
    v_pk_add_f32 v[110:111], v[110:111], v[118:119]
    buffer_store_dwordx4 v[108:111], v25, s[12:15], s52 offen
    s_add_u32 s53, s50, 0x2c000
    buffer_load_dwordx2 v[240:241], v24, s[8:11], s53 offen
    s_add_u32 s53, s50, 0x2d000
    buffer_load_dwordx2 v[242:243], v24, s[8:11], s53 offen
    s_add_u32 s53, s50, 0x2e000
    buffer_load_dwordx2 v[244:245], v24, s[8:11], s53 offen
    s_add_u32 s53, s50, 0x2f000
    buffer_load_dwordx2 v[246:247], v24, s[8:11], s53 offen
    s_add_u32 s53, s50, 0x3c000
    buffer_load_dwordx2 v[248:249], v24, s[8:11], s53 offen
    s_add_u32 s53, s50, 0x3d000
    buffer_load_dwordx2 v[250:251], v24, s[8:11], s53 offen
    s_add_u32 s53, s50, 0x3e000
    buffer_load_dwordx2 v[252:253], v24, s[8:11], s53 offen
    s_add_u32 s53, s50, 0x3f000
    buffer_load_dwordx2 v[254:255], v24, s[8:11], s53 offen
    s_waitcnt vmcnt(48) lgkmcnt(8)
    ds_read_b128 v[80:83], v28 offset:8448
    ds_read_b128 v[84:87], v28 offset:9504
    ds_read_b128 v[88:91], v28 offset:10560
    ds_read_b128 v[92:95], v28 offset:11616
    ds_read_b128 v[96:99], v28 offset:12672
    ds_read_b128 v[100:103], v28 offset:13728
    ds_read_b128 v[104:107], v28 offset:14784
    ds_read_b128 v[108:111], v28 offset:15840
    ds_write_b128 v27, a[24:27] offset:16896
    ds_write_b128 v27, a[56:59] offset:16960
    ds_write_b128 v27, a[88:91] offset:17024
    ds_write_b128 v27, a[120:123] offset:17088
    ds_write_b128 v27, a[152:155] offset:17152
    ds_write_b128 v27, a[184:187] offset:17216
    ds_write_b128 v27, a[216:219] offset:17280
    ds_write_b128 v27, a[248:251] offset:17344
    v_lshlrev_b32 v112, 16, v192
    v_and_b32 v113, 0xffff0000, v192
    v_lshlrev_b32 v114, 16, v193
    v_and_b32 v115, 0xffff0000, v193
    v_pk_mul_f32 v[112:113], v[112:113], v[40:41]
    v_pk_mul_f32 v[114:115], v[114:115], v[42:43]
    s_add_u32 s52, s51, 0x20000
    v_cvt_pk_bf16_f32 v112, 0, v112
    v_cvt_pk_bf16_f32 v113, 0, v113
    v_cvt_pk_bf16_f32 v114, 0, v114
    v_cvt_pk_bf16_f32 v115, 0, v115
    v_pk_add_f32 v[48:49], v[48:49], v[112:113]
    v_pk_add_f32 v[50:51], v[50:51], v[114:115]
    buffer_store_dwordx4 v[48:51], v25, s[12:15], s52 offen
    v_lshlrev_b32 v116, 16, v194
    v_and_b32 v117, 0xffff0000, v194
    v_lshlrev_b32 v118, 16, v195
    v_and_b32 v119, 0xffff0000, v195
    v_pk_mul_f32 v[116:117], v[116:117], v[40:41]
    v_pk_mul_f32 v[118:119], v[118:119], v[42:43]
    s_add_u32 s52, s51, 0x24000
    v_cvt_pk_bf16_f32 v116, 0, v116
    v_cvt_pk_bf16_f32 v117, 0, v117
    v_cvt_pk_bf16_f32 v118, 0, v118
    v_cvt_pk_bf16_f32 v119, 0, v119
    v_pk_add_f32 v[52:53], v[52:53], v[116:117]
    v_pk_add_f32 v[54:55], v[54:55], v[118:119]
    buffer_store_dwordx4 v[52:55], v25, s[12:15], s52 offen
    v_lshlrev_b32 v112, 16, v196
    v_and_b32 v113, 0xffff0000, v196
    v_lshlrev_b32 v114, 16, v197
    v_and_b32 v115, 0xffff0000, v197
    v_pk_mul_f32 v[112:113], v[112:113], v[40:41]
    v_pk_mul_f32 v[114:115], v[114:115], v[42:43]
    s_add_u32 s52, s51, 0x28000
    v_cvt_pk_bf16_f32 v112, 0, v112
    v_cvt_pk_bf16_f32 v113, 0, v113
    v_cvt_pk_bf16_f32 v114, 0, v114
    v_cvt_pk_bf16_f32 v115, 0, v115
    v_pk_add_f32 v[56:57], v[56:57], v[112:113]
    v_pk_add_f32 v[58:59], v[58:59], v[114:115]
    buffer_store_dwordx4 v[56:59], v25, s[12:15], s52 offen
    v_lshlrev_b32 v116, 16, v198
    v_and_b32 v117, 0xffff0000, v198
    v_lshlrev_b32 v118, 16, v199
    v_and_b32 v119, 0xffff0000, v199
    v_pk_mul_f32 v[116:117], v[116:117], v[40:41]
    v_pk_mul_f32 v[118:119], v[118:119], v[42:43]
    s_add_u32 s52, s51, 0x2c000
    v_cvt_pk_bf16_f32 v116, 0, v116
    v_cvt_pk_bf16_f32 v117, 0, v117
    v_cvt_pk_bf16_f32 v118, 0, v118
    v_cvt_pk_bf16_f32 v119, 0, v119
    v_pk_add_f32 v[60:61], v[60:61], v[116:117]
    v_pk_add_f32 v[62:63], v[62:63], v[118:119]
    buffer_store_dwordx4 v[60:63], v25, s[12:15], s52 offen
    v_lshlrev_b32 v112, 16, v200
    v_and_b32 v113, 0xffff0000, v200
    v_lshlrev_b32 v114, 16, v201
    v_and_b32 v115, 0xffff0000, v201
    v_pk_mul_f32 v[112:113], v[112:113], v[40:41]
    v_pk_mul_f32 v[114:115], v[114:115], v[42:43]
    s_add_u32 s52, s51, 0x60000
    v_cvt_pk_bf16_f32 v112, 0, v112
    v_cvt_pk_bf16_f32 v113, 0, v113
    v_cvt_pk_bf16_f32 v114, 0, v114
    v_cvt_pk_bf16_f32 v115, 0, v115
    v_pk_add_f32 v[64:65], v[64:65], v[112:113]
    v_pk_add_f32 v[66:67], v[66:67], v[114:115]
    buffer_store_dwordx4 v[64:67], v25, s[12:15], s52 offen
    v_lshlrev_b32 v116, 16, v202
    v_and_b32 v117, 0xffff0000, v202
    v_lshlrev_b32 v118, 16, v203
    v_and_b32 v119, 0xffff0000, v203
    v_pk_mul_f32 v[116:117], v[116:117], v[40:41]
    v_pk_mul_f32 v[118:119], v[118:119], v[42:43]
    s_add_u32 s52, s51, 0x64000
    v_cvt_pk_bf16_f32 v116, 0, v116
    v_cvt_pk_bf16_f32 v117, 0, v117
    v_cvt_pk_bf16_f32 v118, 0, v118
    v_cvt_pk_bf16_f32 v119, 0, v119
    v_pk_add_f32 v[68:69], v[68:69], v[116:117]
    v_pk_add_f32 v[70:71], v[70:71], v[118:119]
    buffer_store_dwordx4 v[68:71], v25, s[12:15], s52 offen
    v_lshlrev_b32 v112, 16, v204
    v_and_b32 v113, 0xffff0000, v204
    v_lshlrev_b32 v114, 16, v205
    v_and_b32 v115, 0xffff0000, v205
    v_pk_mul_f32 v[112:113], v[112:113], v[40:41]
    v_pk_mul_f32 v[114:115], v[114:115], v[42:43]
    s_add_u32 s52, s51, 0x68000
    v_cvt_pk_bf16_f32 v112, 0, v112
    v_cvt_pk_bf16_f32 v113, 0, v113
    v_cvt_pk_bf16_f32 v114, 0, v114
    v_cvt_pk_bf16_f32 v115, 0, v115
    v_pk_add_f32 v[72:73], v[72:73], v[112:113]
    v_pk_add_f32 v[74:75], v[74:75], v[114:115]
    buffer_store_dwordx4 v[72:75], v25, s[12:15], s52 offen
    v_lshlrev_b32 v116, 16, v206
    v_and_b32 v117, 0xffff0000, v206
    v_lshlrev_b32 v118, 16, v207
    v_and_b32 v119, 0xffff0000, v207
    v_pk_mul_f32 v[116:117], v[116:117], v[40:41]
    v_pk_mul_f32 v[118:119], v[118:119], v[42:43]
    s_add_u32 s52, s51, 0x6c000
    v_cvt_pk_bf16_f32 v116, 0, v116
    v_cvt_pk_bf16_f32 v117, 0, v117
    v_cvt_pk_bf16_f32 v118, 0, v118
    v_cvt_pk_bf16_f32 v119, 0, v119
    v_pk_add_f32 v[76:77], v[76:77], v[116:117]
    v_pk_add_f32 v[78:79], v[78:79], v[118:119]
    buffer_store_dwordx4 v[76:79], v25, s[12:15], s52 offen
    s_waitcnt vmcnt(40) lgkmcnt(8)
    ds_read_b128 v[48:51], v28 offset:16896
    ds_read_b128 v[52:55], v28 offset:17952
    ds_read_b128 v[56:59], v28 offset:19008
    ds_read_b128 v[60:63], v28 offset:20064
    ds_read_b128 v[64:67], v28 offset:21120
    ds_read_b128 v[68:71], v28 offset:22176
    ds_read_b128 v[72:75], v28 offset:23232
    ds_read_b128 v[76:79], v28 offset:24288
    ds_write_b128 v27, a[28:31] offset:25344
    ds_write_b128 v27, a[60:63] offset:25408
    ds_write_b128 v27, a[92:95] offset:25472
    ds_write_b128 v27, a[124:127] offset:25536
    ds_write_b128 v27, a[156:159] offset:25600
    ds_write_b128 v27, a[188:191] offset:25664
    ds_write_b128 v27, a[220:223] offset:25728
    ds_write_b128 v27, a[252:255] offset:25792
    v_lshlrev_b32 v112, 16, v208
    v_and_b32 v113, 0xffff0000, v208
    v_lshlrev_b32 v114, 16, v209
    v_and_b32 v115, 0xffff0000, v209
    v_pk_mul_f32 v[112:113], v[112:113], v[40:41]
    v_pk_mul_f32 v[114:115], v[114:115], v[42:43]
    s_add_u32 s52, s51, 0xa0000
    v_cvt_pk_bf16_f32 v112, 0, v112
    v_cvt_pk_bf16_f32 v113, 0, v113
    v_cvt_pk_bf16_f32 v114, 0, v114
    v_cvt_pk_bf16_f32 v115, 0, v115
    v_pk_add_f32 v[80:81], v[80:81], v[112:113]
    v_pk_add_f32 v[82:83], v[82:83], v[114:115]
    buffer_store_dwordx4 v[80:83], v25, s[12:15], s52 offen
    v_lshlrev_b32 v116, 16, v210
    v_and_b32 v117, 0xffff0000, v210
    v_lshlrev_b32 v118, 16, v211
    v_and_b32 v119, 0xffff0000, v211
    v_pk_mul_f32 v[116:117], v[116:117], v[40:41]
    v_pk_mul_f32 v[118:119], v[118:119], v[42:43]
    s_add_u32 s52, s51, 0xa4000
    v_cvt_pk_bf16_f32 v116, 0, v116
    v_cvt_pk_bf16_f32 v117, 0, v117
    v_cvt_pk_bf16_f32 v118, 0, v118
    v_cvt_pk_bf16_f32 v119, 0, v119
    v_pk_add_f32 v[84:85], v[84:85], v[116:117]
    v_pk_add_f32 v[86:87], v[86:87], v[118:119]
    buffer_store_dwordx4 v[84:87], v25, s[12:15], s52 offen
    v_lshlrev_b32 v112, 16, v212
    v_and_b32 v113, 0xffff0000, v212
    v_lshlrev_b32 v114, 16, v213
    v_and_b32 v115, 0xffff0000, v213
    v_pk_mul_f32 v[112:113], v[112:113], v[40:41]
    v_pk_mul_f32 v[114:115], v[114:115], v[42:43]
    s_add_u32 s52, s51, 0xa8000
    v_cvt_pk_bf16_f32 v112, 0, v112
    v_cvt_pk_bf16_f32 v113, 0, v113
    v_cvt_pk_bf16_f32 v114, 0, v114
    v_cvt_pk_bf16_f32 v115, 0, v115
    v_pk_add_f32 v[88:89], v[88:89], v[112:113]
    v_pk_add_f32 v[90:91], v[90:91], v[114:115]
    buffer_store_dwordx4 v[88:91], v25, s[12:15], s52 offen
    v_lshlrev_b32 v116, 16, v214
    v_and_b32 v117, 0xffff0000, v214
    v_lshlrev_b32 v118, 16, v215
    v_and_b32 v119, 0xffff0000, v215
    v_pk_mul_f32 v[116:117], v[116:117], v[40:41]
    v_pk_mul_f32 v[118:119], v[118:119], v[42:43]
    s_add_u32 s52, s51, 0xac000
    v_cvt_pk_bf16_f32 v116, 0, v116
    v_cvt_pk_bf16_f32 v117, 0, v117
    v_cvt_pk_bf16_f32 v118, 0, v118
    v_cvt_pk_bf16_f32 v119, 0, v119
    v_pk_add_f32 v[92:93], v[92:93], v[116:117]
    v_pk_add_f32 v[94:95], v[94:95], v[118:119]
    buffer_store_dwordx4 v[92:95], v25, s[12:15], s52 offen
    v_lshlrev_b32 v112, 16, v216
    v_and_b32 v113, 0xffff0000, v216
    v_lshlrev_b32 v114, 16, v217
    v_and_b32 v115, 0xffff0000, v217
    v_pk_mul_f32 v[112:113], v[112:113], v[40:41]
    v_pk_mul_f32 v[114:115], v[114:115], v[42:43]
    s_add_u32 s52, s51, 0xe0000
    v_cvt_pk_bf16_f32 v112, 0, v112
    v_cvt_pk_bf16_f32 v113, 0, v113
    v_cvt_pk_bf16_f32 v114, 0, v114
    v_cvt_pk_bf16_f32 v115, 0, v115
    v_pk_add_f32 v[96:97], v[96:97], v[112:113]
    v_pk_add_f32 v[98:99], v[98:99], v[114:115]
    buffer_store_dwordx4 v[96:99], v25, s[12:15], s52 offen
    v_lshlrev_b32 v116, 16, v218
    v_and_b32 v117, 0xffff0000, v218
    v_lshlrev_b32 v118, 16, v219
    v_and_b32 v119, 0xffff0000, v219
    v_pk_mul_f32 v[116:117], v[116:117], v[40:41]
    v_pk_mul_f32 v[118:119], v[118:119], v[42:43]
    s_add_u32 s52, s51, 0xe4000
    v_cvt_pk_bf16_f32 v116, 0, v116
    v_cvt_pk_bf16_f32 v117, 0, v117
    v_cvt_pk_bf16_f32 v118, 0, v118
    v_cvt_pk_bf16_f32 v119, 0, v119
    v_pk_add_f32 v[100:101], v[100:101], v[116:117]
    v_pk_add_f32 v[102:103], v[102:103], v[118:119]
    buffer_store_dwordx4 v[100:103], v25, s[12:15], s52 offen
    v_lshlrev_b32 v112, 16, v220
    v_and_b32 v113, 0xffff0000, v220
    v_lshlrev_b32 v114, 16, v221
    v_and_b32 v115, 0xffff0000, v221
    v_pk_mul_f32 v[112:113], v[112:113], v[40:41]
    v_pk_mul_f32 v[114:115], v[114:115], v[42:43]
    s_add_u32 s52, s51, 0xe8000
    v_cvt_pk_bf16_f32 v112, 0, v112
    v_cvt_pk_bf16_f32 v113, 0, v113
    v_cvt_pk_bf16_f32 v114, 0, v114
    v_cvt_pk_bf16_f32 v115, 0, v115
    v_pk_add_f32 v[104:105], v[104:105], v[112:113]
    v_pk_add_f32 v[106:107], v[106:107], v[114:115]
    buffer_store_dwordx4 v[104:107], v25, s[12:15], s52 offen
    v_lshlrev_b32 v116, 16, v222
    v_and_b32 v117, 0xffff0000, v222
    v_lshlrev_b32 v118, 16, v223
    v_and_b32 v119, 0xffff0000, v223
    v_pk_mul_f32 v[116:117], v[116:117], v[40:41]
    v_pk_mul_f32 v[118:119], v[118:119], v[42:43]
    s_add_u32 s52, s51, 0xec000
    v_cvt_pk_bf16_f32 v116, 0, v116
    v_cvt_pk_bf16_f32 v117, 0, v117
    v_cvt_pk_bf16_f32 v118, 0, v118
    v_cvt_pk_bf16_f32 v119, 0, v119
    v_pk_add_f32 v[108:109], v[108:109], v[116:117]
    v_pk_add_f32 v[110:111], v[110:111], v[118:119]
    buffer_store_dwordx4 v[108:111], v25, s[12:15], s52 offen
    s_waitcnt vmcnt(32) lgkmcnt(8)
    ds_read_b128 v[80:83], v28 offset:25344
    ds_read_b128 v[84:87], v28 offset:26400
    ds_read_b128 v[88:91], v28 offset:27456
    ds_read_b128 v[92:95], v28 offset:28512
    ds_read_b128 v[96:99], v28 offset:29568
    ds_read_b128 v[100:103], v28 offset:30624
    ds_read_b128 v[104:107], v28 offset:31680
    ds_read_b128 v[108:111], v28 offset:32736
    v_lshlrev_b32 v112, 16, v224
    v_and_b32 v113, 0xffff0000, v224
    v_lshlrev_b32 v114, 16, v225
    v_and_b32 v115, 0xffff0000, v225
    v_pk_mul_f32 v[112:113], v[112:113], v[40:41]
    v_pk_mul_f32 v[114:115], v[114:115], v[42:43]
    s_add_u32 s52, s51, 0x30000
    v_cvt_pk_bf16_f32 v112, 0, v112
    v_cvt_pk_bf16_f32 v113, 0, v113
    v_cvt_pk_bf16_f32 v114, 0, v114
    v_cvt_pk_bf16_f32 v115, 0, v115
    v_pk_add_f32 v[48:49], v[48:49], v[112:113]
    v_pk_add_f32 v[50:51], v[50:51], v[114:115]
    buffer_store_dwordx4 v[48:51], v25, s[12:15], s52 offen
    v_lshlrev_b32 v116, 16, v226
    v_and_b32 v117, 0xffff0000, v226
    v_lshlrev_b32 v118, 16, v227
    v_and_b32 v119, 0xffff0000, v227
    v_pk_mul_f32 v[116:117], v[116:117], v[40:41]
    v_pk_mul_f32 v[118:119], v[118:119], v[42:43]
    s_add_u32 s52, s51, 0x34000
    v_cvt_pk_bf16_f32 v116, 0, v116
    v_cvt_pk_bf16_f32 v117, 0, v117
    v_cvt_pk_bf16_f32 v118, 0, v118
    v_cvt_pk_bf16_f32 v119, 0, v119
    v_pk_add_f32 v[52:53], v[52:53], v[116:117]
    v_pk_add_f32 v[54:55], v[54:55], v[118:119]
    buffer_store_dwordx4 v[52:55], v25, s[12:15], s52 offen
    v_lshlrev_b32 v112, 16, v228
    v_and_b32 v113, 0xffff0000, v228
    v_lshlrev_b32 v114, 16, v229
    v_and_b32 v115, 0xffff0000, v229
    v_pk_mul_f32 v[112:113], v[112:113], v[40:41]
    v_pk_mul_f32 v[114:115], v[114:115], v[42:43]
    s_add_u32 s52, s51, 0x38000
    v_cvt_pk_bf16_f32 v112, 0, v112
    v_cvt_pk_bf16_f32 v113, 0, v113
    v_cvt_pk_bf16_f32 v114, 0, v114
    v_cvt_pk_bf16_f32 v115, 0, v115
    v_pk_add_f32 v[56:57], v[56:57], v[112:113]
    v_pk_add_f32 v[58:59], v[58:59], v[114:115]
    buffer_store_dwordx4 v[56:59], v25, s[12:15], s52 offen
    v_lshlrev_b32 v116, 16, v230
    v_and_b32 v117, 0xffff0000, v230
    v_lshlrev_b32 v118, 16, v231
    v_and_b32 v119, 0xffff0000, v231
    v_pk_mul_f32 v[116:117], v[116:117], v[40:41]
    v_pk_mul_f32 v[118:119], v[118:119], v[42:43]
    s_add_u32 s52, s51, 0x3c000
    v_cvt_pk_bf16_f32 v116, 0, v116
    v_cvt_pk_bf16_f32 v117, 0, v117
    v_cvt_pk_bf16_f32 v118, 0, v118
    v_cvt_pk_bf16_f32 v119, 0, v119
    v_pk_add_f32 v[60:61], v[60:61], v[116:117]
    v_pk_add_f32 v[62:63], v[62:63], v[118:119]
    buffer_store_dwordx4 v[60:63], v25, s[12:15], s52 offen
    v_lshlrev_b32 v112, 16, v232
    v_and_b32 v113, 0xffff0000, v232
    v_lshlrev_b32 v114, 16, v233
    v_and_b32 v115, 0xffff0000, v233
    v_pk_mul_f32 v[112:113], v[112:113], v[40:41]
    v_pk_mul_f32 v[114:115], v[114:115], v[42:43]
    s_add_u32 s52, s51, 0x70000
    v_cvt_pk_bf16_f32 v112, 0, v112
    v_cvt_pk_bf16_f32 v113, 0, v113
    v_cvt_pk_bf16_f32 v114, 0, v114
    v_cvt_pk_bf16_f32 v115, 0, v115
    v_pk_add_f32 v[64:65], v[64:65], v[112:113]
    v_pk_add_f32 v[66:67], v[66:67], v[114:115]
    buffer_store_dwordx4 v[64:67], v25, s[12:15], s52 offen
    v_lshlrev_b32 v116, 16, v234
    v_and_b32 v117, 0xffff0000, v234
    v_lshlrev_b32 v118, 16, v235
    v_and_b32 v119, 0xffff0000, v235
    v_pk_mul_f32 v[116:117], v[116:117], v[40:41]
    v_pk_mul_f32 v[118:119], v[118:119], v[42:43]
    s_add_u32 s52, s51, 0x74000
    v_cvt_pk_bf16_f32 v116, 0, v116
    v_cvt_pk_bf16_f32 v117, 0, v117
    v_cvt_pk_bf16_f32 v118, 0, v118
    v_cvt_pk_bf16_f32 v119, 0, v119
    v_pk_add_f32 v[68:69], v[68:69], v[116:117]
    v_pk_add_f32 v[70:71], v[70:71], v[118:119]
    buffer_store_dwordx4 v[68:71], v25, s[12:15], s52 offen
    v_lshlrev_b32 v112, 16, v236
    v_and_b32 v113, 0xffff0000, v236
    v_lshlrev_b32 v114, 16, v237
    v_and_b32 v115, 0xffff0000, v237
    v_pk_mul_f32 v[112:113], v[112:113], v[40:41]
    v_pk_mul_f32 v[114:115], v[114:115], v[42:43]
    s_add_u32 s52, s51, 0x78000
    v_cvt_pk_bf16_f32 v112, 0, v112
    v_cvt_pk_bf16_f32 v113, 0, v113
    v_cvt_pk_bf16_f32 v114, 0, v114
    v_cvt_pk_bf16_f32 v115, 0, v115
    v_pk_add_f32 v[72:73], v[72:73], v[112:113]
    v_pk_add_f32 v[74:75], v[74:75], v[114:115]
    buffer_store_dwordx4 v[72:75], v25, s[12:15], s52 offen
    v_lshlrev_b32 v116, 16, v238
    v_and_b32 v117, 0xffff0000, v238
    v_lshlrev_b32 v118, 16, v239
    v_and_b32 v119, 0xffff0000, v239
    v_pk_mul_f32 v[116:117], v[116:117], v[40:41]
    v_pk_mul_f32 v[118:119], v[118:119], v[42:43]
    s_add_u32 s52, s51, 0x7c000
    v_cvt_pk_bf16_f32 v116, 0, v116
    v_cvt_pk_bf16_f32 v117, 0, v117
    v_cvt_pk_bf16_f32 v118, 0, v118
    v_cvt_pk_bf16_f32 v119, 0, v119
    v_pk_add_f32 v[76:77], v[76:77], v[116:117]
    v_pk_add_f32 v[78:79], v[78:79], v[118:119]
    buffer_store_dwordx4 v[76:79], v25, s[12:15], s52 offen
    s_waitcnt vmcnt(24) lgkmcnt(0)
    v_lshlrev_b32 v112, 16, v240
    v_and_b32 v113, 0xffff0000, v240
    v_lshlrev_b32 v114, 16, v241
    v_and_b32 v115, 0xffff0000, v241
    v_pk_mul_f32 v[112:113], v[112:113], v[40:41]
    v_pk_mul_f32 v[114:115], v[114:115], v[42:43]
    s_add_u32 s52, s51, 0xb0000
    v_cvt_pk_bf16_f32 v112, 0, v112
    v_cvt_pk_bf16_f32 v113, 0, v113
    v_cvt_pk_bf16_f32 v114, 0, v114
    v_cvt_pk_bf16_f32 v115, 0, v115
    v_pk_add_f32 v[80:81], v[80:81], v[112:113]
    v_pk_add_f32 v[82:83], v[82:83], v[114:115]
    buffer_store_dwordx4 v[80:83], v25, s[12:15], s52 offen
    v_lshlrev_b32 v116, 16, v242
    v_and_b32 v117, 0xffff0000, v242
    v_lshlrev_b32 v118, 16, v243
    v_and_b32 v119, 0xffff0000, v243
    v_pk_mul_f32 v[116:117], v[116:117], v[40:41]
    v_pk_mul_f32 v[118:119], v[118:119], v[42:43]
    s_add_u32 s52, s51, 0xb4000
    v_cvt_pk_bf16_f32 v116, 0, v116
    v_cvt_pk_bf16_f32 v117, 0, v117
    v_cvt_pk_bf16_f32 v118, 0, v118
    v_cvt_pk_bf16_f32 v119, 0, v119
    v_pk_add_f32 v[84:85], v[84:85], v[116:117]
    v_pk_add_f32 v[86:87], v[86:87], v[118:119]
    buffer_store_dwordx4 v[84:87], v25, s[12:15], s52 offen
    v_lshlrev_b32 v112, 16, v244
    v_and_b32 v113, 0xffff0000, v244
    v_lshlrev_b32 v114, 16, v245
    v_and_b32 v115, 0xffff0000, v245
    v_pk_mul_f32 v[112:113], v[112:113], v[40:41]
    v_pk_mul_f32 v[114:115], v[114:115], v[42:43]
    s_add_u32 s52, s51, 0xb8000
    v_cvt_pk_bf16_f32 v112, 0, v112
    v_cvt_pk_bf16_f32 v113, 0, v113
    v_cvt_pk_bf16_f32 v114, 0, v114
    v_cvt_pk_bf16_f32 v115, 0, v115
    v_pk_add_f32 v[88:89], v[88:89], v[112:113]
    v_pk_add_f32 v[90:91], v[90:91], v[114:115]
    buffer_store_dwordx4 v[88:91], v25, s[12:15], s52 offen
    v_lshlrev_b32 v116, 16, v246
    v_and_b32 v117, 0xffff0000, v246
    v_lshlrev_b32 v118, 16, v247
    v_and_b32 v119, 0xffff0000, v247
    v_pk_mul_f32 v[116:117], v[116:117], v[40:41]
    v_pk_mul_f32 v[118:119], v[118:119], v[42:43]
    s_add_u32 s52, s51, 0xbc000
    v_cvt_pk_bf16_f32 v116, 0, v116
    v_cvt_pk_bf16_f32 v117, 0, v117
    v_cvt_pk_bf16_f32 v118, 0, v118
    v_cvt_pk_bf16_f32 v119, 0, v119
    v_pk_add_f32 v[92:93], v[92:93], v[116:117]
    v_pk_add_f32 v[94:95], v[94:95], v[118:119]
    buffer_store_dwordx4 v[92:95], v25, s[12:15], s52 offen
    v_lshlrev_b32 v112, 16, v248
    v_and_b32 v113, 0xffff0000, v248
    v_lshlrev_b32 v114, 16, v249
    v_and_b32 v115, 0xffff0000, v249
    v_pk_mul_f32 v[112:113], v[112:113], v[40:41]
    v_pk_mul_f32 v[114:115], v[114:115], v[42:43]
    s_add_u32 s52, s51, 0xf0000
    v_cvt_pk_bf16_f32 v112, 0, v112
    v_cvt_pk_bf16_f32 v113, 0, v113
    v_cvt_pk_bf16_f32 v114, 0, v114
    v_cvt_pk_bf16_f32 v115, 0, v115
    v_pk_add_f32 v[96:97], v[96:97], v[112:113]
    v_pk_add_f32 v[98:99], v[98:99], v[114:115]
    buffer_store_dwordx4 v[96:99], v25, s[12:15], s52 offen
    v_lshlrev_b32 v116, 16, v250
    v_and_b32 v117, 0xffff0000, v250
    v_lshlrev_b32 v118, 16, v251
    v_and_b32 v119, 0xffff0000, v251
    v_pk_mul_f32 v[116:117], v[116:117], v[40:41]
    v_pk_mul_f32 v[118:119], v[118:119], v[42:43]
    s_add_u32 s52, s51, 0xf4000
    v_cvt_pk_bf16_f32 v116, 0, v116
    v_cvt_pk_bf16_f32 v117, 0, v117
    v_cvt_pk_bf16_f32 v118, 0, v118
    v_cvt_pk_bf16_f32 v119, 0, v119
    v_pk_add_f32 v[100:101], v[100:101], v[116:117]
    v_pk_add_f32 v[102:103], v[102:103], v[118:119]
    buffer_store_dwordx4 v[100:103], v25, s[12:15], s52 offen
    v_lshlrev_b32 v112, 16, v252
    v_and_b32 v113, 0xffff0000, v252
    v_lshlrev_b32 v114, 16, v253
    v_and_b32 v115, 0xffff0000, v253
    v_pk_mul_f32 v[112:113], v[112:113], v[40:41]
    v_pk_mul_f32 v[114:115], v[114:115], v[42:43]
    s_add_u32 s52, s51, 0xf8000
    v_cvt_pk_bf16_f32 v112, 0, v112
    v_cvt_pk_bf16_f32 v113, 0, v113
    v_cvt_pk_bf16_f32 v114, 0, v114
    v_cvt_pk_bf16_f32 v115, 0, v115
    v_pk_add_f32 v[104:105], v[104:105], v[112:113]
    v_pk_add_f32 v[106:107], v[106:107], v[114:115]
    buffer_store_dwordx4 v[104:107], v25, s[12:15], s52 offen
    v_lshlrev_b32 v116, 16, v254
    v_and_b32 v117, 0xffff0000, v254
    v_lshlrev_b32 v118, 16, v255
    v_and_b32 v119, 0xffff0000, v255
    v_pk_mul_f32 v[116:117], v[116:117], v[40:41]
    v_pk_mul_f32 v[118:119], v[118:119], v[42:43]
    s_add_u32 s52, s51, 0xfc000
    v_cvt_pk_bf16_f32 v116, 0, v116
    v_cvt_pk_bf16_f32 v117, 0, v117
    v_cvt_pk_bf16_f32 v118, 0, v118
    v_cvt_pk_bf16_f32 v119, 0, v119
    v_pk_add_f32 v[108:109], v[108:109], v[116:117]
    v_pk_add_f32 v[110:111], v[110:111], v[118:119]
    buffer_store_dwordx4 v[108:111], v25, s[12:15], s52 offen
chain_kernel_seg:
    s_xor_b32 s57, s57, 2
    s_waitcnt vmcnt(0) lgkmcnt(0)
    s_barrier
    s_mov_b32 s12, s92
    s_and_b32 s13, s93, 0xffff
    s_mov_b32 s14, 0x800000
    s_mov_b32 s15, 0x00020000
    s_lshr_b32 s60, s57, 3
    s_lshl_b32 s28, s60, 21
    s_and_b32 s60, s57, 7
    s_lshl_b32 s60, s60, 8
    s_add_u32 s28, s28, s60
    v_bfe_u32 v24, v0, 4, 3
    v_lshlrev_b32 v24, 1, v24
    v_and_b32 v25, 15, v0
    v_xor_b32 v24, v24, v25
    v_lshlrev_b32 v6, 4, v24
    v_bfe_u32 v24, v0, 4, 2
    v_lshl_add_u32 v6, v24, 11, v6
    v_bfe_u32 v24, v0, 6, 1
    v_lshl_add_u32 v6, v24, 13, v6
    v_bfe_u32 v24, v0, 7, 1
    v_lshl_add_u32 v6, v24, 15, v6
    s_and_b32 s60, s58, 1
    s_lshl_b32 s61, s60, 11
    s_lshr_b32 s60, s58, 1
    s_lshl_b32 s60, s60, 10
    s_add_u32 s32, s60, s61
    s_add_u32 m0, s32, 0
    s_add_u32 s61, s28, 0x0
    buffer_load_dwordx4 v6, s[12:15], s61 offen nt lds
    s_add_u32 m0, s32, 4096
    s_add_u32 s61, s28, 0x4000
    buffer_load_dwordx4 v6, s[12:15], s61 offen nt lds
    s_add_u32 m0, s32, 8192
    s_add_u32 s61, s28, 0x10000
    buffer_load_dwordx4 v6, s[12:15], s61 offen nt lds
    s_add_u32 m0, s32, 12288
    s_add_u32 s61, s28, 0x14000
    buffer_load_dwordx4 v6, s[12:15], s61 offen nt lds
    s_add_u32 m0, s32, 16384
    s_add_u32 s61, s28, 0x20000
    buffer_load_dwordx4 v6, s[12:15], s61 offen nt lds
    s_add_u32 m0, s32, 20480
    s_add_u32 s61, s28, 0x24000
    buffer_load_dwordx4 v6, s[12:15], s61 offen nt lds
    s_add_u32 m0, s32, 24576
    s_add_u32 s61, s28, 0x30000
    buffer_load_dwordx4 v6, s[12:15], s61 offen nt lds
    s_add_u32 m0, s32, 28672
    s_add_u32 s61, s28, 0x34000
    buffer_load_dwordx4 v6, s[12:15], s61 offen nt lds
    s_mov_b32 s8, s100
    s_and_b32 s9, s101, 0xffff
    s_mov_b32 s10, 0xe000000
    s_mov_b32 s11, 0x00020000
    s_mov_b32 s16, s96
    s_and_b32 s17, s97, 0xffff
    s_mov_b32 s18, 0x1000000
    s_mov_b32 s19, 0x00020000
    v_and_b32 v24, 63, v0
    v_lshlrev_b32 v1, 4, v24
    v_add_u32 v2, 4096, v1
    v_lshlrev_b32 v10, 7, v24
    v_mov_b32 v11, 0
    s_lshl_b32 s60, s56, 8
    s_add_u32 s60, s60, 0xd200400
    s_lshl2_add_u32 s27, s57, s60
    s_and_b32 s38, s57, 7
    s_lshl_b32 s38, s38, 16
    s_cmp_eq_u32 s58, 0
    s_cselect_b32 s27, s27, 0xe000000
    s_cselect_b32 s38, s38, 0xe000000
    s_add_u32 s60, s60, s100
    s_addc_u32 s61, s101, 0
    v_and_b32 v25, 31, v0
    v_lshlrev_b32 v25, 2, v25
    v_add_u32 v16, s60, v25
    v_mov_b32 v17, s61
    s_add_u32 s60, s98, 208
    s_addc_u32 s61, s99, 0
    v_writelane_b32 v16, s60, 32
    v_writelane_b32 v17, s61, 32
    s_mov_b32 s26, 0
    s_mov_b32 s30, 0
    s_mov_b32 s40, 0
    s_mov_b32 s29, 32768
    v_and_b32 v24, 15, v0
    v_lshlrev_b32 v15, 13, v24
    v_bfe_u32 v24, v0, 4, 2
    v_lshl_add_u32 v15, v24, 4, v15
    s_lshr_b32 s60, s57, 4
    s_lshl_b32 s60, s60, 17
    s_and_b32 s61, s57, 7
    s_lshl_b32 s61, s61, 9
    s_add_u32 s60, s60, s61
    s_lshl_b32 s61, s58, 7
    s_add_u32 s60, s60, s61
    s_and_b32 s61, s57, 8
    s_lshl_b32 s61, s61, 3
    s_add_u32 s60, s60, s61
    s_add_u32 s60, s60, 4096
    v_add_u32 v15, s60, v15
    s_lshl_b32 s61, s58, 12
    s_xor_b32 s60, s57, 24
    s_lshl_b32 s60, s60, 14
    s_add_u32 s60, s60, s61
    s_add_u32 s60, s60, 0
    v_add_u32 v20, s60, v1
    s_xor_b32 s60, s57, 16
    s_lshl_b32 s60, s60, 14
    s_add_u32 s60, s60, s61
    s_add_u32 s60, s60, 1024
    v_add_u32 v21, s60, v1
    s_xor_b32 s60, s57, 8
    s_lshl_b32 s60, s60, 14
    s_add_u32 s60, s60, s61
    s_add_u32 s60, s60, 2048
    v_add_u32 v22, s60, v1
    s_xor_b32 s60, s57, 0
    s_lshl_b32 s60, s60, 14
    s_add_u32 s60, s60, s61
    s_add_u32 s60, s60, 0
    v_add_u32 v23, s60, v1
    s_lshl_b32 s24, s56, 20
    s_add_u32 s24, s24, 0xd800000
    s_and_b32 s60, s57, 24
    s_add_u32 s60, s60, s58
    s_lshl_b32 s31, s60, 16
    s_add_u32 s31, s31, 0xc000
    s_add_u32 s31, s31, s59
    s_mul_i32 s33, s56, 8
    s_lshr_b32 s33, 0x201000c, s33
    s_and_b32 s33, s33, 255
    s_mul_i32 s39, s56, 8
    s_lshr_b32 s39, 0xf0f0f0c, s39
    s_and_b32 s39, s39, 255
    s_cmp_eq_u32 s56, 0
    s_cmov_b32 s36, 0x3c
    s_cmp_eq_u32 s56, 1
    s_cmov_b32 s36, 0x3d39
    s_cmp_eq_u32 s56, 2
    s_cmov_b32 s36, 0x3e3a
    s_cmp_eq_u32 s56, 3
    s_cmov_b32 s36, 0x3f3b
    s_add_u32 m0, s32, 32768
    s_add_u32 s61, s28, 0x40000
    buffer_load_dwordx4 v6, s[12:15], s61 offen nt lds
    s_add_u32 m0, s32, 36864
    s_add_u32 s61, s28, 0x44000
    buffer_load_dwordx4 v6, s[12:15], s61 offen nt lds
    s_add_u32 m0, s32, 40960
    s_add_u32 s61, s28, 0x50000
    buffer_load_dwordx4 v6, s[12:15], s61 offen nt lds
    s_add_u32 m0, s32, 45056
    s_add_u32 s61, s28, 0x54000
    buffer_load_dwordx4 v6, s[12:15], s61 offen nt lds
    s_add_u32 m0, s32, 49152
    s_add_u32 s61, s28, 0x60000
    buffer_load_dwordx4 v6, s[12:15], s61 offen nt lds
    s_add_u32 m0, s32, 53248
    s_add_u32 s61, s28, 0x64000
    buffer_load_dwordx4 v6, s[12:15], s61 offen nt lds
    s_add_u32 m0, s32, 57344
    s_add_u32 s61, s28, 0x70000
    buffer_load_dwordx4 v6, s[12:15], s61 offen nt lds
    s_add_u32 m0, s32, 61440
    s_add_u32 s61, s28, 0x74000
    buffer_load_dwordx4 v6, s[12:15], s61 offen nt lds
    s_add_u32 m0, s32, 65536
    s_add_u32 s61, s28, 0x80000
    buffer_load_dwordx4 v6, s[12:15], s61 offen nt lds
    s_add_u32 m0, s32, 69632
    s_add_u32 s61, s28, 0x84000
    buffer_load_dwordx4 v6, s[12:15], s61 offen nt lds
    s_add_u32 m0, s32, 73728
    s_add_u32 s61, s28, 0x90000
    buffer_load_dwordx4 v6, s[12:15], s61 offen nt lds
    s_add_u32 m0, s32, 77824
    s_add_u32 s61, s28, 0x94000
    buffer_load_dwordx4 v6, s[12:15], s61 offen nt lds
    s_add_u32 m0, s32, 81920
    s_add_u32 s61, s28, 0xa0000
    buffer_load_dwordx4 v6, s[12:15], s61 offen nt lds
    s_add_u32 m0, s32, 86016
    s_add_u32 s61, s28, 0xa4000
    buffer_load_dwordx4 v6, s[12:15], s61 offen nt lds
    s_add_u32 m0, s32, 90112
    s_add_u32 s61, s28, 0xb0000
    buffer_load_dwordx4 v6, s[12:15], s61 offen nt lds
    s_add_u32 m0, s32, 94208
    s_add_u32 s61, s28, 0xb4000
    buffer_load_dwordx4 v6, s[12:15], s61 offen nt lds
    s_add_u32 m0, s32, 98304
    s_add_u32 s61, s28, 0xc0000
    buffer_load_dwordx4 v6, s[12:15], s61 offen nt lds
    s_add_u32 m0, s32, 102400
    s_add_u32 s61, s28, 0xc4000
    buffer_load_dwordx4 v6, s[12:15], s61 offen nt lds
    s_add_u32 m0, s32, 106496
    s_add_u32 s61, s28, 0xd0000
    buffer_load_dwordx4 v6, s[12:15], s61 offen nt lds
    s_add_u32 m0, s32, 110592
    s_add_u32 s61, s28, 0xd4000
    buffer_load_dwordx4 v6, s[12:15], s61 offen nt lds
    s_add_u32 m0, s32, 114688
    s_add_u32 s61, s28, 0xe0000
    buffer_load_dwordx4 v6, s[12:15], s61 offen nt lds
    s_add_u32 m0, s32, 118784
    s_add_u32 s61, s28, 0xe4000
    buffer_load_dwordx4 v6, s[12:15], s61 offen nt lds
    s_add_u32 m0, s32, 122880
    s_add_u32 s61, s28, 0xf0000
    buffer_load_dwordx4 v6, s[12:15], s61 offen nt lds
    s_add_u32 m0, s32, 126976
    s_add_u32 s61, s28, 0xf4000
    buffer_load_dwordx4 v6, s[12:15], s61 offen nt lds
    s_add_u32 m0, s32, 131072
    s_add_u32 s61, s28, 0x100000
    buffer_load_dwordx4 v6, s[12:15], s61 offen nt lds
    s_add_u32 m0, s32, 135168
    s_add_u32 s61, s28, 0x104000
    buffer_load_dwordx4 v6, s[12:15], s61 offen nt lds
    s_add_u32 m0, s32, 139264
    s_add_u32 s61, s28, 0x110000
    buffer_load_dwordx4 v6, s[12:15], s61 offen nt lds
    s_add_u32 m0, s32, 143360
    s_add_u32 s61, s28, 0x114000
    buffer_load_dwordx4 v6, s[12:15], s61 offen nt lds
    s_add_u32 m0, s32, 147456
    s_add_u32 s61, s28, 0x120000
    buffer_load_dwordx4 v6, s[12:15], s61 offen nt lds
    s_add_u32 m0, s32, 151552
    s_add_u32 s61, s28, 0x124000
    buffer_load_dwordx4 v6, s[12:15], s61 offen nt lds
    s_add_u32 m0, s32, 155648
    s_add_u32 s61, s28, 0x130000
    buffer_load_dwordx4 v6, s[12:15], s61 offen nt lds
    s_add_u32 m0, s32, 159744
    s_add_u32 s61, s28, 0x134000
    buffer_load_dwordx4 v6, s[12:15], s61 offen nt lds
    s_andn2_b32 s60, 8, s57
    s_lshl_b32 s60, s60, 2
    v_bfe_u32 v24, v0, 2, 3
    v_lshrrev_b32 v25, 6, v0
    v_lshlrev_b32 v25, 1, v25
    v_xor_b32 v24, v24, v25
    v_lshlrev_b32 v8, 5, v24
    v_bfe_u32 v24, v0, 0, 2
    v_lshl_add_u32 v8, v24, 3, v8
    v_bfe_u32 v24, v0, 2, 2
    v_lshl_add_u32 v8, v24, 8, v8
    v_bfe_u32 v24, v0, 4, 2
    v_lshl_add_u32 v8, v24, 11, v8
    v_xor_b32 v8, s60, v8
    v_xor_b32 v9, 32, v8
    s_waitcnt vmcnt(32)
    s_barrier
    ds_read_b64_tr_b16 a[0:1], v8 offset:0
    ds_read_b64_tr_b16 a[2:3], v8 offset:1024
    ds_read_b64_tr_b16 a[4:5], v9 offset:0
    ds_read_b64_tr_b16 a[6:7], v9 offset:1024
    ds_read_b64_tr_b16 a[8:9], v8 offset:8192
    ds_read_b64_tr_b16 a[10:11], v8 offset:9216
    ds_read_b64_tr_b16 a[12:13], v9 offset:8192
    ds_read_b64_tr_b16 a[14:15], v9 offset:9216
    s_waitcnt lgkmcnt(0)
    ds_read_b64_tr_b16 a[16:17], v8 offset:16384
    ds_read_b64_tr_b16 a[18:19], v8 offset:17408
    ds_read_b64_tr_b16 a[20:21], v9 offset:16384
    ds_read_b64_tr_b16 a[22:23], v9 offset:17408
    ds_read_b64_tr_b16 a[24:25], v8 offset:24576
    ds_read_b64_tr_b16 a[26:27], v8 offset:25600
    ds_read_b64_tr_b16 a[28:29], v9 offset:24576
    ds_read_b64_tr_b16 a[30:31], v9 offset:25600
    s_waitcnt lgkmcnt(0)
    s_waitcnt vmcnt(24)
    s_barrier
    s_add_u32 m0, s32, 0
    s_add_u32 s61, s28, 0x140000
    buffer_load_dwordx4 v6, s[12:15], s61 offen nt lds
    s_add_u32 m0, s32, 4096
    s_add_u32 s61, s28, 0x144000
    buffer_load_dwordx4 v6, s[12:15], s61 offen nt lds
    s_add_u32 m0, s32, 8192
    s_add_u32 s61, s28, 0x150000
    buffer_load_dwordx4 v6, s[12:15], s61 offen nt lds
    s_add_u32 m0, s32, 12288
    s_add_u32 s61, s28, 0x154000
    buffer_load_dwordx4 v6, s[12:15], s61 offen nt lds
    s_add_u32 m0, s32, 16384
    s_add_u32 s61, s28, 0x160000
    buffer_load_dwordx4 v6, s[12:15], s61 offen nt lds
    s_add_u32 m0, s32, 20480
    s_add_u32 s61, s28, 0x164000
    buffer_load_dwordx4 v6, s[12:15], s61 offen nt lds
    s_add_u32 m0, s32, 24576
    s_add_u32 s61, s28, 0x170000
    buffer_load_dwordx4 v6, s[12:15], s61 offen nt lds
    s_add_u32 m0, s32, 28672
    s_add_u32 s61, s28, 0x174000
    buffer_load_dwordx4 v6, s[12:15], s61 offen nt lds
    ds_read_b64_tr_b16 a[32:33], v8 offset:32768
    ds_read_b64_tr_b16 a[34:35], v8 offset:33792
    ds_read_b64_tr_b16 a[36:37], v9 offset:32768
    ds_read_b64_tr_b16 a[38:39], v9 offset:33792
    ds_read_b64_tr_b16 a[40:41], v8 offset:40960
    ds_read_b64_tr_b16 a[42:43], v8 offset:41984
    ds_read_b64_tr_b16 a[44:45], v9 offset:40960
    ds_read_b64_tr_b16 a[46:47], v9 offset:41984
    s_waitcnt lgkmcnt(0)
    ds_read_b64_tr_b16 a[48:49], v8 offset:49152
    ds_read_b64_tr_b16 a[50:51], v8 offset:50176
    ds_read_b64_tr_b16 a[52:53], v9 offset:49152
    ds_read_b64_tr_b16 a[54:55], v9 offset:50176
    ds_read_b64_tr_b16 a[56:57], v8 offset:57344
    ds_read_b64_tr_b16 a[58:59], v8 offset:58368
    ds_read_b64_tr_b16 a[60:61], v9 offset:57344
    ds_read_b64_tr_b16 a[62:63], v9 offset:58368
    s_waitcnt lgkmcnt(0)
    s_waitcnt vmcnt(24)
    s_barrier
    s_add_u32 m0, s32, 32768
    s_add_u32 s61, s28, 0x180000
    buffer_load_dwordx4 v6, s[12:15], s61 offen nt lds
    s_add_u32 m0, s32, 36864
    s_add_u32 s61, s28, 0x184000
    buffer_load_dwordx4 v6, s[12:15], s61 offen nt lds
    s_add_u32 m0, s32, 40960
    s_add_u32 s61, s28, 0x190000
    buffer_load_dwordx4 v6, s[12:15], s61 offen nt lds
    s_add_u32 m0, s32, 45056
    s_add_u32 s61, s28, 0x194000
    buffer_load_dwordx4 v6, s[12:15], s61 offen nt lds
    s_add_u32 m0, s32, 49152
    s_add_u32 s61, s28, 0x1a0000
    buffer_load_dwordx4 v6, s[12:15], s61 offen nt lds
    s_add_u32 m0, s32, 53248
    s_add_u32 s61, s28, 0x1a4000
    buffer_load_dwordx4 v6, s[12:15], s61 offen nt lds
    s_add_u32 m0, s32, 57344
    s_add_u32 s61, s28, 0x1b0000
    buffer_load_dwordx4 v6, s[12:15], s61 offen nt lds
    s_add_u32 m0, s32, 61440
    s_add_u32 s61, s28, 0x1b4000
    buffer_load_dwordx4 v6, s[12:15], s61 offen nt lds
    v_add_u32 v8, 0x10000, v8
    v_add_u32 v9, 0x10000, v9
    ds_read_b64_tr_b16 a[64:65], v8 offset:0
    ds_read_b64_tr_b16 a[66:67], v8 offset:1024
    ds_read_b64_tr_b16 a[68:69], v9 offset:0
    ds_read_b64_tr_b16 a[70:71], v9 offset:1024
    ds_read_b64_tr_b16 a[72:73], v8 offset:8192
    ds_read_b64_tr_b16 a[74:75], v8 offset:9216
    ds_read_b64_tr_b16 a[76:77], v9 offset:8192
    ds_read_b64_tr_b16 a[78:79], v9 offset:9216
    s_waitcnt lgkmcnt(0)
    ds_read_b64_tr_b16 a[80:81], v8 offset:16384
    ds_read_b64_tr_b16 a[82:83], v8 offset:17408
    ds_read_b64_tr_b16 a[84:85], v9 offset:16384
    ds_read_b64_tr_b16 a[86:87], v9 offset:17408
    ds_read_b64_tr_b16 a[88:89], v8 offset:24576
    ds_read_b64_tr_b16 a[90:91], v8 offset:25600
    ds_read_b64_tr_b16 a[92:93], v9 offset:24576
    ds_read_b64_tr_b16 a[94:95], v9 offset:25600
    s_waitcnt lgkmcnt(0)
    s_waitcnt vmcnt(24)
    s_barrier
    s_add_u32 m0, s32, 65536
    s_add_u32 s61, s28, 0x1c0000
    buffer_load_dwordx4 v6, s[12:15], s61 offen nt lds
    s_add_u32 m0, s32, 69632
    s_add_u32 s61, s28, 0x1c4000
    buffer_load_dwordx4 v6, s[12:15], s61 offen nt lds
    s_add_u32 m0, s32, 73728
    s_add_u32 s61, s28, 0x1d0000
    buffer_load_dwordx4 v6, s[12:15], s61 offen nt lds
    s_add_u32 m0, s32, 77824
    s_add_u32 s61, s28, 0x1d4000
    buffer_load_dwordx4 v6, s[12:15], s61 offen nt lds
    s_add_u32 m0, s32, 81920
    s_add_u32 s61, s28, 0x1e0000
    buffer_load_dwordx4 v6, s[12:15], s61 offen nt lds
    s_add_u32 m0, s32, 86016
    s_add_u32 s61, s28, 0x1e4000
    buffer_load_dwordx4 v6, s[12:15], s61 offen nt lds
    s_add_u32 m0, s32, 90112
    s_add_u32 s61, s28, 0x1f0000
    buffer_load_dwordx4 v6, s[12:15], s61 offen nt lds
    s_add_u32 m0, s32, 94208
    s_add_u32 s61, s28, 0x1f4000
    buffer_load_dwordx4 v6, s[12:15], s61 offen nt lds
    ds_read_b64_tr_b16 a[96:97], v8 offset:32768
    ds_read_b64_tr_b16 a[98:99], v8 offset:33792
    ds_read_b64_tr_b16 a[100:101], v9 offset:32768
    ds_read_b64_tr_b16 a[102:103], v9 offset:33792
    ds_read_b64_tr_b16 a[104:105], v8 offset:40960
    ds_read_b64_tr_b16 a[106:107], v8 offset:41984
    ds_read_b64_tr_b16 a[108:109], v9 offset:40960
    ds_read_b64_tr_b16 a[110:111], v9 offset:41984
    s_waitcnt lgkmcnt(0)
    ds_read_b64_tr_b16 a[112:113], v8 offset:49152
    ds_read_b64_tr_b16 a[114:115], v8 offset:50176
    ds_read_b64_tr_b16 a[116:117], v9 offset:49152
    ds_read_b64_tr_b16 a[118:119], v9 offset:50176
    ds_read_b64_tr_b16 a[120:121], v8 offset:57344
    ds_read_b64_tr_b16 a[122:123], v8 offset:58368
    ds_read_b64_tr_b16 a[124:125], v9 offset:57344
    ds_read_b64_tr_b16 a[126:127], v9 offset:58368
    s_waitcnt lgkmcnt(0)
    s_waitcnt vmcnt(24)
    s_barrier
    v_add_u32 v8, 0x10000, v8
    v_add_u32 v9, 0x10000, v9
    ds_read_b64_tr_b16 a[128:129], v8 offset:0
    ds_read_b64_tr_b16 a[130:131], v8 offset:1024
    ds_read_b64_tr_b16 a[132:133], v9 offset:0
    ds_read_b64_tr_b16 a[134:135], v9 offset:1024
    ds_read_b64_tr_b16 a[136:137], v8 offset:8192
    ds_read_b64_tr_b16 a[138:139], v8 offset:9216
    ds_read_b64_tr_b16 a[140:141], v9 offset:8192
    ds_read_b64_tr_b16 a[142:143], v9 offset:9216
    s_waitcnt lgkmcnt(0)
    ds_read_b64_tr_b16 a[144:145], v8 offset:16384
    ds_read_b64_tr_b16 a[146:147], v8 offset:17408
    ds_read_b64_tr_b16 a[148:149], v9 offset:16384
    ds_read_b64_tr_b16 a[150:151], v9 offset:17408
    ds_read_b64_tr_b16 a[152:153], v8 offset:24576
    ds_read_b64_tr_b16 a[154:155], v8 offset:25600
    ds_read_b64_tr_b16 a[156:157], v9 offset:24576
    ds_read_b64_tr_b16 a[158:159], v9 offset:25600
    s_waitcnt lgkmcnt(0)
    s_waitcnt vmcnt(16)
    s_barrier
    v_add_u32 v8, 0xfffe0000, v8
    v_add_u32 v9, 0xfffe0000, v9
    ds_read_b64_tr_b16 a[160:161], v8 offset:0
    ds_read_b64_tr_b16 a[162:163], v8 offset:1024
    ds_read_b64_tr_b16 a[164:165], v9 offset:0
    ds_read_b64_tr_b16 a[166:167], v9 offset:1024
    ds_read_b64_tr_b16 a[168:169], v8 offset:8192
    ds_read_b64_tr_b16 a[170:171], v8 offset:9216
    ds_read_b64_tr_b16 a[172:173], v9 offset:8192
    ds_read_b64_tr_b16 a[174:175], v9 offset:9216
    s_waitcnt lgkmcnt(0)
    ds_read_b64_tr_b16 a[176:177], v8 offset:16384
    ds_read_b64_tr_b16 a[178:179], v8 offset:17408
    ds_read_b64_tr_b16 a[180:181], v9 offset:16384
    ds_read_b64_tr_b16 a[182:183], v9 offset:17408
    ds_read_b64_tr_b16 a[184:185], v8 offset:24576
    ds_read_b64_tr_b16 a[186:187], v8 offset:25600
    ds_read_b64_tr_b16 a[188:189], v9 offset:24576
    ds_read_b64_tr_b16 a[190:191], v9 offset:25600
    s_waitcnt lgkmcnt(0)
    s_waitcnt vmcnt(8)
    s_barrier
    ds_read_b64_tr_b16 a[192:193], v8 offset:32768
    ds_read_b64_tr_b16 a[194:195], v8 offset:33792
    ds_read_b64_tr_b16 a[196:197], v9 offset:32768
    ds_read_b64_tr_b16 a[198:199], v9 offset:33792
    ds_read_b64_tr_b16 a[200:201], v8 offset:40960
    ds_read_b64_tr_b16 a[202:203], v8 offset:41984
    ds_read_b64_tr_b16 a[204:205], v9 offset:40960
    ds_read_b64_tr_b16 a[206:207], v9 offset:41984
    s_waitcnt lgkmcnt(0)
    ds_read_b64_tr_b16 a[208:209], v8 offset:49152
    ds_read_b64_tr_b16 a[210:211], v8 offset:50176
    ds_read_b64_tr_b16 a[212:213], v9 offset:49152
    ds_read_b64_tr_b16 a[214:215], v9 offset:50176
    ds_read_b64_tr_b16 a[216:217], v8 offset:57344
    ds_read_b64_tr_b16 a[218:219], v8 offset:58368
    ds_read_b64_tr_b16 a[220:221], v9 offset:57344
    ds_read_b64_tr_b16 a[222:223], v9 offset:58368
    s_waitcnt lgkmcnt(0)
    s_waitcnt vmcnt(0)
    s_barrier
    v_add_u32 v8, 0x10000, v8
    v_add_u32 v9, 0x10000, v9
    ds_read_b64_tr_b16 a[224:225], v8 offset:0
    ds_read_b64_tr_b16 a[226:227], v8 offset:1024
    ds_read_b64_tr_b16 a[228:229], v9 offset:0
    ds_read_b64_tr_b16 a[230:231], v9 offset:1024
    ds_read_b64_tr_b16 a[232:233], v8 offset:8192
    ds_read_b64_tr_b16 a[234:235], v8 offset:9216
    ds_read_b64_tr_b16 a[236:237], v9 offset:8192
    ds_read_b64_tr_b16 a[238:239], v9 offset:9216
    s_waitcnt lgkmcnt(0)
    ds_read_b64_tr_b16 a[240:241], v8 offset:16384
    ds_read_b64_tr_b16 a[242:243], v8 offset:17408
    ds_read_b64_tr_b16 a[244:245], v9 offset:16384
    ds_read_b64_tr_b16 a[246:247], v9 offset:17408
    ds_read_b64_tr_b16 a[248:249], v8 offset:24576
    ds_read_b64_tr_b16 a[250:251], v8 offset:25600
    ds_read_b64_tr_b16 a[252:253], v9 offset:24576
    ds_read_b64_tr_b16 a[254:255], v9 offset:25600
    s_waitcnt lgkmcnt(0)
    s_barrier
    s_cmp_eq_u32 s39, 0
    s_cbranch_scc1 seg_t0
    s_lshl_b32 s20, s58, 13
    s_mov_b32 s21, 0
    s_lshr_b32 s60, s57, 4
    s_lshl_b32 s60, s60, 12
    v_add_u32 v5, s60, v1
    v_xor_b32 v4, 4096, v5
    s_mul_i32 s35, s56, 8
    s_lshr_b32 s35, 0x37363538, s35
    s_and_b32 s35, s35, 255
    s_add_u32 s34, s33, 11
    s_mov_b32 s25, 0
    s_mov_b32 s42, 0
    s_mov_b32 s18, 0
    v_mov_b32 v18, s26
    v_writelane_b32 v18, s34, 32
    v_writelane_b32 v18, s40, 33
L_sp_52:
    global_load_dword v19, v[16:17], off sc1
    s_add_u32 s30, s30, 1
    s_cmp_gt_u32 s30, 0x200000
    s_cbranch_scc1 chain_kernel_wabort
    s_waitcnt vmcnt(0)
    v_cmp_lt_u32 vcc, v19, v18
    s_cbranch_vccz L_spok_53
    s_sleep 4
    s_branch L_sp_52
L_spok_53:
    s_cmp_lt_u32 s33, 9
    s_cselect_b32 s41, 3, 4
    s_add_u32 s41, s41, s33
    s_lshl_b32 s61, s33, 13
    s_and_b32 s61, s61, 0x2000
    s_xor_b32 s61, s61, s31
    s_lshl_b32 s23, s33, 21
    s_add_u32 s23, s23, s61
    s_cmp_gt_u32 s33, s35
    s_cselect_b32 s23, 0xe000000, s23
    s_add_u32 m0, s20, 0
    s_nop 0
    buffer_load_dwordx4 v1, s[8:11], s23 offen offset:0 lds
    buffer_load_dwordx4 v1, s[8:11], s23 offen offset:1024 lds
    buffer_load_dwordx4 v1, s[8:11], s23 offen offset:2048 lds
    buffer_load_dwordx4 v1, s[8:11], s23 offen offset:3072 lds
    s_add_u32 m0, s20, 4096
    s_nop 0
    buffer_load_dwordx4 v2, s[8:11], s23 offen offset:0 lds
    buffer_load_dwordx4 v2, s[8:11], s23 offen offset:1024 lds
    buffer_load_dwordx4 v2, s[8:11], s23 offen offset:2048 lds
    buffer_load_dwordx4 v2, s[8:11], s23 offen offset:3072 lds
    s_add_u32 s20, s20, 32768
    s_cmp_ge_u32 s20, 163840
    s_cselect_b32 s60, 163840, 0
    s_sub_u32 s20, s20, s60
    s_add_u32 s23, s23, 0x40000
    s_add_u32 m0, s20, 0
    s_nop 0
    buffer_load_dwordx4 v1, s[8:11], s23 offen offset:0 lds
    buffer_load_dwordx4 v1, s[8:11], s23 offen offset:1024 lds
    buffer_load_dwordx4 v1, s[8:11], s23 offen offset:2048 lds
    buffer_load_dwordx4 v1, s[8:11], s23 offen offset:3072 lds
    s_add_u32 m0, s20, 4096
    s_nop 0
    buffer_load_dwordx4 v2, s[8:11], s23 offen offset:0 lds
    buffer_load_dwordx4 v2, s[8:11], s23 offen offset:1024 lds
    buffer_load_dwordx4 v2, s[8:11], s23 offen offset:2048 lds
    buffer_load_dwordx4 v2, s[8:11], s23 offen offset:3072 lds
    s_add_u32 s20, s20, 32768
    s_cmp_ge_u32 s20, 163840
    s_cselect_b32 s60, 163840, 0
    s_sub_u32 s20, s20, s60
    s_lshl_b32 s42, s42, 8
    s_or_b32 s42, s42, s33
    s_mov_b32 s33, s41
    s_cmp_lt_u32 s33, 9
    s_cselect_b32 s41, 3, 4
    s_add_u32 s41, s41, s33
    s_lshl_b32 s61, s33, 13
    s_and_b32 s61, s61, 0x2000
    s_xor_b32 s61, s61, s31
    s_lshl_b32 s23, s33, 21
    s_add_u32 s23, s23, s61
    s_cmp_gt_u32 s33, s35
    s_cselect_b32 s23, 0xe000000, s23
    s_add_u32 m0, s20, 0
    s_nop 0
    buffer_load_dwordx4 v1, s[8:11], s23 offen offset:0 lds
    buffer_load_dwordx4 v1, s[8:11], s23 offen offset:1024 lds
    buffer_load_dwordx4 v1, s[8:11], s23 offen offset:2048 lds
    buffer_load_dwordx4 v1, s[8:11], s23 offen offset:3072 lds
    s_add_u32 m0, s20, 4096
    s_nop 0
    buffer_load_dwordx4 v2, s[8:11], s23 offen offset:0 lds
    buffer_load_dwordx4 v2, s[8:11], s23 offen offset:1024 lds
    buffer_load_dwordx4 v2, s[8:11], s23 offen offset:2048 lds
    buffer_load_dwordx4 v2, s[8:11], s23 offen offset:3072 lds
    s_add_u32 s20, s20, 32768
    s_cmp_ge_u32 s20, 163840
    s_cselect_b32 s60, 163840, 0
    s_sub_u32 s20, s20, s60
    s_add_u32 s23, s23, 0x40000
    s_mov_b32 s37, 0xe000000
    s_waitcnt vmcnt(8)
    s_barrier
    ds_read_b128 v[72:75], v4 offset:0
    ds_read_b128 v[76:79], v5 offset:0
    ds_read_b128 v[80:83], v4 offset:1024
    ds_read_b128 v[84:87], v5 offset:1024
    ds_read_b128 v[88:91], v4 offset:2048
    ds_read_b128 v[92:95], v5 offset:2048
seg_p:
    s_waitcnt lgkmcnt(4)
    v_mfma_f32_16x16x32_bf16 v[32:35], a[0:3], v[72:75], 0
    ds_read_b128 v[96:99], v4 offset:3072
    s_waitcnt vmcnt(4)
    v_mfma_f32_16x16x32_bf16 v[36:39], a[4:7], v[72:75], 0
    ds_read_b128 v[100:103], v5 offset:3072
    v_pk_add_f32 v[104:105], v[104:105], v[64:65]
    v_mfma_f32_16x16x32_bf16 v[44:47], a[4:7], v[76:79], 0
    v_pk_add_f32 v[106:107], v[106:107], v[66:67]
    s_xor_b32 s24, s24, 0x80000
    v_mfma_f32_16x16x32_bf16 v[40:43], a[0:3], v[76:79], 0
    buffer_store_dwordx4 v[48:51], v20, s[8:11], s24 offen
    s_waitcnt lgkmcnt(4)
    v_mfma_f32_16x16x32_bf16 v[32:35], a[8:11], v[80:83], v[32:35]
    ds_read_b128 v[72:75], v4 offset:8192
    v_mfma_f32_16x16x32_bf16 v[36:39], a[12:15], v[80:83], v[36:39]
    ds_read_b128 v[76:79], v5 offset:8192
    buffer_store_dwordx4 v[52:55], v21, s[8:11], s24 offen
    v_mfma_f32_16x16x32_bf16 v[44:47], a[12:15], v[84:87], v[44:47]
    v_mfma_f32_16x16x32_bf16 v[40:43], a[8:11], v[84:87], v[40:43]
    buffer_store_dwordx4 v[56:59], v22, s[8:11], s24 offen
    s_waitcnt lgkmcnt(4)
    v_mfma_f32_16x16x32_bf16 v[32:35], a[16:19], v[88:91], v[32:35]
    ds_read_b128 v[80:83], v4 offset:9216
    buffer_load_dword v13, v10, s[8:11], s37 offen
    v_mfma_f32_16x16x32_bf16 v[36:39], a[20:23], v[88:91], v[36:39]
    ds_read_b128 v[84:87], v5 offset:9216
    v_pk_add_f32 v[108:109], v[108:109], v[112:113]
    v_mfma_f32_16x16x32_bf16 v[44:47], a[20:23], v[92:95], v[44:47]
    v_pk_add_f32 v[110:111], v[110:111], v[114:115]
    v_pk_add_f32 v[104:105], v[104:105], v[108:109]
    v_mfma_f32_16x16x32_bf16 v[40:43], a[16:19], v[92:95], v[40:43]
    v_pk_add_f32 v[106:107], v[106:107], v[110:111]
    s_waitcnt lgkmcnt(4)
    v_mfma_f32_16x16x32_bf16 v[32:35], a[24:27], v[96:99], v[32:35]
    ds_read_b128 v[88:91], v4 offset:10240
    v_cvt_pk_bf16_f32 v104, 0, v104
    v_mfma_f32_16x16x32_bf16 v[36:39], a[28:31], v[96:99], v[36:39]
    ds_read_b128 v[92:95], v5 offset:10240
    v_cvt_pk_bf16_f32 v105, 0, v105
    v_mfma_f32_16x16x32_bf16 v[44:47], a[28:31], v[100:103], v[44:47]
    v_cvt_pk_bf16_f32 v106, 0, v106
    v_cvt_pk_bf16_f32 v107, 0, v107
    v_mfma_f32_16x16x32_bf16 v[40:43], a[24:27], v[100:103], v[40:43]
    buffer_store_dwordx4 v[104:107], v15, s[16:19], s25 offen
    s_waitcnt lgkmcnt(4)
    v_mfma_f32_16x16x32_bf16 v[32:35], a[32:35], v[72:75], v[32:35]
    ds_read_b128 v[96:99], v4 offset:11264
    v_mov_b32 v64, v60
    v_mfma_f32_16x16x32_bf16 v[36:39], a[36:39], v[72:75], v[36:39]
    ds_read_b128 v[100:103], v5 offset:11264
    v_mov_b32 v65, v61
    v_mfma_f32_16x16x32_bf16 v[44:47], a[36:39], v[76:79], v[44:47]
    v_mov_b32 v66, v62
    v_mov_b32 v67, v63
    v_mfma_f32_16x16x32_bf16 v[40:43], a[32:35], v[76:79], v[40:43]
    s_waitcnt lgkmcnt(4)
    v_mfma_f32_16x16x32_bf16 v[32:35], a[40:43], v[80:83], v[32:35]
    ds_read_b128 v[72:75], v4 offset:16384
    v_mfma_f32_16x16x32_bf16 v[36:39], a[44:47], v[80:83], v[36:39]
    ds_read_b128 v[76:79], v5 offset:16384
    v_mfma_f32_16x16x32_bf16 v[44:47], a[44:47], v[84:87], v[44:47]
    v_mfma_f32_16x16x32_bf16 v[40:43], a[40:43], v[84:87], v[40:43]
    s_waitcnt lgkmcnt(4)
    v_mfma_f32_16x16x32_bf16 v[32:35], a[48:51], v[88:91], v[32:35]
    ds_read_b128 v[80:83], v4 offset:17408
    s_lshl_b32 s42, s42, 8
    v_mfma_f32_16x16x32_bf16 v[36:39], a[52:55], v[88:91], v[36:39]
    ds_read_b128 v[84:87], v5 offset:17408
    s_or_b32 s42, s42, s33
    v_mfma_f32_16x16x32_bf16 v[44:47], a[52:55], v[92:95], v[44:47]
    s_mov_b32 s33, s41
    s_cmp_lt_u32 s33, 9
    v_mfma_f32_16x16x32_bf16 v[40:43], a[48:51], v[92:95], v[40:43]
    s_cselect_b32 s41, 3, 4
    s_waitcnt lgkmcnt(4)
    v_mfma_f32_16x16x32_bf16 v[32:35], a[56:59], v[96:99], v[32:35]
    ds_read_b128 v[88:91], v4 offset:18432
    s_add_u32 s41, s41, s33
    v_mfma_f32_16x16x32_bf16 v[36:39], a[60:63], v[96:99], v[36:39]
    ds_read_b128 v[92:95], v5 offset:18432
    s_cmp_ge_u32 s21, 131072
    v_mfma_f32_16x16x32_bf16 v[44:47], a[60:63], v[100:103], v[44:47]
    s_cselect_b32 s22, 0xfffe0000, s29
    s_add_u32 s21, s21, s22
    v_mfma_f32_16x16x32_bf16 v[40:43], a[56:59], v[100:103], v[40:43]
    s_min_u32 s34, s41, s35
    s_waitcnt lgkmcnt(4)
    v_mfma_f32_16x16x32_bf16 v[32:35], a[64:67], v[72:75], v[32:35]
    ds_read_b128 v[96:99], v4 offset:19456
    s_add_u32 s34, s34, 3
    v_mfma_f32_16x16x32_bf16 v[36:39], a[68:71], v[72:75], v[36:39]
    ds_read_b128 v[100:103], v5 offset:19456
    s_bfe_u32 s25, s42, 0x80010
    v_mfma_f32_16x16x32_bf16 v[44:47], a[68:71], v[76:79], v[44:47]
    s_lshl_b32 s25, s25, 18
    s_cmp_ge_u32 s26, 1
    v_mfma_f32_16x16x32_bf16 v[40:43], a[64:67], v[76:79], v[40:43]
    s_cselect_b32 s18, 0x1000000, 0
    s_waitcnt lgkmcnt(4)
    v_mfma_f32_16x16x32_bf16 v[32:35], a[72:75], v[80:83], v[32:35]
    ds_read_b128 v[72:75], v4 offset:24576
    v_mfma_f32_16x16x32_bf16 v[36:39], a[76:79], v[80:83], v[36:39]
    ds_read_b128 v[76:79], v5 offset:24576
    v_mfma_f32_16x16x32_bf16 v[44:47], a[76:79], v[84:87], v[44:47]
    v_mfma_f32_16x16x32_bf16 v[40:43], a[72:75], v[84:87], v[40:43]
    s_waitcnt lgkmcnt(4)
    v_mfma_f32_16x16x32_bf16 v[32:35], a[80:83], v[88:91], v[32:35]
    ds_read_b128 v[80:83], v4 offset:25600
    s_add_u32 m0, s20, 0
    v_mfma_f32_16x16x32_bf16 v[36:39], a[84:87], v[88:91], v[36:39]
    ds_read_b128 v[84:87], v5 offset:25600
    buffer_load_dwordx4 v1, s[8:11], s23 offen offset:0 lds
    v_mfma_f32_16x16x32_bf16 v[44:47], a[84:87], v[92:95], v[44:47]
    v_mfma_f32_16x16x32_bf16 v[40:43], a[80:83], v[92:95], v[40:43]
    s_waitcnt lgkmcnt(4)
    v_mfma_f32_16x16x32_bf16 v[32:35], a[88:91], v[96:99], v[32:35]
    ds_read_b128 v[88:91], v4 offset:26624
    v_mfma_f32_16x16x32_bf16 v[36:39], a[92:95], v[96:99], v[36:39]
    ds_read_b128 v[92:95], v5 offset:26624
    buffer_load_dwordx4 v1, s[8:11], s23 offen offset:1024 lds
    v_mfma_f32_16x16x32_bf16 v[44:47], a[92:95], v[100:103], v[44:47]
    v_mfma_f32_16x16x32_bf16 v[40:43], a[88:91], v[100:103], v[40:43]
    s_waitcnt lgkmcnt(4)
    v_mfma_f32_16x16x32_bf16 v[32:35], a[96:99], v[72:75], v[32:35]
    ds_read_b128 v[96:99], v4 offset:27648
    v_mfma_f32_16x16x32_bf16 v[36:39], a[100:103], v[72:75], v[36:39]
    ds_read_b128 v[100:103], v5 offset:27648
    v_mfma_f32_16x16x32_bf16 v[44:47], a[100:103], v[76:79], v[44:47]
    v_add_u32 v4, s22, v4
    v_add_u32 v5, s22, v5
    v_mfma_f32_16x16x32_bf16 v[40:43], a[96:99], v[76:79], v[40:43]
    buffer_load_dwordx4 v1, s[8:11], s23 offen offset:2048 lds
    s_waitcnt vmcnt(5)
    s_barrier
    s_waitcnt lgkmcnt(4)
    v_mfma_f32_16x16x32_bf16 v[32:35], a[104:107], v[80:83], v[32:35]
    ds_read_b128 v[72:75], v4 offset:0
    s_add_u32 s26, s26, 1
    v_mfma_f32_16x16x32_bf16 v[36:39], a[108:111], v[80:83], v[36:39]
    ds_read_b128 v[76:79], v5 offset:0
    v_mov_b32 v12, s26
    v_mfma_f32_16x16x32_bf16 v[44:47], a[108:111], v[84:87], v[44:47]
    buffer_store_dword v12, v11, s[8:11], s27 offen
    v_mfma_f32_16x16x32_bf16 v[40:43], a[104:107], v[84:87], v[40:43]
    buffer_load_dwordx4 v1, s[8:11], s23 offen offset:3072 lds
    s_waitcnt lgkmcnt(4)
    v_mfma_f32_16x16x32_bf16 v[32:35], a[112:115], v[88:91], v[32:35]
    ds_read_b128 v[80:83], v4 offset:1024
    v_mfma_f32_16x16x32_bf16 v[36:39], a[116:119], v[88:91], v[36:39]
    ds_read_b128 v[84:87], v5 offset:1024
    v_mov_b32 v18, s26
    v_mfma_f32_16x16x32_bf16 v[44:47], a[116:119], v[92:95], v[44:47]
    v_writelane_b32 v18, s34, 32
    v_writelane_b32 v18, s40, 33
    v_mfma_f32_16x16x32_bf16 v[40:43], a[112:115], v[92:95], v[40:43]
    s_waitcnt lgkmcnt(4)
    v_mfma_f32_16x16x32_bf16 v[32:35], a[120:123], v[96:99], v[32:35]
    ds_read_b128 v[88:91], v4 offset:2048
    s_add_u32 m0, s20, 4096
    v_mfma_f32_16x16x32_bf16 v[36:39], a[124:127], v[96:99], v[36:39]
    ds_read_b128 v[92:95], v5 offset:2048
    buffer_load_dwordx4 v2, s[8:11], s23 offen offset:0 lds
    v_mfma_f32_16x16x32_bf16 v[44:47], a[124:127], v[100:103], v[44:47]
    s_cmp_ge_u32 s21, 131072
    s_cselect_b32 s22, 0xfffe0000, s29
    v_mfma_f32_16x16x32_bf16 v[40:43], a[120:123], v[100:103], v[40:43]
    s_add_u32 s21, s21, s22
    s_waitcnt lgkmcnt(4)
    v_mfma_f32_16x16x32_bf16 v[32:35], a[128:131], v[72:75], v[32:35]
    ds_read_b128 v[96:99], v4 offset:3072
    s_lshl_b32 s61, s41, 13
    v_mfma_f32_16x16x32_bf16 v[36:39], a[132:135], v[72:75], v[36:39]
    ds_read_b128 v[100:103], v5 offset:3072
    s_and_b32 s61, s61, 0x2000
    v_mfma_f32_16x16x32_bf16 v[44:47], a[132:135], v[76:79], v[44:47]
    s_xor_b32 s61, s61, s31
    s_lshl_b32 s37, s41, 21
    v_mfma_f32_16x16x32_bf16 v[40:43], a[128:131], v[76:79], v[40:43]
    s_add_u32 s37, s37, s61
    s_waitcnt lgkmcnt(4)
    v_mfma_f32_16x16x32_bf16 v[32:35], a[136:139], v[80:83], v[32:35]
    ds_read_b128 v[72:75], v4 offset:8192
    s_cmp_gt_u32 s41, s35
    v_mfma_f32_16x16x32_bf16 v[36:39], a[140:143], v[80:83], v[36:39]
    ds_read_b128 v[76:79], v5 offset:8192
    s_cselect_b32 s37, 0xe000000, s37
    v_mfma_f32_16x16x32_bf16 v[44:47], a[140:143], v[84:87], v[44:47]
    s_add_u32 s37, s37, s38
    buffer_load_dwordx4 v2, s[8:11], s23 offen offset:1024 lds
    v_mfma_f32_16x16x32_bf16 v[40:43], a[136:139], v[84:87], v[40:43]
    buffer_load_dwordx4 v2, s[8:11], s23 offen offset:2048 lds
    s_waitcnt lgkmcnt(4)
    v_mfma_f32_16x16x32_bf16 v[32:35], a[144:147], v[88:91], v[32:35]
    ds_read_b128 v[80:83], v4 offset:9216
    global_load_dword v19, v[16:17], off sc1
    v_mfma_f32_16x16x32_bf16 v[36:39], a[148:151], v[88:91], v[36:39]
    ds_read_b128 v[84:87], v5 offset:9216
    v_mfma_f32_16x16x32_bf16 v[44:47], a[148:151], v[92:95], v[44:47]
    v_mfma_f32_16x16x32_bf16 v[40:43], a[144:147], v[92:95], v[40:43]
    buffer_load_dwordx4 v2, s[8:11], s23 offen offset:3072 lds
    s_waitcnt lgkmcnt(4)
    v_mfma_f32_16x16x32_bf16 v[32:35], a[152:155], v[96:99], v[32:35]
    ds_read_b128 v[88:91], v4 offset:10240
    s_add_u32 s20, s20, 32768
    v_mfma_f32_16x16x32_bf16 v[36:39], a[156:159], v[96:99], v[36:39]
    ds_read_b128 v[92:95], v5 offset:10240
    s_cmp_ge_u32 s20, 163840
    v_mfma_f32_16x16x32_bf16 v[44:47], a[156:159], v[100:103], v[44:47]
    s_cselect_b32 s60, 163840, 0
    s_sub_u32 s20, s20, s60
    v_mfma_f32_16x16x32_bf16 v[40:43], a[152:155], v[100:103], v[40:43]
    s_lshl_b32 s61, s33, 13
    s_waitcnt lgkmcnt(4)
    v_mfma_f32_16x16x32_bf16 v[32:35], a[160:163], v[72:75], v[32:35]
    ds_read_b128 v[96:99], v4 offset:11264
    s_and_b32 s61, s61, 0x2000
    v_mfma_f32_16x16x32_bf16 v[36:39], a[164:167], v[72:75], v[36:39]
    ds_read_b128 v[100:103], v5 offset:11264
    s_xor_b32 s61, s61, s31
    v_mfma_f32_16x16x32_bf16 v[44:47], a[164:167], v[76:79], v[44:47]
    s_lshl_b32 s23, s33, 21
    s_add_u32 s23, s23, s61
    v_mfma_f32_16x16x32_bf16 v[40:43], a[160:163], v[76:79], v[40:43]
    s_cmp_gt_u32 s33, s35
    s_waitcnt lgkmcnt(4)
    v_mfma_f32_16x16x32_bf16 v[32:35], a[168:171], v[80:83], v[32:35]
    ds_read_b128 v[72:75], v4 offset:16384
    s_cselect_b32 s23, 0xe000000, s23
    v_mfma_f32_16x16x32_bf16 v[36:39], a[172:175], v[80:83], v[36:39]
    ds_read_b128 v[76:79], v5 offset:16384
    s_add_u32 m0, s20, 0
    v_mfma_f32_16x16x32_bf16 v[44:47], a[172:175], v[84:87], v[44:47]
    buffer_load_dwordx4 v1, s[8:11], s23 offen offset:0 lds
    v_mfma_f32_16x16x32_bf16 v[40:43], a[168:171], v[84:87], v[40:43]
    buffer_load_dwordx4 v1, s[8:11], s23 offen offset:1024 lds
    s_waitcnt lgkmcnt(4)
    v_mfma_f32_16x16x32_bf16 v[32:35], a[176:179], v[88:91], v[32:35]
    ds_read_b128 v[80:83], v4 offset:17408
    v_mfma_f32_16x16x32_bf16 v[36:39], a[180:183], v[88:91], v[36:39]
    ds_read_b128 v[84:87], v5 offset:17408
    v_mfma_f32_16x16x32_bf16 v[44:47], a[180:183], v[92:95], v[44:47]
    buffer_load_dwordx4 v1, s[8:11], s23 offen offset:2048 lds
    v_mfma_f32_16x16x32_bf16 v[40:43], a[176:179], v[92:95], v[40:43]
    s_waitcnt lgkmcnt(4)
    v_mfma_f32_16x16x32_bf16 v[32:35], a[184:187], v[96:99], v[32:35]
    ds_read_b128 v[88:91], v4 offset:18432
    v_mfma_f32_16x16x32_bf16 v[36:39], a[188:191], v[96:99], v[36:39]
    ds_read_b128 v[92:95], v5 offset:18432
    v_mfma_f32_16x16x32_bf16 v[44:47], a[188:191], v[100:103], v[44:47]
    v_mfma_f32_16x16x32_bf16 v[40:43], a[184:187], v[100:103], v[40:43]
    buffer_load_dwordx4 v1, s[8:11], s23 offen offset:3072 lds
    s_waitcnt lgkmcnt(4)
    v_mfma_f32_16x16x32_bf16 v[32:35], a[192:195], v[72:75], v[32:35]
    ds_read_b128 v[96:99], v4 offset:19456
    s_waitcnt vmcnt(5)
    v_cmp_lt_u32 vcc, v19, v18
    v_mfma_f32_16x16x32_bf16 v[36:39], a[196:199], v[72:75], v[36:39]
    ds_read_b128 v[100:103], v5 offset:19456
    v_mfma_f32_16x16x32_bf16 v[44:47], a[196:199], v[76:79], v[44:47]
    v_mfma_f32_16x16x32_bf16 v[40:43], a[192:195], v[76:79], v[40:43]
    s_cbranch_vccnz seg_pslow
seg_pok:
    s_waitcnt lgkmcnt(4)
    v_mfma_f32_16x16x32_bf16 v[32:35], a[200:203], v[80:83], v[32:35]
    ds_read_b128 v[72:75], v4 offset:24576
    buffer_load_dwordx4 v[104:107], v23, s[8:11], s24 offen offset:0 sc1
    v_mfma_f32_16x16x32_bf16 v[36:39], a[204:207], v[80:83], v[36:39]
    ds_read_b128 v[76:79], v5 offset:24576
    buffer_load_dwordx4 v[108:111], v23, s[8:11], s24 offen offset:1024 sc1
    v_mfma_f32_16x16x32_bf16 v[44:47], a[204:207], v[84:87], v[44:47]
    buffer_load_dwordx4 v[112:115], v23, s[8:11], s24 offen offset:2048 sc1
    v_mfma_f32_16x16x32_bf16 v[40:43], a[200:203], v[84:87], v[40:43]
    s_add_u32 m0, s20, 4096
    s_waitcnt lgkmcnt(4)
    v_mfma_f32_16x16x32_bf16 v[32:35], a[208:211], v[88:91], v[32:35]
    ds_read_b128 v[80:83], v4 offset:25600
    buffer_load_dwordx4 v2, s[8:11], s23 offen offset:0 lds
    v_mfma_f32_16x16x32_bf16 v[36:39], a[212:215], v[88:91], v[36:39]
    ds_read_b128 v[84:87], v5 offset:25600
    buffer_load_dwordx4 v2, s[8:11], s23 offen offset:1024 lds
    v_mfma_f32_16x16x32_bf16 v[44:47], a[212:215], v[92:95], v[44:47]
    v_mfma_f32_16x16x32_bf16 v[40:43], a[208:211], v[92:95], v[40:43]
    s_waitcnt lgkmcnt(4)
    v_mfma_f32_16x16x32_bf16 v[32:35], a[216:219], v[96:99], v[32:35]
    ds_read_b128 v[88:91], v4 offset:26624
    v_mfma_f32_16x16x32_bf16 v[36:39], a[220:223], v[96:99], v[36:39]
    ds_read_b128 v[92:95], v5 offset:26624
    v_mfma_f32_16x16x32_bf16 v[44:47], a[220:223], v[100:103], v[44:47]
    buffer_load_dwordx4 v2, s[8:11], s23 offen offset:2048 lds
    v_mfma_f32_16x16x32_bf16 v[40:43], a[216:219], v[100:103], v[40:43]
    s_waitcnt lgkmcnt(4)
    v_mfma_f32_16x16x32_bf16 v[32:35], a[224:227], v[72:75], v[32:35]
    ds_read_b128 v[96:99], v4 offset:27648
    v_mfma_f32_16x16x32_bf16 v[36:39], a[228:231], v[72:75], v[36:39]
    ds_read_b128 v[100:103], v5 offset:27648
    v_mfma_f32_16x16x32_bf16 v[44:47], a[228:231], v[76:79], v[44:47]
    v_add_u32 v4, s22, v4
    v_add_u32 v5, s22, v5
    v_mfma_f32_16x16x32_bf16 v[40:43], a[224:227], v[76:79], v[40:43]
    buffer_load_dwordx4 v2, s[8:11], s23 offen offset:3072 lds
    s_waitcnt vmcnt(26)
    s_barrier
    s_waitcnt lgkmcnt(4)
    v_mfma_f32_16x16x32_bf16 v[32:35], a[232:235], v[80:83], v[32:35]
    ds_read_b128 v[72:75], v4 offset:0
    s_add_u32 s20, s20, 32768
    s_cmp_ge_u32 s20, 163840
    v_mfma_f32_16x16x32_bf16 v[36:39], a[236:239], v[80:83], v[36:39]
    ds_read_b128 v[76:79], v5 offset:0
    s_cselect_b32 s60, 163840, 0
    s_sub_u32 s20, s20, s60
    v_mfma_f32_16x16x32_bf16 v[44:47], a[236:239], v[84:87], v[44:47]
    s_add_u32 s23, s23, 0x40000
    v_mfma_f32_16x16x32_bf16 v[40:43], a[232:235], v[84:87], v[40:43]
    s_waitcnt lgkmcnt(4)
    v_mfma_f32_16x16x32_bf16 v[32:35], a[240:243], v[88:91], v[32:35]
    ds_read_b128 v[80:83], v4 offset:1024
    v_mfma_f32_16x16x32_bf16 v[36:39], a[244:247], v[88:91], v[36:39]
    ds_read_b128 v[84:87], v5 offset:1024
    v_mfma_f32_16x16x32_bf16 v[44:47], a[244:247], v[92:95], v[44:47]
    v_mfma_f32_16x16x32_bf16 v[40:43], a[240:243], v[92:95], v[40:43]
    s_waitcnt lgkmcnt(4)
    v_mfma_f32_16x16x32_bf16 v[48:51], a[248:251], v[96:99], v[32:35]
    ds_read_b128 v[88:91], v4 offset:2048
    v_mfma_f32_16x16x32_bf16 v[52:55], a[252:255], v[96:99], v[36:39]
    ds_read_b128 v[92:95], v5 offset:2048
    v_mfma_f32_16x16x32_bf16 v[60:63], a[252:255], v[100:103], v[44:47]
    s_cmp_lt_u32 s26, s39
    v_mfma_f32_16x16x32_bf16 v[56:59], a[248:251], v[100:103], v[40:43]
    s_cbranch_scc1 seg_p
    s_xor_b32 s24, s24, 0x80000
    s_waitcnt vmcnt(0)
    v_pk_add_f32 v[104:105], v[104:105], v[64:65]
    v_pk_add_f32 v[106:107], v[106:107], v[66:67]
    v_pk_add_f32 v[108:109], v[108:109], v[112:113]
    v_pk_add_f32 v[110:111], v[110:111], v[114:115]
    v_pk_add_f32 v[104:105], v[104:105], v[108:109]
    v_pk_add_f32 v[106:107], v[106:107], v[110:111]
    v_cvt_pk_bf16_f32 v104, 0, v104
    v_cvt_pk_bf16_f32 v105, 0, v105
    v_cvt_pk_bf16_f32 v106, 0, v106
    v_cvt_pk_bf16_f32 v107, 0, v107
    buffer_store_dwordx4 v[104:107], v15, s[16:19], s25 offen
    buffer_store_dwordx4 v[48:51], v20, s[8:11], s24 offen
    buffer_store_dwordx4 v[52:55], v21, s[8:11], s24 offen
    buffer_store_dwordx4 v[56:59], v22, s[8:11], s24 offen
    s_lshl_b32 s25, s35, 18
    s_waitcnt vmcnt(0)
    s_barrier
    s_add_u32 s26, s26, 1
    v_mov_b32 v12, s26
    buffer_store_dword v12, v11, s[8:11], s27 offen
    v_mov_b32 v18, s26
    v_writelane_b32 v18, s34, 32
    v_writelane_b32 v18, s40, 33
L_sp_54:
    global_load_dword v19, v[16:17], off sc1
    s_add_u32 s30, s30, 1
    s_cmp_gt_u32 s30, 0x200000
    s_cbranch_scc1 chain_kernel_wabort
    s_waitcnt vmcnt(0)
    v_cmp_lt_u32 vcc, v19, v18
    s_cbranch_vccz L_spok_55
    s_branch L_sp_54
L_spok_55:
    buffer_load_dwordx4 v[104:107], v23, s[8:11], s24 offen offset:0 sc1
    buffer_load_dwordx4 v[108:111], v23, s[8:11], s24 offen offset:1024 sc1
    buffer_load_dwordx4 v[112:115], v23, s[8:11], s24 offen offset:2048 sc1
    s_waitcnt vmcnt(0) lgkmcnt(0)
    v_pk_add_f32 v[104:105], v[104:105], v[60:61]
    v_pk_add_f32 v[106:107], v[106:107], v[62:63]
    v_pk_add_f32 v[108:109], v[108:109], v[112:113]
    v_pk_add_f32 v[110:111], v[110:111], v[114:115]
    v_pk_add_f32 v[104:105], v[104:105], v[108:109]
    v_pk_add_f32 v[106:107], v[106:107], v[110:111]
    v_cvt_pk_bf16_f32 v104, 0, v104
    v_cvt_pk_bf16_f32 v105, 0, v105
    v_cvt_pk_bf16_f32 v106, 0, v106
    v_cvt_pk_bf16_f32 v107, 0, v107
    buffer_store_dwordx4 v[104:107], v15, s[16:19], s25 offen
seg_t0:
    s_mov_b32 s35, 63
    s_lshr_b32 s60, s57, 3
    s_lshl_b32 s60, s60, 8
    s_add_u32 s60, s60, 0xd201000
    s_add_u32 s37, s60, s100
    s_addc_u32 s38, s101, 0
seg_t:
    s_and_b32 s33, s36, 0xff
    s_cbranch_scc0 seg_end
    s_lshr_b32 s36, s36, 8
    s_lshl_b32 s20, s58, 13
    s_mov_b32 s21, 0
    s_lshr_b32 s60, s57, 4
    s_lshl_b32 s60, s60, 12
    v_add_u32 v5, s60, v1
    v_xor_b32 v4, 4096, v5
    s_lshl_b32 s61, s33, 13
    s_and_b32 s61, s61, 0x2000
    s_xor_b32 s61, s61, s31
    s_lshl_b32 s23, s33, 21
    s_add_u32 s23, s23, s61
    s_cmp_gt_u32 s33, s35
    s_cselect_b32 s23, 0xe000000, s23
    s_xor_b32 s24, s24, 0x80000
    s_lshl_b32 s25, s33, 18
    s_add_u32 s34, s33, 3
    s_min_u32 s34, s34, 64
    v_mov_b32 v18, s26
    v_writelane_b32 v18, s34, 32
    v_writelane_b32 v18, s40, 33
L_sp_56:
    global_load_dword v19, v[16:17], off sc1
    s_add_u32 s30, s30, 1
    s_cmp_gt_u32 s30, 0x200000
    s_cbranch_scc1 chain_kernel_wabort
    s_waitcnt vmcnt(0)
    v_cmp_lt_u32 vcc, v19, v18
    s_cbranch_vccz L_spok_57
    s_sleep 2
    s_branch L_sp_56
L_spok_57:
    s_cmp_lt_u32 s33, 62
    s_cbranch_scc1 L_tf_58
    v_writelane_b32 v16, s37, 33
    v_writelane_b32 v17, s38, 33
    s_mov_b32 s40, 32
    v_mov_b32 v18, s26
    v_writelane_b32 v18, s34, 32
    v_writelane_b32 v18, s40, 33
L_sp_59:
    global_load_dword v19, v[16:17], off sc1
    s_add_u32 s30, s30, 1
    s_cmp_gt_u32 s30, 0x200000
    s_cbranch_scc1 chain_kernel_wabort
    s_waitcnt vmcnt(0)
    v_cmp_lt_u32 vcc, v19, v18
    s_cbranch_vccz L_spok_60
    s_branch L_sp_59
L_spok_60:
L_tf_58:
    s_add_u32 m0, s20, 0
    s_nop 0
    buffer_load_dwordx4 v1, s[8:11], s23 offen offset:0 lds
    buffer_load_dwordx4 v1, s[8:11], s23 offen offset:1024 lds
    buffer_load_dwordx4 v1, s[8:11], s23 offen offset:2048 lds
    buffer_load_dwordx4 v1, s[8:11], s23 offen offset:3072 lds
    s_add_u32 m0, s20, 4096
    s_nop 0
    buffer_load_dwordx4 v2, s[8:11], s23 offen offset:0 lds
    buffer_load_dwordx4 v2, s[8:11], s23 offen offset:1024 lds
    buffer_load_dwordx4 v2, s[8:11], s23 offen offset:2048 lds
    buffer_load_dwordx4 v2, s[8:11], s23 offen offset:3072 lds
    s_add_u32 s20, s20, 32768
    s_cmp_ge_u32 s20, 163840
    s_cselect_b32 s60, 163840, 0
    s_sub_u32 s20, s20, s60
    s_add_u32 s23, s23, 0x40000
    s_add_u32 m0, s20, 0
    s_nop 0
    buffer_load_dwordx4 v1, s[8:11], s23 offen offset:0 lds
    buffer_load_dwordx4 v1, s[8:11], s23 offen offset:1024 lds
    buffer_load_dwordx4 v1, s[8:11], s23 offen offset:2048 lds
    buffer_load_dwordx4 v1, s[8:11], s23 offen offset:3072 lds
    s_add_u32 m0, s20, 4096
    s_nop 0
    buffer_load_dwordx4 v2, s[8:11], s23 offen offset:0 lds
    buffer_load_dwordx4 v2, s[8:11], s23 offen offset:1024 lds
    buffer_load_dwordx4 v2, s[8:11], s23 offen offset:2048 lds
    buffer_load_dwordx4 v2, s[8:11], s23 offen offset:3072 lds
    s_waitcnt vmcnt(8)
    s_barrier
    ds_read_b128 v[72:75], v4 offset:0
    ds_read_b128 v[76:79], v5 offset:0
    ds_read_b128 v[80:83], v4 offset:1024
    ds_read_b128 v[84:87], v5 offset:1024
    ds_read_b128 v[88:91], v4 offset:2048
    ds_read_b128 v[92:95], v5 offset:2048
    s_waitcnt lgkmcnt(4)
    v_mfma_f32_16x16x32_bf16 v[32:35], a[0:3], v[72:75], 0
    ds_read_b128 v[96:99], v4 offset:3072
    v_mfma_f32_16x16x32_bf16 v[36:39], a[4:7], v[72:75], 0
    ds_read_b128 v[100:103], v5 offset:3072
    v_mfma_f32_16x16x32_bf16 v[44:47], a[4:7], v[76:79], 0
    v_mfma_f32_16x16x32_bf16 v[40:43], a[0:3], v[76:79], 0
    s_waitcnt lgkmcnt(4)
    v_mfma_f32_16x16x32_bf16 v[32:35], a[8:11], v[80:83], v[32:35]
    ds_read_b128 v[72:75], v4 offset:8192
    v_mfma_f32_16x16x32_bf16 v[36:39], a[12:15], v[80:83], v[36:39]
    ds_read_b128 v[76:79], v5 offset:8192
    v_mfma_f32_16x16x32_bf16 v[44:47], a[12:15], v[84:87], v[44:47]
    v_mfma_f32_16x16x32_bf16 v[40:43], a[8:11], v[84:87], v[40:43]
    s_waitcnt lgkmcnt(4)
    v_mfma_f32_16x16x32_bf16 v[32:35], a[16:19], v[88:91], v[32:35]
    ds_read_b128 v[80:83], v4 offset:9216
    v_mfma_f32_16x16x32_bf16 v[36:39], a[20:23], v[88:91], v[36:39]
    ds_read_b128 v[84:87], v5 offset:9216
    v_mfma_f32_16x16x32_bf16 v[44:47], a[20:23], v[92:95], v[44:47]
    v_mfma_f32_16x16x32_bf16 v[40:43], a[16:19], v[92:95], v[40:43]
    s_waitcnt lgkmcnt(4)
    v_mfma_f32_16x16x32_bf16 v[32:35], a[24:27], v[96:99], v[32:35]
    ds_read_b128 v[88:91], v4 offset:10240
    v_mfma_f32_16x16x32_bf16 v[36:39], a[28:31], v[96:99], v[36:39]
    ds_read_b128 v[92:95], v5 offset:10240
    v_mfma_f32_16x16x32_bf16 v[44:47], a[28:31], v[100:103], v[44:47]
    v_mfma_f32_16x16x32_bf16 v[40:43], a[24:27], v[100:103], v[40:43]
    s_waitcnt lgkmcnt(4)
    v_mfma_f32_16x16x32_bf16 v[32:35], a[32:35], v[72:75], v[32:35]
    ds_read_b128 v[96:99], v4 offset:11264
    v_mfma_f32_16x16x32_bf16 v[36:39], a[36:39], v[72:75], v[36:39]
    ds_read_b128 v[100:103], v5 offset:11264
    v_mfma_f32_16x16x32_bf16 v[44:47], a[36:39], v[76:79], v[44:47]
    v_mfma_f32_16x16x32_bf16 v[40:43], a[32:35], v[76:79], v[40:43]
    s_waitcnt lgkmcnt(4)
    v_mfma_f32_16x16x32_bf16 v[32:35], a[40:43], v[80:83], v[32:35]
    ds_read_b128 v[72:75], v4 offset:16384
    v_mfma_f32_16x16x32_bf16 v[36:39], a[44:47], v[80:83], v[36:39]
    ds_read_b128 v[76:79], v5 offset:16384
    v_mfma_f32_16x16x32_bf16 v[44:47], a[44:47], v[84:87], v[44:47]
    v_mfma_f32_16x16x32_bf16 v[40:43], a[40:43], v[84:87], v[40:43]
    s_waitcnt lgkmcnt(4)
    v_mfma_f32_16x16x32_bf16 v[32:35], a[48:51], v[88:91], v[32:35]
    ds_read_b128 v[80:83], v4 offset:17408
    v_mfma_f32_16x16x32_bf16 v[36:39], a[52:55], v[88:91], v[36:39]
    ds_read_b128 v[84:87], v5 offset:17408
    v_mfma_f32_16x16x32_bf16 v[44:47], a[52:55], v[92:95], v[44:47]
    v_mfma_f32_16x16x32_bf16 v[40:43], a[48:51], v[92:95], v[40:43]
    s_waitcnt lgkmcnt(4)
    v_mfma_f32_16x16x32_bf16 v[32:35], a[56:59], v[96:99], v[32:35]
    ds_read_b128 v[88:91], v4 offset:18432
    v_mfma_f32_16x16x32_bf16 v[36:39], a[60:63], v[96:99], v[36:39]
    ds_read_b128 v[92:95], v5 offset:18432
    v_mfma_f32_16x16x32_bf16 v[44:47], a[60:63], v[100:103], v[44:47]
    v_mfma_f32_16x16x32_bf16 v[40:43], a[56:59], v[100:103], v[40:43]
    s_waitcnt lgkmcnt(4)
    v_mfma_f32_16x16x32_bf16 v[32:35], a[64:67], v[72:75], v[32:35]
    ds_read_b128 v[96:99], v4 offset:19456
    v_mfma_f32_16x16x32_bf16 v[36:39], a[68:71], v[72:75], v[36:39]
    ds_read_b128 v[100:103], v5 offset:19456
    v_mfma_f32_16x16x32_bf16 v[44:47], a[68:71], v[76:79], v[44:47]
    v_mfma_f32_16x16x32_bf16 v[40:43], a[64:67], v[76:79], v[40:43]
    s_waitcnt lgkmcnt(4)
    v_mfma_f32_16x16x32_bf16 v[32:35], a[72:75], v[80:83], v[32:35]
    ds_read_b128 v[72:75], v4 offset:24576
    v_mfma_f32_16x16x32_bf16 v[36:39], a[76:79], v[80:83], v[36:39]
    ds_read_b128 v[76:79], v5 offset:24576
    v_mfma_f32_16x16x32_bf16 v[44:47], a[76:79], v[84:87], v[44:47]
    v_mfma_f32_16x16x32_bf16 v[40:43], a[72:75], v[84:87], v[40:43]
    s_waitcnt lgkmcnt(4)
    v_mfma_f32_16x16x32_bf16 v[32:35], a[80:83], v[88:91], v[32:35]
    ds_read_b128 v[80:83], v4 offset:25600
    v_mfma_f32_16x16x32_bf16 v[36:39], a[84:87], v[88:91], v[36:39]
    ds_read_b128 v[84:87], v5 offset:25600
    v_mfma_f32_16x16x32_bf16 v[44:47], a[84:87], v[92:95], v[44:47]
    v_mfma_f32_16x16x32_bf16 v[40:43], a[80:83], v[92:95], v[40:43]
    s_waitcnt lgkmcnt(4)
    v_mfma_f32_16x16x32_bf16 v[32:35], a[88:91], v[96:99], v[32:35]
    ds_read_b128 v[88:91], v4 offset:26624
    v_mfma_f32_16x16x32_bf16 v[36:39], a[92:95], v[96:99], v[36:39]
    ds_read_b128 v[92:95], v5 offset:26624
    v_mfma_f32_16x16x32_bf16 v[44:47], a[92:95], v[100:103], v[44:47]
    v_mfma_f32_16x16x32_bf16 v[40:43], a[88:91], v[100:103], v[40:43]
    s_waitcnt lgkmcnt(4)
    v_mfma_f32_16x16x32_bf16 v[32:35], a[96:99], v[72:75], v[32:35]
    ds_read_b128 v[96:99], v4 offset:27648
    v_mfma_f32_16x16x32_bf16 v[36:39], a[100:103], v[72:75], v[36:39]
    ds_read_b128 v[100:103], v5 offset:27648
    v_mfma_f32_16x16x32_bf16 v[44:47], a[100:103], v[76:79], v[44:47]
    v_mfma_f32_16x16x32_bf16 v[40:43], a[96:99], v[76:79], v[40:43]
    s_waitcnt vmcnt(0)
    s_barrier
    s_waitcnt lgkmcnt(4)
    v_mfma_f32_16x16x32_bf16 v[32:35], a[104:107], v[80:83], v[32:35]
    ds_read_b128 v[72:75], v4 offset:32768
    v_mfma_f32_16x16x32_bf16 v[36:39], a[108:111], v[80:83], v[36:39]
    ds_read_b128 v[76:79], v5 offset:32768
    v_mfma_f32_16x16x32_bf16 v[44:47], a[108:111], v[84:87], v[44:47]
    v_mfma_f32_16x16x32_bf16 v[40:43], a[104:107], v[84:87], v[40:43]
    s_waitcnt lgkmcnt(4)
    v_mfma_f32_16x16x32_bf16 v[32:35], a[112:115], v[88:91], v[32:35]
    ds_read_b128 v[80:83], v4 offset:33792
    v_mfma_f32_16x16x32_bf16 v[36:39], a[116:119], v[88:91], v[36:39]
    ds_read_b128 v[84:87], v5 offset:33792
    v_mfma_f32_16x16x32_bf16 v[44:47], a[116:119], v[92:95], v[44:47]
    v_mfma_f32_16x16x32_bf16 v[40:43], a[112:115], v[92:95], v[40:43]
    s_waitcnt lgkmcnt(4)
    v_mfma_f32_16x16x32_bf16 v[32:35], a[120:123], v[96:99], v[32:35]
    ds_read_b128 v[88:91], v4 offset:34816
    v_mfma_f32_16x16x32_bf16 v[36:39], a[124:127], v[96:99], v[36:39]
    ds_read_b128 v[92:95], v5 offset:34816
    v_mfma_f32_16x16x32_bf16 v[44:47], a[124:127], v[100:103], v[44:47]
    v_mfma_f32_16x16x32_bf16 v[40:43], a[120:123], v[100:103], v[40:43]
    s_waitcnt lgkmcnt(4)
    v_mfma_f32_16x16x32_bf16 v[32:35], a[128:131], v[72:75], v[32:35]
    ds_read_b128 v[96:99], v4 offset:35840
    v_mfma_f32_16x16x32_bf16 v[36:39], a[132:135], v[72:75], v[36:39]
    ds_read_b128 v[100:103], v5 offset:35840
    v_mfma_f32_16x16x32_bf16 v[44:47], a[132:135], v[76:79], v[44:47]
    v_mfma_f32_16x16x32_bf16 v[40:43], a[128:131], v[76:79], v[40:43]
    s_waitcnt lgkmcnt(4)
    v_mfma_f32_16x16x32_bf16 v[32:35], a[136:139], v[80:83], v[32:35]
    ds_read_b128 v[72:75], v4 offset:40960
    v_mfma_f32_16x16x32_bf16 v[36:39], a[140:143], v[80:83], v[36:39]
    ds_read_b128 v[76:79], v5 offset:40960
    v_mfma_f32_16x16x32_bf16 v[44:47], a[140:143], v[84:87], v[44:47]
    v_mfma_f32_16x16x32_bf16 v[40:43], a[136:139], v[84:87], v[40:43]
    s_waitcnt lgkmcnt(4)
    v_mfma_f32_16x16x32_bf16 v[32:35], a[144:147], v[88:91], v[32:35]
    ds_read_b128 v[80:83], v4 offset:41984
    v_mfma_f32_16x16x32_bf16 v[36:39], a[148:151], v[88:91], v[36:39]
    ds_read_b128 v[84:87], v5 offset:41984
    v_mfma_f32_16x16x32_bf16 v[44:47], a[148:151], v[92:95], v[44:47]
    v_mfma_f32_16x16x32_bf16 v[40:43], a[144:147], v[92:95], v[40:43]
    s_waitcnt lgkmcnt(4)
    v_mfma_f32_16x16x32_bf16 v[32:35], a[152:155], v[96:99], v[32:35]
    ds_read_b128 v[88:91], v4 offset:43008
    v_mfma_f32_16x16x32_bf16 v[36:39], a[156:159], v[96:99], v[36:39]
    ds_read_b128 v[92:95], v5 offset:43008
    v_mfma_f32_16x16x32_bf16 v[44:47], a[156:159], v[100:103], v[44:47]
    v_mfma_f32_16x16x32_bf16 v[40:43], a[152:155], v[100:103], v[40:43]
    s_waitcnt lgkmcnt(4)
    v_mfma_f32_16x16x32_bf16 v[32:35], a[160:163], v[72:75], v[32:35]
    ds_read_b128 v[96:99], v4 offset:44032
    v_mfma_f32_16x16x32_bf16 v[36:39], a[164:167], v[72:75], v[36:39]
    ds_read_b128 v[100:103], v5 offset:44032
    v_mfma_f32_16x16x32_bf16 v[44:47], a[164:167], v[76:79], v[44:47]
    v_mfma_f32_16x16x32_bf16 v[40:43], a[160:163], v[76:79], v[40:43]
    s_waitcnt lgkmcnt(4)
    v_mfma_f32_16x16x32_bf16 v[32:35], a[168:171], v[80:83], v[32:35]
    ds_read_b128 v[72:75], v4 offset:49152
    v_mfma_f32_16x16x32_bf16 v[36:39], a[172:175], v[80:83], v[36:39]
    ds_read_b128 v[76:79], v5 offset:49152
    v_mfma_f32_16x16x32_bf16 v[44:47], a[172:175], v[84:87], v[44:47]
    v_mfma_f32_16x16x32_bf16 v[40:43], a[168:171], v[84:87], v[40:43]
    s_waitcnt lgkmcnt(4)
    v_mfma_f32_16x16x32_bf16 v[32:35], a[176:179], v[88:91], v[32:35]
    ds_read_b128 v[80:83], v4 offset:50176
    v_mfma_f32_16x16x32_bf16 v[36:39], a[180:183], v[88:91], v[36:39]
    ds_read_b128 v[84:87], v5 offset:50176
    v_mfma_f32_16x16x32_bf16 v[44:47], a[180:183], v[92:95], v[44:47]
    v_mfma_f32_16x16x32_bf16 v[40:43], a[176:179], v[92:95], v[40:43]
    s_waitcnt lgkmcnt(4)
    v_mfma_f32_16x16x32_bf16 v[32:35], a[184:187], v[96:99], v[32:35]
    ds_read_b128 v[88:91], v4 offset:51200
    v_mfma_f32_16x16x32_bf16 v[36:39], a[188:191], v[96:99], v[36:39]
    ds_read_b128 v[92:95], v5 offset:51200
    v_mfma_f32_16x16x32_bf16 v[44:47], a[188:191], v[100:103], v[44:47]
    v_mfma_f32_16x16x32_bf16 v[40:43], a[184:187], v[100:103], v[40:43]
    s_waitcnt lgkmcnt(4)
    v_mfma_f32_16x16x32_bf16 v[32:35], a[192:195], v[72:75], v[32:35]
    ds_read_b128 v[96:99], v4 offset:52224
    v_mfma_f32_16x16x32_bf16 v[36:39], a[196:199], v[72:75], v[36:39]
    ds_read_b128 v[100:103], v5 offset:52224
    v_mfma_f32_16x16x32_bf16 v[44:47], a[196:199], v[76:79], v[44:47]
    v_mfma_f32_16x16x32_bf16 v[40:43], a[192:195], v[76:79], v[40:43]
    s_waitcnt lgkmcnt(4)
    v_mfma_f32_16x16x32_bf16 v[32:35], a[200:203], v[80:83], v[32:35]
    ds_read_b128 v[72:75], v4 offset:57344
    v_mfma_f32_16x16x32_bf16 v[36:39], a[204:207], v[80:83], v[36:39]
    ds_read_b128 v[76:79], v5 offset:57344
    v_mfma_f32_16x16x32_bf16 v[44:47], a[204:207], v[84:87], v[44:47]
    v_mfma_f32_16x16x32_bf16 v[40:43], a[200:203], v[84:87], v[40:43]
    s_waitcnt lgkmcnt(4)
    v_mfma_f32_16x16x32_bf16 v[32:35], a[208:211], v[88:91], v[32:35]
    ds_read_b128 v[80:83], v4 offset:58368
    v_mfma_f32_16x16x32_bf16 v[36:39], a[212:215], v[88:91], v[36:39]
    ds_read_b128 v[84:87], v5 offset:58368
    v_mfma_f32_16x16x32_bf16 v[44:47], a[212:215], v[92:95], v[44:47]
    v_mfma_f32_16x16x32_bf16 v[40:43], a[208:211], v[92:95], v[40:43]
    s_waitcnt lgkmcnt(4)
    v_mfma_f32_16x16x32_bf16 v[32:35], a[216:219], v[96:99], v[32:35]
    ds_read_b128 v[88:91], v4 offset:59392
    v_mfma_f32_16x16x32_bf16 v[36:39], a[220:223], v[96:99], v[36:39]
    ds_read_b128 v[92:95], v5 offset:59392
    v_mfma_f32_16x16x32_bf16 v[44:47], a[220:223], v[100:103], v[44:47]
    v_mfma_f32_16x16x32_bf16 v[40:43], a[216:219], v[100:103], v[40:43]
    s_waitcnt lgkmcnt(4)
    v_mfma_f32_16x16x32_bf16 v[32:35], a[224:227], v[72:75], v[32:35]
    ds_read_b128 v[96:99], v4 offset:60416
    v_mfma_f32_16x16x32_bf16 v[36:39], a[228:231], v[72:75], v[36:39]
    ds_read_b128 v[100:103], v5 offset:60416
    v_mfma_f32_16x16x32_bf16 v[44:47], a[228:231], v[76:79], v[44:47]
    v_mfma_f32_16x16x32_bf16 v[40:43], a[224:227], v[76:79], v[40:43]
    s_waitcnt lgkmcnt(4)
    v_mfma_f32_16x16x32_bf16 v[32:35], a[232:235], v[80:83], v[32:35]
    v_mfma_f32_16x16x32_bf16 v[36:39], a[236:239], v[80:83], v[36:39]
    v_mfma_f32_16x16x32_bf16 v[44:47], a[236:239], v[84:87], v[44:47]
    v_mfma_f32_16x16x32_bf16 v[40:43], a[232:235], v[84:87], v[40:43]
    s_waitcnt lgkmcnt(2)
    v_mfma_f32_16x16x32_bf16 v[32:35], a[240:243], v[88:91], v[32:35]
    v_mfma_f32_16x16x32_bf16 v[36:39], a[244:247], v[88:91], v[36:39]
    v_mfma_f32_16x16x32_bf16 v[44:47], a[244:247], v[92:95], v[44:47]
    v_mfma_f32_16x16x32_bf16 v[40:43], a[240:243], v[92:95], v[40:43]
    s_waitcnt lgkmcnt(0)
    v_mfma_f32_16x16x32_bf16 v[48:51], a[248:251], v[96:99], v[32:35]
    v_mfma_f32_16x16x32_bf16 v[52:55], a[252:255], v[96:99], v[36:39]
    v_mfma_f32_16x16x32_bf16 v[60:63], a[252:255], v[100:103], v[44:47]
    v_mfma_f32_16x16x32_bf16 v[56:59], a[248:251], v[100:103], v[40:43]
    s_nop 7
    buffer_store_dwordx4 v[48:51], v20, s[8:11], s24 offen
    buffer_store_dwordx4 v[52:55], v21, s[8:11], s24 offen
    buffer_store_dwordx4 v[56:59], v22, s[8:11], s24 offen
    s_waitcnt vmcnt(0)
    s_barrier
    s_add_u32 s26, s26, 1
    v_mov_b32 v12, s26
    buffer_store_dword v12, v11, s[8:11], s27 offen
    v_mov_b32 v18, s26
    v_writelane_b32 v18, s34, 32
    v_writelane_b32 v18, s40, 33
L_sp_61:
    global_load_dword v19, v[16:17], off sc1
    s_add_u32 s30, s30, 1
    s_cmp_gt_u32 s30, 0x200000
    s_cbranch_scc1 chain_kernel_wabort
    s_waitcnt vmcnt(0)
    v_cmp_lt_u32 vcc, v19, v18
    s_cbranch_vccz L_spok_62
    s_branch L_sp_61
L_spok_62:
    buffer_load_dwordx4 v[104:107], v23, s[8:11], s24 offen offset:0 sc1
    buffer_load_dwordx4 v[108:111], v23, s[8:11], s24 offen offset:1024 sc1
    buffer_load_dwordx4 v[112:115], v23, s[8:11], s24 offen offset:2048 sc1
    s_waitcnt vmcnt(0)
    v_pk_add_f32 v[104:105], v[104:105], v[60:61]
    v_pk_add_f32 v[106:107], v[106:107], v[62:63]
    v_pk_add_f32 v[108:109], v[108:109], v[112:113]
    v_pk_add_f32 v[110:111], v[110:111], v[114:115]
    v_pk_add_f32 v[104:105], v[104:105], v[108:109]
    v_pk_add_f32 v[106:107], v[106:107], v[110:111]
    v_cvt_pk_bf16_f32 v104, 0, v104
    v_cvt_pk_bf16_f32 v105, 0, v105
    v_cvt_pk_bf16_f32 v106, 0, v106
    v_cvt_pk_bf16_f32 v107, 0, v107
    buffer_store_dwordx4 v[104:107], v15, s[16:19], s25 offen
    s_branch seg_t
seg_end:
    s_endpgm
seg_pslow:
L_sp_63:
    global_load_dword v19, v[16:17], off sc1
    s_add_u32 s30, s30, 1
    s_cmp_gt_u32 s30, 0x200000
    s_cbranch_scc1 chain_kernel_wabort
    s_waitcnt vmcnt(0)
    v_cmp_lt_u32 vcc, v19, v18
    s_cbranch_vccz L_spok_64
    s_sleep 2
    s_branch L_sp_63
L_spok_64:
    s_branch seg_pok
    s_endpgm
chain_kernel_wabort:
    s_mov_b64 exec, 1
    v_mov_b32 v1, 0xdeadbeef
    v_mov_b32 v2, 120
    global_store_dword v2, v1, s[98:99]
    s_endpgm
t_g2_c:
    s_mov_b32 s43, 0
    v_bfe_u32 v16, v0, 5, 1
    v_lshlrev_b32 v23, 13, v16
    v_bfe_u32 v16, v0, 7, 1
    v_lshl_add_u32 v23, v16, 12, v23
    v_bfe_u32 v16, v0, 1, 1
    v_lshl_add_u32 v23, v16, 8, v23
    v_bfe_u32 v16, v0, 1, 1
    v_lshl_add_u32 v23, v16, 6, v23
    v_bfe_u32 v16, v0, 4, 1
    v_lshl_add_u32 v23, v16, 7, v23
    v_bfe_u32 v16, v0, 2, 2
    v_lshl_add_u32 v23, v16, 4, v23
    v_bfe_u32 v16, v0, 0, 1
    v_lshl_add_u32 v23, v16, 3, v23
    v_add_u32 v14, s49, v23
    v_xor_b32 v15, 64, v14
    ds_read_b64_tr_b16 v[72:73], v14 offset:0
    ds_read_b64_tr_b16 v[74:75], v15 offset:0
    ds_read_b128 v[44:47], v12 offset:2048
    ds_read_b128 v[40:43], v12 offset:0
    ds_read_b64_tr_b16 v[76:77], v14 offset:512
    ds_read_b64_tr_b16 v[78:79], v15 offset:512
    ds_read_b128 v[52:55], v12 offset:6144
    ds_read_b128 v[48:51], v12 offset:4096
    ds_read_b128 v[60:63], v12 offset:10240
    ds_read_b128 v[56:59], v12 offset:8192
    ds_read_b128 v[68:71], v12 offset:14336
    ds_read_b128 v[64:67], v12 offset:12288
    s_branch t_g2_as
t_g2:
    s_mov_b32 s43, 0
    v_bfe_u32 v16, v0, 5, 1
    v_lshlrev_b32 v23, 13, v16
    v_bfe_u32 v16, v0, 7, 1
    v_lshl_add_u32 v23, v16, 12, v23
    v_bfe_u32 v16, v0, 1, 1
    v_lshl_add_u32 v23, v16, 8, v23
    v_bfe_u32 v16, v0, 1, 1
    v_lshl_add_u32 v23, v16, 6, v23
    v_bfe_u32 v16, v0, 4, 1
    v_lshl_add_u32 v23, v16, 7, v23
    v_bfe_u32 v16, v0, 2, 2
    v_lshl_add_u32 v23, v16, 4, v23
    v_bfe_u32 v16, v0, 0, 1
    v_lshl_add_u32 v23, v16, 3, v23
    v_add_u32 v14, s49, v23
    v_xor_b32 v15, 64, v14
    ds_read_b64_tr_b16 v[72:73], v14 offset:0
    ds_read_b64_tr_b16 v[74:75], v15 offset:0
    ds_read_b128 v[44:47], v12 offset:2048
    ds_read_b128 v[40:43], v12 offset:0
    ds_read_b64_tr_b16 v[76:77], v14 offset:512
    ds_read_b64_tr_b16 v[78:79], v15 offset:512
    ds_read_b128 v[52:55], v12 offset:6144
    ds_read_b128 v[48:51], v12 offset:4096
    ds_read_b128 v[60:63], v12 offset:10240
    ds_read_b128 v[56:59], v12 offset:8192
    ds_read_b128 v[68:71], v12 offset:14336
    ds_read_b128 v[64:67], v12 offset:12288
    s_waitcnt lgkmcnt(8)
    v_mfma_f32_16x16x32_bf16 a[0:3], v[40:43], v[72:75], 0
    s_xor_b32 m0, s44, 0
    v_mfma_f32_16x16x32_bf16 a[32:35], v[44:47], v[72:75], 0
    buffer_load_dwordx4 v4, s[8:11], s20 offen lds
    s_waitcnt lgkmcnt(6)
    v_mfma_f32_16x16x32_bf16 a[36:39], v[44:47], v[76:79], 0
    ds_read_b64_tr_b16 v[80:81], v14 offset:1024
    v_mfma_f32_16x16x32_bf16 a[4:7], v[40:43], v[76:79], 0
    s_waitcnt lgkmcnt(5)
    v_mfma_f32_16x16x32_bf16 a[64:67], v[48:51], v[72:75], 0
    ds_read_b64_tr_b16 v[82:83], v15 offset:1024
    s_xor_b32 m0, s44, 1024
    v_mfma_f32_16x16x32_bf16 a[96:99], v[52:55], v[72:75], 0
    buffer_load_dwordx4 v5, s[8:11], s20 offen lds
    v_mfma_f32_16x16x32_bf16 a[100:103], v[52:55], v[76:79], 0
    ds_read_b64_tr_b16 v[84:85], v14 offset:1536
    s_add_u32 s20, s20, 128
    v_mfma_f32_16x16x32_bf16 a[68:71], v[48:51], v[76:79], 0
    s_waitcnt lgkmcnt(5)
    v_mfma_f32_16x16x32_bf16 a[128:131], v[56:59], v[72:75], 0
    ds_read_b64_tr_b16 v[86:87], v15 offset:1536
    s_mov_b64 vcc, 0
    v_mfma_f32_16x16x32_bf16 a[160:163], v[60:63], v[72:75], 0
    s_xor_b32 m0, s44, 2048
    v_mfma_f32_16x16x32_bf16 a[164:167], v[60:63], v[76:79], 0
    buffer_load_dwordx4 v4, s[8:11], s21 offen lds
    v_mfma_f32_16x16x32_bf16 a[132:135], v[56:59], v[76:79], 0
    s_bitcmp1_b32 s43, 0
    s_waitcnt lgkmcnt(4)
    v_mfma_f32_16x16x32_bf16 a[192:195], v[64:67], v[72:75], 0
    s_cselect_b32 s61, s5, 0
    s_lshl1_add_u32 s53, s61, s50
    v_mfma_f32_16x16x32_bf16 a[224:227], v[68:71], v[72:75], 0
    s_bitcmp1_b32 s43, 1
    s_cselect_b32 s61, s51, 0
    v_mfma_f32_16x16x32_bf16 a[228:231], v[68:71], v[76:79], 0
    s_add_u32 s53, s53, s61
    s_bitcmp1_b32 s43, 2
    v_mfma_f32_16x16x32_bf16 a[196:199], v[64:67], v[76:79], 0
    s_cselect_b32 s61, s52, 0
    s_waitcnt lgkmcnt(2)
    v_mfma_f32_16x16x32_bf16 a[8:11], v[40:43], v[80:83], 0
    s_add_u32 s53, s53, s61
    s_lshl_b32 s29, s43, 4
    v_mfma_f32_16x16x32_bf16 a[40:43], v[44:47], v[80:83], 0
    s_mov_b64 vcc, -1
    s_waitcnt lgkmcnt(0)
    v_mfma_f32_16x16x32_bf16 a[44:47], v[44:47], v[84:87], 0
    ds_read_b64_tr_b16 v[72:73], v14 offset:2048
    s_xor_b32 m0, s44, 3072
    v_mfma_f32_16x16x32_bf16 a[12:15], v[40:43], v[84:87], 0
    buffer_load_dwordx4 v5, s[8:11], s21 offen lds
    v_mfma_f32_16x16x32_bf16 a[72:75], v[48:51], v[80:83], 0
    ds_read_b64_tr_b16 v[74:75], v15 offset:2048
    s_add_u32 s21, s21, 128
    v_mfma_f32_16x16x32_bf16 a[104:107], v[52:55], v[80:83], 0
    s_xor_b32 m0, s44, 16384
    v_mfma_f32_16x16x32_bf16 a[108:111], v[52:55], v[84:87], 0
    ds_read_b64_tr_b16 v[76:77], v14 offset:2560
    buffer_load_dwordx4 v4, s[8:11], s22 offen lds
    v_mfma_f32_16x16x32_bf16 a[76:79], v[48:51], v[84:87], 0
    s_xor_b32 m0, s44, 17408
    v_mfma_f32_16x16x32_bf16 a[136:139], v[56:59], v[80:83], 0
    ds_read_b64_tr_b16 v[78:79], v15 offset:2560
    buffer_load_dwordx4 v5, s[8:11], s22 offen lds
    v_mfma_f32_16x16x32_bf16 a[168:171], v[60:63], v[80:83], 0
    s_add_u32 s22, s22, 128
    s_xor_b32 m0, s44, 18432
    v_mfma_f32_16x16x32_bf16 a[172:175], v[60:63], v[84:87], 0
    buffer_load_dwordx4 v4, s[8:11], s23 offen lds
    v_mfma_f32_16x16x32_bf16 a[140:143], v[56:59], v[84:87], 0
    v_mfma_f32_16x16x32_bf16 a[200:203], v[64:67], v[80:83], 0
    s_xor_b32 m0, s44, 19456
    v_mfma_f32_16x16x32_bf16 a[232:235], v[68:71], v[80:83], 0
    buffer_load_dwordx4 v5, s[8:11], s23 offen lds
    v_mfma_f32_16x16x32_bf16 a[236:239], v[68:71], v[84:87], 0
    s_add_u32 s23, s23, 128
    s_cmp_ge_u32 s44, 98304
    v_mfma_f32_16x16x32_bf16 a[204:207], v[64:67], v[84:87], 0
    s_cselect_b32 s60, s6, s7
    s_waitcnt lgkmcnt(2)
    v_mfma_f32_16x16x32_bf16 a[16:19], v[40:43], v[72:75], 0
    s_add_u32 s44, s44, s60
    v_mfma_f32_16x16x32_bf16 a[48:51], v[44:47], v[72:75], 0
    s_waitcnt lgkmcnt(0)
    v_mfma_f32_16x16x32_bf16 a[52:55], v[44:47], v[76:79], 0
    ds_read_b64_tr_b16 v[80:81], v14 offset:3072
    v_mfma_f32_16x16x32_bf16 a[20:23], v[40:43], v[76:79], 0
    v_mfma_f32_16x16x32_bf16 a[80:83], v[48:51], v[72:75], 0
    ds_read_b64_tr_b16 v[82:83], v15 offset:3072
    s_set_gpr_idx_on s29, gpr_idx(SRC0)
    v_mov_b32 v24, v128
    v_mov_b32 v25, v129
    v_mov_b32 v26, v130
    v_mov_b32 v27, v131
    s_set_gpr_idx_off
    v_mfma_f32_16x16x32_bf16 a[112:115], v[52:55], v[72:75], 0
    v_mfma_f32_16x16x32_bf16 a[116:119], v[52:55], v[76:79], 0
    ds_read_b64_tr_b16 v[84:85], v14 offset:3584
    s_set_gpr_idx_on s29, gpr_idx(SRC0)
    v_mov_b32 v28, v132
    v_mov_b32 v29, v133
    v_mov_b32 v30, v134
    v_mov_b32 v31, v135
    s_set_gpr_idx_off
    v_mfma_f32_16x16x32_bf16 a[84:87], v[48:51], v[76:79], 0
    v_mfma_f32_16x16x32_bf16 a[144:147], v[56:59], v[72:75], 0
    ds_read_b64_tr_b16 v[86:87], v15 offset:3584
    s_set_gpr_idx_on s29, gpr_idx(SRC0)
    v_mov_b32 v32, v136
    v_mov_b32 v33, v137
    v_mov_b32 v34, v138
    v_mov_b32 v35, v139
    s_set_gpr_idx_off
    v_mfma_f32_16x16x32_bf16 a[176:179], v[60:63], v[72:75], 0
    v_mfma_f32_16x16x32_bf16 a[180:183], v[60:63], v[76:79], 0
    s_set_gpr_idx_on s29, gpr_idx(SRC0)
    v_mov_b32 v36, v140
    v_mov_b32 v37, v141
    v_mov_b32 v38, v142
    v_mov_b32 v39, v143
    s_set_gpr_idx_off
    v_mfma_f32_16x16x32_bf16 a[148:151], v[56:59], v[76:79], 0
    v_mfma_f32_16x16x32_bf16 a[208:211], v[64:67], v[72:75], 0
    buffer_store_dwordx4 v[24:27], v2, s[16:19], s53 offen sc1
    v_mfma_f32_16x16x32_bf16 a[240:243], v[68:71], v[72:75], 0
    v_mfma_f32_16x16x32_bf16 a[244:247], v[68:71], v[76:79], 0
    buffer_store_dwordx4 v[28:31], v3, s[16:19], s53 offen sc1
    v_mfma_f32_16x16x32_bf16 a[212:215], v[64:67], v[76:79], 0
    s_add_u32 s53, s53, s5
    s_waitcnt lgkmcnt(2)
    v_mfma_f32_16x16x32_bf16 a[24:27], v[40:43], v[80:83], 0
    ds_read_b64_tr_b16 v[72:73], v14 offset:16384
    buffer_store_dwordx4 v[32:35], v2, s[16:19], s53 offen sc1
    v_mfma_f32_16x16x32_bf16 a[56:59], v[44:47], v[80:83], 0
    ds_read_b64_tr_b16 v[74:75], v15 offset:16384
    s_waitcnt lgkmcnt(2)
    v_mfma_f32_16x16x32_bf16 a[60:63], v[44:47], v[84:87], 0
    ds_read_b128 v[44:47], v13 offset:2048
    buffer_store_dwordx4 v[36:39], v3, s[16:19], s53 offen sc1
    v_mfma_f32_16x16x32_bf16 a[28:31], v[40:43], v[84:87], 0
    ds_read_b128 v[40:43], v13 offset:0
    v_mfma_f32_16x16x32_bf16 a[88:91], v[48:51], v[80:83], 0
    ds_read_b64_tr_b16 v[76:77], v14 offset:16896
    v_mfma_f32_16x16x32_bf16 a[120:123], v[52:55], v[80:83], 0
    ds_read_b64_tr_b16 v[78:79], v15 offset:16896
    v_mfma_f32_16x16x32_bf16 a[124:127], v[52:55], v[84:87], 0
    ds_read_b128 v[52:55], v13 offset:6144
    v_mfma_f32_16x16x32_bf16 a[92:95], v[48:51], v[84:87], 0
    ds_read_b128 v[48:51], v13 offset:4096
    v_mfma_f32_16x16x32_bf16 a[152:155], v[56:59], v[80:83], 0
    v_mfma_f32_16x16x32_bf16 a[184:187], v[60:63], v[80:83], 0
    v_mfma_f32_16x16x32_bf16 a[188:191], v[60:63], v[84:87], 0
    ds_read_b128 v[60:63], v13 offset:10240
    v_mfma_f32_16x16x32_bf16 a[156:159], v[56:59], v[84:87], 0
    ds_read_b128 v[56:59], v13 offset:8192
    v_mfma_f32_16x16x32_bf16 a[216:219], v[64:67], v[80:83], 0
    v_mfma_f32_16x16x32_bf16 a[248:251], v[68:71], v[80:83], 0
    v_mfma_f32_16x16x32_bf16 a[252:255], v[68:71], v[84:87], 0
    ds_read_b128 v[68:71], v13 offset:14336
    v_mfma_f32_16x16x32_bf16 a[220:223], v[64:67], v[84:87], 0
    ds_read_b128 v[64:67], v13 offset:12288
    s_branch t_g2_b
t_g2_hook:
    s_cmp_eq_u32 s43, 1
    s_cbranch_scc1 t_g2_sig0
    s_cmp_eq_u32 s43, 6
    s_cbranch_scc1 t_g2_sws
    s_cmp_eq_u32 s43, 7
    s_cbranch_scc1 t_g2_swp
    s_cmp_lg_u32 s58, 0
    s_cbranch_scc1 t_g2_a
t_g2_wait:
    s_cmp_eq_u32 s3, 0
    s_cbranch_scc1 t_g2_a
    s_mov_b32 s62, 0
L_sw_65:
    s_load_dword s63, s[98:99], s3 glc
    s_add_u32 s62, s62, 1
    s_cmp_gt_u32 s62, 0x200000
    s_cbranch_scc1 chain_kernel_wabort
    s_waitcnt lgkmcnt(0)
    s_cmp_ge_u32 s63, 32
    s_cbranch_scc1 L_swok_66
    s_sleep 16
    s_branch L_sw_65
L_swok_66:
    s_branch t_g2_a
t_g2_sig0:
    s_cmp_eq_u32 s1, 0
    s_cbranch_scc1 t_g2_as
    v_mov_b32 v24, s1
    v_mov_b32 v25, 1
    s_mov_b64 exec, 1
    global_atomic_add v24, v25, s[98:99] sc1
    s_mov_b64 exec, -1
    s_mov_b32 s1, 0
    s_branch t_g2_as
t_g2_sws:
    s_mov_b32 s12, s36
    s_mov_b32 s13, s37
    s_mov_b32 s14, s38
    s_and_b32 s45, s45, 0xffffb7ff
    s_bitcmp1_b32 s0, 3
    s_cselect_b32 s24, s41, 0
    s_cselect_b32 s26, 0, s41
    s_cselect_b32 s60, 0x4000, 0
    s_or_b32 s45, s45, s60
    s_add_u32 s24, s24, s39
    s_add_u32 s26, s26, s39
    s_bitcmp1_b32 s0, 2
    s_cselect_b32 s61, s40, 0
    s_cselect_b32 s62, 0, s40
    s_cselect_b32 s60, 0x800, 0
    s_or_b32 s45, s45, s60
    s_add_u32 s25, s24, s62
    s_add_u32 s24, s24, s61
    s_add_u32 s27, s26, s62
    s_add_u32 s26, s26, s61
    s_mov_b32 s28, s42
    v_mov_b32 v6, v10
    v_mov_b32 v7, v11
    s_branch t_g2_a
t_g2_swp:
    s_mov_b32 s8, s30
    s_mov_b32 s9, s31
    s_mov_b32 s10, s32
    s_and_b32 s44, s44, 0xffffb7ff
    s_bitcmp1_b32 s0, 1
    s_cselect_b32 s20, s35, 0
    s_cselect_b32 s22, 0, s35
    s_cselect_b32 s60, 0x4000, 0
    s_or_b32 s44, s44, s60
    s_add_u32 s20, s20, s33
    s_add_u32 s22, s22, s33
    s_bitcmp1_b32 s0, 0
    s_cselect_b32 s61, s34, 0
    s_cselect_b32 s62, 0, s34
    s_cselect_b32 s60, 0x800, 0
    s_or_b32 s44, s44, s60
    s_add_u32 s21, s20, s62
    s_add_u32 s20, s20, s61
    s_add_u32 s23, s22, s62
    s_add_u32 s22, s22, s61
    v_mov_b32 v4, v8
    v_mov_b32 v5, v9
t_g2_a:
t_g2_as:
    s_waitcnt lgkmcnt(8)
    v_mfma_f32_16x16x32_bf16 a[0:3], v[40:43], v[72:75], a[0:3]
    s_xor_b32 m0, s44, 0
    v_mfma_f32_16x16x32_bf16 a[32:35], v[44:47], v[72:75], a[32:35]
    buffer_load_dwordx4 v4, s[8:11], s20 offen lds
    s_waitcnt lgkmcnt(6)
    v_mfma_f32_16x16x32_bf16 a[36:39], v[44:47], v[76:79], a[36:39]
    ds_read_b64_tr_b16 v[80:81], v14 offset:1024
    v_mfma_f32_16x16x32_bf16 a[4:7], v[40:43], v[76:79], a[4:7]
    s_waitcnt lgkmcnt(5)
    v_mfma_f32_16x16x32_bf16 a[64:67], v[48:51], v[72:75], a[64:67]
    ds_read_b64_tr_b16 v[82:83], v15 offset:1024
    s_xor_b32 m0, s44, 1024
    v_mfma_f32_16x16x32_bf16 a[96:99], v[52:55], v[72:75], a[96:99]
    buffer_load_dwordx4 v5, s[8:11], s20 offen lds
    v_mfma_f32_16x16x32_bf16 a[100:103], v[52:55], v[76:79], a[100:103]
    ds_read_b64_tr_b16 v[84:85], v14 offset:1536
    s_add_u32 s20, s20, 128
    v_mfma_f32_16x16x32_bf16 a[68:71], v[48:51], v[76:79], a[68:71]
    s_waitcnt lgkmcnt(5)
    v_mfma_f32_16x16x32_bf16 a[128:131], v[56:59], v[72:75], a[128:131]
    ds_read_b64_tr_b16 v[86:87], v15 offset:1536
    s_mov_b64 vcc, 0
    v_mfma_f32_16x16x32_bf16 a[160:163], v[60:63], v[72:75], a[160:163]
    s_xor_b32 m0, s44, 2048
    v_mfma_f32_16x16x32_bf16 a[164:167], v[60:63], v[76:79], a[164:167]
    buffer_load_dwordx4 v4, s[8:11], s21 offen lds
    v_mfma_f32_16x16x32_bf16 a[132:135], v[56:59], v[76:79], a[132:135]
    s_bitcmp1_b32 s43, 0
    s_waitcnt lgkmcnt(4)
    v_mfma_f32_16x16x32_bf16 a[192:195], v[64:67], v[72:75], a[192:195]
    s_cselect_b32 s61, s5, 0
    s_lshl1_add_u32 s53, s61, s50
    v_mfma_f32_16x16x32_bf16 a[224:227], v[68:71], v[72:75], a[224:227]
    s_bitcmp1_b32 s43, 1
    s_cselect_b32 s61, s51, 0
    v_mfma_f32_16x16x32_bf16 a[228:231], v[68:71], v[76:79], a[228:231]
    s_add_u32 s53, s53, s61
    s_bitcmp1_b32 s43, 2
    v_mfma_f32_16x16x32_bf16 a[196:199], v[64:67], v[76:79], a[196:199]
    s_cselect_b32 s61, s52, 0
    s_waitcnt lgkmcnt(2)
    v_mfma_f32_16x16x32_bf16 a[8:11], v[40:43], v[80:83], a[8:11]
    s_add_u32 s53, s53, s61
    s_lshl_b32 s29, s43, 4
    v_mfma_f32_16x16x32_bf16 a[40:43], v[44:47], v[80:83], a[40:43]
    s_mov_b64 vcc, -1
    s_waitcnt lgkmcnt(0)
    v_mfma_f32_16x16x32_bf16 a[44:47], v[44:47], v[84:87], a[44:47]
    ds_read_b64_tr_b16 v[72:73], v14 offset:2048
    s_xor_b32 m0, s44, 3072
    v_mfma_f32_16x16x32_bf16 a[12:15], v[40:43], v[84:87], a[12:15]
    buffer_load_dwordx4 v5, s[8:11], s21 offen lds
    v_mfma_f32_16x16x32_bf16 a[72:75], v[48:51], v[80:83], a[72:75]
    ds_read_b64_tr_b16 v[74:75], v15 offset:2048
    s_add_u32 s21, s21, 128
    v_mfma_f32_16x16x32_bf16 a[104:107], v[52:55], v[80:83], a[104:107]
    s_xor_b32 m0, s44, 16384
    v_mfma_f32_16x16x32_bf16 a[108:111], v[52:55], v[84:87], a[108:111]
    ds_read_b64_tr_b16 v[76:77], v14 offset:2560
    buffer_load_dwordx4 v4, s[8:11], s22 offen lds
    v_mfma_f32_16x16x32_bf16 a[76:79], v[48:51], v[84:87], a[76:79]
    s_xor_b32 m0, s44, 17408
    v_mfma_f32_16x16x32_bf16 a[136:139], v[56:59], v[80:83], a[136:139]
    ds_read_b64_tr_b16 v[78:79], v15 offset:2560
    buffer_load_dwordx4 v5, s[8:11], s22 offen lds
    v_mfma_f32_16x16x32_bf16 a[168:171], v[60:63], v[80:83], a[168:171]
    s_add_u32 s22, s22, 128
    s_xor_b32 m0, s44, 18432
    v_mfma_f32_16x16x32_bf16 a[172:175], v[60:63], v[84:87], a[172:175]
    buffer_load_dwordx4 v4, s[8:11], s23 offen lds
    v_mfma_f32_16x16x32_bf16 a[140:143], v[56:59], v[84:87], a[140:143]
    v_mfma_f32_16x16x32_bf16 a[200:203], v[64:67], v[80:83], a[200:203]
    s_xor_b32 m0, s44, 19456
    v_mfma_f32_16x16x32_bf16 a[232:235], v[68:71], v[80:83], a[232:235]
    buffer_load_dwordx4 v5, s[8:11], s23 offen lds
    v_mfma_f32_16x16x32_bf16 a[236:239], v[68:71], v[84:87], a[236:239]
    s_add_u32 s23, s23, 128
    s_cmp_ge_u32 s44, 98304
    v_mfma_f32_16x16x32_bf16 a[204:207], v[64:67], v[84:87], a[204:207]
    s_cselect_b32 s60, s6, s7
    s_waitcnt lgkmcnt(2)
    v_mfma_f32_16x16x32_bf16 a[16:19], v[40:43], v[72:75], a[16:19]
    s_add_u32 s44, s44, s60
    v_mfma_f32_16x16x32_bf16 a[48:51], v[44:47], v[72:75], a[48:51]
    s_waitcnt lgkmcnt(0)
    v_mfma_f32_16x16x32_bf16 a[52:55], v[44:47], v[76:79], a[52:55]
    ds_read_b64_tr_b16 v[80:81], v14 offset:3072
    v_mfma_f32_16x16x32_bf16 a[20:23], v[40:43], v[76:79], a[20:23]
    v_mfma_f32_16x16x32_bf16 a[80:83], v[48:51], v[72:75], a[80:83]
    ds_read_b64_tr_b16 v[82:83], v15 offset:3072
    s_set_gpr_idx_on s29, gpr_idx(SRC0)
    v_mov_b32 v24, v128
    v_mov_b32 v25, v129
    v_mov_b32 v26, v130
    v_mov_b32 v27, v131
    s_set_gpr_idx_off
    v_mfma_f32_16x16x32_bf16 a[112:115], v[52:55], v[72:75], a[112:115]
    v_mfma_f32_16x16x32_bf16 a[116:119], v[52:55], v[76:79], a[116:119]
    ds_read_b64_tr_b16 v[84:85], v14 offset:3584
    s_set_gpr_idx_on s29, gpr_idx(SRC0)
    v_mov_b32 v28, v132
    v_mov_b32 v29, v133
    v_mov_b32 v30, v134
    v_mov_b32 v31, v135
    s_set_gpr_idx_off
    v_mfma_f32_16x16x32_bf16 a[84:87], v[48:51], v[76:79], a[84:87]
    v_mfma_f32_16x16x32_bf16 a[144:147], v[56:59], v[72:75], a[144:147]
    ds_read_b64_tr_b16 v[86:87], v15 offset:3584
    s_set_gpr_idx_on s29, gpr_idx(SRC0)
    v_mov_b32 v32, v136
    v_mov_b32 v33, v137
    v_mov_b32 v34, v138
    v_mov_b32 v35, v139
    s_set_gpr_idx_off
    v_mfma_f32_16x16x32_bf16 a[176:179], v[60:63], v[72:75], a[176:179]
    v_mfma_f32_16x16x32_bf16 a[180:183], v[60:63], v[76:79], a[180:183]
    s_set_gpr_idx_on s29, gpr_idx(SRC0)
    v_mov_b32 v36, v140
    v_mov_b32 v37, v141
    v_mov_b32 v38, v142
    v_mov_b32 v39, v143
    s_set_gpr_idx_off
    v_mfma_f32_16x16x32_bf16 a[148:151], v[56:59], v[76:79], a[148:151]
    v_mfma_f32_16x16x32_bf16 a[208:211], v[64:67], v[72:75], a[208:211]
    buffer_store_dwordx4 v[24:27], v2, s[16:19], s53 offen sc1
    v_mfma_f32_16x16x32_bf16 a[240:243], v[68:71], v[72:75], a[240:243]
    v_mfma_f32_16x16x32_bf16 a[244:247], v[68:71], v[76:79], a[244:247]
    buffer_store_dwordx4 v[28:31], v3, s[16:19], s53 offen sc1
    v_mfma_f32_16x16x32_bf16 a[212:215], v[64:67], v[76:79], a[212:215]
    s_add_u32 s53, s53, s5
    s_waitcnt lgkmcnt(2)
    v_mfma_f32_16x16x32_bf16 a[24:27], v[40:43], v[80:83], a[24:27]
    ds_read_b64_tr_b16 v[72:73], v14 offset:16384
    buffer_store_dwordx4 v[32:35], v2, s[16:19], s53 offen sc1
    v_mfma_f32_16x16x32_bf16 a[56:59], v[44:47], v[80:83], a[56:59]
    ds_read_b64_tr_b16 v[74:75], v15 offset:16384
    s_waitcnt lgkmcnt(2)
    v_mfma_f32_16x16x32_bf16 a[60:63], v[44:47], v[84:87], a[60:63]
    ds_read_b128 v[44:47], v13 offset:2048
    buffer_store_dwordx4 v[36:39], v3, s[16:19], s53 offen sc1
    v_mfma_f32_16x16x32_bf16 a[28:31], v[40:43], v[84:87], a[28:31]
    ds_read_b128 v[40:43], v13 offset:0
    v_mfma_f32_16x16x32_bf16 a[88:91], v[48:51], v[80:83], a[88:91]
    ds_read_b64_tr_b16 v[76:77], v14 offset:16896
    v_mfma_f32_16x16x32_bf16 a[120:123], v[52:55], v[80:83], a[120:123]
    ds_read_b64_tr_b16 v[78:79], v15 offset:16896
    v_mfma_f32_16x16x32_bf16 a[124:127], v[52:55], v[84:87], a[124:127]
    ds_read_b128 v[52:55], v13 offset:6144
    v_mfma_f32_16x16x32_bf16 a[92:95], v[48:51], v[84:87], a[92:95]
    ds_read_b128 v[48:51], v13 offset:4096
    v_mfma_f32_16x16x32_bf16 a[152:155], v[56:59], v[80:83], a[152:155]
    v_mfma_f32_16x16x32_bf16 a[184:187], v[60:63], v[80:83], a[184:187]
    v_mfma_f32_16x16x32_bf16 a[188:191], v[60:63], v[84:87], a[188:191]
    ds_read_b128 v[60:63], v13 offset:10240
    v_mfma_f32_16x16x32_bf16 a[156:159], v[56:59], v[84:87], a[156:159]
    ds_read_b128 v[56:59], v13 offset:8192
    v_mfma_f32_16x16x32_bf16 a[216:219], v[64:67], v[80:83], a[216:219]
    v_mfma_f32_16x16x32_bf16 a[248:251], v[68:71], v[80:83], a[248:251]
    v_mfma_f32_16x16x32_bf16 a[252:255], v[68:71], v[84:87], a[252:255]
    ds_read_b128 v[68:71], v13 offset:14336
    v_mfma_f32_16x16x32_bf16 a[220:223], v[64:67], v[84:87], a[220:223]
    ds_read_b128 v[64:67], v13 offset:12288
t_g2_b:
    s_waitcnt lgkmcnt(8)
    v_mfma_f32_16x16x32_bf16 a[0:3], v[40:43], v[72:75], a[0:3]
    v_mfma_f32_16x16x32_bf16 a[32:35], v[44:47], v[72:75], a[32:35]
    s_waitcnt lgkmcnt(6)
    v_mfma_f32_16x16x32_bf16 a[36:39], v[44:47], v[76:79], a[36:39]
    ds_read_b64_tr_b16 v[80:81], v14 offset:17408
    v_mfma_f32_16x16x32_bf16 a[4:7], v[40:43], v[76:79], a[4:7]
    s_cmp_ge_u32 s48, 98304
    s_waitcnt lgkmcnt(5)
    v_mfma_f32_16x16x32_bf16 a[64:67], v[48:51], v[72:75], a[64:67]
    ds_read_b64_tr_b16 v[82:83], v15 offset:17408
    s_cselect_b32 s46, s6, s7
    v_mfma_f32_16x16x32_bf16 a[96:99], v[52:55], v[72:75], a[96:99]
    s_add_u32 s48, s48, s46
    v_mfma_f32_16x16x32_bf16 a[100:103], v[52:55], v[76:79], a[100:103]
    ds_read_b64_tr_b16 v[84:85], v14 offset:17920
    v_mfma_f32_16x16x32_bf16 a[68:71], v[48:51], v[76:79], a[68:71]
    s_cmp_ge_u32 s49, 98304
    s_waitcnt lgkmcnt(5)
    v_mfma_f32_16x16x32_bf16 a[128:131], v[56:59], v[72:75], a[128:131]
    ds_read_b64_tr_b16 v[86:87], v15 offset:17920
    s_cselect_b32 s47, s6, s7
    v_mfma_f32_16x16x32_bf16 a[160:163], v[60:63], v[72:75], a[160:163]
    s_add_u32 s49, s49, s47
    v_mfma_f32_16x16x32_bf16 a[164:167], v[60:63], v[76:79], a[164:167]
    v_mfma_f32_16x16x32_bf16 a[132:135], v[56:59], v[76:79], a[132:135]
    s_waitcnt lgkmcnt(4)
    v_mfma_f32_16x16x32_bf16 a[192:195], v[64:67], v[72:75], a[192:195]
    v_mfma_f32_16x16x32_bf16 a[224:227], v[68:71], v[72:75], a[224:227]
    v_mfma_f32_16x16x32_bf16 a[228:231], v[68:71], v[76:79], a[228:231]
    v_mfma_f32_16x16x32_bf16 a[196:199], v[64:67], v[76:79], a[196:199]
    s_waitcnt lgkmcnt(2)
    v_mfma_f32_16x16x32_bf16 a[8:11], v[40:43], v[80:83], a[8:11]
    s_xor_b32 m0, s45, 0
    v_mfma_f32_16x16x32_bf16 a[40:43], v[44:47], v[80:83], a[40:43]
    buffer_load_dwordx4 v6, s[12:15], s24 offen lds
    s_waitcnt lgkmcnt(0)
    v_mfma_f32_16x16x32_bf16 a[44:47], v[44:47], v[84:87], a[44:47]
    ds_read_b64_tr_b16 v[72:73], v14 offset:18432
    v_add_u32 v12, s46, v12
    v_mfma_f32_16x16x32_bf16 a[12:15], v[40:43], v[84:87], a[12:15]
    v_add_u32 v13, s46, v13
    v_mfma_f32_16x16x32_bf16 a[72:75], v[48:51], v[80:83], a[72:75]
    ds_read_b64_tr_b16 v[74:75], v15 offset:18432
    s_xor_b32 m0, s45, 1024
    v_mfma_f32_16x16x32_bf16 a[104:107], v[52:55], v[80:83], a[104:107]
    buffer_load_dwordx4 v7, s[12:15], s24 offen lds
    v_mfma_f32_16x16x32_bf16 a[108:111], v[52:55], v[84:87], a[108:111]
    ds_read_b64_tr_b16 v[76:77], v14 offset:18944
    s_add_u32 s24, s24, s28
    v_mfma_f32_16x16x32_bf16 a[76:79], v[48:51], v[84:87], a[76:79]
    v_mfma_f32_16x16x32_bf16 a[136:139], v[56:59], v[80:83], a[136:139]
    ds_read_b64_tr_b16 v[78:79], v15 offset:18944
    s_xor_b32 m0, s45, 2048
    v_mfma_f32_16x16x32_bf16 a[168:171], v[60:63], v[80:83], a[168:171]
    buffer_load_dwordx4 v6, s[12:15], s25 offen lds
    v_mfma_f32_16x16x32_bf16 a[172:175], v[60:63], v[84:87], a[172:175]
    v_mfma_f32_16x16x32_bf16 a[140:143], v[56:59], v[84:87], a[140:143]
    v_mfma_f32_16x16x32_bf16 a[200:203], v[64:67], v[80:83], a[200:203]
    s_xor_b32 m0, s45, 3072
    v_mfma_f32_16x16x32_bf16 a[232:235], v[68:71], v[80:83], a[232:235]
    buffer_load_dwordx4 v7, s[12:15], s25 offen lds
    v_mfma_f32_16x16x32_bf16 a[236:239], v[68:71], v[84:87], a[236:239]
    s_add_u32 s25, s25, s28
    v_mfma_f32_16x16x32_bf16 a[204:207], v[64:67], v[84:87], a[204:207]
    s_waitcnt lgkmcnt(2)
    v_mfma_f32_16x16x32_bf16 a[16:19], v[40:43], v[72:75], a[16:19]
    s_xor_b32 m0, s45, 16384
    v_mfma_f32_16x16x32_bf16 a[48:51], v[44:47], v[72:75], a[48:51]
    buffer_load_dwordx4 v6, s[12:15], s26 offen lds
    s_waitcnt lgkmcnt(0)
    v_mfma_f32_16x16x32_bf16 a[52:55], v[44:47], v[76:79], a[52:55]
    ds_read_b64_tr_b16 v[80:81], v14 offset:19456
    v_mfma_f32_16x16x32_bf16 a[20:23], v[40:43], v[76:79], a[20:23]
    s_xor_b32 m0, s45, 17408
    v_mfma_f32_16x16x32_bf16 a[80:83], v[48:51], v[72:75], a[80:83]
    ds_read_b64_tr_b16 v[82:83], v15 offset:19456
    buffer_load_dwordx4 v7, s[12:15], s26 offen lds
    v_mfma_f32_16x16x32_bf16 a[112:115], v[52:55], v[72:75], a[112:115]
    s_add_u32 s26, s26, s28
    s_xor_b32 m0, s45, 18432
    v_mfma_f32_16x16x32_bf16 a[116:119], v[52:55], v[76:79], a[116:119]
    ds_read_b64_tr_b16 v[84:85], v14 offset:19968
    buffer_load_dwordx4 v6, s[12:15], s27 offen lds
    v_mfma_f32_16x16x32_bf16 a[84:87], v[48:51], v[76:79], a[84:87]
    s_xor_b32 m0, s45, 19456
    v_mfma_f32_16x16x32_bf16 a[144:147], v[56:59], v[72:75], a[144:147]
    ds_read_b64_tr_b16 v[86:87], v15 offset:19968
    buffer_load_dwordx4 v7, s[12:15], s27 offen lds
    v_mfma_f32_16x16x32_bf16 a[176:179], v[60:63], v[72:75], a[176:179]
    s_add_u32 s27, s27, s28
    s_cmp_ge_u32 s45, 98304
    v_mfma_f32_16x16x32_bf16 a[180:183], v[60:63], v[76:79], a[180:183]
    s_cselect_b32 s60, s6, s7
    s_add_u32 s45, s45, s60
    v_mfma_f32_16x16x32_bf16 a[148:151], v[56:59], v[76:79], a[148:151]
    v_add_u32 v14, s47, v14
    v_add_u32 v15, s47, v15
    v_mfma_f32_16x16x32_bf16 a[208:211], v[64:67], v[72:75], a[208:211]
    s_add_u32 s43, s43, 1
    s_cmp_eq_u32 s43, 8
    v_mfma_f32_16x16x32_bf16 a[240:243], v[68:71], v[72:75], a[240:243]
    v_mfma_f32_16x16x32_bf16 a[244:247], v[68:71], v[76:79], a[244:247]
    v_mfma_f32_16x16x32_bf16 a[212:215], v[64:67], v[76:79], a[212:215]
    s_waitcnt vmcnt(12) lgkmcnt(0)
    s_cbranch_vccnz t_g2_bar
    s_waitcnt vmcnt(8)
t_g2_bar:
    s_barrier
    s_cbranch_scc1 t_g2_last
    v_mfma_f32_16x16x32_bf16 a[24:27], v[40:43], v[80:83], a[24:27]
    ds_read_b64_tr_b16 v[72:73], v14 offset:0
    v_mfma_f32_16x16x32_bf16 a[56:59], v[44:47], v[80:83], a[56:59]
    ds_read_b64_tr_b16 v[74:75], v15 offset:0
    v_mfma_f32_16x16x32_bf16 a[60:63], v[44:47], v[84:87], a[60:63]
    ds_read_b128 v[44:47], v12 offset:2048
    v_mfma_f32_16x16x32_bf16 a[28:31], v[40:43], v[84:87], a[28:31]
    ds_read_b128 v[40:43], v12 offset:0
    v_mfma_f32_16x16x32_bf16 a[88:91], v[48:51], v[80:83], a[88:91]
    ds_read_b64_tr_b16 v[76:77], v14 offset:512
    v_mfma_f32_16x16x32_bf16 a[120:123], v[52:55], v[80:83], a[120:123]
    ds_read_b64_tr_b16 v[78:79], v15 offset:512
    v_mfma_f32_16x16x32_bf16 a[124:127], v[52:55], v[84:87], a[124:127]
    ds_read_b128 v[52:55], v12 offset:6144
    v_mfma_f32_16x16x32_bf16 a[92:95], v[48:51], v[84:87], a[92:95]
    ds_read_b128 v[48:51], v12 offset:4096
    v_mfma_f32_16x16x32_bf16 a[152:155], v[56:59], v[80:83], a[152:155]
    v_mfma_f32_16x16x32_bf16 a[184:187], v[60:63], v[80:83], a[184:187]
    v_mfma_f32_16x16x32_bf16 a[188:191], v[60:63], v[84:87], a[188:191]
    ds_read_b128 v[60:63], v12 offset:10240
    v_mfma_f32_16x16x32_bf16 a[156:159], v[56:59], v[84:87], a[156:159]
    ds_read_b128 v[56:59], v12 offset:8192
    v_mfma_f32_16x16x32_bf16 a[216:219], v[64:67], v[80:83], a[216:219]
    s_sub_u32 s61, s43, 2
    s_cmp_lt_u32 s61, 3
    v_mfma_f32_16x16x32_bf16 a[248:251], v[68:71], v[80:83], a[248:251]
    v_mfma_f32_16x16x32_bf16 a[252:255], v[68:71], v[84:87], a[252:255]
    ds_read_b128 v[68:71], v12 offset:14336
    v_mfma_f32_16x16x32_bf16 a[220:223], v[64:67], v[84:87], a[220:223]
    ds_read_b128 v[64:67], v12 offset:12288
    s_cbranch_scc1 t_g2_a
    s_branch t_g2_hook
t_g2_last:
    v_mfma_f32_16x16x32_bf16 a[24:27], v[40:43], v[80:83], a[24:27]
    v_mfma_f32_16x16x32_bf16 a[56:59], v[44:47], v[80:83], a[56:59]
    v_mfma_f32_16x16x32_bf16 a[60:63], v[44:47], v[84:87], a[60:63]
    v_mfma_f32_16x16x32_bf16 a[28:31], v[40:43], v[84:87], a[28:31]
    v_mfma_f32_16x16x32_bf16 a[88:91], v[48:51], v[80:83], a[88:91]
    v_mfma_f32_16x16x32_bf16 a[120:123], v[52:55], v[80:83], a[120:123]
    v_mfma_f32_16x16x32_bf16 a[124:127], v[52:55], v[84:87], a[124:127]
    v_mfma_f32_16x16x32_bf16 a[92:95], v[48:51], v[84:87], a[92:95]
    v_mfma_f32_16x16x32_bf16 a[152:155], v[56:59], v[80:83], a[152:155]
    v_mfma_f32_16x16x32_bf16 a[184:187], v[60:63], v[80:83], a[184:187]
    v_mfma_f32_16x16x32_bf16 a[188:191], v[60:63], v[84:87], a[188:191]
    v_mfma_f32_16x16x32_bf16 a[156:159], v[56:59], v[84:87], a[156:159]
    v_mfma_f32_16x16x32_bf16 a[216:219], v[64:67], v[80:83], a[216:219]
    v_mfma_f32_16x16x32_bf16 a[248:251], v[68:71], v[80:83], a[248:251]
    v_mfma_f32_16x16x32_bf16 a[252:255], v[68:71], v[84:87], a[252:255]
    v_mfma_f32_16x16x32_bf16 a[220:223], v[64:67], v[84:87], a[220:223]
    s_setpc_b64 s[54:55]
t_g1:
    s_mov_b32 s43, 0
    v_add_u32 v14, s49, v23
    v_xor_b32 v15, 64, v14
    ds_read_b128 v[72:75], v14 offset:0
    ds_read_b128 v[76:79], v14 offset:2048
    ds_read_b128 v[44:47], v12 offset:2048
    ds_read_b128 v[40:43], v12 offset:0
    ds_read_b128 v[52:55], v12 offset:6144
    ds_read_b128 v[48:51], v12 offset:4096
    ds_read_b128 v[60:63], v12 offset:10240
    ds_read_b128 v[56:59], v12 offset:8192
    ds_read_b128 v[68:71], v12 offset:14336
    ds_read_b128 v[64:67], v12 offset:12288
    s_waitcnt lgkmcnt(6)
    v_mfma_f32_16x16x32_bf16 a[0:3], v[40:43], v[72:75], 0
    s_xor_b32 m0, s44, 0
    v_mfma_f32_16x16x32_bf16 a[32:35], v[44:47], v[72:75], 0
    buffer_load_dwordx4 v4, s[8:11], s20 offen lds
    v_mfma_f32_16x16x32_bf16 a[36:39], v[44:47], v[76:79], 0
    ds_read_b128 v[80:83], v14 offset:4096
    v_mfma_f32_16x16x32_bf16 a[4:7], v[40:43], v[76:79], 0
    s_waitcnt lgkmcnt(5)
    v_mfma_f32_16x16x32_bf16 a[64:67], v[48:51], v[72:75], 0
    ds_read_b128 v[84:87], v14 offset:6144
    s_xor_b32 m0, s44, 1024
    v_mfma_f32_16x16x32_bf16 a[96:99], v[52:55], v[72:75], 0
    buffer_load_dwordx4 v5, s[8:11], s20 offen lds
    v_mfma_f32_16x16x32_bf16 a[100:103], v[52:55], v[76:79], 0
    s_add_u32 s20, s20, 128
    v_mfma_f32_16x16x32_bf16 a[68:71], v[48:51], v[76:79], 0
    s_waitcnt lgkmcnt(4)
    v_mfma_f32_16x16x32_bf16 a[128:131], v[56:59], v[72:75], 0
    s_mov_b64 vcc, 0
    s_xor_b32 m0, s44, 2048
    v_mfma_f32_16x16x32_bf16 a[160:163], v[60:63], v[72:75], 0
    buffer_load_dwordx4 v4, s[8:11], s21 offen lds
    v_mfma_f32_16x16x32_bf16 a[164:167], v[60:63], v[76:79], 0
    s_bitcmp1_b32 s43, 0
    s_cselect_b32 s61, s5, 0
    v_mfma_f32_16x16x32_bf16 a[132:135], v[56:59], v[76:79], 0
    s_lshl1_add_u32 s53, s61, s50
    s_waitcnt lgkmcnt(2)
    v_mfma_f32_16x16x32_bf16 a[192:195], v[64:67], v[72:75], 0
    s_bitcmp1_b32 s43, 1
    s_cselect_b32 s61, s51, 0
    v_mfma_f32_16x16x32_bf16 a[224:227], v[68:71], v[72:75], 0
    s_add_u32 s53, s53, s61
    s_bitcmp1_b32 s43, 2
    v_mfma_f32_16x16x32_bf16 a[228:231], v[68:71], v[76:79], 0
    s_cselect_b32 s61, s52, 0
    s_add_u32 s53, s53, s61
    v_mfma_f32_16x16x32_bf16 a[196:199], v[64:67], v[76:79], 0
    s_lshl_b32 s29, s43, 4
    s_waitcnt lgkmcnt(1)
    v_mfma_f32_16x16x32_bf16 a[8:11], v[40:43], v[80:83], 0
    s_mov_b64 vcc, -1
    s_xor_b32 m0, s44, 3072
    v_mfma_f32_16x16x32_bf16 a[40:43], v[44:47], v[80:83], 0
    buffer_load_dwordx4 v5, s[8:11], s21 offen lds
    s_waitcnt lgkmcnt(0)
    v_mfma_f32_16x16x32_bf16 a[44:47], v[44:47], v[84:87], 0
    ds_read_b128 v[72:75], v14 offset:8192
    s_add_u32 s21, s21, 128
    v_mfma_f32_16x16x32_bf16 a[12:15], v[40:43], v[84:87], 0
    s_xor_b32 m0, s44, 16384
    v_mfma_f32_16x16x32_bf16 a[72:75], v[48:51], v[80:83], 0
    ds_read_b128 v[76:79], v14 offset:10240
    buffer_load_dwordx4 v4, s[8:11], s22 offen lds
    v_mfma_f32_16x16x32_bf16 a[104:107], v[52:55], v[80:83], 0
    s_xor_b32 m0, s44, 17408
    v_mfma_f32_16x16x32_bf16 a[108:111], v[52:55], v[84:87], 0
    buffer_load_dwordx4 v5, s[8:11], s22 offen lds
    v_mfma_f32_16x16x32_bf16 a[76:79], v[48:51], v[84:87], 0
    s_add_u32 s22, s22, 128
    v_mfma_f32_16x16x32_bf16 a[136:139], v[56:59], v[80:83], 0
    s_xor_b32 m0, s44, 18432
    v_mfma_f32_16x16x32_bf16 a[168:171], v[60:63], v[80:83], 0
    buffer_load_dwordx4 v4, s[8:11], s23 offen lds
    v_mfma_f32_16x16x32_bf16 a[172:175], v[60:63], v[84:87], 0
    v_mfma_f32_16x16x32_bf16 a[140:143], v[56:59], v[84:87], 0
    v_mfma_f32_16x16x32_bf16 a[200:203], v[64:67], v[80:83], 0
    s_xor_b32 m0, s44, 19456
    v_mfma_f32_16x16x32_bf16 a[232:235], v[68:71], v[80:83], 0
    buffer_load_dwordx4 v5, s[8:11], s23 offen lds
    v_mfma_f32_16x16x32_bf16 a[236:239], v[68:71], v[84:87], 0
    s_add_u32 s23, s23, 128
    s_cmp_ge_u32 s44, 98304
    v_mfma_f32_16x16x32_bf16 a[204:207], v[64:67], v[84:87], 0
    s_cselect_b32 s60, s6, s7
    s_waitcnt lgkmcnt(1)
    v_mfma_f32_16x16x32_bf16 a[16:19], v[40:43], v[72:75], 0
    s_add_u32 s44, s44, s60
    v_mfma_f32_16x16x32_bf16 a[48:51], v[44:47], v[72:75], 0
    s_waitcnt lgkmcnt(0)
    v_mfma_f32_16x16x32_bf16 a[52:55], v[44:47], v[76:79], 0
    ds_read_b128 v[80:83], v14 offset:12288
    v_mfma_f32_16x16x32_bf16 a[20:23], v[40:43], v[76:79], 0
    v_mfma_f32_16x16x32_bf16 a[80:83], v[48:51], v[72:75], 0
    ds_read_b128 v[84:87], v14 offset:14336
    s_set_gpr_idx_on s29, gpr_idx(SRC0)
    v_mov_b32 v24, v128
    v_mov_b32 v25, v129
    v_mov_b32 v26, v130
    v_mov_b32 v27, v131
    s_set_gpr_idx_off
    v_mfma_f32_16x16x32_bf16 a[112:115], v[52:55], v[72:75], 0
    v_mfma_f32_16x16x32_bf16 a[116:119], v[52:55], v[76:79], 0
    s_set_gpr_idx_on s29, gpr_idx(SRC0)
    v_mov_b32 v28, v132
    v_mov_b32 v29, v133
    v_mov_b32 v30, v134
    v_mov_b32 v31, v135
    s_set_gpr_idx_off
    v_mfma_f32_16x16x32_bf16 a[84:87], v[48:51], v[76:79], 0
    v_mfma_f32_16x16x32_bf16 a[144:147], v[56:59], v[72:75], 0
    s_set_gpr_idx_on s29, gpr_idx(SRC0)
    v_mov_b32 v32, v136
    v_mov_b32 v33, v137
    v_mov_b32 v34, v138
    v_mov_b32 v35, v139
    s_set_gpr_idx_off
    v_mfma_f32_16x16x32_bf16 a[176:179], v[60:63], v[72:75], 0
    v_mfma_f32_16x16x32_bf16 a[180:183], v[60:63], v[76:79], 0
    s_set_gpr_idx_on s29, gpr_idx(SRC0)
    v_mov_b32 v36, v140
    v_mov_b32 v37, v141
    v_mov_b32 v38, v142
    v_mov_b32 v39, v143
    s_set_gpr_idx_off
    v_mfma_f32_16x16x32_bf16 a[148:151], v[56:59], v[76:79], 0
    v_mfma_f32_16x16x32_bf16 a[208:211], v[64:67], v[72:75], 0
    buffer_store_dwordx4 v[24:27], v2, s[16:19], s53 offen sc1
    v_mfma_f32_16x16x32_bf16 a[240:243], v[68:71], v[72:75], 0
    v_mfma_f32_16x16x32_bf16 a[244:247], v[68:71], v[76:79], 0
    buffer_store_dwordx4 v[28:31], v3, s[16:19], s53 offen sc1
    v_mfma_f32_16x16x32_bf16 a[212:215], v[64:67], v[76:79], 0
    s_add_u32 s53, s53, s5
    s_waitcnt lgkmcnt(1)
    v_mfma_f32_16x16x32_bf16 a[24:27], v[40:43], v[80:83], 0
    ds_read_b128 v[72:75], v15 offset:0
    buffer_store_dwordx4 v[32:35], v2, s[16:19], s53 offen sc1
    v_mfma_f32_16x16x32_bf16 a[56:59], v[44:47], v[80:83], 0
    ds_read_b128 v[76:79], v15 offset:2048
    s_waitcnt lgkmcnt(2)
    v_mfma_f32_16x16x32_bf16 a[60:63], v[44:47], v[84:87], 0
    ds_read_b128 v[44:47], v13 offset:2048
    buffer_store_dwordx4 v[36:39], v3, s[16:19], s53 offen sc1
    v_mfma_f32_16x16x32_bf16 a[28:31], v[40:43], v[84:87], 0
    ds_read_b128 v[40:43], v13 offset:0
    v_mfma_f32_16x16x32_bf16 a[88:91], v[48:51], v[80:83], 0
    v_mfma_f32_16x16x32_bf16 a[120:123], v[52:55], v[80:83], 0
    v_mfma_f32_16x16x32_bf16 a[124:127], v[52:55], v[84:87], 0
    ds_read_b128 v[52:55], v13 offset:6144
    v_mfma_f32_16x16x32_bf16 a[92:95], v[48:51], v[84:87], 0
    ds_read_b128 v[48:51], v13 offset:4096
    v_mfma_f32_16x16x32_bf16 a[152:155], v[56:59], v[80:83], 0
    v_mfma_f32_16x16x32_bf16 a[184:187], v[60:63], v[80:83], 0
    v_mfma_f32_16x16x32_bf16 a[188:191], v[60:63], v[84:87], 0
    ds_read_b128 v[60:63], v13 offset:10240
    v_mfma_f32_16x16x32_bf16 a[156:159], v[56:59], v[84:87], 0
    ds_read_b128 v[56:59], v13 offset:8192
    v_mfma_f32_16x16x32_bf16 a[216:219], v[64:67], v[80:83], 0
    v_mfma_f32_16x16x32_bf16 a[248:251], v[68:71], v[80:83], 0
    v_mfma_f32_16x16x32_bf16 a[252:255], v[68:71], v[84:87], 0
    ds_read_b128 v[68:71], v13 offset:14336
    v_mfma_f32_16x16x32_bf16 a[220:223], v[64:67], v[84:87], 0
    ds_read_b128 v[64:67], v13 offset:12288
    s_branch t_g1_b
t_g1_as:
    s_waitcnt lgkmcnt(6)
    v_mfma_f32_16x16x32_bf16 a[0:3], v[40:43], v[72:75], a[0:3]
    s_xor_b32 m0, s44, 0
    v_mfma_f32_16x16x32_bf16 a[32:35], v[44:47], v[72:75], a[32:35]
    buffer_load_dwordx4 v4, s[8:11], s20 offen lds
    v_mfma_f32_16x16x32_bf16 a[36:39], v[44:47], v[76:79], a[36:39]
    ds_read_b128 v[80:83], v14 offset:4096
    v_mfma_f32_16x16x32_bf16 a[4:7], v[40:43], v[76:79], a[4:7]
    s_waitcnt lgkmcnt(5)
    v_mfma_f32_16x16x32_bf16 a[64:67], v[48:51], v[72:75], a[64:67]
    ds_read_b128 v[84:87], v14 offset:6144
    s_xor_b32 m0, s44, 1024
    v_mfma_f32_16x16x32_bf16 a[96:99], v[52:55], v[72:75], a[96:99]
    buffer_load_dwordx4 v5, s[8:11], s20 offen lds
    v_mfma_f32_16x16x32_bf16 a[100:103], v[52:55], v[76:79], a[100:103]
    s_add_u32 s20, s20, 128
    v_mfma_f32_16x16x32_bf16 a[68:71], v[48:51], v[76:79], a[68:71]
    s_waitcnt lgkmcnt(4)
    v_mfma_f32_16x16x32_bf16 a[128:131], v[56:59], v[72:75], a[128:131]
    s_mov_b64 vcc, 0
    s_xor_b32 m0, s44, 2048
    v_mfma_f32_16x16x32_bf16 a[160:163], v[60:63], v[72:75], a[160:163]
    buffer_load_dwordx4 v4, s[8:11], s21 offen lds
    v_mfma_f32_16x16x32_bf16 a[164:167], v[60:63], v[76:79], a[164:167]
    s_bitcmp1_b32 s43, 0
    s_cselect_b32 s61, s5, 0
    v_mfma_f32_16x16x32_bf16 a[132:135], v[56:59], v[76:79], a[132:135]
    s_lshl1_add_u32 s53, s61, s50
    s_waitcnt lgkmcnt(2)
    v_mfma_f32_16x16x32_bf16 a[192:195], v[64:67], v[72:75], a[192:195]
    s_bitcmp1_b32 s43, 1
    s_cselect_b32 s61, s51, 0
    v_mfma_f32_16x16x32_bf16 a[224:227], v[68:71], v[72:75], a[224:227]
    s_add_u32 s53, s53, s61
    s_bitcmp1_b32 s43, 2
    v_mfma_f32_16x16x32_bf16 a[228:231], v[68:71], v[76:79], a[228:231]
    s_cselect_b32 s61, s52, 0
    s_add_u32 s53, s53, s61
    v_mfma_f32_16x16x32_bf16 a[196:199], v[64:67], v[76:79], a[196:199]
    s_lshl_b32 s29, s43, 4
    s_waitcnt lgkmcnt(1)
    v_mfma_f32_16x16x32_bf16 a[8:11], v[40:43], v[80:83], a[8:11]
    s_mov_b64 vcc, -1
    s_xor_b32 m0, s44, 3072
    v_mfma_f32_16x16x32_bf16 a[40:43], v[44:47], v[80:83], a[40:43]
    buffer_load_dwordx4 v5, s[8:11], s21 offen lds
    s_waitcnt lgkmcnt(0)
    v_mfma_f32_16x16x32_bf16 a[44:47], v[44:47], v[84:87], a[44:47]
    ds_read_b128 v[72:75], v14 offset:8192
    s_add_u32 s21, s21, 128
    v_mfma_f32_16x16x32_bf16 a[12:15], v[40:43], v[84:87], a[12:15]
    s_xor_b32 m0, s44, 16384
    v_mfma_f32_16x16x32_bf16 a[72:75], v[48:51], v[80:83], a[72:75]
    ds_read_b128 v[76:79], v14 offset:10240
    buffer_load_dwordx4 v4, s[8:11], s22 offen lds
    v_mfma_f32_16x16x32_bf16 a[104:107], v[52:55], v[80:83], a[104:107]
    s_xor_b32 m0, s44, 17408
    v_mfma_f32_16x16x32_bf16 a[108:111], v[52:55], v[84:87], a[108:111]
    buffer_load_dwordx4 v5, s[8:11], s22 offen lds
    v_mfma_f32_16x16x32_bf16 a[76:79], v[48:51], v[84:87], a[76:79]
    s_add_u32 s22, s22, 128
    v_mfma_f32_16x16x32_bf16 a[136:139], v[56:59], v[80:83], a[136:139]
    s_xor_b32 m0, s44, 18432
    v_mfma_f32_16x16x32_bf16 a[168:171], v[60:63], v[80:83], a[168:171]
    buffer_load_dwordx4 v4, s[8:11], s23 offen lds
    v_mfma_f32_16x16x32_bf16 a[172:175], v[60:63], v[84:87], a[172:175]
    v_mfma_f32_16x16x32_bf16 a[140:143], v[56:59], v[84:87], a[140:143]
    v_mfma_f32_16x16x32_bf16 a[200:203], v[64:67], v[80:83], a[200:203]
    s_xor_b32 m0, s44, 19456
    v_mfma_f32_16x16x32_bf16 a[232:235], v[68:71], v[80:83], a[232:235]
    buffer_load_dwordx4 v5, s[8:11], s23 offen lds
    v_mfma_f32_16x16x32_bf16 a[236:239], v[68:71], v[84:87], a[236:239]
    s_add_u32 s23, s23, 128
    s_cmp_ge_u32 s44, 98304
    v_mfma_f32_16x16x32_bf16 a[204:207], v[64:67], v[84:87], a[204:207]
    s_cselect_b32 s60, s6, s7
    s_waitcnt lgkmcnt(1)
    v_mfma_f32_16x16x32_bf16 a[16:19], v[40:43], v[72:75], a[16:19]
    s_add_u32 s44, s44, s60
    v_mfma_f32_16x16x32_bf16 a[48:51], v[44:47], v[72:75], a[48:51]
    s_waitcnt lgkmcnt(0)
    v_mfma_f32_16x16x32_bf16 a[52:55], v[44:47], v[76:79], a[52:55]
    ds_read_b128 v[80:83], v14 offset:12288
    v_mfma_f32_16x16x32_bf16 a[20:23], v[40:43], v[76:79], a[20:23]
    v_mfma_f32_16x16x32_bf16 a[80:83], v[48:51], v[72:75], a[80:83]
    ds_read_b128 v[84:87], v14 offset:14336
    s_set_gpr_idx_on s29, gpr_idx(SRC0)
    v_mov_b32 v24, v128
    v_mov_b32 v25, v129
    v_mov_b32 v26, v130
    v_mov_b32 v27, v131
    s_set_gpr_idx_off
    v_mfma_f32_16x16x32_bf16 a[112:115], v[52:55], v[72:75], a[112:115]
    v_mfma_f32_16x16x32_bf16 a[116:119], v[52:55], v[76:79], a[116:119]
    s_set_gpr_idx_on s29, gpr_idx(SRC0)
    v_mov_b32 v28, v132
    v_mov_b32 v29, v133
    v_mov_b32 v30, v134
    v_mov_b32 v31, v135
    s_set_gpr_idx_off
    v_mfma_f32_16x16x32_bf16 a[84:87], v[48:51], v[76:79], a[84:87]
    v_mfma_f32_16x16x32_bf16 a[144:147], v[56:59], v[72:75], a[144:147]
    s_set_gpr_idx_on s29, gpr_idx(SRC0)
    v_mov_b32 v32, v136
    v_mov_b32 v33, v137
    v_mov_b32 v34, v138
    v_mov_b32 v35, v139
    s_set_gpr_idx_off
    v_mfma_f32_16x16x32_bf16 a[176:179], v[60:63], v[72:75], a[176:179]
    v_mfma_f32_16x16x32_bf16 a[180:183], v[60:63], v[76:79], a[180:183]
    s_set_gpr_idx_on s29, gpr_idx(SRC0)
    v_mov_b32 v36, v140
    v_mov_b32 v37, v141
    v_mov_b32 v38, v142
    v_mov_b32 v39, v143
    s_set_gpr_idx_off
    v_mfma_f32_16x16x32_bf16 a[148:151], v[56:59], v[76:79], a[148:151]
    v_mfma_f32_16x16x32_bf16 a[208:211], v[64:67], v[72:75], a[208:211]
    buffer_store_dwordx4 v[24:27], v2, s[16:19], s53 offen sc1
    v_mfma_f32_16x16x32_bf16 a[240:243], v[68:71], v[72:75], a[240:243]
    v_mfma_f32_16x16x32_bf16 a[244:247], v[68:71], v[76:79], a[244:247]
    buffer_store_dwordx4 v[28:31], v3, s[16:19], s53 offen sc1
    v_mfma_f32_16x16x32_bf16 a[212:215], v[64:67], v[76:79], a[212:215]
    s_add_u32 s53, s53, s5
    s_waitcnt lgkmcnt(1)
    v_mfma_f32_16x16x32_bf16 a[24:27], v[40:43], v[80:83], a[24:27]
    ds_read_b128 v[72:75], v15 offset:0
    buffer_store_dwordx4 v[32:35], v2, s[16:19], s53 offen sc1
    v_mfma_f32_16x16x32_bf16 a[56:59], v[44:47], v[80:83], a[56:59]
    ds_read_b128 v[76:79], v15 offset:2048
    s_waitcnt lgkmcnt(2)
    v_mfma_f32_16x16x32_bf16 a[60:63], v[44:47], v[84:87], a[60:63]
    ds_read_b128 v[44:47], v13 offset:2048
    buffer_store_dwordx4 v[36:39], v3, s[16:19], s53 offen sc1
    v_mfma_f32_16x16x32_bf16 a[28:31], v[40:43], v[84:87], a[28:31]
    ds_read_b128 v[40:43], v13 offset:0
    v_mfma_f32_16x16x32_bf16 a[88:91], v[48:51], v[80:83], a[88:91]
    v_mfma_f32_16x16x32_bf16 a[120:123], v[52:55], v[80:83], a[120:123]
    v_mfma_f32_16x16x32_bf16 a[124:127], v[52:55], v[84:87], a[124:127]
    ds_read_b128 v[52:55], v13 offset:6144
    v_mfma_f32_16x16x32_bf16 a[92:95], v[48:51], v[84:87], a[92:95]
    ds_read_b128 v[48:51], v13 offset:4096
    v_mfma_f32_16x16x32_bf16 a[152:155], v[56:59], v[80:83], a[152:155]
    v_mfma_f32_16x16x32_bf16 a[184:187], v[60:63], v[80:83], a[184:187]
    v_mfma_f32_16x16x32_bf16 a[188:191], v[60:63], v[84:87], a[188:191]
    ds_read_b128 v[60:63], v13 offset:10240
    v_mfma_f32_16x16x32_bf16 a[156:159], v[56:59], v[84:87], a[156:159]
    ds_read_b128 v[56:59], v13 offset:8192
    v_mfma_f32_16x16x32_bf16 a[216:219], v[64:67], v[80:83], a[216:219]
    v_mfma_f32_16x16x32_bf16 a[248:251], v[68:71], v[80:83], a[248:251]
    v_mfma_f32_16x16x32_bf16 a[252:255], v[68:71], v[84:87], a[252:255]
    ds_read_b128 v[68:71], v13 offset:14336
    v_mfma_f32_16x16x32_bf16 a[220:223], v[64:67], v[84:87], a[220:223]
    ds_read_b128 v[64:67], v13 offset:12288
    s_branch t_g1_b
t_g1_hook:
    s_cmp_eq_u32 s43, 1
    s_cbranch_scc1 t_g1_sig0
    s_cmp_lt_u32 s43, 8
    s_cbranch_scc1 t_g1_as
    s_cmp_eq_u32 s43, 14
    s_cbranch_scc1 t_g1_sws
    s_cmp_eq_u32 s43, 15
    s_cbranch_scc1 t_g1_swp
    s_cmp_lg_u32 s58, 0
    s_cbranch_scc1 t_g1_a
    s_cmp_eq_u32 s43, 13
    s_cbranch_scc1 t_g1_wait
    s_cmp_lg_u32 s43, 9
    s_cbranch_scc1 t_g1_a
    s_cmp_eq_u32 s4, 0
    s_cbranch_scc1 t_g1_a
    v_mov_b32 v24, s4
    v_mov_b32 v25, 1
    s_mov_b64 exec, 1
    global_atomic_add v24, v25, s[98:99] sc1
    s_mov_b64 exec, -1
    s_branch t_g1_a
t_g1_wait:
    s_cmp_eq_u32 s3, 0
    s_cbranch_scc1 t_g1_a
    s_mov_b32 s62, 0
L_sw_67:
    s_load_dword s63, s[98:99], s3 glc
    s_add_u32 s62, s62, 1
    s_cmp_gt_u32 s62, 0x200000
    s_cbranch_scc1 chain_kernel_wabort
    s_waitcnt lgkmcnt(0)
    s_cmp_ge_u32 s63, 32
    s_cbranch_scc1 L_swok_68
    s_sleep 16
    s_branch L_sw_67
L_swok_68:
    s_branch t_g1_a
t_g1_sig0:
    s_cmp_eq_u32 s1, 0
    s_cbranch_scc1 t_g1_as
    v_mov_b32 v24, s1
    v_mov_b32 v25, 1
    s_mov_b64 exec, 1
    global_atomic_add v24, v25, s[98:99] sc1
    s_mov_b64 exec, -1
    s_mov_b32 s1, 0
    s_branch t_g1_as
t_g1_sws:
    s_mov_b32 s12, s36
    s_mov_b32 s13, s37
    s_mov_b32 s14, s38
    s_and_b32 s45, s45, 0xffffb7ff
    s_bitcmp1_b32 s0, 3
    s_cselect_b32 s24, s41, 0
    s_cselect_b32 s26, 0, s41
    s_cselect_b32 s60, 0x4000, 0
    s_or_b32 s45, s45, s60
    s_add_u32 s24, s24, s39
    s_add_u32 s26, s26, s39
    s_bitcmp1_b32 s0, 2
    s_cselect_b32 s61, s40, 0
    s_cselect_b32 s62, 0, s40
    s_cselect_b32 s60, 0x800, 0
    s_or_b32 s45, s45, s60
    s_add_u32 s25, s24, s62
    s_add_u32 s24, s24, s61
    s_add_u32 s27, s26, s62
    s_add_u32 s26, s26, s61
    s_mov_b32 s28, s42
    v_mov_b32 v6, v10
    v_mov_b32 v7, v11
    s_branch t_g1_a
t_g1_swp:
    s_mov_b32 s8, s30
    s_mov_b32 s9, s31
    s_mov_b32 s10, s32
    s_and_b32 s44, s44, 0xffffb7ff
    s_bitcmp1_b32 s0, 1
    s_cselect_b32 s20, s35, 0
    s_cselect_b32 s22, 0, s35
    s_cselect_b32 s60, 0x4000, 0
    s_or_b32 s44, s44, s60
    s_add_u32 s20, s20, s33
    s_add_u32 s22, s22, s33
    s_bitcmp1_b32 s0, 0
    s_cselect_b32 s61, s34, 0
    s_cselect_b32 s62, 0, s34
    s_cselect_b32 s60, 0x800, 0
    s_or_b32 s44, s44, s60
    s_add_u32 s21, s20, s62
    s_add_u32 s20, s20, s61
    s_add_u32 s23, s22, s62
    s_add_u32 s22, s22, s61
    v_mov_b32 v4, v8
    v_mov_b32 v5, v9
t_g1_a:
    s_waitcnt lgkmcnt(6)
    v_mfma_f32_16x16x32_bf16 a[0:3], v[40:43], v[72:75], a[0:3]
    s_xor_b32 m0, s44, 0
    v_mfma_f32_16x16x32_bf16 a[32:35], v[44:47], v[72:75], a[32:35]
    buffer_load_dwordx4 v4, s[8:11], s20 offen lds
    v_mfma_f32_16x16x32_bf16 a[36:39], v[44:47], v[76:79], a[36:39]
    ds_read_b128 v[80:83], v14 offset:4096
    v_mfma_f32_16x16x32_bf16 a[4:7], v[40:43], v[76:79], a[4:7]
    s_waitcnt lgkmcnt(5)
    v_mfma_f32_16x16x32_bf16 a[64:67], v[48:51], v[72:75], a[64:67]
    ds_read_b128 v[84:87], v14 offset:6144
    s_xor_b32 m0, s44, 1024
    v_mfma_f32_16x16x32_bf16 a[96:99], v[52:55], v[72:75], a[96:99]
    buffer_load_dwordx4 v5, s[8:11], s20 offen lds
    v_mfma_f32_16x16x32_bf16 a[100:103], v[52:55], v[76:79], a[100:103]
    s_add_u32 s20, s20, 128
    v_mfma_f32_16x16x32_bf16 a[68:71], v[48:51], v[76:79], a[68:71]
    s_waitcnt lgkmcnt(4)
    v_mfma_f32_16x16x32_bf16 a[128:131], v[56:59], v[72:75], a[128:131]
    s_mov_b64 vcc, 0
    s_xor_b32 m0, s44, 2048
    v_mfma_f32_16x16x32_bf16 a[160:163], v[60:63], v[72:75], a[160:163]
    buffer_load_dwordx4 v4, s[8:11], s21 offen lds
    v_mfma_f32_16x16x32_bf16 a[164:167], v[60:63], v[76:79], a[164:167]
    v_mfma_f32_16x16x32_bf16 a[132:135], v[56:59], v[76:79], a[132:135]
    s_waitcnt lgkmcnt(2)
    v_mfma_f32_16x16x32_bf16 a[192:195], v[64:67], v[72:75], a[192:195]
    s_xor_b32 m0, s44, 3072
    v_mfma_f32_16x16x32_bf16 a[224:227], v[68:71], v[72:75], a[224:227]
    buffer_load_dwordx4 v5, s[8:11], s21 offen lds
    v_mfma_f32_16x16x32_bf16 a[228:231], v[68:71], v[76:79], a[228:231]
    s_add_u32 s21, s21, 128
    v_mfma_f32_16x16x32_bf16 a[196:199], v[64:67], v[76:79], a[196:199]
    s_waitcnt lgkmcnt(1)
    v_mfma_f32_16x16x32_bf16 a[8:11], v[40:43], v[80:83], a[8:11]
    s_xor_b32 m0, s44, 16384
    v_mfma_f32_16x16x32_bf16 a[40:43], v[44:47], v[80:83], a[40:43]
    buffer_load_dwordx4 v4, s[8:11], s22 offen lds
    s_waitcnt lgkmcnt(0)
    v_mfma_f32_16x16x32_bf16 a[44:47], v[44:47], v[84:87], a[44:47]
    ds_read_b128 v[72:75], v14 offset:8192
    v_mfma_f32_16x16x32_bf16 a[12:15], v[40:43], v[84:87], a[12:15]
    v_mfma_f32_16x16x32_bf16 a[72:75], v[48:51], v[80:83], a[72:75]
    ds_read_b128 v[76:79], v14 offset:10240
    s_xor_b32 m0, s44, 17408
    v_mfma_f32_16x16x32_bf16 a[104:107], v[52:55], v[80:83], a[104:107]
    buffer_load_dwordx4 v5, s[8:11], s22 offen lds
    v_mfma_f32_16x16x32_bf16 a[108:111], v[52:55], v[84:87], a[108:111]
    s_add_u32 s22, s22, 128
    v_mfma_f32_16x16x32_bf16 a[76:79], v[48:51], v[84:87], a[76:79]
    v_mfma_f32_16x16x32_bf16 a[136:139], v[56:59], v[80:83], a[136:139]
    s_xor_b32 m0, s44, 18432
    v_mfma_f32_16x16x32_bf16 a[168:171], v[60:63], v[80:83], a[168:171]
    buffer_load_dwordx4 v4, s[8:11], s23 offen lds
    v_mfma_f32_16x16x32_bf16 a[172:175], v[60:63], v[84:87], a[172:175]
    v_mfma_f32_16x16x32_bf16 a[140:143], v[56:59], v[84:87], a[140:143]
    v_mfma_f32_16x16x32_bf16 a[200:203], v[64:67], v[80:83], a[200:203]
    s_xor_b32 m0, s44, 19456
    v_mfma_f32_16x16x32_bf16 a[232:235], v[68:71], v[80:83], a[232:235]
    buffer_load_dwordx4 v5, s[8:11], s23 offen lds
    v_mfma_f32_16x16x32_bf16 a[236:239], v[68:71], v[84:87], a[236:239]
    s_add_u32 s23, s23, 128
    s_cmp_ge_u32 s44, 98304
    v_mfma_f32_16x16x32_bf16 a[204:207], v[64:67], v[84:87], a[204:207]
    s_cselect_b32 s60, s6, s7
    s_waitcnt lgkmcnt(1)
    v_mfma_f32_16x16x32_bf16 a[16:19], v[40:43], v[72:75], a[16:19]
    s_add_u32 s44, s44, s60
    v_mfma_f32_16x16x32_bf16 a[48:51], v[44:47], v[72:75], a[48:51]
    s_waitcnt lgkmcnt(0)
    v_mfma_f32_16x16x32_bf16 a[52:55], v[44:47], v[76:79], a[52:55]
    ds_read_b128 v[80:83], v14 offset:12288
    v_mfma_f32_16x16x32_bf16 a[20:23], v[40:43], v[76:79], a[20:23]
    v_mfma_f32_16x16x32_bf16 a[80:83], v[48:51], v[72:75], a[80:83]
    ds_read_b128 v[84:87], v14 offset:14336
    v_mfma_f32_16x16x32_bf16 a[112:115], v[52:55], v[72:75], a[112:115]
    v_mfma_f32_16x16x32_bf16 a[116:119], v[52:55], v[76:79], a[116:119]
    v_mfma_f32_16x16x32_bf16 a[84:87], v[48:51], v[76:79], a[84:87]
    v_mfma_f32_16x16x32_bf16 a[144:147], v[56:59], v[72:75], a[144:147]
    v_mfma_f32_16x16x32_bf16 a[176:179], v[60:63], v[72:75], a[176:179]
    v_mfma_f32_16x16x32_bf16 a[180:183], v[60:63], v[76:79], a[180:183]
    v_mfma_f32_16x16x32_bf16 a[148:151], v[56:59], v[76:79], a[148:151]
    v_mfma_f32_16x16x32_bf16 a[208:211], v[64:67], v[72:75], a[208:211]
    v_mfma_f32_16x16x32_bf16 a[240:243], v[68:71], v[72:75], a[240:243]
    v_mfma_f32_16x16x32_bf16 a[244:247], v[68:71], v[76:79], a[244:247]
    v_mfma_f32_16x16x32_bf16 a[212:215], v[64:67], v[76:79], a[212:215]
    s_waitcnt lgkmcnt(1)
    v_mfma_f32_16x16x32_bf16 a[24:27], v[40:43], v[80:83], a[24:27]
    ds_read_b128 v[72:75], v15 offset:0
    v_mfma_f32_16x16x32_bf16 a[56:59], v[44:47], v[80:83], a[56:59]
    ds_read_b128 v[76:79], v15 offset:2048
    s_waitcnt lgkmcnt(2)
    v_mfma_f32_16x16x32_bf16 a[60:63], v[44:47], v[84:87], a[60:63]
    ds_read_b128 v[44:47], v13 offset:2048
    v_mfma_f32_16x16x32_bf16 a[28:31], v[40:43], v[84:87], a[28:31]
    ds_read_b128 v[40:43], v13 offset:0
    v_mfma_f32_16x16x32_bf16 a[88:91], v[48:51], v[80:83], a[88:91]
    v_mfma_f32_16x16x32_bf16 a[120:123], v[52:55], v[80:83], a[120:123]
    v_mfma_f32_16x16x32_bf16 a[124:127], v[52:55], v[84:87], a[124:127]
    ds_read_b128 v[52:55], v13 offset:6144
    v_mfma_f32_16x16x32_bf16 a[92:95], v[48:51], v[84:87], a[92:95]
    ds_read_b128 v[48:51], v13 offset:4096
    v_mfma_f32_16x16x32_bf16 a[152:155], v[56:59], v[80:83], a[152:155]
    v_mfma_f32_16x16x32_bf16 a[184:187], v[60:63], v[80:83], a[184:187]
    v_mfma_f32_16x16x32_bf16 a[188:191], v[60:63], v[84:87], a[188:191]
    ds_read_b128 v[60:63], v13 offset:10240
    v_mfma_f32_16x16x32_bf16 a[156:159], v[56:59], v[84:87], a[156:159]
    ds_read_b128 v[56:59], v13 offset:8192
    v_mfma_f32_16x16x32_bf16 a[216:219], v[64:67], v[80:83], a[216:219]
    v_mfma_f32_16x16x32_bf16 a[248:251], v[68:71], v[80:83], a[248:251]
    v_mfma_f32_16x16x32_bf16 a[252:255], v[68:71], v[84:87], a[252:255]
    ds_read_b128 v[68:71], v13 offset:14336
    v_mfma_f32_16x16x32_bf16 a[220:223], v[64:67], v[84:87], a[220:223]
    ds_read_b128 v[64:67], v13 offset:12288
t_g1_b:
    s_waitcnt lgkmcnt(6)
    v_mfma_f32_16x16x32_bf16 a[0:3], v[40:43], v[72:75], a[0:3]
    v_mfma_f32_16x16x32_bf16 a[32:35], v[44:47], v[72:75], a[32:35]
    v_mfma_f32_16x16x32_bf16 a[36:39], v[44:47], v[76:79], a[36:39]
    ds_read_b128 v[80:83], v15 offset:4096
    v_mfma_f32_16x16x32_bf16 a[4:7], v[40:43], v[76:79], a[4:7]
    s_cmp_ge_u32 s48, 98304
    s_waitcnt lgkmcnt(5)
    v_mfma_f32_16x16x32_bf16 a[64:67], v[48:51], v[72:75], a[64:67]
    ds_read_b128 v[84:87], v15 offset:6144
    s_cselect_b32 s46, s6, s7
    v_mfma_f32_16x16x32_bf16 a[96:99], v[52:55], v[72:75], a[96:99]
    s_add_u32 s48, s48, s46
    v_mfma_f32_16x16x32_bf16 a[100:103], v[52:55], v[76:79], a[100:103]
    v_mfma_f32_16x16x32_bf16 a[68:71], v[48:51], v[76:79], a[68:71]
    s_cmp_ge_u32 s49, 98304
    s_waitcnt lgkmcnt(4)
    v_mfma_f32_16x16x32_bf16 a[128:131], v[56:59], v[72:75], a[128:131]
    s_cselect_b32 s47, s6, s7
    s_add_u32 s49, s49, s47
    v_mfma_f32_16x16x32_bf16 a[160:163], v[60:63], v[72:75], a[160:163]
    v_mfma_f32_16x16x32_bf16 a[164:167], v[60:63], v[76:79], a[164:167]
    v_mfma_f32_16x16x32_bf16 a[132:135], v[56:59], v[76:79], a[132:135]
    s_waitcnt lgkmcnt(2)
    v_mfma_f32_16x16x32_bf16 a[192:195], v[64:67], v[72:75], a[192:195]
    v_mfma_f32_16x16x32_bf16 a[224:227], v[68:71], v[72:75], a[224:227]
    v_mfma_f32_16x16x32_bf16 a[228:231], v[68:71], v[76:79], a[228:231]
    v_mfma_f32_16x16x32_bf16 a[196:199], v[64:67], v[76:79], a[196:199]
    s_waitcnt lgkmcnt(1)
    v_mfma_f32_16x16x32_bf16 a[8:11], v[40:43], v[80:83], a[8:11]
    s_xor_b32 m0, s45, 0
    v_mfma_f32_16x16x32_bf16 a[40:43], v[44:47], v[80:83], a[40:43]
    buffer_load_dwordx4 v6, s[12:15], s24 offen lds
    s_waitcnt lgkmcnt(0)
    v_mfma_f32_16x16x32_bf16 a[44:47], v[44:47], v[84:87], a[44:47]
    ds_read_b128 v[72:75], v15 offset:8192
    v_add_u32 v12, s46, v12
    v_mfma_f32_16x16x32_bf16 a[12:15], v[40:43], v[84:87], a[12:15]
    v_add_u32 v13, s46, v13
    v_add_u32 v14, s47, v14
    v_mfma_f32_16x16x32_bf16 a[72:75], v[48:51], v[80:83], a[72:75]
    ds_read_b128 v[76:79], v15 offset:10240
    s_xor_b32 m0, s45, 1024
    v_mfma_f32_16x16x32_bf16 a[104:107], v[52:55], v[80:83], a[104:107]
    buffer_load_dwordx4 v7, s[12:15], s24 offen lds
    v_mfma_f32_16x16x32_bf16 a[108:111], v[52:55], v[84:87], a[108:111]
    s_add_u32 s24, s24, s28
    v_mfma_f32_16x16x32_bf16 a[76:79], v[48:51], v[84:87], a[76:79]
    v_mfma_f32_16x16x32_bf16 a[136:139], v[56:59], v[80:83], a[136:139]
    s_xor_b32 m0, s45, 2048
    v_mfma_f32_16x16x32_bf16 a[168:171], v[60:63], v[80:83], a[168:171]
    buffer_load_dwordx4 v6, s[12:15], s25 offen lds
    v_mfma_f32_16x16x32_bf16 a[172:175], v[60:63], v[84:87], a[172:175]
    v_mfma_f32_16x16x32_bf16 a[140:143], v[56:59], v[84:87], a[140:143]
    v_mfma_f32_16x16x32_bf16 a[200:203], v[64:67], v[80:83], a[200:203]
    s_xor_b32 m0, s45, 3072
    v_mfma_f32_16x16x32_bf16 a[232:235], v[68:71], v[80:83], a[232:235]
    buffer_load_dwordx4 v7, s[12:15], s25 offen lds
    v_mfma_f32_16x16x32_bf16 a[236:239], v[68:71], v[84:87], a[236:239]
    s_add_u32 s25, s25, s28
    v_mfma_f32_16x16x32_bf16 a[204:207], v[64:67], v[84:87], a[204:207]
    s_waitcnt lgkmcnt(1)
    v_mfma_f32_16x16x32_bf16 a[16:19], v[40:43], v[72:75], a[16:19]
    s_xor_b32 m0, s45, 16384
    v_mfma_f32_16x16x32_bf16 a[48:51], v[44:47], v[72:75], a[48:51]
    buffer_load_dwordx4 v6, s[12:15], s26 offen lds
    s_waitcnt lgkmcnt(0)
    v_mfma_f32_16x16x32_bf16 a[52:55], v[44:47], v[76:79], a[52:55]
    ds_read_b128 v[80:83], v15 offset:12288
    v_mfma_f32_16x16x32_bf16 a[20:23], v[40:43], v[76:79], a[20:23]
    s_xor_b32 m0, s45, 17408
    v_mfma_f32_16x16x32_bf16 a[80:83], v[48:51], v[72:75], a[80:83]
    ds_read_b128 v[84:87], v15 offset:14336
    buffer_load_dwordx4 v7, s[12:15], s26 offen lds
    v_mfma_f32_16x16x32_bf16 a[112:115], v[52:55], v[72:75], a[112:115]
    s_add_u32 s26, s26, s28
    s_xor_b32 m0, s45, 18432
    v_mfma_f32_16x16x32_bf16 a[116:119], v[52:55], v[76:79], a[116:119]
    buffer_load_dwordx4 v6, s[12:15], s27 offen lds
    v_mfma_f32_16x16x32_bf16 a[84:87], v[48:51], v[76:79], a[84:87]
    s_xor_b32 m0, s45, 19456
    v_mfma_f32_16x16x32_bf16 a[144:147], v[56:59], v[72:75], a[144:147]
    buffer_load_dwordx4 v7, s[12:15], s27 offen lds
    v_mfma_f32_16x16x32_bf16 a[176:179], v[60:63], v[72:75], a[176:179]
    s_add_u32 s27, s27, s28
    s_cmp_ge_u32 s45, 98304
    v_mfma_f32_16x16x32_bf16 a[180:183], v[60:63], v[76:79], a[180:183]
    s_cselect_b32 s60, s6, s7
    s_add_u32 s45, s45, s60
    v_mfma_f32_16x16x32_bf16 a[148:151], v[56:59], v[76:79], a[148:151]
    v_add_u32 v15, s47, v15
    v_mfma_f32_16x16x32_bf16 a[208:211], v[64:67], v[72:75], a[208:211]
    s_add_u32 s43, s43, 1
    s_cmp_eq_u32 s43, 16
    v_mfma_f32_16x16x32_bf16 a[240:243], v[68:71], v[72:75], a[240:243]
    v_mfma_f32_16x16x32_bf16 a[244:247], v[68:71], v[76:79], a[244:247]
    v_mfma_f32_16x16x32_bf16 a[212:215], v[64:67], v[76:79], a[212:215]
    s_waitcnt vmcnt(12) lgkmcnt(0)
    s_cbranch_vccnz t_g1_bar
    s_waitcnt vmcnt(8)
t_g1_bar:
    s_barrier
    s_cbranch_scc1 t_g1_last
    v_mfma_f32_16x16x32_bf16 a[24:27], v[40:43], v[80:83], a[24:27]
    ds_read_b128 v[72:75], v14 offset:0
    v_mfma_f32_16x16x32_bf16 a[56:59], v[44:47], v[80:83], a[56:59]
    ds_read_b128 v[76:79], v14 offset:2048
    v_mfma_f32_16x16x32_bf16 a[60:63], v[44:47], v[84:87], a[60:63]
    ds_read_b128 v[44:47], v12 offset:2048
    v_mfma_f32_16x16x32_bf16 a[28:31], v[40:43], v[84:87], a[28:31]
    ds_read_b128 v[40:43], v12 offset:0
    v_mfma_f32_16x16x32_bf16 a[88:91], v[48:51], v[80:83], a[88:91]
    v_mfma_f32_16x16x32_bf16 a[120:123], v[52:55], v[80:83], a[120:123]
    v_mfma_f32_16x16x32_bf16 a[124:127], v[52:55], v[84:87], a[124:127]
    ds_read_b128 v[52:55], v12 offset:6144
    v_mfma_f32_16x16x32_bf16 a[92:95], v[48:51], v[84:87], a[92:95]
    ds_read_b128 v[48:51], v12 offset:4096
    v_mfma_f32_16x16x32_bf16 a[152:155], v[56:59], v[80:83], a[152:155]
    v_mfma_f32_16x16x32_bf16 a[184:187], v[60:63], v[80:83], a[184:187]
    v_mfma_f32_16x16x32_bf16 a[188:191], v[60:63], v[84:87], a[188:191]
    ds_read_b128 v[60:63], v12 offset:10240
    v_mfma_f32_16x16x32_bf16 a[156:159], v[56:59], v[84:87], a[156:159]
    ds_read_b128 v[56:59], v12 offset:8192
    v_mfma_f32_16x16x32_bf16 a[216:219], v[64:67], v[80:83], a[216:219]
    s_sub_u32 s61, s43, 10
    s_cmp_lt_u32 s61, 3
    v_mfma_f32_16x16x32_bf16 a[248:251], v[68:71], v[80:83], a[248:251]
    v_mfma_f32_16x16x32_bf16 a[252:255], v[68:71], v[84:87], a[252:255]
    ds_read_b128 v[68:71], v12 offset:14336
    v_mfma_f32_16x16x32_bf16 a[220:223], v[64:67], v[84:87], a[220:223]
    ds_read_b128 v[64:67], v12 offset:12288
    s_cbranch_scc1 t_g1_a
    s_branch t_g1_hook
t_g1_last:
    v_mfma_f32_16x16x32_bf16 a[24:27], v[40:43], v[80:83], a[24:27]
    v_mfma_f32_16x16x32_bf16 a[56:59], v[44:47], v[80:83], a[56:59]
    v_mfma_f32_16x16x32_bf16 a[60:63], v[44:47], v[84:87], a[60:63]
    v_mfma_f32_16x16x32_bf16 a[28:31], v[40:43], v[84:87], a[28:31]
    v_mfma_f32_16x16x32_bf16 a[88:91], v[48:51], v[80:83], a[88:91]
    v_mfma_f32_16x16x32_bf16 a[120:123], v[52:55], v[80:83], a[120:123]
    v_mfma_f32_16x16x32_bf16 a[124:127], v[52:55], v[84:87], a[124:127]
    v_mfma_f32_16x16x32_bf16 a[92:95], v[48:51], v[84:87], a[92:95]
    v_mfma_f32_16x16x32_bf16 a[152:155], v[56:59], v[80:83], a[152:155]
    v_mfma_f32_16x16x32_bf16 a[184:187], v[60:63], v[80:83], a[184:187]
    v_mfma_f32_16x16x32_bf16 a[188:191], v[60:63], v[84:87], a[188:191]
    v_mfma_f32_16x16x32_bf16 a[156:159], v[56:59], v[84:87], a[156:159]
    v_mfma_f32_16x16x32_bf16 a[216:219], v[64:67], v[80:83], a[216:219]
    v_mfma_f32_16x16x32_bf16 a[248:251], v[68:71], v[80:83], a[248:251]
    v_mfma_f32_16x16x32_bf16 a[252:255], v[68:71], v[84:87], a[252:255]
    v_mfma_f32_16x16x32_bf16 a[220:223], v[64:67], v[84:87], a[220:223]
    s_setpc_b64 s[54:55]
t_scan:
    s_nop 7
    v_accvgpr_read_b32 v40, a0
    v_accvgpr_read_b32 v42, a4
    v_accvgpr_read_b32 v44, a8
    v_accvgpr_read_b32 v46, a12
    v_accvgpr_read_b32 v41, a16
    v_accvgpr_read_b32 v43, a20
    v_accvgpr_read_b32 v45, a24
    v_accvgpr_read_b32 v47, a28
    v_accvgpr_read_b32 v48, a1
    v_accvgpr_read_b32 v50, a5
    v_accvgpr_read_b32 v52, a9
    v_accvgpr_read_b32 v54, a13
    v_accvgpr_read_b32 v49, a17
    v_accvgpr_read_b32 v51, a21
    v_accvgpr_read_b32 v53, a25
    v_accvgpr_read_b32 v55, a29
    v_pk_fma_f32 v[56:57], v[88:89], v[40:41], v[48:49] op_sel:[0,0,0] op_sel_hi:[0,1,1]
    v_pk_fma_f32 v[58:59], v[90:91], v[42:43], v[50:51] op_sel:[0,0,0] op_sel_hi:[0,1,1]
    v_pk_fma_f32 v[60:61], v[92:93], v[44:45], v[52:53] op_sel:[0,0,0] op_sel_hi:[0,1,1]
    v_pk_fma_f32 v[62:63], v[94:95], v[46:47], v[54:55] op_sel:[0,0,0] op_sel_hi:[0,1,1]
    v_pk_fma_f32 v[40:41], v[88:89], v[40:41], v[56:57] op_sel:[1,1,0] op_sel_hi:[1,0,1] neg_lo:[1,0,0]
    v_pk_fma_f32 v[42:43], v[90:91], v[42:43], v[58:59] op_sel:[1,1,0] op_sel_hi:[1,0,1] neg_lo:[1,0,0]
    v_pk_fma_f32 v[44:45], v[92:93], v[44:45], v[60:61] op_sel:[1,1,0] op_sel_hi:[1,0,1] neg_lo:[1,0,0]
    v_pk_fma_f32 v[46:47], v[94:95], v[46:47], v[62:63] op_sel:[1,1,0] op_sel_hi:[1,0,1] neg_lo:[1,0,0]
    v_accvgpr_read_b32 v64, a2
    v_accvgpr_read_b32 v66, a6
    v_accvgpr_read_b32 v68, a10
    v_accvgpr_read_b32 v70, a14
    v_accvgpr_read_b32 v65, a18
    v_accvgpr_read_b32 v67, a22
    v_accvgpr_read_b32 v69, a26
    v_accvgpr_read_b32 v71, a30
    v_pk_fma_f32 v[56:57], v[88:89], v[40:41], v[64:65] op_sel:[0,0,0] op_sel_hi:[0,1,1]
    v_pk_fma_f32 v[58:59], v[90:91], v[42:43], v[66:67] op_sel:[0,0,0] op_sel_hi:[0,1,1]
    v_pk_fma_f32 v[60:61], v[92:93], v[44:45], v[68:69] op_sel:[0,0,0] op_sel_hi:[0,1,1]
    v_pk_fma_f32 v[62:63], v[94:95], v[46:47], v[70:71] op_sel:[0,0,0] op_sel_hi:[0,1,1]
    v_pk_fma_f32 v[40:41], v[88:89], v[40:41], v[56:57] op_sel:[1,1,0] op_sel_hi:[1,0,1] neg_lo:[1,0,0]
    v_pk_fma_f32 v[42:43], v[90:91], v[42:43], v[58:59] op_sel:[1,1,0] op_sel_hi:[1,0,1] neg_lo:[1,0,0]
    v_pk_fma_f32 v[44:45], v[92:93], v[44:45], v[60:61] op_sel:[1,1,0] op_sel_hi:[1,0,1] neg_lo:[1,0,0]
    v_pk_fma_f32 v[46:47], v[94:95], v[46:47], v[62:63] op_sel:[1,1,0] op_sel_hi:[1,0,1] neg_lo:[1,0,0]
    v_accvgpr_read_b32 v48, a3
    v_accvgpr_read_b32 v50, a7
    v_accvgpr_read_b32 v52, a11
    v_accvgpr_read_b32 v54, a15
    v_accvgpr_read_b32 v49, a19
    v_accvgpr_read_b32 v51, a23
    v_accvgpr_read_b32 v53, a27
    v_accvgpr_read_b32 v55, a31
    v_pk_fma_f32 v[56:57], v[88:89], v[40:41], v[48:49] op_sel:[0,0,0] op_sel_hi:[0,1,1]
    v_pk_fma_f32 v[58:59], v[90:91], v[42:43], v[50:51] op_sel:[0,0,0] op_sel_hi:[0,1,1]
    v_pk_fma_f32 v[60:61], v[92:93], v[44:45], v[52:53] op_sel:[0,0,0] op_sel_hi:[0,1,1]
    v_pk_fma_f32 v[62:63], v[94:95], v[46:47], v[54:55] op_sel:[0,0,0] op_sel_hi:[0,1,1]
    v_pk_fma_f32 v[40:41], v[88:89], v[40:41], v[56:57] op_sel:[1,1,0] op_sel_hi:[1,0,1] neg_lo:[1,0,0]
    v_pk_fma_f32 v[42:43], v[90:91], v[42:43], v[58:59] op_sel:[1,1,0] op_sel_hi:[1,0,1] neg_lo:[1,0,0]
    v_pk_fma_f32 v[44:45], v[92:93], v[44:45], v[60:61] op_sel:[1,1,0] op_sel_hi:[1,0,1] neg_lo:[1,0,0]
    v_pk_fma_f32 v[46:47], v[94:95], v[46:47], v[62:63] op_sel:[1,1,0] op_sel_hi:[1,0,1] neg_lo:[1,0,0]
    v_accvgpr_read_b32 v64, a32
    v_accvgpr_read_b32 v66, a36
    v_accvgpr_read_b32 v68, a40
    v_accvgpr_read_b32 v70, a44
    v_accvgpr_read_b32 v65, a48
    v_accvgpr_read_b32 v67, a52
    v_accvgpr_read_b32 v69, a56
    v_accvgpr_read_b32 v71, a60
    v_pk_fma_f32 v[56:57], v[88:89], v[40:41], v[64:65] op_sel:[0,0,0] op_sel_hi:[0,1,1]
    v_pk_fma_f32 v[58:59], v[90:91], v[42:43], v[66:67] op_sel:[0,0,0] op_sel_hi:[0,1,1]
    v_pk_fma_f32 v[60:61], v[92:93], v[44:45], v[68:69] op_sel:[0,0,0] op_sel_hi:[0,1,1]
    v_pk_fma_f32 v[62:63], v[94:95], v[46:47], v[70:71] op_sel:[0,0,0] op_sel_hi:[0,1,1]
    v_pk_fma_f32 v[40:41], v[88:89], v[40:41], v[56:57] op_sel:[1,1,0] op_sel_hi:[1,0,1] neg_lo:[1,0,0]
    v_pk_fma_f32 v[42:43], v[90:91], v[42:43], v[58:59] op_sel:[1,1,0] op_sel_hi:[1,0,1] neg_lo:[1,0,0]
    v_pk_fma_f32 v[44:45], v[92:93], v[44:45], v[60:61] op_sel:[1,1,0] op_sel_hi:[1,0,1] neg_lo:[1,0,0]
    v_pk_fma_f32 v[46:47], v[94:95], v[46:47], v[62:63] op_sel:[1,1,0] op_sel_hi:[1,0,1] neg_lo:[1,0,0]
    v_accvgpr_read_b32 v48, a33
    v_accvgpr_read_b32 v50, a37
    v_accvgpr_read_b32 v52, a41
    v_accvgpr_read_b32 v54, a45
    v_accvgpr_read_b32 v49, a49
    v_accvgpr_read_b32 v51, a53
    v_accvgpr_read_b32 v53, a57
    v_accvgpr_read_b32 v55, a61
    v_pk_fma_f32 v[56:57], v[88:89], v[40:41], v[48:49] op_sel:[0,0,0] op_sel_hi:[0,1,1]
    v_pk_fma_f32 v[58:59], v[90:91], v[42:43], v[50:51] op_sel:[0,0,0] op_sel_hi:[0,1,1]
    v_pk_fma_f32 v[60:61], v[92:93], v[44:45], v[52:53] op_sel:[0,0,0] op_sel_hi:[0,1,1]
    v_pk_fma_f32 v[62:63], v[94:95], v[46:47], v[54:55] op_sel:[0,0,0] op_sel_hi:[0,1,1]
    v_pk_fma_f32 v[40:41], v[88:89], v[40:41], v[56:57] op_sel:[1,1,0] op_sel_hi:[1,0,1] neg_lo:[1,0,0]
    v_pk_fma_f32 v[42:43], v[90:91], v[42:43], v[58:59] op_sel:[1,1,0] op_sel_hi:[1,0,1] neg_lo:[1,0,0]
    v_pk_fma_f32 v[44:45], v[92:93], v[44:45], v[60:61] op_sel:[1,1,0] op_sel_hi:[1,0,1] neg_lo:[1,0,0]
    v_pk_fma_f32 v[46:47], v[94:95], v[46:47], v[62:63] op_sel:[1,1,0] op_sel_hi:[1,0,1] neg_lo:[1,0,0]
    v_accvgpr_read_b32 v64, a34
    v_accvgpr_read_b32 v66, a38
    v_accvgpr_read_b32 v68, a42
    v_accvgpr_read_b32 v70, a46
    v_accvgpr_read_b32 v65, a50
    v_accvgpr_read_b32 v67, a54
    v_accvgpr_read_b32 v69, a58
    v_accvgpr_read_b32 v71, a62
    v_pk_fma_f32 v[56:57], v[88:89], v[40:41], v[64:65] op_sel:[0,0,0] op_sel_hi:[0,1,1]
    v_pk_fma_f32 v[58:59], v[90:91], v[42:43], v[66:67] op_sel:[0,0,0] op_sel_hi:[0,1,1]
    v_pk_fma_f32 v[60:61], v[92:93], v[44:45], v[68:69] op_sel:[0,0,0] op_sel_hi:[0,1,1]
    v_pk_fma_f32 v[62:63], v[94:95], v[46:47], v[70:71] op_sel:[0,0,0] op_sel_hi:[0,1,1]
    v_pk_fma_f32 v[40:41], v[88:89], v[40:41], v[56:57] op_sel:[1,1,0] op_sel_hi:[1,0,1] neg_lo:[1,0,0]
    v_pk_fma_f32 v[42:43], v[90:91], v[42:43], v[58:59] op_sel:[1,1,0] op_sel_hi:[1,0,1] neg_lo:[1,0,0]
    v_pk_fma_f32 v[44:45], v[92:93], v[44:45], v[60:61] op_sel:[1,1,0] op_sel_hi:[1,0,1] neg_lo:[1,0,0]
    v_pk_fma_f32 v[46:47], v[94:95], v[46:47], v[62:63] op_sel:[1,1,0] op_sel_hi:[1,0,1] neg_lo:[1,0,0]
    v_accvgpr_read_b32 v48, a35
    v_accvgpr_read_b32 v50, a39
    v_accvgpr_read_b32 v52, a43
    v_accvgpr_read_b32 v54, a47
    v_accvgpr_read_b32 v49, a51
    v_accvgpr_read_b32 v51, a55
    v_accvgpr_read_b32 v53, a59
    v_accvgpr_read_b32 v55, a63
    v_pk_fma_f32 v[56:57], v[88:89], v[40:41], v[48:49] op_sel:[0,0,0] op_sel_hi:[0,1,1]
    v_pk_fma_f32 v[58:59], v[90:91], v[42:43], v[50:51] op_sel:[0,0,0] op_sel_hi:[0,1,1]
    v_pk_fma_f32 v[60:61], v[92:93], v[44:45], v[52:53] op_sel:[0,0,0] op_sel_hi:[0,1,1]
    v_pk_fma_f32 v[62:63], v[94:95], v[46:47], v[54:55] op_sel:[0,0,0] op_sel_hi:[0,1,1]
    v_pk_fma_f32 v[40:41], v[88:89], v[40:41], v[56:57] op_sel:[1,1,0] op_sel_hi:[1,0,1] neg_lo:[1,0,0]
    v_pk_fma_f32 v[42:43], v[90:91], v[42:43], v[58:59] op_sel:[1,1,0] op_sel_hi:[1,0,1] neg_lo:[1,0,0]
    v_pk_fma_f32 v[44:45], v[92:93], v[44:45], v[60:61] op_sel:[1,1,0] op_sel_hi:[1,0,1] neg_lo:[1,0,0]
    v_pk_fma_f32 v[46:47], v[94:95], v[46:47], v[62:63] op_sel:[1,1,0] op_sel_hi:[1,0,1] neg_lo:[1,0,0]
    v_accvgpr_read_b32 v64, a64
    v_accvgpr_read_b32 v66, a68
    v_accvgpr_read_b32 v68, a72
    v_accvgpr_read_b32 v70, a76
    v_accvgpr_read_b32 v65, a80
    v_accvgpr_read_b32 v67, a84
    v_accvgpr_read_b32 v69, a88
    v_accvgpr_read_b32 v71, a92
    v_pk_fma_f32 v[56:57], v[88:89], v[40:41], v[64:65] op_sel:[0,0,0] op_sel_hi:[0,1,1]
    v_pk_fma_f32 v[58:59], v[90:91], v[42:43], v[66:67] op_sel:[0,0,0] op_sel_hi:[0,1,1]
    v_pk_fma_f32 v[60:61], v[92:93], v[44:45], v[68:69] op_sel:[0,0,0] op_sel_hi:[0,1,1]
    v_pk_fma_f32 v[62:63], v[94:95], v[46:47], v[70:71] op_sel:[0,0,0] op_sel_hi:[0,1,1]
    v_pk_fma_f32 v[40:41], v[88:89], v[40:41], v[56:57] op_sel:[1,1,0] op_sel_hi:[1,0,1] neg_lo:[1,0,0]
    v_pk_fma_f32 v[42:43], v[90:91], v[42:43], v[58:59] op_sel:[1,1,0] op_sel_hi:[1,0,1] neg_lo:[1,0,0]
    v_pk_fma_f32 v[44:45], v[92:93], v[44:45], v[60:61] op_sel:[1,1,0] op_sel_hi:[1,0,1] neg_lo:[1,0,0]
    v_pk_fma_f32 v[46:47], v[94:95], v[46:47], v[62:63] op_sel:[1,1,0] op_sel_hi:[1,0,1] neg_lo:[1,0,0]
    v_accvgpr_read_b32 v48, a65
    v_accvgpr_read_b32 v50, a69
    v_accvgpr_read_b32 v52, a73
    v_accvgpr_read_b32 v54, a77
    v_accvgpr_read_b32 v49, a81
    v_accvgpr_read_b32 v51, a85
    v_accvgpr_read_b32 v53, a89
    v_accvgpr_read_b32 v55, a93
    v_pk_fma_f32 v[56:57], v[88:89], v[40:41], v[48:49] op_sel:[0,0,0] op_sel_hi:[0,1,1]
    v_pk_fma_f32 v[58:59], v[90:91], v[42:43], v[50:51] op_sel:[0,0,0] op_sel_hi:[0,1,1]
    v_pk_fma_f32 v[60:61], v[92:93], v[44:45], v[52:53] op_sel:[0,0,0] op_sel_hi:[0,1,1]
    v_pk_fma_f32 v[62:63], v[94:95], v[46:47], v[54:55] op_sel:[0,0,0] op_sel_hi:[0,1,1]
    v_pk_fma_f32 v[40:41], v[88:89], v[40:41], v[56:57] op_sel:[1,1,0] op_sel_hi:[1,0,1] neg_lo:[1,0,0]
    v_pk_fma_f32 v[42:43], v[90:91], v[42:43], v[58:59] op_sel:[1,1,0] op_sel_hi:[1,0,1] neg_lo:[1,0,0]
    v_pk_fma_f32 v[44:45], v[92:93], v[44:45], v[60:61] op_sel:[1,1,0] op_sel_hi:[1,0,1] neg_lo:[1,0,0]
    v_pk_fma_f32 v[46:47], v[94:95], v[46:47], v[62:63] op_sel:[1,1,0] op_sel_hi:[1,0,1] neg_lo:[1,0,0]
    v_accvgpr_read_b32 v64, a66
    v_accvgpr_read_b32 v66, a70
    v_accvgpr_read_b32 v68, a74
    v_accvgpr_read_b32 v70, a78
    v_accvgpr_read_b32 v65, a82
    v_accvgpr_read_b32 v67, a86
    v_accvgpr_read_b32 v69, a90
    v_accvgpr_read_b32 v71, a94
    v_pk_fma_f32 v[56:57], v[88:89], v[40:41], v[64:65] op_sel:[0,0,0] op_sel_hi:[0,1,1]
    v_pk_fma_f32 v[58:59], v[90:91], v[42:43], v[66:67] op_sel:[0,0,0] op_sel_hi:[0,1,1]
    v_pk_fma_f32 v[60:61], v[92:93], v[44:45], v[68:69] op_sel:[0,0,0] op_sel_hi:[0,1,1]
    v_pk_fma_f32 v[62:63], v[94:95], v[46:47], v[70:71] op_sel:[0,0,0] op_sel_hi:[0,1,1]
    v_pk_fma_f32 v[40:41], v[88:89], v[40:41], v[56:57] op_sel:[1,1,0] op_sel_hi:[1,0,1] neg_lo:[1,0,0]
    v_pk_fma_f32 v[42:43], v[90:91], v[42:43], v[58:59] op_sel:[1,1,0] op_sel_hi:[1,0,1] neg_lo:[1,0,0]
    v_pk_fma_f32 v[44:45], v[92:93], v[44:45], v[60:61] op_sel:[1,1,0] op_sel_hi:[1,0,1] neg_lo:[1,0,0]
    v_pk_fma_f32 v[46:47], v[94:95], v[46:47], v[62:63] op_sel:[1,1,0] op_sel_hi:[1,0,1] neg_lo:[1,0,0]
    v_accvgpr_read_b32 v48, a67
    v_accvgpr_read_b32 v50, a71
    v_accvgpr_read_b32 v52, a75
    v_accvgpr_read_b32 v54, a79
    v_accvgpr_read_b32 v49, a83
    v_accvgpr_read_b32 v51, a87
    v_accvgpr_read_b32 v53, a91
    v_accvgpr_read_b32 v55, a95
    v_pk_fma_f32 v[56:57], v[88:89], v[40:41], v[48:49] op_sel:[0,0,0] op_sel_hi:[0,1,1]
    v_pk_fma_f32 v[58:59], v[90:91], v[42:43], v[50:51] op_sel:[0,0,0] op_sel_hi:[0,1,1]
    v_pk_fma_f32 v[60:61], v[92:93], v[44:45], v[52:53] op_sel:[0,0,0] op_sel_hi:[0,1,1]
    v_pk_fma_f32 v[62:63], v[94:95], v[46:47], v[54:55] op_sel:[0,0,0] op_sel_hi:[0,1,1]
    v_pk_fma_f32 v[40:41], v[88:89], v[40:41], v[56:57] op_sel:[1,1,0] op_sel_hi:[1,0,1] neg_lo:[1,0,0]
    v_pk_fma_f32 v[42:43], v[90:91], v[42:43], v[58:59] op_sel:[1,1,0] op_sel_hi:[1,0,1] neg_lo:[1,0,0]
    v_pk_fma_f32 v[44:45], v[92:93], v[44:45], v[60:61] op_sel:[1,1,0] op_sel_hi:[1,0,1] neg_lo:[1,0,0]
    v_pk_fma_f32 v[46:47], v[94:95], v[46:47], v[62:63] op_sel:[1,1,0] op_sel_hi:[1,0,1] neg_lo:[1,0,0]
    v_accvgpr_read_b32 v64, a96
    v_accvgpr_read_b32 v66, a100
    v_accvgpr_read_b32 v68, a104
    v_accvgpr_read_b32 v70, a108
    v_accvgpr_read_b32 v65, a112
    v_accvgpr_read_b32 v67, a116
    v_accvgpr_read_b32 v69, a120
    v_accvgpr_read_b32 v71, a124
    v_pk_fma_f32 v[56:57], v[88:89], v[40:41], v[64:65] op_sel:[0,0,0] op_sel_hi:[0,1,1]
    v_pk_fma_f32 v[58:59], v[90:91], v[42:43], v[66:67] op_sel:[0,0,0] op_sel_hi:[0,1,1]
    v_pk_fma_f32 v[60:61], v[92:93], v[44:45], v[68:69] op_sel:[0,0,0] op_sel_hi:[0,1,1]
    v_pk_fma_f32 v[62:63], v[94:95], v[46:47], v[70:71] op_sel:[0,0,0] op_sel_hi:[0,1,1]
    v_pk_fma_f32 v[40:41], v[88:89], v[40:41], v[56:57] op_sel:[1,1,0] op_sel_hi:[1,0,1] neg_lo:[1,0,0]
    v_pk_fma_f32 v[42:43], v[90:91], v[42:43], v[58:59] op_sel:[1,1,0] op_sel_hi:[1,0,1] neg_lo:[1,0,0]
    v_pk_fma_f32 v[44:45], v[92:93], v[44:45], v[60:61] op_sel:[1,1,0] op_sel_hi:[1,0,1] neg_lo:[1,0,0]
    v_pk_fma_f32 v[46:47], v[94:95], v[46:47], v[62:63] op_sel:[1,1,0] op_sel_hi:[1,0,1] neg_lo:[1,0,0]
    v_accvgpr_read_b32 v48, a97
    v_accvgpr_read_b32 v50, a101
    v_accvgpr_read_b32 v52, a105
    v_accvgpr_read_b32 v54, a109
    v_accvgpr_read_b32 v49, a113
    v_accvgpr_read_b32 v51, a117
    v_accvgpr_read_b32 v53, a121
    v_accvgpr_read_b32 v55, a125
    v_pk_fma_f32 v[56:57], v[88:89], v[40:41], v[48:49] op_sel:[0,0,0] op_sel_hi:[0,1,1]
    v_pk_fma_f32 v[58:59], v[90:91], v[42:43], v[50:51] op_sel:[0,0,0] op_sel_hi:[0,1,1]
    v_pk_fma_f32 v[60:61], v[92:93], v[44:45], v[52:53] op_sel:[0,0,0] op_sel_hi:[0,1,1]
    v_pk_fma_f32 v[62:63], v[94:95], v[46:47], v[54:55] op_sel:[0,0,0] op_sel_hi:[0,1,1]
    v_pk_fma_f32 v[40:41], v[88:89], v[40:41], v[56:57] op_sel:[1,1,0] op_sel_hi:[1,0,1] neg_lo:[1,0,0]
    v_pk_fma_f32 v[42:43], v[90:91], v[42:43], v[58:59] op_sel:[1,1,0] op_sel_hi:[1,0,1] neg_lo:[1,0,0]
    v_pk_fma_f32 v[44:45], v[92:93], v[44:45], v[60:61] op_sel:[1,1,0] op_sel_hi:[1,0,1] neg_lo:[1,0,0]
    v_pk_fma_f32 v[46:47], v[94:95], v[46:47], v[62:63] op_sel:[1,1,0] op_sel_hi:[1,0,1] neg_lo:[1,0,0]
    v_accvgpr_read_b32 v64, a98
    v_accvgpr_read_b32 v66, a102
    v_accvgpr_read_b32 v68, a106
    v_accvgpr_read_b32 v70, a110
    v_accvgpr_read_b32 v65, a114
    v_accvgpr_read_b32 v67, a118
    v_accvgpr_read_b32 v69, a122
    v_accvgpr_read_b32 v71, a126
    v_pk_fma_f32 v[56:57], v[88:89], v[40:41], v[64:65] op_sel:[0,0,0] op_sel_hi:[0,1,1]
    v_pk_fma_f32 v[58:59], v[90:91], v[42:43], v[66:67] op_sel:[0,0,0] op_sel_hi:[0,1,1]
    v_pk_fma_f32 v[60:61], v[92:93], v[44:45], v[68:69] op_sel:[0,0,0] op_sel_hi:[0,1,1]
    v_pk_fma_f32 v[62:63], v[94:95], v[46:47], v[70:71] op_sel:[0,0,0] op_sel_hi:[0,1,1]
    v_pk_fma_f32 v[40:41], v[88:89], v[40:41], v[56:57] op_sel:[1,1,0] op_sel_hi:[1,0,1] neg_lo:[1,0,0]
    v_pk_fma_f32 v[42:43], v[90:91], v[42:43], v[58:59] op_sel:[1,1,0] op_sel_hi:[1,0,1] neg_lo:[1,0,0]
    v_pk_fma_f32 v[44:45], v[92:93], v[44:45], v[60:61] op_sel:[1,1,0] op_sel_hi:[1,0,1] neg_lo:[1,0,0]
    v_pk_fma_f32 v[46:47], v[94:95], v[46:47], v[62:63] op_sel:[1,1,0] op_sel_hi:[1,0,1] neg_lo:[1,0,0]
    v_accvgpr_read_b32 v48, a99
    v_accvgpr_read_b32 v50, a103
    v_accvgpr_read_b32 v52, a107
    v_accvgpr_read_b32 v54, a111
    v_accvgpr_read_b32 v49, a115
    v_accvgpr_read_b32 v51, a119
    v_accvgpr_read_b32 v53, a123
    v_accvgpr_read_b32 v55, a127
    v_pk_fma_f32 v[56:57], v[88:89], v[40:41], v[48:49] op_sel:[0,0,0] op_sel_hi:[0,1,1]
    v_pk_fma_f32 v[58:59], v[90:91], v[42:43], v[50:51] op_sel:[0,0,0] op_sel_hi:[0,1,1]
    v_pk_fma_f32 v[60:61], v[92:93], v[44:45], v[52:53] op_sel:[0,0,0] op_sel_hi:[0,1,1]
    v_pk_fma_f32 v[62:63], v[94:95], v[46:47], v[54:55] op_sel:[0,0,0] op_sel_hi:[0,1,1]
    v_pk_fma_f32 v[40:41], v[88:89], v[40:41], v[56:57] op_sel:[1,1,0] op_sel_hi:[1,0,1] neg_lo:[1,0,0]
    v_pk_fma_f32 v[42:43], v[90:91], v[42:43], v[58:59] op_sel:[1,1,0] op_sel_hi:[1,0,1] neg_lo:[1,0,0]
    v_pk_fma_f32 v[44:45], v[92:93], v[44:45], v[60:61] op_sel:[1,1,0] op_sel_hi:[1,0,1] neg_lo:[1,0,0]
    v_pk_fma_f32 v[46:47], v[94:95], v[46:47], v[62:63] op_sel:[1,1,0] op_sel_hi:[1,0,1] neg_lo:[1,0,0]
    v_accvgpr_read_b32 v64, a128
    v_accvgpr_read_b32 v66, a132
    v_accvgpr_read_b32 v68, a136
    v_accvgpr_read_b32 v70, a140
    v_accvgpr_read_b32 v65, a144
    v_accvgpr_read_b32 v67, a148
    v_accvgpr_read_b32 v69, a152
    v_accvgpr_read_b32 v71, a156
    v_pk_fma_f32 v[56:57], v[88:89], v[40:41], v[64:65] op_sel:[0,0,0] op_sel_hi:[0,1,1]
    v_pk_fma_f32 v[58:59], v[90:91], v[42:43], v[66:67] op_sel:[0,0,0] op_sel_hi:[0,1,1]
    v_pk_fma_f32 v[60:61], v[92:93], v[44:45], v[68:69] op_sel:[0,0,0] op_sel_hi:[0,1,1]
    v_pk_fma_f32 v[62:63], v[94:95], v[46:47], v[70:71] op_sel:[0,0,0] op_sel_hi:[0,1,1]
    v_pk_fma_f32 v[40:41], v[88:89], v[40:41], v[56:57] op_sel:[1,1,0] op_sel_hi:[1,0,1] neg_lo:[1,0,0]
    v_pk_fma_f32 v[42:43], v[90:91], v[42:43], v[58:59] op_sel:[1,1,0] op_sel_hi:[1,0,1] neg_lo:[1,0,0]
    v_pk_fma_f32 v[44:45], v[92:93], v[44:45], v[60:61] op_sel:[1,1,0] op_sel_hi:[1,0,1] neg_lo:[1,0,0]
    v_pk_fma_f32 v[46:47], v[94:95], v[46:47], v[62:63] op_sel:[1,1,0] op_sel_hi:[1,0,1] neg_lo:[1,0,0]
    v_accvgpr_read_b32 v48, a129
    v_accvgpr_read_b32 v50, a133
    v_accvgpr_read_b32 v52, a137
    v_accvgpr_read_b32 v54, a141
    v_accvgpr_read_b32 v49, a145
    v_accvgpr_read_b32 v51, a149
    v_accvgpr_read_b32 v53, a153
    v_accvgpr_read_b32 v55, a157
    v_pk_fma_f32 v[56:57], v[88:89], v[40:41], v[48:49] op_sel:[0,0,0] op_sel_hi:[0,1,1]
    v_pk_fma_f32 v[58:59], v[90:91], v[42:43], v[50:51] op_sel:[0,0,0] op_sel_hi:[0,1,1]
    v_pk_fma_f32 v[60:61], v[92:93], v[44:45], v[52:53] op_sel:[0,0,0] op_sel_hi:[0,1,1]
    v_pk_fma_f32 v[62:63], v[94:95], v[46:47], v[54:55] op_sel:[0,0,0] op_sel_hi:[0,1,1]
    v_pk_fma_f32 v[40:41], v[88:89], v[40:41], v[56:57] op_sel:[1,1,0] op_sel_hi:[1,0,1] neg_lo:[1,0,0]
    v_pk_fma_f32 v[42:43], v[90:91], v[42:43], v[58:59] op_sel:[1,1,0] op_sel_hi:[1,0,1] neg_lo:[1,0,0]
    v_pk_fma_f32 v[44:45], v[92:93], v[44:45], v[60:61] op_sel:[1,1,0] op_sel_hi:[1,0,1] neg_lo:[1,0,0]
    v_pk_fma_f32 v[46:47], v[94:95], v[46:47], v[62:63] op_sel:[1,1,0] op_sel_hi:[1,0,1] neg_lo:[1,0,0]
    v_accvgpr_read_b32 v64, a130
    v_accvgpr_read_b32 v66, a134
    v_accvgpr_read_b32 v68, a138
    v_accvgpr_read_b32 v70, a142
    v_accvgpr_read_b32 v65, a146
    v_accvgpr_read_b32 v67, a150
    v_accvgpr_read_b32 v69, a154
    v_accvgpr_read_b32 v71, a158
    v_pk_fma_f32 v[56:57], v[88:89], v[40:41], v[64:65] op_sel:[0,0,0] op_sel_hi:[0,1,1]
    v_pk_fma_f32 v[58:59], v[90:91], v[42:43], v[66:67] op_sel:[0,0,0] op_sel_hi:[0,1,1]
    v_pk_fma_f32 v[60:61], v[92:93], v[44:45], v[68:69] op_sel:[0,0,0] op_sel_hi:[0,1,1]
    v_pk_fma_f32 v[62:63], v[94:95], v[46:47], v[70:71] op_sel:[0,0,0] op_sel_hi:[0,1,1]
    v_pk_fma_f32 v[40:41], v[88:89], v[40:41], v[56:57] op_sel:[1,1,0] op_sel_hi:[1,0,1] neg_lo:[1,0,0]
    v_pk_fma_f32 v[42:43], v[90:91], v[42:43], v[58:59] op_sel:[1,1,0] op_sel_hi:[1,0,1] neg_lo:[1,0,0]
    v_pk_fma_f32 v[44:45], v[92:93], v[44:45], v[60:61] op_sel:[1,1,0] op_sel_hi:[1,0,1] neg_lo:[1,0,0]
    v_pk_fma_f32 v[46:47], v[94:95], v[46:47], v[62:63] op_sel:[1,1,0] op_sel_hi:[1,0,1] neg_lo:[1,0,0]
    v_accvgpr_read_b32 v48, a131
    v_accvgpr_read_b32 v50, a135
    v_accvgpr_read_b32 v52, a139
    v_accvgpr_read_b32 v54, a143
    v_accvgpr_read_b32 v49, a147
    v_accvgpr_read_b32 v51, a151
    v_accvgpr_read_b32 v53, a155
    v_accvgpr_read_b32 v55, a159
    v_pk_fma_f32 v[56:57], v[88:89], v[40:41], v[48:49] op_sel:[0,0,0] op_sel_hi:[0,1,1]
    v_pk_fma_f32 v[58:59], v[90:91], v[42:43], v[50:51] op_sel:[0,0,0] op_sel_hi:[0,1,1]
    v_pk_fma_f32 v[60:61], v[92:93], v[44:45], v[52:53] op_sel:[0,0,0] op_sel_hi:[0,1,1]
    v_pk_fma_f32 v[62:63], v[94:95], v[46:47], v[54:55] op_sel:[0,0,0] op_sel_hi:[0,1,1]
    v_pk_fma_f32 v[40:41], v[88:89], v[40:41], v[56:57] op_sel:[1,1,0] op_sel_hi:[1,0,1] neg_lo:[1,0,0]
    v_pk_fma_f32 v[42:43], v[90:91], v[42:43], v[58:59] op_sel:[1,1,0] op_sel_hi:[1,0,1] neg_lo:[1,0,0]
    v_pk_fma_f32 v[44:45], v[92:93], v[44:45], v[60:61] op_sel:[1,1,0] op_sel_hi:[1,0,1] neg_lo:[1,0,0]
    v_pk_fma_f32 v[46:47], v[94:95], v[46:47], v[62:63] op_sel:[1,1,0] op_sel_hi:[1,0,1] neg_lo:[1,0,0]
    v_accvgpr_read_b32 v64, a160
    v_accvgpr_read_b32 v66, a164
    v_accvgpr_read_b32 v68, a168
    v_accvgpr_read_b32 v70, a172
    v_accvgpr_read_b32 v65, a176
    v_accvgpr_read_b32 v67, a180
    v_accvgpr_read_b32 v69, a184
    v_accvgpr_read_b32 v71, a188
    v_pk_fma_f32 v[56:57], v[88:89], v[40:41], v[64:65] op_sel:[0,0,0] op_sel_hi:[0,1,1]
    v_pk_fma_f32 v[58:59], v[90:91], v[42:43], v[66:67] op_sel:[0,0,0] op_sel_hi:[0,1,1]
    v_pk_fma_f32 v[60:61], v[92:93], v[44:45], v[68:69] op_sel:[0,0,0] op_sel_hi:[0,1,1]
    v_pk_fma_f32 v[62:63], v[94:95], v[46:47], v[70:71] op_sel:[0,0,0] op_sel_hi:[0,1,1]
    v_pk_fma_f32 v[40:41], v[88:89], v[40:41], v[56:57] op_sel:[1,1,0] op_sel_hi:[1,0,1] neg_lo:[1,0,0]
    v_pk_fma_f32 v[42:43], v[90:91], v[42:43], v[58:59] op_sel:[1,1,0] op_sel_hi:[1,0,1] neg_lo:[1,0,0]
    v_pk_fma_f32 v[44:45], v[92:93], v[44:45], v[60:61] op_sel:[1,1,0] op_sel_hi:[1,0,1] neg_lo:[1,0,0]
    v_pk_fma_f32 v[46:47], v[94:95], v[46:47], v[62:63] op_sel:[1,1,0] op_sel_hi:[1,0,1] neg_lo:[1,0,0]
    v_accvgpr_read_b32 v48, a161
    v_accvgpr_read_b32 v50, a165
    v_accvgpr_read_b32 v52, a169
    v_accvgpr_read_b32 v54, a173
    v_accvgpr_read_b32 v49, a177
    v_accvgpr_read_b32 v51, a181
    v_accvgpr_read_b32 v53, a185
    v_accvgpr_read_b32 v55, a189
    v_pk_fma_f32 v[56:57], v[88:89], v[40:41], v[48:49] op_sel:[0,0,0] op_sel_hi:[0,1,1]
    v_pk_fma_f32 v[58:59], v[90:91], v[42:43], v[50:51] op_sel:[0,0,0] op_sel_hi:[0,1,1]
    v_pk_fma_f32 v[60:61], v[92:93], v[44:45], v[52:53] op_sel:[0,0,0] op_sel_hi:[0,1,1]
    v_pk_fma_f32 v[62:63], v[94:95], v[46:47], v[54:55] op_sel:[0,0,0] op_sel_hi:[0,1,1]
    v_pk_fma_f32 v[40:41], v[88:89], v[40:41], v[56:57] op_sel:[1,1,0] op_sel_hi:[1,0,1] neg_lo:[1,0,0]
    v_pk_fma_f32 v[42:43], v[90:91], v[42:43], v[58:59] op_sel:[1,1,0] op_sel_hi:[1,0,1] neg_lo:[1,0,0]
    v_pk_fma_f32 v[44:45], v[92:93], v[44:45], v[60:61] op_sel:[1,1,0] op_sel_hi:[1,0,1] neg_lo:[1,0,0]
    v_pk_fma_f32 v[46:47], v[94:95], v[46:47], v[62:63] op_sel:[1,1,0] op_sel_hi:[1,0,1] neg_lo:[1,0,0]
    v_accvgpr_read_b32 v64, a162
    v_accvgpr_read_b32 v66, a166
    v_accvgpr_read_b32 v68, a170
    v_accvgpr_read_b32 v70, a174
    v_accvgpr_read_b32 v65, a178
    v_accvgpr_read_b32 v67, a182
    v_accvgpr_read_b32 v69, a186
    v_accvgpr_read_b32 v71, a190
    v_pk_fma_f32 v[56:57], v[88:89], v[40:41], v[64:65] op_sel:[0,0,0] op_sel_hi:[0,1,1]
    v_pk_fma_f32 v[58:59], v[90:91], v[42:43], v[66:67] op_sel:[0,0,0] op_sel_hi:[0,1,1]
    v_pk_fma_f32 v[60:61], v[92:93], v[44:45], v[68:69] op_sel:[0,0,0] op_sel_hi:[0,1,1]
    v_pk_fma_f32 v[62:63], v[94:95], v[46:47], v[70:71] op_sel:[0,0,0] op_sel_hi:[0,1,1]
    v_pk_fma_f32 v[40:41], v[88:89], v[40:41], v[56:57] op_sel:[1,1,0] op_sel_hi:[1,0,1] neg_lo:[1,0,0]
    v_pk_fma_f32 v[42:43], v[90:91], v[42:43], v[58:59] op_sel:[1,1,0] op_sel_hi:[1,0,1] neg_lo:[1,0,0]
    v_pk_fma_f32 v[44:45], v[92:93], v[44:45], v[60:61] op_sel:[1,1,0] op_sel_hi:[1,0,1] neg_lo:[1,0,0]
    v_pk_fma_f32 v[46:47], v[94:95], v[46:47], v[62:63] op_sel:[1,1,0] op_sel_hi:[1,0,1] neg_lo:[1,0,0]
    v_accvgpr_read_b32 v48, a163
    v_accvgpr_read_b32 v50, a167
    v_accvgpr_read_b32 v52, a171
    v_accvgpr_read_b32 v54, a175
    v_accvgpr_read_b32 v49, a179
    v_accvgpr_read_b32 v51, a183
    v_accvgpr_read_b32 v53, a187
    v_accvgpr_read_b32 v55, a191
    v_pk_fma_f32 v[56:57], v[88:89], v[40:41], v[48:49] op_sel:[0,0,0] op_sel_hi:[0,1,1]
    v_pk_fma_f32 v[58:59], v[90:91], v[42:43], v[50:51] op_sel:[0,0,0] op_sel_hi:[0,1,1]
    v_pk_fma_f32 v[60:61], v[92:93], v[44:45], v[52:53] op_sel:[0,0,0] op_sel_hi:[0,1,1]
    v_pk_fma_f32 v[62:63], v[94:95], v[46:47], v[54:55] op_sel:[0,0,0] op_sel_hi:[0,1,1]
    v_pk_fma_f32 v[40:41], v[88:89], v[40:41], v[56:57] op_sel:[1,1,0] op_sel_hi:[1,0,1] neg_lo:[1,0,0]
    v_pk_fma_f32 v[42:43], v[90:91], v[42:43], v[58:59] op_sel:[1,1,0] op_sel_hi:[1,0,1] neg_lo:[1,0,0]
    v_pk_fma_f32 v[44:45], v[92:93], v[44:45], v[60:61] op_sel:[1,1,0] op_sel_hi:[1,0,1] neg_lo:[1,0,0]
    v_pk_fma_f32 v[46:47], v[94:95], v[46:47], v[62:63] op_sel:[1,1,0] op_sel_hi:[1,0,1] neg_lo:[1,0,0]
    v_accvgpr_read_b32 v64, a192
    v_accvgpr_read_b32 v66, a196
    v_accvgpr_read_b32 v68, a200
    v_accvgpr_read_b32 v70, a204
    v_accvgpr_read_b32 v65, a208
    v_accvgpr_read_b32 v67, a212
    v_accvgpr_read_b32 v69, a216
    v_accvgpr_read_b32 v71, a220
    v_pk_fma_f32 v[56:57], v[88:89], v[40:41], v[64:65] op_sel:[0,0,0] op_sel_hi:[0,1,1]
    v_pk_fma_f32 v[58:59], v[90:91], v[42:43], v[66:67] op_sel:[0,0,0] op_sel_hi:[0,1,1]
    v_pk_fma_f32 v[60:61], v[92:93], v[44:45], v[68:69] op_sel:[0,0,0] op_sel_hi:[0,1,1]
    v_pk_fma_f32 v[62:63], v[94:95], v[46:47], v[70:71] op_sel:[0,0,0] op_sel_hi:[0,1,1]
    v_pk_fma_f32 v[40:41], v[88:89], v[40:41], v[56:57] op_sel:[1,1,0] op_sel_hi:[1,0,1] neg_lo:[1,0,0]
    v_pk_fma_f32 v[42:43], v[90:91], v[42:43], v[58:59] op_sel:[1,1,0] op_sel_hi:[1,0,1] neg_lo:[1,0,0]
    v_pk_fma_f32 v[44:45], v[92:93], v[44:45], v[60:61] op_sel:[1,1,0] op_sel_hi:[1,0,1] neg_lo:[1,0,0]
    v_pk_fma_f32 v[46:47], v[94:95], v[46:47], v[62:63] op_sel:[1,1,0] op_sel_hi:[1,0,1] neg_lo:[1,0,0]
    v_accvgpr_read_b32 v48, a193
    v_accvgpr_read_b32 v50, a197
    v_accvgpr_read_b32 v52, a201
    v_accvgpr_read_b32 v54, a205
    v_accvgpr_read_b32 v49, a209
    v_accvgpr_read_b32 v51, a213
    v_accvgpr_read_b32 v53, a217
    v_accvgpr_read_b32 v55, a221
    v_pk_fma_f32 v[56:57], v[88:89], v[40:41], v[48:49] op_sel:[0,0,0] op_sel_hi:[0,1,1]
    v_pk_fma_f32 v[58:59], v[90:91], v[42:43], v[50:51] op_sel:[0,0,0] op_sel_hi:[0,1,1]
    v_pk_fma_f32 v[60:61], v[92:93], v[44:45], v[52:53] op_sel:[0,0,0] op_sel_hi:[0,1,1]
    v_pk_fma_f32 v[62:63], v[94:95], v[46:47], v[54:55] op_sel:[0,0,0] op_sel_hi:[0,1,1]
    v_pk_fma_f32 v[40:41], v[88:89], v[40:41], v[56:57] op_sel:[1,1,0] op_sel_hi:[1,0,1] neg_lo:[1,0,0]
    v_pk_fma_f32 v[42:43], v[90:91], v[42:43], v[58:59] op_sel:[1,1,0] op_sel_hi:[1,0,1] neg_lo:[1,0,0]
    v_pk_fma_f32 v[44:45], v[92:93], v[44:45], v[60:61] op_sel:[1,1,0] op_sel_hi:[1,0,1] neg_lo:[1,0,0]
    v_pk_fma_f32 v[46:47], v[94:95], v[46:47], v[62:63] op_sel:[1,1,0] op_sel_hi:[1,0,1] neg_lo:[1,0,0]
    v_accvgpr_read_b32 v64, a194
    v_accvgpr_read_b32 v66, a198
    v_accvgpr_read_b32 v68, a202
    v_accvgpr_read_b32 v70, a206
    v_accvgpr_read_b32 v65, a210
    v_accvgpr_read_b32 v67, a214
    v_accvgpr_read_b32 v69, a218
    v_accvgpr_read_b32 v71, a222
    v_pk_fma_f32 v[56:57], v[88:89], v[40:41], v[64:65] op_sel:[0,0,0] op_sel_hi:[0,1,1]
    v_pk_fma_f32 v[58:59], v[90:91], v[42:43], v[66:67] op_sel:[0,0,0] op_sel_hi:[0,1,1]
    v_pk_fma_f32 v[60:61], v[92:93], v[44:45], v[68:69] op_sel:[0,0,0] op_sel_hi:[0,1,1]
    v_pk_fma_f32 v[62:63], v[94:95], v[46:47], v[70:71] op_sel:[0,0,0] op_sel_hi:[0,1,1]
    v_pk_fma_f32 v[40:41], v[88:89], v[40:41], v[56:57] op_sel:[1,1,0] op_sel_hi:[1,0,1] neg_lo:[1,0,0]
    v_pk_fma_f32 v[42:43], v[90:91], v[42:43], v[58:59] op_sel:[1,1,0] op_sel_hi:[1,0,1] neg_lo:[1,0,0]
    v_pk_fma_f32 v[44:45], v[92:93], v[44:45], v[60:61] op_sel:[1,1,0] op_sel_hi:[1,0,1] neg_lo:[1,0,0]
    v_pk_fma_f32 v[46:47], v[94:95], v[46:47], v[62:63] op_sel:[1,1,0] op_sel_hi:[1,0,1] neg_lo:[1,0,0]
    v_accvgpr_read_b32 v48, a195
    v_accvgpr_read_b32 v50, a199
    v_accvgpr_read_b32 v52, a203
    v_accvgpr_read_b32 v54, a207
    v_accvgpr_read_b32 v49, a211
    v_accvgpr_read_b32 v51, a215
    v_accvgpr_read_b32 v53, a219
    v_accvgpr_read_b32 v55, a223
    v_pk_fma_f32 v[56:57], v[88:89], v[40:41], v[48:49] op_sel:[0,0,0] op_sel_hi:[0,1,1]
    v_pk_fma_f32 v[58:59], v[90:91], v[42:43], v[50:51] op_sel:[0,0,0] op_sel_hi:[0,1,1]
    v_pk_fma_f32 v[60:61], v[92:93], v[44:45], v[52:53] op_sel:[0,0,0] op_sel_hi:[0,1,1]
    v_pk_fma_f32 v[62:63], v[94:95], v[46:47], v[54:55] op_sel:[0,0,0] op_sel_hi:[0,1,1]
    v_pk_fma_f32 v[40:41], v[88:89], v[40:41], v[56:57] op_sel:[1,1,0] op_sel_hi:[1,0,1] neg_lo:[1,0,0]
    v_pk_fma_f32 v[42:43], v[90:91], v[42:43], v[58:59] op_sel:[1,1,0] op_sel_hi:[1,0,1] neg_lo:[1,0,0]
    v_pk_fma_f32 v[44:45], v[92:93], v[44:45], v[60:61] op_sel:[1,1,0] op_sel_hi:[1,0,1] neg_lo:[1,0,0]
    v_pk_fma_f32 v[46:47], v[94:95], v[46:47], v[62:63] op_sel:[1,1,0] op_sel_hi:[1,0,1] neg_lo:[1,0,0]
    v_accvgpr_read_b32 v64, a224
    v_accvgpr_read_b32 v66, a228
    v_accvgpr_read_b32 v68, a232
    v_accvgpr_read_b32 v70, a236
    v_accvgpr_read_b32 v65, a240
    v_accvgpr_read_b32 v67, a244
    v_accvgpr_read_b32 v69, a248
    v_accvgpr_read_b32 v71, a252
    v_pk_fma_f32 v[56:57], v[88:89], v[40:41], v[64:65] op_sel:[0,0,0] op_sel_hi:[0,1,1]
    v_pk_fma_f32 v[58:59], v[90:91], v[42:43], v[66:67] op_sel:[0,0,0] op_sel_hi:[0,1,1]
    v_pk_fma_f32 v[60:61], v[92:93], v[44:45], v[68:69] op_sel:[0,0,0] op_sel_hi:[0,1,1]
    v_pk_fma_f32 v[62:63], v[94:95], v[46:47], v[70:71] op_sel:[0,0,0] op_sel_hi:[0,1,1]
    v_pk_fma_f32 v[40:41], v[88:89], v[40:41], v[56:57] op_sel:[1,1,0] op_sel_hi:[1,0,1] neg_lo:[1,0,0]
    v_pk_fma_f32 v[42:43], v[90:91], v[42:43], v[58:59] op_sel:[1,1,0] op_sel_hi:[1,0,1] neg_lo:[1,0,0]
    v_pk_fma_f32 v[44:45], v[92:93], v[44:45], v[60:61] op_sel:[1,1,0] op_sel_hi:[1,0,1] neg_lo:[1,0,0]
    v_pk_fma_f32 v[46:47], v[94:95], v[46:47], v[62:63] op_sel:[1,1,0] op_sel_hi:[1,0,1] neg_lo:[1,0,0]
    v_accvgpr_read_b32 v48, a225
    v_accvgpr_read_b32 v50, a229
    v_accvgpr_read_b32 v52, a233
    v_accvgpr_read_b32 v54, a237
    v_accvgpr_read_b32 v49, a241
    v_accvgpr_read_b32 v51, a245
    v_accvgpr_read_b32 v53, a249
    v_accvgpr_read_b32 v55, a253
    v_pk_fma_f32 v[56:57], v[88:89], v[40:41], v[48:49] op_sel:[0,0,0] op_sel_hi:[0,1,1]
    v_pk_fma_f32 v[58:59], v[90:91], v[42:43], v[50:51] op_sel:[0,0,0] op_sel_hi:[0,1,1]
    v_pk_fma_f32 v[60:61], v[92:93], v[44:45], v[52:53] op_sel:[0,0,0] op_sel_hi:[0,1,1]
    v_pk_fma_f32 v[62:63], v[94:95], v[46:47], v[54:55] op_sel:[0,0,0] op_sel_hi:[0,1,1]
    v_pk_fma_f32 v[40:41], v[88:89], v[40:41], v[56:57] op_sel:[1,1,0] op_sel_hi:[1,0,1] neg_lo:[1,0,0]
    v_pk_fma_f32 v[42:43], v[90:91], v[42:43], v[58:59] op_sel:[1,1,0] op_sel_hi:[1,0,1] neg_lo:[1,0,0]
    v_pk_fma_f32 v[44:45], v[92:93], v[44:45], v[60:61] op_sel:[1,1,0] op_sel_hi:[1,0,1] neg_lo:[1,0,0]
    v_pk_fma_f32 v[46:47], v[94:95], v[46:47], v[62:63] op_sel:[1,1,0] op_sel_hi:[1,0,1] neg_lo:[1,0,0]
    v_accvgpr_read_b32 v64, a226
    v_accvgpr_read_b32 v66, a230
    v_accvgpr_read_b32 v68, a234
    v_accvgpr_read_b32 v70, a238
    v_accvgpr_read_b32 v65, a242
    v_accvgpr_read_b32 v67, a246
    v_accvgpr_read_b32 v69, a250
    v_accvgpr_read_b32 v71, a254
    v_pk_fma_f32 v[56:57], v[88:89], v[40:41], v[64:65] op_sel:[0,0,0] op_sel_hi:[0,1,1]
    v_pk_fma_f32 v[58:59], v[90:91], v[42:43], v[66:67] op_sel:[0,0,0] op_sel_hi:[0,1,1]
    v_pk_fma_f32 v[60:61], v[92:93], v[44:45], v[68:69] op_sel:[0,0,0] op_sel_hi:[0,1,1]
    v_pk_fma_f32 v[62:63], v[94:95], v[46:47], v[70:71] op_sel:[0,0,0] op_sel_hi:[0,1,1]
    v_pk_fma_f32 v[40:41], v[88:89], v[40:41], v[56:57] op_sel:[1,1,0] op_sel_hi:[1,0,1] neg_lo:[1,0,0]
    v_pk_fma_f32 v[42:43], v[90:91], v[42:43], v[58:59] op_sel:[1,1,0] op_sel_hi:[1,0,1] neg_lo:[1,0,0]
    v_pk_fma_f32 v[44:45], v[92:93], v[44:45], v[60:61] op_sel:[1,1,0] op_sel_hi:[1,0,1] neg_lo:[1,0,0]
    v_pk_fma_f32 v[46:47], v[94:95], v[46:47], v[62:63] op_sel:[1,1,0] op_sel_hi:[1,0,1] neg_lo:[1,0,0]
    v_accvgpr_read_b32 v48, a227
    v_accvgpr_read_b32 v50, a231
    v_accvgpr_read_b32 v52, a235
    v_accvgpr_read_b32 v54, a239
    v_accvgpr_read_b32 v49, a243
    v_accvgpr_read_b32 v51, a247
    v_accvgpr_read_b32 v53, a251
    v_accvgpr_read_b32 v55, a255
    v_pk_fma_f32 v[56:57], v[88:89], v[40:41], v[48:49] op_sel:[0,0,0] op_sel_hi:[0,1,1]
    v_pk_fma_f32 v[58:59], v[90:91], v[42:43], v[50:51] op_sel:[0,0,0] op_sel_hi:[0,1,1]
    v_pk_fma_f32 v[60:61], v[92:93], v[44:45], v[52:53] op_sel:[0,0,0] op_sel_hi:[0,1,1]
    v_pk_fma_f32 v[62:63], v[94:95], v[46:47], v[54:55] op_sel:[0,0,0] op_sel_hi:[0,1,1]
    v_pk_fma_f32 v[40:41], v[88:89], v[40:41], v[56:57] op_sel:[1,1,0] op_sel_hi:[1,0,1] neg_lo:[1,0,0]
    v_pk_fma_f32 v[42:43], v[90:91], v[42:43], v[58:59] op_sel:[1,1,0] op_sel_hi:[1,0,1] neg_lo:[1,0,0]
    v_pk_fma_f32 v[44:45], v[92:93], v[44:45], v[60:61] op_sel:[1,1,0] op_sel_hi:[1,0,1] neg_lo:[1,0,0]
    v_pk_fma_f32 v[46:47], v[94:95], v[46:47], v[62:63] op_sel:[1,1,0] op_sel_hi:[1,0,1] neg_lo:[1,0,0]
    v_mov_b32 v64, v40
    v_mov_b32 v72, v40
    v_mov_b32 v65, v41
    v_mov_b32 v73, v41
    v_mov_b32 v66, v42
    v_mov_b32 v74, v42
    v_mov_b32 v67, v43
    v_mov_b32 v75, v43
    v_mov_b32 v68, v44
    v_mov_b32 v76, v44
    v_mov_b32 v69, v45
    v_mov_b32 v77, v45
    v_mov_b32 v70, v46
    v_mov_b32 v78, v46
    v_mov_b32 v71, v47
    v_mov_b32 v79, v47
    s_nop 1
    v_permlane16_swap_b32 v64, v72
    v_permlane16_swap_b32 v65, v73
    v_permlane16_swap_b32 v66, v74
    v_permlane16_swap_b32 v67, v75
    v_permlane16_swap_b32 v68, v76
    v_permlane16_swap_b32 v69, v77
    v_permlane16_swap_b32 v70, v78
    v_permlane16_swap_b32 v71, v79
    v_pk_fma_f32 v[56:57], v[104:105], v[64:65], v[72:73] op_sel:[0,0,0] op_sel_hi:[0,1,1]
    v_pk_fma_f32 v[58:59], v[106:107], v[66:67], v[74:75] op_sel:[0,0,0] op_sel_hi:[0,1,1]
    v_pk_fma_f32 v[60:61], v[108:109], v[68:69], v[76:77] op_sel:[0,0,0] op_sel_hi:[0,1,1]
    v_pk_fma_f32 v[62:63], v[110:111], v[70:71], v[78:79] op_sel:[0,0,0] op_sel_hi:[0,1,1]
    v_pk_fma_f32 v[80:81], v[104:105], v[64:65], v[56:57] op_sel:[1,1,0] op_sel_hi:[1,0,1] neg_lo:[1,0,0]
    v_pk_fma_f32 v[82:83], v[106:107], v[66:67], v[58:59] op_sel:[1,1,0] op_sel_hi:[1,0,1] neg_lo:[1,0,0]
    v_pk_fma_f32 v[84:85], v[108:109], v[68:69], v[60:61] op_sel:[1,1,0] op_sel_hi:[1,0,1] neg_lo:[1,0,0]
    v_pk_fma_f32 v[86:87], v[110:111], v[70:71], v[62:63] op_sel:[1,1,0] op_sel_hi:[1,0,1] neg_lo:[1,0,0]
    v_mov_b32 v24, v80
    v_mov_b32 v25, v81
    v_mov_b32 v26, v82
    v_mov_b32 v27, v83
    v_mov_b32 v28, v84
    v_mov_b32 v29, v85
    v_mov_b32 v30, v86
    v_mov_b32 v31, v87
    s_nop 1
    v_permlane32_swap_b32 v80, v24
    v_permlane32_swap_b32 v81, v25
    v_permlane32_swap_b32 v82, v26
    v_permlane32_swap_b32 v83, v27
    v_permlane32_swap_b32 v84, v28
    v_permlane32_swap_b32 v85, v29
    v_permlane32_swap_b32 v86, v30
    v_permlane32_swap_b32 v87, v31
    v_pk_fma_f32 v[56:57], v[112:113], v[80:81], v[24:25] op_sel:[0,0,0] op_sel_hi:[0,1,1]
    v_pk_fma_f32 v[58:59], v[114:115], v[82:83], v[26:27] op_sel:[0,0,0] op_sel_hi:[0,1,1]
    v_pk_fma_f32 v[60:61], v[116:117], v[84:85], v[28:29] op_sel:[0,0,0] op_sel_hi:[0,1,1]
    v_pk_fma_f32 v[62:63], v[118:119], v[86:87], v[30:31] op_sel:[0,0,0] op_sel_hi:[0,1,1]
    v_pk_fma_f32 v[40:41], v[112:113], v[80:81], v[56:57] op_sel:[1,1,0] op_sel_hi:[1,0,1] neg_lo:[1,0,0]
    v_pk_fma_f32 v[42:43], v[114:115], v[82:83], v[58:59] op_sel:[1,1,0] op_sel_hi:[1,0,1] neg_lo:[1,0,0]
    v_pk_fma_f32 v[44:45], v[116:117], v[84:85], v[60:61] op_sel:[1,1,0] op_sel_hi:[1,0,1] neg_lo:[1,0,0]
    v_pk_fma_f32 v[46:47], v[118:119], v[86:87], v[62:63] op_sel:[1,1,0] op_sel_hi:[1,0,1] neg_lo:[1,0,0]
    s_mov_b32 exec_lo, 0xffffffff
    s_mov_b32 exec_hi, 0xffffffff
    v_mov_b32 v122, v40
    v_mov_b32 v123, v41
    s_mov_b32 exec_lo, 0xffff0000
    s_mov_b32 exec_hi, 0xffffffff
    v_mov_b32 v122, v42
    v_mov_b32 v123, v43
    s_mov_b32 exec_lo, 0x0
    s_mov_b32 exec_hi, 0xffffffff
    v_mov_b32 v122, v44
    v_mov_b32 v123, v45
    s_mov_b32 exec_lo, 0x0
    s_mov_b32 exec_hi, 0xffff0000
    v_mov_b32 v122, v46
    v_mov_b32 v123, v47
    s_mov_b64 exec, -1
    s_and_b32 s53, s58, 1
    s_lshl1_add_u32 s53, s85, s53
    s_lshl_b32 s53, s53, 13
    s_lshr_b32 s29, s58, 1
    s_lshl1_add_u32 s29, s82, s29
    s_lshl_b32 s29, s29, 9
    s_add_u32 s53, s53, s29
    v_lshrrev_b32 v126, 1, v1
    v_add_u32 v126, s53, v126
    s_add_u32 s60, s100, 0xd100000
    s_addc_u32 s61, s101, 0
    s_and_b32 s61, s61, 0xffff
    s_mov_b32 s62, 0x20000
    s_mov_b32 s63, 0x00020000
    buffer_store_dwordx2 v[122:123], v126, s[60:63], 0 offen
    v_subrev_u32 v160, 8192, v126
    v_subrev_u32 v161, 16384, v126
    v_subrev_u32 v162, 24576, v126
    v_subrev_u32 v163, 32768, v126
    v_subrev_u32 v164, 40960, v126
    v_subrev_u32 v165, 49152, v126
    v_subrev_u32 v166, 57344, v126
    v_subrev_u32 v167, 65536, v126
    v_subrev_u32 v168, 73728, v126
    v_subrev_u32 v169, 81920, v126
    v_subrev_u32 v170, 90112, v126
    v_subrev_u32 v171, 98304, v126
    v_subrev_u32 v172, 106496, v126
    v_subrev_u32 v173, 114688, v126
    v_subrev_u32 v174, 122880, v126
    s_lshr_b32 s53, s82, 2
    s_add_u32 s53, s53, 1
    v_mov_b32 v177, s53
    s_lshl_b32 s50, s57, 2
    s_add_u32 s50, s50, 0xd200480
    v_mov_b32 v176, s50
    s_waitcnt vmcnt(0)
    s_barrier
    global_store_dword v176, v177, s[100:101]
    v_and_b32 v178, 7, v0
    v_min_u32 v178, s85, v178
    v_lshlrev_b32 v178, 4, v178
    v_sub_u32 v176, v176, v178
    s_mov_b32 s50, 0
L_lb_69:
    global_load_dword v178, v176, s[100:101] sc1
    s_add_u32 s50, s50, 1
    s_cmp_gt_u32 s50, 0x200000
    s_cbranch_scc1 chain_kernel_wabort
    s_waitcnt vmcnt(0)
    v_cmp_lt_u32 vcc, v178, v177
    s_cbranch_vccnz L_lb_69
    buffer_load_dwordx2 v[128:129], v160, s[60:63], 0 offen sc1
    buffer_load_dwordx2 v[130:131], v161, s[60:63], 0 offen sc1
    buffer_load_dwordx2 v[132:133], v162, s[60:63], 0 offen sc1
    buffer_load_dwordx2 v[134:135], v163, s[60:63], 0 offen sc1
    buffer_load_dwordx2 v[136:137], v164, s[60:63], 0 offen sc1
    buffer_load_dwordx2 v[138:139], v165, s[60:63], 0 offen sc1
    buffer_load_dwordx2 v[140:141], v166, s[60:63], 0 offen sc1
    buffer_load_dwordx2 v[142:143], v167, s[60:63], 0 offen sc1
    buffer_load_dwordx2 v[144:145], v168, s[60:63], 0 offen sc1
    buffer_load_dwordx2 v[146:147], v169, s[60:63], 0 offen sc1
    buffer_load_dwordx2 v[148:149], v170, s[60:63], 0 offen sc1
    buffer_load_dwordx2 v[150:151], v171, s[60:63], 0 offen sc1
    buffer_load_dwordx2 v[152:153], v172, s[60:63], 0 offen sc1
    buffer_load_dwordx2 v[154:155], v173, s[60:63], 0 offen sc1
    buffer_load_dwordx2 v[156:157], v174, s[60:63], 0 offen sc1
    s_waitcnt vmcnt(0)
    v_pk_fma_f32 v[56:57], v[120:121], v[156:157], v[154:155] op_sel:[0,0,0] op_sel_hi:[0,1,1]
    v_pk_fma_f32 v[154:155], v[120:121], v[156:157], v[56:57] op_sel:[1,1,0] op_sel_hi:[1,0,1] neg_lo:[1,0,0]
    v_pk_fma_f32 v[56:57], v[120:121], v[154:155], v[152:153] op_sel:[0,0,0] op_sel_hi:[0,1,1]
    v_pk_fma_f32 v[152:153], v[120:121], v[154:155], v[56:57] op_sel:[1,1,0] op_sel_hi:[1,0,1] neg_lo:[1,0,0]
    v_pk_fma_f32 v[56:57], v[120:121], v[152:153], v[150:151] op_sel:[0,0,0] op_sel_hi:[0,1,1]
    v_pk_fma_f32 v[150:151], v[120:121], v[152:153], v[56:57] op_sel:[1,1,0] op_sel_hi:[1,0,1] neg_lo:[1,0,0]
    v_pk_fma_f32 v[56:57], v[120:121], v[150:151], v[148:149] op_sel:[0,0,0] op_sel_hi:[0,1,1]
    v_pk_fma_f32 v[148:149], v[120:121], v[150:151], v[56:57] op_sel:[1,1,0] op_sel_hi:[1,0,1] neg_lo:[1,0,0]
    v_pk_fma_f32 v[56:57], v[120:121], v[148:149], v[146:147] op_sel:[0,0,0] op_sel_hi:[0,1,1]
    v_pk_fma_f32 v[146:147], v[120:121], v[148:149], v[56:57] op_sel:[1,1,0] op_sel_hi:[1,0,1] neg_lo:[1,0,0]
    v_pk_fma_f32 v[56:57], v[120:121], v[146:147], v[144:145] op_sel:[0,0,0] op_sel_hi:[0,1,1]
    v_pk_fma_f32 v[144:145], v[120:121], v[146:147], v[56:57] op_sel:[1,1,0] op_sel_hi:[1,0,1] neg_lo:[1,0,0]
    v_pk_fma_f32 v[56:57], v[120:121], v[144:145], v[142:143] op_sel:[0,0,0] op_sel_hi:[0,1,1]
    v_pk_fma_f32 v[142:143], v[120:121], v[144:145], v[56:57] op_sel:[1,1,0] op_sel_hi:[1,0,1] neg_lo:[1,0,0]
    v_pk_fma_f32 v[56:57], v[120:121], v[142:143], v[140:141] op_sel:[0,0,0] op_sel_hi:[0,1,1]
    v_pk_fma_f32 v[140:141], v[120:121], v[142:143], v[56:57] op_sel:[1,1,0] op_sel_hi:[1,0,1] neg_lo:[1,0,0]
    v_pk_fma_f32 v[56:57], v[120:121], v[140:141], v[138:139] op_sel:[0,0,0] op_sel_hi:[0,1,1]
    v_pk_fma_f32 v[138:139], v[120:121], v[140:141], v[56:57] op_sel:[1,1,0] op_sel_hi:[1,0,1] neg_lo:[1,0,0]
    v_pk_fma_f32 v[56:57], v[120:121], v[138:139], v[136:137] op_sel:[0,0,0] op_sel_hi:[0,1,1]
    v_pk_fma_f32 v[136:137], v[120:121], v[138:139], v[56:57] op_sel:[1,1,0] op_sel_hi:[1,0,1] neg_lo:[1,0,0]
    v_pk_fma_f32 v[56:57], v[120:121], v[136:137], v[134:135] op_sel:[0,0,0] op_sel_hi:[0,1,1]
    v_pk_fma_f32 v[134:135], v[120:121], v[136:137], v[56:57] op_sel:[1,1,0] op_sel_hi:[1,0,1] neg_lo:[1,0,0]
    v_pk_fma_f32 v[56:57], v[120:121], v[134:135], v[132:133] op_sel:[0,0,0] op_sel_hi:[0,1,1]
    v_pk_fma_f32 v[132:133], v[120:121], v[134:135], v[56:57] op_sel:[1,1,0] op_sel_hi:[1,0,1] neg_lo:[1,0,0]
    v_pk_fma_f32 v[56:57], v[120:121], v[132:133], v[130:131] op_sel:[0,0,0] op_sel_hi:[0,1,1]
    v_pk_fma_f32 v[130:131], v[120:121], v[132:133], v[56:57] op_sel:[1,1,0] op_sel_hi:[1,0,1] neg_lo:[1,0,0]
    v_pk_fma_f32 v[56:57], v[120:121], v[130:131], v[128:129] op_sel:[0,0,0] op_sel_hi:[0,1,1]
    v_pk_fma_f32 v[128:129], v[120:121], v[130:131], v[56:57] op_sel:[1,1,0] op_sel_hi:[1,0,1] neg_lo:[1,0,0]
    v_mov_b32 v32, v128
    v_mov_b32 v34, v128
    v_mov_b32 v33, v129
    v_mov_b32 v35, v129
    s_nop 1
    v_permlane16_swap_b32 v32, v34
    v_permlane16_swap_b32 v33, v35
    v_mov_b32 v36, v32
    v_mov_b32 v37, v33
    v_mov_b32 v38, v34
    v_mov_b32 v39, v35
    s_nop 1
    v_permlane32_swap_b32 v32, v36
    v_permlane32_swap_b32 v33, v37
    v_permlane32_swap_b32 v34, v38
    v_permlane32_swap_b32 v35, v39
    s_mov_b32 exec_lo, 0
    v_pk_fma_f32 v[56:57], v[112:113], v[32:33], v[80:81] op_sel:[0,0,0] op_sel_hi:[0,1,1]
    v_pk_fma_f32 v[58:59], v[114:115], v[34:35], v[82:83] op_sel:[0,0,0] op_sel_hi:[0,1,1]
    v_pk_fma_f32 v[60:61], v[116:117], v[36:37], v[84:85] op_sel:[0,0,0] op_sel_hi:[0,1,1]
    v_pk_fma_f32 v[62:63], v[118:119], v[38:39], v[86:87] op_sel:[0,0,0] op_sel_hi:[0,1,1]
    v_pk_fma_f32 v[32:33], v[112:113], v[32:33], v[56:57] op_sel:[1,1,0] op_sel_hi:[1,0,1] neg_lo:[1,0,0]
    v_pk_fma_f32 v[34:35], v[114:115], v[34:35], v[58:59] op_sel:[1,1,0] op_sel_hi:[1,0,1] neg_lo:[1,0,0]
    v_pk_fma_f32 v[36:37], v[116:117], v[36:37], v[60:61] op_sel:[1,1,0] op_sel_hi:[1,0,1] neg_lo:[1,0,0]
    v_pk_fma_f32 v[38:39], v[118:119], v[38:39], v[62:63] op_sel:[1,1,0] op_sel_hi:[1,0,1] neg_lo:[1,0,0]
    s_mov_b32 exec_lo, 0xffff0000
    s_mov_b32 exec_hi, 0xffff0000
    v_pk_fma_f32 v[56:57], v[104:105], v[32:33], v[64:65] op_sel:[0,0,0] op_sel_hi:[0,1,1]
    v_pk_fma_f32 v[58:59], v[106:107], v[34:35], v[66:67] op_sel:[0,0,0] op_sel_hi:[0,1,1]
    v_pk_fma_f32 v[60:61], v[108:109], v[36:37], v[68:69] op_sel:[0,0,0] op_sel_hi:[0,1,1]
    v_pk_fma_f32 v[62:63], v[110:111], v[38:39], v[70:71] op_sel:[0,0,0] op_sel_hi:[0,1,1]
    v_pk_fma_f32 v[32:33], v[104:105], v[32:33], v[56:57] op_sel:[1,1,0] op_sel_hi:[1,0,1] neg_lo:[1,0,0]
    v_pk_fma_f32 v[34:35], v[106:107], v[34:35], v[58:59] op_sel:[1,1,0] op_sel_hi:[1,0,1] neg_lo:[1,0,0]
    v_pk_fma_f32 v[36:37], v[108:109], v[36:37], v[60:61] op_sel:[1,1,0] op_sel_hi:[1,0,1] neg_lo:[1,0,0]
    v_pk_fma_f32 v[38:39], v[110:111], v[38:39], v[62:63] op_sel:[1,1,0] op_sel_hi:[1,0,1] neg_lo:[1,0,0]
    s_mov_b64 exec, -1
    v_accvgpr_read_b32 v64, a0
    v_accvgpr_read_b32 v66, a4
    v_accvgpr_read_b32 v68, a8
    v_accvgpr_read_b32 v70, a12
    v_accvgpr_read_b32 v65, a16
    v_accvgpr_read_b32 v67, a20
    v_accvgpr_read_b32 v69, a24
    v_accvgpr_read_b32 v71, a28
    v_pk_fma_f32 v[56:57], v[88:89], v[32:33], v[64:65] op_sel:[0,0,0] op_sel_hi:[0,1,1]
    v_pk_fma_f32 v[58:59], v[90:91], v[34:35], v[66:67] op_sel:[0,0,0] op_sel_hi:[0,1,1]
    v_pk_fma_f32 v[60:61], v[92:93], v[36:37], v[68:69] op_sel:[0,0,0] op_sel_hi:[0,1,1]
    v_pk_fma_f32 v[62:63], v[94:95], v[38:39], v[70:71] op_sel:[0,0,0] op_sel_hi:[0,1,1]
    v_pk_fma_f32 v[32:33], v[88:89], v[32:33], v[56:57] op_sel:[1,1,0] op_sel_hi:[1,0,1] neg_lo:[1,0,0]
    v_pk_fma_f32 v[34:35], v[90:91], v[34:35], v[58:59] op_sel:[1,1,0] op_sel_hi:[1,0,1] neg_lo:[1,0,0]
    v_pk_fma_f32 v[36:37], v[92:93], v[36:37], v[60:61] op_sel:[1,1,0] op_sel_hi:[1,0,1] neg_lo:[1,0,0]
    v_pk_fma_f32 v[38:39], v[94:95], v[38:39], v[62:63] op_sel:[1,1,0] op_sel_hi:[1,0,1] neg_lo:[1,0,0]
    v_pk_mul_f32 v[40:41], v[96:97], v[32:33] op_sel:[0,0] op_sel_hi:[0,1]
    v_pk_mul_f32 v[42:43], v[98:99], v[34:35] op_sel:[0,0] op_sel_hi:[0,1]
    v_pk_mul_f32 v[44:45], v[100:101], v[36:37] op_sel:[0,0] op_sel_hi:[0,1]
    v_pk_mul_f32 v[46:47], v[102:103], v[38:39] op_sel:[0,0] op_sel_hi:[0,1]
    v_pk_fma_f32 v[72:73], v[96:97], v[32:33], v[40:41] op_sel:[1,1,0] op_sel_hi:[1,0,1] neg_lo:[1,0,0] neg_hi:[1,0,1]
    v_pk_fma_f32 v[74:75], v[98:99], v[34:35], v[42:43] op_sel:[1,1,0] op_sel_hi:[1,0,1] neg_lo:[1,0,0] neg_hi:[1,0,1]
    v_pk_fma_f32 v[76:77], v[100:101], v[36:37], v[44:45] op_sel:[1,1,0] op_sel_hi:[1,0,1] neg_lo:[1,0,0] neg_hi:[1,0,1]
    v_pk_fma_f32 v[78:79], v[102:103], v[38:39], v[46:47] op_sel:[1,1,0] op_sel_hi:[1,0,1] neg_lo:[1,0,0] neg_hi:[1,0,1]
    v_accvgpr_read_b32 v48, a1
    v_accvgpr_read_b32 v50, a5
    v_accvgpr_read_b32 v52, a9
    v_accvgpr_read_b32 v54, a13
    v_accvgpr_read_b32 v49, a17
    v_accvgpr_read_b32 v51, a21
    v_accvgpr_read_b32 v53, a25
    v_accvgpr_read_b32 v55, a29
    v_pk_fma_f32 v[56:57], v[88:89], v[32:33], v[48:49] op_sel:[0,0,0] op_sel_hi:[0,1,1]
    v_pk_fma_f32 v[58:59], v[90:91], v[34:35], v[50:51] op_sel:[0,0,0] op_sel_hi:[0,1,1]
    v_pk_fma_f32 v[60:61], v[92:93], v[36:37], v[52:53] op_sel:[0,0,0] op_sel_hi:[0,1,1]
    v_pk_fma_f32 v[62:63], v[94:95], v[38:39], v[54:55] op_sel:[0,0,0] op_sel_hi:[0,1,1]
    v_pk_fma_f32 v[32:33], v[88:89], v[32:33], v[56:57] op_sel:[1,1,0] op_sel_hi:[1,0,1] neg_lo:[1,0,0]
    v_pk_fma_f32 v[34:35], v[90:91], v[34:35], v[58:59] op_sel:[1,1,0] op_sel_hi:[1,0,1] neg_lo:[1,0,0]
    v_pk_fma_f32 v[36:37], v[92:93], v[36:37], v[60:61] op_sel:[1,1,0] op_sel_hi:[1,0,1] neg_lo:[1,0,0]
    v_pk_fma_f32 v[38:39], v[94:95], v[38:39], v[62:63] op_sel:[1,1,0] op_sel_hi:[1,0,1] neg_lo:[1,0,0]
    v_pk_mul_f32 v[40:41], v[96:97], v[32:33] op_sel:[0,0] op_sel_hi:[0,1]
    v_pk_mul_f32 v[42:43], v[98:99], v[34:35] op_sel:[0,0] op_sel_hi:[0,1]
    v_pk_mul_f32 v[44:45], v[100:101], v[36:37] op_sel:[0,0] op_sel_hi:[0,1]
    v_pk_mul_f32 v[46:47], v[102:103], v[38:39] op_sel:[0,0] op_sel_hi:[0,1]
    v_pk_fma_f32 v[80:81], v[96:97], v[32:33], v[40:41] op_sel:[1,1,0] op_sel_hi:[1,0,1] neg_lo:[1,0,0] neg_hi:[1,0,1]
    v_pk_fma_f32 v[82:83], v[98:99], v[34:35], v[42:43] op_sel:[1,1,0] op_sel_hi:[1,0,1] neg_lo:[1,0,0] neg_hi:[1,0,1]
    v_pk_fma_f32 v[84:85], v[100:101], v[36:37], v[44:45] op_sel:[1,1,0] op_sel_hi:[1,0,1] neg_lo:[1,0,0] neg_hi:[1,0,1]
    v_pk_fma_f32 v[86:87], v[102:103], v[38:39], v[46:47] op_sel:[1,1,0] op_sel_hi:[1,0,1] neg_lo:[1,0,0] neg_hi:[1,0,1]
    v_cvt_pk_bf16_f32 v128, v72, v80
    v_cvt_pk_bf16_f32 v136, v74, v82
    v_cvt_pk_bf16_f32 v144, v76, v84
    v_cvt_pk_bf16_f32 v152, v78, v86
    v_cvt_pk_bf16_f32 v192, v73, v81
    v_cvt_pk_bf16_f32 v200, v75, v83
    v_cvt_pk_bf16_f32 v208, v77, v85
    v_cvt_pk_bf16_f32 v216, v79, v87
    v_accvgpr_read_b32 v64, a2
    v_accvgpr_read_b32 v66, a6
    v_accvgpr_read_b32 v68, a10
    v_accvgpr_read_b32 v70, a14
    v_accvgpr_read_b32 v65, a18
    v_accvgpr_read_b32 v67, a22
    v_accvgpr_read_b32 v69, a26
    v_accvgpr_read_b32 v71, a30
    v_pk_fma_f32 v[56:57], v[88:89], v[32:33], v[64:65] op_sel:[0,0,0] op_sel_hi:[0,1,1]
    v_pk_fma_f32 v[58:59], v[90:91], v[34:35], v[66:67] op_sel:[0,0,0] op_sel_hi:[0,1,1]
    v_pk_fma_f32 v[60:61], v[92:93], v[36:37], v[68:69] op_sel:[0,0,0] op_sel_hi:[0,1,1]
    v_pk_fma_f32 v[62:63], v[94:95], v[38:39], v[70:71] op_sel:[0,0,0] op_sel_hi:[0,1,1]
    v_pk_fma_f32 v[32:33], v[88:89], v[32:33], v[56:57] op_sel:[1,1,0] op_sel_hi:[1,0,1] neg_lo:[1,0,0]
    v_pk_fma_f32 v[34:35], v[90:91], v[34:35], v[58:59] op_sel:[1,1,0] op_sel_hi:[1,0,1] neg_lo:[1,0,0]
    v_pk_fma_f32 v[36:37], v[92:93], v[36:37], v[60:61] op_sel:[1,1,0] op_sel_hi:[1,0,1] neg_lo:[1,0,0]
    v_pk_fma_f32 v[38:39], v[94:95], v[38:39], v[62:63] op_sel:[1,1,0] op_sel_hi:[1,0,1] neg_lo:[1,0,0]
    v_pk_mul_f32 v[40:41], v[96:97], v[32:33] op_sel:[0,0] op_sel_hi:[0,1]
    v_pk_mul_f32 v[42:43], v[98:99], v[34:35] op_sel:[0,0] op_sel_hi:[0,1]
    v_pk_mul_f32 v[44:45], v[100:101], v[36:37] op_sel:[0,0] op_sel_hi:[0,1]
    v_pk_mul_f32 v[46:47], v[102:103], v[38:39] op_sel:[0,0] op_sel_hi:[0,1]
    v_pk_fma_f32 v[72:73], v[96:97], v[32:33], v[40:41] op_sel:[1,1,0] op_sel_hi:[1,0,1] neg_lo:[1,0,0] neg_hi:[1,0,1]
    v_pk_fma_f32 v[74:75], v[98:99], v[34:35], v[42:43] op_sel:[1,1,0] op_sel_hi:[1,0,1] neg_lo:[1,0,0] neg_hi:[1,0,1]
    v_pk_fma_f32 v[76:77], v[100:101], v[36:37], v[44:45] op_sel:[1,1,0] op_sel_hi:[1,0,1] neg_lo:[1,0,0] neg_hi:[1,0,1]
    v_pk_fma_f32 v[78:79], v[102:103], v[38:39], v[46:47] op_sel:[1,1,0] op_sel_hi:[1,0,1] neg_lo:[1,0,0] neg_hi:[1,0,1]
    v_accvgpr_read_b32 v48, a3
    v_accvgpr_read_b32 v50, a7
    v_accvgpr_read_b32 v52, a11
    v_accvgpr_read_b32 v54, a15
    v_accvgpr_read_b32 v49, a19
    v_accvgpr_read_b32 v51, a23
    v_accvgpr_read_b32 v53, a27
    v_accvgpr_read_b32 v55, a31
    v_pk_fma_f32 v[56:57], v[88:89], v[32:33], v[48:49] op_sel:[0,0,0] op_sel_hi:[0,1,1]
    v_pk_fma_f32 v[58:59], v[90:91], v[34:35], v[50:51] op_sel:[0,0,0] op_sel_hi:[0,1,1]
    v_pk_fma_f32 v[60:61], v[92:93], v[36:37], v[52:53] op_sel:[0,0,0] op_sel_hi:[0,1,1]
    v_pk_fma_f32 v[62:63], v[94:95], v[38:39], v[54:55] op_sel:[0,0,0] op_sel_hi:[0,1,1]
    v_pk_fma_f32 v[32:33], v[88:89], v[32:33], v[56:57] op_sel:[1,1,0] op_sel_hi:[1,0,1] neg_lo:[1,0,0]
    v_pk_fma_f32 v[34:35], v[90:91], v[34:35], v[58:59] op_sel:[1,1,0] op_sel_hi:[1,0,1] neg_lo:[1,0,0]
    v_pk_fma_f32 v[36:37], v[92:93], v[36:37], v[60:61] op_sel:[1,1,0] op_sel_hi:[1,0,1] neg_lo:[1,0,0]
    v_pk_fma_f32 v[38:39], v[94:95], v[38:39], v[62:63] op_sel:[1,1,0] op_sel_hi:[1,0,1] neg_lo:[1,0,0]
    v_pk_mul_f32 v[40:41], v[96:97], v[32:33] op_sel:[0,0] op_sel_hi:[0,1]
    v_pk_mul_f32 v[42:43], v[98:99], v[34:35] op_sel:[0,0] op_sel_hi:[0,1]
    v_pk_mul_f32 v[44:45], v[100:101], v[36:37] op_sel:[0,0] op_sel_hi:[0,1]
    v_pk_mul_f32 v[46:47], v[102:103], v[38:39] op_sel:[0,0] op_sel_hi:[0,1]
    v_pk_fma_f32 v[80:81], v[96:97], v[32:33], v[40:41] op_sel:[1,1,0] op_sel_hi:[1,0,1] neg_lo:[1,0,0] neg_hi:[1,0,1]
    v_pk_fma_f32 v[82:83], v[98:99], v[34:35], v[42:43] op_sel:[1,1,0] op_sel_hi:[1,0,1] neg_lo:[1,0,0] neg_hi:[1,0,1]
    v_pk_fma_f32 v[84:85], v[100:101], v[36:37], v[44:45] op_sel:[1,1,0] op_sel_hi:[1,0,1] neg_lo:[1,0,0] neg_hi:[1,0,1]
    v_pk_fma_f32 v[86:87], v[102:103], v[38:39], v[46:47] op_sel:[1,1,0] op_sel_hi:[1,0,1] neg_lo:[1,0,0] neg_hi:[1,0,1]
    v_cvt_pk_bf16_f32 v129, v72, v80
    v_cvt_pk_bf16_f32 v137, v74, v82
    v_cvt_pk_bf16_f32 v145, v76, v84
    v_cvt_pk_bf16_f32 v153, v78, v86
    v_cvt_pk_bf16_f32 v193, v73, v81
    v_cvt_pk_bf16_f32 v201, v75, v83
    v_cvt_pk_bf16_f32 v209, v77, v85
    v_cvt_pk_bf16_f32 v217, v79, v87
    v_accvgpr_read_b32 v64, a32
    v_accvgpr_read_b32 v66, a36
    v_accvgpr_read_b32 v68, a40
    v_accvgpr_read_b32 v70, a44
    v_accvgpr_read_b32 v65, a48
    v_accvgpr_read_b32 v67, a52
    v_accvgpr_read_b32 v69, a56
    v_accvgpr_read_b32 v71, a60
    v_pk_fma_f32 v[56:57], v[88:89], v[32:33], v[64:65] op_sel:[0,0,0] op_sel_hi:[0,1,1]
    v_pk_fma_f32 v[58:59], v[90:91], v[34:35], v[66:67] op_sel:[0,0,0] op_sel_hi:[0,1,1]
    v_pk_fma_f32 v[60:61], v[92:93], v[36:37], v[68:69] op_sel:[0,0,0] op_sel_hi:[0,1,1]
    v_pk_fma_f32 v[62:63], v[94:95], v[38:39], v[70:71] op_sel:[0,0,0] op_sel_hi:[0,1,1]
    v_pk_fma_f32 v[32:33], v[88:89], v[32:33], v[56:57] op_sel:[1,1,0] op_sel_hi:[1,0,1] neg_lo:[1,0,0]
    v_pk_fma_f32 v[34:35], v[90:91], v[34:35], v[58:59] op_sel:[1,1,0] op_sel_hi:[1,0,1] neg_lo:[1,0,0]
    v_pk_fma_f32 v[36:37], v[92:93], v[36:37], v[60:61] op_sel:[1,1,0] op_sel_hi:[1,0,1] neg_lo:[1,0,0]
    v_pk_fma_f32 v[38:39], v[94:95], v[38:39], v[62:63] op_sel:[1,1,0] op_sel_hi:[1,0,1] neg_lo:[1,0,0]
    v_pk_mul_f32 v[40:41], v[96:97], v[32:33] op_sel:[0,0] op_sel_hi:[0,1]
    v_pk_mul_f32 v[42:43], v[98:99], v[34:35] op_sel:[0,0] op_sel_hi:[0,1]
    v_pk_mul_f32 v[44:45], v[100:101], v[36:37] op_sel:[0,0] op_sel_hi:[0,1]
    v_pk_mul_f32 v[46:47], v[102:103], v[38:39] op_sel:[0,0] op_sel_hi:[0,1]
    v_pk_fma_f32 v[72:73], v[96:97], v[32:33], v[40:41] op_sel:[1,1,0] op_sel_hi:[1,0,1] neg_lo:[1,0,0] neg_hi:[1,0,1]
    v_pk_fma_f32 v[74:75], v[98:99], v[34:35], v[42:43] op_sel:[1,1,0] op_sel_hi:[1,0,1] neg_lo:[1,0,0] neg_hi:[1,0,1]
    v_pk_fma_f32 v[76:77], v[100:101], v[36:37], v[44:45] op_sel:[1,1,0] op_sel_hi:[1,0,1] neg_lo:[1,0,0] neg_hi:[1,0,1]
    v_pk_fma_f32 v[78:79], v[102:103], v[38:39], v[46:47] op_sel:[1,1,0] op_sel_hi:[1,0,1] neg_lo:[1,0,0] neg_hi:[1,0,1]
    v_accvgpr_read_b32 v48, a33
    v_accvgpr_read_b32 v50, a37
    v_accvgpr_read_b32 v52, a41
    v_accvgpr_read_b32 v54, a45
    v_accvgpr_read_b32 v49, a49
    v_accvgpr_read_b32 v51, a53
    v_accvgpr_read_b32 v53, a57
    v_accvgpr_read_b32 v55, a61
    v_pk_fma_f32 v[56:57], v[88:89], v[32:33], v[48:49] op_sel:[0,0,0] op_sel_hi:[0,1,1]
    v_pk_fma_f32 v[58:59], v[90:91], v[34:35], v[50:51] op_sel:[0,0,0] op_sel_hi:[0,1,1]
    v_pk_fma_f32 v[60:61], v[92:93], v[36:37], v[52:53] op_sel:[0,0,0] op_sel_hi:[0,1,1]
    v_pk_fma_f32 v[62:63], v[94:95], v[38:39], v[54:55] op_sel:[0,0,0] op_sel_hi:[0,1,1]
    v_pk_fma_f32 v[32:33], v[88:89], v[32:33], v[56:57] op_sel:[1,1,0] op_sel_hi:[1,0,1] neg_lo:[1,0,0]
    v_pk_fma_f32 v[34:35], v[90:91], v[34:35], v[58:59] op_sel:[1,1,0] op_sel_hi:[1,0,1] neg_lo:[1,0,0]
    v_pk_fma_f32 v[36:37], v[92:93], v[36:37], v[60:61] op_sel:[1,1,0] op_sel_hi:[1,0,1] neg_lo:[1,0,0]
    v_pk_fma_f32 v[38:39], v[94:95], v[38:39], v[62:63] op_sel:[1,1,0] op_sel_hi:[1,0,1] neg_lo:[1,0,0]
    v_pk_mul_f32 v[40:41], v[96:97], v[32:33] op_sel:[0,0] op_sel_hi:[0,1]
    v_pk_mul_f32 v[42:43], v[98:99], v[34:35] op_sel:[0,0] op_sel_hi:[0,1]
    v_pk_mul_f32 v[44:45], v[100:101], v[36:37] op_sel:[0,0] op_sel_hi:[0,1]
    v_pk_mul_f32 v[46:47], v[102:103], v[38:39] op_sel:[0,0] op_sel_hi:[0,1]
    v_pk_fma_f32 v[80:81], v[96:97], v[32:33], v[40:41] op_sel:[1,1,0] op_sel_hi:[1,0,1] neg_lo:[1,0,0] neg_hi:[1,0,1]
    v_pk_fma_f32 v[82:83], v[98:99], v[34:35], v[42:43] op_sel:[1,1,0] op_sel_hi:[1,0,1] neg_lo:[1,0,0] neg_hi:[1,0,1]
    v_pk_fma_f32 v[84:85], v[100:101], v[36:37], v[44:45] op_sel:[1,1,0] op_sel_hi:[1,0,1] neg_lo:[1,0,0] neg_hi:[1,0,1]
    v_pk_fma_f32 v[86:87], v[102:103], v[38:39], v[46:47] op_sel:[1,1,0] op_sel_hi:[1,0,1] neg_lo:[1,0,0] neg_hi:[1,0,1]
    v_cvt_pk_bf16_f32 v130, v72, v80
    v_cvt_pk_bf16_f32 v138, v74, v82
    v_cvt_pk_bf16_f32 v146, v76, v84
    v_cvt_pk_bf16_f32 v154, v78, v86
    v_cvt_pk_bf16_f32 v194, v73, v81
    v_cvt_pk_bf16_f32 v202, v75, v83
    v_cvt_pk_bf16_f32 v210, v77, v85
    v_cvt_pk_bf16_f32 v218, v79, v87
    v_accvgpr_read_b32 v64, a34
    v_accvgpr_read_b32 v66, a38
    v_accvgpr_read_b32 v68, a42
    v_accvgpr_read_b32 v70, a46
    v_accvgpr_read_b32 v65, a50
    v_accvgpr_read_b32 v67, a54
    v_accvgpr_read_b32 v69, a58
    v_accvgpr_read_b32 v71, a62
    v_pk_fma_f32 v[56:57], v[88:89], v[32:33], v[64:65] op_sel:[0,0,0] op_sel_hi:[0,1,1]
    v_pk_fma_f32 v[58:59], v[90:91], v[34:35], v[66:67] op_sel:[0,0,0] op_sel_hi:[0,1,1]
    v_pk_fma_f32 v[60:61], v[92:93], v[36:37], v[68:69] op_sel:[0,0,0] op_sel_hi:[0,1,1]
    v_pk_fma_f32 v[62:63], v[94:95], v[38:39], v[70:71] op_sel:[0,0,0] op_sel_hi:[0,1,1]
    v_pk_fma_f32 v[32:33], v[88:89], v[32:33], v[56:57] op_sel:[1,1,0] op_sel_hi:[1,0,1] neg_lo:[1,0,0]
    v_pk_fma_f32 v[34:35], v[90:91], v[34:35], v[58:59] op_sel:[1,1,0] op_sel_hi:[1,0,1] neg_lo:[1,0,0]
    v_pk_fma_f32 v[36:37], v[92:93], v[36:37], v[60:61] op_sel:[1,1,0] op_sel_hi:[1,0,1] neg_lo:[1,0,0]
    v_pk_fma_f32 v[38:39], v[94:95], v[38:39], v[62:63] op_sel:[1,1,0] op_sel_hi:[1,0,1] neg_lo:[1,0,0]
    v_pk_mul_f32 v[40:41], v[96:97], v[32:33] op_sel:[0,0] op_sel_hi:[0,1]
    v_pk_mul_f32 v[42:43], v[98:99], v[34:35] op_sel:[0,0] op_sel_hi:[0,1]
    v_pk_mul_f32 v[44:45], v[100:101], v[36:37] op_sel:[0,0] op_sel_hi:[0,1]
    v_pk_mul_f32 v[46:47], v[102:103], v[38:39] op_sel:[0,0] op_sel_hi:[0,1]
    v_pk_fma_f32 v[72:73], v[96:97], v[32:33], v[40:41] op_sel:[1,1,0] op_sel_hi:[1,0,1] neg_lo:[1,0,0] neg_hi:[1,0,1]
    v_pk_fma_f32 v[74:75], v[98:99], v[34:35], v[42:43] op_sel:[1,1,0] op_sel_hi:[1,0,1] neg_lo:[1,0,0] neg_hi:[1,0,1]
    v_pk_fma_f32 v[76:77], v[100:101], v[36:37], v[44:45] op_sel:[1,1,0] op_sel_hi:[1,0,1] neg_lo:[1,0,0] neg_hi:[1,0,1]
    v_pk_fma_f32 v[78:79], v[102:103], v[38:39], v[46:47] op_sel:[1,1,0] op_sel_hi:[1,0,1] neg_lo:[1,0,0] neg_hi:[1,0,1]
    v_accvgpr_read_b32 v48, a35
    v_accvgpr_read_b32 v50, a39
    v_accvgpr_read_b32 v52, a43
    v_accvgpr_read_b32 v54, a47
    v_accvgpr_read_b32 v49, a51
    v_accvgpr_read_b32 v51, a55
    v_accvgpr_read_b32 v53, a59
    v_accvgpr_read_b32 v55, a63
    v_pk_fma_f32 v[56:57], v[88:89], v[32:33], v[48:49] op_sel:[0,0,0] op_sel_hi:[0,1,1]
    v_pk_fma_f32 v[58:59], v[90:91], v[34:35], v[50:51] op_sel:[0,0,0] op_sel_hi:[0,1,1]
    v_pk_fma_f32 v[60:61], v[92:93], v[36:37], v[52:53] op_sel:[0,0,0] op_sel_hi:[0,1,1]
    v_pk_fma_f32 v[62:63], v[94:95], v[38:39], v[54:55] op_sel:[0,0,0] op_sel_hi:[0,1,1]
    v_pk_fma_f32 v[32:33], v[88:89], v[32:33], v[56:57] op_sel:[1,1,0] op_sel_hi:[1,0,1] neg_lo:[1,0,0]
    v_pk_fma_f32 v[34:35], v[90:91], v[34:35], v[58:59] op_sel:[1,1,0] op_sel_hi:[1,0,1] neg_lo:[1,0,0]
    v_pk_fma_f32 v[36:37], v[92:93], v[36:37], v[60:61] op_sel:[1,1,0] op_sel_hi:[1,0,1] neg_lo:[1,0,0]
    v_pk_fma_f32 v[38:39], v[94:95], v[38:39], v[62:63] op_sel:[1,1,0] op_sel_hi:[1,0,1] neg_lo:[1,0,0]
    v_pk_mul_f32 v[40:41], v[96:97], v[32:33] op_sel:[0,0] op_sel_hi:[0,1]
    v_pk_mul_f32 v[42:43], v[98:99], v[34:35] op_sel:[0,0] op_sel_hi:[0,1]
    v_pk_mul_f32 v[44:45], v[100:101], v[36:37] op_sel:[0,0] op_sel_hi:[0,1]
    v_pk_mul_f32 v[46:47], v[102:103], v[38:39] op_sel:[0,0] op_sel_hi:[0,1]
    v_pk_fma_f32 v[80:81], v[96:97], v[32:33], v[40:41] op_sel:[1,1,0] op_sel_hi:[1,0,1] neg_lo:[1,0,0] neg_hi:[1,0,1]
    v_pk_fma_f32 v[82:83], v[98:99], v[34:35], v[42:43] op_sel:[1,1,0] op_sel_hi:[1,0,1] neg_lo:[1,0,0] neg_hi:[1,0,1]
    v_pk_fma_f32 v[84:85], v[100:101], v[36:37], v[44:45] op_sel:[1,1,0] op_sel_hi:[1,0,1] neg_lo:[1,0,0] neg_hi:[1,0,1]
    v_pk_fma_f32 v[86:87], v[102:103], v[38:39], v[46:47] op_sel:[1,1,0] op_sel_hi:[1,0,1] neg_lo:[1,0,0] neg_hi:[1,0,1]
    v_cvt_pk_bf16_f32 v131, v72, v80
    v_cvt_pk_bf16_f32 v139, v74, v82
    v_cvt_pk_bf16_f32 v147, v76, v84
    v_cvt_pk_bf16_f32 v155, v78, v86
    v_cvt_pk_bf16_f32 v195, v73, v81
    v_cvt_pk_bf16_f32 v203, v75, v83
    v_cvt_pk_bf16_f32 v211, v77, v85
    v_cvt_pk_bf16_f32 v219, v79, v87
    v_accvgpr_read_b32 v64, a64
    v_accvgpr_read_b32 v66, a68
    v_accvgpr_read_b32 v68, a72
    v_accvgpr_read_b32 v70, a76
    v_accvgpr_read_b32 v65, a80
    v_accvgpr_read_b32 v67, a84
    v_accvgpr_read_b32 v69, a88
    v_accvgpr_read_b32 v71, a92
    v_pk_fma_f32 v[56:57], v[88:89], v[32:33], v[64:65] op_sel:[0,0,0] op_sel_hi:[0,1,1]
    v_pk_fma_f32 v[58:59], v[90:91], v[34:35], v[66:67] op_sel:[0,0,0] op_sel_hi:[0,1,1]
    v_pk_fma_f32 v[60:61], v[92:93], v[36:37], v[68:69] op_sel:[0,0,0] op_sel_hi:[0,1,1]
    v_pk_fma_f32 v[62:63], v[94:95], v[38:39], v[70:71] op_sel:[0,0,0] op_sel_hi:[0,1,1]
    v_pk_fma_f32 v[32:33], v[88:89], v[32:33], v[56:57] op_sel:[1,1,0] op_sel_hi:[1,0,1] neg_lo:[1,0,0]
    v_pk_fma_f32 v[34:35], v[90:91], v[34:35], v[58:59] op_sel:[1,1,0] op_sel_hi:[1,0,1] neg_lo:[1,0,0]
    v_pk_fma_f32 v[36:37], v[92:93], v[36:37], v[60:61] op_sel:[1,1,0] op_sel_hi:[1,0,1] neg_lo:[1,0,0]
    v_pk_fma_f32 v[38:39], v[94:95], v[38:39], v[62:63] op_sel:[1,1,0] op_sel_hi:[1,0,1] neg_lo:[1,0,0]
    v_pk_mul_f32 v[40:41], v[96:97], v[32:33] op_sel:[0,0] op_sel_hi:[0,1]
    v_pk_mul_f32 v[42:43], v[98:99], v[34:35] op_sel:[0,0] op_sel_hi:[0,1]
    v_pk_mul_f32 v[44:45], v[100:101], v[36:37] op_sel:[0,0] op_sel_hi:[0,1]
    v_pk_mul_f32 v[46:47], v[102:103], v[38:39] op_sel:[0,0] op_sel_hi:[0,1]
    v_pk_fma_f32 v[72:73], v[96:97], v[32:33], v[40:41] op_sel:[1,1,0] op_sel_hi:[1,0,1] neg_lo:[1,0,0] neg_hi:[1,0,1]
    v_pk_fma_f32 v[74:75], v[98:99], v[34:35], v[42:43] op_sel:[1,1,0] op_sel_hi:[1,0,1] neg_lo:[1,0,0] neg_hi:[1,0,1]
    v_pk_fma_f32 v[76:77], v[100:101], v[36:37], v[44:45] op_sel:[1,1,0] op_sel_hi:[1,0,1] neg_lo:[1,0,0] neg_hi:[1,0,1]
    v_pk_fma_f32 v[78:79], v[102:103], v[38:39], v[46:47] op_sel:[1,1,0] op_sel_hi:[1,0,1] neg_lo:[1,0,0] neg_hi:[1,0,1]
    v_accvgpr_read_b32 v48, a65
    v_accvgpr_read_b32 v50, a69
    v_accvgpr_read_b32 v52, a73
    v_accvgpr_read_b32 v54, a77
    v_accvgpr_read_b32 v49, a81
    v_accvgpr_read_b32 v51, a85
    v_accvgpr_read_b32 v53, a89
    v_accvgpr_read_b32 v55, a93
    v_pk_fma_f32 v[56:57], v[88:89], v[32:33], v[48:49] op_sel:[0,0,0] op_sel_hi:[0,1,1]
    v_pk_fma_f32 v[58:59], v[90:91], v[34:35], v[50:51] op_sel:[0,0,0] op_sel_hi:[0,1,1]
    v_pk_fma_f32 v[60:61], v[92:93], v[36:37], v[52:53] op_sel:[0,0,0] op_sel_hi:[0,1,1]
    v_pk_fma_f32 v[62:63], v[94:95], v[38:39], v[54:55] op_sel:[0,0,0] op_sel_hi:[0,1,1]
    v_pk_fma_f32 v[32:33], v[88:89], v[32:33], v[56:57] op_sel:[1,1,0] op_sel_hi:[1,0,1] neg_lo:[1,0,0]
    v_pk_fma_f32 v[34:35], v[90:91], v[34:35], v[58:59] op_sel:[1,1,0] op_sel_hi:[1,0,1] neg_lo:[1,0,0]
    v_pk_fma_f32 v[36:37], v[92:93], v[36:37], v[60:61] op_sel:[1,1,0] op_sel_hi:[1,0,1] neg_lo:[1,0,0]
    v_pk_fma_f32 v[38:39], v[94:95], v[38:39], v[62:63] op_sel:[1,1,0] op_sel_hi:[1,0,1] neg_lo:[1,0,0]
    v_pk_mul_f32 v[40:41], v[96:97], v[32:33] op_sel:[0,0] op_sel_hi:[0,1]
    v_pk_mul_f32 v[42:43], v[98:99], v[34:35] op_sel:[0,0] op_sel_hi:[0,1]
    v_pk_mul_f32 v[44:45], v[100:101], v[36:37] op_sel:[0,0] op_sel_hi:[0,1]
    v_pk_mul_f32 v[46:47], v[102:103], v[38:39] op_sel:[0,0] op_sel_hi:[0,1]
    v_pk_fma_f32 v[80:81], v[96:97], v[32:33], v[40:41] op_sel:[1,1,0] op_sel_hi:[1,0,1] neg_lo:[1,0,0] neg_hi:[1,0,1]
    v_pk_fma_f32 v[82:83], v[98:99], v[34:35], v[42:43] op_sel:[1,1,0] op_sel_hi:[1,0,1] neg_lo:[1,0,0] neg_hi:[1,0,1]
    v_pk_fma_f32 v[84:85], v[100:101], v[36:37], v[44:45] op_sel:[1,1,0] op_sel_hi:[1,0,1] neg_lo:[1,0,0] neg_hi:[1,0,1]
    v_pk_fma_f32 v[86:87], v[102:103], v[38:39], v[46:47] op_sel:[1,1,0] op_sel_hi:[1,0,1] neg_lo:[1,0,0] neg_hi:[1,0,1]
    v_cvt_pk_bf16_f32 v132, v72, v80
    v_cvt_pk_bf16_f32 v140, v74, v82
    v_cvt_pk_bf16_f32 v148, v76, v84
    v_cvt_pk_bf16_f32 v156, v78, v86
    v_cvt_pk_bf16_f32 v196, v73, v81
    v_cvt_pk_bf16_f32 v204, v75, v83
    v_cvt_pk_bf16_f32 v212, v77, v85
    v_cvt_pk_bf16_f32 v220, v79, v87
    v_accvgpr_read_b32 v64, a66
    v_accvgpr_read_b32 v66, a70
    v_accvgpr_read_b32 v68, a74
    v_accvgpr_read_b32 v70, a78
    v_accvgpr_read_b32 v65, a82
    v_accvgpr_read_b32 v67, a86
    v_accvgpr_read_b32 v69, a90
    v_accvgpr_read_b32 v71, a94
    v_pk_fma_f32 v[56:57], v[88:89], v[32:33], v[64:65] op_sel:[0,0,0] op_sel_hi:[0,1,1]
    v_pk_fma_f32 v[58:59], v[90:91], v[34:35], v[66:67] op_sel:[0,0,0] op_sel_hi:[0,1,1]
    v_pk_fma_f32 v[60:61], v[92:93], v[36:37], v[68:69] op_sel:[0,0,0] op_sel_hi:[0,1,1]
    v_pk_fma_f32 v[62:63], v[94:95], v[38:39], v[70:71] op_sel:[0,0,0] op_sel_hi:[0,1,1]
    v_pk_fma_f32 v[32:33], v[88:89], v[32:33], v[56:57] op_sel:[1,1,0] op_sel_hi:[1,0,1] neg_lo:[1,0,0]
    v_pk_fma_f32 v[34:35], v[90:91], v[34:35], v[58:59] op_sel:[1,1,0] op_sel_hi:[1,0,1] neg_lo:[1,0,0]
    v_pk_fma_f32 v[36:37], v[92:93], v[36:37], v[60:61] op_sel:[1,1,0] op_sel_hi:[1,0,1] neg_lo:[1,0,0]
    v_pk_fma_f32 v[38:39], v[94:95], v[38:39], v[62:63] op_sel:[1,1,0] op_sel_hi:[1,0,1] neg_lo:[1,0,0]
    v_pk_mul_f32 v[40:41], v[96:97], v[32:33] op_sel:[0,0] op_sel_hi:[0,1]
    v_pk_mul_f32 v[42:43], v[98:99], v[34:35] op_sel:[0,0] op_sel_hi:[0,1]
    v_pk_mul_f32 v[44:45], v[100:101], v[36:37] op_sel:[0,0] op_sel_hi:[0,1]
    v_pk_mul_f32 v[46:47], v[102:103], v[38:39] op_sel:[0,0] op_sel_hi:[0,1]
    v_pk_fma_f32 v[72:73], v[96:97], v[32:33], v[40:41] op_sel:[1,1,0] op_sel_hi:[1,0,1] neg_lo:[1,0,0] neg_hi:[1,0,1]
    v_pk_fma_f32 v[74:75], v[98:99], v[34:35], v[42:43] op_sel:[1,1,0] op_sel_hi:[1,0,1] neg_lo:[1,0,0] neg_hi:[1,0,1]
    v_pk_fma_f32 v[76:77], v[100:101], v[36:37], v[44:45] op_sel:[1,1,0] op_sel_hi:[1,0,1] neg_lo:[1,0,0] neg_hi:[1,0,1]
    v_pk_fma_f32 v[78:79], v[102:103], v[38:39], v[46:47] op_sel:[1,1,0] op_sel_hi:[1,0,1] neg_lo:[1,0,0] neg_hi:[1,0,1]
    v_accvgpr_read_b32 v48, a67
    v_accvgpr_read_b32 v50, a71
    v_accvgpr_read_b32 v52, a75
    v_accvgpr_read_b32 v54, a79
    v_accvgpr_read_b32 v49, a83
    v_accvgpr_read_b32 v51, a87
    v_accvgpr_read_b32 v53, a91
    v_accvgpr_read_b32 v55, a95
    v_pk_fma_f32 v[56:57], v[88:89], v[32:33], v[48:49] op_sel:[0,0,0] op_sel_hi:[0,1,1]
    v_pk_fma_f32 v[58:59], v[90:91], v[34:35], v[50:51] op_sel:[0,0,0] op_sel_hi:[0,1,1]
    v_pk_fma_f32 v[60:61], v[92:93], v[36:37], v[52:53] op_sel:[0,0,0] op_sel_hi:[0,1,1]
    v_pk_fma_f32 v[62:63], v[94:95], v[38:39], v[54:55] op_sel:[0,0,0] op_sel_hi:[0,1,1]
    v_pk_fma_f32 v[32:33], v[88:89], v[32:33], v[56:57] op_sel:[1,1,0] op_sel_hi:[1,0,1] neg_lo:[1,0,0]
    v_pk_fma_f32 v[34:35], v[90:91], v[34:35], v[58:59] op_sel:[1,1,0] op_sel_hi:[1,0,1] neg_lo:[1,0,0]
    v_pk_fma_f32 v[36:37], v[92:93], v[36:37], v[60:61] op_sel:[1,1,0] op_sel_hi:[1,0,1] neg_lo:[1,0,0]
    v_pk_fma_f32 v[38:39], v[94:95], v[38:39], v[62:63] op_sel:[1,1,0] op_sel_hi:[1,0,1] neg_lo:[1,0,0]
    v_pk_mul_f32 v[40:41], v[96:97], v[32:33] op_sel:[0,0] op_sel_hi:[0,1]
    v_pk_mul_f32 v[42:43], v[98:99], v[34:35] op_sel:[0,0] op_sel_hi:[0,1]
    v_pk_mul_f32 v[44:45], v[100:101], v[36:37] op_sel:[0,0] op_sel_hi:[0,1]
    v_pk_mul_f32 v[46:47], v[102:103], v[38:39] op_sel:[0,0] op_sel_hi:[0,1]
    v_pk_fma_f32 v[80:81], v[96:97], v[32:33], v[40:41] op_sel:[1,1,0] op_sel_hi:[1,0,1] neg_lo:[1,0,0] neg_hi:[1,0,1]
    v_pk_fma_f32 v[82:83], v[98:99], v[34:35], v[42:43] op_sel:[1,1,0] op_sel_hi:[1,0,1] neg_lo:[1,0,0] neg_hi:[1,0,1]
    v_pk_fma_f32 v[84:85], v[100:101], v[36:37], v[44:45] op_sel:[1,1,0] op_sel_hi:[1,0,1] neg_lo:[1,0,0] neg_hi:[1,0,1]
    v_pk_fma_f32 v[86:87], v[102:103], v[38:39], v[46:47] op_sel:[1,1,0] op_sel_hi:[1,0,1] neg_lo:[1,0,0] neg_hi:[1,0,1]
    v_cvt_pk_bf16_f32 v133, v72, v80
    v_cvt_pk_bf16_f32 v141, v74, v82
    v_cvt_pk_bf16_f32 v149, v76, v84
    v_cvt_pk_bf16_f32 v157, v78, v86
    v_cvt_pk_bf16_f32 v197, v73, v81
    v_cvt_pk_bf16_f32 v205, v75, v83
    v_cvt_pk_bf16_f32 v213, v77, v85
    v_cvt_pk_bf16_f32 v221, v79, v87
    v_accvgpr_read_b32 v64, a96
    v_accvgpr_read_b32 v66, a100
    v_accvgpr_read_b32 v68, a104
    v_accvgpr_read_b32 v70, a108
    v_accvgpr_read_b32 v65, a112
    v_accvgpr_read_b32 v67, a116
    v_accvgpr_read_b32 v69, a120
    v_accvgpr_read_b32 v71, a124
    v_pk_fma_f32 v[56:57], v[88:89], v[32:33], v[64:65] op_sel:[0,0,0] op_sel_hi:[0,1,1]
    v_pk_fma_f32 v[58:59], v[90:91], v[34:35], v[66:67] op_sel:[0,0,0] op_sel_hi:[0,1,1]
    v_pk_fma_f32 v[60:61], v[92:93], v[36:37], v[68:69] op_sel:[0,0,0] op_sel_hi:[0,1,1]
    v_pk_fma_f32 v[62:63], v[94:95], v[38:39], v[70:71] op_sel:[0,0,0] op_sel_hi:[0,1,1]
    v_pk_fma_f32 v[32:33], v[88:89], v[32:33], v[56:57] op_sel:[1,1,0] op_sel_hi:[1,0,1] neg_lo:[1,0,0]
    v_pk_fma_f32 v[34:35], v[90:91], v[34:35], v[58:59] op_sel:[1,1,0] op_sel_hi:[1,0,1] neg_lo:[1,0,0]
    v_pk_fma_f32 v[36:37], v[92:93], v[36:37], v[60:61] op_sel:[1,1,0] op_sel_hi:[1,0,1] neg_lo:[1,0,0]
    v_pk_fma_f32 v[38:39], v[94:95], v[38:39], v[62:63] op_sel:[1,1,0] op_sel_hi:[1,0,1] neg_lo:[1,0,0]
    v_pk_mul_f32 v[40:41], v[96:97], v[32:33] op_sel:[0,0] op_sel_hi:[0,1]
    v_pk_mul_f32 v[42:43], v[98:99], v[34:35] op_sel:[0,0] op_sel_hi:[0,1]
    v_pk_mul_f32 v[44:45], v[100:101], v[36:37] op_sel:[0,0] op_sel_hi:[0,1]
    v_pk_mul_f32 v[46:47], v[102:103], v[38:39] op_sel:[0,0] op_sel_hi:[0,1]
    v_pk_fma_f32 v[72:73], v[96:97], v[32:33], v[40:41] op_sel:[1,1,0] op_sel_hi:[1,0,1] neg_lo:[1,0,0] neg_hi:[1,0,1]
    v_pk_fma_f32 v[74:75], v[98:99], v[34:35], v[42:43] op_sel:[1,1,0] op_sel_hi:[1,0,1] neg_lo:[1,0,0] neg_hi:[1,0,1]
    v_pk_fma_f32 v[76:77], v[100:101], v[36:37], v[44:45] op_sel:[1,1,0] op_sel_hi:[1,0,1] neg_lo:[1,0,0] neg_hi:[1,0,1]
    v_pk_fma_f32 v[78:79], v[102:103], v[38:39], v[46:47] op_sel:[1,1,0] op_sel_hi:[1,0,1] neg_lo:[1,0,0] neg_hi:[1,0,1]
    v_accvgpr_read_b32 v48, a97
    v_accvgpr_read_b32 v50, a101
    v_accvgpr_read_b32 v52, a105
    v_accvgpr_read_b32 v54, a109
    v_accvgpr_read_b32 v49, a113
    v_accvgpr_read_b32 v51, a117
    v_accvgpr_read_b32 v53, a121
    v_accvgpr_read_b32 v55, a125
    v_pk_fma_f32 v[56:57], v[88:89], v[32:33], v[48:49] op_sel:[0,0,0] op_sel_hi:[0,1,1]
    v_pk_fma_f32 v[58:59], v[90:91], v[34:35], v[50:51] op_sel:[0,0,0] op_sel_hi:[0,1,1]
    v_pk_fma_f32 v[60:61], v[92:93], v[36:37], v[52:53] op_sel:[0,0,0] op_sel_hi:[0,1,1]
    v_pk_fma_f32 v[62:63], v[94:95], v[38:39], v[54:55] op_sel:[0,0,0] op_sel_hi:[0,1,1]
    v_pk_fma_f32 v[32:33], v[88:89], v[32:33], v[56:57] op_sel:[1,1,0] op_sel_hi:[1,0,1] neg_lo:[1,0,0]
    v_pk_fma_f32 v[34:35], v[90:91], v[34:35], v[58:59] op_sel:[1,1,0] op_sel_hi:[1,0,1] neg_lo:[1,0,0]
    v_pk_fma_f32 v[36:37], v[92:93], v[36:37], v[60:61] op_sel:[1,1,0] op_sel_hi:[1,0,1] neg_lo:[1,0,0]
    v_pk_fma_f32 v[38:39], v[94:95], v[38:39], v[62:63] op_sel:[1,1,0] op_sel_hi:[1,0,1] neg_lo:[1,0,0]
    v_pk_mul_f32 v[40:41], v[96:97], v[32:33] op_sel:[0,0] op_sel_hi:[0,1]
    v_pk_mul_f32 v[42:43], v[98:99], v[34:35] op_sel:[0,0] op_sel_hi:[0,1]
    v_pk_mul_f32 v[44:45], v[100:101], v[36:37] op_sel:[0,0] op_sel_hi:[0,1]
    v_pk_mul_f32 v[46:47], v[102:103], v[38:39] op_sel:[0,0] op_sel_hi:[0,1]
    v_pk_fma_f32 v[80:81], v[96:97], v[32:33], v[40:41] op_sel:[1,1,0] op_sel_hi:[1,0,1] neg_lo:[1,0,0] neg_hi:[1,0,1]
    v_pk_fma_f32 v[82:83], v[98:99], v[34:35], v[42:43] op_sel:[1,1,0] op_sel_hi:[1,0,1] neg_lo:[1,0,0] neg_hi:[1,0,1]
    v_pk_fma_f32 v[84:85], v[100:101], v[36:37], v[44:45] op_sel:[1,1,0] op_sel_hi:[1,0,1] neg_lo:[1,0,0] neg_hi:[1,0,1]
    v_pk_fma_f32 v[86:87], v[102:103], v[38:39], v[46:47] op_sel:[1,1,0] op_sel_hi:[1,0,1] neg_lo:[1,0,0] neg_hi:[1,0,1]
    v_cvt_pk_bf16_f32 v134, v72, v80
    v_cvt_pk_bf16_f32 v142, v74, v82
    v_cvt_pk_bf16_f32 v150, v76, v84
    v_cvt_pk_bf16_f32 v158, v78, v86
    v_cvt_pk_bf16_f32 v198, v73, v81
    v_cvt_pk_bf16_f32 v206, v75, v83
    v_cvt_pk_bf16_f32 v214, v77, v85
    v_cvt_pk_bf16_f32 v222, v79, v87
    v_accvgpr_read_b32 v64, a98
    v_accvgpr_read_b32 v66, a102
    v_accvgpr_read_b32 v68, a106
    v_accvgpr_read_b32 v70, a110
    v_accvgpr_read_b32 v65, a114
    v_accvgpr_read_b32 v67, a118
    v_accvgpr_read_b32 v69, a122
    v_accvgpr_read_b32 v71, a126
    v_pk_fma_f32 v[56:57], v[88:89], v[32:33], v[64:65] op_sel:[0,0,0] op_sel_hi:[0,1,1]
    v_pk_fma_f32 v[58:59], v[90:91], v[34:35], v[66:67] op_sel:[0,0,0] op_sel_hi:[0,1,1]
    v_pk_fma_f32 v[60:61], v[92:93], v[36:37], v[68:69] op_sel:[0,0,0] op_sel_hi:[0,1,1]
    v_pk_fma_f32 v[62:63], v[94:95], v[38:39], v[70:71] op_sel:[0,0,0] op_sel_hi:[0,1,1]
    v_pk_fma_f32 v[32:33], v[88:89], v[32:33], v[56:57] op_sel:[1,1,0] op_sel_hi:[1,0,1] neg_lo:[1,0,0]
    v_pk_fma_f32 v[34:35], v[90:91], v[34:35], v[58:59] op_sel:[1,1,0] op_sel_hi:[1,0,1] neg_lo:[1,0,0]
    v_pk_fma_f32 v[36:37], v[92:93], v[36:37], v[60:61] op_sel:[1,1,0] op_sel_hi:[1,0,1] neg_lo:[1,0,0]
    v_pk_fma_f32 v[38:39], v[94:95], v[38:39], v[62:63] op_sel:[1,1,0] op_sel_hi:[1,0,1] neg_lo:[1,0,0]
    v_pk_mul_f32 v[40:41], v[96:97], v[32:33] op_sel:[0,0] op_sel_hi:[0,1]
    v_pk_mul_f32 v[42:43], v[98:99], v[34:35] op_sel:[0,0] op_sel_hi:[0,1]
    v_pk_mul_f32 v[44:45], v[100:101], v[36:37] op_sel:[0,0] op_sel_hi:[0,1]
    v_pk_mul_f32 v[46:47], v[102:103], v[38:39] op_sel:[0,0] op_sel_hi:[0,1]
    v_pk_fma_f32 v[72:73], v[96:97], v[32:33], v[40:41] op_sel:[1,1,0] op_sel_hi:[1,0,1] neg_lo:[1,0,0] neg_hi:[1,0,1]
    v_pk_fma_f32 v[74:75], v[98:99], v[34:35], v[42:43] op_sel:[1,1,0] op_sel_hi:[1,0,1] neg_lo:[1,0,0] neg_hi:[1,0,1]
    v_pk_fma_f32 v[76:77], v[100:101], v[36:37], v[44:45] op_sel:[1,1,0] op_sel_hi:[1,0,1] neg_lo:[1,0,0] neg_hi:[1,0,1]
    v_pk_fma_f32 v[78:79], v[102:103], v[38:39], v[46:47] op_sel:[1,1,0] op_sel_hi:[1,0,1] neg_lo:[1,0,0] neg_hi:[1,0,1]
    v_accvgpr_read_b32 v48, a99
    v_accvgpr_read_b32 v50, a103
    v_accvgpr_read_b32 v52, a107
    v_accvgpr_read_b32 v54, a111
    v_accvgpr_read_b32 v49, a115
    v_accvgpr_read_b32 v51, a119
    v_accvgpr_read_b32 v53, a123
    v_accvgpr_read_b32 v55, a127
    v_pk_fma_f32 v[56:57], v[88:89], v[32:33], v[48:49] op_sel:[0,0,0] op_sel_hi:[0,1,1]
    v_pk_fma_f32 v[58:59], v[90:91], v[34:35], v[50:51] op_sel:[0,0,0] op_sel_hi:[0,1,1]
    v_pk_fma_f32 v[60:61], v[92:93], v[36:37], v[52:53] op_sel:[0,0,0] op_sel_hi:[0,1,1]
    v_pk_fma_f32 v[62:63], v[94:95], v[38:39], v[54:55] op_sel:[0,0,0] op_sel_hi:[0,1,1]
    v_pk_fma_f32 v[32:33], v[88:89], v[32:33], v[56:57] op_sel:[1,1,0] op_sel_hi:[1,0,1] neg_lo:[1,0,0]
    v_pk_fma_f32 v[34:35], v[90:91], v[34:35], v[58:59] op_sel:[1,1,0] op_sel_hi:[1,0,1] neg_lo:[1,0,0]
    v_pk_fma_f32 v[36:37], v[92:93], v[36:37], v[60:61] op_sel:[1,1,0] op_sel_hi:[1,0,1] neg_lo:[1,0,0]
    v_pk_fma_f32 v[38:39], v[94:95], v[38:39], v[62:63] op_sel:[1,1,0] op_sel_hi:[1,0,1] neg_lo:[1,0,0]
    v_pk_mul_f32 v[40:41], v[96:97], v[32:33] op_sel:[0,0] op_sel_hi:[0,1]
    v_pk_mul_f32 v[42:43], v[98:99], v[34:35] op_sel:[0,0] op_sel_hi:[0,1]
    v_pk_mul_f32 v[44:45], v[100:101], v[36:37] op_sel:[0,0] op_sel_hi:[0,1]
    v_pk_mul_f32 v[46:47], v[102:103], v[38:39] op_sel:[0,0] op_sel_hi:[0,1]
    v_pk_fma_f32 v[80:81], v[96:97], v[32:33], v[40:41] op_sel:[1,1,0] op_sel_hi:[1,0,1] neg_lo:[1,0,0] neg_hi:[1,0,1]
    v_pk_fma_f32 v[82:83], v[98:99], v[34:35], v[42:43] op_sel:[1,1,0] op_sel_hi:[1,0,1] neg_lo:[1,0,0] neg_hi:[1,0,1]
    v_pk_fma_f32 v[84:85], v[100:101], v[36:37], v[44:45] op_sel:[1,1,0] op_sel_hi:[1,0,1] neg_lo:[1,0,0] neg_hi:[1,0,1]
    v_pk_fma_f32 v[86:87], v[102:103], v[38:39], v[46:47] op_sel:[1,1,0] op_sel_hi:[1,0,1] neg_lo:[1,0,0] neg_hi:[1,0,1]
    v_cvt_pk_bf16_f32 v135, v72, v80
    v_cvt_pk_bf16_f32 v143, v74, v82
    v_cvt_pk_bf16_f32 v151, v76, v84
    v_cvt_pk_bf16_f32 v159, v78, v86
    v_cvt_pk_bf16_f32 v199, v73, v81
    v_cvt_pk_bf16_f32 v207, v75, v83
    v_cvt_pk_bf16_f32 v215, v77, v85
    v_cvt_pk_bf16_f32 v223, v79, v87
    v_accvgpr_read_b32 v64, a128
    v_accvgpr_read_b32 v66, a132
    v_accvgpr_read_b32 v68, a136
    v_accvgpr_read_b32 v70, a140
    v_accvgpr_read_b32 v65, a144
    v_accvgpr_read_b32 v67, a148
    v_accvgpr_read_b32 v69, a152
    v_accvgpr_read_b32 v71, a156
    v_pk_fma_f32 v[56:57], v[88:89], v[32:33], v[64:65] op_sel:[0,0,0] op_sel_hi:[0,1,1]
    v_pk_fma_f32 v[58:59], v[90:91], v[34:35], v[66:67] op_sel:[0,0,0] op_sel_hi:[0,1,1]
    v_pk_fma_f32 v[60:61], v[92:93], v[36:37], v[68:69] op_sel:[0,0,0] op_sel_hi:[0,1,1]
    v_pk_fma_f32 v[62:63], v[94:95], v[38:39], v[70:71] op_sel:[0,0,0] op_sel_hi:[0,1,1]
    v_pk_fma_f32 v[32:33], v[88:89], v[32:33], v[56:57] op_sel:[1,1,0] op_sel_hi:[1,0,1] neg_lo:[1,0,0]
    v_pk_fma_f32 v[34:35], v[90:91], v[34:35], v[58:59] op_sel:[1,1,0] op_sel_hi:[1,0,1] neg_lo:[1,0,0]
    v_pk_fma_f32 v[36:37], v[92:93], v[36:37], v[60:61] op_sel:[1,1,0] op_sel_hi:[1,0,1] neg_lo:[1,0,0]
    v_pk_fma_f32 v[38:39], v[94:95], v[38:39], v[62:63] op_sel:[1,1,0] op_sel_hi:[1,0,1] neg_lo:[1,0,0]
    v_pk_mul_f32 v[40:41], v[96:97], v[32:33] op_sel:[0,0] op_sel_hi:[0,1]
    v_pk_mul_f32 v[42:43], v[98:99], v[34:35] op_sel:[0,0] op_sel_hi:[0,1]
    v_pk_mul_f32 v[44:45], v[100:101], v[36:37] op_sel:[0,0] op_sel_hi:[0,1]
    v_pk_mul_f32 v[46:47], v[102:103], v[38:39] op_sel:[0,0] op_sel_hi:[0,1]
    v_pk_fma_f32 v[72:73], v[96:97], v[32:33], v[40:41] op_sel:[1,1,0] op_sel_hi:[1,0,1] neg_lo:[1,0,0] neg_hi:[1,0,1]
    v_pk_fma_f32 v[74:75], v[98:99], v[34:35], v[42:43] op_sel:[1,1,0] op_sel_hi:[1,0,1] neg_lo:[1,0,0] neg_hi:[1,0,1]
    v_pk_fma_f32 v[76:77], v[100:101], v[36:37], v[44:45] op_sel:[1,1,0] op_sel_hi:[1,0,1] neg_lo:[1,0,0] neg_hi:[1,0,1]
    v_pk_fma_f32 v[78:79], v[102:103], v[38:39], v[46:47] op_sel:[1,1,0] op_sel_hi:[1,0,1] neg_lo:[1,0,0] neg_hi:[1,0,1]
    v_accvgpr_read_b32 v48, a129
    v_accvgpr_read_b32 v50, a133
    v_accvgpr_read_b32 v52, a137
    v_accvgpr_read_b32 v54, a141
    v_accvgpr_read_b32 v49, a145
    v_accvgpr_read_b32 v51, a149
    v_accvgpr_read_b32 v53, a153
    v_accvgpr_read_b32 v55, a157
    v_pk_fma_f32 v[56:57], v[88:89], v[32:33], v[48:49] op_sel:[0,0,0] op_sel_hi:[0,1,1]
    v_pk_fma_f32 v[58:59], v[90:91], v[34:35], v[50:51] op_sel:[0,0,0] op_sel_hi:[0,1,1]
    v_pk_fma_f32 v[60:61], v[92:93], v[36:37], v[52:53] op_sel:[0,0,0] op_sel_hi:[0,1,1]
    v_pk_fma_f32 v[62:63], v[94:95], v[38:39], v[54:55] op_sel:[0,0,0] op_sel_hi:[0,1,1]
    v_pk_fma_f32 v[32:33], v[88:89], v[32:33], v[56:57] op_sel:[1,1,0] op_sel_hi:[1,0,1] neg_lo:[1,0,0]
    v_pk_fma_f32 v[34:35], v[90:91], v[34:35], v[58:59] op_sel:[1,1,0] op_sel_hi:[1,0,1] neg_lo:[1,0,0]
    v_pk_fma_f32 v[36:37], v[92:93], v[36:37], v[60:61] op_sel:[1,1,0] op_sel_hi:[1,0,1] neg_lo:[1,0,0]
    v_pk_fma_f32 v[38:39], v[94:95], v[38:39], v[62:63] op_sel:[1,1,0] op_sel_hi:[1,0,1] neg_lo:[1,0,0]
    v_pk_mul_f32 v[40:41], v[96:97], v[32:33] op_sel:[0,0] op_sel_hi:[0,1]
    v_pk_mul_f32 v[42:43], v[98:99], v[34:35] op_sel:[0,0] op_sel_hi:[0,1]
    v_pk_mul_f32 v[44:45], v[100:101], v[36:37] op_sel:[0,0] op_sel_hi:[0,1]
    v_pk_mul_f32 v[46:47], v[102:103], v[38:39] op_sel:[0,0] op_sel_hi:[0,1]
    v_pk_fma_f32 v[80:81], v[96:97], v[32:33], v[40:41] op_sel:[1,1,0] op_sel_hi:[1,0,1] neg_lo:[1,0,0] neg_hi:[1,0,1]
    v_pk_fma_f32 v[82:83], v[98:99], v[34:35], v[42:43] op_sel:[1,1,0] op_sel_hi:[1,0,1] neg_lo:[1,0,0] neg_hi:[1,0,1]
    v_pk_fma_f32 v[84:85], v[100:101], v[36:37], v[44:45] op_sel:[1,1,0] op_sel_hi:[1,0,1] neg_lo:[1,0,0] neg_hi:[1,0,1]
    v_pk_fma_f32 v[86:87], v[102:103], v[38:39], v[46:47] op_sel:[1,1,0] op_sel_hi:[1,0,1] neg_lo:[1,0,0] neg_hi:[1,0,1]
    v_cvt_pk_bf16_f32 v160, v72, v80
    v_cvt_pk_bf16_f32 v168, v74, v82
    v_cvt_pk_bf16_f32 v176, v76, v84
    v_cvt_pk_bf16_f32 v184, v78, v86
    v_cvt_pk_bf16_f32 v224, v73, v81
    v_cvt_pk_bf16_f32 v232, v75, v83
    v_cvt_pk_bf16_f32 v240, v77, v85
    v_cvt_pk_bf16_f32 v248, v79, v87
    v_accvgpr_read_b32 v64, a130
    v_accvgpr_read_b32 v66, a134
    v_accvgpr_read_b32 v68, a138
    v_accvgpr_read_b32 v70, a142
    v_accvgpr_read_b32 v65, a146
    v_accvgpr_read_b32 v67, a150
    v_accvgpr_read_b32 v69, a154
    v_accvgpr_read_b32 v71, a158
    v_pk_fma_f32 v[56:57], v[88:89], v[32:33], v[64:65] op_sel:[0,0,0] op_sel_hi:[0,1,1]
    v_pk_fma_f32 v[58:59], v[90:91], v[34:35], v[66:67] op_sel:[0,0,0] op_sel_hi:[0,1,1]
    v_pk_fma_f32 v[60:61], v[92:93], v[36:37], v[68:69] op_sel:[0,0,0] op_sel_hi:[0,1,1]
    v_pk_fma_f32 v[62:63], v[94:95], v[38:39], v[70:71] op_sel:[0,0,0] op_sel_hi:[0,1,1]
    v_pk_fma_f32 v[32:33], v[88:89], v[32:33], v[56:57] op_sel:[1,1,0] op_sel_hi:[1,0,1] neg_lo:[1,0,0]
    v_pk_fma_f32 v[34:35], v[90:91], v[34:35], v[58:59] op_sel:[1,1,0] op_sel_hi:[1,0,1] neg_lo:[1,0,0]
    v_pk_fma_f32 v[36:37], v[92:93], v[36:37], v[60:61] op_sel:[1,1,0] op_sel_hi:[1,0,1] neg_lo:[1,0,0]
    v_pk_fma_f32 v[38:39], v[94:95], v[38:39], v[62:63] op_sel:[1,1,0] op_sel_hi:[1,0,1] neg_lo:[1,0,0]
    v_pk_mul_f32 v[40:41], v[96:97], v[32:33] op_sel:[0,0] op_sel_hi:[0,1]
    v_pk_mul_f32 v[42:43], v[98:99], v[34:35] op_sel:[0,0] op_sel_hi:[0,1]
    v_pk_mul_f32 v[44:45], v[100:101], v[36:37] op_sel:[0,0] op_sel_hi:[0,1]
    v_pk_mul_f32 v[46:47], v[102:103], v[38:39] op_sel:[0,0] op_sel_hi:[0,1]
    v_pk_fma_f32 v[72:73], v[96:97], v[32:33], v[40:41] op_sel:[1,1,0] op_sel_hi:[1,0,1] neg_lo:[1,0,0] neg_hi:[1,0,1]
    v_pk_fma_f32 v[74:75], v[98:99], v[34:35], v[42:43] op_sel:[1,1,0] op_sel_hi:[1,0,1] neg_lo:[1,0,0] neg_hi:[1,0,1]
    v_pk_fma_f32 v[76:77], v[100:101], v[36:37], v[44:45] op_sel:[1,1,0] op_sel_hi:[1,0,1] neg_lo:[1,0,0] neg_hi:[1,0,1]
    v_pk_fma_f32 v[78:79], v[102:103], v[38:39], v[46:47] op_sel:[1,1,0] op_sel_hi:[1,0,1] neg_lo:[1,0,0] neg_hi:[1,0,1]
    v_accvgpr_read_b32 v48, a131
    v_accvgpr_read_b32 v50, a135
    v_accvgpr_read_b32 v52, a139
    v_accvgpr_read_b32 v54, a143
    v_accvgpr_read_b32 v49, a147
    v_accvgpr_read_b32 v51, a151
    v_accvgpr_read_b32 v53, a155
    v_accvgpr_read_b32 v55, a159
    v_pk_fma_f32 v[56:57], v[88:89], v[32:33], v[48:49] op_sel:[0,0,0] op_sel_hi:[0,1,1]
    v_pk_fma_f32 v[58:59], v[90:91], v[34:35], v[50:51] op_sel:[0,0,0] op_sel_hi:[0,1,1]
    v_pk_fma_f32 v[60:61], v[92:93], v[36:37], v[52:53] op_sel:[0,0,0] op_sel_hi:[0,1,1]
    v_pk_fma_f32 v[62:63], v[94:95], v[38:39], v[54:55] op_sel:[0,0,0] op_sel_hi:[0,1,1]
    v_pk_fma_f32 v[32:33], v[88:89], v[32:33], v[56:57] op_sel:[1,1,0] op_sel_hi:[1,0,1] neg_lo:[1,0,0]
    v_pk_fma_f32 v[34:35], v[90:91], v[34:35], v[58:59] op_sel:[1,1,0] op_sel_hi:[1,0,1] neg_lo:[1,0,0]
    v_pk_fma_f32 v[36:37], v[92:93], v[36:37], v[60:61] op_sel:[1,1,0] op_sel_hi:[1,0,1] neg_lo:[1,0,0]
    v_pk_fma_f32 v[38:39], v[94:95], v[38:39], v[62:63] op_sel:[1,1,0] op_sel_hi:[1,0,1] neg_lo:[1,0,0]
    v_pk_mul_f32 v[40:41], v[96:97], v[32:33] op_sel:[0,0] op_sel_hi:[0,1]
    v_pk_mul_f32 v[42:43], v[98:99], v[34:35] op_sel:[0,0] op_sel_hi:[0,1]
    v_pk_mul_f32 v[44:45], v[100:101], v[36:37] op_sel:[0,0] op_sel_hi:[0,1]
    v_pk_mul_f32 v[46:47], v[102:103], v[38:39] op_sel:[0,0] op_sel_hi:[0,1]
    v_pk_fma_f32 v[80:81], v[96:97], v[32:33], v[40:41] op_sel:[1,1,0] op_sel_hi:[1,0,1] neg_lo:[1,0,0] neg_hi:[1,0,1]
    v_pk_fma_f32 v[82:83], v[98:99], v[34:35], v[42:43] op_sel:[1,1,0] op_sel_hi:[1,0,1] neg_lo:[1,0,0] neg_hi:[1,0,1]
    v_pk_fma_f32 v[84:85], v[100:101], v[36:37], v[44:45] op_sel:[1,1,0] op_sel_hi:[1,0,1] neg_lo:[1,0,0] neg_hi:[1,0,1]
    v_pk_fma_f32 v[86:87], v[102:103], v[38:39], v[46:47] op_sel:[1,1,0] op_sel_hi:[1,0,1] neg_lo:[1,0,0] neg_hi:[1,0,1]
    v_cvt_pk_bf16_f32 v161, v72, v80
    v_cvt_pk_bf16_f32 v169, v74, v82
    v_cvt_pk_bf16_f32 v177, v76, v84
    v_cvt_pk_bf16_f32 v185, v78, v86
    v_cvt_pk_bf16_f32 v225, v73, v81
    v_cvt_pk_bf16_f32 v233, v75, v83
    v_cvt_pk_bf16_f32 v241, v77, v85
    v_cvt_pk_bf16_f32 v249, v79, v87
    v_accvgpr_read_b32 v64, a160
    v_accvgpr_read_b32 v66, a164
    v_accvgpr_read_b32 v68, a168
    v_accvgpr_read_b32 v70, a172
    v_accvgpr_read_b32 v65, a176
    v_accvgpr_read_b32 v67, a180
    v_accvgpr_read_b32 v69, a184
    v_accvgpr_read_b32 v71, a188
    v_pk_fma_f32 v[56:57], v[88:89], v[32:33], v[64:65] op_sel:[0,0,0] op_sel_hi:[0,1,1]
    v_pk_fma_f32 v[58:59], v[90:91], v[34:35], v[66:67] op_sel:[0,0,0] op_sel_hi:[0,1,1]
    v_pk_fma_f32 v[60:61], v[92:93], v[36:37], v[68:69] op_sel:[0,0,0] op_sel_hi:[0,1,1]
    v_pk_fma_f32 v[62:63], v[94:95], v[38:39], v[70:71] op_sel:[0,0,0] op_sel_hi:[0,1,1]
    v_pk_fma_f32 v[32:33], v[88:89], v[32:33], v[56:57] op_sel:[1,1,0] op_sel_hi:[1,0,1] neg_lo:[1,0,0]
    v_pk_fma_f32 v[34:35], v[90:91], v[34:35], v[58:59] op_sel:[1,1,0] op_sel_hi:[1,0,1] neg_lo:[1,0,0]
    v_pk_fma_f32 v[36:37], v[92:93], v[36:37], v[60:61] op_sel:[1,1,0] op_sel_hi:[1,0,1] neg_lo:[1,0,0]
    v_pk_fma_f32 v[38:39], v[94:95], v[38:39], v[62:63] op_sel:[1,1,0] op_sel_hi:[1,0,1] neg_lo:[1,0,0]
    v_pk_mul_f32 v[40:41], v[96:97], v[32:33] op_sel:[0,0] op_sel_hi:[0,1]
    v_pk_mul_f32 v[42:43], v[98:99], v[34:35] op_sel:[0,0] op_sel_hi:[0,1]
    v_pk_mul_f32 v[44:45], v[100:101], v[36:37] op_sel:[0,0] op_sel_hi:[0,1]
    v_pk_mul_f32 v[46:47], v[102:103], v[38:39] op_sel:[0,0] op_sel_hi:[0,1]
    v_pk_fma_f32 v[72:73], v[96:97], v[32:33], v[40:41] op_sel:[1,1,0] op_sel_hi:[1,0,1] neg_lo:[1,0,0] neg_hi:[1,0,1]
    v_pk_fma_f32 v[74:75], v[98:99], v[34:35], v[42:43] op_sel:[1,1,0] op_sel_hi:[1,0,1] neg_lo:[1,0,0] neg_hi:[1,0,1]
    v_pk_fma_f32 v[76:77], v[100:101], v[36:37], v[44:45] op_sel:[1,1,0] op_sel_hi:[1,0,1] neg_lo:[1,0,0] neg_hi:[1,0,1]
    v_pk_fma_f32 v[78:79], v[102:103], v[38:39], v[46:47] op_sel:[1,1,0] op_sel_hi:[1,0,1] neg_lo:[1,0,0] neg_hi:[1,0,1]
    v_accvgpr_read_b32 v48, a161
    v_accvgpr_read_b32 v50, a165
    v_accvgpr_read_b32 v52, a169
    v_accvgpr_read_b32 v54, a173
    v_accvgpr_read_b32 v49, a177
    v_accvgpr_read_b32 v51, a181
    v_accvgpr_read_b32 v53, a185
    v_accvgpr_read_b32 v55, a189
    v_pk_fma_f32 v[56:57], v[88:89], v[32:33], v[48:49] op_sel:[0,0,0] op_sel_hi:[0,1,1]
    v_pk_fma_f32 v[58:59], v[90:91], v[34:35], v[50:51] op_sel:[0,0,0] op_sel_hi:[0,1,1]
    v_pk_fma_f32 v[60:61], v[92:93], v[36:37], v[52:53] op_sel:[0,0,0] op_sel_hi:[0,1,1]
    v_pk_fma_f32 v[62:63], v[94:95], v[38:39], v[54:55] op_sel:[0,0,0] op_sel_hi:[0,1,1]
    v_pk_fma_f32 v[32:33], v[88:89], v[32:33], v[56:57] op_sel:[1,1,0] op_sel_hi:[1,0,1] neg_lo:[1,0,0]
    v_pk_fma_f32 v[34:35], v[90:91], v[34:35], v[58:59] op_sel:[1,1,0] op_sel_hi:[1,0,1] neg_lo:[1,0,0]
    v_pk_fma_f32 v[36:37], v[92:93], v[36:37], v[60:61] op_sel:[1,1,0] op_sel_hi:[1,0,1] neg_lo:[1,0,0]
    v_pk_fma_f32 v[38:39], v[94:95], v[38:39], v[62:63] op_sel:[1,1,0] op_sel_hi:[1,0,1] neg_lo:[1,0,0]
    v_pk_mul_f32 v[40:41], v[96:97], v[32:33] op_sel:[0,0] op_sel_hi:[0,1]
    v_pk_mul_f32 v[42:43], v[98:99], v[34:35] op_sel:[0,0] op_sel_hi:[0,1]
    v_pk_mul_f32 v[44:45], v[100:101], v[36:37] op_sel:[0,0] op_sel_hi:[0,1]
    v_pk_mul_f32 v[46:47], v[102:103], v[38:39] op_sel:[0,0] op_sel_hi:[0,1]
    v_pk_fma_f32 v[80:81], v[96:97], v[32:33], v[40:41] op_sel:[1,1,0] op_sel_hi:[1,0,1] neg_lo:[1,0,0] neg_hi:[1,0,1]
    v_pk_fma_f32 v[82:83], v[98:99], v[34:35], v[42:43] op_sel:[1,1,0] op_sel_hi:[1,0,1] neg_lo:[1,0,0] neg_hi:[1,0,1]
    v_pk_fma_f32 v[84:85], v[100:101], v[36:37], v[44:45] op_sel:[1,1,0] op_sel_hi:[1,0,1] neg_lo:[1,0,0] neg_hi:[1,0,1]
    v_pk_fma_f32 v[86:87], v[102:103], v[38:39], v[46:47] op_sel:[1,1,0] op_sel_hi:[1,0,1] neg_lo:[1,0,0] neg_hi:[1,0,1]
    v_cvt_pk_bf16_f32 v162, v72, v80
    v_cvt_pk_bf16_f32 v170, v74, v82
    v_cvt_pk_bf16_f32 v178, v76, v84
    v_cvt_pk_bf16_f32 v186, v78, v86
    v_cvt_pk_bf16_f32 v226, v73, v81
    v_cvt_pk_bf16_f32 v234, v75, v83
    v_cvt_pk_bf16_f32 v242, v77, v85
    v_cvt_pk_bf16_f32 v250, v79, v87
    v_accvgpr_read_b32 v64, a162
    v_accvgpr_read_b32 v66, a166
    v_accvgpr_read_b32 v68, a170
    v_accvgpr_read_b32 v70, a174
    v_accvgpr_read_b32 v65, a178
    v_accvgpr_read_b32 v67, a182
    v_accvgpr_read_b32 v69, a186
    v_accvgpr_read_b32 v71, a190
    v_pk_fma_f32 v[56:57], v[88:89], v[32:33], v[64:65] op_sel:[0,0,0] op_sel_hi:[0,1,1]
    v_pk_fma_f32 v[58:59], v[90:91], v[34:35], v[66:67] op_sel:[0,0,0] op_sel_hi:[0,1,1]
    v_pk_fma_f32 v[60:61], v[92:93], v[36:37], v[68:69] op_sel:[0,0,0] op_sel_hi:[0,1,1]
    v_pk_fma_f32 v[62:63], v[94:95], v[38:39], v[70:71] op_sel:[0,0,0] op_sel_hi:[0,1,1]
    v_pk_fma_f32 v[32:33], v[88:89], v[32:33], v[56:57] op_sel:[1,1,0] op_sel_hi:[1,0,1] neg_lo:[1,0,0]
    v_pk_fma_f32 v[34:35], v[90:91], v[34:35], v[58:59] op_sel:[1,1,0] op_sel_hi:[1,0,1] neg_lo:[1,0,0]
    v_pk_fma_f32 v[36:37], v[92:93], v[36:37], v[60:61] op_sel:[1,1,0] op_sel_hi:[1,0,1] neg_lo:[1,0,0]
    v_pk_fma_f32 v[38:39], v[94:95], v[38:39], v[62:63] op_sel:[1,1,0] op_sel_hi:[1,0,1] neg_lo:[1,0,0]
    v_pk_mul_f32 v[40:41], v[96:97], v[32:33] op_sel:[0,0] op_sel_hi:[0,1]
    v_pk_mul_f32 v[42:43], v[98:99], v[34:35] op_sel:[0,0] op_sel_hi:[0,1]
    v_pk_mul_f32 v[44:45], v[100:101], v[36:37] op_sel:[0,0] op_sel_hi:[0,1]
    v_pk_mul_f32 v[46:47], v[102:103], v[38:39] op_sel:[0,0] op_sel_hi:[0,1]
    v_pk_fma_f32 v[72:73], v[96:97], v[32:33], v[40:41] op_sel:[1,1,0] op_sel_hi:[1,0,1] neg_lo:[1,0,0] neg_hi:[1,0,1]
    v_pk_fma_f32 v[74:75], v[98:99], v[34:35], v[42:43] op_sel:[1,1,0] op_sel_hi:[1,0,1] neg_lo:[1,0,0] neg_hi:[1,0,1]
    v_pk_fma_f32 v[76:77], v[100:101], v[36:37], v[44:45] op_sel:[1,1,0] op_sel_hi:[1,0,1] neg_lo:[1,0,0] neg_hi:[1,0,1]
    v_pk_fma_f32 v[78:79], v[102:103], v[38:39], v[46:47] op_sel:[1,1,0] op_sel_hi:[1,0,1] neg_lo:[1,0,0] neg_hi:[1,0,1]
    v_accvgpr_read_b32 v48, a163
    v_accvgpr_read_b32 v50, a167
    v_accvgpr_read_b32 v52, a171
    v_accvgpr_read_b32 v54, a175
    v_accvgpr_read_b32 v49, a179
    v_accvgpr_read_b32 v51, a183
    v_accvgpr_read_b32 v53, a187
    v_accvgpr_read_b32 v55, a191
    v_pk_fma_f32 v[56:57], v[88:89], v[32:33], v[48:49] op_sel:[0,0,0] op_sel_hi:[0,1,1]
    v_pk_fma_f32 v[58:59], v[90:91], v[34:35], v[50:51] op_sel:[0,0,0] op_sel_hi:[0,1,1]
    v_pk_fma_f32 v[60:61], v[92:93], v[36:37], v[52:53] op_sel:[0,0,0] op_sel_hi:[0,1,1]
    v_pk_fma_f32 v[62:63], v[94:95], v[38:39], v[54:55] op_sel:[0,0,0] op_sel_hi:[0,1,1]
    v_pk_fma_f32 v[32:33], v[88:89], v[32:33], v[56:57] op_sel:[1,1,0] op_sel_hi:[1,0,1] neg_lo:[1,0,0]
    v_pk_fma_f32 v[34:35], v[90:91], v[34:35], v[58:59] op_sel:[1,1,0] op_sel_hi:[1,0,1] neg_lo:[1,0,0]
    v_pk_fma_f32 v[36:37], v[92:93], v[36:37], v[60:61] op_sel:[1,1,0] op_sel_hi:[1,0,1] neg_lo:[1,0,0]
    v_pk_fma_f32 v[38:39], v[94:95], v[38:39], v[62:63] op_sel:[1,1,0] op_sel_hi:[1,0,1] neg_lo:[1,0,0]
    v_pk_mul_f32 v[40:41], v[96:97], v[32:33] op_sel:[0,0] op_sel_hi:[0,1]
    v_pk_mul_f32 v[42:43], v[98:99], v[34:35] op_sel:[0,0] op_sel_hi:[0,1]
    v_pk_mul_f32 v[44:45], v[100:101], v[36:37] op_sel:[0,0] op_sel_hi:[0,1]
    v_pk_mul_f32 v[46:47], v[102:103], v[38:39] op_sel:[0,0] op_sel_hi:[0,1]
    v_pk_fma_f32 v[80:81], v[96:97], v[32:33], v[40:41] op_sel:[1,1,0] op_sel_hi:[1,0,1] neg_lo:[1,0,0] neg_hi:[1,0,1]
    v_pk_fma_f32 v[82:83], v[98:99], v[34:35], v[42:43] op_sel:[1,1,0] op_sel_hi:[1,0,1] neg_lo:[1,0,0] neg_hi:[1,0,1]
    v_pk_fma_f32 v[84:85], v[100:101], v[36:37], v[44:45] op_sel:[1,1,0] op_sel_hi:[1,0,1] neg_lo:[1,0,0] neg_hi:[1,0,1]
    v_pk_fma_f32 v[86:87], v[102:103], v[38:39], v[46:47] op_sel:[1,1,0] op_sel_hi:[1,0,1] neg_lo:[1,0,0] neg_hi:[1,0,1]
    v_cvt_pk_bf16_f32 v163, v72, v80
    v_cvt_pk_bf16_f32 v171, v74, v82
    v_cvt_pk_bf16_f32 v179, v76, v84
    v_cvt_pk_bf16_f32 v187, v78, v86
    v_cvt_pk_bf16_f32 v227, v73, v81
    v_cvt_pk_bf16_f32 v235, v75, v83
    v_cvt_pk_bf16_f32 v243, v77, v85
    v_cvt_pk_bf16_f32 v251, v79, v87
    v_accvgpr_read_b32 v64, a192
    v_accvgpr_read_b32 v66, a196
    v_accvgpr_read_b32 v68, a200
    v_accvgpr_read_b32 v70, a204
    v_accvgpr_read_b32 v65, a208
    v_accvgpr_read_b32 v67, a212
    v_accvgpr_read_b32 v69, a216
    v_accvgpr_read_b32 v71, a220
    v_pk_fma_f32 v[56:57], v[88:89], v[32:33], v[64:65] op_sel:[0,0,0] op_sel_hi:[0,1,1]
    v_pk_fma_f32 v[58:59], v[90:91], v[34:35], v[66:67] op_sel:[0,0,0] op_sel_hi:[0,1,1]
    v_pk_fma_f32 v[60:61], v[92:93], v[36:37], v[68:69] op_sel:[0,0,0] op_sel_hi:[0,1,1]
    v_pk_fma_f32 v[62:63], v[94:95], v[38:39], v[70:71] op_sel:[0,0,0] op_sel_hi:[0,1,1]
    v_pk_fma_f32 v[32:33], v[88:89], v[32:33], v[56:57] op_sel:[1,1,0] op_sel_hi:[1,0,1] neg_lo:[1,0,0]
    v_pk_fma_f32 v[34:35], v[90:91], v[34:35], v[58:59] op_sel:[1,1,0] op_sel_hi:[1,0,1] neg_lo:[1,0,0]
    v_pk_fma_f32 v[36:37], v[92:93], v[36:37], v[60:61] op_sel:[1,1,0] op_sel_hi:[1,0,1] neg_lo:[1,0,0]
    v_pk_fma_f32 v[38:39], v[94:95], v[38:39], v[62:63] op_sel:[1,1,0] op_sel_hi:[1,0,1] neg_lo:[1,0,0]
    v_pk_mul_f32 v[40:41], v[96:97], v[32:33] op_sel:[0,0] op_sel_hi:[0,1]
    v_pk_mul_f32 v[42:43], v[98:99], v[34:35] op_sel:[0,0] op_sel_hi:[0,1]
    v_pk_mul_f32 v[44:45], v[100:101], v[36:37] op_sel:[0,0] op_sel_hi:[0,1]
    v_pk_mul_f32 v[46:47], v[102:103], v[38:39] op_sel:[0,0] op_sel_hi:[0,1]
    v_pk_fma_f32 v[72:73], v[96:97], v[32:33], v[40:41] op_sel:[1,1,0] op_sel_hi:[1,0,1] neg_lo:[1,0,0] neg_hi:[1,0,1]
    v_pk_fma_f32 v[74:75], v[98:99], v[34:35], v[42:43] op_sel:[1,1,0] op_sel_hi:[1,0,1] neg_lo:[1,0,0] neg_hi:[1,0,1]
    v_pk_fma_f32 v[76:77], v[100:101], v[36:37], v[44:45] op_sel:[1,1,0] op_sel_hi:[1,0,1] neg_lo:[1,0,0] neg_hi:[1,0,1]
    v_pk_fma_f32 v[78:79], v[102:103], v[38:39], v[46:47] op_sel:[1,1,0] op_sel_hi:[1,0,1] neg_lo:[1,0,0] neg_hi:[1,0,1]
    v_accvgpr_read_b32 v48, a193
    v_accvgpr_read_b32 v50, a197
    v_accvgpr_read_b32 v52, a201
    v_accvgpr_read_b32 v54, a205
    v_accvgpr_read_b32 v49, a209
    v_accvgpr_read_b32 v51, a213
    v_accvgpr_read_b32 v53, a217
    v_accvgpr_read_b32 v55, a221
    v_pk_fma_f32 v[56:57], v[88:89], v[32:33], v[48:49] op_sel:[0,0,0] op_sel_hi:[0,1,1]
    v_pk_fma_f32 v[58:59], v[90:91], v[34:35], v[50:51] op_sel:[0,0,0] op_sel_hi:[0,1,1]
    v_pk_fma_f32 v[60:61], v[92:93], v[36:37], v[52:53] op_sel:[0,0,0] op_sel_hi:[0,1,1]
    v_pk_fma_f32 v[62:63], v[94:95], v[38:39], v[54:55] op_sel:[0,0,0] op_sel_hi:[0,1,1]
    v_pk_fma_f32 v[32:33], v[88:89], v[32:33], v[56:57] op_sel:[1,1,0] op_sel_hi:[1,0,1] neg_lo:[1,0,0]
    v_pk_fma_f32 v[34:35], v[90:91], v[34:35], v[58:59] op_sel:[1,1,0] op_sel_hi:[1,0,1] neg_lo:[1,0,0]
    v_pk_fma_f32 v[36:37], v[92:93], v[36:37], v[60:61] op_sel:[1,1,0] op_sel_hi:[1,0,1] neg_lo:[1,0,0]
    v_pk_fma_f32 v[38:39], v[94:95], v[38:39], v[62:63] op_sel:[1,1,0] op_sel_hi:[1,0,1] neg_lo:[1,0,0]
    v_pk_mul_f32 v[40:41], v[96:97], v[32:33] op_sel:[0,0] op_sel_hi:[0,1]
    v_pk_mul_f32 v[42:43], v[98:99], v[34:35] op_sel:[0,0] op_sel_hi:[0,1]
    v_pk_mul_f32 v[44:45], v[100:101], v[36:37] op_sel:[0,0] op_sel_hi:[0,1]
    v_pk_mul_f32 v[46:47], v[102:103], v[38:39] op_sel:[0,0] op_sel_hi:[0,1]
    v_pk_fma_f32 v[80:81], v[96:97], v[32:33], v[40:41] op_sel:[1,1,0] op_sel_hi:[1,0,1] neg_lo:[1,0,0] neg_hi:[1,0,1]
    v_pk_fma_f32 v[82:83], v[98:99], v[34:35], v[42:43] op_sel:[1,1,0] op_sel_hi:[1,0,1] neg_lo:[1,0,0] neg_hi:[1,0,1]
    v_pk_fma_f32 v[84:85], v[100:101], v[36:37], v[44:45] op_sel:[1,1,0] op_sel_hi:[1,0,1] neg_lo:[1,0,0] neg_hi:[1,0,1]
    v_pk_fma_f32 v[86:87], v[102:103], v[38:39], v[46:47] op_sel:[1,1,0] op_sel_hi:[1,0,1] neg_lo:[1,0,0] neg_hi:[1,0,1]
    v_cvt_pk_bf16_f32 v164, v72, v80
    v_cvt_pk_bf16_f32 v172, v74, v82
    v_cvt_pk_bf16_f32 v180, v76, v84
    v_cvt_pk_bf16_f32 v188, v78, v86
    v_cvt_pk_bf16_f32 v228, v73, v81
    v_cvt_pk_bf16_f32 v236, v75, v83
    v_cvt_pk_bf16_f32 v244, v77, v85
    v_cvt_pk_bf16_f32 v252, v79, v87
    v_accvgpr_read_b32 v64, a194
    v_accvgpr_read_b32 v66, a198
    v_accvgpr_read_b32 v68, a202
    v_accvgpr_read_b32 v70, a206
    v_accvgpr_read_b32 v65, a210
    v_accvgpr_read_b32 v67, a214
    v_accvgpr_read_b32 v69, a218
    v_accvgpr_read_b32 v71, a222
    v_pk_fma_f32 v[56:57], v[88:89], v[32:33], v[64:65] op_sel:[0,0,0] op_sel_hi:[0,1,1]
    v_pk_fma_f32 v[58:59], v[90:91], v[34:35], v[66:67] op_sel:[0,0,0] op_sel_hi:[0,1,1]
    v_pk_fma_f32 v[60:61], v[92:93], v[36:37], v[68:69] op_sel:[0,0,0] op_sel_hi:[0,1,1]
    v_pk_fma_f32 v[62:63], v[94:95], v[38:39], v[70:71] op_sel:[0,0,0] op_sel_hi:[0,1,1]
    v_pk_fma_f32 v[32:33], v[88:89], v[32:33], v[56:57] op_sel:[1,1,0] op_sel_hi:[1,0,1] neg_lo:[1,0,0]
    v_pk_fma_f32 v[34:35], v[90:91], v[34:35], v[58:59] op_sel:[1,1,0] op_sel_hi:[1,0,1] neg_lo:[1,0,0]
    v_pk_fma_f32 v[36:37], v[92:93], v[36:37], v[60:61] op_sel:[1,1,0] op_sel_hi:[1,0,1] neg_lo:[1,0,0]
    v_pk_fma_f32 v[38:39], v[94:95], v[38:39], v[62:63] op_sel:[1,1,0] op_sel_hi:[1,0,1] neg_lo:[1,0,0]
    v_pk_mul_f32 v[40:41], v[96:97], v[32:33] op_sel:[0,0] op_sel_hi:[0,1]
    v_pk_mul_f32 v[42:43], v[98:99], v[34:35] op_sel:[0,0] op_sel_hi:[0,1]
    v_pk_mul_f32 v[44:45], v[100:101], v[36:37] op_sel:[0,0] op_sel_hi:[0,1]
    v_pk_mul_f32 v[46:47], v[102:103], v[38:39] op_sel:[0,0] op_sel_hi:[0,1]
    v_pk_fma_f32 v[72:73], v[96:97], v[32:33], v[40:41] op_sel:[1,1,0] op_sel_hi:[1,0,1] neg_lo:[1,0,0] neg_hi:[1,0,1]
    v_pk_fma_f32 v[74:75], v[98:99], v[34:35], v[42:43] op_sel:[1,1,0] op_sel_hi:[1,0,1] neg_lo:[1,0,0] neg_hi:[1,0,1]
    v_pk_fma_f32 v[76:77], v[100:101], v[36:37], v[44:45] op_sel:[1,1,0] op_sel_hi:[1,0,1] neg_lo:[1,0,0] neg_hi:[1,0,1]
    v_pk_fma_f32 v[78:79], v[102:103], v[38:39], v[46:47] op_sel:[1,1,0] op_sel_hi:[1,0,1] neg_lo:[1,0,0] neg_hi:[1,0,1]
    v_accvgpr_read_b32 v48, a195
    v_accvgpr_read_b32 v50, a199
    v_accvgpr_read_b32 v52, a203
    v_accvgpr_read_b32 v54, a207
    v_accvgpr_read_b32 v49, a211
    v_accvgpr_read_b32 v51, a215
    v_accvgpr_read_b32 v53, a219
    v_accvgpr_read_b32 v55, a223
    v_pk_fma_f32 v[56:57], v[88:89], v[32:33], v[48:49] op_sel:[0,0,0] op_sel_hi:[0,1,1]
    v_pk_fma_f32 v[58:59], v[90:91], v[34:35], v[50:51] op_sel:[0,0,0] op_sel_hi:[0,1,1]
    v_pk_fma_f32 v[60:61], v[92:93], v[36:37], v[52:53] op_sel:[0,0,0] op_sel_hi:[0,1,1]
    v_pk_fma_f32 v[62:63], v[94:95], v[38:39], v[54:55] op_sel:[0,0,0] op_sel_hi:[0,1,1]
    v_pk_fma_f32 v[32:33], v[88:89], v[32:33], v[56:57] op_sel:[1,1,0] op_sel_hi:[1,0,1] neg_lo:[1,0,0]
    v_pk_fma_f32 v[34:35], v[90:91], v[34:35], v[58:59] op_sel:[1,1,0] op_sel_hi:[1,0,1] neg_lo:[1,0,0]
    v_pk_fma_f32 v[36:37], v[92:93], v[36:37], v[60:61] op_sel:[1,1,0] op_sel_hi:[1,0,1] neg_lo:[1,0,0]
    v_pk_fma_f32 v[38:39], v[94:95], v[38:39], v[62:63] op_sel:[1,1,0] op_sel_hi:[1,0,1] neg_lo:[1,0,0]
    v_pk_mul_f32 v[40:41], v[96:97], v[32:33] op_sel:[0,0] op_sel_hi:[0,1]
    v_pk_mul_f32 v[42:43], v[98:99], v[34:35] op_sel:[0,0] op_sel_hi:[0,1]
    v_pk_mul_f32 v[44:45], v[100:101], v[36:37] op_sel:[0,0] op_sel_hi:[0,1]
    v_pk_mul_f32 v[46:47], v[102:103], v[38:39] op_sel:[0,0] op_sel_hi:[0,1]
    v_pk_fma_f32 v[80:81], v[96:97], v[32:33], v[40:41] op_sel:[1,1,0] op_sel_hi:[1,0,1] neg_lo:[1,0,0] neg_hi:[1,0,1]
    v_pk_fma_f32 v[82:83], v[98:99], v[34:35], v[42:43] op_sel:[1,1,0] op_sel_hi:[1,0,1] neg_lo:[1,0,0] neg_hi:[1,0,1]
    v_pk_fma_f32 v[84:85], v[100:101], v[36:37], v[44:45] op_sel:[1,1,0] op_sel_hi:[1,0,1] neg_lo:[1,0,0] neg_hi:[1,0,1]
    v_pk_fma_f32 v[86:87], v[102:103], v[38:39], v[46:47] op_sel:[1,1,0] op_sel_hi:[1,0,1] neg_lo:[1,0,0] neg_hi:[1,0,1]
    v_cvt_pk_bf16_f32 v165, v72, v80
    v_cvt_pk_bf16_f32 v173, v74, v82
    v_cvt_pk_bf16_f32 v181, v76, v84
    v_cvt_pk_bf16_f32 v189, v78, v86
    v_cvt_pk_bf16_f32 v229, v73, v81
    v_cvt_pk_bf16_f32 v237, v75, v83
    v_cvt_pk_bf16_f32 v245, v77, v85
    v_cvt_pk_bf16_f32 v253, v79, v87
    v_accvgpr_read_b32 v64, a224
    v_accvgpr_read_b32 v66, a228
    v_accvgpr_read_b32 v68, a232
    v_accvgpr_read_b32 v70, a236
    v_accvgpr_read_b32 v65, a240
    v_accvgpr_read_b32 v67, a244
    v_accvgpr_read_b32 v69, a248
    v_accvgpr_read_b32 v71, a252
    v_pk_fma_f32 v[56:57], v[88:89], v[32:33], v[64:65] op_sel:[0,0,0] op_sel_hi:[0,1,1]
    v_pk_fma_f32 v[58:59], v[90:91], v[34:35], v[66:67] op_sel:[0,0,0] op_sel_hi:[0,1,1]
    v_pk_fma_f32 v[60:61], v[92:93], v[36:37], v[68:69] op_sel:[0,0,0] op_sel_hi:[0,1,1]
    v_pk_fma_f32 v[62:63], v[94:95], v[38:39], v[70:71] op_sel:[0,0,0] op_sel_hi:[0,1,1]
    v_pk_fma_f32 v[32:33], v[88:89], v[32:33], v[56:57] op_sel:[1,1,0] op_sel_hi:[1,0,1] neg_lo:[1,0,0]
    v_pk_fma_f32 v[34:35], v[90:91], v[34:35], v[58:59] op_sel:[1,1,0] op_sel_hi:[1,0,1] neg_lo:[1,0,0]
    v_pk_fma_f32 v[36:37], v[92:93], v[36:37], v[60:61] op_sel:[1,1,0] op_sel_hi:[1,0,1] neg_lo:[1,0,0]
    v_pk_fma_f32 v[38:39], v[94:95], v[38:39], v[62:63] op_sel:[1,1,0] op_sel_hi:[1,0,1] neg_lo:[1,0,0]
    v_pk_mul_f32 v[40:41], v[96:97], v[32:33] op_sel:[0,0] op_sel_hi:[0,1]
    v_pk_mul_f32 v[42:43], v[98:99], v[34:35] op_sel:[0,0] op_sel_hi:[0,1]
    v_pk_mul_f32 v[44:45], v[100:101], v[36:37] op_sel:[0,0] op_sel_hi:[0,1]
    v_pk_mul_f32 v[46:47], v[102:103], v[38:39] op_sel:[0,0] op_sel_hi:[0,1]
    v_pk_fma_f32 v[72:73], v[96:97], v[32:33], v[40:41] op_sel:[1,1,0] op_sel_hi:[1,0,1] neg_lo:[1,0,0] neg_hi:[1,0,1]
    v_pk_fma_f32 v[74:75], v[98:99], v[34:35], v[42:43] op_sel:[1,1,0] op_sel_hi:[1,0,1] neg_lo:[1,0,0] neg_hi:[1,0,1]
    v_pk_fma_f32 v[76:77], v[100:101], v[36:37], v[44:45] op_sel:[1,1,0] op_sel_hi:[1,0,1] neg_lo:[1,0,0] neg_hi:[1,0,1]
    v_pk_fma_f32 v[78:79], v[102:103], v[38:39], v[46:47] op_sel:[1,1,0] op_sel_hi:[1,0,1] neg_lo:[1,0,0] neg_hi:[1,0,1]
    v_accvgpr_read_b32 v48, a225
    v_accvgpr_read_b32 v50, a229
    v_accvgpr_read_b32 v52, a233
    v_accvgpr_read_b32 v54, a237
    v_accvgpr_read_b32 v49, a241
    v_accvgpr_read_b32 v51, a245
    v_accvgpr_read_b32 v53, a249
    v_accvgpr_read_b32 v55, a253
    v_pk_fma_f32 v[56:57], v[88:89], v[32:33], v[48:49] op_sel:[0,0,0] op_sel_hi:[0,1,1]
    v_pk_fma_f32 v[58:59], v[90:91], v[34:35], v[50:51] op_sel:[0,0,0] op_sel_hi:[0,1,1]
    v_pk_fma_f32 v[60:61], v[92:93], v[36:37], v[52:53] op_sel:[0,0,0] op_sel_hi:[0,1,1]
    v_pk_fma_f32 v[62:63], v[94:95], v[38:39], v[54:55] op_sel:[0,0,0] op_sel_hi:[0,1,1]
    v_pk_fma_f32 v[32:33], v[88:89], v[32:33], v[56:57] op_sel:[1,1,0] op_sel_hi:[1,0,1] neg_lo:[1,0,0]
    v_pk_fma_f32 v[34:35], v[90:91], v[34:35], v[58:59] op_sel:[1,1,0] op_sel_hi:[1,0,1] neg_lo:[1,0,0]
    v_pk_fma_f32 v[36:37], v[92:93], v[36:37], v[60:61] op_sel:[1,1,0] op_sel_hi:[1,0,1] neg_lo:[1,0,0]
    v_pk_fma_f32 v[38:39], v[94:95], v[38:39], v[62:63] op_sel:[1,1,0] op_sel_hi:[1,0,1] neg_lo:[1,0,0]
    v_pk_mul_f32 v[40:41], v[96:97], v[32:33] op_sel:[0,0] op_sel_hi:[0,1]
    v_pk_mul_f32 v[42:43], v[98:99], v[34:35] op_sel:[0,0] op_sel_hi:[0,1]
    v_pk_mul_f32 v[44:45], v[100:101], v[36:37] op_sel:[0,0] op_sel_hi:[0,1]
    v_pk_mul_f32 v[46:47], v[102:103], v[38:39] op_sel:[0,0] op_sel_hi:[0,1]
    v_pk_fma_f32 v[80:81], v[96:97], v[32:33], v[40:41] op_sel:[1,1,0] op_sel_hi:[1,0,1] neg_lo:[1,0,0] neg_hi:[1,0,1]
    v_pk_fma_f32 v[82:83], v[98:99], v[34:35], v[42:43] op_sel:[1,1,0] op_sel_hi:[1,0,1] neg_lo:[1,0,0] neg_hi:[1,0,1]
    v_pk_fma_f32 v[84:85], v[100:101], v[36:37], v[44:45] op_sel:[1,1,0] op_sel_hi:[1,0,1] neg_lo:[1,0,0] neg_hi:[1,0,1]
    v_pk_fma_f32 v[86:87], v[102:103], v[38:39], v[46:47] op_sel:[1,1,0] op_sel_hi:[1,0,1] neg_lo:[1,0,0] neg_hi:[1,0,1]
    v_cvt_pk_bf16_f32 v166, v72, v80
    v_cvt_pk_bf16_f32 v174, v74, v82
    v_cvt_pk_bf16_f32 v182, v76, v84
    v_cvt_pk_bf16_f32 v190, v78, v86
    v_cvt_pk_bf16_f32 v230, v73, v81
    v_cvt_pk_bf16_f32 v238, v75, v83
    v_cvt_pk_bf16_f32 v246, v77, v85
    v_cvt_pk_bf16_f32 v254, v79, v87
    v_accvgpr_read_b32 v64, a226
    v_accvgpr_read_b32 v66, a230
    v_accvgpr_read_b32 v68, a234
    v_accvgpr_read_b32 v70, a238
    v_accvgpr_read_b32 v65, a242
    v_accvgpr_read_b32 v67, a246
    v_accvgpr_read_b32 v69, a250
    v_accvgpr_read_b32 v71, a254
    v_pk_fma_f32 v[56:57], v[88:89], v[32:33], v[64:65] op_sel:[0,0,0] op_sel_hi:[0,1,1]
    v_pk_fma_f32 v[58:59], v[90:91], v[34:35], v[66:67] op_sel:[0,0,0] op_sel_hi:[0,1,1]
    v_pk_fma_f32 v[60:61], v[92:93], v[36:37], v[68:69] op_sel:[0,0,0] op_sel_hi:[0,1,1]
    v_pk_fma_f32 v[62:63], v[94:95], v[38:39], v[70:71] op_sel:[0,0,0] op_sel_hi:[0,1,1]
    v_pk_fma_f32 v[32:33], v[88:89], v[32:33], v[56:57] op_sel:[1,1,0] op_sel_hi:[1,0,1] neg_lo:[1,0,0]
    v_pk_fma_f32 v[34:35], v[90:91], v[34:35], v[58:59] op_sel:[1,1,0] op_sel_hi:[1,0,1] neg_lo:[1,0,0]
    v_pk_fma_f32 v[36:37], v[92:93], v[36:37], v[60:61] op_sel:[1,1,0] op_sel_hi:[1,0,1] neg_lo:[1,0,0]
    v_pk_fma_f32 v[38:39], v[94:95], v[38:39], v[62:63] op_sel:[1,1,0] op_sel_hi:[1,0,1] neg_lo:[1,0,0]
    v_pk_mul_f32 v[40:41], v[96:97], v[32:33] op_sel:[0,0] op_sel_hi:[0,1]
    v_pk_mul_f32 v[42:43], v[98:99], v[34:35] op_sel:[0,0] op_sel_hi:[0,1]
    v_pk_mul_f32 v[44:45], v[100:101], v[36:37] op_sel:[0,0] op_sel_hi:[0,1]
    v_pk_mul_f32 v[46:47], v[102:103], v[38:39] op_sel:[0,0] op_sel_hi:[0,1]
    v_pk_fma_f32 v[72:73], v[96:97], v[32:33], v[40:41] op_sel:[1,1,0] op_sel_hi:[1,0,1] neg_lo:[1,0,0] neg_hi:[1,0,1]
    v_pk_fma_f32 v[74:75], v[98:99], v[34:35], v[42:43] op_sel:[1,1,0] op_sel_hi:[1,0,1] neg_lo:[1,0,0] neg_hi:[1,0,1]
    v_pk_fma_f32 v[76:77], v[100:101], v[36:37], v[44:45] op_sel:[1,1,0] op_sel_hi:[1,0,1] neg_lo:[1,0,0] neg_hi:[1,0,1]
    v_pk_fma_f32 v[78:79], v[102:103], v[38:39], v[46:47] op_sel:[1,1,0] op_sel_hi:[1,0,1] neg_lo:[1,0,0] neg_hi:[1,0,1]
    v_accvgpr_read_b32 v48, a227
    v_accvgpr_read_b32 v50, a231
    v_accvgpr_read_b32 v52, a235
    v_accvgpr_read_b32 v54, a239
    v_accvgpr_read_b32 v49, a243
    v_accvgpr_read_b32 v51, a247
    v_accvgpr_read_b32 v53, a251
    v_accvgpr_read_b32 v55, a255
    v_pk_fma_f32 v[56:57], v[88:89], v[32:33], v[48:49] op_sel:[0,0,0] op_sel_hi:[0,1,1]
    v_pk_fma_f32 v[58:59], v[90:91], v[34:35], v[50:51] op_sel:[0,0,0] op_sel_hi:[0,1,1]
    v_pk_fma_f32 v[60:61], v[92:93], v[36:37], v[52:53] op_sel:[0,0,0] op_sel_hi:[0,1,1]
    v_pk_fma_f32 v[62:63], v[94:95], v[38:39], v[54:55] op_sel:[0,0,0] op_sel_hi:[0,1,1]
    v_pk_fma_f32 v[32:33], v[88:89], v[32:33], v[56:57] op_sel:[1,1,0] op_sel_hi:[1,0,1] neg_lo:[1,0,0]
    v_pk_fma_f32 v[34:35], v[90:91], v[34:35], v[58:59] op_sel:[1,1,0] op_sel_hi:[1,0,1] neg_lo:[1,0,0]
    v_pk_fma_f32 v[36:37], v[92:93], v[36:37], v[60:61] op_sel:[1,1,0] op_sel_hi:[1,0,1] neg_lo:[1,0,0]
    v_pk_fma_f32 v[38:39], v[94:95], v[38:39], v[62:63] op_sel:[1,1,0] op_sel_hi:[1,0,1] neg_lo:[1,0,0]
    v_pk_mul_f32 v[40:41], v[96:97], v[32:33] op_sel:[0,0] op_sel_hi:[0,1]
    v_pk_mul_f32 v[42:43], v[98:99], v[34:35] op_sel:[0,0] op_sel_hi:[0,1]
    v_pk_mul_f32 v[44:45], v[100:101], v[36:37] op_sel:[0,0] op_sel_hi:[0,1]
    v_pk_mul_f32 v[46:47], v[102:103], v[38:39] op_sel:[0,0] op_sel_hi:[0,1]
    v_pk_fma_f32 v[80:81], v[96:97], v[32:33], v[40:41] op_sel:[1,1,0] op_sel_hi:[1,0,1] neg_lo:[1,0,0] neg_hi:[1,0,1]
    v_pk_fma_f32 v[82:83], v[98:99], v[34:35], v[42:43] op_sel:[1,1,0] op_sel_hi:[1,0,1] neg_lo:[1,0,0] neg_hi:[1,0,1]
    v_pk_fma_f32 v[84:85], v[100:101], v[36:37], v[44:45] op_sel:[1,1,0] op_sel_hi:[1,0,1] neg_lo:[1,0,0] neg_hi:[1,0,1]
    v_pk_fma_f32 v[86:87], v[102:103], v[38:39], v[46:47] op_sel:[1,1,0] op_sel_hi:[1,0,1] neg_lo:[1,0,0] neg_hi:[1,0,1]
    v_cvt_pk_bf16_f32 v167, v72, v80
    v_cvt_pk_bf16_f32 v175, v74, v82
    v_cvt_pk_bf16_f32 v183, v76, v84
    v_cvt_pk_bf16_f32 v191, v78, v86
    v_cvt_pk_bf16_f32 v231, v73, v81
    v_cvt_pk_bf16_f32 v239, v75, v83
    v_cvt_pk_bf16_f32 v247, v77, v85
    v_cvt_pk_bf16_f32 v255, v79, v87
    s_lshl_b32 s61, s85, 13
    s_andn2_b32 s61, 0x2000, s61
    s_xor_b32 s61, s61, s59
    s_lshl_b32 s50, s85, 21
    s_add_u32 s50, s50, s61
    s_lshr_b32 s60, s82, 2
    s_lshl_b32 s60, s60, 20
    s_add_u32 s50, s50, s60
    s_lshl_b32 s29, s29, 7
    s_and_b32 s29, s29, 0x7ffff
    s_add_u32 s50, s50, s29
    s_and_b32 s60, s58, 1
    s_lshl_b32 s60, s60, 12
    s_add_u32 s50, s50, s60
    s_add_u32 s50, s50, 0xc000000
    s_mov_b32 s5, 16384
    s_mov_b32 s51, 2048
    s_mov_b32 s52, 0x80000
    v_bfe_u32 v2, v0, 4, 1
    v_lshlrev_b32 v2, 6, v2
    v_xor_b32 v2, v2, v1
    v_add_u32 v3, 1024, v2
    s_setpc_b64 s[54:55]
code_end:
    s_endpgm
.section .rodata,"a"
.p2align 6
.amdhsa_kernel chain_kernel
  .amdhsa_next_free_vgpr 512
  .amdhsa_next_free_sgpr 102
  .amdhsa_accum_offset 256
  .amdhsa_group_segment_fixed_size 0
  .amdhsa_kernarg_size 152
  .amdhsa_user_sgpr_count 2
  .amdhsa_user_sgpr_kernarg_segment_ptr 1
  .amdhsa_system_sgpr_workgroup_id_x 1
  .amdhsa_float_denorm_mode_32 3
  .amdhsa_float_denorm_mode_16_64 3
.end_amdhsa_kernel
```

```asm
; @launch kernel=chain_kernel grid=(256,1,1) block=(256,1,1) lds=163840
.amdgcn_target "amdgcn-amd-amdhsa--gfx950"
.text
.globl chain_kernel
.p2align 8
.type chain_kernel,@function
chain_kernel:
    s_cmp_ge_u32 s2, 256
    s_cbranch_scc1 chain_kernel_end
    s_load_dwordx4 s[96:99], s[0:1], 128
    s_load_dwordx2 s[100:101], s[0:1], 144
    s_load_dwordx16 s[64:79], s[0:1], 0
    s_load_dwordx16 s[80:95], s[0:1], 64
    s_getpc_b64 s[8:9]
code_base:
    s_and_b32 s9, s9, 0xffff
    s_mov_b32 s10, code_end - code_base
    s_mov_b32 s11, 0x00020000
    s_bfe_u32 s12, s2, 0x20003
    s_lshl_b32 s12, s12, 15
    v_lshlrev_b32 v1, 7, v0
    buffer_load_dword v255, v1, s[8:11], s12 offen
    s_getreg_b32 s16, hwreg(HW_REG_XCC_ID)
    s_and_b32 s16, s16, 7
    v_lshrrev_b32 v1, 6, v0
    s_nop 0
    v_readfirstlane_b32 s18, v1
    s_waitcnt lgkmcnt(0)
    s_lshr_b32 s17, s2, 3
    s_mov_b32 s2, 0
    s_cmp_lg_u32 s18, 0
    s_cbranch_scc1 L_role_1
    s_lshl_b32 s12, s16, 8
    s_add_u32 s12, s12, 0xd200000
    v_lshl_add_u32 v1, v0, 2, s12
    v_mov_b32 v2, 0
    global_store_dword v1, v2, s[100:101]
    s_lshl_b32 s12, s16, 3
    s_add_u32 s12, s12, 128
    s_lshl_b32 s94, 1, s17
    s_mov_b32 s95, 0x100
    s_waitcnt vmcnt(0)
    s_atomic_add_x2 s[94:95], s[98:99], s12 glc
L_role_1:
    s_cmp_ge_u32 s16, 4
    s_cbranch_scc1 chain_kernel_worker
chain_start:
    s_mov_b32 s8, s100
    s_and_b32 s9, s101, 0xffff
    s_mov_b32 s10, 0x10000000
    s_mov_b32 s11, 0x00020000
    s_mov_b32 s33, 0
    s_xor_b32 s29, s17, 8
    s_and_b32 s28, s17, 1
    s_bfe_u32 s20, s17, 0x10001
    s_xor_b32 s20, s20, 1
    s_lshl1_add_u32 s28, s28, s20
    s_lshl_b32 s20, s16, 10
    s_lshr_b32 s21, s17, 2
    s_lshl_b32 s21, s21, 7
    s_add_u32 s20, s20, s21
    v_bfe_u32 v160, v0, 5, 1
    v_lshlrev_b32 v162, 1, v160
    v_bfe_u32 v160, v0, 3, 1
    v_add_u32 v162, v162, v160
    v_bfe_u32 v160, v0, 4, 1
    v_lshl_add_u32 v162, v160, 3, v162
    v_lshrrev_b32 v160, 6, v0
    v_lshl_add_u32 v162, v160, 8, v162
    v_and_b32 v161, 7, v0
    v_lshlrev_b32 v163, 13, v162
    v_lshl_add_u32 v163, v161, 4, v163
    s_and_b32 s21, s28, 1
    s_lshl_b32 s21, s21, 6
    s_add_u32 s21, s21, s20
    s_lshl_b32 s21, s21, 1
    v_add_u32 v163, s21, v163
    v_add_u32 v164, 0x8000, v163
    v_bfe_u32 v160, v0, 4, 2
    v_lshlrev_b32 v162, 1, v160
    v_bfe_u32 v160, v0, 2, 1
    v_add_u32 v162, v162, v160
    v_bfe_u32 v160, v0, 3, 1
    v_lshl_add_u32 v162, v160, 3, v162
    v_lshrrev_b32 v160, 6, v0
    v_lshl_add_u32 v162, v160, 8, v162
    v_and_b32 v161, 3, v0
    v_lshlrev_b32 v165, 13, v162
    v_lshl_add_u32 v165, v161, 4, v165
    s_and_b32 s21, s17, 3
    s_lshl_b32 s21, s21, 5
    s_add_u32 s21, s21, s20
    s_lshl_b32 s21, s21, 1
    v_add_u32 v165, s21, v165
    v_bfe_u32 v166, v0, 2, 1
    v_bfe_u32 v160, v0, 4, 1
    v_lshl_add_u32 v166, v160, 1, v166
    v_bfe_u32 v160, v0, 3, 1
    v_lshl_add_u32 v166, v160, 2, v166
    v_bfe_u32 v160, v0, 5, 1
    v_lshl_add_u32 v166, v160, 4, v166
    v_lshrrev_b32 v160, 6, v0
    v_lshl_add_u32 v166, v160, 8, v166
    s_lshl_b32 s21, s16, 10
    v_add_u32 v166, s21, v166
    v_lshlrev_b32 v166, 11, v166
    v_lshl_add_u32 v166, v161, 4, v166
    s_lshl_b32 s21, s29, 6
    v_add_u32 v166, s21, v166
    s_lshl_b32 s80, s18, 15
    s_add_u32 s80, s80, 32768
    s_bitcmp1_b32 s28, 1
    s_cselect_b32 s12, s88, s86
    s_cselect_b32 s13, s89, s87
    s_and_b32 s13, s13, 0xffff
    s_mov_b32 s14, 0x800000
    s_mov_b32 s15, 0x00020000
    s_mov_b32 s4, s90
    s_and_b32 s5, s91, 0xffff
    s_mov_b32 s6, 0x800000
    s_mov_b32 s7, 0x00020000
    s_mov_b32 s40, s92
    s_and_b32 s41, s93, 0xffff
    s_mov_b32 s42, 0x800000
    s_mov_b32 s43, 0x00020000
    s_add_u32 m0, s80, 0
    s_mov_b32 s81, 0
    buffer_load_dwordx4 v163, s[12:15], s81 offen nt lds
    s_add_u32 m0, s80, 1024
    s_mov_b32 s81, 0
    buffer_load_dwordx4 v164, s[12:15], s81 offen nt lds
    s_add_u32 m0, s80, 2048
    s_mov_b32 s81, 131072
    buffer_load_dwordx4 v163, s[12:15], s81 offen nt lds
    s_add_u32 m0, s80, 3072
    s_mov_b32 s81, 131072
    buffer_load_dwordx4 v164, s[12:15], s81 offen nt lds
    s_mov_b32 s81, 0
    buffer_load_dwordx4 v[32:35], v165, s[4:7], s81 offen nt
    s_mov_b32 s81, 0
    buffer_load_dwordx4 v[96:99], v166, s[40:43], s81 offen nt
    s_mov_b32 s81, 131072
    buffer_load_dwordx4 v[36:39], v165, s[4:7], s81 offen nt
    s_mov_b32 s81, 16384
    buffer_load_dwordx4 v[100:103], v166, s[40:43], s81 offen nt
    s_mov_b32 s24, 0x00ff00ff
    s_mov_b32 s25, 0x00ff00ff
    s_mov_b32 s26, 0x55555555
    s_mov_b32 s27, 0x55555555
    s_mov_b32 s56, 0x3fb8aa3b
    s_mov_b32 s57, 0x3fb8aa3b
    s_mov_b32 s58, 0x3db504f3
    s_mov_b32 s59, 0x3db504f3
    s_lshl_b32 s53, s16, 16
    s_add_u32 s53, s53, 0xd000000
    s_lshl_b32 s47, s16, 5
    s_add_u32 s47, s47, s17
    s_mov_b64 s[60:61], s[98:99]
    v_mov_b32 v28, -1
    v_mov_b32 v29, -1
    v_mov_b32 v30, -1
    v_mov_b32 v31, -1
    v_and_b32 v210, 63, v0
    v_and_b32 v208, 15, v0
    v_bfe_u32 v209, v0, 4, 2
    v_lshlrev_b32 v1, 4, v210
    v_lshlrev_b32 v26, 3, v210
    s_lshl_b32 s21, s18, 12
    v_add_u32 v2, s21, v1
    s_xor_b32 s22, s18, 3
    s_lshl_b32 s22, s22, 4
    v_xor_b32 v3, s22, v2
    v_add_u32 v3, 16384, v3
    s_and_b32 s22, s22, 16
    s_lshl_b32 s22, s22, 1
    v_xor_b32 v2, s22, v2
    v_mov_b32 v19, 0xeeeeeeee
    v_mov_b32 v212, 0x44444444
    v_cndmask_b32 v19, v19, v212, s[24:25]
    v_mov_b32 v18, 0x03020706
    v_mov_b32 v212, 0x05040100
    v_cndmask_b32 v18, v18, v212, s[26:27]
    s_lshr_b32 s21, s17, 2
    s_lshl_b32 s21, s21, 12
    s_add_u32 s21, s21, 32768
    v_add_u32 v5, s21, v1
    s_and_b32 s22, s28, 1
    s_lshl_b32 s22, s22, 11
    s_add_u32 s21, s21, s22
    s_bfe_u32 s22, s28, 0x10001
    s_lshl_b32 s22, s22, 7
    s_add_u32 s23, s21, s22
    v_and_b32 v212, 1, v209
    s_add_u32 m0, s80, 4096
    s_mov_b32 s81, 262144
    buffer_load_dwordx4 v163, s[12:15], s81 offen nt lds
    s_add_u32 m0, s80, 5120
    s_mov_b32 s81, 262144
    buffer_load_dwordx4 v164, s[12:15], s81 offen nt lds
    s_add_u32 m0, s80, 6144
    s_mov_b32 s81, 393216
    buffer_load_dwordx4 v163, s[12:15], s81 offen nt lds
    s_add_u32 m0, s80, 7168
    s_mov_b32 s81, 393216
    buffer_load_dwordx4 v164, s[12:15], s81 offen nt lds
    s_mov_b32 s81, 262144
    buffer_load_dwordx4 v[40:43], v165, s[4:7], s81 offen nt
    s_mov_b32 s81, 65536
    buffer_load_dwordx4 v[104:107], v166, s[40:43], s81 offen nt
    s_mov_b32 s81, 393216
    buffer_load_dwordx4 v[44:47], v165, s[4:7], s81 offen nt
    s_mov_b32 s81, 81920
    buffer_load_dwordx4 v[108:111], v166, s[40:43], s81 offen nt
    v_lshlrev_b32 v234, 5, v212
    v_and_b32 v212, 1, v208
    v_lshl_add_u32 v234, v212, 4, v234
    v_bfe_u32 v212, v208, 1, 2
    v_lshl_add_u32 v234, v212, 2, v234
    s_and_b32 s22, s18, 1
    s_lshl_b32 s22, s22, 6
    v_add_u32 v234, s22, v234
    v_lshrrev_b32 v212, 3, v208
    v_and_b32 v213, 2, v209
    v_add_u32 v212, v212, v213
    s_and_b32 s22, s18, 2
    s_lshl_b32 s22, s22, 1
    v_add_u32 v212, s22, v212
    v_lshl_add_u32 v4, v212, 8, v234
    v_lshlrev_b32 v234, 3, v208
    v_and_b32 v212, 1, v209
    v_lshl_add_u32 v234, v212, 8, v234
    v_lshrrev_b32 v212, 1, v209
    v_lshl_add_u32 v234, v212, 7, v234
    v_add_u32 v4, s23, v4
    v_lshrrev_b32 v212, 3, v210
    v_and_b32 v213, 7, v210
    v_lshlrev_b32 v22, 8, v212
    s_or_b32 s76, s16, s18
    s_or_b32 s76, s76, s2
    s_cbranch_scc1 L_cal_2
    s_waitcnt lgkmcnt(0)
    s_lshr_b32 s74, s95, 8
    s_cmp_ge_u32 s74, 15
    s_cbranch_scc1 L_cal_2
    s_lshl_b32 s76, s74, 14
    s_add_u32 s76, s76, 0xd400000
    s_add_u32 s64, s100, s76
    s_addc_u32 s65, s101, 0
    s_mov_b32 s76, 0
    s_atomic_or s76, s[64:65], 0
    s_atomic_or s76, s[64:65], 0x2000
    s_waitcnt lgkmcnt(0)
    s_mov_b32 s77, -1
    s_mov_b32 s78, -1
    s_memtime s[66:67]
    s_atomic_or s76, s[64:65], 0
    s_waitcnt lgkmcnt(0)
    s_memtime s[68:69]
    s_atomic_or s76, s[64:65], 0x2000
    s_waitcnt lgkmcnt(0)
    s_sub_u32 s79, s68, s66
    s_memtime s[66:67]
    s_min_u32 s77, s77, s79
    s_waitcnt lgkmcnt(0)
    s_sub_u32 s79, s66, s68
    s_min_u32 s78, s78, s79
    s_memtime s[66:67]
    s_atomic_or s76, s[64:65], 0
    s_waitcnt lgkmcnt(0)
    s_memtime s[68:69]
    s_atomic_or s76, s[64:65], 0x2000
    s_waitcnt lgkmcnt(0)
    s_sub_u32 s79, s68, s66
    s_memtime s[66:67]
    s_min_u32 s77, s77, s79
    s_waitcnt lgkmcnt(0)
    s_sub_u32 s79, s66, s68
    s_min_u32 s78, s78, s79
    s_memtime s[66:67]
    s_atomic_or s76, s[64:65], 0
    s_waitcnt lgkmcnt(0)
    s_memtime s[68:69]
    s_atomic_or s76, s[64:65], 0x2000
    s_waitcnt lgkmcnt(0)
    s_sub_u32 s79, s68, s66
    s_memtime s[66:67]
    s_min_u32 s77, s77, s79
    s_waitcnt lgkmcnt(0)
    s_sub_u32 s79, s66, s68
    s_min_u32 s78, s78, s79
    s_memtime s[66:67]
    s_atomic_or s76, s[64:65], 0
    s_waitcnt lgkmcnt(0)
    s_memtime s[68:69]
    s_atomic_or s76, s[64:65], 0x2000
    s_waitcnt lgkmcnt(0)
    s_sub_u32 s79, s68, s66
    s_memtime s[66:67]
    s_min_u32 s77, s77, s79
    s_waitcnt lgkmcnt(0)
    s_sub_u32 s79, s66, s68
    s_min_u32 s78, s78, s79
    s_cmp_lt_u32 s78, s77
    s_cselect_b32 s76, 0x101, 1
    s_atomic_add s76, s[98:99], 4
    s_waitcnt lgkmcnt(0)
L_cal_2:
    s_add_u32 m0, s80, 8192
    s_mov_b32 s81, 524288
    buffer_load_dwordx4 v163, s[12:15], s81 offen nt lds
    s_add_u32 m0, s80, 9216
    s_mov_b32 s81, 524288
    buffer_load_dwordx4 v164, s[12:15], s81 offen nt lds
    s_add_u32 m0, s80, 10240
    s_mov_b32 s81, 655360
    buffer_load_dwordx4 v163, s[12:15], s81 offen nt lds
    s_add_u32 m0, s80, 11264
    s_mov_b32 s81, 655360
    buffer_load_dwordx4 v164, s[12:15], s81 offen nt lds
    s_mov_b32 s81, 524288
    buffer_load_dwordx4 v[48:51], v165, s[4:7], s81 offen nt
    s_mov_b32 s81, 131072
    buffer_load_dwordx4 v[112:115], v166, s[40:43], s81 offen nt
    s_mov_b32 s81, 655360
    buffer_load_dwordx4 v[52:55], v165, s[4:7], s81 offen nt
    s_mov_b32 s81, 147456
    buffer_load_dwordx4 v[116:119], v166, s[40:43], s81 offen nt
    v_lshl_add_u32 v22, v213, 4, v22
    v_add_u32 v22, s23, v22
    s_lshr_b32 s20, s47, 2
    s_lshl_b32 s48, s20, 16
    s_and_b32 s21, s17, 3
    s_lshl_b32 s22, s21, 11
    s_add_u32 s22, s22, 0x4000
    v_add_u32 v237, s22, v1
    v_lshlrev_b32 v236, 7, v208
    v_and_b32 v212, 1, v209
    v_lshl_add_u32 v236, v212, 15, v236
    s_lshl_b32 s22, s21, 11
    v_add_u32 v236, s22, v236
    v_mov_b32 v25, v236
    s_cmp_lt_u32 s18, 2
    s_cselect_b32 s38, 0xf0000000, 0
    s_cmp_lg_u32 s18, 1
    s_cselect_b32 s39, 0xf0000000, 0
    s_lshr_b32 s22, s18, 1
    s_mul_i32 s54, s22, 10240
    s_lshl_b32 s22, s22, 15
    s_and_b32 s23, s18, 1
    s_lshl_b32 s23, s23, 12
    s_add_u32 s54, s54, s23
    s_add_u32 s54, s54, 32768
    s_add_u32 m0, s80, 12288
    s_mov_b32 s81, 786432
    buffer_load_dwordx4 v163, s[12:15], s81 offen nt lds
    s_add_u32 m0, s80, 13312
    s_mov_b32 s81, 786432
    buffer_load_dwordx4 v164, s[12:15], s81 offen nt lds
    s_add_u32 m0, s80, 14336
    s_mov_b32 s81, 917504
    buffer_load_dwordx4 v163, s[12:15], s81 offen nt lds
    s_add_u32 m0, s80, 15360
    s_mov_b32 s81, 917504
    buffer_load_dwordx4 v164, s[12:15], s81 offen nt lds
    s_mov_b32 s81, 786432
    buffer_load_dwordx4 v[56:59], v165, s[4:7], s81 offen nt
    s_mov_b32 s81, 196608
    buffer_load_dwordx4 v[120:123], v166, s[40:43], s81 offen nt
    s_mov_b32 s81, 917504
    buffer_load_dwordx4 v[60:63], v165, s[4:7], s81 offen nt
    s_mov_b32 s81, 212992
    buffer_load_dwordx4 v[124:127], v166, s[40:43], s81 offen nt
    s_add_u32 s22, s22, s23
    v_add_u32 v235, s22, v1
    s_lshl_b32 s51, s18, 11
    v_add_u32 v243, s51, v1
    v_add_u32 v244, 0x8000, v243
    v_lshrrev_b32 v212, 3, v210
    v_lshl_add_u32 v24, v212, 7, v5
    v_add_u32 v24, 128, v24
    s_and_b32 s22, s18, 1
    s_lshl_b32 s22, s22, 12
    v_add_u32 v242, s22, v1
    s_lshl_b32 s21, s21, 10
    s_add_u32 s21, s21, 0xc000
    v_add_u32 v23, s21, v242
    v_lshlrev_b32 v241, 7, v209
    v_bfe_u32 v212, v0, 2, 1
    v_lshl_add_u32 v241, v212, 6, v241
    v_bfe_u32 v212, v0, 3, 1
    v_lshl_add_u32 v241, v212, 5, v241
    v_bfe_u32 v212, v0, 0, 1
    v_lshl_add_u32 v241, v212, 4, v241
    v_and_b32 v212, 7, v208
    v_lshlrev_b32 v6, 4, v212
    v_lshl_add_u32 v6, v209, 7, v6
    s_lshl_b32 s21, s17, 9
    s_add_u32 m0, s80, 16384
    s_mov_b32 s81, 1048576
    buffer_load_dwordx4 v163, s[12:15], s81 offen nt lds
    s_add_u32 m0, s80, 17408
    s_mov_b32 s81, 1048576
    buffer_load_dwordx4 v164, s[12:15], s81 offen nt lds
    s_add_u32 m0, s80, 18432
    s_mov_b32 s81, 1179648
    buffer_load_dwordx4 v163, s[12:15], s81 offen nt lds
    s_add_u32 m0, s80, 19456
    s_mov_b32 s81, 1179648
    buffer_load_dwordx4 v164, s[12:15], s81 offen nt lds
    s_mov_b32 s81, 1048576
    buffer_load_dwordx4 v[64:67], v165, s[4:7], s81 offen nt
    s_mov_b32 s81, 262144
    buffer_load_dwordx4 v[128:131], v166, s[40:43], s81 offen nt
    s_mov_b32 s81, 1179648
    buffer_load_dwordx4 v[68:71], v165, s[4:7], s81 offen nt
    s_mov_b32 s81, 278528
    buffer_load_dwordx4 v[132:135], v166, s[40:43], s81 offen nt
    s_add_u32 s22, s21, 16384
    v_add_u32 v6, s22, v6
    v_lshrrev_b32 v212, 3, v208
    v_and_b32 v213, 2, v209
    v_add_u32 v212, v212, v213
    v_lshlrev_b32 v7, 7, v212
    v_and_b32 v212, 1, v209
    v_lshl_add_u32 v7, v212, 4, v7
    v_bfe_u32 v212, v208, 1, 2
    v_lshl_add_u32 v7, v212, 2, v7
    s_lshl_b32 s21, s29, 9
    s_lshl_b32 s22, s18, 5
    s_add_u32 s21, s21, s22
    v_add_u32 v7, s21, v7
    v_bfe_u32 v212, v210, 1, 3
    v_and_b32 v213, 1, v210
    v_lshlrev_b32 v27, 11, v212
    v_lshl_add_u32 v27, v213, 3, v27
    v_lshl_add_u32 v27, v209, 4, v27
    s_lshl_b32 s21, s29, 6
    v_add_u32 v27, s21, v27
    v_lshlrev_b32 v212, 2, v210
    s_xor_b32 s21, s18, 3
    s_mul_i32 s21, s21, 768
    s_add_u32 m0, s80, 20480
    s_mov_b32 s81, 1310720
    buffer_load_dwordx4 v163, s[12:15], s81 offen nt lds
    s_add_u32 m0, s80, 21504
    s_mov_b32 s81, 1310720
    buffer_load_dwordx4 v164, s[12:15], s81 offen nt lds
    s_add_u32 m0, s80, 22528
    s_mov_b32 s81, 1441792
    buffer_load_dwordx4 v163, s[12:15], s81 offen nt lds
    s_add_u32 m0, s80, 23552
    s_mov_b32 s81, 1441792
    buffer_load_dwordx4 v164, s[12:15], s81 offen nt lds
    s_mov_b32 s81, 1310720
    buffer_load_dwordx4 v[72:75], v165, s[4:7], s81 offen nt
    s_mov_b32 s81, 327680
    buffer_load_dwordx4 v[136:139], v166, s[40:43], s81 offen nt
    s_mov_b32 s81, 1441792
    buffer_load_dwordx4 v[76:79], v165, s[4:7], s81 offen nt
    s_mov_b32 s81, 344064
    buffer_load_dwordx4 v[140:143], v166, s[40:43], s81 offen nt
    s_add_u32 s21, s21, 0
    v_add_u32 v238, s21, v212
    v_lshlrev_b32 v12, 1, v238
    s_xor_b32 s21, s18, 2
    s_mul_i32 s21, s21, 768
    s_add_u32 s21, s21, 256
    v_add_u32 v239, s21, v212
    v_lshlrev_b32 v13, 1, v239
    s_xor_b32 s21, s18, 1
    s_mul_i32 s21, s21, 768
    s_add_u32 s21, s21, 512
    v_add_u32 v240, s21, v212
    v_lshlrev_b32 v14, 1, v240
    s_mul_i32 s21, s18, 768
    v_add_u32 v17, s21, v212
    v_lshlrev_b32 v15, 1, v17
    s_lshl_b32 s21, s18, 10
    v_add_u32 v16, s21, v1
    global_load_dwordx2 v[246:247], v27, s[84:85]
    v_and_b32 v208, 15, v0
    v_bfe_u32 v209, v0, 6, 1
    v_lshl_add_u32 v208, v209, 4, v208
    v_bfe_u32 v209, v0, 4, 2
    v_lshlrev_b32 v209, 2, v209
    v_sub_u32 v208, v208, v209
    s_or_b32 s76, s2, s18
    s_cbranch_scc1 L_rw_3
    s_lshl_b32 s78, s16, 3
    s_add_u32 s78, s78, 128
    s_mov_b32 s79, 0
L_rp_4:
    s_load_dwordx2 s[76:77], s[98:99], s78 glc
    s_add_u32 s79, s79, 1
    s_cmp_gt_u32 s79, 0x100000
    s_cbranch_scc1 chain_kernel_abort
    s_waitcnt lgkmcnt(0)
    s_cmp_lt_u32 s77, 0x2000
    s_cbranch_scc1 L_rp_4
    s_lshr_b32 s77, s95, 8
    s_cmp_eq_u32 s76, -1
    s_cselect_b32 s94, -1, s77
L_rw_3:
    s_waitcnt vmcnt(44)
    s_add_u32 m0, s80, 24576
    s_mov_b32 s81, 1572864
    buffer_load_dwordx4 v163, s[12:15], s81 offen nt lds
    s_add_u32 m0, s80, 25600
    s_mov_b32 s81, 1572864
    buffer_load_dwordx4 v164, s[12:15], s81 offen nt lds
    s_add_u32 m0, s80, 26624
    s_mov_b32 s81, 1703936
    buffer_load_dwordx4 v163, s[12:15], s81 offen nt lds
    s_add_u32 m0, s80, 27648
    s_mov_b32 s81, 1703936
    buffer_load_dwordx4 v164, s[12:15], s81 offen nt lds
    s_mov_b32 s81, 1572864
    buffer_load_dwordx4 v[80:83], v165, s[4:7], s81 offen nt
    s_mov_b32 s81, 393216
    buffer_load_dwordx4 v[144:147], v166, s[40:43], s81 offen nt
    s_mov_b32 s81, 1703936
    buffer_load_dwordx4 v[84:87], v165, s[4:7], s81 offen nt
    s_mov_b32 s81, 409600
    buffer_load_dwordx4 v[148:151], v166, s[40:43], s81 offen nt
    v_mov_b32 v209, 0xff800000
    v_cmp_gt_i32 vcc, 0, v208
    s_nop 1
    v_cndmask_b32 v226, 0, v209, vcc
    v_cmp_gt_i32 vcc, 1, v208
    s_nop 1
    v_cndmask_b32 v227, 0, v209, vcc
    v_cmp_gt_i32 vcc, 2, v208
    s_nop 1
    v_cndmask_b32 v228, 0, v209, vcc
    v_cmp_gt_i32 vcc, 3, v208
    s_nop 1
    v_cndmask_b32 v229, 0, v209, vcc
    v_cmp_gt_i32 vcc, 16, v208
    s_nop 1
    v_cndmask_b32 v230, 0, v209, vcc
    v_cmp_gt_i32 vcc, 17, v208
    s_nop 1
    v_cndmask_b32 v231, 0, v209, vcc
    v_cmp_gt_i32 vcc, 18, v208
    s_nop 1
    v_cndmask_b32 v232, 0, v209, vcc
    v_cmp_gt_i32 vcc, 19, v208
    s_nop 1
    v_cndmask_b32 v233, 0, v209, vcc
    s_waitcnt vmcnt(44)
    s_add_u32 m0, s80, 28672
    s_mov_b32 s81, 1835008
    buffer_load_dwordx4 v163, s[12:15], s81 offen nt lds
    s_add_u32 m0, s80, 29696
    s_mov_b32 s81, 1835008
    buffer_load_dwordx4 v164, s[12:15], s81 offen nt lds
    s_add_u32 m0, s80, 30720
    s_mov_b32 s81, 1966080
    buffer_load_dwordx4 v163, s[12:15], s81 offen nt lds
    s_add_u32 m0, s80, 31744
    s_mov_b32 s81, 1966080
    buffer_load_dwordx4 v164, s[12:15], s81 offen nt lds
    s_mov_b32 s81, 1835008
    buffer_load_dwordx4 v[88:91], v165, s[4:7], s81 offen nt
    s_mov_b32 s81, 458752
    buffer_load_dwordx4 v[152:155], v166, s[40:43], s81 offen nt
    s_mov_b32 s81, 1966080
    buffer_load_dwordx4 v[92:95], v165, s[4:7], s81 offen nt
    s_mov_b32 s81, 475136
    buffer_load_dwordx4 v[156:159], v166, s[40:43], s81 offen nt
    s_cmp_lg_u32 s2, 0
    s_cbranch_scc1 L_rok_5
    v_mov_b32 v208, 31744
    s_cmp_lg_u32 s18, 0
    s_cbranch_scc1 L_rw_6
    v_mov_b32 v209, s94
    ds_write_b32 v208, v209
    s_waitcnt lgkmcnt(0)
L_rw_6:
    s_barrier
    ds_read_b32 v209, v208
    s_waitcnt lgkmcnt(0)
    v_readfirstlane_b32 s20, v209
    s_mov_b32 s2, 1
    s_cmp_eq_u32 s20, -1
    s_cbranch_scc1 L_rok_5
    s_mov_b32 s17, s20
    s_waitcnt vmcnt(0)
    s_barrier
    s_cmp_ge_u32 s17, 32
    s_cbranch_scc1 chain_kernel_end
    s_branch chain_start
L_rok_5:
    s_lshl_b32 s42, s18, 18
    s_add_u32 s42, s42, s53
    buffer_store_dwordx4 v[28:31], v22, s[8:11], s42 offen
    s_lshl_b32 s21, s29, 9
    s_add_u32 s21, s21, s42
    buffer_store_dwordx2 v[28:29], v26, s[8:11], s21 offen
    s_xor_b32 s21, s21, 20480
    buffer_store_dwordx2 v[28:29], v26, s[8:11], s21 offen
    s_lshl_b32 s62, s16, 8
    s_add_u32 s62, s62, 0xd200000
    s_cmp_eq_u32 s17, 1
    s_cselect_b32 s21, s62, 0x10000000
    v_mov_b32 v248, 0
    s_add_u32 s21, s21, 4096
    buffer_store_dword v248, v248, s[8:11], s21 offen sc1
    v_mov_b32 v249, 4
    global_load_dword v249, v249, s[60:61] sc1
    v_bfe_u32 v160, v0, 4, 2
    v_lshlrev_b32 v160, 3, v160
    v_bfe_u32 v162, v0, 2, 2
    v_add_u32 v160, v160, v162
    v_and_b32 v161, 3, v0
    v_bfe_u32 v163, v0, 3, 1
    v_lshlrev_b32 v162, 7, v160
    v_and_b32 v164, 1, v0
    v_lshl_add_u32 v162, v164, 5, v162
    v_bfe_u32 v164, v0, 1, 1
    v_lshl_add_u32 v162, v164, 3, v162
    v_lshl_add_u32 v162, v163, 4, v162
    s_lshr_b32 s21, s18, 1
    s_xor_b32 s21, s21, 1
    s_lshl_b32 s21, s21, 6
    s_add_u32 s21, s21, s80
    v_add_u32 v167, s21, v162
    v_xor_b32 v168, 256, v167
    s_lshr_b32 s21, s18, 1
    s_xor_b32 s21, s21, 0
    s_lshl_b32 s21, s21, 6
    s_add_u32 s21, s21, s80
    v_add_u32 v169, s21, v162
    v_xor_b32 v170, 256, v169
    s_waitcnt vmcnt(44)
    ds_read_b64_tr_b16 a[0:1], v167 offset:0
    ds_read_b64_tr_b16 a[2:3], v167 offset:512
    ds_read_b64_tr_b16 a[4:5], v167 offset:4096
    ds_read_b64_tr_b16 a[6:7], v167 offset:4608
    ds_read_b64_tr_b16 a[32:33], v168 offset:0
    ds_read_b64_tr_b16 a[34:35], v168 offset:512
    ds_read_b64_tr_b16 a[36:37], v168 offset:4096
    ds_read_b64_tr_b16 a[38:39], v168 offset:4608
    s_waitcnt lgkmcnt(0)
    ds_read_b64_tr_b16 a[64:65], v169 offset:0
    ds_read_b64_tr_b16 a[66:67], v169 offset:512
    ds_read_b64_tr_b16 a[68:69], v169 offset:4096
    ds_read_b64_tr_b16 a[70:71], v169 offset:4608
    ds_read_b64_tr_b16 a[96:97], v170 offset:0
    ds_read_b64_tr_b16 a[98:99], v170 offset:512
    ds_read_b64_tr_b16 a[100:101], v170 offset:4096
    ds_read_b64_tr_b16 a[102:103], v170 offset:4608
    s_waitcnt lgkmcnt(0)
    s_waitcnt vmcnt(41)
    ds_read_b64_tr_b16 a[8:9], v167 offset:8192
    ds_read_b64_tr_b16 a[10:11], v167 offset:8704
    ds_read_b64_tr_b16 a[12:13], v167 offset:12288
    ds_read_b64_tr_b16 a[14:15], v167 offset:12800
    ds_read_b64_tr_b16 a[40:41], v168 offset:8192
    ds_read_b64_tr_b16 a[42:43], v168 offset:8704
    ds_read_b64_tr_b16 a[44:45], v168 offset:12288
    ds_read_b64_tr_b16 a[46:47], v168 offset:12800
    s_waitcnt lgkmcnt(0)
    ds_read_b64_tr_b16 a[72:73], v169 offset:8192
    ds_read_b64_tr_b16 a[74:75], v169 offset:8704
    ds_read_b64_tr_b16 a[76:77], v169 offset:12288
    ds_read_b64_tr_b16 a[78:79], v169 offset:12800
    ds_read_b64_tr_b16 a[104:105], v170 offset:8192
    ds_read_b64_tr_b16 a[106:107], v170 offset:8704
    ds_read_b64_tr_b16 a[108:109], v170 offset:12288
    ds_read_b64_tr_b16 a[110:111], v170 offset:12800
    s_waitcnt lgkmcnt(0)
    s_waitcnt vmcnt(25)
    ds_read_b64_tr_b16 a[16:17], v167 offset:16384
    ds_read_b64_tr_b16 a[18:19], v167 offset:16896
    ds_read_b64_tr_b16 a[20:21], v167 offset:20480
    ds_read_b64_tr_b16 a[22:23], v167 offset:20992
    ds_read_b64_tr_b16 a[48:49], v168 offset:16384
    ds_read_b64_tr_b16 a[50:51], v168 offset:16896
    ds_read_b64_tr_b16 a[52:53], v168 offset:20480
    ds_read_b64_tr_b16 a[54:55], v168 offset:20992
    s_waitcnt lgkmcnt(0)
    ds_read_b64_tr_b16 a[80:81], v169 offset:16384
    ds_read_b64_tr_b16 a[82:83], v169 offset:16896
    ds_read_b64_tr_b16 a[84:85], v169 offset:20480
    ds_read_b64_tr_b16 a[86:87], v169 offset:20992
    ds_read_b64_tr_b16 a[112:113], v170 offset:16384
    ds_read_b64_tr_b16 a[114:115], v170 offset:16896
    ds_read_b64_tr_b16 a[116:117], v170 offset:20480
    ds_read_b64_tr_b16 a[118:119], v170 offset:20992
    s_waitcnt lgkmcnt(0)
    s_waitcnt vmcnt(9)
    ds_read_b64_tr_b16 a[24:25], v167 offset:24576
    ds_read_b64_tr_b16 a[26:27], v167 offset:25088
    ds_read_b64_tr_b16 a[28:29], v167 offset:28672
    ds_read_b64_tr_b16 a[30:31], v167 offset:29184
    ds_read_b64_tr_b16 a[56:57], v168 offset:24576
    ds_read_b64_tr_b16 a[58:59], v168 offset:25088
    ds_read_b64_tr_b16 a[60:61], v168 offset:28672
    ds_read_b64_tr_b16 a[62:63], v168 offset:29184
    s_waitcnt lgkmcnt(0)
    ds_read_b64_tr_b16 a[88:89], v169 offset:24576
    ds_read_b64_tr_b16 a[90:91], v169 offset:25088
    ds_read_b64_tr_b16 a[92:93], v169 offset:28672
    ds_read_b64_tr_b16 a[94:95], v169 offset:29184
    ds_read_b64_tr_b16 a[120:121], v170 offset:24576
    ds_read_b64_tr_b16 a[122:123], v170 offset:25088
    ds_read_b64_tr_b16 a[124:125], v170 offset:28672
    ds_read_b64_tr_b16 a[126:127], v170 offset:29184
    s_waitcnt lgkmcnt(0)
    v_add_u32 v171, s80, v1
    v_lshlrev_b32 v162, 6, v160
    v_add_u32 v162, s80, v162
    v_lshl_add_u32 v169, v161, 3, v162
    v_lshl_add_u32 v169, v163, 5, v169
    v_xor_b32 v170, 128, v169
    s_waitcnt vmcnt(0)
    s_barrier
    s_load_dwordx16 s[64:79], s[0:1], 0
    v_lshlrev_b32 v208, 3, v1
    s_lshl2_add_u32 s20, s47, s18
    s_lshl_b32 s20, s20, 13
    s_and_b32 s21, s20, 0x1fffff
    s_waitcnt lgkmcnt(0)
    s_bitcmp1_b32 s20, 21
    s_cselect_b64 s[22:23], s[72:73], s[70:71]
    s_mov_b32 s12, s22
    s_and_b32 s13, s23, 0xffff
    s_mov_b32 s14, 0x200000
    s_mov_b32 s15, 0x00020000
    buffer_load_dword v250, v208, s[12:15], s21 offen
    s_bitcmp1_b32 s20, 21
    s_cselect_b64 s[22:23], s[76:77], s[74:75]
    s_mov_b32 s12, s22
    s_and_b32 s13, s23, 0xffff
    s_mov_b32 s14, 0x200000
    s_mov_b32 s15, 0x00020000
    buffer_load_dword v250, v208, s[12:15], s21 offen
    s_mov_b32 s12, s82
    s_and_b32 s13, s83, 0xffff
    s_mov_b32 s14, 0x400000
    s_mov_b32 s15, 0x00020000
    buffer_load_dword v250, v208, s[12:15], s20 offen
    v_and_b32 v208, 15, v0
    v_lshlrev_b32 v208, 7, v208
    s_lshl_b32 s21, s17, 11
    s_add_u32 s21, s21, s42
    buffer_load_dword v250, v208, s[8:11], s21 offen sc1
    s_cmp_lg_u32 s18, 0
    s_cbranch_scc1 L_m0_7
    s_lshl2_add_u32 s21, s17, s62
    buffer_store_dword v28, v248, s[8:11], s21 offen
    s_lshl_b32 s21, s29, 9
    s_add_u32 s21, s21, s53
    v_min_u32 v246, 0xfffffffe, v246
    v_min_u32 v247, 0xfffffffe, v247
    buffer_store_dwordx2 v[246:247], v26, s[8:11], s21 offen
L_m0_7:
    ds_write_b128 v171, v[32:35] offset:0
    ds_write_b128 v171, v[36:39] offset:1024
    ds_write_b128 v171, v[40:43] offset:2048
    ds_write_b128 v171, v[44:47] offset:3072
    ds_write_b128 v171, v[48:51] offset:4096
    ds_write_b128 v171, v[52:55] offset:5120
    ds_write_b128 v171, v[56:59] offset:6144
    ds_write_b128 v171, v[60:63] offset:7168
    ds_write_b128 v171, v[64:67] offset:8192
    ds_write_b128 v171, v[68:71] offset:9216
    ds_write_b128 v171, v[72:75] offset:10240
    ds_write_b128 v171, v[76:79] offset:11264
    ds_write_b128 v171, v[80:83] offset:12288
    ds_write_b128 v171, v[84:87] offset:13312
    ds_write_b128 v171, v[88:91] offset:14336
    ds_write_b128 v171, v[92:95] offset:15360
    s_waitcnt lgkmcnt(0)
    ds_read_b64_tr_b16 a[128:129], v169 offset:0
    ds_read_b64_tr_b16 a[130:131], v169 offset:256
    ds_read_b64_tr_b16 a[132:133], v169 offset:2048
    ds_read_b64_tr_b16 a[134:135], v169 offset:2304
    ds_read_b64_tr_b16 a[160:161], v170 offset:0
    ds_read_b64_tr_b16 a[162:163], v170 offset:256
    ds_read_b64_tr_b16 a[164:165], v170 offset:2048
    ds_read_b64_tr_b16 a[166:167], v170 offset:2304
    s_waitcnt lgkmcnt(0)
    ds_read_b64_tr_b16 a[136:137], v169 offset:4096
    ds_read_b64_tr_b16 a[138:139], v169 offset:4352
    ds_read_b64_tr_b16 a[140:141], v169 offset:6144
    ds_read_b64_tr_b16 a[142:143], v169 offset:6400
    ds_read_b64_tr_b16 a[168:169], v170 offset:4096
    ds_read_b64_tr_b16 a[170:171], v170 offset:4352
    ds_read_b64_tr_b16 a[172:173], v170 offset:6144
    ds_read_b64_tr_b16 a[174:175], v170 offset:6400
    s_waitcnt lgkmcnt(0)
    ds_read_b64_tr_b16 a[144:145], v169 offset:8192
    ds_read_b64_tr_b16 a[146:147], v169 offset:8448
    ds_read_b64_tr_b16 a[148:149], v169 offset:10240
    ds_read_b64_tr_b16 a[150:151], v169 offset:10496
    ds_read_b64_tr_b16 a[176:177], v170 offset:8192
    ds_read_b64_tr_b16 a[178:179], v170 offset:8448
    ds_read_b64_tr_b16 a[180:181], v170 offset:10240
    ds_read_b64_tr_b16 a[182:183], v170 offset:10496
    s_waitcnt lgkmcnt(0)
    ds_read_b64_tr_b16 a[152:153], v169 offset:12288
    ds_read_b64_tr_b16 a[154:155], v169 offset:12544
    ds_read_b64_tr_b16 a[156:157], v169 offset:14336
    ds_read_b64_tr_b16 a[158:159], v169 offset:14592
    ds_read_b64_tr_b16 a[184:185], v170 offset:12288
    ds_read_b64_tr_b16 a[186:187], v170 offset:12544
    ds_read_b64_tr_b16 a[188:189], v170 offset:14336
    ds_read_b64_tr_b16 a[190:191], v170 offset:14592
    s_waitcnt lgkmcnt(0)
    ds_write_b128 v171, v[96:99] offset:16384
    ds_write_b128 v171, v[100:103] offset:17408
    ds_write_b128 v171, v[104:107] offset:18432
    ds_write_b128 v171, v[108:111] offset:19456
    ds_write_b128 v171, v[112:115] offset:20480
    ds_write_b128 v171, v[116:119] offset:21504
    ds_write_b128 v171, v[120:123] offset:22528
    ds_write_b128 v171, v[124:127] offset:23552
    ds_write_b128 v171, v[128:131] offset:24576
    ds_write_b128 v171, v[132:135] offset:25600
    ds_write_b128 v171, v[136:139] offset:26624
    ds_write_b128 v171, v[140:143] offset:27648
    ds_write_b128 v171, v[144:147] offset:28672
    ds_write_b128 v171, v[148:151] offset:29696
    ds_write_b128 v171, v[152:155] offset:30720
    ds_write_b128 v171, v[156:159] offset:31744
    s_waitcnt lgkmcnt(0)
    ds_read_b64_tr_b16 a[192:193], v169 offset:16384
    ds_read_b64_tr_b16 a[194:195], v169 offset:16640
    ds_read_b64_tr_b16 a[196:197], v169 offset:18432
    ds_read_b64_tr_b16 a[198:199], v169 offset:18688
    ds_read_b64_tr_b16 a[224:225], v170 offset:16384
    ds_read_b64_tr_b16 a[226:227], v170 offset:16640
    ds_read_b64_tr_b16 a[228:229], v170 offset:18432
    ds_read_b64_tr_b16 a[230:231], v170 offset:18688
    s_waitcnt lgkmcnt(0)
    ds_read_b64_tr_b16 a[200:201], v169 offset:20480
    ds_read_b64_tr_b16 a[202:203], v169 offset:20736
    ds_read_b64_tr_b16 a[204:205], v169 offset:22528
    ds_read_b64_tr_b16 a[206:207], v169 offset:22784
    ds_read_b64_tr_b16 a[232:233], v170 offset:20480
    ds_read_b64_tr_b16 a[234:235], v170 offset:20736
    ds_read_b64_tr_b16 a[236:237], v170 offset:22528
    ds_read_b64_tr_b16 a[238:239], v170 offset:22784
    s_waitcnt lgkmcnt(0)
    ds_read_b64_tr_b16 a[208:209], v169 offset:24576
    ds_read_b64_tr_b16 a[210:211], v169 offset:24832
    ds_read_b64_tr_b16 a[212:213], v169 offset:26624
    ds_read_b64_tr_b16 a[214:215], v169 offset:26880
    ds_read_b64_tr_b16 a[240:241], v170 offset:24576
    ds_read_b64_tr_b16 a[242:243], v170 offset:24832
    ds_read_b64_tr_b16 a[244:245], v170 offset:26624
    ds_read_b64_tr_b16 a[246:247], v170 offset:26880
    s_waitcnt lgkmcnt(0)
    ds_read_b64_tr_b16 a[216:217], v169 offset:28672
    ds_read_b64_tr_b16 a[218:219], v169 offset:28928
    ds_read_b64_tr_b16 a[220:221], v169 offset:30720
    ds_read_b64_tr_b16 a[222:223], v169 offset:30976
    ds_read_b64_tr_b16 a[248:249], v170 offset:28672
    ds_read_b64_tr_b16 a[250:251], v170 offset:28928
    ds_read_b64_tr_b16 a[252:253], v170 offset:30720
    ds_read_b64_tr_b16 a[254:255], v170 offset:30976
    s_waitcnt lgkmcnt(0)
    s_mov_b32 s19, 0
    s_mov_b32 s55, 0
    s_mov_b32 s30, 0xc0000
    s_mov_b32 s41, s53
    v_mov_b32 v197, 0
    v_mov_b32 v198, 0
    v_mov_b32 v216, 0x3f803f80
    v_mov_b32 v217, 0x3f803f80
    v_mov_b32 v218, 0x3f803f80
    v_mov_b32 v219, 0x3f803f80
    v_mov_b32 v64, 0
    v_mov_b32 v65, 0
    v_mov_b32 v66, 0
    v_mov_b32 v67, 0
    v_mov_b32 v68, 0
    v_mov_b32 v69, 0
    v_mov_b32 v70, 0
    v_mov_b32 v71, 0
    v_mov_b32 v72, 0
    v_mov_b32 v73, 0
    v_mov_b32 v74, 0
    v_mov_b32 v75, 0
    v_mov_b32 v76, 0
    v_mov_b32 v77, 0
    v_mov_b32 v78, 0
    v_mov_b32 v79, 0
    v_mov_b32 v248, 4
    s_branch L_kvw_8_c
L_kvw_8:
    global_load_dword v249, v248, s[60:61] sc1
    s_add_u32 s33, s33, 1
    s_cmp_gt_u32 s33, 0x100000
    s_cbranch_scc1 chain_kernel_abort
    s_waitcnt vmcnt(0)
L_kvw_8_c:
    v_readfirstlane_b32 s20, v249
    s_and_b32 s21, s20, 0xff
    s_cmp_ge_u32 s21, 15
    s_cbranch_scc1 L_kvok_9
    s_sleep 16
    s_branch L_kvw_8
L_kvok_9:
    s_cmp_ge_u32 s20, 0x800
    s_cselect_b32 s50, 0x2000, 0
    s_add_u32 s52, s50, 0x8000000
    s_add_u32 s48, s48, s50
    v_and_b32 v208, 63, v0
    v_lshlrev_b32 v208, 1, v208
    s_lshr_b32 s22, s17, 4
    s_lshl_b32 s22, s22, 14
    s_and_b32 s23, s17, 15
    s_lshl2_add_u32 s23, s23, s18
    s_lshl_b32 s23, s23, 7
    s_add_u32 s22, s22, s23
    s_xor_b32 s21, s16, 0
    s_lshl_b32 s21, s21, 15
    s_add_u32 s21, s21, s22
    v_add_u32 v8, s21, v208
    s_xor_b32 s21, s16, 1
    s_lshl_b32 s21, s21, 15
    s_add_u32 s21, s21, s22
    v_add_u32 v9, s21, v208
    s_xor_b32 s21, s16, 2
    s_lshl_b32 s21, s21, 15
    s_add_u32 s21, s21, s22
    v_add_u32 v10, s21, v208
    s_xor_b32 s21, s16, 3
    s_lshl_b32 s21, s21, 15
    s_add_u32 s21, s21, s22
    v_add_u32 v11, s21, v208
    s_barrier
    s_add_u32 s21, s19, 0
    s_min_u32 s21, s21, 63
    s_lshl_b32 s31, s21, 21
    s_lshl_b32 s21, s21, 13
    s_and_b32 s21, s21, 0x2000
    s_xor_b32 s21, s21, s48
    s_add_u32 s31, s31, s21
    s_cmp_lg_u32 s18, 1
    s_cbranch_scc1 L_init0_10
    v_mov_b32 v248, 0
    s_lshl2_add_u32 s20, s17, s18
    s_cmp_lg_u32 s20, 5
    s_cbranch_scc1 L_rlo_12
L_rl_11:
    s_load_dword s20, s[60:61], 64 glc
    s_add_u32 s33, s33, 1
    s_cmp_gt_u32 s33, 0x100000
    s_cbranch_scc1 chain_kernel_abort
    s_waitcnt lgkmcnt(0)
    s_cmp_lt_u32 s20, 96
    s_cbranch_scc1 L_rl_11
    v_mov_b32 v249, 1
    buffer_store_dword v249, v248, s[8:11], s62 offen offset:128
    s_branch L_rlok_13
L_rlo_12:
    buffer_load_dword v249, v248, s[8:11], s62 offen offset:128 sc1
    s_add_u32 s33, s33, 1
    s_cmp_gt_u32 s33, 0x100000
    s_cbranch_scc1 chain_kernel_abort
    s_waitcnt vmcnt(0)
    v_readfirstlane_b32 s20, v249
    s_cmp_ge_u32 s20, 1
    s_cbranch_scc1 L_rlok_13
    s_sleep 1
    s_branch L_rlo_12
L_rlok_13:
    s_mov_b32 m0, 40960
    s_nop 0
    buffer_load_dwordx4 v237, s[8:11], s31 offen offset:0 lds
    buffer_load_dwordx4 v237, s[8:11], s31 offen offset:1024 lds
L_init0_10:
    s_cmp_lg_u32 s18, 2
    s_cbranch_scc1 L_init2_14
    v_and_b32 v248, 31, v0
    v_lshlrev_b32 v248, 2, v248
L_initp_15:
    buffer_load_dword v249, v248, s[8:11], s62 offen sc1
    s_add_u32 s33, s33, 1
    s_cmp_gt_u32 s33, 0x100000
    s_cbranch_scc1 chain_kernel_abort
    s_waitcnt vmcnt(0)
    v_cmp_eq_u32 vcc, 0, v249
    s_cbranch_vccz L_init2_14
    s_sleep 2
    s_branch L_initp_15
L_init2_14:
    s_barrier
    s_mov_b32 m0, s54
    s_nop 0
    buffer_load_dwordx4 v235, s[8:11], s31 offen offset:0 lds
    buffer_load_dwordx4 v235, s[8:11], s31 offen offset:1024 lds
    buffer_load_dwordx4 v235, s[8:11], s31 offen offset:2048 lds
    buffer_load_dwordx4 v235, s[8:11], s31 offen offset:3072 lds
    s_waitcnt vmcnt(0) lgkmcnt(0)
    s_barrier
chain_kernel_loop:
    s_mov_b32 s40, s41
    v_mov_b32 v64, 0
    v_mov_b32 v65, 0
    v_mov_b32 v66, 0
    v_mov_b32 v67, 0
    v_mov_b32 v68, 0
    v_mov_b32 v69, 0
    v_mov_b32 v70, 0
    v_mov_b32 v71, 0
    v_mov_b32 v72, 0
    v_mov_b32 v73, 0
    v_mov_b32 v74, 0
    v_mov_b32 v75, 0
    v_mov_b32 v76, 0
    v_mov_b32 v77, 0
    v_mov_b32 v78, 0
    v_mov_b32 v79, 0
    s_add_u32 s30, s30, 0x40000
    s_and_b32 s30, s30, 0xc0000
    s_xor_b32 s20, s30, 0x80000
    s_add_u32 s42, s53, s20
    s_lshl_b32 s43, s19, 18
    s_lshl_b32 s20, s19, 10
    s_and_b32 s20, s20, 0x2000
    s_xor_b32 s20, s20, s52
    s_add_u32 s43, s43, s20
    s_add_u32 s44, s43, 0x20000
    s_add_u32 s20, s30, 0x40000
    s_and_b32 s20, s20, 0xc0000
    s_add_u32 s41, s53, s20
    s_nop 13
    buffer_load_dwordx4 v[32:35], v2, s[8:11], s40 offen offset:0 sc1
    s_nop 13
    buffer_load_dwordx4 v[36:39], v2, s[8:11], s40 offen offset:1024 sc1
    s_nop 13
    buffer_load_dwordx4 v[40:43], v2, s[8:11], s40 offen offset:2048 sc1
    s_nop 13
    buffer_load_dwordx4 v[44:47], v2, s[8:11], s40 offen offset:3072 sc1
Gq_18_s0123:
    s_waitcnt vmcnt(3)
    v_cmp_eq_u32 vcc, -1, v32
    v_mov_b32_dpp v48, v32 row_ror:8 row_mask:0xf bank_mask:0xf
    v_mov_b32_dpp v49, v33 row_ror:8 row_mask:0xf bank_mask:0xf
    v_mov_b32_dpp v50, v34 row_ror:8 row_mask:0xf bank_mask:0xf
    v_mov_b32_dpp v51, v35 row_ror:8 row_mask:0xf bank_mask:0xf
    s_cbranch_vccnz Gq_18_f0123
    v_smfmac_f32_16x16x64_bf16 v[64:67], v[32:35], a[0:7], v19
    v_smfmac_f32_16x16x64_bf16 v[68:71], v[32:35], a[64:71], v19
Gq_18_s123p0:
    s_waitcnt vmcnt(2)
    v_cmp_eq_u32 vcc, -1, v36
    v_smfmac_f32_16x16x64_bf16 v[64:67], v[48:51], a[32:39], v19
    v_mov_b32_dpp v52, v36 row_ror:8 row_mask:0xf bank_mask:0xf
    v_mov_b32_dpp v53, v37 row_ror:8 row_mask:0xf bank_mask:0xf
    v_smfmac_f32_16x16x64_bf16 v[68:71], v[48:51], a[96:103], v19
    v_mov_b32_dpp v54, v38 row_ror:8 row_mask:0xf bank_mask:0xf
    v_mov_b32_dpp v55, v39 row_ror:8 row_mask:0xf bank_mask:0xf
    s_cbranch_vccnz Gq_18_f123p0
    v_smfmac_f32_16x16x64_bf16 v[64:67], v[36:39], a[8:15], v19
    v_smfmac_f32_16x16x64_bf16 v[68:71], v[36:39], a[72:79], v19
Gq_18_s23p1:
    s_waitcnt vmcnt(1)
    v_cmp_eq_u32 vcc, -1, v40
    v_smfmac_f32_16x16x64_bf16 v[64:67], v[52:55], a[40:47], v19
    v_mov_b32_dpp v56, v40 row_ror:8 row_mask:0xf bank_mask:0xf
    v_mov_b32_dpp v57, v41 row_ror:8 row_mask:0xf bank_mask:0xf
    v_smfmac_f32_16x16x64_bf16 v[68:71], v[52:55], a[104:111], v19
    v_mov_b32_dpp v58, v42 row_ror:8 row_mask:0xf bank_mask:0xf
    v_mov_b32_dpp v59, v43 row_ror:8 row_mask:0xf bank_mask:0xf
    s_cbranch_vccnz Gq_18_f23p1
    v_smfmac_f32_16x16x64_bf16 v[64:67], v[40:43], a[16:23], v19
    v_smfmac_f32_16x16x64_bf16 v[68:71], v[40:43], a[80:87], v19
Gq_18_s3p2:
    s_waitcnt vmcnt(0)
    v_cmp_eq_u32 vcc, -1, v44
    v_smfmac_f32_16x16x64_bf16 v[64:67], v[56:59], a[48:55], v19
    v_mov_b32_dpp v60, v44 row_ror:8 row_mask:0xf bank_mask:0xf
    v_mov_b32_dpp v61, v45 row_ror:8 row_mask:0xf bank_mask:0xf
    v_smfmac_f32_16x16x64_bf16 v[68:71], v[56:59], a[112:119], v19
    v_mov_b32_dpp v62, v46 row_ror:8 row_mask:0xf bank_mask:0xf
    v_mov_b32_dpp v63, v47 row_ror:8 row_mask:0xf bank_mask:0xf
    s_cbranch_vccnz Gq_18_f3p2
    v_smfmac_f32_16x16x64_bf16 v[64:67], v[44:47], a[24:31], v19
    v_smfmac_f32_16x16x64_bf16 v[68:71], v[44:47], a[88:95], v19
    v_smfmac_f32_16x16x64_bf16 v[64:67], v[60:63], a[56:63], v19
    v_smfmac_f32_16x16x64_bf16 v[68:71], v[60:63], a[120:127], v19
Gq_18_done:
    v_max3_u32 v20, v33, v34, v35
    v_max3_u32 v208, v37, v38, v39
    v_max3_u32 v209, v41, v42, v43
    v_max3_u32 v210, v45, v46, v47
    ds_write_b64 v12, v[64:65] offset:0
    ds_write_b64 v13, v[66:67] offset:0
    v_max_u32 v20, v20, v208
    v_max3_u32 v20, v20, v209, v210
    ds_write_b64 v14, v[68:69] offset:0
    s_add_u32 m0, s51, 32768
    v_cmp_eq_u32 vcc, -1, v20
    buffer_load_dwordx4 v243, s[8:11], s31 offen offset:0 lds
    buffer_load_dwordx4 v243, s[8:11], s31 offen offset:1024 lds
    v_smfmac_f32_16x16x64_bf16 v[72:75], v[32:35], a[128:135], v19
    v_smfmac_f32_16x16x64_bf16 v[72:75], v[48:51], a[160:167], v19
    s_cbranch_vccnz Gq_18_redo
    s_waitcnt lgkmcnt(0)
    s_barrier
    ds_read_b64 v[80:81], v15 offset:0
    ds_read_b64 v[82:83], v15 offset:512
    ds_read_b64 v[84:85], v15 offset:1024
    v_smfmac_f32_16x16x64_bf16 v[72:75], v[36:39], a[136:143], v19
    v_smfmac_f32_16x16x64_bf16 v[72:75], v[52:55], a[168:175], v19
    s_waitcnt lgkmcnt(2)
    v_pk_add_f32 v[70:71], v[70:71], v[80:81]
    s_waitcnt lgkmcnt(0)
    v_pk_add_f32 v[82:83], v[82:83], v[84:85]
    v_pk_add_f32 v[70:71], v[70:71], v[82:83]
    v_cvt_pk_bf16_f32 v70, v70, v71
    s_cmp_lg_u32 s18, 0
    s_nop 0
    v_mov_b32_dpp v71, v70 quad_perm:[1,0,3,2] row_mask:0xf bank_mask:0xf
    v_perm_b32 v70, v71, v70, v18
    v_min_u32 v70, 0xfffffffe, v70
    buffer_store_dword v70, v4, s[8:11], s40 offen
    v_smfmac_f32_16x16x64_bf16 v[72:75], v[40:43], a[144:151], v19
    v_smfmac_f32_16x16x64_bf16 v[72:75], v[56:59], a[176:183], v19
    v_smfmac_f32_16x16x64_bf16 v[72:75], v[44:47], a[152:159], v19
    v_smfmac_f32_16x16x64_bf16 v[72:75], v[60:63], a[184:191], v19
    s_nop 7
    ds_write_b128 v16, v[72:75] offset:12288
    s_cbranch_scc1 L_help_16
    s_waitcnt vmcnt(1) lgkmcnt(0)
    s_barrier
    ds_read_b128 v[104:107], v1 offset:32768
    ds_read_b128 v[108:111], v1 offset:33792
    ds_read_b128 v[112:115], v1 offset:34816
    ds_read_b128 v[116:119], v1 offset:35840
    buffer_load_dwordx4 v[148:151], v5, s[8:11], s40 offen offset:0 sc1
    buffer_load_dwordx4 v[152:155], v5, s[8:11], s40 offen offset:1024 sc1
    buffer_load_dwordx4 v[156:159], v5, s[8:11], s40 offen offset:2048 sc1
    buffer_load_dwordx4 v[160:163], v5, s[8:11], s40 offen offset:3072 sc1
    ds_read_b128 v[120:123], v1 offset:36864
    ds_read_b128 v[124:127], v1 offset:37888
    ds_read_b128 v[128:131], v1 offset:38912
    ds_read_b128 v[132:135], v1 offset:39936
    ds_read_b128 v[136:139], v1 offset:40960
    ds_read_b128 v[140:143], v1 offset:41984
    s_nop 7
    buffer_load_dwordx4 v[164:167], v5, s[8:11], s40 offen offset:0 sc1
    buffer_load_dwordx4 v[168:171], v5, s[8:11], s40 offen offset:1024 sc1
    buffer_load_dwordx4 v[172:175], v5, s[8:11], s40 offen offset:2048 sc1
    buffer_load_dwordx4 v[176:179], v5, s[8:11], s40 offen offset:3072 sc1
    s_nop 13
    buffer_load_dwordx4 v[32:35], v5, s[8:11], s40 offen offset:0 sc1
    buffer_load_dwordx4 v[36:39], v5, s[8:11], s40 offen offset:1024 sc1
    buffer_load_dwordx4 v[40:43], v5, s[8:11], s40 offen offset:2048 sc1
    buffer_load_dwordx4 v[44:47], v5, s[8:11], s40 offen offset:3072 sc1
    s_waitcnt lgkmcnt(0)
L_sd_19_0_0:
    s_waitcnt vmcnt(11)
    v_max3_u32 v20, v148, v149, v150
    v_mfma_f32_16x16x32_bf16 v[88:91], v[148:151], v[148:151], 0
    v_max_u32 v20, v20, v151
    v_cmp_eq_u32 vcc, -1, v20
    v_mfma_f32_16x16x32_bf16 v[84:87], v[120:123], v[148:151], 0
    v_mfma_f32_16x16x32_bf16 v[80:83], v[104:107], v[148:151], 0
    s_cbranch_vccnz L_sd_19_1_0
L_sd_19_0_1:
    s_waitcnt vmcnt(10)
    v_max3_u32 v20, v152, v153, v154
    v_mfma_f32_16x16x32_bf16 v[100:103], v[152:155], v[152:155], v[88:91]
    v_max_u32 v20, v20, v155
    v_cmp_eq_u32 vcc, -1, v20
    v_mfma_f32_16x16x32_bf16 v[96:99], v[124:127], v[152:155], v[84:87]
    v_mfma_f32_16x16x32_bf16 v[92:95], v[108:111], v[152:155], v[80:83]
    s_cbranch_vccnz L_sd_19_1_1
L_sd_19_0_2:
    s_waitcnt vmcnt(9)
    v_max3_u32 v20, v156, v157, v158
    v_mfma_f32_16x16x32_bf16 v[228:231], v[156:159], v[156:159], v[100:103]
    v_max_u32 v20, v20, v159
    v_cmp_eq_u32 vcc, -1, v20
    v_mfma_f32_16x16x32_bf16 v[224:227], v[128:131], v[156:159], v[96:99]
    v_mfma_f32_16x16x32_bf16 v[220:223], v[112:115], v[156:159], v[92:95]
    s_cbranch_vccnz L_sd_19_1_2
L_sd_19_0_3:
    s_waitcnt vmcnt(8)
    v_max3_u32 v20, v160, v161, v162
    v_mfma_f32_16x16x32_bf16 v[188:191], v[160:163], v[160:163], v[228:231]
    v_max_u32 v20, v20, v163
    v_cmp_eq_u32 vcc, -1, v20
    v_mfma_f32_16x16x32_bf16 v[184:187], v[132:135], v[160:163], v[224:227]
    v_mfma_f32_16x16x32_bf16 v[180:183], v[116:119], v[160:163], v[220:223]
    v_mov_b32_dpp v188, v189 row_ror:8 row_mask:0xf bank_mask:0xc
    v_mov_b32_dpp v190, v191 row_ror:8 row_mask:0xf bank_mask:0xc
    s_cbranch_vccnz L_sd_19_1_3
L_sd_19:
    s_barrier
    v_permlane32_swap_b32 v188, v190
    ds_read_b64 v[144:145], v26 offset:28672
    s_cmp_eq_u32 s19, 63
    s_cbranch_scc1 chain_kernel_fin
    v_mov_b32_dpp v180, v184 row_ror:8 row_mask:0xf bank_mask:0xc
    v_mov_b32_dpp v181, v185 row_ror:8 row_mask:0xf bank_mask:0xc
    v_mov_b32_dpp v182, v186 row_ror:8 row_mask:0xf bank_mask:0xc
    v_mov_b32_dpp v183, v187 row_ror:8 row_mask:0xf bank_mask:0xc
    v_max3_f32 v208, v190, v180, v181
    v_max3_f32 v208, v208, v182, v183
    v_cvt_pk_bf16_f32 v180, 0, v180
    v_cvt_pk_bf16_f32 v181, 0, v181
    v_max_f32_dpp v208, v208, v208 row_ror:8 row_mask:0xf bank_mask:0xf
    v_mov_b32 v209, v208
    v_cvt_pk_bf16_f32 v182, 0, v182
    v_cvt_pk_bf16_f32 v183, 0, v183
    v_permlane16_swap_b32 v208, v209
    v_cvt_pk_bf16_f32 v190, 0, v190
    v_max_f32 v208, v208, v209
    v_mov_b32 v209, v208
    v_pk_mul_f32 v[180:181], v[180:181], s[58:59]
    v_pk_mul_f32 v[182:183], v[182:183], s[58:59]
    v_permlane32_swap_b32 v208, v209
    v_mul_f32 v190, s58, v190
    v_max_f32 v208, v208, v209
    v_cvt_pk_bf16_f32 v190, 0, v190
    v_cvt_pk_bf16_f32 v208, 0, v208
    v_cvt_pk_bf16_f32 v180, 0, v180
    v_mul_f32 v208, s58, v208
    v_cvt_pk_bf16_f32 v181, 0, v181
    v_cvt_pk_bf16_f32 v208, 0, v208
    v_cvt_pk_bf16_f32 v182, 0, v182
    v_mul_f32 v208, s56, v208
    v_cvt_pk_bf16_f32 v183, 0, v183
    v_fma_f32 v190, v190, s56, -v208
    v_pk_fma_f32 v[180:181], v[180:181], s[56:57], v[208:209] op_sel_hi:[1,1,0] neg_lo:[0,0,1] neg_hi:[0,0,1]
    v_exp_f32 v190, v190
    v_pk_fma_f32 v[182:183], v[182:183], s[56:57], v[208:209] op_sel_hi:[1,1,0] neg_lo:[0,0,1] neg_hi:[0,0,1]
    v_exp_f32 v180, v180
    v_mov_b32_dpp v209, v190 row_ror:8 row_mask:0xf bank_mask:0xf
    v_exp_f32 v181, v181
    v_cvt_pk_bf16_f32 v196, v190, v209
    v_cvt_pk_bf16_f32 v199, v190, v209
    v_exp_f32 v182, v182
    v_mfma_f32_16x16x16_bf16 v[184:187], v[216:217], v[196:197], 0
    v_exp_f32 v183, v183
    s_waitcnt lgkmcnt(0)
    v_mfma_f32_16x16x16_bf16 v[200:203], v[144:145], v[196:197], 0
    v_cvt_pk_bf16_f32 v192, v180, v181
    v_cvt_pk_bf16_f32 v193, v182, v183
    v_mfma_f32_16x16x16_bf16 v[204:207], v[144:145], v[198:199], 0
    v_mov_b32_dpp v194, v192 row_ror:8 row_mask:0xf bank_mask:0xf
    v_mov_b32_dpp v195, v193 row_ror:8 row_mask:0xf bank_mask:0xf
    s_mov_b64 exec, s[24:25]
    s_nop 0
    v_mfma_f32_16x16x32_bf16 v[184:187], v[216:219], v[192:195], v[184:187]
    v_mfma_f32_16x16x32_bf16 v[200:203], v[136:139], v[192:195], v[200:203]
    v_mfma_f32_16x16x32_bf16 v[204:207], v[140:143], v[192:195], v[204:207]
    s_nop 0
    v_rcp_f32 v184, v184
    s_nop 1
    v_pk_mul_f32 v[200:201], v[200:201], v[184:185] op_sel_hi:[1,0]
    v_pk_mul_f32 v[202:203], v[202:203], v[184:185] op_sel_hi:[1,0]
    v_cvt_pk_bf16_f32 v200, v200, v201
    v_cvt_pk_bf16_f32 v201, v202, v203
    v_pk_mul_f32 v[204:205], v[204:205], v[184:185] op_sel_hi:[1,0]
    v_pk_mul_f32 v[206:207], v[206:207], v[184:185] op_sel_hi:[1,0]
    v_cvt_pk_bf16_f32 v202, v204, v205
    v_cvt_pk_bf16_f32 v203, v206, v207
    v_min_u32 v200, 0xfffffffe, v200
    v_min_u32 v201, 0xfffffffe, v201
    v_min_u32 v202, 0xfffffffe, v202
    v_min_u32 v203, 0xfffffffe, v203
    buffer_store_dwordx4 v[200:203], v6, s[8:11], s40 offen
    s_mov_b64 exec, -1
L_b4_17:
    s_barrier
    s_add_u32 s21, s19, 1
    s_min_u32 s21, s21, 63
    s_lshl_b32 s31, s21, 21
    s_lshl_b32 s21, s21, 13
    s_and_b32 s21, s21, 0x2000
    s_xor_b32 s21, s21, s48
    s_add_u32 s31, s31, s21
    s_add_u32 s19, s19, 1
    s_nop 15
    s_nop 11
    buffer_load_dwordx4 v[32:35], v3, s[8:11], s40 offen offset:0 sc1
    s_nop 13
    buffer_load_dwordx4 v[36:39], v3, s[8:11], s40 offen offset:1024 sc1
    s_nop 13
    buffer_load_dwordx4 v[40:43], v3, s[8:11], s40 offen offset:2048 sc1
    s_nop 13
    buffer_load_dwordx4 v[44:47], v3, s[8:11], s40 offen offset:3072 sc1
Go_20_s0123:
    s_waitcnt vmcnt(3)
    v_cmp_eq_u32 vcc, -1, v32
    v_mov_b32_dpp v48, v32 row_ror:8 row_mask:0xf bank_mask:0xf
    v_mov_b32_dpp v49, v33 row_ror:8 row_mask:0xf bank_mask:0xf
    v_mov_b32_dpp v50, v34 row_ror:8 row_mask:0xf bank_mask:0xf
    v_mov_b32_dpp v51, v35 row_ror:8 row_mask:0xf bank_mask:0xf
    s_cbranch_vccnz Go_20_f0123
    v_smfmac_f32_16x16x64_bf16 v[76:79], v[32:35], a[192:199], v19
    v_smfmac_f32_16x16x64_bf16 v[76:79], v[48:51], a[224:231], v19
Go_20_s123:
    s_waitcnt vmcnt(2)
    v_cmp_eq_u32 vcc, -1, v36
    v_mov_b32_dpp v52, v36 row_ror:8 row_mask:0xf bank_mask:0xf
    v_mov_b32_dpp v53, v37 row_ror:8 row_mask:0xf bank_mask:0xf
    v_mov_b32_dpp v54, v38 row_ror:8 row_mask:0xf bank_mask:0xf
    v_mov_b32_dpp v55, v39 row_ror:8 row_mask:0xf bank_mask:0xf
    s_cbranch_vccnz Go_20_f123
    v_smfmac_f32_16x16x64_bf16 v[76:79], v[36:39], a[200:207], v19
    v_smfmac_f32_16x16x64_bf16 v[76:79], v[52:55], a[232:239], v19
Go_20_s23:
    s_waitcnt vmcnt(1)
    v_cmp_eq_u32 vcc, -1, v40
    v_mov_b32_dpp v56, v40 row_ror:8 row_mask:0xf bank_mask:0xf
    v_mov_b32_dpp v57, v41 row_ror:8 row_mask:0xf bank_mask:0xf
    v_mov_b32_dpp v58, v42 row_ror:8 row_mask:0xf bank_mask:0xf
    v_mov_b32_dpp v59, v43 row_ror:8 row_mask:0xf bank_mask:0xf
    s_cbranch_vccnz Go_20_f23
    v_smfmac_f32_16x16x64_bf16 v[76:79], v[40:43], a[208:215], v19
    v_smfmac_f32_16x16x64_bf16 v[76:79], v[56:59], a[240:247], v19
Go_20_s3:
    s_waitcnt vmcnt(0)
    v_cmp_eq_u32 vcc, -1, v44
    v_mov_b32_dpp v60, v44 row_ror:8 row_mask:0xf bank_mask:0xf
    v_mov_b32_dpp v61, v45 row_ror:8 row_mask:0xf bank_mask:0xf
    v_mov_b32_dpp v62, v46 row_ror:8 row_mask:0xf bank_mask:0xf
    v_mov_b32_dpp v63, v47 row_ror:8 row_mask:0xf bank_mask:0xf
    s_cbranch_vccnz Go_20_f3
    v_smfmac_f32_16x16x64_bf16 v[76:79], v[44:47], a[216:223], v19
    v_smfmac_f32_16x16x64_bf16 v[76:79], v[60:63], a[248:255], v19
Go_20_done:
    v_max3_u32 v20, v33, v34, v35
    v_max3_u32 v208, v37, v38, v39
    v_max3_u32 v209, v41, v42, v43
    v_max3_u32 v210, v45, v46, v47
    v_max_u32 v20, v20, v208
    v_max3_u32 v20, v20, v209, v210
    v_cmp_eq_u32 vcc, -1, v20
    s_nop 0
    ds_write_b32 v238, v76 offset:20480
    ds_write_b32 v239, v77 offset:20480
    ds_write_b32 v240, v78 offset:20480
    s_cbranch_vccnz Go_20_redo
    s_waitcnt lgkmcnt(0)
    s_barrier
    ds_read_b32 v80, v17 offset:20480
    ds_read_b32 v81, v17 offset:20736
    ds_read_b32 v82, v17 offset:20992
    s_cmp_lt_u32 s18, 2
    s_waitcnt lgkmcnt(2)
    v_add_f32 v80, v80, v79
    s_waitcnt lgkmcnt(0)
    v_add_f32 v81, v81, v82
    v_add_f32 v80, v80, v81
    v_cvt_pk_bf16_f32 v80, 0, v80
    v_min_u32 v80, 0xfffe0000, v80
    buffer_store_short_d16_hi v80, v8, s[8:11], s43 offen sc1
    buffer_store_short_d16_hi v80, v8, s[8:11], s44 offen sc1
    ds_read_b128 v[164:167], v241 offset:51200
    ds_read_b128 v[168:171], v241 offset:51712
    ds_read_b128 v[172:175], v241 offset:52224
    v_mov_b32 v220, 0
    v_mov_b32 v221, 0
    v_mov_b32 v222, 0
    v_mov_b32 v223, 0
    v_mov_b32 v224, 0
    v_mov_b32 v225, 0
    ds_read_b128 v[176:179], v241 offset:52736
    s_waitcnt lgkmcnt(3)
    v_mfma_f32_16x16x32_bf16 v[188:191], v[164:167], v[148:151], 0
    s_waitcnt lgkmcnt(2)
    v_mfma_f32_16x16x32_bf16 v[188:191], v[168:171], v[152:155], v[188:191]
    s_waitcnt lgkmcnt(1)
    v_mfma_f32_16x16x32_bf16 v[188:191], v[172:175], v[156:159], v[188:191]
    s_waitcnt lgkmcnt(0)
    v_mfma_f32_16x16x32_bf16 v[188:191], v[176:179], v[160:163], v[188:191]
    s_nop 7
    v_cvt_pk_bf16_f32 v188, 0, v188
    v_cvt_pk_bf16_f32 v189, 0, v189
    v_pk_mul_f32 v[188:189], v[188:189], s[58:59]
    v_cvt_pk_bf16_f32 v188, 0, v188
    v_cvt_pk_bf16_f32 v189, 0, v189
    v_max3_f32 v86, v86, v188, v189
    v_mov_b32 v87, v86
    buffer_load_short_d16_hi v220, v9, s[8:11], s43 offen sc1
    buffer_load_short_d16_hi v221, v10, s[8:11], s43 offen sc1
    buffer_load_short_d16_hi v222, v11, s[8:11], s43 offen sc1
    s_nop 1
    v_permlane16_swap_b32 v86, v87
    v_max_f32 v86, v86, v87
    v_mov_b32 v87, v86
    s_nop 1
    v_permlane32_swap_b32 v86, v87
    v_max_f32 v86, v86, v87
    v_mul_f32 v86, s56, v86
    v_pk_fma_f32 v[180:181], v[180:181], s[56:57], v[86:87] op_sel_hi:[1,1,0] neg_lo:[0,0,1] neg_hi:[0,0,1]
    v_pk_fma_f32 v[182:183], v[182:183], s[56:57], v[86:87] op_sel_hi:[1,1,0] neg_lo:[0,0,1] neg_hi:[0,0,1]
    v_pk_fma_f32 v[184:185], v[184:185], s[56:57], v[86:87] op_sel_hi:[1,1,0] neg_lo:[0,0,1] neg_hi:[0,0,1]
    v_pk_fma_f32 v[186:187], v[186:187], s[56:57], v[86:87] op_sel_hi:[1,1,0] neg_lo:[0,0,1] neg_hi:[0,0,1]
    v_pk_fma_f32 v[188:189], v[188:189], s[56:57], v[86:87] op_sel_hi:[1,1,0] neg_lo:[0,0,1] neg_hi:[0,0,1]
    v_exp_f32 v180, v180
    v_exp_f32 v181, v181
    v_exp_f32 v182, v182
    v_exp_f32 v183, v183
    v_exp_f32 v184, v184
    v_exp_f32 v185, v185
    v_exp_f32 v186, v186
    v_exp_f32 v187, v187
    v_exp_f32 v188, v188
    buffer_load_short_d16_hi v223, v9, s[8:11], s44 offen sc1
    buffer_load_short_d16_hi v224, v10, s[8:11], s44 offen sc1
    buffer_load_short_d16_hi v225, v11, s[8:11], s44 offen sc1
    s_add_u32 m0, s51, 43008
    v_exp_f32 v189, v189
    v_pk_add_f32 v[88:89], v[180:181], v[182:183]
    v_pk_add_f32 v[90:91], v[184:185], v[186:187]
    v_pk_add_f32 v[88:89], v[88:89], v[188:189]
    v_pk_add_f32 v[88:89], v[88:89], v[90:91]
    v_add_f32 v88, v88, v89
    buffer_load_dwordx4 v244, s[8:11], s31 offen offset:0 lds
    v_mov_b32 v87, v88
    s_nop 1
    v_permlane16_swap_b32 v88, v87
    v_add_f32 v88, v88, v87
    v_mov_b32 v87, v88
    s_nop 1
    buffer_load_dwordx4 v244, s[8:11], s31 offen offset:1024 lds
    v_permlane32_swap_b32 v88, v87
    v_add_f32 v88, v88, v87
    v_rcp_f32 v88, v88
    s_nop 0
    v_pk_mul_f32 v[180:181], v[180:181], v[88:89] op_sel_hi:[1,0]
    v_pk_mul_f32 v[182:183], v[182:183], v[88:89] op_sel_hi:[1,0]
    v_pk_mul_f32 v[184:185], v[184:185], v[88:89] op_sel_hi:[1,0]
    v_pk_mul_f32 v[186:187], v[186:187], v[88:89] op_sel_hi:[1,0]
    v_pk_mul_f32 v[188:189], v[188:189], v[88:89] op_sel_hi:[1,0]
    v_cvt_pk_bf16_f32 v192, v180, v181
    v_cvt_pk_bf16_f32 v193, v182, v183
    v_cvt_pk_bf16_f32 v194, v184, v185
    v_cvt_pk_bf16_f32 v195, v186, v187
    v_cvt_pk_bf16_f32 v196, v188, v189
    v_cvt_pk_bf16_f32 v199, v188, v189
    v_mfma_f32_16x16x32_bf16 v[200:203], v[136:139], v[192:195], 0
    v_mfma_f32_16x16x32_bf16 v[204:207], v[140:143], v[192:195], 0
    v_mfma_f32_16x16x16_bf16 v[200:203], v[144:145], v[196:197], v[200:203]
    v_mfma_f32_16x16x16_bf16 v[204:207], v[144:145], v[198:199], v[204:207]
    s_waitcnt vmcnt(7)
    v_add_f32 v208, v80, v220
    s_waitcnt vmcnt(5)
    v_max3_u32 v20, v220, v221, v222
    v_add_f32 v209, v221, v222
    v_cmp_eq_u32 vcc, 0xffff0000, v20
    v_add_f32 v208, v208, v209
    s_nop 1
    v_mov_b32_dpp v209, v208 quad_perm:[1,0,3,2] row_mask:0xf bank_mask:0xf
    s_mov_b64 exec, s[26:27]
    v_cvt_pk_bf16_f32 v208, v208, v209
    v_min_u32 v208, 0xfffffffe, v208
    s_cbranch_vccnz L_pf_22
L_pd_21:
    buffer_store_dword v208, v7, s[8:11], s41 offen
    s_mov_b64 exec, -1
    s_branch chain_kernel_loop
L_help_16:
    s_waitcnt vmcnt(1) lgkmcnt(0)
    s_barrier
    s_cmp_ge_u32 s18, 2
    s_cbranch_scc1 L_w2_26
    ds_read_b128 v[80:83], v1 offset:12288
    ds_read_b128 v[84:87], v1 offset:14336
    ds_read_b128 v[88:91], v1 offset:15360
    s_waitcnt lgkmcnt(2)
    v_pk_add_f32 v[72:73], v[72:73], v[82:83]
    v_pk_add_f32 v[74:75], v[74:75], v[80:81]
    s_waitcnt lgkmcnt(1)
    v_pk_add_f32 v[72:73], v[72:73], v[86:87]
    v_pk_add_f32 v[74:75], v[74:75], v[84:85]
    s_waitcnt lgkmcnt(0)
    v_pk_add_f32 v[72:73], v[72:73], v[88:89]
    v_pk_add_f32 v[74:75], v[74:75], v[90:91]
    v_cvt_pk_bf16_f32 v144, v72, v73
    v_cvt_pk_bf16_f32 v145, v74, v75
    s_nop 1
    v_permlane32_swap_b32 v144, v145
    s_nop 1
    ds_write_b64 v234, v[144:145] offset:28672
    s_add_u32 s21, s19, 1
    s_min_u32 s21, s21, 63
    s_lshl_b32 s63, s21, 21
    s_lshl_b32 s21, s21, 13
    s_and_b32 s21, s21, 0x2000
    s_xor_b32 s21, s21, s48
    s_add_u32 s63, s63, s21
    s_nop 15
    s_nop 15
    s_nop 0
    buffer_load_dword v250, v25, s[8:11], s63 offen sc1
    s_add_u32 s20, s19, 2
    s_min_u32 s20, s20, 63
    s_bfm_b64 s[22:23], s20, 0
    s_and_b32 s22, s22, 0x204225f
    s_and_b32 s23, s23, 0x80004004
    s_bcnt1_i32_b64 s32, s[22:23]
    s_lshl_b32 s32, s32, 2
    s_add_u32 s32, s32, 64
    s_cmp_eq_u32 s47, 1
    s_cselect_b32 s32, s32, s55
    s_add_u32 s21, s19, 1
    s_min_u32 s21, s21, 63
    s_lshl_b32 s31, s21, 21
    s_lshl_b32 s21, s21, 13
    s_and_b32 s21, s21, 0x2000
    s_xor_b32 s21, s21, s48
    s_add_u32 s31, s31, s21
    s_waitcnt lgkmcnt(0)
    s_cmp_eq_u32 s32, s55
    s_cbranch_scc1 L_nog_29
    s_load_dword s22, s[60:61], s32 glc
L_nog_29:
    s_mov_b32 s23, 1
    s_barrier
    s_cmp_lg_u32 s19, 0
    s_cbranch_scc1 L_ns0_32
    v_mov_b32 v248, 0
    s_lshl2_add_u32 s20, s17, s18
    s_cmp_lg_u32 s20, 5
    s_cbranch_scc1 L_rlo_34
L_rl_33:
    s_load_dword s20, s[60:61], 68 glc
    s_add_u32 s33, s33, 1
    s_cmp_gt_u32 s33, 0x100000
    s_cbranch_scc1 chain_kernel_abort
    s_waitcnt lgkmcnt(0)
    s_cmp_lt_u32 s20, 96
    s_cbranch_scc1 L_rl_33
    v_mov_b32 v249, 2
    buffer_store_dword v249, v248, s[8:11], s62 offen offset:128
    s_branch L_rlok_35
L_rlo_34:
    buffer_load_dword v249, v248, s[8:11], s62 offen offset:128 sc1
    s_add_u32 s33, s33, 1
    s_cmp_gt_u32 s33, 0x100000
    s_cbranch_scc1 chain_kernel_abort
    s_waitcnt vmcnt(0)
    v_readfirstlane_b32 s20, v249
    s_cmp_ge_u32 s20, 2
    s_cbranch_scc1 L_rlok_35
    s_sleep 1
    s_branch L_rlo_34
L_rlok_35:
L_ns0_32:
    s_mov_b32 m0, 40960
    s_nop 0
    buffer_load_dwordx4 v237, s[8:11], s31 offen offset:0 lds
    buffer_load_dwordx4 v237, s[8:11], s31 offen offset:1024 lds
    s_cmp_lg_u32 s47, 0
    s_cbranch_scc1 L_nof_31
    s_atomic_add s23, s[60:61], 208
L_nof_31:
    buffer_store_dwordx4 v[28:31], v22, s[8:11], s42 offen
    s_lshl_b32 s21, s29, 9
    s_add_u32 s21, s21, s42
    buffer_store_dwordx2 v[28:29], v26, s[8:11], s21 offen
    s_xor_b32 s21, s21, 20480
    buffer_store_dwordx2 v[28:29], v26, s[8:11], s21 offen
    s_cmp_eq_u32 s32, s55
    s_cbranch_scc1 L_he_28
    s_mov_b32 s55, s32
L_gr_30:
    s_waitcnt lgkmcnt(0)
    s_cmp_ge_u32 s22, 96
    s_cbranch_scc1 L_he_28
    s_add_u32 s33, s33, 1
    s_cmp_gt_u32 s33, 0x100000
    s_cbranch_scc1 chain_kernel_abort
    s_load_dword s22, s[60:61], s32 glc
    s_branch L_gr_30
L_w2_26:
    ds_read_b128 v[148:151], v242 offset:43008
    ds_read_b128 v[104:107], v1 offset:32768
    ds_read_b128 v[108:111], v1 offset:36864
    ds_read_b128 v[152:155], v242 offset:44032
    ds_read_b128 v[112:115], v1 offset:33792
    ds_read_b128 v[116:119], v1 offset:37888
    ds_read_b128 v[156:159], v242 offset:45056
    ds_read_b128 v[120:123], v1 offset:34816
    ds_read_b128 v[124:127], v1 offset:38912
    ds_read_b128 v[160:163], v242 offset:46080
    ds_read_b128 v[128:131], v1 offset:35840
    ds_read_b128 v[132:135], v1 offset:39936
    ds_read_b128 v[136:139], v1 offset:40960
    ds_read_b128 v[140:143], v1 offset:41984
    v_cvt_pk_bf16_f32 v200, v200, v201
    v_cvt_pk_bf16_f32 v201, v202, v203
    v_cvt_pk_bf16_f32 v202, v204, v205
    v_cvt_pk_bf16_f32 v203, v206, v207
    s_add_u32 s21, s19, -1
    s_lshl_b32 s32, s21, 21
    s_lshl_b32 s21, s21, 13
    s_and_b32 s21, s21, 0x2000
    s_xor_b32 s21, s21, s48
    s_add_u32 s32, s32, s21
    s_waitcnt lgkmcnt(11)
    v_mfma_f32_16x16x32_bf16 v[180:183], v[104:107], v[148:151], 0
    v_mfma_f32_16x16x32_bf16 v[184:187], v[108:111], v[148:151], 0
    s_waitcnt lgkmcnt(8)
    v_mfma_f32_16x16x32_bf16 v[180:183], v[112:115], v[152:155], v[180:183]
    v_mfma_f32_16x16x32_bf16 v[184:187], v[116:119], v[152:155], v[184:187]
    s_waitcnt lgkmcnt(5)
    v_mfma_f32_16x16x32_bf16 v[180:183], v[120:123], v[156:159], v[180:183]
    v_mfma_f32_16x16x32_bf16 v[184:187], v[124:127], v[156:159], v[184:187]
    s_waitcnt lgkmcnt(2)
    v_mfma_f32_16x16x32_bf16 v[180:183], v[128:131], v[160:163], v[180:183]
    v_mfma_f32_16x16x32_bf16 v[184:187], v[132:135], v[160:163], v[184:187]
    buffer_store_dwordx4 v[200:203], v23, s[8:11], s32 offen sc1
    s_nop 6
    v_cvt_pk_bf16_f32 v180, 0, v180
    v_cvt_pk_bf16_f32 v181, 0, v181
    v_cvt_pk_bf16_f32 v182, 0, v182
    v_cvt_pk_bf16_f32 v183, 0, v183
    v_cvt_pk_bf16_f32 v184, 0, v184
    v_cvt_pk_bf16_f32 v185, 0, v185
    v_cvt_pk_bf16_f32 v186, 0, v186
    v_cvt_pk_bf16_f32 v187, 0, v187
    v_pk_mul_f32 v[180:181], v[180:181], s[58:59]
    v_pk_mul_f32 v[182:183], v[182:183], s[58:59]
    v_pk_mul_f32 v[184:185], v[184:185], s[58:59]
    v_pk_mul_f32 v[186:187], v[186:187], s[58:59]
    v_cvt_pk_bf16_f32 v180, 0, v180
    v_cvt_pk_bf16_f32 v181, 0, v181
    v_cvt_pk_bf16_f32 v182, 0, v182
    v_cvt_pk_bf16_f32 v183, 0, v183
    v_cvt_pk_bf16_f32 v184, 0, v184
    v_cvt_pk_bf16_f32 v185, 0, v185
    v_cvt_pk_bf16_f32 v186, 0, v186
    v_cvt_pk_bf16_f32 v187, 0, v187
    v_pk_add_f32 v[180:181], v[180:181], v[226:227]
    v_pk_add_f32 v[182:183], v[182:183], v[228:229]
    v_pk_add_f32 v[184:185], v[184:185], v[230:231]
    v_pk_add_f32 v[186:187], v[186:187], v[232:233]
    v_max3_f32 v86, v180, v181, v182
    v_max3_f32 v87, v183, v184, v185
    v_max3_f32 v86, v86, v186, v187
    v_max_f32 v86, v86, v87
    s_cmp_eq_u32 s18, 3
    s_waitcnt lgkmcnt(0)
    s_barrier
    ds_read_b64 v[144:145], v26 offset:28672
    s_cbranch_scc0 L_w3_27
    s_mov_b32 m0, 51200
    s_nop 0
    buffer_load_dwordx4 v24, s[8:11], s40 offen offset:0 sc1 lds
    s_mov_b32 m0, 50176
    s_nop 0
    buffer_load_dwordx4 v24, s[8:11], s40 offen offset:2048 sc1 lds
L_w3_27:
L_he_28:
    s_cmp_lg_u32 s19, 63
    s_cbranch_scc1 L_b4_17
chain_kernel_fin:
    s_waitcnt vmcnt(0) lgkmcnt(0)
    s_barrier
    s_cmp_lt_u32 s18, 2
    s_cbranch_scc1 L_f2_36
    ds_read_b128 v[164:167], v241 offset:51200
    ds_read_b128 v[168:171], v241 offset:51712
    ds_read_b128 v[172:175], v241 offset:52224
    ds_read_b128 v[176:179], v241 offset:52736
    s_waitcnt lgkmcnt(3)
    v_mfma_f32_16x16x32_bf16 v[188:191], v[164:167], v[148:151], 0
    s_waitcnt lgkmcnt(2)
    v_mfma_f32_16x16x32_bf16 v[188:191], v[168:171], v[152:155], v[188:191]
    s_waitcnt lgkmcnt(1)
    v_mfma_f32_16x16x32_bf16 v[188:191], v[172:175], v[156:159], v[188:191]
    s_waitcnt lgkmcnt(0)
    v_mfma_f32_16x16x32_bf16 v[188:191], v[176:179], v[160:163], v[188:191]
    s_nop 7
    v_cvt_pk_bf16_f32 v188, 0, v188
    v_cvt_pk_bf16_f32 v189, 0, v189
    v_pk_mul_f32 v[188:189], v[188:189], s[58:59]
    v_cvt_pk_bf16_f32 v188, 0, v188
    v_cvt_pk_bf16_f32 v189, 0, v189
    v_max3_f32 v86, v86, v188, v189
    v_mov_b32 v87, v86
    s_nop 1
    v_permlane16_swap_b32 v86, v87
    v_max_f32 v86, v86, v87
    v_mov_b32 v87, v86
    s_nop 1
    v_permlane32_swap_b32 v86, v87
    v_max_f32 v86, v86, v87
    v_mul_f32 v86, s56, v86
    v_pk_fma_f32 v[180:181], v[180:181], s[56:57], v[86:87] op_sel_hi:[1,1,0] neg_lo:[0,0,1] neg_hi:[0,0,1]
    v_pk_fma_f32 v[182:183], v[182:183], s[56:57], v[86:87] op_sel_hi:[1,1,0] neg_lo:[0,0,1] neg_hi:[0,0,1]
    v_pk_fma_f32 v[184:185], v[184:185], s[56:57], v[86:87] op_sel_hi:[1,1,0] neg_lo:[0,0,1] neg_hi:[0,0,1]
    v_pk_fma_f32 v[186:187], v[186:187], s[56:57], v[86:87] op_sel_hi:[1,1,0] neg_lo:[0,0,1] neg_hi:[0,0,1]
    v_pk_fma_f32 v[188:189], v[188:189], s[56:57], v[86:87] op_sel_hi:[1,1,0] neg_lo:[0,0,1] neg_hi:[0,0,1]
    v_exp_f32 v180, v180
    v_exp_f32 v181, v181
    v_exp_f32 v182, v182
    v_exp_f32 v183, v183
    v_exp_f32 v184, v184
    v_exp_f32 v185, v185
    v_exp_f32 v186, v186
    v_exp_f32 v187, v187
    v_exp_f32 v188, v188
    v_exp_f32 v189, v189
    v_pk_add_f32 v[88:89], v[180:181], v[182:183]
    v_pk_add_f32 v[90:91], v[184:185], v[186:187]
    v_pk_add_f32 v[88:89], v[88:89], v[188:189]
    v_pk_add_f32 v[88:89], v[88:89], v[90:91]
    v_add_f32 v88, v88, v89
    v_mov_b32 v87, v88
    s_nop 1
    v_permlane16_swap_b32 v88, v87
    v_add_f32 v88, v88, v87
    v_mov_b32 v87, v88
    s_nop 1
    v_permlane32_swap_b32 v88, v87
    v_add_f32 v88, v88, v87
    v_rcp_f32 v88, v88
    s_nop 0
    v_pk_mul_f32 v[180:181], v[180:181], v[88:89] op_sel_hi:[1,0]
    v_pk_mul_f32 v[182:183], v[182:183], v[88:89] op_sel_hi:[1,0]
    v_pk_mul_f32 v[184:185], v[184:185], v[88:89] op_sel_hi:[1,0]
    v_pk_mul_f32 v[186:187], v[186:187], v[88:89] op_sel_hi:[1,0]
    v_pk_mul_f32 v[188:189], v[188:189], v[88:89] op_sel_hi:[1,0]
    v_cvt_pk_bf16_f32 v192, v180, v181
    v_cvt_pk_bf16_f32 v193, v182, v183
    v_cvt_pk_bf16_f32 v194, v184, v185
    v_cvt_pk_bf16_f32 v195, v186, v187
    v_cvt_pk_bf16_f32 v196, v188, v189
    v_cvt_pk_bf16_f32 v199, v188, v189
    v_mfma_f32_16x16x32_bf16 v[200:203], v[136:139], v[192:195], 0
    v_mfma_f32_16x16x32_bf16 v[204:207], v[140:143], v[192:195], 0
    v_mfma_f32_16x16x16_bf16 v[200:203], v[144:145], v[196:197], v[200:203]
    v_mfma_f32_16x16x16_bf16 v[204:207], v[144:145], v[198:199], v[204:207]
    s_add_u32 s21, s19, 0
    s_min_u32 s21, s21, 63
    s_lshl_b32 s32, s21, 21
    s_lshl_b32 s21, s21, 13
    s_and_b32 s21, s21, 0x2000
    s_xor_b32 s21, s21, s48
    s_add_u32 s32, s32, s21
    s_nop 1
    v_cvt_pk_bf16_f32 v200, v200, v201
    v_cvt_pk_bf16_f32 v201, v202, v203
    v_cvt_pk_bf16_f32 v202, v204, v205
    v_cvt_pk_bf16_f32 v203, v206, v207
    buffer_store_dwordx4 v[200:203], v23, s[8:11], s32 offen sc1
    s_waitcnt vmcnt(0)
L_f2_36:
    s_barrier
    s_cmp_lg_u32 s18, 0
    s_cbranch_scc1 chain_kernel_done
    s_add_u32 s20, s62, 4096
    s_mov_b32 s21, 1
    s_atomic_add s21, s[100:101], s20
    s_branch chain_kernel_done
Gq_18_f0123:
    buffer_load_dwordx4 v[32:35], v2, s[8:11], s40 offen offset:0 sc1
    s_branch Gq_18_s1230
Gq_18_f123p0:
    buffer_load_dwordx4 v[36:39], v2, s[8:11], s40 offen offset:1024 sc1
    s_add_u32 s33, s33, 1
    s_cmp_gt_u32 s33, 0x100000
    s_cbranch_scc1 chain_kernel_abort
    s_branch Gq_18_s231
Gq_18_f23p1:
    buffer_load_dwordx4 v[40:43], v2, s[8:11], s40 offen offset:2048 sc1
    s_add_u32 s33, s33, 1
    s_cmp_gt_u32 s33, 0x100000
    s_cbranch_scc1 chain_kernel_abort
    s_branch Gq_18_s32
Gq_18_f3p2:
    buffer_load_dwordx4 v[44:47], v2, s[8:11], s40 offen offset:3072 sc1
    s_add_u32 s33, s33, 1
    s_cmp_gt_u32 s33, 0x100000
    s_cbranch_scc1 chain_kernel_abort
    s_branch Gq_18_s3
Gq_18_redo:
    buffer_load_dwordx4 v[32:35], v2, s[8:11], s40 offen offset:0 sc1
    buffer_load_dwordx4 v[36:39], v2, s[8:11], s40 offen offset:1024 sc1
    buffer_load_dwordx4 v[40:43], v2, s[8:11], s40 offen offset:2048 sc1
    buffer_load_dwordx4 v[44:47], v2, s[8:11], s40 offen offset:3072 sc1
    s_add_u32 s33, s33, 1
    s_cmp_gt_u32 s33, 0x100000
    s_cbranch_scc1 chain_kernel_abort
    s_nop 5
    v_mov_b32 v64, 0
    v_mov_b32 v65, 0
    v_mov_b32 v66, 0
    v_mov_b32 v67, 0
    v_mov_b32 v68, 0
    v_mov_b32 v69, 0
    v_mov_b32 v70, 0
    v_mov_b32 v71, 0
    v_mov_b32 v72, 0
    v_mov_b32 v73, 0
    v_mov_b32 v74, 0
    v_mov_b32 v75, 0
    s_branch Gq_18_s0123
Gq_18_s1230:
    s_waitcnt vmcnt(3)
    v_cmp_eq_u32 vcc, -1, v36
    v_mov_b32_dpp v52, v36 row_ror:8 row_mask:0xf bank_mask:0xf
    v_mov_b32_dpp v53, v37 row_ror:8 row_mask:0xf bank_mask:0xf
    v_mov_b32_dpp v54, v38 row_ror:8 row_mask:0xf bank_mask:0xf
    v_mov_b32_dpp v55, v39 row_ror:8 row_mask:0xf bank_mask:0xf
    s_cbranch_vccnz Gq_18_f1230
    v_smfmac_f32_16x16x64_bf16 v[64:67], v[36:39], a[8:15], v19
    v_smfmac_f32_16x16x64_bf16 v[68:71], v[36:39], a[72:79], v19
Gq_18_s230p1:
    s_waitcnt vmcnt(2)
    v_cmp_eq_u32 vcc, -1, v40
    v_smfmac_f32_16x16x64_bf16 v[64:67], v[52:55], a[40:47], v19
    v_mov_b32_dpp v56, v40 row_ror:8 row_mask:0xf bank_mask:0xf
    v_mov_b32_dpp v57, v41 row_ror:8 row_mask:0xf bank_mask:0xf
    v_smfmac_f32_16x16x64_bf16 v[68:71], v[52:55], a[104:111], v19
    v_mov_b32_dpp v58, v42 row_ror:8 row_mask:0xf bank_mask:0xf
    v_mov_b32_dpp v59, v43 row_ror:8 row_mask:0xf bank_mask:0xf
    s_cbranch_vccnz Gq_18_f230p1
    v_smfmac_f32_16x16x64_bf16 v[64:67], v[40:43], a[16:23], v19
    v_smfmac_f32_16x16x64_bf16 v[68:71], v[40:43], a[80:87], v19
Gq_18_s30p2:
    s_waitcnt vmcnt(1)
    v_cmp_eq_u32 vcc, -1, v44
    v_smfmac_f32_16x16x64_bf16 v[64:67], v[56:59], a[48:55], v19
    v_mov_b32_dpp v60, v44 row_ror:8 row_mask:0xf bank_mask:0xf
    v_mov_b32_dpp v61, v45 row_ror:8 row_mask:0xf bank_mask:0xf
    v_smfmac_f32_16x16x64_bf16 v[68:71], v[56:59], a[112:119], v19
    v_mov_b32_dpp v62, v46 row_ror:8 row_mask:0xf bank_mask:0xf
    v_mov_b32_dpp v63, v47 row_ror:8 row_mask:0xf bank_mask:0xf
    s_cbranch_vccnz Gq_18_f30p2
    v_smfmac_f32_16x16x64_bf16 v[64:67], v[44:47], a[24:31], v19
    v_smfmac_f32_16x16x64_bf16 v[68:71], v[44:47], a[88:95], v19
Gq_18_s0p3:
    s_waitcnt vmcnt(0)
    v_cmp_eq_u32 vcc, -1, v32
    v_smfmac_f32_16x16x64_bf16 v[64:67], v[60:63], a[56:63], v19
    v_mov_b32_dpp v48, v32 row_ror:8 row_mask:0xf bank_mask:0xf
    v_mov_b32_dpp v49, v33 row_ror:8 row_mask:0xf bank_mask:0xf
    v_smfmac_f32_16x16x64_bf16 v[68:71], v[60:63], a[120:127], v19
    v_mov_b32_dpp v50, v34 row_ror:8 row_mask:0xf bank_mask:0xf
    v_mov_b32_dpp v51, v35 row_ror:8 row_mask:0xf bank_mask:0xf
    s_cbranch_vccnz Gq_18_f0p3
    v_smfmac_f32_16x16x64_bf16 v[64:67], v[32:35], a[0:7], v19
    v_smfmac_f32_16x16x64_bf16 v[68:71], v[32:35], a[64:71], v19
    v_smfmac_f32_16x16x64_bf16 v[64:67], v[48:51], a[32:39], v19
    v_smfmac_f32_16x16x64_bf16 v[68:71], v[48:51], a[96:103], v19
    s_branch Gq_18_done
Gq_18_f1230:
    buffer_load_dwordx4 v[36:39], v2, s[8:11], s40 offen offset:1024 sc1
    s_add_u32 s33, s33, 1
    s_cmp_gt_u32 s33, 0x100000
    s_cbranch_scc1 chain_kernel_abort
    s_branch Gq_18_s2301
Gq_18_f230p1:
    buffer_load_dwordx4 v[40:43], v2, s[8:11], s40 offen offset:2048 sc1
    s_add_u32 s33, s33, 1
    s_cmp_gt_u32 s33, 0x100000
    s_cbranch_scc1 chain_kernel_abort
    s_branch Gq_18_s302
Gq_18_f30p2:
    buffer_load_dwordx4 v[44:47], v2, s[8:11], s40 offen offset:3072 sc1
    s_add_u32 s33, s33, 1
    s_cmp_gt_u32 s33, 0x100000
    s_cbranch_scc1 chain_kernel_abort
    s_branch Gq_18_s03
Gq_18_f0p3:
    buffer_load_dwordx4 v[32:35], v2, s[8:11], s40 offen offset:0 sc1
    s_add_u32 s33, s33, 1
    s_cmp_gt_u32 s33, 0x100000
    s_cbranch_scc1 chain_kernel_abort
    s_branch Gq_18_s0
Gq_18_s231:
    s_waitcnt vmcnt(2)
    v_cmp_eq_u32 vcc, -1, v40
    v_mov_b32_dpp v56, v40 row_ror:8 row_mask:0xf bank_mask:0xf
    v_mov_b32_dpp v57, v41 row_ror:8 row_mask:0xf bank_mask:0xf
    v_mov_b32_dpp v58, v42 row_ror:8 row_mask:0xf bank_mask:0xf
    v_mov_b32_dpp v59, v43 row_ror:8 row_mask:0xf bank_mask:0xf
    s_cbranch_vccnz Gq_18_f231
    v_smfmac_f32_16x16x64_bf16 v[64:67], v[40:43], a[16:23], v19
    v_smfmac_f32_16x16x64_bf16 v[68:71], v[40:43], a[80:87], v19
Gq_18_s31p2:
    s_waitcnt vmcnt(1)
    v_cmp_eq_u32 vcc, -1, v44
    v_smfmac_f32_16x16x64_bf16 v[64:67], v[56:59], a[48:55], v19
    v_mov_b32_dpp v60, v44 row_ror:8 row_mask:0xf bank_mask:0xf
    v_mov_b32_dpp v61, v45 row_ror:8 row_mask:0xf bank_mask:0xf
    v_smfmac_f32_16x16x64_bf16 v[68:71], v[56:59], a[112:119], v19
    v_mov_b32_dpp v62, v46 row_ror:8 row_mask:0xf bank_mask:0xf
    v_mov_b32_dpp v63, v47 row_ror:8 row_mask:0xf bank_mask:0xf
    s_cbranch_vccnz Gq_18_f31p2
    v_smfmac_f32_16x16x64_bf16 v[64:67], v[44:47], a[24:31], v19
    v_smfmac_f32_16x16x64_bf16 v[68:71], v[44:47], a[88:95], v19
Gq_18_s1p3:
    s_waitcnt vmcnt(0)
    v_cmp_eq_u32 vcc, -1, v36
    v_smfmac_f32_16x16x64_bf16 v[64:67], v[60:63], a[56:63], v19
    v_mov_b32_dpp v52, v36 row_ror:8 row_mask:0xf bank_mask:0xf
    v_mov_b32_dpp v53, v37 row_ror:8 row_mask:0xf bank_mask:0xf
    v_smfmac_f32_16x16x64_bf16 v[68:71], v[60:63], a[120:127], v19
    v_mov_b32_dpp v54, v38 row_ror:8 row_mask:0xf bank_mask:0xf
    v_mov_b32_dpp v55, v39 row_ror:8 row_mask:0xf bank_mask:0xf
    s_cbranch_vccnz Gq_18_f1p3
    v_smfmac_f32_16x16x64_bf16 v[64:67], v[36:39], a[8:15], v19
    v_smfmac_f32_16x16x64_bf16 v[68:71], v[36:39], a[72:79], v19
    v_smfmac_f32_16x16x64_bf16 v[64:67], v[52:55], a[40:47], v19
    v_smfmac_f32_16x16x64_bf16 v[68:71], v[52:55], a[104:111], v19
    s_branch Gq_18_done
Gq_18_f231:
    buffer_load_dwordx4 v[40:43], v2, s[8:11], s40 offen offset:2048 sc1
    s_add_u32 s33, s33, 1
    s_cmp_gt_u32 s33, 0x100000
    s_cbranch_scc1 chain_kernel_abort
    s_branch Gq_18_s312
Gq_18_f31p2:
    buffer_load_dwordx4 v[44:47], v2, s[8:11], s40 offen offset:3072 sc1
    s_add_u32 s33, s33, 1
    s_cmp_gt_u32 s33, 0x100000
    s_cbranch_scc1 chain_kernel_abort
    s_branch Gq_18_s13
Gq_18_f1p3:
    buffer_load_dwordx4 v[36:39], v2, s[8:11], s40 offen offset:1024 sc1
    s_add_u32 s33, s33, 1
    s_cmp_gt_u32 s33, 0x100000
    s_cbranch_scc1 chain_kernel_abort
    s_branch Gq_18_s1
Gq_18_s32:
    s_waitcnt vmcnt(1)
    v_cmp_eq_u32 vcc, -1, v44
    v_mov_b32_dpp v60, v44 row_ror:8 row_mask:0xf bank_mask:0xf
    v_mov_b32_dpp v61, v45 row_ror:8 row_mask:0xf bank_mask:0xf
    v_mov_b32_dpp v62, v46 row_ror:8 row_mask:0xf bank_mask:0xf
    v_mov_b32_dpp v63, v47 row_ror:8 row_mask:0xf bank_mask:0xf
    s_cbranch_vccnz Gq_18_f32
    v_smfmac_f32_16x16x64_bf16 v[64:67], v[44:47], a[24:31], v19
    v_smfmac_f32_16x16x64_bf16 v[68:71], v[44:47], a[88:95], v19
Gq_18_s2p3:
    s_waitcnt vmcnt(0)
    v_cmp_eq_u32 vcc, -1, v40
    v_smfmac_f32_16x16x64_bf16 v[64:67], v[60:63], a[56:63], v19
    v_mov_b32_dpp v56, v40 row_ror:8 row_mask:0xf bank_mask:0xf
    v_mov_b32_dpp v57, v41 row_ror:8 row_mask:0xf bank_mask:0xf
    v_smfmac_f32_16x16x64_bf16 v[68:71], v[60:63], a[120:127], v19
    v_mov_b32_dpp v58, v42 row_ror:8 row_mask:0xf bank_mask:0xf
    v_mov_b32_dpp v59, v43 row_ror:8 row_mask:0xf bank_mask:0xf
    s_cbranch_vccnz Gq_18_f2p3
    v_smfmac_f32_16x16x64_bf16 v[64:67], v[40:43], a[16:23], v19
    v_smfmac_f32_16x16x64_bf16 v[68:71], v[40:43], a[80:87], v19
    v_smfmac_f32_16x16x64_bf16 v[64:67], v[56:59], a[48:55], v19
    v_smfmac_f32_16x16x64_bf16 v[68:71], v[56:59], a[112:119], v19
    s_branch Gq_18_done
Gq_18_f32:
    buffer_load_dwordx4 v[44:47], v2, s[8:11], s40 offen offset:3072 sc1
    s_add_u32 s33, s33, 1
    s_cmp_gt_u32 s33, 0x100000
    s_cbranch_scc1 chain_kernel_abort
    s_branch Gq_18_s23
Gq_18_f2p3:
    buffer_load_dwordx4 v[40:43], v2, s[8:11], s40 offen offset:2048 sc1
    s_add_u32 s33, s33, 1
    s_cmp_gt_u32 s33, 0x100000
    s_cbranch_scc1 chain_kernel_abort
    s_branch Gq_18_s2
Gq_18_s3:
    s_waitcnt vmcnt(0)
    v_cmp_eq_u32 vcc, -1, v44
    v_mov_b32_dpp v60, v44 row_ror:8 row_mask:0xf bank_mask:0xf
    v_mov_b32_dpp v61, v45 row_ror:8 row_mask:0xf bank_mask:0xf
    v_mov_b32_dpp v62, v46 row_ror:8 row_mask:0xf bank_mask:0xf
    v_mov_b32_dpp v63, v47 row_ror:8 row_mask:0xf bank_mask:0xf
    s_cbranch_vccnz Gq_18_f3
    v_smfmac_f32_16x16x64_bf16 v[64:67], v[44:47], a[24:31], v19
    v_smfmac_f32_16x16x64_bf16 v[68:71], v[44:47], a[88:95], v19
    v_smfmac_f32_16x16x64_bf16 v[64:67], v[60:63], a[56:63], v19
    v_smfmac_f32_16x16x64_bf16 v[68:71], v[60:63], a[120:127], v19
    s_branch Gq_18_done
Gq_18_f3:
    buffer_load_dwordx4 v[44:47], v2, s[8:11], s40 offen offset:3072 sc1
    s_add_u32 s33, s33, 1
    s_cmp_gt_u32 s33, 0x100000
    s_cbranch_scc1 chain_kernel_abort
    s_branch Gq_18_s3
Gq_18_s2301:
    s_waitcnt vmcnt(3)
    v_cmp_eq_u32 vcc, -1, v40
    v_mov_b32_dpp v56, v40 row_ror:8 row_mask:0xf bank_mask:0xf
    v_mov_b32_dpp v57, v41 row_ror:8 row_mask:0xf bank_mask:0xf
    v_mov_b32_dpp v58, v42 row_ror:8 row_mask:0xf bank_mask:0xf
    v_mov_b32_dpp v59, v43 row_ror:8 row_mask:0xf bank_mask:0xf
    s_cbranch_vccnz Gq_18_f2301
    v_smfmac_f32_16x16x64_bf16 v[64:67], v[40:43], a[16:23], v19
    v_smfmac_f32_16x16x64_bf16 v[68:71], v[40:43], a[80:87], v19
Gq_18_s301p2:
    s_waitcnt vmcnt(2)
    v_cmp_eq_u32 vcc, -1, v44
    v_smfmac_f32_16x16x64_bf16 v[64:67], v[56:59], a[48:55], v19
    v_mov_b32_dpp v60, v44 row_ror:8 row_mask:0xf bank_mask:0xf
    v_mov_b32_dpp v61, v45 row_ror:8 row_mask:0xf bank_mask:0xf
    v_smfmac_f32_16x16x64_bf16 v[68:71], v[56:59], a[112:119], v19
    v_mov_b32_dpp v62, v46 row_ror:8 row_mask:0xf bank_mask:0xf
    v_mov_b32_dpp v63, v47 row_ror:8 row_mask:0xf bank_mask:0xf
    s_cbranch_vccnz Gq_18_f301p2
    v_smfmac_f32_16x16x64_bf16 v[64:67], v[44:47], a[24:31], v19
    v_smfmac_f32_16x16x64_bf16 v[68:71], v[44:47], a[88:95], v19
Gq_18_s01p3:
    s_waitcnt vmcnt(1)
    v_cmp_eq_u32 vcc, -1, v32
    v_smfmac_f32_16x16x64_bf16 v[64:67], v[60:63], a[56:63], v19
    v_mov_b32_dpp v48, v32 row_ror:8 row_mask:0xf bank_mask:0xf
    v_mov_b32_dpp v49, v33 row_ror:8 row_mask:0xf bank_mask:0xf
    v_smfmac_f32_16x16x64_bf16 v[68:71], v[60:63], a[120:127], v19
    v_mov_b32_dpp v50, v34 row_ror:8 row_mask:0xf bank_mask:0xf
    v_mov_b32_dpp v51, v35 row_ror:8 row_mask:0xf bank_mask:0xf
    s_cbranch_vccnz Gq_18_f01p3
    v_smfmac_f32_16x16x64_bf16 v[64:67], v[32:35], a[0:7], v19
    v_smfmac_f32_16x16x64_bf16 v[68:71], v[32:35], a[64:71], v19
Gq_18_s1p0:
    s_waitcnt vmcnt(0)
    v_cmp_eq_u32 vcc, -1, v36
    v_smfmac_f32_16x16x64_bf16 v[64:67], v[48:51], a[32:39], v19
    v_mov_b32_dpp v52, v36 row_ror:8 row_mask:0xf bank_mask:0xf
    v_mov_b32_dpp v53, v37 row_ror:8 row_mask:0xf bank_mask:0xf
    v_smfmac_f32_16x16x64_bf16 v[68:71], v[48:51], a[96:103], v19
    v_mov_b32_dpp v54, v38 row_ror:8 row_mask:0xf bank_mask:0xf
    v_mov_b32_dpp v55, v39 row_ror:8 row_mask:0xf bank_mask:0xf
    s_cbranch_vccnz Gq_18_f1p0
    v_smfmac_f32_16x16x64_bf16 v[64:67], v[36:39], a[8:15], v19
    v_smfmac_f32_16x16x64_bf16 v[68:71], v[36:39], a[72:79], v19
    v_smfmac_f32_16x16x64_bf16 v[64:67], v[52:55], a[40:47], v19
    v_smfmac_f32_16x16x64_bf16 v[68:71], v[52:55], a[104:111], v19
    s_branch Gq_18_done
Gq_18_f2301:
    buffer_load_dwordx4 v[40:43], v2, s[8:11], s40 offen offset:2048 sc1
    s_add_u32 s33, s33, 1
    s_cmp_gt_u32 s33, 0x100000
    s_cbranch_scc1 chain_kernel_abort
    s_branch Gq_18_s3012
Gq_18_f301p2:
    buffer_load_dwordx4 v[44:47], v2, s[8:11], s40 offen offset:3072 sc1
    s_add_u32 s33, s33, 1
    s_cmp_gt_u32 s33, 0x100000
    s_cbranch_scc1 chain_kernel_abort
    s_branch Gq_18_s013
Gq_18_f01p3:
    buffer_load_dwordx4 v[32:35], v2, s[8:11], s40 offen offset:0 sc1
    s_add_u32 s33, s33, 1
    s_cmp_gt_u32 s33, 0x100000
    s_cbranch_scc1 chain_kernel_abort
    s_branch Gq_18_s10
Gq_18_f1p0:
    buffer_load_dwordx4 v[36:39], v2, s[8:11], s40 offen offset:1024 sc1
    s_add_u32 s33, s33, 1
    s_cmp_gt_u32 s33, 0x100000
    s_cbranch_scc1 chain_kernel_abort
    s_branch Gq_18_s1
Gq_18_s302:
    s_waitcnt vmcnt(2)
    v_cmp_eq_u32 vcc, -1, v44
    v_mov_b32_dpp v60, v44 row_ror:8 row_mask:0xf bank_mask:0xf
    v_mov_b32_dpp v61, v45 row_ror:8 row_mask:0xf bank_mask:0xf
    v_mov_b32_dpp v62, v46 row_ror:8 row_mask:0xf bank_mask:0xf
    v_mov_b32_dpp v63, v47 row_ror:8 row_mask:0xf bank_mask:0xf
    s_cbranch_vccnz Gq_18_f302
    v_smfmac_f32_16x16x64_bf16 v[64:67], v[44:47], a[24:31], v19
    v_smfmac_f32_16x16x64_bf16 v[68:71], v[44:47], a[88:95], v19
Gq_18_s02p3:
    s_waitcnt vmcnt(1)
    v_cmp_eq_u32 vcc, -1, v32
    v_smfmac_f32_16x16x64_bf16 v[64:67], v[60:63], a[56:63], v19
    v_mov_b32_dpp v48, v32 row_ror:8 row_mask:0xf bank_mask:0xf
    v_mov_b32_dpp v49, v33 row_ror:8 row_mask:0xf bank_mask:0xf
    v_smfmac_f32_16x16x64_bf16 v[68:71], v[60:63], a[120:127], v19
    v_mov_b32_dpp v50, v34 row_ror:8 row_mask:0xf bank_mask:0xf
    v_mov_b32_dpp v51, v35 row_ror:8 row_mask:0xf bank_mask:0xf
    s_cbranch_vccnz Gq_18_f02p3
    v_smfmac_f32_16x16x64_bf16 v[64:67], v[32:35], a[0:7], v19
    v_smfmac_f32_16x16x64_bf16 v[68:71], v[32:35], a[64:71], v19
Gq_18_s2p0:
    s_waitcnt vmcnt(0)
    v_cmp_eq_u32 vcc, -1, v40
    v_smfmac_f32_16x16x64_bf16 v[64:67], v[48:51], a[32:39], v19
    v_mov_b32_dpp v56, v40 row_ror:8 row_mask:0xf bank_mask:0xf
    v_mov_b32_dpp v57, v41 row_ror:8 row_mask:0xf bank_mask:0xf
    v_smfmac_f32_16x16x64_bf16 v[68:71], v[48:51], a[96:103], v19
    v_mov_b32_dpp v58, v42 row_ror:8 row_mask:0xf bank_mask:0xf
    v_mov_b32_dpp v59, v43 row_ror:8 row_mask:0xf bank_mask:0xf
    s_cbranch_vccnz Gq_18_f2p0
    v_smfmac_f32_16x16x64_bf16 v[64:67], v[40:43], a[16:23], v19
    v_smfmac_f32_16x16x64_bf16 v[68:71], v[40:43], a[80:87], v19
    v_smfmac_f32_16x16x64_bf16 v[64:67], v[56:59], a[48:55], v19
    v_smfmac_f32_16x16x64_bf16 v[68:71], v[56:59], a[112:119], v19
    s_branch Gq_18_done
Gq_18_f302:
    buffer_load_dwordx4 v[44:47], v2, s[8:11], s40 offen offset:3072 sc1
    s_add_u32 s33, s33, 1
    s_cmp_gt_u32 s33, 0x100000
    s_cbranch_scc1 chain_kernel_abort
    s_branch Gq_18_s023
Gq_18_f02p3:
    buffer_load_dwordx4 v[32:35], v2, s[8:11], s40 offen offset:0 sc1
    s_add_u32 s33, s33, 1
    s_cmp_gt_u32 s33, 0x100000
    s_cbranch_scc1 chain_kernel_abort
    s_branch Gq_18_s20
Gq_18_f2p0:
    buffer_load_dwordx4 v[40:43], v2, s[8:11], s40 offen offset:2048 sc1
    s_add_u32 s33, s33, 1
    s_cmp_gt_u32 s33, 0x100000
    s_cbranch_scc1 chain_kernel_abort
    s_branch Gq_18_s2
Gq_18_s03:
    s_waitcnt vmcnt(1)
    v_cmp_eq_u32 vcc, -1, v32
    v_mov_b32_dpp v48, v32 row_ror:8 row_mask:0xf bank_mask:0xf
    v_mov_b32_dpp v49, v33 row_ror:8 row_mask:0xf bank_mask:0xf
    v_mov_b32_dpp v50, v34 row_ror:8 row_mask:0xf bank_mask:0xf
    v_mov_b32_dpp v51, v35 row_ror:8 row_mask:0xf bank_mask:0xf
    s_cbranch_vccnz Gq_18_f03
    v_smfmac_f32_16x16x64_bf16 v[64:67], v[32:35], a[0:7], v19
    v_smfmac_f32_16x16x64_bf16 v[68:71], v[32:35], a[64:71], v19
Gq_18_s3p0:
    s_waitcnt vmcnt(0)
    v_cmp_eq_u32 vcc, -1, v44
    v_smfmac_f32_16x16x64_bf16 v[64:67], v[48:51], a[32:39], v19
    v_mov_b32_dpp v60, v44 row_ror:8 row_mask:0xf bank_mask:0xf
    v_mov_b32_dpp v61, v45 row_ror:8 row_mask:0xf bank_mask:0xf
    v_smfmac_f32_16x16x64_bf16 v[68:71], v[48:51], a[96:103], v19
    v_mov_b32_dpp v62, v46 row_ror:8 row_mask:0xf bank_mask:0xf
    v_mov_b32_dpp v63, v47 row_ror:8 row_mask:0xf bank_mask:0xf
    s_cbranch_vccnz Gq_18_f3p0
    v_smfmac_f32_16x16x64_bf16 v[64:67], v[44:47], a[24:31], v19
    v_smfmac_f32_16x16x64_bf16 v[68:71], v[44:47], a[88:95], v19
    v_smfmac_f32_16x16x64_bf16 v[64:67], v[60:63], a[56:63], v19
    v_smfmac_f32_16x16x64_bf16 v[68:71], v[60:63], a[120:127], v19
    s_branch Gq_18_done
Gq_18_f03:
    buffer_load_dwordx4 v[32:35], v2, s[8:11], s40 offen offset:0 sc1
    s_add_u32 s33, s33, 1
    s_cmp_gt_u32 s33, 0x100000
    s_cbranch_scc1 chain_kernel_abort
    s_branch Gq_18_s30
Gq_18_f3p0:
    buffer_load_dwordx4 v[44:47], v2, s[8:11], s40 offen offset:3072 sc1
    s_add_u32 s33, s33, 1
    s_cmp_gt_u32 s33, 0x100000
    s_cbranch_scc1 chain_kernel_abort
    s_branch Gq_18_s3
Gq_18_s0:
    s_waitcnt vmcnt(0)
    v_cmp_eq_u32 vcc, -1, v32
    v_mov_b32_dpp v48, v32 row_ror:8 row_mask:0xf bank_mask:0xf
    v_mov_b32_dpp v49, v33 row_ror:8 row_mask:0xf bank_mask:0xf
    v_mov_b32_dpp v50, v34 row_ror:8 row_mask:0xf bank_mask:0xf
    v_mov_b32_dpp v51, v35 row_ror:8 row_mask:0xf bank_mask:0xf
    s_cbranch_vccnz Gq_18_f0
    v_smfmac_f32_16x16x64_bf16 v[64:67], v[32:35], a[0:7], v19
    v_smfmac_f32_16x16x64_bf16 v[68:71], v[32:35], a[64:71], v19
    v_smfmac_f32_16x16x64_bf16 v[64:67], v[48:51], a[32:39], v19
    v_smfmac_f32_16x16x64_bf16 v[68:71], v[48:51], a[96:103], v19
    s_branch Gq_18_done
Gq_18_f0:
    buffer_load_dwordx4 v[32:35], v2, s[8:11], s40 offen offset:0 sc1
    s_add_u32 s33, s33, 1
    s_cmp_gt_u32 s33, 0x100000
    s_cbranch_scc1 chain_kernel_abort
    s_branch Gq_18_s0
Gq_18_s312:
    s_waitcnt vmcnt(2)
    v_cmp_eq_u32 vcc, -1, v44
    v_mov_b32_dpp v60, v44 row_ror:8 row_mask:0xf bank_mask:0xf
    v_mov_b32_dpp v61, v45 row_ror:8 row_mask:0xf bank_mask:0xf
    v_mov_b32_dpp v62, v46 row_ror:8 row_mask:0xf bank_mask:0xf
    v_mov_b32_dpp v63, v47 row_ror:8 row_mask:0xf bank_mask:0xf
    s_cbranch_vccnz Gq_18_f312
    v_smfmac_f32_16x16x64_bf16 v[64:67], v[44:47], a[24:31], v19
    v_smfmac_f32_16x16x64_bf16 v[68:71], v[44:47], a[88:95], v19
Gq_18_s12p3:
    s_waitcnt vmcnt(1)
    v_cmp_eq_u32 vcc, -1, v36
    v_smfmac_f32_16x16x64_bf16 v[64:67], v[60:63], a[56:63], v19
    v_mov_b32_dpp v52, v36 row_ror:8 row_mask:0xf bank_mask:0xf
    v_mov_b32_dpp v53, v37 row_ror:8 row_mask:0xf bank_mask:0xf
    v_smfmac_f32_16x16x64_bf16 v[68:71], v[60:63], a[120:127], v19
    v_mov_b32_dpp v54, v38 row_ror:8 row_mask:0xf bank_mask:0xf
    v_mov_b32_dpp v55, v39 row_ror:8 row_mask:0xf bank_mask:0xf
    s_cbranch_vccnz Gq_18_f12p3
    v_smfmac_f32_16x16x64_bf16 v[64:67], v[36:39], a[8:15], v19
    v_smfmac_f32_16x16x64_bf16 v[68:71], v[36:39], a[72:79], v19
Gq_18_s2p1:
    s_waitcnt vmcnt(0)
    v_cmp_eq_u32 vcc, -1, v40
    v_smfmac_f32_16x16x64_bf16 v[64:67], v[52:55], a[40:47], v19
    v_mov_b32_dpp v56, v40 row_ror:8 row_mask:0xf bank_mask:0xf
    v_mov_b32_dpp v57, v41 row_ror:8 row_mask:0xf bank_mask:0xf
    v_smfmac_f32_16x16x64_bf16 v[68:71], v[52:55], a[104:111], v19
    v_mov_b32_dpp v58, v42 row_ror:8 row_mask:0xf bank_mask:0xf
    v_mov_b32_dpp v59, v43 row_ror:8 row_mask:0xf bank_mask:0xf
    s_cbranch_vccnz Gq_18_f2p1
    v_smfmac_f32_16x16x64_bf16 v[64:67], v[40:43], a[16:23], v19
    v_smfmac_f32_16x16x64_bf16 v[68:71], v[40:43], a[80:87], v19
    v_smfmac_f32_16x16x64_bf16 v[64:67], v[56:59], a[48:55], v19
    v_smfmac_f32_16x16x64_bf16 v[68:71], v[56:59], a[112:119], v19
    s_branch Gq_18_done
Gq_18_f312:
    buffer_load_dwordx4 v[44:47], v2, s[8:11], s40 offen offset:3072 sc1
    s_add_u32 s33, s33, 1
    s_cmp_gt_u32 s33, 0x100000
    s_cbranch_scc1 chain_kernel_abort
    s_branch Gq_18_s123
Gq_18_f12p3:
    buffer_load_dwordx4 v[36:39], v2, s[8:11], s40 offen offset:1024 sc1
    s_add_u32 s33, s33, 1
    s_cmp_gt_u32 s33, 0x100000
    s_cbranch_scc1 chain_kernel_abort
    s_branch Gq_18_s21
Gq_18_f2p1:
    buffer_load_dwordx4 v[40:43], v2, s[8:11], s40 offen offset:2048 sc1
    s_add_u32 s33, s33, 1
    s_cmp_gt_u32 s33, 0x100000
    s_cbranch_scc1 chain_kernel_abort
    s_branch Gq_18_s2
Gq_18_s13:
    s_waitcnt vmcnt(1)
    v_cmp_eq_u32 vcc, -1, v36
    v_mov_b32_dpp v52, v36 row_ror:8 row_mask:0xf bank_mask:0xf
    v_mov_b32_dpp v53, v37 row_ror:8 row_mask:0xf bank_mask:0xf
    v_mov_b32_dpp v54, v38 row_ror:8 row_mask:0xf bank_mask:0xf
    v_mov_b32_dpp v55, v39 row_ror:8 row_mask:0xf bank_mask:0xf
    s_cbranch_vccnz Gq_18_f13
    v_smfmac_f32_16x16x64_bf16 v[64:67], v[36:39], a[8:15], v19
    v_smfmac_f32_16x16x64_bf16 v[68:71], v[36:39], a[72:79], v19
Gq_18_s3p1:
    s_waitcnt vmcnt(0)
    v_cmp_eq_u32 vcc, -1, v44
    v_smfmac_f32_16x16x64_bf16 v[64:67], v[52:55], a[40:47], v19
    v_mov_b32_dpp v60, v44 row_ror:8 row_mask:0xf bank_mask:0xf
    v_mov_b32_dpp v61, v45 row_ror:8 row_mask:0xf bank_mask:0xf
    v_smfmac_f32_16x16x64_bf16 v[68:71], v[52:55], a[104:111], v19
    v_mov_b32_dpp v62, v46 row_ror:8 row_mask:0xf bank_mask:0xf
    v_mov_b32_dpp v63, v47 row_ror:8 row_mask:0xf bank_mask:0xf
    s_cbranch_vccnz Gq_18_f3p1
    v_smfmac_f32_16x16x64_bf16 v[64:67], v[44:47], a[24:31], v19
    v_smfmac_f32_16x16x64_bf16 v[68:71], v[44:47], a[88:95], v19
    v_smfmac_f32_16x16x64_bf16 v[64:67], v[60:63], a[56:63], v19
    v_smfmac_f32_16x16x64_bf16 v[68:71], v[60:63], a[120:127], v19
    s_branch Gq_18_done
Gq_18_f13:
    buffer_load_dwordx4 v[36:39], v2, s[8:11], s40 offen offset:1024 sc1
    s_add_u32 s33, s33, 1
    s_cmp_gt_u32 s33, 0x100000
    s_cbranch_scc1 chain_kernel_abort
    s_branch Gq_18_s31
Gq_18_f3p1:
    buffer_load_dwordx4 v[44:47], v2, s[8:11], s40 offen offset:3072 sc1
    s_add_u32 s33, s33, 1
    s_cmp_gt_u32 s33, 0x100000
    s_cbranch_scc1 chain_kernel_abort
    s_branch Gq_18_s3
Gq_18_s1:
    s_waitcnt vmcnt(0)
    v_cmp_eq_u32 vcc, -1, v36
    v_mov_b32_dpp v52, v36 row_ror:8 row_mask:0xf bank_mask:0xf
    v_mov_b32_dpp v53, v37 row_ror:8 row_mask:0xf bank_mask:0xf
    v_mov_b32_dpp v54, v38 row_ror:8 row_mask:0xf bank_mask:0xf
    v_mov_b32_dpp v55, v39 row_ror:8 row_mask:0xf bank_mask:0xf
    s_cbranch_vccnz Gq_18_f1
    v_smfmac_f32_16x16x64_bf16 v[64:67], v[36:39], a[8:15], v19
    v_smfmac_f32_16x16x64_bf16 v[68:71], v[36:39], a[72:79], v19
    v_smfmac_f32_16x16x64_bf16 v[64:67], v[52:55], a[40:47], v19
    v_smfmac_f32_16x16x64_bf16 v[68:71], v[52:55], a[104:111], v19
    s_branch Gq_18_done
Gq_18_f1:
    buffer_load_dwordx4 v[36:39], v2, s[8:11], s40 offen offset:1024 sc1
    s_add_u32 s33, s33, 1
    s_cmp_gt_u32 s33, 0x100000
    s_cbranch_scc1 chain_kernel_abort
    s_branch Gq_18_s1
Gq_18_s23:
    s_waitcnt vmcnt(1)
    v_cmp_eq_u32 vcc, -1, v40
    v_mov_b32_dpp v56, v40 row_ror:8 row_mask:0xf bank_mask:0xf
    v_mov_b32_dpp v57, v41 row_ror:8 row_mask:0xf bank_mask:0xf
    v_mov_b32_dpp v58, v42 row_ror:8 row_mask:0xf bank_mask:0xf
    v_mov_b32_dpp v59, v43 row_ror:8 row_mask:0xf bank_mask:0xf
    s_cbranch_vccnz Gq_18_f23
    v_smfmac_f32_16x16x64_bf16 v[64:67], v[40:43], a[16:23], v19
    v_smfmac_f32_16x16x64_bf16 v[68:71], v[40:43], a[80:87], v19
    s_branch Gq_18_s3p2
Gq_18_f23:
    buffer_load_dwordx4 v[40:43], v2, s[8:11], s40 offen offset:2048 sc1
    s_add_u32 s33, s33, 1
    s_cmp_gt_u32 s33, 0x100000
    s_cbranch_scc1 chain_kernel_abort
    s_branch Gq_18_s32
Gq_18_s2:
    s_waitcnt vmcnt(0)
    v_cmp_eq_u32 vcc, -1, v40
    v_mov_b32_dpp v56, v40 row_ror:8 row_mask:0xf bank_mask:0xf
    v_mov_b32_dpp v57, v41 row_ror:8 row_mask:0xf bank_mask:0xf
    v_mov_b32_dpp v58, v42 row_ror:8 row_mask:0xf bank_mask:0xf
    v_mov_b32_dpp v59, v43 row_ror:8 row_mask:0xf bank_mask:0xf
    s_cbranch_vccnz Gq_18_f2
    v_smfmac_f32_16x16x64_bf16 v[64:67], v[40:43], a[16:23], v19
    v_smfmac_f32_16x16x64_bf16 v[68:71], v[40:43], a[80:87], v19
    v_smfmac_f32_16x16x64_bf16 v[64:67], v[56:59], a[48:55], v19
    v_smfmac_f32_16x16x64_bf16 v[68:71], v[56:59], a[112:119], v19
    s_branch Gq_18_done
Gq_18_f2:
    buffer_load_dwordx4 v[40:43], v2, s[8:11], s40 offen offset:2048 sc1
    s_add_u32 s33, s33, 1
    s_cmp_gt_u32 s33, 0x100000
    s_cbranch_scc1 chain_kernel_abort
    s_branch Gq_18_s2
Gq_18_s3012:
    s_waitcnt vmcnt(3)
    v_cmp_eq_u32 vcc, -1, v44
    v_mov_b32_dpp v60, v44 row_ror:8 row_mask:0xf bank_mask:0xf
    v_mov_b32_dpp v61, v45 row_ror:8 row_mask:0xf bank_mask:0xf
    v_mov_b32_dpp v62, v46 row_ror:8 row_mask:0xf bank_mask:0xf
    v_mov_b32_dpp v63, v47 row_ror:8 row_mask:0xf bank_mask:0xf
    s_cbranch_vccnz Gq_18_f3012
    v_smfmac_f32_16x16x64_bf16 v[64:67], v[44:47], a[24:31], v19
    v_smfmac_f32_16x16x64_bf16 v[68:71], v[44:47], a[88:95], v19
Gq_18_s012p3:
    s_waitcnt vmcnt(2)
    v_cmp_eq_u32 vcc, -1, v32
    v_smfmac_f32_16x16x64_bf16 v[64:67], v[60:63], a[56:63], v19
    v_mov_b32_dpp v48, v32 row_ror:8 row_mask:0xf bank_mask:0xf
    v_mov_b32_dpp v49, v33 row_ror:8 row_mask:0xf bank_mask:0xf
    v_smfmac_f32_16x16x64_bf16 v[68:71], v[60:63], a[120:127], v19
    v_mov_b32_dpp v50, v34 row_ror:8 row_mask:0xf bank_mask:0xf
    v_mov_b32_dpp v51, v35 row_ror:8 row_mask:0xf bank_mask:0xf
    s_cbranch_vccnz Gq_18_f012p3
    v_smfmac_f32_16x16x64_bf16 v[64:67], v[32:35], a[0:7], v19
    v_smfmac_f32_16x16x64_bf16 v[68:71], v[32:35], a[64:71], v19
Gq_18_s12p0:
    s_waitcnt vmcnt(1)
    v_cmp_eq_u32 vcc, -1, v36
    v_smfmac_f32_16x16x64_bf16 v[64:67], v[48:51], a[32:39], v19
    v_mov_b32_dpp v52, v36 row_ror:8 row_mask:0xf bank_mask:0xf
    v_mov_b32_dpp v53, v37 row_ror:8 row_mask:0xf bank_mask:0xf
    v_smfmac_f32_16x16x64_bf16 v[68:71], v[48:51], a[96:103], v19
    v_mov_b32_dpp v54, v38 row_ror:8 row_mask:0xf bank_mask:0xf
    v_mov_b32_dpp v55, v39 row_ror:8 row_mask:0xf bank_mask:0xf
    s_cbranch_vccnz Gq_18_f12p0
    v_smfmac_f32_16x16x64_bf16 v[64:67], v[36:39], a[8:15], v19
    v_smfmac_f32_16x16x64_bf16 v[68:71], v[36:39], a[72:79], v19
    s_branch Gq_18_s2p1
Gq_18_f3012:
    buffer_load_dwordx4 v[44:47], v2, s[8:11], s40 offen offset:3072 sc1
    s_add_u32 s33, s33, 1
    s_cmp_gt_u32 s33, 0x100000
    s_cbranch_scc1 chain_kernel_abort
    s_branch Gq_18_s0123
Gq_18_f012p3:
    buffer_load_dwordx4 v[32:35], v2, s[8:11], s40 offen offset:0 sc1
    s_add_u32 s33, s33, 1
    s_cmp_gt_u32 s33, 0x100000
    s_cbranch_scc1 chain_kernel_abort
    s_branch Gq_18_s120
Gq_18_f12p0:
    buffer_load_dwordx4 v[36:39], v2, s[8:11], s40 offen offset:1024 sc1
    s_add_u32 s33, s33, 1
    s_cmp_gt_u32 s33, 0x100000
    s_cbranch_scc1 chain_kernel_abort
    s_branch Gq_18_s21
Gq_18_s013:
    s_waitcnt vmcnt(2)
    v_cmp_eq_u32 vcc, -1, v32
    v_mov_b32_dpp v48, v32 row_ror:8 row_mask:0xf bank_mask:0xf
    v_mov_b32_dpp v49, v33 row_ror:8 row_mask:0xf bank_mask:0xf
    v_mov_b32_dpp v50, v34 row_ror:8 row_mask:0xf bank_mask:0xf
    v_mov_b32_dpp v51, v35 row_ror:8 row_mask:0xf bank_mask:0xf
    s_cbranch_vccnz Gq_18_f013
    v_smfmac_f32_16x16x64_bf16 v[64:67], v[32:35], a[0:7], v19
    v_smfmac_f32_16x16x64_bf16 v[68:71], v[32:35], a[64:71], v19
Gq_18_s13p0:
    s_waitcnt vmcnt(1)
    v_cmp_eq_u32 vcc, -1, v36
    v_smfmac_f32_16x16x64_bf16 v[64:67], v[48:51], a[32:39], v19
    v_mov_b32_dpp v52, v36 row_ror:8 row_mask:0xf bank_mask:0xf
    v_mov_b32_dpp v53, v37 row_ror:8 row_mask:0xf bank_mask:0xf
    v_smfmac_f32_16x16x64_bf16 v[68:71], v[48:51], a[96:103], v19
    v_mov_b32_dpp v54, v38 row_ror:8 row_mask:0xf bank_mask:0xf
    v_mov_b32_dpp v55, v39 row_ror:8 row_mask:0xf bank_mask:0xf
    s_cbranch_vccnz Gq_18_f13p0
    v_smfmac_f32_16x16x64_bf16 v[64:67], v[36:39], a[8:15], v19
    v_smfmac_f32_16x16x64_bf16 v[68:71], v[36:39], a[72:79], v19
    s_branch Gq_18_s3p1
Gq_18_f013:
    buffer_load_dwordx4 v[32:35], v2, s[8:11], s40 offen offset:0 sc1
    s_add_u32 s33, s33, 1
    s_cmp_gt_u32 s33, 0x100000
    s_cbranch_scc1 chain_kernel_abort
    s_branch Gq_18_s130
Gq_18_f13p0:
    buffer_load_dwordx4 v[36:39], v2, s[8:11], s40 offen offset:1024 sc1
    s_add_u32 s33, s33, 1
    s_cmp_gt_u32 s33, 0x100000
    s_cbranch_scc1 chain_kernel_abort
    s_branch Gq_18_s31
Gq_18_s10:
    s_waitcnt vmcnt(1)
    v_cmp_eq_u32 vcc, -1, v36
    v_mov_b32_dpp v52, v36 row_ror:8 row_mask:0xf bank_mask:0xf
    v_mov_b32_dpp v53, v37 row_ror:8 row_mask:0xf bank_mask:0xf
    v_mov_b32_dpp v54, v38 row_ror:8 row_mask:0xf bank_mask:0xf
    v_mov_b32_dpp v55, v39 row_ror:8 row_mask:0xf bank_mask:0xf
    s_cbranch_vccnz Gq_18_f10
    v_smfmac_f32_16x16x64_bf16 v[64:67], v[36:39], a[8:15], v19
    v_smfmac_f32_16x16x64_bf16 v[68:71], v[36:39], a[72:79], v19
Gq_18_s0p1:
    s_waitcnt vmcnt(0)
    v_cmp_eq_u32 vcc, -1, v32
    v_smfmac_f32_16x16x64_bf16 v[64:67], v[52:55], a[40:47], v19
    v_mov_b32_dpp v48, v32 row_ror:8 row_mask:0xf bank_mask:0xf
    v_mov_b32_dpp v49, v33 row_ror:8 row_mask:0xf bank_mask:0xf
    v_smfmac_f32_16x16x64_bf16 v[68:71], v[52:55], a[104:111], v19
    v_mov_b32_dpp v50, v34 row_ror:8 row_mask:0xf bank_mask:0xf
    v_mov_b32_dpp v51, v35 row_ror:8 row_mask:0xf bank_mask:0xf
    s_cbranch_vccnz Gq_18_f0p1
    v_smfmac_f32_16x16x64_bf16 v[64:67], v[32:35], a[0:7], v19
    v_smfmac_f32_16x16x64_bf16 v[68:71], v[32:35], a[64:71], v19
    v_smfmac_f32_16x16x64_bf16 v[64:67], v[48:51], a[32:39], v19
    v_smfmac_f32_16x16x64_bf16 v[68:71], v[48:51], a[96:103], v19
    s_branch Gq_18_done
Gq_18_f10:
    buffer_load_dwordx4 v[36:39], v2, s[8:11], s40 offen offset:1024 sc1
    s_add_u32 s33, s33, 1
    s_cmp_gt_u32 s33, 0x100000
    s_cbranch_scc1 chain_kernel_abort
    s_branch Gq_18_s01
Gq_18_f0p1:
    buffer_load_dwordx4 v[32:35], v2, s[8:11], s40 offen offset:0 sc1
    s_add_u32 s33, s33, 1
    s_cmp_gt_u32 s33, 0x100000
    s_cbranch_scc1 chain_kernel_abort
    s_branch Gq_18_s0
Gq_18_s023:
    s_waitcnt vmcnt(2)
    v_cmp_eq_u32 vcc, -1, v32
    v_mov_b32_dpp v48, v32 row_ror:8 row_mask:0xf bank_mask:0xf
    v_mov_b32_dpp v49, v33 row_ror:8 row_mask:0xf bank_mask:0xf
    v_mov_b32_dpp v50, v34 row_ror:8 row_mask:0xf bank_mask:0xf
    v_mov_b32_dpp v51, v35 row_ror:8 row_mask:0xf bank_mask:0xf
    s_cbranch_vccnz Gq_18_f023
    v_smfmac_f32_16x16x64_bf16 v[64:67], v[32:35], a[0:7], v19
    v_smfmac_f32_16x16x64_bf16 v[68:71], v[32:35], a[64:71], v19
Gq_18_s23p0:
    s_waitcnt vmcnt(1)
    v_cmp_eq_u32 vcc, -1, v40
    v_smfmac_f32_16x16x64_bf16 v[64:67], v[48:51], a[32:39], v19
    v_mov_b32_dpp v56, v40 row_ror:8 row_mask:0xf bank_mask:0xf
    v_mov_b32_dpp v57, v41 row_ror:8 row_mask:0xf bank_mask:0xf
    v_smfmac_f32_16x16x64_bf16 v[68:71], v[48:51], a[96:103], v19
    v_mov_b32_dpp v58, v42 row_ror:8 row_mask:0xf bank_mask:0xf
    v_mov_b32_dpp v59, v43 row_ror:8 row_mask:0xf bank_mask:0xf
    s_cbranch_vccnz Gq_18_f23p0
    v_smfmac_f32_16x16x64_bf16 v[64:67], v[40:43], a[16:23], v19
    v_smfmac_f32_16x16x64_bf16 v[68:71], v[40:43], a[80:87], v19
    s_branch Gq_18_s3p2
Gq_18_f023:
    buffer_load_dwordx4 v[32:35], v2, s[8:11], s40 offen offset:0 sc1
    s_add_u32 s33, s33, 1
    s_cmp_gt_u32 s33, 0x100000
    s_cbranch_scc1 chain_kernel_abort
    s_branch Gq_18_s230
Gq_18_f23p0:
    buffer_load_dwordx4 v[40:43], v2, s[8:11], s40 offen offset:2048 sc1
    s_add_u32 s33, s33, 1
    s_cmp_gt_u32 s33, 0x100000
    s_cbranch_scc1 chain_kernel_abort
    s_branch Gq_18_s32
Gq_18_s20:
    s_waitcnt vmcnt(1)
    v_cmp_eq_u32 vcc, -1, v40
    v_mov_b32_dpp v56, v40 row_ror:8 row_mask:0xf bank_mask:0xf
    v_mov_b32_dpp v57, v41 row_ror:8 row_mask:0xf bank_mask:0xf
    v_mov_b32_dpp v58, v42 row_ror:8 row_mask:0xf bank_mask:0xf
    v_mov_b32_dpp v59, v43 row_ror:8 row_mask:0xf bank_mask:0xf
    s_cbranch_vccnz Gq_18_f20
    v_smfmac_f32_16x16x64_bf16 v[64:67], v[40:43], a[16:23], v19
    v_smfmac_f32_16x16x64_bf16 v[68:71], v[40:43], a[80:87], v19
Gq_18_s0p2:
    s_waitcnt vmcnt(0)
    v_cmp_eq_u32 vcc, -1, v32
    v_smfmac_f32_16x16x64_bf16 v[64:67], v[56:59], a[48:55], v19
    v_mov_b32_dpp v48, v32 row_ror:8 row_mask:0xf bank_mask:0xf
    v_mov_b32_dpp v49, v33 row_ror:8 row_mask:0xf bank_mask:0xf
    v_smfmac_f32_16x16x64_bf16 v[68:71], v[56:59], a[112:119], v19
    v_mov_b32_dpp v50, v34 row_ror:8 row_mask:0xf bank_mask:0xf
    v_mov_b32_dpp v51, v35 row_ror:8 row_mask:0xf bank_mask:0xf
    s_cbranch_vccnz Gq_18_f0p2
    v_smfmac_f32_16x16x64_bf16 v[64:67], v[32:35], a[0:7], v19
    v_smfmac_f32_16x16x64_bf16 v[68:71], v[32:35], a[64:71], v19
    v_smfmac_f32_16x16x64_bf16 v[64:67], v[48:51], a[32:39], v19
    v_smfmac_f32_16x16x64_bf16 v[68:71], v[48:51], a[96:103], v19
    s_branch Gq_18_done
Gq_18_f20:
    buffer_load_dwordx4 v[40:43], v2, s[8:11], s40 offen offset:2048 sc1
    s_add_u32 s33, s33, 1
    s_cmp_gt_u32 s33, 0x100000
    s_cbranch_scc1 chain_kernel_abort
    s_branch Gq_18_s02
Gq_18_f0p2:
    buffer_load_dwordx4 v[32:35], v2, s[8:11], s40 offen offset:0 sc1
    s_add_u32 s33, s33, 1
    s_cmp_gt_u32 s33, 0x100000
    s_cbranch_scc1 chain_kernel_abort
    s_branch Gq_18_s0
Gq_18_s30:
    s_waitcnt vmcnt(1)
    v_cmp_eq_u32 vcc, -1, v44
    v_mov_b32_dpp v60, v44 row_ror:8 row_mask:0xf bank_mask:0xf
    v_mov_b32_dpp v61, v45 row_ror:8 row_mask:0xf bank_mask:0xf
    v_mov_b32_dpp v62, v46 row_ror:8 row_mask:0xf bank_mask:0xf
    v_mov_b32_dpp v63, v47 row_ror:8 row_mask:0xf bank_mask:0xf
    s_cbranch_vccnz Gq_18_f30
    v_smfmac_f32_16x16x64_bf16 v[64:67], v[44:47], a[24:31], v19
    v_smfmac_f32_16x16x64_bf16 v[68:71], v[44:47], a[88:95], v19
    s_branch Gq_18_s0p3
Gq_18_f30:
    buffer_load_dwordx4 v[44:47], v2, s[8:11], s40 offen offset:3072 sc1
    s_add_u32 s33, s33, 1
    s_cmp_gt_u32 s33, 0x100000
    s_cbranch_scc1 chain_kernel_abort
    s_branch Gq_18_s03
Gq_18_s123:
    s_waitcnt vmcnt(2)
    v_cmp_eq_u32 vcc, -1, v36
    v_mov_b32_dpp v52, v36 row_ror:8 row_mask:0xf bank_mask:0xf
    v_mov_b32_dpp v53, v37 row_ror:8 row_mask:0xf bank_mask:0xf
    v_mov_b32_dpp v54, v38 row_ror:8 row_mask:0xf bank_mask:0xf
    v_mov_b32_dpp v55, v39 row_ror:8 row_mask:0xf bank_mask:0xf
    s_cbranch_vccnz Gq_18_f123
    v_smfmac_f32_16x16x64_bf16 v[64:67], v[36:39], a[8:15], v19
    v_smfmac_f32_16x16x64_bf16 v[68:71], v[36:39], a[72:79], v19
    s_branch Gq_18_s23p1
Gq_18_f123:
    buffer_load_dwordx4 v[36:39], v2, s[8:11], s40 offen offset:1024 sc1
    s_add_u32 s33, s33, 1
    s_cmp_gt_u32 s33, 0x100000
    s_cbranch_scc1 chain_kernel_abort
    s_branch Gq_18_s231
Gq_18_s21:
    s_waitcnt vmcnt(1)
    v_cmp_eq_u32 vcc, -1, v40
    v_mov_b32_dpp v56, v40 row_ror:8 row_mask:0xf bank_mask:0xf
    v_mov_b32_dpp v57, v41 row_ror:8 row_mask:0xf bank_mask:0xf
    v_mov_b32_dpp v58, v42 row_ror:8 row_mask:0xf bank_mask:0xf
    v_mov_b32_dpp v59, v43 row_ror:8 row_mask:0xf bank_mask:0xf
    s_cbranch_vccnz Gq_18_f21
    v_smfmac_f32_16x16x64_bf16 v[64:67], v[40:43], a[16:23], v19
    v_smfmac_f32_16x16x64_bf16 v[68:71], v[40:43], a[80:87], v19
Gq_18_s1p2:
    s_waitcnt vmcnt(0)
    v_cmp_eq_u32 vcc, -1, v36
    v_smfmac_f32_16x16x64_bf16 v[64:67], v[56:59], a[48:55], v19
    v_mov_b32_dpp v52, v36 row_ror:8 row_mask:0xf bank_mask:0xf
    v_mov_b32_dpp v53, v37 row_ror:8 row_mask:0xf bank_mask:0xf
    v_smfmac_f32_16x16x64_bf16 v[68:71], v[56:59], a[112:119], v19
    v_mov_b32_dpp v54, v38 row_ror:8 row_mask:0xf bank_mask:0xf
    v_mov_b32_dpp v55, v39 row_ror:8 row_mask:0xf bank_mask:0xf
    s_cbranch_vccnz Gq_18_f1p2
    v_smfmac_f32_16x16x64_bf16 v[64:67], v[36:39], a[8:15], v19
    v_smfmac_f32_16x16x64_bf16 v[68:71], v[36:39], a[72:79], v19
    v_smfmac_f32_16x16x64_bf16 v[64:67], v[52:55], a[40:47], v19
    v_smfmac_f32_16x16x64_bf16 v[68:71], v[52:55], a[104:111], v19
    s_branch Gq_18_done
Gq_18_f21:
    buffer_load_dwordx4 v[40:43], v2, s[8:11], s40 offen offset:2048 sc1
    s_add_u32 s33, s33, 1
    s_cmp_gt_u32 s33, 0x100000
    s_cbranch_scc1 chain_kernel_abort
    s_branch Gq_18_s12
Gq_18_f1p2:
    buffer_load_dwordx4 v[36:39], v2, s[8:11], s40 offen offset:1024 sc1
    s_add_u32 s33, s33, 1
    s_cmp_gt_u32 s33, 0x100000
    s_cbranch_scc1 chain_kernel_abort
    s_branch Gq_18_s1
Gq_18_s31:
    s_waitcnt vmcnt(1)
    v_cmp_eq_u32 vcc, -1, v44
    v_mov_b32_dpp v60, v44 row_ror:8 row_mask:0xf bank_mask:0xf
    v_mov_b32_dpp v61, v45 row_ror:8 row_mask:0xf bank_mask:0xf
    v_mov_b32_dpp v62, v46 row_ror:8 row_mask:0xf bank_mask:0xf
    v_mov_b32_dpp v63, v47 row_ror:8 row_mask:0xf bank_mask:0xf
    s_cbranch_vccnz Gq_18_f31
    v_smfmac_f32_16x16x64_bf16 v[64:67], v[44:47], a[24:31], v19
    v_smfmac_f32_16x16x64_bf16 v[68:71], v[44:47], a[88:95], v19
    s_branch Gq_18_s1p3
Gq_18_f31:
    buffer_load_dwordx4 v[44:47], v2, s[8:11], s40 offen offset:3072 sc1
    s_add_u32 s33, s33, 1
    s_cmp_gt_u32 s33, 0x100000
    s_cbranch_scc1 chain_kernel_abort
    s_branch Gq_18_s13
Gq_18_s120:
    s_waitcnt vmcnt(2)
    v_cmp_eq_u32 vcc, -1, v36
    v_mov_b32_dpp v52, v36 row_ror:8 row_mask:0xf bank_mask:0xf
    v_mov_b32_dpp v53, v37 row_ror:8 row_mask:0xf bank_mask:0xf
    v_mov_b32_dpp v54, v38 row_ror:8 row_mask:0xf bank_mask:0xf
    v_mov_b32_dpp v55, v39 row_ror:8 row_mask:0xf bank_mask:0xf
    s_cbranch_vccnz Gq_18_f120
    v_smfmac_f32_16x16x64_bf16 v[64:67], v[36:39], a[8:15], v19
    v_smfmac_f32_16x16x64_bf16 v[68:71], v[36:39], a[72:79], v19
Gq_18_s20p1:
    s_waitcnt vmcnt(1)
    v_cmp_eq_u32 vcc, -1, v40
    v_smfmac_f32_16x16x64_bf16 v[64:67], v[52:55], a[40:47], v19
    v_mov_b32_dpp v56, v40 row_ror:8 row_mask:0xf bank_mask:0xf
    v_mov_b32_dpp v57, v41 row_ror:8 row_mask:0xf bank_mask:0xf
    v_smfmac_f32_16x16x64_bf16 v[68:71], v[52:55], a[104:111], v19
    v_mov_b32_dpp v58, v42 row_ror:8 row_mask:0xf bank_mask:0xf
    v_mov_b32_dpp v59, v43 row_ror:8 row_mask:0xf bank_mask:0xf
    s_cbranch_vccnz Gq_18_f20p1
    v_smfmac_f32_16x16x64_bf16 v[64:67], v[40:43], a[16:23], v19
    v_smfmac_f32_16x16x64_bf16 v[68:71], v[40:43], a[80:87], v19
    s_branch Gq_18_s0p2
Gq_18_f120:
    buffer_load_dwordx4 v[36:39], v2, s[8:11], s40 offen offset:1024 sc1
    s_add_u32 s33, s33, 1
    s_cmp_gt_u32 s33, 0x100000
    s_cbranch_scc1 chain_kernel_abort
    s_branch Gq_18_s201
Gq_18_f20p1:
    buffer_load_dwordx4 v[40:43], v2, s[8:11], s40 offen offset:2048 sc1
    s_add_u32 s33, s33, 1
    s_cmp_gt_u32 s33, 0x100000
    s_cbranch_scc1 chain_kernel_abort
    s_branch Gq_18_s02
Gq_18_s130:
    s_waitcnt vmcnt(2)
    v_cmp_eq_u32 vcc, -1, v36
    v_mov_b32_dpp v52, v36 row_ror:8 row_mask:0xf bank_mask:0xf
    v_mov_b32_dpp v53, v37 row_ror:8 row_mask:0xf bank_mask:0xf
    v_mov_b32_dpp v54, v38 row_ror:8 row_mask:0xf bank_mask:0xf
    v_mov_b32_dpp v55, v39 row_ror:8 row_mask:0xf bank_mask:0xf
    s_cbranch_vccnz Gq_18_f130
    v_smfmac_f32_16x16x64_bf16 v[64:67], v[36:39], a[8:15], v19
    v_smfmac_f32_16x16x64_bf16 v[68:71], v[36:39], a[72:79], v19
Gq_18_s30p1:
    s_waitcnt vmcnt(1)
    v_cmp_eq_u32 vcc, -1, v44
    v_smfmac_f32_16x16x64_bf16 v[64:67], v[52:55], a[40:47], v19
    v_mov_b32_dpp v60, v44 row_ror:8 row_mask:0xf bank_mask:0xf
    v_mov_b32_dpp v61, v45 row_ror:8 row_mask:0xf bank_mask:0xf
    v_smfmac_f32_16x16x64_bf16 v[68:71], v[52:55], a[104:111], v19
    v_mov_b32_dpp v62, v46 row_ror:8 row_mask:0xf bank_mask:0xf
    v_mov_b32_dpp v63, v47 row_ror:8 row_mask:0xf bank_mask:0xf
    s_cbranch_vccnz Gq_18_f30p1
    v_smfmac_f32_16x16x64_bf16 v[64:67], v[44:47], a[24:31], v19
    v_smfmac_f32_16x16x64_bf16 v[68:71], v[44:47], a[88:95], v19
    s_branch Gq_18_s0p3
Gq_18_f130:
    buffer_load_dwordx4 v[36:39], v2, s[8:11], s40 offen offset:1024 sc1
    s_add_u32 s33, s33, 1
    s_cmp_gt_u32 s33, 0x100000
    s_cbranch_scc1 chain_kernel_abort
    s_branch Gq_18_s301
Gq_18_f30p1:
    buffer_load_dwordx4 v[44:47], v2, s[8:11], s40 offen offset:3072 sc1
    s_add_u32 s33, s33, 1
    s_cmp_gt_u32 s33, 0x100000
    s_cbranch_scc1 chain_kernel_abort
    s_branch Gq_18_s03
Gq_18_s01:
    s_waitcnt vmcnt(1)
    v_cmp_eq_u32 vcc, -1, v32
    v_mov_b32_dpp v48, v32 row_ror:8 row_mask:0xf bank_mask:0xf
    v_mov_b32_dpp v49, v33 row_ror:8 row_mask:0xf bank_mask:0xf
    v_mov_b32_dpp v50, v34 row_ror:8 row_mask:0xf bank_mask:0xf
    v_mov_b32_dpp v51, v35 row_ror:8 row_mask:0xf bank_mask:0xf
    s_cbranch_vccnz Gq_18_f01
    v_smfmac_f32_16x16x64_bf16 v[64:67], v[32:35], a[0:7], v19
    v_smfmac_f32_16x16x64_bf16 v[68:71], v[32:35], a[64:71], v19
    s_branch Gq_18_s1p0
Gq_18_f01:
    buffer_load_dwordx4 v[32:35], v2, s[8:11], s40 offen offset:0 sc1
    s_add_u32 s33, s33, 1
    s_cmp_gt_u32 s33, 0x100000
    s_cbranch_scc1 chain_kernel_abort
    s_branch Gq_18_s10
Gq_18_s230:
    s_waitcnt vmcnt(2)
    v_cmp_eq_u32 vcc, -1, v40
    v_mov_b32_dpp v56, v40 row_ror:8 row_mask:0xf bank_mask:0xf
    v_mov_b32_dpp v57, v41 row_ror:8 row_mask:0xf bank_mask:0xf
    v_mov_b32_dpp v58, v42 row_ror:8 row_mask:0xf bank_mask:0xf
    v_mov_b32_dpp v59, v43 row_ror:8 row_mask:0xf bank_mask:0xf
    s_cbranch_vccnz Gq_18_f230
    v_smfmac_f32_16x16x64_bf16 v[64:67], v[40:43], a[16:23], v19
    v_smfmac_f32_16x16x64_bf16 v[68:71], v[40:43], a[80:87], v19
    s_branch Gq_18_s30p2
Gq_18_f230:
    buffer_load_dwordx4 v[40:43], v2, s[8:11], s40 offen offset:2048 sc1
    s_add_u32 s33, s33, 1
    s_cmp_gt_u32 s33, 0x100000
    s_cbranch_scc1 chain_kernel_abort
    s_branch Gq_18_s302
Gq_18_s02:
    s_waitcnt vmcnt(1)
    v_cmp_eq_u32 vcc, -1, v32
    v_mov_b32_dpp v48, v32 row_ror:8 row_mask:0xf bank_mask:0xf
    v_mov_b32_dpp v49, v33 row_ror:8 row_mask:0xf bank_mask:0xf
    v_mov_b32_dpp v50, v34 row_ror:8 row_mask:0xf bank_mask:0xf
    v_mov_b32_dpp v51, v35 row_ror:8 row_mask:0xf bank_mask:0xf
    s_cbranch_vccnz Gq_18_f02
    v_smfmac_f32_16x16x64_bf16 v[64:67], v[32:35], a[0:7], v19
    v_smfmac_f32_16x16x64_bf16 v[68:71], v[32:35], a[64:71], v19
    s_branch Gq_18_s2p0
Gq_18_f02:
    buffer_load_dwordx4 v[32:35], v2, s[8:11], s40 offen offset:0 sc1
    s_add_u32 s33, s33, 1
    s_cmp_gt_u32 s33, 0x100000
    s_cbranch_scc1 chain_kernel_abort
    s_branch Gq_18_s20
Gq_18_s12:
    s_waitcnt vmcnt(1)
    v_cmp_eq_u32 vcc, -1, v36
    v_mov_b32_dpp v52, v36 row_ror:8 row_mask:0xf bank_mask:0xf
    v_mov_b32_dpp v53, v37 row_ror:8 row_mask:0xf bank_mask:0xf
    v_mov_b32_dpp v54, v38 row_ror:8 row_mask:0xf bank_mask:0xf
    v_mov_b32_dpp v55, v39 row_ror:8 row_mask:0xf bank_mask:0xf
    s_cbranch_vccnz Gq_18_f12
    v_smfmac_f32_16x16x64_bf16 v[64:67], v[36:39], a[8:15], v19
    v_smfmac_f32_16x16x64_bf16 v[68:71], v[36:39], a[72:79], v19
    s_branch Gq_18_s2p1
Gq_18_f12:
    buffer_load_dwordx4 v[36:39], v2, s[8:11], s40 offen offset:1024 sc1
    s_add_u32 s33, s33, 1
    s_cmp_gt_u32 s33, 0x100000
    s_cbranch_scc1 chain_kernel_abort
    s_branch Gq_18_s21
Gq_18_s201:
    s_waitcnt vmcnt(2)
    v_cmp_eq_u32 vcc, -1, v40
    v_mov_b32_dpp v56, v40 row_ror:8 row_mask:0xf bank_mask:0xf
    v_mov_b32_dpp v57, v41 row_ror:8 row_mask:0xf bank_mask:0xf
    v_mov_b32_dpp v58, v42 row_ror:8 row_mask:0xf bank_mask:0xf
    v_mov_b32_dpp v59, v43 row_ror:8 row_mask:0xf bank_mask:0xf
    s_cbranch_vccnz Gq_18_f201
    v_smfmac_f32_16x16x64_bf16 v[64:67], v[40:43], a[16:23], v19
    v_smfmac_f32_16x16x64_bf16 v[68:71], v[40:43], a[80:87], v19
Gq_18_s01p2:
    s_waitcnt vmcnt(1)
    v_cmp_eq_u32 vcc, -1, v32
    v_smfmac_f32_16x16x64_bf16 v[64:67], v[56:59], a[48:55], v19
    v_mov_b32_dpp v48, v32 row_ror:8 row_mask:0xf bank_mask:0xf
    v_mov_b32_dpp v49, v33 row_ror:8 row_mask:0xf bank_mask:0xf
    v_smfmac_f32_16x16x64_bf16 v[68:71], v[56:59], a[112:119], v19
    v_mov_b32_dpp v50, v34 row_ror:8 row_mask:0xf bank_mask:0xf
    v_mov_b32_dpp v51, v35 row_ror:8 row_mask:0xf bank_mask:0xf
    s_cbranch_vccnz Gq_18_f01p2
    v_smfmac_f32_16x16x64_bf16 v[64:67], v[32:35], a[0:7], v19
    v_smfmac_f32_16x16x64_bf16 v[68:71], v[32:35], a[64:71], v19
    s_branch Gq_18_s1p0
Gq_18_f201:
    buffer_load_dwordx4 v[40:43], v2, s[8:11], s40 offen offset:2048 sc1
    s_add_u32 s33, s33, 1
    s_cmp_gt_u32 s33, 0x100000
    s_cbranch_scc1 chain_kernel_abort
    s_branch Gq_18_s012
Gq_18_f01p2:
    buffer_load_dwordx4 v[32:35], v2, s[8:11], s40 offen offset:0 sc1
    s_add_u32 s33, s33, 1
    s_cmp_gt_u32 s33, 0x100000
    s_cbranch_scc1 chain_kernel_abort
    s_branch Gq_18_s10
Gq_18_s301:
    s_waitcnt vmcnt(2)
    v_cmp_eq_u32 vcc, -1, v44
    v_mov_b32_dpp v60, v44 row_ror:8 row_mask:0xf bank_mask:0xf
    v_mov_b32_dpp v61, v45 row_ror:8 row_mask:0xf bank_mask:0xf
    v_mov_b32_dpp v62, v46 row_ror:8 row_mask:0xf bank_mask:0xf
    v_mov_b32_dpp v63, v47 row_ror:8 row_mask:0xf bank_mask:0xf
    s_cbranch_vccnz Gq_18_f301
    v_smfmac_f32_16x16x64_bf16 v[64:67], v[44:47], a[24:31], v19
    v_smfmac_f32_16x16x64_bf16 v[68:71], v[44:47], a[88:95], v19
    s_branch Gq_18_s01p3
Gq_18_f301:
    buffer_load_dwordx4 v[44:47], v2, s[8:11], s40 offen offset:3072 sc1
    s_add_u32 s33, s33, 1
    s_cmp_gt_u32 s33, 0x100000
    s_cbranch_scc1 chain_kernel_abort
    s_branch Gq_18_s013
Gq_18_s012:
    s_waitcnt vmcnt(2)
    v_cmp_eq_u32 vcc, -1, v32
    v_mov_b32_dpp v48, v32 row_ror:8 row_mask:0xf bank_mask:0xf
    v_mov_b32_dpp v49, v33 row_ror:8 row_mask:0xf bank_mask:0xf
    v_mov_b32_dpp v50, v34 row_ror:8 row_mask:0xf bank_mask:0xf
    v_mov_b32_dpp v51, v35 row_ror:8 row_mask:0xf bank_mask:0xf
    s_cbranch_vccnz Gq_18_f012
    v_smfmac_f32_16x16x64_bf16 v[64:67], v[32:35], a[0:7], v19
    v_smfmac_f32_16x16x64_bf16 v[68:71], v[32:35], a[64:71], v19
    s_branch Gq_18_s12p0
Gq_18_f012:
    buffer_load_dwordx4 v[32:35], v2, s[8:11], s40 offen offset:0 sc1
    s_add_u32 s33, s33, 1
    s_cmp_gt_u32 s33, 0x100000
    s_cbranch_scc1 chain_kernel_abort
    s_branch Gq_18_s120
L_sd_19_0_0f:
    s_branch L_sd_19_1_0
L_sd_19_0_1f:
    s_branch L_sd_19_1_1
L_sd_19_0_2f:
    s_branch L_sd_19_1_2
L_sd_19_0_3f:
    s_branch L_sd_19_1_3
L_sd_19_1_0:
    s_waitcnt vmcnt(7)
    v_max3_u32 v20, v164, v165, v166
    v_mfma_f32_16x16x32_bf16 v[88:91], v[164:167], v[164:167], 0
    v_max_u32 v20, v20, v167
    v_cmp_eq_u32 vcc, -1, v20
    v_mfma_f32_16x16x32_bf16 v[84:87], v[120:123], v[164:167], 0
    v_mfma_f32_16x16x32_bf16 v[80:83], v[104:107], v[164:167], 0
    s_cbranch_vccnz L_sd_19_2_0
L_sd_19_1_1:
    s_waitcnt vmcnt(6)
    v_max3_u32 v20, v168, v169, v170
    v_mfma_f32_16x16x32_bf16 v[100:103], v[168:171], v[168:171], v[88:91]
    v_max_u32 v20, v20, v171
    v_cmp_eq_u32 vcc, -1, v20
    v_mfma_f32_16x16x32_bf16 v[96:99], v[124:127], v[168:171], v[84:87]
    v_mfma_f32_16x16x32_bf16 v[92:95], v[108:111], v[168:171], v[80:83]
    s_cbranch_vccnz L_sd_19_2_1
L_sd_19_1_2:
    s_waitcnt vmcnt(5)
    v_max3_u32 v20, v172, v173, v174
    v_mfma_f32_16x16x32_bf16 v[228:231], v[172:175], v[172:175], v[100:103]
    v_max_u32 v20, v20, v175
    v_cmp_eq_u32 vcc, -1, v20
    v_mfma_f32_16x16x32_bf16 v[224:227], v[128:131], v[172:175], v[96:99]
    v_mfma_f32_16x16x32_bf16 v[220:223], v[112:115], v[172:175], v[92:95]
    s_cbranch_vccnz L_sd_19_2_2
L_sd_19_1_3:
    s_waitcnt vmcnt(4)
    v_max3_u32 v20, v176, v177, v178
    v_mfma_f32_16x16x32_bf16 v[188:191], v[176:179], v[176:179], v[228:231]
    v_max_u32 v20, v20, v179
    v_cmp_eq_u32 vcc, -1, v20
    v_mfma_f32_16x16x32_bf16 v[184:187], v[132:135], v[176:179], v[224:227]
    v_mfma_f32_16x16x32_bf16 v[180:183], v[116:119], v[176:179], v[220:223]
    v_mov_b32_dpp v188, v189 row_ror:8 row_mask:0xf bank_mask:0xc
    v_mov_b32_dpp v190, v191 row_ror:8 row_mask:0xf bank_mask:0xc
    s_cbranch_vccnz L_sd_19_2_3
    s_branch L_sd_19
L_sd_19_1_0f:
    s_branch L_sd_19_2_0
L_sd_19_1_1f:
    s_branch L_sd_19_2_1
L_sd_19_1_2f:
    s_branch L_sd_19_2_2
L_sd_19_1_3f:
    s_branch L_sd_19_2_3
L_sd_19_2_0:
    s_waitcnt vmcnt(3)
    v_max3_u32 v20, v32, v33, v34
    v_mfma_f32_16x16x32_bf16 v[88:91], v[32:35], v[32:35], 0
    v_max_u32 v20, v20, v35
    v_cmp_eq_u32 vcc, -1, v20
    v_mfma_f32_16x16x32_bf16 v[84:87], v[120:123], v[32:35], 0
    v_mfma_f32_16x16x32_bf16 v[80:83], v[104:107], v[32:35], 0
    s_cbranch_vccnz L_sd_19_2_0f
L_sd_19_2_1:
    s_waitcnt vmcnt(2)
    v_max3_u32 v20, v36, v37, v38
    v_mfma_f32_16x16x32_bf16 v[100:103], v[36:39], v[36:39], v[88:91]
    v_max_u32 v20, v20, v39
    v_cmp_eq_u32 vcc, -1, v20
    v_mfma_f32_16x16x32_bf16 v[96:99], v[124:127], v[36:39], v[84:87]
    v_mfma_f32_16x16x32_bf16 v[92:95], v[108:111], v[36:39], v[80:83]
    s_cbranch_vccnz L_sd_19_2_1f
L_sd_19_2_2:
    s_waitcnt vmcnt(1)
    v_max3_u32 v20, v40, v41, v42
    v_mfma_f32_16x16x32_bf16 v[228:231], v[40:43], v[40:43], v[100:103]
    v_max_u32 v20, v20, v43
    v_cmp_eq_u32 vcc, -1, v20
    v_mfma_f32_16x16x32_bf16 v[224:227], v[128:131], v[40:43], v[96:99]
    v_mfma_f32_16x16x32_bf16 v[220:223], v[112:115], v[40:43], v[92:95]
    s_cbranch_vccnz L_sd_19_2_2f
L_sd_19_2_3:
    s_waitcnt vmcnt(0)
    v_max3_u32 v20, v44, v45, v46
    v_mfma_f32_16x16x32_bf16 v[188:191], v[44:47], v[44:47], v[228:231]
    v_max_u32 v20, v20, v47
    v_cmp_eq_u32 vcc, -1, v20
    v_mfma_f32_16x16x32_bf16 v[184:187], v[132:135], v[44:47], v[224:227]
    v_mfma_f32_16x16x32_bf16 v[180:183], v[116:119], v[44:47], v[220:223]
    v_mov_b32_dpp v188, v189 row_ror:8 row_mask:0xf bank_mask:0xc
    v_mov_b32_dpp v190, v191 row_ror:8 row_mask:0xf bank_mask:0xc
    s_cbranch_vccnz L_sd_19_2_3f
    s_branch L_sd_19
L_sd_19_2_0f:
    buffer_load_dwordx4 v[148:151], v5, s[8:11], s40 offen offset:0 sc1
    buffer_load_dwordx4 v[152:155], v5, s[8:11], s40 offen offset:1024 sc1
    buffer_load_dwordx4 v[156:159], v5, s[8:11], s40 offen offset:2048 sc1
    buffer_load_dwordx4 v[160:163], v5, s[8:11], s40 offen offset:3072 sc1
    s_add_u32 s33, s33, 1
    s_cmp_gt_u32 s33, 0x100000
    s_cbranch_scc1 chain_kernel_abort
    s_branch L_sd_19_3_0
L_sd_19_2_1f:
    buffer_load_dwordx4 v[152:155], v5, s[8:11], s40 offen offset:1024 sc1
    buffer_load_dwordx4 v[156:159], v5, s[8:11], s40 offen offset:2048 sc1
    buffer_load_dwordx4 v[160:163], v5, s[8:11], s40 offen offset:3072 sc1
    s_add_u32 s33, s33, 1
    s_cmp_gt_u32 s33, 0x100000
    s_cbranch_scc1 chain_kernel_abort
    s_branch L_sd_19_3_1
L_sd_19_2_2f:
    buffer_load_dwordx4 v[156:159], v5, s[8:11], s40 offen offset:2048 sc1
    buffer_load_dwordx4 v[160:163], v5, s[8:11], s40 offen offset:3072 sc1
    s_add_u32 s33, s33, 1
    s_cmp_gt_u32 s33, 0x100000
    s_cbranch_scc1 chain_kernel_abort
    s_branch L_sd_19_3_2
L_sd_19_2_3f:
    buffer_load_dwordx4 v[160:163], v5, s[8:11], s40 offen offset:3072 sc1
    s_add_u32 s33, s33, 1
    s_cmp_gt_u32 s33, 0x100000
    s_cbranch_scc1 chain_kernel_abort
    s_branch L_sd_19_3_3
L_sd_19_3_0:
    s_waitcnt vmcnt(3)
    v_max3_u32 v20, v148, v149, v150
    v_mfma_f32_16x16x32_bf16 v[88:91], v[148:151], v[148:151], 0
    v_max_u32 v20, v20, v151
    v_cmp_eq_u32 vcc, -1, v20
    v_mfma_f32_16x16x32_bf16 v[84:87], v[120:123], v[148:151], 0
    v_mfma_f32_16x16x32_bf16 v[80:83], v[104:107], v[148:151], 0
    s_cbranch_vccnz L_sd_19_3_0f
L_sd_19_3_1:
    s_waitcnt vmcnt(2)
    v_max3_u32 v20, v152, v153, v154
    v_mfma_f32_16x16x32_bf16 v[100:103], v[152:155], v[152:155], v[88:91]
    v_max_u32 v20, v20, v155
    v_cmp_eq_u32 vcc, -1, v20
    v_mfma_f32_16x16x32_bf16 v[96:99], v[124:127], v[152:155], v[84:87]
    v_mfma_f32_16x16x32_bf16 v[92:95], v[108:111], v[152:155], v[80:83]
    s_cbranch_vccnz L_sd_19_3_1f
L_sd_19_3_2:
    s_waitcnt vmcnt(1)
    v_max3_u32 v20, v156, v157, v158
    v_mfma_f32_16x16x32_bf16 v[228:231], v[156:159], v[156:159], v[100:103]
    v_max_u32 v20, v20, v159
    v_cmp_eq_u32 vcc, -1, v20
    v_mfma_f32_16x16x32_bf16 v[224:227], v[128:131], v[156:159], v[96:99]
    v_mfma_f32_16x16x32_bf16 v[220:223], v[112:115], v[156:159], v[92:95]
    s_cbranch_vccnz L_sd_19_3_2f
L_sd_19_3_3:
    s_waitcnt vmcnt(0)
    v_max3_u32 v20, v160, v161, v162
    v_mfma_f32_16x16x32_bf16 v[188:191], v[160:163], v[160:163], v[228:231]
    v_max_u32 v20, v20, v163
    v_cmp_eq_u32 vcc, -1, v20
    v_mfma_f32_16x16x32_bf16 v[184:187], v[132:135], v[160:163], v[224:227]
    v_mfma_f32_16x16x32_bf16 v[180:183], v[116:119], v[160:163], v[220:223]
    v_mov_b32_dpp v188, v189 row_ror:8 row_mask:0xf bank_mask:0xc
    v_mov_b32_dpp v190, v191 row_ror:8 row_mask:0xf bank_mask:0xc
    s_cbranch_vccnz L_sd_19_3_3f
    s_branch L_sd_19
L_sd_19_3_0f:
    buffer_load_dwordx4 v[148:151], v5, s[8:11], s40 offen offset:0 sc1
    buffer_load_dwordx4 v[152:155], v5, s[8:11], s40 offen offset:1024 sc1
    buffer_load_dwordx4 v[156:159], v5, s[8:11], s40 offen offset:2048 sc1
    buffer_load_dwordx4 v[160:163], v5, s[8:11], s40 offen offset:3072 sc1
    s_add_u32 s33, s33, 1
    s_cmp_gt_u32 s33, 0x100000
    s_cbranch_scc1 chain_kernel_abort
    s_branch L_sd_19_3_0
L_sd_19_3_1f:
    buffer_load_dwordx4 v[152:155], v5, s[8:11], s40 offen offset:1024 sc1
    buffer_load_dwordx4 v[156:159], v5, s[8:11], s40 offen offset:2048 sc1
    buffer_load_dwordx4 v[160:163], v5, s[8:11], s40 offen offset:3072 sc1
    s_add_u32 s33, s33, 1
    s_cmp_gt_u32 s33, 0x100000
    s_cbranch_scc1 chain_kernel_abort
    s_branch L_sd_19_3_1
L_sd_19_3_2f:
    buffer_load_dwordx4 v[156:159], v5, s[8:11], s40 offen offset:2048 sc1
    buffer_load_dwordx4 v[160:163], v5, s[8:11], s40 offen offset:3072 sc1
    s_add_u32 s33, s33, 1
    s_cmp_gt_u32 s33, 0x100000
    s_cbranch_scc1 chain_kernel_abort
    s_branch L_sd_19_3_2
L_sd_19_3_3f:
    buffer_load_dwordx4 v[160:163], v5, s[8:11], s40 offen offset:3072 sc1
    s_add_u32 s33, s33, 1
    s_cmp_gt_u32 s33, 0x100000
    s_cbranch_scc1 chain_kernel_abort
    s_branch L_sd_19_3_3
Go_20_f0123:
    buffer_load_dwordx4 v[32:35], v3, s[8:11], s40 offen offset:0 sc1
    s_branch Go_20_s1230
Go_20_f123:
    buffer_load_dwordx4 v[36:39], v3, s[8:11], s40 offen offset:1024 sc1
    s_add_u32 s33, s33, 1
    s_cmp_gt_u32 s33, 0x100000
    s_cbranch_scc1 chain_kernel_abort
    s_branch Go_20_s231
Go_20_f23:
    buffer_load_dwordx4 v[40:43], v3, s[8:11], s40 offen offset:2048 sc1
    s_add_u32 s33, s33, 1
    s_cmp_gt_u32 s33, 0x100000
    s_cbranch_scc1 chain_kernel_abort
    s_branch Go_20_s32
Go_20_f3:
    buffer_load_dwordx4 v[44:47], v3, s[8:11], s40 offen offset:3072 sc1
    s_add_u32 s33, s33, 1
    s_cmp_gt_u32 s33, 0x100000
    s_cbranch_scc1 chain_kernel_abort
    s_branch Go_20_s3
Go_20_redo:
    buffer_load_dwordx4 v[32:35], v3, s[8:11], s40 offen offset:0 sc1
    buffer_load_dwordx4 v[36:39], v3, s[8:11], s40 offen offset:1024 sc1
    buffer_load_dwordx4 v[40:43], v3, s[8:11], s40 offen offset:2048 sc1
    buffer_load_dwordx4 v[44:47], v3, s[8:11], s40 offen offset:3072 sc1
    s_add_u32 s33, s33, 1
    s_cmp_gt_u32 s33, 0x100000
    s_cbranch_scc1 chain_kernel_abort
    s_nop 5
    v_mov_b32 v76, 0
    v_mov_b32 v77, 0
    v_mov_b32 v78, 0
    v_mov_b32 v79, 0
    s_branch Go_20_s0123
Go_20_s1230:
    s_waitcnt vmcnt(3)
    v_cmp_eq_u32 vcc, -1, v36
    v_mov_b32_dpp v52, v36 row_ror:8 row_mask:0xf bank_mask:0xf
    v_mov_b32_dpp v53, v37 row_ror:8 row_mask:0xf bank_mask:0xf
    v_mov_b32_dpp v54, v38 row_ror:8 row_mask:0xf bank_mask:0xf
    v_mov_b32_dpp v55, v39 row_ror:8 row_mask:0xf bank_mask:0xf
    s_cbranch_vccnz Go_20_f1230
    v_smfmac_f32_16x16x64_bf16 v[76:79], v[36:39], a[200:207], v19
    v_smfmac_f32_16x16x64_bf16 v[76:79], v[52:55], a[232:239], v19
Go_20_s230:
    s_waitcnt vmcnt(2)
    v_cmp_eq_u32 vcc, -1, v40
    v_mov_b32_dpp v56, v40 row_ror:8 row_mask:0xf bank_mask:0xf
    v_mov_b32_dpp v57, v41 row_ror:8 row_mask:0xf bank_mask:0xf
    v_mov_b32_dpp v58, v42 row_ror:8 row_mask:0xf bank_mask:0xf
    v_mov_b32_dpp v59, v43 row_ror:8 row_mask:0xf bank_mask:0xf
    s_cbranch_vccnz Go_20_f230
    v_smfmac_f32_16x16x64_bf16 v[76:79], v[40:43], a[208:215], v19
    v_smfmac_f32_16x16x64_bf16 v[76:79], v[56:59], a[240:247], v19
Go_20_s30:
    s_waitcnt vmcnt(1)
    v_cmp_eq_u32 vcc, -1, v44
    v_mov_b32_dpp v60, v44 row_ror:8 row_mask:0xf bank_mask:0xf
    v_mov_b32_dpp v61, v45 row_ror:8 row_mask:0xf bank_mask:0xf
    v_mov_b32_dpp v62, v46 row_ror:8 row_mask:0xf bank_mask:0xf
    v_mov_b32_dpp v63, v47 row_ror:8 row_mask:0xf bank_mask:0xf
    s_cbranch_vccnz Go_20_f30
    v_smfmac_f32_16x16x64_bf16 v[76:79], v[44:47], a[216:223], v19
    v_smfmac_f32_16x16x64_bf16 v[76:79], v[60:63], a[248:255], v19
Go_20_s0:
    s_waitcnt vmcnt(0)
    v_cmp_eq_u32 vcc, -1, v32
    v_mov_b32_dpp v48, v32 row_ror:8 row_mask:0xf bank_mask:0xf
    v_mov_b32_dpp v49, v33 row_ror:8 row_mask:0xf bank_mask:0xf
    v_mov_b32_dpp v50, v34 row_ror:8 row_mask:0xf bank_mask:0xf
    v_mov_b32_dpp v51, v35 row_ror:8 row_mask:0xf bank_mask:0xf
    s_cbranch_vccnz Go_20_f0
    v_smfmac_f32_16x16x64_bf16 v[76:79], v[32:35], a[192:199], v19
    v_smfmac_f32_16x16x64_bf16 v[76:79], v[48:51], a[224:231], v19
    s_branch Go_20_done
Go_20_f1230:
    buffer_load_dwordx4 v[36:39], v3, s[8:11], s40 offen offset:1024 sc1
    s_add_u32 s33, s33, 1
    s_cmp_gt_u32 s33, 0x100000
    s_cbranch_scc1 chain_kernel_abort
    s_branch Go_20_s2301
Go_20_f230:
    buffer_load_dwordx4 v[40:43], v3, s[8:11], s40 offen offset:2048 sc1
    s_add_u32 s33, s33, 1
    s_cmp_gt_u32 s33, 0x100000
    s_cbranch_scc1 chain_kernel_abort
    s_branch Go_20_s302
Go_20_f30:
    buffer_load_dwordx4 v[44:47], v3, s[8:11], s40 offen offset:3072 sc1
    s_add_u32 s33, s33, 1
    s_cmp_gt_u32 s33, 0x100000
    s_cbranch_scc1 chain_kernel_abort
    s_branch Go_20_s03
Go_20_f0:
    buffer_load_dwordx4 v[32:35], v3, s[8:11], s40 offen offset:0 sc1
    s_add_u32 s33, s33, 1
    s_cmp_gt_u32 s33, 0x100000
    s_cbranch_scc1 chain_kernel_abort
    s_branch Go_20_s0
Go_20_s231:
    s_waitcnt vmcnt(2)
    v_cmp_eq_u32 vcc, -1, v40
    v_mov_b32_dpp v56, v40 row_ror:8 row_mask:0xf bank_mask:0xf
    v_mov_b32_dpp v57, v41 row_ror:8 row_mask:0xf bank_mask:0xf
    v_mov_b32_dpp v58, v42 row_ror:8 row_mask:0xf bank_mask:0xf
    v_mov_b32_dpp v59, v43 row_ror:8 row_mask:0xf bank_mask:0xf
    s_cbranch_vccnz Go_20_f231
    v_smfmac_f32_16x16x64_bf16 v[76:79], v[40:43], a[208:215], v19
    v_smfmac_f32_16x16x64_bf16 v[76:79], v[56:59], a[240:247], v19
Go_20_s31:
    s_waitcnt vmcnt(1)
    v_cmp_eq_u32 vcc, -1, v44
    v_mov_b32_dpp v60, v44 row_ror:8 row_mask:0xf bank_mask:0xf
    v_mov_b32_dpp v61, v45 row_ror:8 row_mask:0xf bank_mask:0xf
    v_mov_b32_dpp v62, v46 row_ror:8 row_mask:0xf bank_mask:0xf
    v_mov_b32_dpp v63, v47 row_ror:8 row_mask:0xf bank_mask:0xf
    s_cbranch_vccnz Go_20_f31
    v_smfmac_f32_16x16x64_bf16 v[76:79], v[44:47], a[216:223], v19
    v_smfmac_f32_16x16x64_bf16 v[76:79], v[60:63], a[248:255], v19
Go_20_s1:
    s_waitcnt vmcnt(0)
    v_cmp_eq_u32 vcc, -1, v36
    v_mov_b32_dpp v52, v36 row_ror:8 row_mask:0xf bank_mask:0xf
    v_mov_b32_dpp v53, v37 row_ror:8 row_mask:0xf bank_mask:0xf
    v_mov_b32_dpp v54, v38 row_ror:8 row_mask:0xf bank_mask:0xf
    v_mov_b32_dpp v55, v39 row_ror:8 row_mask:0xf bank_mask:0xf
    s_cbranch_vccnz Go_20_f1
    v_smfmac_f32_16x16x64_bf16 v[76:79], v[36:39], a[200:207], v19
    v_smfmac_f32_16x16x64_bf16 v[76:79], v[52:55], a[232:239], v19
    s_branch Go_20_done
Go_20_f231:
    buffer_load_dwordx4 v[40:43], v3, s[8:11], s40 offen offset:2048 sc1
    s_add_u32 s33, s33, 1
    s_cmp_gt_u32 s33, 0x100000
    s_cbranch_scc1 chain_kernel_abort
    s_branch Go_20_s312
Go_20_f31:
    buffer_load_dwordx4 v[44:47], v3, s[8:11], s40 offen offset:3072 sc1
    s_add_u32 s33, s33, 1
    s_cmp_gt_u32 s33, 0x100000
    s_cbranch_scc1 chain_kernel_abort
    s_branch Go_20_s13
Go_20_f1:
    buffer_load_dwordx4 v[36:39], v3, s[8:11], s40 offen offset:1024 sc1
    s_add_u32 s33, s33, 1
    s_cmp_gt_u32 s33, 0x100000
    s_cbranch_scc1 chain_kernel_abort
    s_branch Go_20_s1
Go_20_s32:
    s_waitcnt vmcnt(1)
    v_cmp_eq_u32 vcc, -1, v44
    v_mov_b32_dpp v60, v44 row_ror:8 row_mask:0xf bank_mask:0xf
    v_mov_b32_dpp v61, v45 row_ror:8 row_mask:0xf bank_mask:0xf
    v_mov_b32_dpp v62, v46 row_ror:8 row_mask:0xf bank_mask:0xf
    v_mov_b32_dpp v63, v47 row_ror:8 row_mask:0xf bank_mask:0xf
    s_cbranch_vccnz Go_20_f32
    v_smfmac_f32_16x16x64_bf16 v[76:79], v[44:47], a[216:223], v19
    v_smfmac_f32_16x16x64_bf16 v[76:79], v[60:63], a[248:255], v19
Go_20_s2:
    s_waitcnt vmcnt(0)
    v_cmp_eq_u32 vcc, -1, v40
    v_mov_b32_dpp v56, v40 row_ror:8 row_mask:0xf bank_mask:0xf
    v_mov_b32_dpp v57, v41 row_ror:8 row_mask:0xf bank_mask:0xf
    v_mov_b32_dpp v58, v42 row_ror:8 row_mask:0xf bank_mask:0xf
    v_mov_b32_dpp v59, v43 row_ror:8 row_mask:0xf bank_mask:0xf
    s_cbranch_vccnz Go_20_f2
    v_smfmac_f32_16x16x64_bf16 v[76:79], v[40:43], a[208:215], v19
    v_smfmac_f32_16x16x64_bf16 v[76:79], v[56:59], a[240:247], v19
    s_branch Go_20_done
Go_20_f32:
    buffer_load_dwordx4 v[44:47], v3, s[8:11], s40 offen offset:3072 sc1
    s_add_u32 s33, s33, 1
    s_cmp_gt_u32 s33, 0x100000
    s_cbranch_scc1 chain_kernel_abort
    s_branch Go_20_s23
Go_20_f2:
    buffer_load_dwordx4 v[40:43], v3, s[8:11], s40 offen offset:2048 sc1
    s_add_u32 s33, s33, 1
    s_cmp_gt_u32 s33, 0x100000
    s_cbranch_scc1 chain_kernel_abort
    s_branch Go_20_s2
Go_20_s2301:
    s_waitcnt vmcnt(3)
    v_cmp_eq_u32 vcc, -1, v40
    v_mov_b32_dpp v56, v40 row_ror:8 row_mask:0xf bank_mask:0xf
    v_mov_b32_dpp v57, v41 row_ror:8 row_mask:0xf bank_mask:0xf
    v_mov_b32_dpp v58, v42 row_ror:8 row_mask:0xf bank_mask:0xf
    v_mov_b32_dpp v59, v43 row_ror:8 row_mask:0xf bank_mask:0xf
    s_cbranch_vccnz Go_20_f2301
    v_smfmac_f32_16x16x64_bf16 v[76:79], v[40:43], a[208:215], v19
    v_smfmac_f32_16x16x64_bf16 v[76:79], v[56:59], a[240:247], v19
Go_20_s301:
    s_waitcnt vmcnt(2)
    v_cmp_eq_u32 vcc, -1, v44
    v_mov_b32_dpp v60, v44 row_ror:8 row_mask:0xf bank_mask:0xf
    v_mov_b32_dpp v61, v45 row_ror:8 row_mask:0xf bank_mask:0xf
    v_mov_b32_dpp v62, v46 row_ror:8 row_mask:0xf bank_mask:0xf
    v_mov_b32_dpp v63, v47 row_ror:8 row_mask:0xf bank_mask:0xf
    s_cbranch_vccnz Go_20_f301
    v_smfmac_f32_16x16x64_bf16 v[76:79], v[44:47], a[216:223], v19
    v_smfmac_f32_16x16x64_bf16 v[76:79], v[60:63], a[248:255], v19
Go_20_s01:
    s_waitcnt vmcnt(1)
    v_cmp_eq_u32 vcc, -1, v32
    v_mov_b32_dpp v48, v32 row_ror:8 row_mask:0xf bank_mask:0xf
    v_mov_b32_dpp v49, v33 row_ror:8 row_mask:0xf bank_mask:0xf
    v_mov_b32_dpp v50, v34 row_ror:8 row_mask:0xf bank_mask:0xf
    v_mov_b32_dpp v51, v35 row_ror:8 row_mask:0xf bank_mask:0xf
    s_cbranch_vccnz Go_20_f01
    v_smfmac_f32_16x16x64_bf16 v[76:79], v[32:35], a[192:199], v19
    v_smfmac_f32_16x16x64_bf16 v[76:79], v[48:51], a[224:231], v19
    s_branch Go_20_s1
Go_20_f2301:
    buffer_load_dwordx4 v[40:43], v3, s[8:11], s40 offen offset:2048 sc1
    s_add_u32 s33, s33, 1
    s_cmp_gt_u32 s33, 0x100000
    s_cbranch_scc1 chain_kernel_abort
    s_branch Go_20_s3012
Go_20_f301:
    buffer_load_dwordx4 v[44:47], v3, s[8:11], s40 offen offset:3072 sc1
    s_add_u32 s33, s33, 1
    s_cmp_gt_u32 s33, 0x100000
    s_cbranch_scc1 chain_kernel_abort
    s_branch Go_20_s013
Go_20_f01:
    buffer_load_dwordx4 v[32:35], v3, s[8:11], s40 offen offset:0 sc1
    s_add_u32 s33, s33, 1
    s_cmp_gt_u32 s33, 0x100000
    s_cbranch_scc1 chain_kernel_abort
    s_branch Go_20_s10
Go_20_s302:
    s_waitcnt vmcnt(2)
    v_cmp_eq_u32 vcc, -1, v44
    v_mov_b32_dpp v60, v44 row_ror:8 row_mask:0xf bank_mask:0xf
    v_mov_b32_dpp v61, v45 row_ror:8 row_mask:0xf bank_mask:0xf
    v_mov_b32_dpp v62, v46 row_ror:8 row_mask:0xf bank_mask:0xf
    v_mov_b32_dpp v63, v47 row_ror:8 row_mask:0xf bank_mask:0xf
    s_cbranch_vccnz Go_20_f302
    v_smfmac_f32_16x16x64_bf16 v[76:79], v[44:47], a[216:223], v19
    v_smfmac_f32_16x16x64_bf16 v[76:79], v[60:63], a[248:255], v19
Go_20_s02:
    s_waitcnt vmcnt(1)
    v_cmp_eq_u32 vcc, -1, v32
    v_mov_b32_dpp v48, v32 row_ror:8 row_mask:0xf bank_mask:0xf
    v_mov_b32_dpp v49, v33 row_ror:8 row_mask:0xf bank_mask:0xf
    v_mov_b32_dpp v50, v34 row_ror:8 row_mask:0xf bank_mask:0xf
    v_mov_b32_dpp v51, v35 row_ror:8 row_mask:0xf bank_mask:0xf
    s_cbranch_vccnz Go_20_f02
    v_smfmac_f32_16x16x64_bf16 v[76:79], v[32:35], a[192:199], v19
    v_smfmac_f32_16x16x64_bf16 v[76:79], v[48:51], a[224:231], v19
    s_branch Go_20_s2
Go_20_f302:
    buffer_load_dwordx4 v[44:47], v3, s[8:11], s40 offen offset:3072 sc1
    s_add_u32 s33, s33, 1
    s_cmp_gt_u32 s33, 0x100000
    s_cbranch_scc1 chain_kernel_abort
    s_branch Go_20_s023
Go_20_f02:
    buffer_load_dwordx4 v[32:35], v3, s[8:11], s40 offen offset:0 sc1
    s_add_u32 s33, s33, 1
    s_cmp_gt_u32 s33, 0x100000
    s_cbranch_scc1 chain_kernel_abort
    s_branch Go_20_s20
Go_20_s03:
    s_waitcnt vmcnt(1)
    v_cmp_eq_u32 vcc, -1, v32
    v_mov_b32_dpp v48, v32 row_ror:8 row_mask:0xf bank_mask:0xf
    v_mov_b32_dpp v49, v33 row_ror:8 row_mask:0xf bank_mask:0xf
    v_mov_b32_dpp v50, v34 row_ror:8 row_mask:0xf bank_mask:0xf
    v_mov_b32_dpp v51, v35 row_ror:8 row_mask:0xf bank_mask:0xf
    s_cbranch_vccnz Go_20_f03
    v_smfmac_f32_16x16x64_bf16 v[76:79], v[32:35], a[192:199], v19
    v_smfmac_f32_16x16x64_bf16 v[76:79], v[48:51], a[224:231], v19
    s_branch Go_20_s3
Go_20_f03:
    buffer_load_dwordx4 v[32:35], v3, s[8:11], s40 offen offset:0 sc1
    s_add_u32 s33, s33, 1
    s_cmp_gt_u32 s33, 0x100000
    s_cbranch_scc1 chain_kernel_abort
    s_branch Go_20_s30
Go_20_s312:
    s_waitcnt vmcnt(2)
    v_cmp_eq_u32 vcc, -1, v44
    v_mov_b32_dpp v60, v44 row_ror:8 row_mask:0xf bank_mask:0xf
    v_mov_b32_dpp v61, v45 row_ror:8 row_mask:0xf bank_mask:0xf
    v_mov_b32_dpp v62, v46 row_ror:8 row_mask:0xf bank_mask:0xf
    v_mov_b32_dpp v63, v47 row_ror:8 row_mask:0xf bank_mask:0xf
    s_cbranch_vccnz Go_20_f312
    v_smfmac_f32_16x16x64_bf16 v[76:79], v[44:47], a[216:223], v19
    v_smfmac_f32_16x16x64_bf16 v[76:79], v[60:63], a[248:255], v19
Go_20_s12:
    s_waitcnt vmcnt(1)
    v_cmp_eq_u32 vcc, -1, v36
    v_mov_b32_dpp v52, v36 row_ror:8 row_mask:0xf bank_mask:0xf
    v_mov_b32_dpp v53, v37 row_ror:8 row_mask:0xf bank_mask:0xf
    v_mov_b32_dpp v54, v38 row_ror:8 row_mask:0xf bank_mask:0xf
    v_mov_b32_dpp v55, v39 row_ror:8 row_mask:0xf bank_mask:0xf
    s_cbranch_vccnz Go_20_f12
    v_smfmac_f32_16x16x64_bf16 v[76:79], v[36:39], a[200:207], v19
    v_smfmac_f32_16x16x64_bf16 v[76:79], v[52:55], a[232:239], v19
    s_branch Go_20_s2
Go_20_f312:
    buffer_load_dwordx4 v[44:47], v3, s[8:11], s40 offen offset:3072 sc1
    s_add_u32 s33, s33, 1
    s_cmp_gt_u32 s33, 0x100000
    s_cbranch_scc1 chain_kernel_abort
    s_branch Go_20_s123
Go_20_f12:
    buffer_load_dwordx4 v[36:39], v3, s[8:11], s40 offen offset:1024 sc1
    s_add_u32 s33, s33, 1
    s_cmp_gt_u32 s33, 0x100000
    s_cbranch_scc1 chain_kernel_abort
    s_branch Go_20_s21
Go_20_s13:
    s_waitcnt vmcnt(1)
    v_cmp_eq_u32 vcc, -1, v36
    v_mov_b32_dpp v52, v36 row_ror:8 row_mask:0xf bank_mask:0xf
    v_mov_b32_dpp v53, v37 row_ror:8 row_mask:0xf bank_mask:0xf
    v_mov_b32_dpp v54, v38 row_ror:8 row_mask:0xf bank_mask:0xf
    v_mov_b32_dpp v55, v39 row_ror:8 row_mask:0xf bank_mask:0xf
    s_cbranch_vccnz Go_20_f13
    v_smfmac_f32_16x16x64_bf16 v[76:79], v[36:39], a[200:207], v19
    v_smfmac_f32_16x16x64_bf16 v[76:79], v[52:55], a[232:239], v19
    s_branch Go_20_s3
Go_20_f13:
    buffer_load_dwordx4 v[36:39], v3, s[8:11], s40 offen offset:1024 sc1
    s_add_u32 s33, s33, 1
    s_cmp_gt_u32 s33, 0x100000
    s_cbranch_scc1 chain_kernel_abort
    s_branch Go_20_s31
Go_20_s3012:
    s_waitcnt vmcnt(3)
    v_cmp_eq_u32 vcc, -1, v44
    v_mov_b32_dpp v60, v44 row_ror:8 row_mask:0xf bank_mask:0xf
    v_mov_b32_dpp v61, v45 row_ror:8 row_mask:0xf bank_mask:0xf
    v_mov_b32_dpp v62, v46 row_ror:8 row_mask:0xf bank_mask:0xf
    v_mov_b32_dpp v63, v47 row_ror:8 row_mask:0xf bank_mask:0xf
    s_cbranch_vccnz Go_20_f3012
    v_smfmac_f32_16x16x64_bf16 v[76:79], v[44:47], a[216:223], v19
    v_smfmac_f32_16x16x64_bf16 v[76:79], v[60:63], a[248:255], v19
Go_20_s012:
    s_waitcnt vmcnt(2)
    v_cmp_eq_u32 vcc, -1, v32
    v_mov_b32_dpp v48, v32 row_ror:8 row_mask:0xf bank_mask:0xf
    v_mov_b32_dpp v49, v33 row_ror:8 row_mask:0xf bank_mask:0xf
    v_mov_b32_dpp v50, v34 row_ror:8 row_mask:0xf bank_mask:0xf
    v_mov_b32_dpp v51, v35 row_ror:8 row_mask:0xf bank_mask:0xf
    s_cbranch_vccnz Go_20_f012
    v_smfmac_f32_16x16x64_bf16 v[76:79], v[32:35], a[192:199], v19
    v_smfmac_f32_16x16x64_bf16 v[76:79], v[48:51], a[224:231], v19
    s_branch Go_20_s12
Go_20_f3012:
    buffer_load_dwordx4 v[44:47], v3, s[8:11], s40 offen offset:3072 sc1
    s_add_u32 s33, s33, 1
    s_cmp_gt_u32 s33, 0x100000
    s_cbranch_scc1 chain_kernel_abort
    s_branch Go_20_s0123
Go_20_f012:
    buffer_load_dwordx4 v[32:35], v3, s[8:11], s40 offen offset:0 sc1
    s_add_u32 s33, s33, 1
    s_cmp_gt_u32 s33, 0x100000
    s_cbranch_scc1 chain_kernel_abort
    s_branch Go_20_s120
Go_20_s013:
    s_waitcnt vmcnt(2)
    v_cmp_eq_u32 vcc, -1, v32
    v_mov_b32_dpp v48, v32 row_ror:8 row_mask:0xf bank_mask:0xf
    v_mov_b32_dpp v49, v33 row_ror:8 row_mask:0xf bank_mask:0xf
    v_mov_b32_dpp v50, v34 row_ror:8 row_mask:0xf bank_mask:0xf
    v_mov_b32_dpp v51, v35 row_ror:8 row_mask:0xf bank_mask:0xf
    s_cbranch_vccnz Go_20_f013
    v_smfmac_f32_16x16x64_bf16 v[76:79], v[32:35], a[192:199], v19
    v_smfmac_f32_16x16x64_bf16 v[76:79], v[48:51], a[224:231], v19
    s_branch Go_20_s13
Go_20_f013:
    buffer_load_dwordx4 v[32:35], v3, s[8:11], s40 offen offset:0 sc1
    s_add_u32 s33, s33, 1
    s_cmp_gt_u32 s33, 0x100000
    s_cbranch_scc1 chain_kernel_abort
    s_branch Go_20_s130
Go_20_s10:
    s_waitcnt vmcnt(1)
    v_cmp_eq_u32 vcc, -1, v36
    v_mov_b32_dpp v52, v36 row_ror:8 row_mask:0xf bank_mask:0xf
    v_mov_b32_dpp v53, v37 row_ror:8 row_mask:0xf bank_mask:0xf
    v_mov_b32_dpp v54, v38 row_ror:8 row_mask:0xf bank_mask:0xf
    v_mov_b32_dpp v55, v39 row_ror:8 row_mask:0xf bank_mask:0xf
    s_cbranch_vccnz Go_20_f10
    v_smfmac_f32_16x16x64_bf16 v[76:79], v[36:39], a[200:207], v19
    v_smfmac_f32_16x16x64_bf16 v[76:79], v[52:55], a[232:239], v19
    s_branch Go_20_s0
Go_20_f10:
    buffer_load_dwordx4 v[36:39], v3, s[8:11], s40 offen offset:1024 sc1
    s_add_u32 s33, s33, 1
    s_cmp_gt_u32 s33, 0x100000
    s_cbranch_scc1 chain_kernel_abort
    s_branch Go_20_s01
Go_20_s023:
    s_waitcnt vmcnt(2)
    v_cmp_eq_u32 vcc, -1, v32
    v_mov_b32_dpp v48, v32 row_ror:8 row_mask:0xf bank_mask:0xf
    v_mov_b32_dpp v49, v33 row_ror:8 row_mask:0xf bank_mask:0xf
    v_mov_b32_dpp v50, v34 row_ror:8 row_mask:0xf bank_mask:0xf
    v_mov_b32_dpp v51, v35 row_ror:8 row_mask:0xf bank_mask:0xf
    s_cbranch_vccnz Go_20_f023
    v_smfmac_f32_16x16x64_bf16 v[76:79], v[32:35], a[192:199], v19
    v_smfmac_f32_16x16x64_bf16 v[76:79], v[48:51], a[224:231], v19
    s_branch Go_20_s23
Go_20_f023:
    buffer_load_dwordx4 v[32:35], v3, s[8:11], s40 offen offset:0 sc1
    s_add_u32 s33, s33, 1
    s_cmp_gt_u32 s33, 0x100000
    s_cbranch_scc1 chain_kernel_abort
    s_branch Go_20_s230
Go_20_s20:
    s_waitcnt vmcnt(1)
    v_cmp_eq_u32 vcc, -1, v40
    v_mov_b32_dpp v56, v40 row_ror:8 row_mask:0xf bank_mask:0xf
    v_mov_b32_dpp v57, v41 row_ror:8 row_mask:0xf bank_mask:0xf
    v_mov_b32_dpp v58, v42 row_ror:8 row_mask:0xf bank_mask:0xf
    v_mov_b32_dpp v59, v43 row_ror:8 row_mask:0xf bank_mask:0xf
    s_cbranch_vccnz Go_20_f20
    v_smfmac_f32_16x16x64_bf16 v[76:79], v[40:43], a[208:215], v19
    v_smfmac_f32_16x16x64_bf16 v[76:79], v[56:59], a[240:247], v19
    s_branch Go_20_s0
Go_20_f20:
    buffer_load_dwordx4 v[40:43], v3, s[8:11], s40 offen offset:2048 sc1
    s_add_u32 s33, s33, 1
    s_cmp_gt_u32 s33, 0x100000
    s_cbranch_scc1 chain_kernel_abort
    s_branch Go_20_s02
Go_20_s21:
    s_waitcnt vmcnt(1)
    v_cmp_eq_u32 vcc, -1, v40
    v_mov_b32_dpp v56, v40 row_ror:8 row_mask:0xf bank_mask:0xf
    v_mov_b32_dpp v57, v41 row_ror:8 row_mask:0xf bank_mask:0xf
    v_mov_b32_dpp v58, v42 row_ror:8 row_mask:0xf bank_mask:0xf
    v_mov_b32_dpp v59, v43 row_ror:8 row_mask:0xf bank_mask:0xf
    s_cbranch_vccnz Go_20_f21
    v_smfmac_f32_16x16x64_bf16 v[76:79], v[40:43], a[208:215], v19
    v_smfmac_f32_16x16x64_bf16 v[76:79], v[56:59], a[240:247], v19
    s_branch Go_20_s1
Go_20_f21:
    buffer_load_dwordx4 v[40:43], v3, s[8:11], s40 offen offset:2048 sc1
    s_add_u32 s33, s33, 1
    s_cmp_gt_u32 s33, 0x100000
    s_cbranch_scc1 chain_kernel_abort
    s_branch Go_20_s12
Go_20_s120:
    s_waitcnt vmcnt(2)
    v_cmp_eq_u32 vcc, -1, v36
    v_mov_b32_dpp v52, v36 row_ror:8 row_mask:0xf bank_mask:0xf
    v_mov_b32_dpp v53, v37 row_ror:8 row_mask:0xf bank_mask:0xf
    v_mov_b32_dpp v54, v38 row_ror:8 row_mask:0xf bank_mask:0xf
    v_mov_b32_dpp v55, v39 row_ror:8 row_mask:0xf bank_mask:0xf
    s_cbranch_vccnz Go_20_f120
    v_smfmac_f32_16x16x64_bf16 v[76:79], v[36:39], a[200:207], v19
    v_smfmac_f32_16x16x64_bf16 v[76:79], v[52:55], a[232:239], v19
    s_branch Go_20_s20
Go_20_f120:
    buffer_load_dwordx4 v[36:39], v3, s[8:11], s40 offen offset:1024 sc1
    s_add_u32 s33, s33, 1
    s_cmp_gt_u32 s33, 0x100000
    s_cbranch_scc1 chain_kernel_abort
    s_branch Go_20_s201
Go_20_s130:
    s_waitcnt vmcnt(2)
    v_cmp_eq_u32 vcc, -1, v36
    v_mov_b32_dpp v52, v36 row_ror:8 row_mask:0xf bank_mask:0xf
    v_mov_b32_dpp v53, v37 row_ror:8 row_mask:0xf bank_mask:0xf
    v_mov_b32_dpp v54, v38 row_ror:8 row_mask:0xf bank_mask:0xf
    v_mov_b32_dpp v55, v39 row_ror:8 row_mask:0xf bank_mask:0xf
    s_cbranch_vccnz Go_20_f130
    v_smfmac_f32_16x16x64_bf16 v[76:79], v[36:39], a[200:207], v19
    v_smfmac_f32_16x16x64_bf16 v[76:79], v[52:55], a[232:239], v19
    s_branch Go_20_s30
Go_20_f130:
    buffer_load_dwordx4 v[36:39], v3, s[8:11], s40 offen offset:1024 sc1
    s_add_u32 s33, s33, 1
    s_cmp_gt_u32 s33, 0x100000
    s_cbranch_scc1 chain_kernel_abort
    s_branch Go_20_s301
Go_20_s201:
    s_waitcnt vmcnt(2)
    v_cmp_eq_u32 vcc, -1, v40
    v_mov_b32_dpp v56, v40 row_ror:8 row_mask:0xf bank_mask:0xf
    v_mov_b32_dpp v57, v41 row_ror:8 row_mask:0xf bank_mask:0xf
    v_mov_b32_dpp v58, v42 row_ror:8 row_mask:0xf bank_mask:0xf
    v_mov_b32_dpp v59, v43 row_ror:8 row_mask:0xf bank_mask:0xf
    s_cbranch_vccnz Go_20_f201
    v_smfmac_f32_16x16x64_bf16 v[76:79], v[40:43], a[208:215], v19
    v_smfmac_f32_16x16x64_bf16 v[76:79], v[56:59], a[240:247], v19
    s_branch Go_20_s01
Go_20_f201:
    buffer_load_dwordx4 v[40:43], v3, s[8:11], s40 offen offset:2048 sc1
    s_add_u32 s33, s33, 1
    s_cmp_gt_u32 s33, 0x100000
    s_cbranch_scc1 chain_kernel_abort
    s_branch Go_20_s012
L_pf_22:
    s_mov_b64 exec, -1
    buffer_load_short_d16_hi v220, v9, s[8:11], s43 offen sc1
    buffer_load_short_d16_hi v221, v10, s[8:11], s43 offen sc1
    buffer_load_short_d16_hi v222, v11, s[8:11], s43 offen sc1
    s_add_u32 s33, s33, 1
    s_cmp_gt_u32 s33, 0x100000
    s_cbranch_scc1 chain_kernel_abort
    s_branch L_pd_21_1
L_pd_21_1:
    s_waitcnt vmcnt(7)
    v_add_f32 v208, v80, v223
    s_waitcnt vmcnt(5)
    v_max3_u32 v20, v223, v224, v225
    v_add_f32 v209, v224, v225
    v_cmp_eq_u32 vcc, 0xffff0000, v20
    v_add_f32 v208, v208, v209
    s_nop 1
    v_mov_b32_dpp v209, v208 quad_perm:[1,0,3,2] row_mask:0xf bank_mask:0xf
    s_mov_b64 exec, s[26:27]
    v_cvt_pk_bf16_f32 v208, v208, v209
    v_min_u32 v208, 0xfffffffe, v208
    s_cbranch_vccnz L_pf_23
    s_branch L_pd_21
L_pf_23:
    s_mov_b64 exec, -1
    buffer_load_short_d16_hi v223, v9, s[8:11], s44 offen sc1
    buffer_load_short_d16_hi v224, v10, s[8:11], s44 offen sc1
    buffer_load_short_d16_hi v225, v11, s[8:11], s44 offen sc1
    s_add_u32 s33, s33, 1
    s_cmp_gt_u32 s33, 0x100000
    s_cbranch_scc1 chain_kernel_abort
    s_branch L_pd_21_2
L_pd_21_2:
    s_waitcnt vmcnt(5)
    v_add_f32 v208, v80, v220
    s_waitcnt vmcnt(3)
    v_max3_u32 v20, v220, v221, v222
    v_add_f32 v209, v221, v222
    v_cmp_eq_u32 vcc, 0xffff0000, v20
    v_add_f32 v208, v208, v209
    s_nop 1
    v_mov_b32_dpp v209, v208 quad_perm:[1,0,3,2] row_mask:0xf bank_mask:0xf
    s_mov_b64 exec, s[26:27]
    v_cvt_pk_bf16_f32 v208, v208, v209
    v_min_u32 v208, 0xfffffffe, v208
    s_cbranch_vccnz L_pf_24
    s_branch L_pd_21
L_pf_24:
    s_mov_b64 exec, -1
    buffer_load_short_d16_hi v220, v9, s[8:11], s43 offen sc1
    buffer_load_short_d16_hi v221, v10, s[8:11], s43 offen sc1
    buffer_load_short_d16_hi v222, v11, s[8:11], s43 offen sc1
    s_add_u32 s33, s33, 1
    s_cmp_gt_u32 s33, 0x100000
    s_cbranch_scc1 chain_kernel_abort
    s_branch L_pd_21_3
L_pd_21_3:
    s_waitcnt vmcnt(5)
    v_add_f32 v208, v80, v223
    s_waitcnt vmcnt(3)
    v_max3_u32 v20, v223, v224, v225
    v_add_f32 v209, v224, v225
    v_cmp_eq_u32 vcc, 0xffff0000, v20
    v_add_f32 v208, v208, v209
    s_nop 1
    v_mov_b32_dpp v209, v208 quad_perm:[1,0,3,2] row_mask:0xf bank_mask:0xf
    s_mov_b64 exec, s[26:27]
    v_cvt_pk_bf16_f32 v208, v208, v209
    v_min_u32 v208, 0xfffffffe, v208
    s_cbranch_vccnz L_pf_25
    s_branch L_pd_21
L_pf_25:
    s_mov_b64 exec, -1
    buffer_load_short_d16_hi v223, v9, s[8:11], s44 offen sc1
    buffer_load_short_d16_hi v224, v10, s[8:11], s44 offen sc1
    buffer_load_short_d16_hi v225, v11, s[8:11], s44 offen sc1
    s_add_u32 s33, s33, 1
    s_cmp_gt_u32 s33, 0x100000
    s_cbranch_scc1 chain_kernel_abort
    s_branch L_pd_21_2
chain_kernel_abort:
    s_mov_b32 s12, s98
    s_and_b32 s13, s99, 0xffff
    s_mov_b32 s14, 0x100
    s_mov_b32 s15, 0x00020000
    s_mov_b64 exec, 1
    v_mov_b32 v1, s19
    v_or_b32 v1, 0xdead0000, v1
    v_mov_b32 v2, 124
    buffer_store_dword v1, v2, s[12:15], 0 offen
chain_kernel_done:
    s_endpgm
chain_kernel_end:
    s_endpgm
chain_kernel_worker:
    s_sub_u32 s56, s16, 4
    s_mov_b32 s57, s17
    s_mov_b32 s58, s18
    s_cmp_eq_u32 s56, 0
    s_cbranch_scc1 L_big_37
kvs_start:
    s_cmp_eq_u32 s56, 3
    s_cselect_b64 s[12:13], s[90:91], s[88:89]
    s_cmp_eq_u32 s56, 1
    s_cselect_b64 s[12:13], s[86:87], s[12:13]
    s_and_b32 s13, s13, 0xffff
    s_mov_b32 s14, 0x800000
    s_mov_b32 s15, 0x00020000
    s_lshl_b32 s28, s57, 8
    v_bfe_u32 v24, v0, 4, 3
    v_lshlrev_b32 v24, 1, v24
    v_and_b32 v25, 15, v0
    v_xor_b32 v24, v24, v25
    v_lshlrev_b32 v6, 4, v24
    v_bfe_u32 v24, v0, 4, 2
    v_lshl_add_u32 v6, v24, 13, v6
    v_bfe_u32 v24, v0, 6, 1
    v_lshl_add_u32 v6, v24, 16, v6
    v_bfe_u32 v24, v0, 7, 1
    v_lshl_add_u32 v6, v24, 15, v6
    s_and_b32 s60, s58, 1
    s_lshl_b32 s61, s60, 11
    s_lshr_b32 s60, s58, 1
    s_lshl_b32 s60, s60, 10
    s_add_u32 s32, s60, s61
    s_add_u32 m0, s32, 0
    s_add_u32 s61, s28, 0x0
    buffer_load_dwordx4 v6, s[12:15], s61 offen nt lds
    s_add_u32 m0, s32, 4096
    s_add_u32 s61, s28, 0x20000
    buffer_load_dwordx4 v6, s[12:15], s61 offen nt lds
    s_add_u32 m0, s32, 8192
    s_add_u32 s61, s28, 0x40000
    buffer_load_dwordx4 v6, s[12:15], s61 offen nt lds
    s_add_u32 m0, s32, 12288
    s_add_u32 s61, s28, 0x60000
    buffer_load_dwordx4 v6, s[12:15], s61 offen nt lds
    s_add_u32 m0, s32, 16384
    s_add_u32 s61, s28, 0x80000
    buffer_load_dwordx4 v6, s[12:15], s61 offen nt lds
    s_add_u32 m0, s32, 20480
    s_add_u32 s61, s28, 0xa0000
    buffer_load_dwordx4 v6, s[12:15], s61 offen nt lds
    s_add_u32 m0, s32, 24576
    s_add_u32 s61, s28, 0xc0000
    buffer_load_dwordx4 v6, s[12:15], s61 offen nt lds
    s_add_u32 m0, s32, 28672
    s_add_u32 s61, s28, 0xe0000
    buffer_load_dwordx4 v6, s[12:15], s61 offen nt lds
    s_mov_b32 s8, s82
    s_and_b32 s9, s83, 0xffff
    s_mov_b32 s10, 0x400000
    s_mov_b32 s11, 0x00020000
    s_mov_b32 s16, s100
    s_and_b32 s17, s101, 0xffff
    s_mov_b32 s18, 0xc000000
    s_mov_b32 s19, 0x00020000
    v_and_b32 v24, 63, v0
    v_lshlrev_b32 v1, 4, v24
    v_add_u32 v12, 4096, v1
    v_lshlrev_b32 v10, 7, v24
    s_lshl_b32 s27, s57, 13
    s_add_u32 m0, s32, 32768
    s_add_u32 s61, s28, 0x100000
    buffer_load_dwordx4 v6, s[12:15], s61 offen nt lds
    s_add_u32 m0, s32, 36864
    s_add_u32 s61, s28, 0x120000
    buffer_load_dwordx4 v6, s[12:15], s61 offen nt lds
    s_add_u32 m0, s32, 40960
    s_add_u32 s61, s28, 0x140000
    buffer_load_dwordx4 v6, s[12:15], s61 offen nt lds
    s_add_u32 m0, s32, 45056
    s_add_u32 s61, s28, 0x160000
    buffer_load_dwordx4 v6, s[12:15], s61 offen nt lds
    s_add_u32 m0, s32, 49152
    s_add_u32 s61, s28, 0x180000
    buffer_load_dwordx4 v6, s[12:15], s61 offen nt lds
    s_add_u32 m0, s32, 53248
    s_add_u32 s61, s28, 0x1a0000
    buffer_load_dwordx4 v6, s[12:15], s61 offen nt lds
    s_add_u32 m0, s32, 57344
    s_add_u32 s61, s28, 0x1c0000
    buffer_load_dwordx4 v6, s[12:15], s61 offen nt lds
    s_add_u32 m0, s32, 61440
    s_add_u32 s61, s28, 0x1e0000
    buffer_load_dwordx4 v6, s[12:15], s61 offen nt lds
    v_bfe_u32 v24, v0, 4, 3
    v_and_b32 v25, 7, v0
    v_xor_b32 v24, v24, v25
    v_lshlrev_b32 v2, 4, v24
    v_lshrrev_b32 v24, 3, v0
    v_lshl_add_u32 v2, v24, 11, v2
    v_bfe_u32 v24, v0, 1, 3
    v_bfe_u32 v25, v0, 4, 2
    v_xor_b32 v24, v24, v25
    v_lshlrev_b32 v4, 4, v24
    v_and_b32 v25, 15, v0
    v_lshl_add_u32 v4, v25, 7, v4
    v_add_u32 v4, 98304, v4
    v_xor_b32 v5, 64, v4
    s_add_u32 m0, s32, 65536
    s_add_u32 s61, s28, 0x200000
    buffer_load_dwordx4 v6, s[12:15], s61 offen nt lds
    s_add_u32 m0, s32, 69632
    s_add_u32 s61, s28, 0x220000
    buffer_load_dwordx4 v6, s[12:15], s61 offen nt lds
    s_add_u32 m0, s32, 73728
    s_add_u32 s61, s28, 0x240000
    buffer_load_dwordx4 v6, s[12:15], s61 offen nt lds
    s_add_u32 m0, s32, 77824
    s_add_u32 s61, s28, 0x260000
    buffer_load_dwordx4 v6, s[12:15], s61 offen nt lds
    s_add_u32 m0, s32, 81920
    s_add_u32 s61, s28, 0x280000
    buffer_load_dwordx4 v6, s[12:15], s61 offen nt lds
    s_add_u32 m0, s32, 86016
    s_add_u32 s61, s28, 0x2a0000
    buffer_load_dwordx4 v6, s[12:15], s61 offen nt lds
    s_add_u32 m0, s32, 90112
    s_add_u32 s61, s28, 0x2c0000
    buffer_load_dwordx4 v6, s[12:15], s61 offen nt lds
    s_add_u32 m0, s32, 94208
    s_add_u32 s61, s28, 0x2e0000
    buffer_load_dwordx4 v6, s[12:15], s61 offen nt lds
    v_bfe_u32 v24, v0, 2, 3
    v_lshrrev_b32 v25, 6, v0
    v_lshlrev_b32 v25, 1, v25
    v_xor_b32 v24, v24, v25
    v_lshlrev_b32 v8, 5, v24
    v_bfe_u32 v24, v0, 0, 2
    v_lshl_add_u32 v8, v24, 3, v8
    v_bfe_u32 v24, v0, 2, 2
    v_lshl_add_u32 v8, v24, 8, v8
    v_bfe_u32 v24, v0, 4, 2
    v_lshl_add_u32 v8, v24, 11, v8
    v_xor_b32 v9, 32, v8
    v_mov_b32 v28, -1
    v_mov_b32 v29, -1
    v_mov_b32 v30, -1
    v_mov_b32 v31, -1
    s_lshl_b32 s20, s58, 10
    s_add_u32 s20, s20, 98304
    s_mov_b32 s21, 98304
    s_mov_b32 s23, 0
    s_mov_b32 s29, 32768
    s_add_u32 m0, s32, 98304
    s_add_u32 s61, s28, 0x300000
    buffer_load_dwordx4 v6, s[12:15], s61 offen nt lds
    s_add_u32 m0, s32, 102400
    s_add_u32 s61, s28, 0x320000
    buffer_load_dwordx4 v6, s[12:15], s61 offen nt lds
    s_add_u32 m0, s32, 106496
    s_add_u32 s61, s28, 0x340000
    buffer_load_dwordx4 v6, s[12:15], s61 offen nt lds
    s_add_u32 m0, s32, 110592
    s_add_u32 s61, s28, 0x360000
    buffer_load_dwordx4 v6, s[12:15], s61 offen nt lds
    s_add_u32 m0, s32, 114688
    s_add_u32 s61, s28, 0x380000
    buffer_load_dwordx4 v6, s[12:15], s61 offen nt lds
    s_add_u32 m0, s32, 118784
    s_add_u32 s61, s28, 0x3a0000
    buffer_load_dwordx4 v6, s[12:15], s61 offen nt lds
    s_add_u32 m0, s32, 122880
    s_add_u32 s61, s28, 0x3c0000
    buffer_load_dwordx4 v6, s[12:15], s61 offen nt lds
    s_add_u32 m0, s32, 126976
    s_add_u32 s61, s28, 0x3e0000
    buffer_load_dwordx4 v6, s[12:15], s61 offen nt lds
    s_lshl_b32 s30, s57, 16
    s_cmp_eq_u32 s56, 3
    s_cselect_b32 s60, 11, 10
    s_cselect_b32 s61, 0x4000, 0
    s_lshl_b32 s60, s58, s60
    s_add_u32 s30, s30, s60
    s_add_u32 s30, s30, s61
    s_lshr_b32 s31, s57, 1
    s_lshl_b32 s31, s31, 14
    s_and_b32 s61, s57, 1
    s_lshl2_add_u32 s60, s61, s58
    s_lshl_b32 s60, s60, 10
    s_add_u32 s31, s31, s60
    s_mov_b32 s61, 0xc000000
    s_cmp_eq_u32 s56, 1
    s_cmov_b32 s61, 0x8000000
    s_add_u32 s31, s31, s61
    s_cmp_eq_u32 s56, 1
    s_cselect_b32 s60, 0x8000, 0
    s_add_u32 s30, s30, s60
    s_add_u32 m0, s32, 131072
    s_add_u32 s61, s28, 0x400000
    buffer_load_dwordx4 v6, s[12:15], s61 offen nt lds
    s_add_u32 m0, s32, 135168
    s_add_u32 s61, s28, 0x420000
    buffer_load_dwordx4 v6, s[12:15], s61 offen nt lds
    s_add_u32 m0, s32, 139264
    s_add_u32 s61, s28, 0x440000
    buffer_load_dwordx4 v6, s[12:15], s61 offen nt lds
    s_add_u32 m0, s32, 143360
    s_add_u32 s61, s28, 0x460000
    buffer_load_dwordx4 v6, s[12:15], s61 offen nt lds
    s_add_u32 m0, s32, 147456
    s_add_u32 s61, s28, 0x480000
    buffer_load_dwordx4 v6, s[12:15], s61 offen nt lds
    s_add_u32 m0, s32, 151552
    s_add_u32 s61, s28, 0x4a0000
    buffer_load_dwordx4 v6, s[12:15], s61 offen nt lds
    s_add_u32 m0, s32, 155648
    s_add_u32 s61, s28, 0x4c0000
    buffer_load_dwordx4 v6, s[12:15], s61 offen nt lds
    s_add_u32 m0, s32, 159744
    s_add_u32 s61, s28, 0x4e0000
    buffer_load_dwordx4 v6, s[12:15], s61 offen nt lds
    s_waitcnt vmcnt(32)
    s_barrier
    ds_read_b64_tr_b16 a[0:1], v8 offset:0
    ds_read_b64_tr_b16 a[2:3], v8 offset:1024
    ds_read_b64_tr_b16 a[4:5], v9 offset:0
    ds_read_b64_tr_b16 a[6:7], v9 offset:1024
    ds_read_b64_tr_b16 a[8:9], v8 offset:8192
    ds_read_b64_tr_b16 a[10:11], v8 offset:9216
    ds_read_b64_tr_b16 a[12:13], v9 offset:8192
    ds_read_b64_tr_b16 a[14:15], v9 offset:9216
    s_waitcnt lgkmcnt(0)
    ds_read_b64_tr_b16 a[16:17], v8 offset:16384
    ds_read_b64_tr_b16 a[18:19], v8 offset:17408
    ds_read_b64_tr_b16 a[20:21], v9 offset:16384
    ds_read_b64_tr_b16 a[22:23], v9 offset:17408
    ds_read_b64_tr_b16 a[24:25], v8 offset:24576
    ds_read_b64_tr_b16 a[26:27], v8 offset:25600
    ds_read_b64_tr_b16 a[28:29], v9 offset:24576
    ds_read_b64_tr_b16 a[30:31], v9 offset:25600
    s_waitcnt lgkmcnt(0)
    s_waitcnt vmcnt(24)
    s_barrier
    s_add_u32 m0, s32, 0
    s_add_u32 s61, s28, 0x500000
    buffer_load_dwordx4 v6, s[12:15], s61 offen nt lds
    s_add_u32 m0, s32, 4096
    s_add_u32 s61, s28, 0x520000
    buffer_load_dwordx4 v6, s[12:15], s61 offen nt lds
    s_add_u32 m0, s32, 8192
    s_add_u32 s61, s28, 0x540000
    buffer_load_dwordx4 v6, s[12:15], s61 offen nt lds
    s_add_u32 m0, s32, 12288
    s_add_u32 s61, s28, 0x560000
    buffer_load_dwordx4 v6, s[12:15], s61 offen nt lds
    s_add_u32 m0, s32, 16384
    s_add_u32 s61, s28, 0x580000
    buffer_load_dwordx4 v6, s[12:15], s61 offen nt lds
    s_add_u32 m0, s32, 20480
    s_add_u32 s61, s28, 0x5a0000
    buffer_load_dwordx4 v6, s[12:15], s61 offen nt lds
    s_add_u32 m0, s32, 24576
    s_add_u32 s61, s28, 0x5c0000
    buffer_load_dwordx4 v6, s[12:15], s61 offen nt lds
    s_add_u32 m0, s32, 28672
    s_add_u32 s61, s28, 0x5e0000
    buffer_load_dwordx4 v6, s[12:15], s61 offen nt lds
    ds_read_b64_tr_b16 a[32:33], v8 offset:32768
    ds_read_b64_tr_b16 a[34:35], v8 offset:33792
    ds_read_b64_tr_b16 a[36:37], v9 offset:32768
    ds_read_b64_tr_b16 a[38:39], v9 offset:33792
    ds_read_b64_tr_b16 a[40:41], v8 offset:40960
    ds_read_b64_tr_b16 a[42:43], v8 offset:41984
    ds_read_b64_tr_b16 a[44:45], v9 offset:40960
    ds_read_b64_tr_b16 a[46:47], v9 offset:41984
    s_waitcnt lgkmcnt(0)
    ds_read_b64_tr_b16 a[48:49], v8 offset:49152
    ds_read_b64_tr_b16 a[50:51], v8 offset:50176
    ds_read_b64_tr_b16 a[52:53], v9 offset:49152
    ds_read_b64_tr_b16 a[54:55], v9 offset:50176
    ds_read_b64_tr_b16 a[56:57], v8 offset:57344
    ds_read_b64_tr_b16 a[58:59], v8 offset:58368
    ds_read_b64_tr_b16 a[60:61], v9 offset:57344
    ds_read_b64_tr_b16 a[62:63], v9 offset:58368
    s_waitcnt lgkmcnt(0)
    s_waitcnt vmcnt(24)
    s_barrier
    s_add_u32 m0, s32, 32768
    s_add_u32 s61, s28, 0x600000
    buffer_load_dwordx4 v6, s[12:15], s61 offen nt lds
    s_add_u32 m0, s32, 36864
    s_add_u32 s61, s28, 0x620000
    buffer_load_dwordx4 v6, s[12:15], s61 offen nt lds
    s_add_u32 m0, s32, 40960
    s_add_u32 s61, s28, 0x640000
    buffer_load_dwordx4 v6, s[12:15], s61 offen nt lds
    s_add_u32 m0, s32, 45056
    s_add_u32 s61, s28, 0x660000
    buffer_load_dwordx4 v6, s[12:15], s61 offen nt lds
    s_add_u32 m0, s32, 49152
    s_add_u32 s61, s28, 0x680000
    buffer_load_dwordx4 v6, s[12:15], s61 offen nt lds
    s_add_u32 m0, s32, 53248
    s_add_u32 s61, s28, 0x6a0000
    buffer_load_dwordx4 v6, s[12:15], s61 offen nt lds
    s_add_u32 m0, s32, 57344
    s_add_u32 s61, s28, 0x6c0000
    buffer_load_dwordx4 v6, s[12:15], s61 offen nt lds
    s_add_u32 m0, s32, 61440
    s_add_u32 s61, s28, 0x6e0000
    buffer_load_dwordx4 v6, s[12:15], s61 offen nt lds
    s_and_b32 s60, s58, 1
    s_lshl_b32 s60, s60, 18
    s_add_u32 s60, s60, s27
    buffer_load_dword v13, v10, s[8:11], s60 offen
    s_add_u32 s27, s27, 0x80000
    v_add_u32 v8, 0x10000, v8
    v_add_u32 v9, 0x10000, v9
    ds_read_b64_tr_b16 a[64:65], v8 offset:0
    ds_read_b64_tr_b16 a[66:67], v8 offset:1024
    ds_read_b64_tr_b16 a[68:69], v9 offset:0
    ds_read_b64_tr_b16 a[70:71], v9 offset:1024
    ds_read_b64_tr_b16 a[72:73], v8 offset:8192
    ds_read_b64_tr_b16 a[74:75], v8 offset:9216
    ds_read_b64_tr_b16 a[76:77], v9 offset:8192
    ds_read_b64_tr_b16 a[78:79], v9 offset:9216
    s_waitcnt lgkmcnt(0)
    ds_read_b64_tr_b16 a[80:81], v8 offset:16384
    ds_read_b64_tr_b16 a[82:83], v8 offset:17408
    ds_read_b64_tr_b16 a[84:85], v9 offset:16384
    ds_read_b64_tr_b16 a[86:87], v9 offset:17408
    ds_read_b64_tr_b16 a[88:89], v8 offset:24576
    ds_read_b64_tr_b16 a[90:91], v8 offset:25600
    ds_read_b64_tr_b16 a[92:93], v9 offset:24576
    ds_read_b64_tr_b16 a[94:95], v9 offset:25600
    s_waitcnt lgkmcnt(0)
    s_waitcnt vmcnt(24)
    s_barrier
    s_add_u32 m0, s32, 65536
    s_add_u32 s61, s28, 0x700000
    buffer_load_dwordx4 v6, s[12:15], s61 offen nt lds
    s_add_u32 m0, s32, 69632
    s_add_u32 s61, s28, 0x720000
    buffer_load_dwordx4 v6, s[12:15], s61 offen nt lds
    s_add_u32 m0, s32, 73728
    s_add_u32 s61, s28, 0x740000
    buffer_load_dwordx4 v6, s[12:15], s61 offen nt lds
    s_add_u32 m0, s32, 77824
    s_add_u32 s61, s28, 0x760000
    buffer_load_dwordx4 v6, s[12:15], s61 offen nt lds
    s_add_u32 m0, s32, 81920
    s_add_u32 s61, s28, 0x780000
    buffer_load_dwordx4 v6, s[12:15], s61 offen nt lds
    s_add_u32 m0, s32, 86016
    s_add_u32 s61, s28, 0x7a0000
    buffer_load_dwordx4 v6, s[12:15], s61 offen nt lds
    s_add_u32 m0, s32, 90112
    s_add_u32 s61, s28, 0x7c0000
    buffer_load_dwordx4 v6, s[12:15], s61 offen nt lds
    s_add_u32 m0, s32, 94208
    s_add_u32 s61, s28, 0x7e0000
    buffer_load_dwordx4 v6, s[12:15], s61 offen nt lds
    v_mov_b32 v24, 4
    global_load_dword v11, v24, s[98:99] sc1
    s_or_b32 s60, s2, s58
    s_cbranch_scc1 L_rw_38
    s_lshl_b32 s62, s56, 3
    s_add_u32 s62, s62, 160
    s_mov_b32 s63, 0
L_rp_39:
    s_load_dwordx2 s[60:61], s[98:99], s62 glc
    s_add_u32 s63, s63, 1
    s_cmp_gt_u32 s63, 0x100000
    s_cbranch_scc1 chain_kernel_wabort
    s_waitcnt lgkmcnt(0)
    s_cmp_lt_u32 s61, 0x2000
    s_cbranch_scc1 L_rp_39
    s_lshr_b32 s61, s95, 8
    s_cmp_eq_u32 s60, -1
    s_cselect_b32 s94, -1, s61
L_rw_38:
    ds_read_b64_tr_b16 a[96:97], v8 offset:32768
    ds_read_b64_tr_b16 a[98:99], v8 offset:33792
    ds_read_b64_tr_b16 a[100:101], v9 offset:32768
    ds_read_b64_tr_b16 a[102:103], v9 offset:33792
    ds_read_b64_tr_b16 a[104:105], v8 offset:40960
    ds_read_b64_tr_b16 a[106:107], v8 offset:41984
    ds_read_b64_tr_b16 a[108:109], v9 offset:40960
    ds_read_b64_tr_b16 a[110:111], v9 offset:41984
    s_waitcnt lgkmcnt(0)
    ds_read_b64_tr_b16 a[112:113], v8 offset:49152
    ds_read_b64_tr_b16 a[114:115], v8 offset:50176
    ds_read_b64_tr_b16 a[116:117], v9 offset:49152
    ds_read_b64_tr_b16 a[118:119], v9 offset:50176
    ds_read_b64_tr_b16 a[120:121], v8 offset:57344
    ds_read_b64_tr_b16 a[122:123], v8 offset:58368
    ds_read_b64_tr_b16 a[124:125], v9 offset:57344
    ds_read_b64_tr_b16 a[126:127], v9 offset:58368
    s_waitcnt lgkmcnt(0)
    s_waitcnt vmcnt(24)
    s_barrier
    s_add_u32 m0, s20, 0
    s_nop 0
    buffer_load_dwordx4 v2, s[8:11], s23 offen offset:0 lds
    s_add_u32 m0, s20, 3968
    s_nop 0
    buffer_load_dwordx4 v2, s[8:11], s23 offen offset:128 lds
    s_add_u32 m0, s20, 7936
    s_nop 0
    buffer_load_dwordx4 v2, s[8:11], s23 offen offset:256 lds
    s_add_u32 m0, s20, 11904
    s_nop 0
    buffer_load_dwordx4 v2, s[8:11], s23 offen offset:384 lds
    s_add_u32 m0, s20, 15872
    s_nop 0
    buffer_load_dwordx4 v2, s[8:11], s23 offen offset:512 lds
    s_add_u32 m0, s20, 19840
    s_nop 0
    buffer_load_dwordx4 v2, s[8:11], s23 offen offset:640 lds
    s_add_u32 m0, s20, 23808
    s_nop 0
    buffer_load_dwordx4 v2, s[8:11], s23 offen offset:768 lds
    s_add_u32 m0, s20, 27776
    s_nop 0
    buffer_load_dwordx4 v2, s[8:11], s23 offen offset:896 lds
    s_add_u32 s23, s23, 1024
    s_bitcmp1_b32 s23, 11
    s_cselect_b32 s60, 0xf800, 0
    s_add_u32 s23, s23, s60
    s_add_u32 s20, s20, 32768
    s_cmp_ge_u32 s20, 163840
    s_cselect_b32 s60, 163840, 0
    s_sub_u32 s20, s20, s60
    v_add_u32 v8, 0x10000, v8
    v_add_u32 v9, 0x10000, v9
    ds_read_b64_tr_b16 a[128:129], v8 offset:0
    ds_read_b64_tr_b16 a[130:131], v8 offset:1024
    ds_read_b64_tr_b16 a[132:133], v9 offset:0
    ds_read_b64_tr_b16 a[134:135], v9 offset:1024
    ds_read_b64_tr_b16 a[136:137], v8 offset:8192
    ds_read_b64_tr_b16 a[138:139], v8 offset:9216
    ds_read_b64_tr_b16 a[140:141], v9 offset:8192
    ds_read_b64_tr_b16 a[142:143], v9 offset:9216
    s_waitcnt lgkmcnt(0)
    ds_read_b64_tr_b16 a[144:145], v8 offset:16384
    ds_read_b64_tr_b16 a[146:147], v8 offset:17408
    ds_read_b64_tr_b16 a[148:149], v9 offset:16384
    ds_read_b64_tr_b16 a[150:151], v9 offset:17408
    ds_read_b64_tr_b16 a[152:153], v8 offset:24576
    ds_read_b64_tr_b16 a[154:155], v8 offset:25600
    ds_read_b64_tr_b16 a[156:157], v9 offset:24576
    ds_read_b64_tr_b16 a[158:159], v9 offset:25600
    s_waitcnt lgkmcnt(0)
    s_waitcnt vmcnt(24)
    s_barrier
    s_add_u32 m0, s20, 0
    s_nop 0
    buffer_load_dwordx4 v2, s[8:11], s23 offen offset:0 lds
    s_add_u32 m0, s20, 3968
    s_nop 0
    buffer_load_dwordx4 v2, s[8:11], s23 offen offset:128 lds
    s_add_u32 m0, s20, 7936
    s_nop 0
    buffer_load_dwordx4 v2, s[8:11], s23 offen offset:256 lds
    s_add_u32 m0, s20, 11904
    s_nop 0
    buffer_load_dwordx4 v2, s[8:11], s23 offen offset:384 lds
    s_add_u32 m0, s20, 15872
    s_nop 0
    buffer_load_dwordx4 v2, s[8:11], s23 offen offset:512 lds
    s_add_u32 m0, s20, 19840
    s_nop 0
    buffer_load_dwordx4 v2, s[8:11], s23 offen offset:640 lds
    s_add_u32 m0, s20, 23808
    s_nop 0
    buffer_load_dwordx4 v2, s[8:11], s23 offen offset:768 lds
    s_add_u32 m0, s20, 27776
    s_nop 0
    buffer_load_dwordx4 v2, s[8:11], s23 offen offset:896 lds
    s_add_u32 s23, s23, 1024
    s_bitcmp1_b32 s23, 11
    s_cselect_b32 s60, 0xf800, 0
    s_add_u32 s23, s23, s60
    s_add_u32 s20, s20, 32768
    s_cmp_ge_u32 s20, 163840
    s_cselect_b32 s60, 163840, 0
    s_sub_u32 s20, s20, s60
    v_add_u32 v8, 0xfffe0000, v8
    v_add_u32 v9, 0xfffe0000, v9
    ds_read_b64_tr_b16 a[160:161], v8 offset:0
    ds_read_b64_tr_b16 a[162:163], v8 offset:1024
    ds_read_b64_tr_b16 a[164:165], v9 offset:0
    ds_read_b64_tr_b16 a[166:167], v9 offset:1024
    ds_read_b64_tr_b16 a[168:169], v8 offset:8192
    ds_read_b64_tr_b16 a[170:171], v8 offset:9216
    ds_read_b64_tr_b16 a[172:173], v9 offset:8192
    ds_read_b64_tr_b16 a[174:175], v9 offset:9216
    s_waitcnt lgkmcnt(0)
    ds_read_b64_tr_b16 a[176:177], v8 offset:16384
    ds_read_b64_tr_b16 a[178:179], v8 offset:17408
    ds_read_b64_tr_b16 a[180:181], v9 offset:16384
    ds_read_b64_tr_b16 a[182:183], v9 offset:17408
    ds_read_b64_tr_b16 a[184:185], v8 offset:24576
    ds_read_b64_tr_b16 a[186:187], v8 offset:25600
    ds_read_b64_tr_b16 a[188:189], v9 offset:24576
    ds_read_b64_tr_b16 a[190:191], v9 offset:25600
    s_waitcnt lgkmcnt(0)
    s_waitcnt vmcnt(24)
    s_barrier
    s_add_u32 m0, s20, 0
    s_nop 0
    buffer_load_dwordx4 v2, s[8:11], s23 offen offset:0 lds
    s_add_u32 m0, s20, 3968
    s_nop 0
    buffer_load_dwordx4 v2, s[8:11], s23 offen offset:128 lds
    s_add_u32 m0, s20, 7936
    s_nop 0
    buffer_load_dwordx4 v2, s[8:11], s23 offen offset:256 lds
    s_add_u32 m0, s20, 11904
    s_nop 0
    buffer_load_dwordx4 v2, s[8:11], s23 offen offset:384 lds
    s_add_u32 m0, s20, 15872
    s_nop 0
    buffer_load_dwordx4 v2, s[8:11], s23 offen offset:512 lds
    s_add_u32 m0, s20, 19840
    s_nop 0
    buffer_load_dwordx4 v2, s[8:11], s23 offen offset:640 lds
    s_add_u32 m0, s20, 23808
    s_nop 0
    buffer_load_dwordx4 v2, s[8:11], s23 offen offset:768 lds
    s_add_u32 m0, s20, 27776
    s_nop 0
    buffer_load_dwordx4 v2, s[8:11], s23 offen offset:896 lds
    s_add_u32 s23, s23, 1024
    s_bitcmp1_b32 s23, 11
    s_cselect_b32 s60, 0xf800, 0
    s_add_u32 s23, s23, s60
    s_add_u32 s20, s20, 32768
    s_cmp_ge_u32 s20, 163840
    s_cselect_b32 s60, 163840, 0
    s_sub_u32 s20, s20, s60
    ds_read_b64_tr_b16 a[192:193], v8 offset:32768
    ds_read_b64_tr_b16 a[194:195], v8 offset:33792
    ds_read_b64_tr_b16 a[196:197], v9 offset:32768
    ds_read_b64_tr_b16 a[198:199], v9 offset:33792
    ds_read_b64_tr_b16 a[200:201], v8 offset:40960
    ds_read_b64_tr_b16 a[202:203], v8 offset:41984
    ds_read_b64_tr_b16 a[204:205], v9 offset:40960
    ds_read_b64_tr_b16 a[206:207], v9 offset:41984
    s_waitcnt lgkmcnt(0)
    ds_read_b64_tr_b16 a[208:209], v8 offset:49152
    ds_read_b64_tr_b16 a[210:211], v8 offset:50176
    ds_read_b64_tr_b16 a[212:213], v9 offset:49152
    ds_read_b64_tr_b16 a[214:215], v9 offset:50176
    ds_read_b64_tr_b16 a[216:217], v8 offset:57344
    ds_read_b64_tr_b16 a[218:219], v8 offset:58368
    ds_read_b64_tr_b16 a[220:221], v9 offset:57344
    ds_read_b64_tr_b16 a[222:223], v9 offset:58368
    s_waitcnt lgkmcnt(0)
    s_waitcnt vmcnt(24)
    s_barrier
    s_cmp_lg_u32 s2, 0
    s_cbranch_scc1 L_rok_40
    v_mov_b32 v24, 32768
    s_cmp_lg_u32 s58, 0
    s_cbranch_scc1 L_rw_41
    v_mov_b32 v25, s94
    ds_write_b32 v24, v25
    s_waitcnt lgkmcnt(0)
L_rw_41:
    s_barrier
    ds_read_b32 v25, v24
    s_waitcnt lgkmcnt(0)
    v_readfirstlane_b32 s60, v25
    s_mov_b32 s2, 1
    s_cmp_eq_u32 s60, -1
    s_cbranch_scc1 L_rok_40
    s_mov_b32 s57, s60
    s_waitcnt vmcnt(0)
    s_barrier
    s_cmp_ge_u32 s57, 32
    s_cbranch_scc1 chain_kernel_end
    s_branch kvs_start
L_rok_40:
    v_add_u32 v8, 0x10000, v8
    v_add_u32 v9, 0x10000, v9
    ds_read_b64_tr_b16 a[224:225], v8 offset:0
    ds_read_b64_tr_b16 a[226:227], v8 offset:1024
    ds_read_b64_tr_b16 a[228:229], v9 offset:0
    ds_read_b64_tr_b16 a[230:231], v9 offset:1024
    ds_read_b64_tr_b16 a[232:233], v8 offset:8192
    ds_read_b64_tr_b16 a[234:235], v8 offset:9216
    ds_read_b64_tr_b16 a[236:237], v9 offset:8192
    ds_read_b64_tr_b16 a[238:239], v9 offset:9216
    s_waitcnt lgkmcnt(0)
    ds_read_b64_tr_b16 a[240:241], v8 offset:16384
    ds_read_b64_tr_b16 a[242:243], v8 offset:17408
    ds_read_b64_tr_b16 a[244:245], v9 offset:16384
    ds_read_b64_tr_b16 a[246:247], v9 offset:17408
    ds_read_b64_tr_b16 a[248:249], v8 offset:24576
    ds_read_b64_tr_b16 a[250:251], v8 offset:25600
    ds_read_b64_tr_b16 a[252:253], v9 offset:24576
    ds_read_b64_tr_b16 a[254:255], v9 offset:25600
    s_waitcnt lgkmcnt(0)
    s_waitcnt vmcnt(16)
    s_barrier
    s_mov_b32 s62, 0
L_pp_42:
    v_readfirstlane_b32 s59, v11
    s_and_b32 s60, s59, 0xff
    s_cmp_ge_u32 s60, 15
    s_cbranch_scc1 L_pok_43
    v_mov_b32 v24, 4
    global_load_dword v11, v24, s[98:99] sc1
    s_add_u32 s62, s62, 1
    s_cmp_gt_u32 s62, 0x200000
    s_cbranch_scc1 chain_kernel_wabort
    s_waitcnt vmcnt(0)
    s_branch L_pp_42
L_pok_43:
    s_cmp_ge_u32 s59, 0x800
    s_cselect_b32 s59, 0x2000, 0
    s_xor_b32 s31, s31, s59
    s_xor_b32 s30, s30, s59
    s_xor_b32 s63, s57, 2
    s_mov_b32 s12, s92
    s_and_b32 s13, s93, 0xffff
    s_mov_b32 s14, 0x800000
    s_mov_b32 s15, 0x00020000
    s_lshr_b32 s60, s63, 3
    s_lshl_b32 s28, s60, 21
    s_and_b32 s60, s63, 7
    s_lshl_b32 s60, s60, 8
    s_add_u32 s28, s28, s60
    v_bfe_u32 v24, v0, 4, 3
    v_lshlrev_b32 v24, 1, v24
    v_and_b32 v25, 15, v0
    v_xor_b32 v24, v24, v25
    v_lshlrev_b32 v6, 4, v24
    v_bfe_u32 v24, v0, 4, 2
    v_lshl_add_u32 v6, v24, 11, v6
    v_bfe_u32 v24, v0, 6, 1
    v_lshl_add_u32 v6, v24, 13, v6
    v_bfe_u32 v24, v0, 7, 1
    v_lshl_add_u32 v6, v24, 15, v6
    s_and_b32 s60, s58, 1
    s_lshl_b32 s61, s60, 11
    s_lshr_b32 s60, s58, 1
    s_lshl_b32 s60, s60, 10
    s_add_u32 s32, s60, s61
    s_mov_b32 s24, 0
    s_mov_b32 s18, 0
    s_cmp_eq_u32 s56, 3
    s_cbranch_scc1 L_kvv_44
    ds_read_b128 v[72:75], v4 offset:0
    ds_read_b128 v[76:79], v4 offset:2048
    ds_read_b128 v[80:83], v5 offset:0
    ds_read_b128 v[84:87], v5 offset:2048
    ds_read_b128 v[88:91], v4 offset:4096
    ds_read_b128 v[92:95], v4 offset:6144
    s_mov_b32 s34, 0x2042258
    s_mov_b32 s35, 0x4ffff004
    s_cmp_eq_u32 s58, 0
    s_cselect_b32 s33, s27, 0x400000
    s_mov_b32 s25, 0
    s_mov_b32 s26, 0
kvsk:
    s_waitcnt lgkmcnt(4)
    v_mfma_f32_16x16x32_bf16 v[32:35], a[0:3], v[72:75], 0
    ds_read_b128 v[96:99], v5 offset:4096
    v_mfma_f32_16x16x32_bf16 v[36:39], a[4:7], v[72:75], 0
    ds_read_b128 v[100:103], v5 offset:6144
    v_mfma_f32_16x16x32_bf16 v[44:47], a[4:7], v[76:79], 0
    v_mfma_f32_16x16x32_bf16 v[40:43], a[0:3], v[76:79], 0
    v_cvt_pk_bf16_f32 v64, v48, v49
    s_waitcnt lgkmcnt(4)
    v_mfma_f32_16x16x32_bf16 v[32:35], a[8:11], v[80:83], v[32:35]
    ds_read_b128 v[72:75], v4 offset:8192
    v_cvt_pk_bf16_f32 v65, v50, v51
    v_mfma_f32_16x16x32_bf16 v[36:39], a[12:15], v[80:83], v[36:39]
    ds_read_b128 v[76:79], v4 offset:10240
    v_cvt_pk_bf16_f32 v66, v52, v53
    v_mfma_f32_16x16x32_bf16 v[44:47], a[12:15], v[84:87], v[44:47]
    v_cvt_pk_bf16_f32 v67, v54, v55
    v_cvt_pk_bf16_f32 v68, v56, v57
    v_mfma_f32_16x16x32_bf16 v[40:43], a[8:11], v[84:87], v[40:43]
    v_cvt_pk_bf16_f32 v69, v58, v59
    s_waitcnt lgkmcnt(4)
    v_mfma_f32_16x16x32_bf16 v[32:35], a[16:19], v[88:91], v[32:35]
    ds_read_b128 v[80:83], v5 offset:8192
    v_cvt_pk_bf16_f32 v70, v60, v61
    v_mfma_f32_16x16x32_bf16 v[36:39], a[20:23], v[88:91], v[36:39]
    ds_read_b128 v[84:87], v5 offset:10240
    v_cvt_pk_bf16_f32 v71, v62, v63
    v_mfma_f32_16x16x32_bf16 v[44:47], a[20:23], v[92:95], v[44:47]
    buffer_store_dwordx4 v[64:67], v1, s[16:19], s25 offen sc1
    v_mfma_f32_16x16x32_bf16 v[40:43], a[16:19], v[92:95], v[40:43]
    buffer_store_dwordx4 v[68:71], v12, s[16:19], s25 offen sc1
    s_waitcnt lgkmcnt(4)
    v_mfma_f32_16x16x32_bf16 v[32:35], a[24:27], v[96:99], v[32:35]
    ds_read_b128 v[88:91], v4 offset:12288
    buffer_store_dwordx4 v[28:31], v1, s[16:19], s26 offen sc1
    v_mfma_f32_16x16x32_bf16 v[36:39], a[28:31], v[96:99], v[36:39]
    ds_read_b128 v[92:95], v4 offset:14336
    v_mfma_f32_16x16x32_bf16 v[44:47], a[28:31], v[100:103], v[44:47]
    v_mfma_f32_16x16x32_bf16 v[40:43], a[24:27], v[100:103], v[40:43]
    buffer_load_dword v13, v10, s[8:11], s33 offen
    s_waitcnt lgkmcnt(4)
    v_mfma_f32_16x16x32_bf16 v[32:35], a[32:35], v[72:75], v[32:35]
    ds_read_b128 v[96:99], v5 offset:12288
    v_mfma_f32_16x16x32_bf16 v[36:39], a[36:39], v[72:75], v[36:39]
    ds_read_b128 v[100:103], v5 offset:14336
    v_mfma_f32_16x16x32_bf16 v[44:47], a[36:39], v[76:79], v[44:47]
    s_mov_b32 s18, 0xc000000
    s_lshl_b32 s25, s24, 21
    v_mfma_f32_16x16x32_bf16 v[40:43], a[32:35], v[76:79], v[40:43]
    s_lshl_b32 s62, s24, 13
    s_waitcnt lgkmcnt(4)
    v_mfma_f32_16x16x32_bf16 v[32:35], a[40:43], v[80:83], v[32:35]
    ds_read_b128 v[72:75], v4 offset:16384
    s_and_b32 s62, s62, 0x2000
    v_mfma_f32_16x16x32_bf16 v[36:39], a[44:47], v[80:83], v[36:39]
    ds_read_b128 v[76:79], v4 offset:18432
    s_xor_b32 s62, s62, s30
    v_mfma_f32_16x16x32_bf16 v[44:47], a[44:47], v[84:87], v[44:47]
    s_add_u32 s25, s25, s62
    s_lshl_b32 s26, s24, 18
    v_mfma_f32_16x16x32_bf16 v[40:43], a[40:43], v[84:87], v[40:43]
    s_lshl_b32 s62, s24, 10
    s_waitcnt lgkmcnt(4)
    v_mfma_f32_16x16x32_bf16 v[32:35], a[48:51], v[88:91], v[32:35]
    ds_read_b128 v[80:83], v5 offset:16384
    s_and_b32 s62, s62, 0x2000
    v_mfma_f32_16x16x32_bf16 v[36:39], a[52:55], v[88:91], v[36:39]
    ds_read_b128 v[84:87], v5 offset:18432
    s_xor_b32 s62, s62, s31
    v_mfma_f32_16x16x32_bf16 v[44:47], a[52:55], v[92:95], v[44:47]
    s_add_u32 s26, s26, s62
    s_cmp_ge_u32 s21, 131072
    v_mfma_f32_16x16x32_bf16 v[40:43], a[48:51], v[92:95], v[40:43]
    s_cselect_b32 s22, 0xfffe0000, s29
    s_waitcnt lgkmcnt(4)
    v_mfma_f32_16x16x32_bf16 v[32:35], a[56:59], v[96:99], v[32:35]
    ds_read_b128 v[88:91], v4 offset:20480
    s_add_u32 s21, s21, s22
    v_mfma_f32_16x16x32_bf16 v[36:39], a[60:63], v[96:99], v[36:39]
    ds_read_b128 v[92:95], v4 offset:22528
    s_add_u32 s27, s27, 0x10000
    v_mfma_f32_16x16x32_bf16 v[44:47], a[60:63], v[100:103], v[44:47]
    s_andn2_b32 s61, 3, s24
    s_or_b32 s61, s61, s58
    v_mfma_f32_16x16x32_bf16 v[40:43], a[56:59], v[100:103], v[40:43]
    s_cselect_b32 s33, 0x400000, s27
    s_waitcnt lgkmcnt(4)
    v_mfma_f32_16x16x32_bf16 v[32:35], a[64:67], v[72:75], v[32:35]
    ds_read_b128 v[96:99], v5 offset:20480
    s_cmp_lt_u32 s24, 4
    v_mfma_f32_16x16x32_bf16 v[36:39], a[68:71], v[72:75], v[36:39]
    ds_read_b128 v[100:103], v5 offset:22528
    s_cselect_b64 vcc, -1, 0
    v_mfma_f32_16x16x32_bf16 v[44:47], a[68:71], v[76:79], v[44:47]
    v_mfma_f32_16x16x32_bf16 v[40:43], a[64:67], v[76:79], v[40:43]
    s_waitcnt lgkmcnt(4)
    v_mfma_f32_16x16x32_bf16 v[32:35], a[72:75], v[80:83], v[32:35]
    ds_read_b128 v[72:75], v4 offset:24576
    v_mfma_f32_16x16x32_bf16 v[36:39], a[76:79], v[80:83], v[36:39]
    ds_read_b128 v[76:79], v4 offset:26624
    v_mfma_f32_16x16x32_bf16 v[44:47], a[76:79], v[84:87], v[44:47]
    v_mfma_f32_16x16x32_bf16 v[40:43], a[72:75], v[84:87], v[40:43]
    s_waitcnt lgkmcnt(4)
    v_mfma_f32_16x16x32_bf16 v[32:35], a[80:83], v[88:91], v[32:35]
    ds_read_b128 v[80:83], v5 offset:24576
    s_add_u32 m0, s20, 0
    v_mfma_f32_16x16x32_bf16 v[36:39], a[84:87], v[88:91], v[36:39]
    ds_read_b128 v[84:87], v5 offset:26624
    buffer_load_dwordx4 v2, s[8:11], s23 offen offset:0 lds
    v_mfma_f32_16x16x32_bf16 v[44:47], a[84:87], v[92:95], v[44:47]
    v_mfma_f32_16x16x32_bf16 v[40:43], a[80:83], v[92:95], v[40:43]
    s_waitcnt lgkmcnt(4)
    v_mfma_f32_16x16x32_bf16 v[32:35], a[88:91], v[96:99], v[32:35]
    ds_read_b128 v[88:91], v4 offset:28672
    v_mfma_f32_16x16x32_bf16 v[36:39], a[92:95], v[96:99], v[36:39]
    ds_read_b128 v[92:95], v4 offset:30720
    s_add_u32 m0, s20, 3968
    v_mfma_f32_16x16x32_bf16 v[44:47], a[92:95], v[100:103], v[44:47]
    buffer_load_dwordx4 v2, s[8:11], s23 offen offset:128 lds
    v_mfma_f32_16x16x32_bf16 v[40:43], a[88:91], v[100:103], v[40:43]
    v_add_u32 v4, s22, v4
    s_waitcnt lgkmcnt(4)
    v_mfma_f32_16x16x32_bf16 v[32:35], a[96:99], v[72:75], v[32:35]
    ds_read_b128 v[96:99], v5 offset:28672
    v_mfma_f32_16x16x32_bf16 v[36:39], a[100:103], v[72:75], v[36:39]
    ds_read_b128 v[100:103], v5 offset:30720
    v_mfma_f32_16x16x32_bf16 v[44:47], a[100:103], v[76:79], v[44:47]
    v_add_u32 v5, s22, v5
    s_add_u32 m0, s20, 7936
    v_mfma_f32_16x16x32_bf16 v[40:43], a[96:99], v[76:79], v[40:43]
    buffer_load_dwordx4 v2, s[8:11], s23 offen offset:256 lds
    s_waitcnt vmcnt(15)
    s_cbranch_vccnz kvsk_early
    s_barrier
kvsk_mid:
    s_waitcnt lgkmcnt(4)
    v_mfma_f32_16x16x32_bf16 v[32:35], a[104:107], v[80:83], v[32:35]
    ds_read_b128 v[72:75], v4 offset:0
    v_mfma_f32_16x16x32_bf16 v[36:39], a[108:111], v[80:83], v[36:39]
    ds_read_b128 v[76:79], v4 offset:2048
    v_mfma_f32_16x16x32_bf16 v[44:47], a[108:111], v[84:87], v[44:47]
    v_mfma_f32_16x16x32_bf16 v[40:43], a[104:107], v[84:87], v[40:43]
    s_add_u32 m0, s20, 11904
    s_waitcnt lgkmcnt(4)
    v_mfma_f32_16x16x32_bf16 v[32:35], a[112:115], v[88:91], v[32:35]
    ds_read_b128 v[80:83], v5 offset:0
    buffer_load_dwordx4 v2, s[8:11], s23 offen offset:384 lds
    v_mfma_f32_16x16x32_bf16 v[36:39], a[116:119], v[88:91], v[36:39]
    ds_read_b128 v[84:87], v5 offset:2048
    v_mfma_f32_16x16x32_bf16 v[44:47], a[116:119], v[92:95], v[44:47]
    v_mfma_f32_16x16x32_bf16 v[40:43], a[112:115], v[92:95], v[40:43]
    s_waitcnt lgkmcnt(4)
    v_mfma_f32_16x16x32_bf16 v[32:35], a[120:123], v[96:99], v[32:35]
    ds_read_b128 v[88:91], v4 offset:4096
    s_add_u32 m0, s20, 15872
    v_mfma_f32_16x16x32_bf16 v[36:39], a[124:127], v[96:99], v[36:39]
    ds_read_b128 v[92:95], v4 offset:6144
    buffer_load_dwordx4 v2, s[8:11], s23 offen offset:512 lds
    v_mfma_f32_16x16x32_bf16 v[44:47], a[124:127], v[100:103], v[44:47]
    s_cmp_ge_u32 s21, 131072
    s_cselect_b32 s22, 0xfffe0000, s29
    v_mfma_f32_16x16x32_bf16 v[40:43], a[120:123], v[100:103], v[40:43]
    s_add_u32 s21, s21, s22
    s_waitcnt lgkmcnt(4)
    v_mfma_f32_16x16x32_bf16 v[32:35], a[128:131], v[72:75], v[32:35]
    ds_read_b128 v[96:99], v5 offset:4096
    v_mfma_f32_16x16x32_bf16 v[36:39], a[132:135], v[72:75], v[36:39]
    ds_read_b128 v[100:103], v5 offset:6144
    s_add_u32 m0, s20, 19840
    v_mfma_f32_16x16x32_bf16 v[44:47], a[132:135], v[76:79], v[44:47]
    buffer_load_dwordx4 v2, s[8:11], s23 offen offset:640 lds
    v_mfma_f32_16x16x32_bf16 v[40:43], a[128:131], v[76:79], v[40:43]
    s_waitcnt lgkmcnt(4)
    v_mfma_f32_16x16x32_bf16 v[32:35], a[136:139], v[80:83], v[32:35]
    ds_read_b128 v[72:75], v4 offset:8192
    v_mfma_f32_16x16x32_bf16 v[36:39], a[140:143], v[80:83], v[36:39]
    ds_read_b128 v[76:79], v4 offset:10240
    v_mfma_f32_16x16x32_bf16 v[44:47], a[140:143], v[84:87], v[44:47]
    s_add_u32 m0, s20, 23808
    v_mfma_f32_16x16x32_bf16 v[40:43], a[136:139], v[84:87], v[40:43]
    buffer_load_dwordx4 v2, s[8:11], s23 offen offset:768 lds
    s_waitcnt lgkmcnt(4)
    v_mfma_f32_16x16x32_bf16 v[32:35], a[144:147], v[88:91], v[32:35]
    ds_read_b128 v[80:83], v5 offset:8192
    v_mfma_f32_16x16x32_bf16 v[36:39], a[148:151], v[88:91], v[36:39]
    ds_read_b128 v[84:87], v5 offset:10240
    v_mfma_f32_16x16x32_bf16 v[44:47], a[148:151], v[92:95], v[44:47]
    v_mfma_f32_16x16x32_bf16 v[40:43], a[144:147], v[92:95], v[40:43]
    s_add_u32 m0, s20, 27776
    s_waitcnt lgkmcnt(4)
    v_mfma_f32_16x16x32_bf16 v[32:35], a[152:155], v[96:99], v[32:35]
    ds_read_b128 v[88:91], v4 offset:12288
    buffer_load_dwordx4 v2, s[8:11], s23 offen offset:896 lds
    v_mfma_f32_16x16x32_bf16 v[36:39], a[156:159], v[96:99], v[36:39]
    ds_read_b128 v[92:95], v4 offset:14336
    s_add_u32 s23, s23, 1024
    v_mfma_f32_16x16x32_bf16 v[44:47], a[156:159], v[100:103], v[44:47]
    s_bitcmp1_b32 s23, 11
    s_cselect_b32 s60, 0xf800, 0
    v_mfma_f32_16x16x32_bf16 v[40:43], a[152:155], v[100:103], v[40:43]
    s_add_u32 s23, s23, s60
    s_waitcnt lgkmcnt(4)
    v_mfma_f32_16x16x32_bf16 v[32:35], a[160:163], v[72:75], v[32:35]
    ds_read_b128 v[96:99], v5 offset:12288
    s_add_u32 s20, s20, 32768
    v_mfma_f32_16x16x32_bf16 v[36:39], a[164:167], v[72:75], v[36:39]
    ds_read_b128 v[100:103], v5 offset:14336
    s_cmp_ge_u32 s20, 163840
    v_mfma_f32_16x16x32_bf16 v[44:47], a[164:167], v[76:79], v[44:47]
    s_cselect_b32 s60, 163840, 0
    s_sub_u32 s20, s20, s60
    v_mfma_f32_16x16x32_bf16 v[40:43], a[160:163], v[76:79], v[40:43]
    s_add_u32 m0, s20, 0
    s_waitcnt lgkmcnt(4)
    v_mfma_f32_16x16x32_bf16 v[32:35], a[168:171], v[80:83], v[32:35]
    ds_read_b128 v[72:75], v4 offset:16384
    buffer_load_dwordx4 v2, s[8:11], s23 offen offset:0 lds
    v_mfma_f32_16x16x32_bf16 v[36:39], a[172:175], v[80:83], v[36:39]
    ds_read_b128 v[76:79], v4 offset:18432
    s_add_u32 m0, s20, 3968
    v_mfma_f32_16x16x32_bf16 v[44:47], a[172:175], v[84:87], v[44:47]
    buffer_load_dwordx4 v2, s[8:11], s23 offen offset:128 lds
    v_mfma_f32_16x16x32_bf16 v[40:43], a[168:171], v[84:87], v[40:43]
    s_waitcnt lgkmcnt(4)
    v_mfma_f32_16x16x32_bf16 v[32:35], a[176:179], v[88:91], v[32:35]
    ds_read_b128 v[80:83], v5 offset:16384
    v_mfma_f32_16x16x32_bf16 v[36:39], a[180:183], v[88:91], v[36:39]
    ds_read_b128 v[84:87], v5 offset:18432
    v_mfma_f32_16x16x32_bf16 v[44:47], a[180:183], v[92:95], v[44:47]
    s_add_u32 m0, s20, 7936
    v_mfma_f32_16x16x32_bf16 v[40:43], a[176:179], v[92:95], v[40:43]
    buffer_load_dwordx4 v2, s[8:11], s23 offen offset:256 lds
    s_waitcnt lgkmcnt(4)
    v_mfma_f32_16x16x32_bf16 v[32:35], a[184:187], v[96:99], v[32:35]
    ds_read_b128 v[88:91], v4 offset:20480
    v_mfma_f32_16x16x32_bf16 v[36:39], a[188:191], v[96:99], v[36:39]
    ds_read_b128 v[92:95], v4 offset:22528
    v_mfma_f32_16x16x32_bf16 v[44:47], a[188:191], v[100:103], v[44:47]
    v_mfma_f32_16x16x32_bf16 v[40:43], a[184:187], v[100:103], v[40:43]
    s_add_u32 m0, s20, 11904
    s_waitcnt lgkmcnt(4)
    v_mfma_f32_16x16x32_bf16 v[32:35], a[192:195], v[72:75], v[32:35]
    ds_read_b128 v[96:99], v5 offset:20480
    buffer_load_dwordx4 v2, s[8:11], s23 offen offset:384 lds
    v_mfma_f32_16x16x32_bf16 v[36:39], a[196:199], v[72:75], v[36:39]
    ds_read_b128 v[100:103], v5 offset:22528
    v_mfma_f32_16x16x32_bf16 v[44:47], a[196:199], v[76:79], v[44:47]
    v_mfma_f32_16x16x32_bf16 v[40:43], a[192:195], v[76:79], v[40:43]
    s_waitcnt lgkmcnt(4)
    v_mfma_f32_16x16x32_bf16 v[32:35], a[200:203], v[80:83], v[32:35]
    ds_read_b128 v[72:75], v4 offset:24576
    s_add_u32 m0, s20, 15872
    v_mfma_f32_16x16x32_bf16 v[36:39], a[204:207], v[80:83], v[36:39]
    ds_read_b128 v[76:79], v4 offset:26624
    buffer_load_dwordx4 v2, s[8:11], s23 offen offset:512 lds
    v_mfma_f32_16x16x32_bf16 v[44:47], a[204:207], v[84:87], v[44:47]
    v_mfma_f32_16x16x32_bf16 v[40:43], a[200:203], v[84:87], v[40:43]
    s_waitcnt lgkmcnt(4)
    v_mfma_f32_16x16x32_bf16 v[32:35], a[208:211], v[88:91], v[32:35]
    ds_read_b128 v[80:83], v5 offset:24576
    v_mfma_f32_16x16x32_bf16 v[36:39], a[212:215], v[88:91], v[36:39]
    ds_read_b128 v[84:87], v5 offset:26624
    s_add_u32 m0, s20, 19840
    v_mfma_f32_16x16x32_bf16 v[44:47], a[212:215], v[92:95], v[44:47]
    buffer_load_dwordx4 v2, s[8:11], s23 offen offset:640 lds
    v_mfma_f32_16x16x32_bf16 v[40:43], a[208:211], v[92:95], v[40:43]
    s_waitcnt lgkmcnt(4)
    v_mfma_f32_16x16x32_bf16 v[32:35], a[216:219], v[96:99], v[32:35]
    ds_read_b128 v[88:91], v4 offset:28672
    v_mfma_f32_16x16x32_bf16 v[36:39], a[220:223], v[96:99], v[36:39]
    ds_read_b128 v[92:95], v4 offset:30720
    v_mfma_f32_16x16x32_bf16 v[44:47], a[220:223], v[100:103], v[44:47]
    v_add_u32 v4, s22, v4
    s_add_u32 m0, s20, 23808
    v_mfma_f32_16x16x32_bf16 v[40:43], a[216:219], v[100:103], v[40:43]
    buffer_load_dwordx4 v2, s[8:11], s23 offen offset:768 lds
    s_waitcnt lgkmcnt(4)
    v_mfma_f32_16x16x32_bf16 v[32:35], a[224:227], v[72:75], v[32:35]
    ds_read_b128 v[96:99], v5 offset:28672
    v_mfma_f32_16x16x32_bf16 v[36:39], a[228:231], v[72:75], v[36:39]
    ds_read_b128 v[100:103], v5 offset:30720
    v_mfma_f32_16x16x32_bf16 v[44:47], a[228:231], v[76:79], v[44:47]
    v_add_u32 v5, s22, v5
    v_mfma_f32_16x16x32_bf16 v[40:43], a[224:227], v[76:79], v[40:43]
    s_add_u32 m0, s20, 27776
    s_waitcnt vmcnt(16)
    s_barrier
    s_waitcnt lgkmcnt(4)
    v_mfma_f32_16x16x32_bf16 v[32:35], a[232:235], v[80:83], v[32:35]
    ds_read_b128 v[72:75], v4 offset:0
    buffer_load_dwordx4 v2, s[8:11], s23 offen offset:896 lds
    v_mfma_f32_16x16x32_bf16 v[36:39], a[236:239], v[80:83], v[36:39]
    ds_read_b128 v[76:79], v4 offset:2048
    s_add_u32 s23, s23, 1024
    v_mfma_f32_16x16x32_bf16 v[44:47], a[236:239], v[84:87], v[44:47]
    s_bitcmp1_b32 s23, 11
    s_cselect_b32 s60, 0xf800, 0
    v_mfma_f32_16x16x32_bf16 v[40:43], a[232:235], v[84:87], v[40:43]
    s_add_u32 s23, s23, s60
    s_waitcnt lgkmcnt(4)
    v_mfma_f32_16x16x32_bf16 v[32:35], a[240:243], v[88:91], v[32:35]
    ds_read_b128 v[80:83], v5 offset:0
    s_add_u32 s20, s20, 32768
    s_cmp_ge_u32 s20, 163840
    v_mfma_f32_16x16x32_bf16 v[36:39], a[244:247], v[88:91], v[36:39]
    ds_read_b128 v[84:87], v5 offset:2048
    s_cselect_b32 s60, 163840, 0
    s_sub_u32 s20, s20, s60
    v_mfma_f32_16x16x32_bf16 v[44:47], a[244:247], v[92:95], v[44:47]
    v_mfma_f32_16x16x32_bf16 v[40:43], a[240:243], v[92:95], v[40:43]
    s_waitcnt lgkmcnt(4)
    v_mfma_f32_16x16x32_bf16 v[48:51], a[248:251], v[96:99], v[32:35]
    ds_read_b128 v[88:91], v4 offset:4096
    s_add_u32 s24, s24, 1
    s_sub_u32 s61, s24, 2
    v_mfma_f32_16x16x32_bf16 v[52:55], a[252:255], v[96:99], v[36:39]
    ds_read_b128 v[92:95], v4 offset:6144
    s_bitcmp1_b64 s[34:35], s61
    v_mfma_f32_16x16x32_bf16 v[60:63], a[252:255], v[100:103], v[44:47]
    v_mfma_f32_16x16x32_bf16 v[56:59], a[248:251], v[100:103], v[40:43]
    s_cbranch_scc0 kvsk
    s_cmp_eq_u32 s24, 64
    s_cbranch_scc1 kvsk_fin
    s_sub_u32 s62, s24, 46
    s_cmp_ge_u32 s62, 16
    s_cbranch_scc1 kvsk_sig
    s_cmp_ge_u32 s24, 54
    s_cbranch_scc1 L_wp_46
    s_cmp_ge_u32 s24, 50
    s_cbranch_scc1 L_wp_47
    s_cmp_ge_u32 s24, 48
    s_cbranch_scc1 L_wp_48
    s_cmp_ge_u32 s24, 47
    s_cbranch_scc1 L_wp_49
    s_add_u32 s62, s28, 0x0
    buffer_load_dwordx4 v[128:131], v6, s[12:15], s62 offen nt
    s_add_u32 s62, s28, 0x4000
    buffer_load_dwordx4 v[132:135], v6, s[12:15], s62 offen nt
    s_branch kvsk_sig
L_wp_49:
    s_add_u32 s62, s28, 0x10000
    buffer_load_dwordx4 v[136:139], v6, s[12:15], s62 offen nt
    s_add_u32 s62, s28, 0x14000
    buffer_load_dwordx4 v[140:143], v6, s[12:15], s62 offen nt
    s_branch kvsk_sig
L_wp_48:
    s_cmp_ge_u32 s24, 49
    s_cbranch_scc1 L_wp_50
    s_add_u32 s62, s28, 0x20000
    buffer_load_dwordx4 v[144:147], v6, s[12:15], s62 offen nt
    s_add_u32 s62, s28, 0x24000
    buffer_load_dwordx4 v[148:151], v6, s[12:15], s62 offen nt
    s_branch kvsk_sig
L_wp_50:
    s_add_u32 s62, s28, 0x30000
    buffer_load_dwordx4 v[152:155], v6, s[12:15], s62 offen nt
    s_add_u32 s62, s28, 0x34000
    buffer_load_dwordx4 v[156:159], v6, s[12:15], s62 offen nt
    s_branch kvsk_sig
L_wp_47:
    s_cmp_ge_u32 s24, 52
    s_cbranch_scc1 L_wp_51
    s_cmp_ge_u32 s24, 51
    s_cbranch_scc1 L_wp_52
    s_add_u32 s62, s28, 0x40000
    buffer_load_dwordx4 v[160:163], v6, s[12:15], s62 offen nt
    s_add_u32 s62, s28, 0x44000
    buffer_load_dwordx4 v[164:167], v6, s[12:15], s62 offen nt
    s_branch kvsk_sig
L_wp_52:
    s_add_u32 s62, s28, 0x50000
    buffer_load_dwordx4 v[168:171], v6, s[12:15], s62 offen nt
    s_add_u32 s62, s28, 0x54000
    buffer_load_dwordx4 v[172:175], v6, s[12:15], s62 offen nt
    s_branch kvsk_sig
L_wp_51:
    s_cmp_ge_u32 s24, 53
    s_cbranch_scc1 L_wp_53
    s_add_u32 s62, s28, 0x60000
    buffer_load_dwordx4 v[176:179], v6, s[12:15], s62 offen nt
    s_add_u32 s62, s28, 0x64000
    buffer_load_dwordx4 v[180:183], v6, s[12:15], s62 offen nt
    s_branch kvsk_sig
L_wp_53:
    s_add_u32 s62, s28, 0x70000
    buffer_load_dwordx4 v[184:187], v6, s[12:15], s62 offen nt
    s_add_u32 s62, s28, 0x74000
    buffer_load_dwordx4 v[188:191], v6, s[12:15], s62 offen nt
    s_branch kvsk_sig
L_wp_46:
    s_cmp_ge_u32 s24, 58
    s_cbranch_scc1 L_wp_54
    s_cmp_ge_u32 s24, 56
    s_cbranch_scc1 L_wp_55
    s_cmp_ge_u32 s24, 55
    s_cbranch_scc1 L_wp_56
    s_add_u32 s62, s28, 0x80000
    buffer_load_dwordx4 v[192:195], v6, s[12:15], s62 offen nt
    s_add_u32 s62, s28, 0x84000
    buffer_load_dwordx4 v[196:199], v6, s[12:15], s62 offen nt
    s_branch kvsk_sig
L_wp_56:
    s_add_u32 s62, s28, 0x90000
    buffer_load_dwordx4 v[200:203], v6, s[12:15], s62 offen nt
    s_add_u32 s62, s28, 0x94000
    buffer_load_dwordx4 v[204:207], v6, s[12:15], s62 offen nt
    s_branch kvsk_sig
L_wp_55:
    s_cmp_ge_u32 s24, 57
    s_cbranch_scc1 L_wp_57
    s_add_u32 s62, s28, 0xa0000
    buffer_load_dwordx4 v[208:211], v6, s[12:15], s62 offen nt
    s_add_u32 s62, s28, 0xa4000
    buffer_load_dwordx4 v[212:215], v6, s[12:15], s62 offen nt
    s_branch kvsk_sig
L_wp_57:
    s_add_u32 s62, s28, 0xb0000
    buffer_load_dwordx4 v[216:219], v6, s[12:15], s62 offen nt
    s_add_u32 s62, s28, 0xb4000
    buffer_load_dwordx4 v[220:223], v6, s[12:15], s62 offen nt
    s_branch kvsk_sig
L_wp_54:
    s_cmp_ge_u32 s24, 60
    s_cbranch_scc1 L_wp_58
    s_cmp_ge_u32 s24, 59
    s_cbranch_scc1 L_wp_59
    s_add_u32 s62, s28, 0xc0000
    buffer_load_dwordx4 v[224:227], v6, s[12:15], s62 offen nt
    s_add_u32 s62, s28, 0xc4000
    buffer_load_dwordx4 v[228:231], v6, s[12:15], s62 offen nt
    s_branch kvsk_sig
L_wp_59:
    s_add_u32 s62, s28, 0xd0000
    buffer_load_dwordx4 v[232:235], v6, s[12:15], s62 offen nt
    s_add_u32 s62, s28, 0xd4000
    buffer_load_dwordx4 v[236:239], v6, s[12:15], s62 offen nt
    s_branch kvsk_sig
L_wp_58:
    s_cmp_ge_u32 s24, 61
    s_cbranch_scc1 L_wp_60
    s_add_u32 s62, s28, 0xe0000
    buffer_load_dwordx4 v[240:243], v6, s[12:15], s62 offen nt
    s_add_u32 s62, s28, 0xe4000
    buffer_load_dwordx4 v[244:247], v6, s[12:15], s62 offen nt
    s_branch kvsk_sig
L_wp_60:
    s_add_u32 s62, s28, 0xf0000
    buffer_load_dwordx4 v[248:251], v6, s[12:15], s62 offen nt
    s_add_u32 s62, s28, 0xf4000
    buffer_load_dwordx4 v[252:255], v6, s[12:15], s62 offen nt
    s_branch kvsk_sig
kvsk_sig:
    s_cmp_lg_u32 s58, 0
    s_cbranch_scc1 kvsk
    s_mov_b32 s62, 0x2042258
    s_mov_b32 s63, 0x4004
    s_bitcmp1_b64 s[62:63], s61
    s_cbranch_scc0 kvsk
    s_bfm_b64 s[62:63], s61, 0
    s_and_b32 s62, s62, 0x204225f
    s_and_b32 s63, s63, 0x80004004
    s_bcnt1_i32_b64 s60, s[62:63]
    s_lshl_b32 s60, s60, 2
    s_add_u32 s60, s60, 64
    v_mov_b32 v24, s60
    v_mov_b32 v25, 1
    s_mov_b64 exec, 1
    global_atomic_add v24, v25, s[98:99] sc1
    s_mov_b64 exec, -1
    s_branch kvsk
kvsk_early:
    s_waitcnt vmcnt(4)
    s_barrier
    s_cmp_eq_u32 s24, 0
    s_cbranch_scc1 kvsk_mid
    s_cmp_lg_u32 s58, 0
    s_cbranch_scc1 kvsk_mid
    s_lshl_b32 s60, s24, 2
    s_add_u32 s60, s60, 60
    v_mov_b32 v24, s60
    v_mov_b32 v25, 1
    s_mov_b64 exec, 1
    global_atomic_add v24, v25, s[98:99] sc1
    s_mov_b64 exec, -1
    s_branch kvsk_mid
kvsk_fin:
    s_nop 7
    v_cvt_pk_bf16_f32 v64, v48, v49
    v_cvt_pk_bf16_f32 v65, v50, v51
    v_cvt_pk_bf16_f32 v66, v52, v53
    v_cvt_pk_bf16_f32 v67, v54, v55
    v_cvt_pk_bf16_f32 v68, v56, v57
    v_cvt_pk_bf16_f32 v69, v58, v59
    v_cvt_pk_bf16_f32 v70, v60, v61
    v_cvt_pk_bf16_f32 v71, v62, v63
    buffer_store_dwordx4 v[64:67], v1, s[16:19], s25 offen sc1
    buffer_store_dwordx4 v[68:71], v12, s[16:19], s25 offen sc1
    buffer_store_dwordx4 v[28:31], v1, s[16:19], s26 offen sc1
    s_waitcnt vmcnt(0) lgkmcnt(0)
    s_barrier
    s_cmp_lg_u32 s58, 0
    s_cbranch_scc1 L_kve_45
    s_mov_b32 s60, 112
    v_mov_b32 v24, s60
    v_mov_b32 v25, 1
    s_mov_b64 exec, 1
    global_atomic_add v24, v25, s[98:99] sc1
    s_mov_b64 exec, -1
    s_branch L_kve_45
L_kvv_44:
    ds_read_b128 v[72:75], v4 offset:0
    ds_read_b128 v[76:79], v4 offset:2048
    ds_read_b128 v[80:83], v5 offset:0
    ds_read_b128 v[84:87], v5 offset:2048
    ds_read_b128 v[88:91], v4 offset:4096
    ds_read_b128 v[92:95], v4 offset:6144
    s_mov_b32 s34, 0x2042258
    s_mov_b32 s35, 0x4ffff004
    s_cmp_eq_u32 s58, 0
    s_cselect_b32 s33, s27, 0x400000
    s_mov_b32 s25, 0
    s_mov_b32 s26, 0
kvsv:
    s_waitcnt lgkmcnt(4)
    v_mfma_f32_16x16x32_bf16 v[32:35], v[72:75], a[0:3], 0
    ds_read_b128 v[96:99], v5 offset:4096
    v_mfma_f32_16x16x32_bf16 v[40:43], v[72:75], a[4:7], 0
    ds_read_b128 v[100:103], v5 offset:6144
    v_mfma_f32_16x16x32_bf16 v[44:47], v[76:79], a[4:7], 0
    v_mfma_f32_16x16x32_bf16 v[36:39], v[76:79], a[0:3], 0
    v_cvt_pk_bf16_f32 v64, v48, v49
    s_waitcnt lgkmcnt(4)
    v_mfma_f32_16x16x32_bf16 v[32:35], v[80:83], a[8:11], v[32:35]
    ds_read_b128 v[72:75], v4 offset:8192
    v_cvt_pk_bf16_f32 v65, v50, v51
    v_mfma_f32_16x16x32_bf16 v[40:43], v[80:83], a[12:15], v[40:43]
    ds_read_b128 v[76:79], v4 offset:10240
    v_cvt_pk_bf16_f32 v66, v52, v53
    v_mfma_f32_16x16x32_bf16 v[44:47], v[84:87], a[12:15], v[44:47]
    v_cvt_pk_bf16_f32 v67, v54, v55
    v_cvt_pk_bf16_f32 v68, v56, v57
    v_mfma_f32_16x16x32_bf16 v[36:39], v[84:87], a[8:11], v[36:39]
    v_cvt_pk_bf16_f32 v69, v58, v59
    s_waitcnt lgkmcnt(4)
    v_mfma_f32_16x16x32_bf16 v[32:35], v[88:91], a[16:19], v[32:35]
    ds_read_b128 v[80:83], v5 offset:8192
    v_cvt_pk_bf16_f32 v70, v60, v61
    v_mfma_f32_16x16x32_bf16 v[40:43], v[88:91], a[20:23], v[40:43]
    ds_read_b128 v[84:87], v5 offset:10240
    v_cvt_pk_bf16_f32 v71, v62, v63
    v_mfma_f32_16x16x32_bf16 v[44:47], v[92:95], a[20:23], v[44:47]
    buffer_store_dwordx4 v[64:67], v1, s[16:19], s25 offen sc1
    v_mfma_f32_16x16x32_bf16 v[36:39], v[92:95], a[16:19], v[36:39]
    buffer_store_dwordx4 v[68:71], v1, s[16:19], s25 offen offset:1024 sc1
    s_waitcnt lgkmcnt(4)
    v_mfma_f32_16x16x32_bf16 v[32:35], v[96:99], a[24:27], v[32:35]
    ds_read_b128 v[88:91], v4 offset:12288
    buffer_store_dwordx4 v[28:31], v1, s[16:19], s26 offen sc1
    v_mfma_f32_16x16x32_bf16 v[40:43], v[96:99], a[28:31], v[40:43]
    ds_read_b128 v[92:95], v4 offset:14336
    v_mfma_f32_16x16x32_bf16 v[44:47], v[100:103], a[28:31], v[44:47]
    v_mfma_f32_16x16x32_bf16 v[36:39], v[100:103], a[24:27], v[36:39]
    buffer_load_dword v13, v10, s[8:11], s33 offen
    s_waitcnt lgkmcnt(4)
    v_mfma_f32_16x16x32_bf16 v[32:35], v[72:75], a[32:35], v[32:35]
    ds_read_b128 v[96:99], v5 offset:12288
    v_mfma_f32_16x16x32_bf16 v[40:43], v[72:75], a[36:39], v[40:43]
    ds_read_b128 v[100:103], v5 offset:14336
    v_mfma_f32_16x16x32_bf16 v[44:47], v[76:79], a[36:39], v[44:47]
    s_mov_b32 s18, 0xc000000
    s_lshl_b32 s25, s24, 21
    v_mfma_f32_16x16x32_bf16 v[36:39], v[76:79], a[32:35], v[36:39]
    s_lshl_b32 s62, s24, 13
    s_waitcnt lgkmcnt(4)
    v_mfma_f32_16x16x32_bf16 v[32:35], v[80:83], a[40:43], v[32:35]
    ds_read_b128 v[72:75], v4 offset:16384
    s_and_b32 s62, s62, 0x2000
    v_mfma_f32_16x16x32_bf16 v[40:43], v[80:83], a[44:47], v[40:43]
    ds_read_b128 v[76:79], v4 offset:18432
    s_xor_b32 s62, s62, s30
    v_mfma_f32_16x16x32_bf16 v[44:47], v[84:87], a[44:47], v[44:47]
    s_add_u32 s25, s25, s62
    s_lshl_b32 s26, s24, 18
    v_mfma_f32_16x16x32_bf16 v[36:39], v[84:87], a[40:43], v[36:39]
    s_lshl_b32 s62, s24, 10
    s_waitcnt lgkmcnt(4)
    v_mfma_f32_16x16x32_bf16 v[32:35], v[88:91], a[48:51], v[32:35]
    ds_read_b128 v[80:83], v5 offset:16384
    s_and_b32 s62, s62, 0x2000
    v_mfma_f32_16x16x32_bf16 v[40:43], v[88:91], a[52:55], v[40:43]
    ds_read_b128 v[84:87], v5 offset:18432
    s_xor_b32 s62, s62, s31
    v_mfma_f32_16x16x32_bf16 v[44:47], v[92:95], a[52:55], v[44:47]
    s_add_u32 s26, s26, s62
    s_cmp_ge_u32 s21, 131072
    v_mfma_f32_16x16x32_bf16 v[36:39], v[92:95], a[48:51], v[36:39]
    s_cselect_b32 s22, 0xfffe0000, s29
    s_waitcnt lgkmcnt(4)
    v_mfma_f32_16x16x32_bf16 v[32:35], v[96:99], a[56:59], v[32:35]
    ds_read_b128 v[88:91], v4 offset:20480
    s_add_u32 s21, s21, s22
    v_mfma_f32_16x16x32_bf16 v[40:43], v[96:99], a[60:63], v[40:43]
    ds_read_b128 v[92:95], v4 offset:22528
    s_add_u32 s27, s27, 0x10000
    v_mfma_f32_16x16x32_bf16 v[44:47], v[100:103], a[60:63], v[44:47]
    s_andn2_b32 s61, 3, s24
    s_or_b32 s61, s61, s58
    v_mfma_f32_16x16x32_bf16 v[36:39], v[100:103], a[56:59], v[36:39]
    s_cselect_b32 s33, 0x400000, s27
    s_waitcnt lgkmcnt(4)
    v_mfma_f32_16x16x32_bf16 v[32:35], v[72:75], a[64:67], v[32:35]
    ds_read_b128 v[96:99], v5 offset:20480
    s_cmp_lt_u32 s24, 4
    v_mfma_f32_16x16x32_bf16 v[40:43], v[72:75], a[68:71], v[40:43]
    ds_read_b128 v[100:103], v5 offset:22528
    s_cselect_b64 vcc, -1, 0
    v_mfma_f32_16x16x32_bf16 v[44:47], v[76:79], a[68:71], v[44:47]
    v_mfma_f32_16x16x32_bf16 v[36:39], v[76:79], a[64:67], v[36:39]
    s_waitcnt lgkmcnt(4)
    v_mfma_f32_16x16x32_bf16 v[32:35], v[80:83], a[72:75], v[32:35]
    ds_read_b128 v[72:75], v4 offset:24576
    v_mfma_f32_16x16x32_bf16 v[40:43], v[80:83], a[76:79], v[40:43]
    ds_read_b128 v[76:79], v4 offset:26624
    v_mfma_f32_16x16x32_bf16 v[44:47], v[84:87], a[76:79], v[44:47]
    v_mfma_f32_16x16x32_bf16 v[36:39], v[84:87], a[72:75], v[36:39]
    s_waitcnt lgkmcnt(4)
    v_mfma_f32_16x16x32_bf16 v[32:35], v[88:91], a[80:83], v[32:35]
    ds_read_b128 v[80:83], v5 offset:24576
    s_add_u32 m0, s20, 0
    v_mfma_f32_16x16x32_bf16 v[40:43], v[88:91], a[84:87], v[40:43]
    ds_read_b128 v[84:87], v5 offset:26624
    buffer_load_dwordx4 v2, s[8:11], s23 offen offset:0 lds
    v_mfma_f32_16x16x32_bf16 v[44:47], v[92:95], a[84:87], v[44:47]
    v_mfma_f32_16x16x32_bf16 v[36:39], v[92:95], a[80:83], v[36:39]
    s_waitcnt lgkmcnt(4)
    v_mfma_f32_16x16x32_bf16 v[32:35], v[96:99], a[88:91], v[32:35]
    ds_read_b128 v[88:91], v4 offset:28672
    v_mfma_f32_16x16x32_bf16 v[40:43], v[96:99], a[92:95], v[40:43]
    ds_read_b128 v[92:95], v4 offset:30720
    s_add_u32 m0, s20, 3968
    v_mfma_f32_16x16x32_bf16 v[44:47], v[100:103], a[92:95], v[44:47]
    buffer_load_dwordx4 v2, s[8:11], s23 offen offset:128 lds
    v_mfma_f32_16x16x32_bf16 v[36:39], v[100:103], a[88:91], v[36:39]
    v_add_u32 v4, s22, v4
    s_waitcnt lgkmcnt(4)
    v_mfma_f32_16x16x32_bf16 v[32:35], v[72:75], a[96:99], v[32:35]
    ds_read_b128 v[96:99], v5 offset:28672
    v_mfma_f32_16x16x32_bf16 v[40:43], v[72:75], a[100:103], v[40:43]
    ds_read_b128 v[100:103], v5 offset:30720
    v_mfma_f32_16x16x32_bf16 v[44:47], v[76:79], a[100:103], v[44:47]
    v_add_u32 v5, s22, v5
    s_add_u32 m0, s20, 7936
    v_mfma_f32_16x16x32_bf16 v[36:39], v[76:79], a[96:99], v[36:39]
    buffer_load_dwordx4 v2, s[8:11], s23 offen offset:256 lds
    s_waitcnt vmcnt(15)
    s_cbranch_vccnz kvsv_early
    s_barrier
kvsv_mid:
    s_waitcnt lgkmcnt(4)
    v_mfma_f32_16x16x32_bf16 v[32:35], v[80:83], a[104:107], v[32:35]
    ds_read_b128 v[72:75], v4 offset:0
    v_mfma_f32_16x16x32_bf16 v[40:43], v[80:83], a[108:111], v[40:43]
    ds_read_b128 v[76:79], v4 offset:2048
    v_mfma_f32_16x16x32_bf16 v[44:47], v[84:87], a[108:111], v[44:47]
    v_mfma_f32_16x16x32_bf16 v[36:39], v[84:87], a[104:107], v[36:39]
    s_add_u32 m0, s20, 11904
    s_waitcnt lgkmcnt(4)
    v_mfma_f32_16x16x32_bf16 v[32:35], v[88:91], a[112:115], v[32:35]
    ds_read_b128 v[80:83], v5 offset:0
    buffer_load_dwordx4 v2, s[8:11], s23 offen offset:384 lds
    v_mfma_f32_16x16x32_bf16 v[40:43], v[88:91], a[116:119], v[40:43]
    ds_read_b128 v[84:87], v5 offset:2048
    v_mfma_f32_16x16x32_bf16 v[44:47], v[92:95], a[116:119], v[44:47]
    v_mfma_f32_16x16x32_bf16 v[36:39], v[92:95], a[112:115], v[36:39]
    s_waitcnt lgkmcnt(4)
    v_mfma_f32_16x16x32_bf16 v[32:35], v[96:99], a[120:123], v[32:35]
    ds_read_b128 v[88:91], v4 offset:4096
    s_add_u32 m0, s20, 15872
    v_mfma_f32_16x16x32_bf16 v[40:43], v[96:99], a[124:127], v[40:43]
    ds_read_b128 v[92:95], v4 offset:6144
    buffer_load_dwordx4 v2, s[8:11], s23 offen offset:512 lds
    v_mfma_f32_16x16x32_bf16 v[44:47], v[100:103], a[124:127], v[44:47]
    s_cmp_ge_u32 s21, 131072
    s_cselect_b32 s22, 0xfffe0000, s29
    v_mfma_f32_16x16x32_bf16 v[36:39], v[100:103], a[120:123], v[36:39]
    s_add_u32 s21, s21, s22
    s_waitcnt lgkmcnt(4)
    v_mfma_f32_16x16x32_bf16 v[32:35], v[72:75], a[128:131], v[32:35]
    ds_read_b128 v[96:99], v5 offset:4096
    v_mfma_f32_16x16x32_bf16 v[40:43], v[72:75], a[132:135], v[40:43]
    ds_read_b128 v[100:103], v5 offset:6144
    s_add_u32 m0, s20, 19840
    v_mfma_f32_16x16x32_bf16 v[44:47], v[76:79], a[132:135], v[44:47]
    buffer_load_dwordx4 v2, s[8:11], s23 offen offset:640 lds
    v_mfma_f32_16x16x32_bf16 v[36:39], v[76:79], a[128:131], v[36:39]
    s_waitcnt lgkmcnt(4)
    v_mfma_f32_16x16x32_bf16 v[32:35], v[80:83], a[136:139], v[32:35]
    ds_read_b128 v[72:75], v4 offset:8192
    v_mfma_f32_16x16x32_bf16 v[40:43], v[80:83], a[140:143], v[40:43]
    ds_read_b128 v[76:79], v4 offset:10240
    v_mfma_f32_16x16x32_bf16 v[44:47], v[84:87], a[140:143], v[44:47]
    s_add_u32 m0, s20, 23808
    v_mfma_f32_16x16x32_bf16 v[36:39], v[84:87], a[136:139], v[36:39]
    buffer_load_dwordx4 v2, s[8:11], s23 offen offset:768 lds
    s_waitcnt lgkmcnt(4)
    v_mfma_f32_16x16x32_bf16 v[32:35], v[88:91], a[144:147], v[32:35]
    ds_read_b128 v[80:83], v5 offset:8192
    v_mfma_f32_16x16x32_bf16 v[40:43], v[88:91], a[148:151], v[40:43]
    ds_read_b128 v[84:87], v5 offset:10240
    v_mfma_f32_16x16x32_bf16 v[44:47], v[92:95], a[148:151], v[44:47]
    v_mfma_f32_16x16x32_bf16 v[36:39], v[92:95], a[144:147], v[36:39]
    s_add_u32 m0, s20, 27776
    s_waitcnt lgkmcnt(4)
    v_mfma_f32_16x16x32_bf16 v[32:35], v[96:99], a[152:155], v[32:35]
    ds_read_b128 v[88:91], v4 offset:12288
    buffer_load_dwordx4 v2, s[8:11], s23 offen offset:896 lds
    v_mfma_f32_16x16x32_bf16 v[40:43], v[96:99], a[156:159], v[40:43]
    ds_read_b128 v[92:95], v4 offset:14336
    s_add_u32 s23, s23, 1024
    v_mfma_f32_16x16x32_bf16 v[44:47], v[100:103], a[156:159], v[44:47]
    s_bitcmp1_b32 s23, 11
    s_cselect_b32 s60, 0xf800, 0
    v_mfma_f32_16x16x32_bf16 v[36:39], v[100:103], a[152:155], v[36:39]
    s_add_u32 s23, s23, s60
    s_waitcnt lgkmcnt(4)
    v_mfma_f32_16x16x32_bf16 v[32:35], v[72:75], a[160:163], v[32:35]
    ds_read_b128 v[96:99], v5 offset:12288
    s_add_u32 s20, s20, 32768
    v_mfma_f32_16x16x32_bf16 v[40:43], v[72:75], a[164:167], v[40:43]
    ds_read_b128 v[100:103], v5 offset:14336
    s_cmp_ge_u32 s20, 163840
    v_mfma_f32_16x16x32_bf16 v[44:47], v[76:79], a[164:167], v[44:47]
    s_cselect_b32 s60, 163840, 0
    s_sub_u32 s20, s20, s60
    v_mfma_f32_16x16x32_bf16 v[36:39], v[76:79], a[160:163], v[36:39]
    s_add_u32 m0, s20, 0
    s_waitcnt lgkmcnt(4)
    v_mfma_f32_16x16x32_bf16 v[32:35], v[80:83], a[168:171], v[32:35]
    ds_read_b128 v[72:75], v4 offset:16384
    buffer_load_dwordx4 v2, s[8:11], s23 offen offset:0 lds
    v_mfma_f32_16x16x32_bf16 v[40:43], v[80:83], a[172:175], v[40:43]
    ds_read_b128 v[76:79], v4 offset:18432
    s_add_u32 m0, s20, 3968
    v_mfma_f32_16x16x32_bf16 v[44:47], v[84:87], a[172:175], v[44:47]
    buffer_load_dwordx4 v2, s[8:11], s23 offen offset:128 lds
    v_mfma_f32_16x16x32_bf16 v[36:39], v[84:87], a[168:171], v[36:39]
    s_waitcnt lgkmcnt(4)
    v_mfma_f32_16x16x32_bf16 v[32:35], v[88:91], a[176:179], v[32:35]
    ds_read_b128 v[80:83], v5 offset:16384
    v_mfma_f32_16x16x32_bf16 v[40:43], v[88:91], a[180:183], v[40:43]
    ds_read_b128 v[84:87], v5 offset:18432
    v_mfma_f32_16x16x32_bf16 v[44:47], v[92:95], a[180:183], v[44:47]
    s_add_u32 m0, s20, 7936
    v_mfma_f32_16x16x32_bf16 v[36:39], v[92:95], a[176:179], v[36:39]
    buffer_load_dwordx4 v2, s[8:11], s23 offen offset:256 lds
    s_waitcnt lgkmcnt(4)
    v_mfma_f32_16x16x32_bf16 v[32:35], v[96:99], a[184:187], v[32:35]
    ds_read_b128 v[88:91], v4 offset:20480
    v_mfma_f32_16x16x32_bf16 v[40:43], v[96:99], a[188:191], v[40:43]
    ds_read_b128 v[92:95], v4 offset:22528
    v_mfma_f32_16x16x32_bf16 v[44:47], v[100:103], a[188:191], v[44:47]
    v_mfma_f32_16x16x32_bf16 v[36:39], v[100:103], a[184:187], v[36:39]
    s_add_u32 m0, s20, 11904
    s_waitcnt lgkmcnt(4)
    v_mfma_f32_16x16x32_bf16 v[32:35], v[72:75], a[192:195], v[32:35]
    ds_read_b128 v[96:99], v5 offset:20480
    buffer_load_dwordx4 v2, s[8:11], s23 offen offset:384 lds
    v_mfma_f32_16x16x32_bf16 v[40:43], v[72:75], a[196:199], v[40:43]
    ds_read_b128 v[100:103], v5 offset:22528
    v_mfma_f32_16x16x32_bf16 v[44:47], v[76:79], a[196:199], v[44:47]
    v_mfma_f32_16x16x32_bf16 v[36:39], v[76:79], a[192:195], v[36:39]
    s_waitcnt lgkmcnt(4)
    v_mfma_f32_16x16x32_bf16 v[32:35], v[80:83], a[200:203], v[32:35]
    ds_read_b128 v[72:75], v4 offset:24576
    s_add_u32 m0, s20, 15872
    v_mfma_f32_16x16x32_bf16 v[40:43], v[80:83], a[204:207], v[40:43]
    ds_read_b128 v[76:79], v4 offset:26624
    buffer_load_dwordx4 v2, s[8:11], s23 offen offset:512 lds
    v_mfma_f32_16x16x32_bf16 v[44:47], v[84:87], a[204:207], v[44:47]
    v_mfma_f32_16x16x32_bf16 v[36:39], v[84:87], a[200:203], v[36:39]
    s_waitcnt lgkmcnt(4)
    v_mfma_f32_16x16x32_bf16 v[32:35], v[88:91], a[208:211], v[32:35]
    ds_read_b128 v[80:83], v5 offset:24576
    v_mfma_f32_16x16x32_bf16 v[40:43], v[88:91], a[212:215], v[40:43]
    ds_read_b128 v[84:87], v5 offset:26624
    s_add_u32 m0, s20, 19840
    v_mfma_f32_16x16x32_bf16 v[44:47], v[92:95], a[212:215], v[44:47]
    buffer_load_dwordx4 v2, s[8:11], s23 offen offset:640 lds
    v_mfma_f32_16x16x32_bf16 v[36:39], v[92:95], a[208:211], v[36:39]
    s_waitcnt lgkmcnt(4)
    v_mfma_f32_16x16x32_bf16 v[32:35], v[96:99], a[216:219], v[32:35]
    ds_read_b128 v[88:91], v4 offset:28672
    v_mfma_f32_16x16x32_bf16 v[40:43], v[96:99], a[220:223], v[40:43]
    ds_read_b128 v[92:95], v4 offset:30720
    v_mfma_f32_16x16x32_bf16 v[44:47], v[100:103], a[220:223], v[44:47]
    v_add_u32 v4, s22, v4
    s_add_u32 m0, s20, 23808
    v_mfma_f32_16x16x32_bf16 v[36:39], v[100:103], a[216:219], v[36:39]
    buffer_load_dwordx4 v2, s[8:11], s23 offen offset:768 lds
    s_waitcnt lgkmcnt(4)
    v_mfma_f32_16x16x32_bf16 v[32:35], v[72:75], a[224:227], v[32:35]
    ds_read_b128 v[96:99], v5 offset:28672
    v_mfma_f32_16x16x32_bf16 v[40:43], v[72:75], a[228:231], v[40:43]
    ds_read_b128 v[100:103], v5 offset:30720
    v_mfma_f32_16x16x32_bf16 v[44:47], v[76:79], a[228:231], v[44:47]
    v_add_u32 v5, s22, v5
    v_mfma_f32_16x16x32_bf16 v[36:39], v[76:79], a[224:227], v[36:39]
    s_add_u32 m0, s20, 27776
    s_waitcnt vmcnt(16)
    s_barrier
    s_waitcnt lgkmcnt(4)
    v_mfma_f32_16x16x32_bf16 v[32:35], v[80:83], a[232:235], v[32:35]
    ds_read_b128 v[72:75], v4 offset:0
    buffer_load_dwordx4 v2, s[8:11], s23 offen offset:896 lds
    v_mfma_f32_16x16x32_bf16 v[40:43], v[80:83], a[236:239], v[40:43]
    ds_read_b128 v[76:79], v4 offset:2048
    s_add_u32 s23, s23, 1024
    v_mfma_f32_16x16x32_bf16 v[44:47], v[84:87], a[236:239], v[44:47]
    s_bitcmp1_b32 s23, 11
    s_cselect_b32 s60, 0xf800, 0
    v_mfma_f32_16x16x32_bf16 v[36:39], v[84:87], a[232:235], v[36:39]
    s_add_u32 s23, s23, s60
    s_waitcnt lgkmcnt(4)
    v_mfma_f32_16x16x32_bf16 v[32:35], v[88:91], a[240:243], v[32:35]
    ds_read_b128 v[80:83], v5 offset:0
    s_add_u32 s20, s20, 32768
    s_cmp_ge_u32 s20, 163840
    v_mfma_f32_16x16x32_bf16 v[40:43], v[88:91], a[244:247], v[40:43]
    ds_read_b128 v[84:87], v5 offset:2048
    s_cselect_b32 s60, 163840, 0
    s_sub_u32 s20, s20, s60
    v_mfma_f32_16x16x32_bf16 v[44:47], v[92:95], a[244:247], v[44:47]
    v_mfma_f32_16x16x32_bf16 v[36:39], v[92:95], a[240:243], v[36:39]
    s_waitcnt lgkmcnt(4)
    v_mfma_f32_16x16x32_bf16 v[48:51], v[96:99], a[248:251], v[32:35]
    ds_read_b128 v[88:91], v4 offset:4096
    s_add_u32 s24, s24, 1
    s_sub_u32 s61, s24, 2
    v_mfma_f32_16x16x32_bf16 v[56:59], v[96:99], a[252:255], v[40:43]
    ds_read_b128 v[92:95], v4 offset:6144
    s_bitcmp1_b64 s[34:35], s61
    v_mfma_f32_16x16x32_bf16 v[60:63], v[100:103], a[252:255], v[44:47]
    v_mfma_f32_16x16x32_bf16 v[52:55], v[100:103], a[248:251], v[36:39]
    s_cbranch_scc0 kvsv
    s_cmp_eq_u32 s24, 64
    s_cbranch_scc1 kvsv_fin
    s_sub_u32 s62, s24, 46
    s_cmp_ge_u32 s62, 16
    s_cbranch_scc1 kvsv_sig
    s_cmp_ge_u32 s24, 54
    s_cbranch_scc1 L_wp_61
    s_cmp_ge_u32 s24, 50
    s_cbranch_scc1 L_wp_62
    s_cmp_ge_u32 s24, 48
    s_cbranch_scc1 L_wp_63
    s_cmp_ge_u32 s24, 47
    s_cbranch_scc1 L_wp_64
    s_add_u32 s62, s28, 0x0
    buffer_load_dwordx4 v[128:131], v6, s[12:15], s62 offen nt
    s_add_u32 s62, s28, 0x4000
    buffer_load_dwordx4 v[132:135], v6, s[12:15], s62 offen nt
    s_branch kvsv_sig
L_wp_64:
    s_add_u32 s62, s28, 0x10000
    buffer_load_dwordx4 v[136:139], v6, s[12:15], s62 offen nt
    s_add_u32 s62, s28, 0x14000
    buffer_load_dwordx4 v[140:143], v6, s[12:15], s62 offen nt
    s_branch kvsv_sig
L_wp_63:
    s_cmp_ge_u32 s24, 49
    s_cbranch_scc1 L_wp_65
    s_add_u32 s62, s28, 0x20000
    buffer_load_dwordx4 v[144:147], v6, s[12:15], s62 offen nt
    s_add_u32 s62, s28, 0x24000
    buffer_load_dwordx4 v[148:151], v6, s[12:15], s62 offen nt
    s_branch kvsv_sig
L_wp_65:
    s_add_u32 s62, s28, 0x30000
    buffer_load_dwordx4 v[152:155], v6, s[12:15], s62 offen nt
    s_add_u32 s62, s28, 0x34000
    buffer_load_dwordx4 v[156:159], v6, s[12:15], s62 offen nt
    s_branch kvsv_sig
L_wp_62:
    s_cmp_ge_u32 s24, 52
    s_cbranch_scc1 L_wp_66
    s_cmp_ge_u32 s24, 51
    s_cbranch_scc1 L_wp_67
    s_add_u32 s62, s28, 0x40000
    buffer_load_dwordx4 v[160:163], v6, s[12:15], s62 offen nt
    s_add_u32 s62, s28, 0x44000
    buffer_load_dwordx4 v[164:167], v6, s[12:15], s62 offen nt
    s_branch kvsv_sig
L_wp_67:
    s_add_u32 s62, s28, 0x50000
    buffer_load_dwordx4 v[168:171], v6, s[12:15], s62 offen nt
    s_add_u32 s62, s28, 0x54000
    buffer_load_dwordx4 v[172:175], v6, s[12:15], s62 offen nt
    s_branch kvsv_sig
L_wp_66:
    s_cmp_ge_u32 s24, 53
    s_cbranch_scc1 L_wp_68
    s_add_u32 s62, s28, 0x60000
    buffer_load_dwordx4 v[176:179], v6, s[12:15], s62 offen nt
    s_add_u32 s62, s28, 0x64000
    buffer_load_dwordx4 v[180:183], v6, s[12:15], s62 offen nt
    s_branch kvsv_sig
L_wp_68:
    s_add_u32 s62, s28, 0x70000
    buffer_load_dwordx4 v[184:187], v6, s[12:15], s62 offen nt
    s_add_u32 s62, s28, 0x74000
    buffer_load_dwordx4 v[188:191], v6, s[12:15], s62 offen nt
    s_branch kvsv_sig
L_wp_61:
    s_cmp_ge_u32 s24, 58
    s_cbranch_scc1 L_wp_69
    s_cmp_ge_u32 s24, 56
    s_cbranch_scc1 L_wp_70
    s_cmp_ge_u32 s24, 55
    s_cbranch_scc1 L_wp_71
    s_add_u32 s62, s28, 0x80000
    buffer_load_dwordx4 v[192:195], v6, s[12:15], s62 offen nt
    s_add_u32 s62, s28, 0x84000
    buffer_load_dwordx4 v[196:199], v6, s[12:15], s62 offen nt
    s_branch kvsv_sig
L_wp_71:
    s_add_u32 s62, s28, 0x90000
    buffer_load_dwordx4 v[200:203], v6, s[12:15], s62 offen nt
    s_add_u32 s62, s28, 0x94000
    buffer_load_dwordx4 v[204:207], v6, s[12:15], s62 offen nt
    s_branch kvsv_sig
L_wp_70:
    s_cmp_ge_u32 s24, 57
    s_cbranch_scc1 L_wp_72
    s_add_u32 s62, s28, 0xa0000
    buffer_load_dwordx4 v[208:211], v6, s[12:15], s62 offen nt
    s_add_u32 s62, s28, 0xa4000
    buffer_load_dwordx4 v[212:215], v6, s[12:15], s62 offen nt
    s_branch kvsv_sig
L_wp_72:
    s_add_u32 s62, s28, 0xb0000
    buffer_load_dwordx4 v[216:219], v6, s[12:15], s62 offen nt
    s_add_u32 s62, s28, 0xb4000
    buffer_load_dwordx4 v[220:223], v6, s[12:15], s62 offen nt
    s_branch kvsv_sig
L_wp_69:
    s_cmp_ge_u32 s24, 60
    s_cbranch_scc1 L_wp_73
    s_cmp_ge_u32 s24, 59
    s_cbranch_scc1 L_wp_74
    s_add_u32 s62, s28, 0xc0000
    buffer_load_dwordx4 v[224:227], v6, s[12:15], s62 offen nt
    s_add_u32 s62, s28, 0xc4000
    buffer_load_dwordx4 v[228:231], v6, s[12:15], s62 offen nt
    s_branch kvsv_sig
L_wp_74:
    s_add_u32 s62, s28, 0xd0000
    buffer_load_dwordx4 v[232:235], v6, s[12:15], s62 offen nt
    s_add_u32 s62, s28, 0xd4000
    buffer_load_dwordx4 v[236:239], v6, s[12:15], s62 offen nt
    s_branch kvsv_sig
L_wp_73:
    s_cmp_ge_u32 s24, 61
    s_cbranch_scc1 L_wp_75
    s_add_u32 s62, s28, 0xe0000
    buffer_load_dwordx4 v[240:243], v6, s[12:15], s62 offen nt
    s_add_u32 s62, s28, 0xe4000
    buffer_load_dwordx4 v[244:247], v6, s[12:15], s62 offen nt
    s_branch kvsv_sig
L_wp_75:
    s_add_u32 s62, s28, 0xf0000
    buffer_load_dwordx4 v[248:251], v6, s[12:15], s62 offen nt
    s_add_u32 s62, s28, 0xf4000
    buffer_load_dwordx4 v[252:255], v6, s[12:15], s62 offen nt
    s_branch kvsv_sig
kvsv_sig:
    s_cmp_lg_u32 s58, 0
    s_cbranch_scc1 kvsv
    s_mov_b32 s62, 0x2042258
    s_mov_b32 s63, 0x4004
    s_bitcmp1_b64 s[62:63], s61
    s_cbranch_scc0 kvsv
    s_bfm_b64 s[62:63], s61, 0
    s_and_b32 s62, s62, 0x204225f
    s_and_b32 s63, s63, 0x80004004
    s_bcnt1_i32_b64 s60, s[62:63]
    s_lshl_b32 s60, s60, 2
    s_add_u32 s60, s60, 64
    v_mov_b32 v24, s60
    v_mov_b32 v25, 1
    s_mov_b64 exec, 1
    global_atomic_add v24, v25, s[98:99] sc1
    s_mov_b64 exec, -1
    s_branch kvsv
kvsv_early:
    s_waitcnt vmcnt(4)
    s_barrier
    s_cmp_eq_u32 s24, 0
    s_cbranch_scc1 kvsv_mid
    s_cmp_lg_u32 s58, 0
    s_cbranch_scc1 kvsv_mid
    s_lshl_b32 s60, s24, 2
    s_add_u32 s60, s60, 60
    v_mov_b32 v24, s60
    v_mov_b32 v25, 1
    s_mov_b64 exec, 1
    global_atomic_add v24, v25, s[98:99] sc1
    s_mov_b64 exec, -1
    s_branch kvsv_mid
kvsv_fin:
    s_nop 7
    v_cvt_pk_bf16_f32 v64, v48, v49
    v_cvt_pk_bf16_f32 v65, v50, v51
    v_cvt_pk_bf16_f32 v66, v52, v53
    v_cvt_pk_bf16_f32 v67, v54, v55
    v_cvt_pk_bf16_f32 v68, v56, v57
    v_cvt_pk_bf16_f32 v69, v58, v59
    v_cvt_pk_bf16_f32 v70, v60, v61
    v_cvt_pk_bf16_f32 v71, v62, v63
    buffer_store_dwordx4 v[64:67], v1, s[16:19], s25 offen sc1
    buffer_store_dwordx4 v[68:71], v1, s[16:19], s25 offen offset:1024 sc1
    buffer_store_dwordx4 v[28:31], v1, s[16:19], s26 offen sc1
    s_waitcnt vmcnt(0) lgkmcnt(0)
    s_barrier
    s_cmp_lg_u32 s58, 0
    s_cbranch_scc1 L_kve_45
    s_mov_b32 s60, 112
    v_mov_b32 v24, s60
    v_mov_b32 v25, 1
    s_mov_b64 exec, 1
    global_atomic_add v24, v25, s[98:99] sc1
    s_mov_b64 exec, -1
    s_branch L_kve_45
L_kve_45:
    s_branch chain_kernel_seg
L_big_37:
    v_and_b32 v24, 63, v0
    v_lshlrev_b32 v1, 4, v24
    v_mov_b32 v2, v1
    v_add_u32 v3, 1024, v1
    v_bfe_u32 v24, v0, 1, 3
    v_bfe_u32 v25, v0, 4, 2
    v_xor_b32 v24, v24, v25
    v_lshlrev_b32 v24, 4, v24
    v_and_b32 v25, 15, v0
    v_lshl_add_u32 v24, v25, 7, v24
    s_lshr_b32 s60, s58, 1
    s_lshl_b32 s60, s60, 14
    v_add_u32 v23, s60, v24
    s_and_b32 s60, s58, 1
    s_lshl_b32 s60, s60, 14
    s_add_u32 s60, s60, 32768
    v_add_u32 v12, s60, v24
    v_xor_b32 v13, 64, v12
    v_bfe_u32 v24, v0, 2, 3
    v_lshlrev_b32 v22, 5, v24
    v_and_b32 v24, 3, v0
    v_lshl_add_u32 v22, v24, 3, v22
    v_bfe_u32 v24, v0, 2, 2
    v_lshl_add_u32 v22, v24, 9, v22
    v_bfe_u32 v24, v0, 4, 2
    v_lshl_add_u32 v22, v24, 12, v22
    v_bfe_u32 v24, v0, 7, 1
    v_lshl_add_u32 v22, v24, 8, v22
    s_mov_b32 s49, 0
    s_mov_b32 s48, 32768
    s_lshl_b32 s45, s58, 12
    s_add_u32 s44, s45, 32768
    s_mov_b32 s11, 0x00020000
    s_mov_b32 s15, 0x00020000
    s_mov_b32 s19, 0x00020000
    s_mov_b32 s91, 0x00020000
    s_mov_b32 s90, 0x200000
    v_bfe_u32 v24, v0, 2, 3
    v_lshlrev_b32 v125, 11, v24
    v_and_b32 v24, 3, v0
    v_lshl_add_u32 v125, v24, 7, v125
    s_and_b32 s82, s57, 3
    s_lshr_b32 s85, s57, 2
    s_and_b32 s0, s82, 3
    s_lshl2_add_u32 s0, s85, s0
    s_lshl_b32 s60, s85, 19
    s_mov_b32 s30, s64
    s_and_b32 s31, s65, 0xffff
    s_mov_b32 s32, 0x400000
    s_mov_b32 s33, s60
    s_mov_b32 s34, 0x2000
    s_mov_b32 s35, 0x40000
    s_lshl_b32 s60, s82, 18
    s_mov_b32 s36, s70
    s_and_b32 s37, s71, 0xffff
    s_mov_b32 s38, 0x200000
    s_mov_b32 s39, s60
    s_mov_b32 s40, 0x8000
    s_mov_b32 s41, 0x20000
    s_mov_b32 s42, 0x80
    s_cmp_ge_u32 s58, 2
    s_cselect_b32 s36, s72, s70
    s_cselect_b32 s37, s73, s71
    s_and_b32 s37, s37, 0xffff
    v_bfe_u32 v24, v0, 4, 2
    v_and_b32 v25, 7, v0
    v_xor_b32 v24, v24, v25
    v_lshlrev_b32 v8, 4, v24
    v_bfe_u32 v24, v0, 3, 2
    v_lshl_add_u32 v8, v24, 11, v8
    v_bfe_u32 v24, v0, 5, 1
    v_lshl_add_u32 v8, v24, 16, v8
    v_lshrrev_b32 v24, 6, v0
    v_lshl_add_u32 v8, v24, 14, v8
    v_xor_b32 v9, 64, v8
    v_add_u32 v9, 0x20000, v9
    v_bfe_u32 v24, v0, 4, 2
    v_and_b32 v25, 7, v0
    v_xor_b32 v24, v24, v25
    v_lshlrev_b32 v10, 4, v24
    v_bfe_u32 v24, v0, 3, 3
    v_lshl_add_u32 v10, v24, 11, v10
    v_bfe_u32 v24, v0, 6, 1
    v_lshl_add_u32 v10, v24, 16, v10
    v_xor_b32 v11, 64, v10
    v_add_u32 v11, 0x4000, v11
    v_and_b32 v24, 15, v0
    v_bfe_u32 v25, v0, 7, 1
    v_lshl_add_u32 v24, v25, 6, v24
    v_lshlrev_b32 v24, 1, v24
    s_lshl_b32 s53, s82, 8
    s_mov_b32 s60, s66
    s_and_b32 s61, s67, 0xffff
    s_mov_b32 s62, 0x800
    s_mov_b32 s63, 0x00020000
    buffer_load_ushort v192, v24, s[60:63], s53 offen offset:0
    buffer_load_ushort v200, v24, s[60:63], s53 offen offset:32
    buffer_load_ushort v208, v24, s[60:63], s53 offen offset:64
    buffer_load_ushort v216, v24, s[60:63], s53 offen offset:96
    s_mov_b32 s60, s68
    s_and_b32 s61, s69, 0xffff
    s_mov_b32 s62, 0x800
    s_mov_b32 s63, 0x00020000
    buffer_load_ushort v193, v24, s[60:63], s53 offen offset:0
    buffer_load_ushort v201, v24, s[60:63], s53 offen offset:32
    buffer_load_ushort v209, v24, s[60:63], s53 offen offset:64
    buffer_load_ushort v217, v24, s[60:63], s53 offen offset:96
    s_mov_b32 s60, s78
    s_and_b32 s61, s79, 0xffff
    s_mov_b32 s62, 0x800
    s_mov_b32 s63, 0x00020000
    buffer_load_ushort v194, v24, s[60:63], s53 offen offset:0
    buffer_load_ushort v202, v24, s[60:63], s53 offen offset:32
    buffer_load_ushort v210, v24, s[60:63], s53 offen offset:64
    buffer_load_ushort v218, v24, s[60:63], s53 offen offset:96
    s_mov_b32 s6, 0xfffe8000
    s_mov_b32 s7, 65536
    s_mov_b32 s12, s36
    s_mov_b32 s13, s37
    s_mov_b32 s14, s38
    s_and_b32 s45, s45, 0xffffb7ff
    s_bitcmp1_b32 s0, 3
    s_cselect_b32 s24, s41, 0
    s_cselect_b32 s26, 0, s41
    s_cselect_b32 s60, 0x4000, 0
    s_or_b32 s45, s45, s60
    s_add_u32 s24, s24, s39
    s_add_u32 s26, s26, s39
    s_bitcmp1_b32 s0, 2
    s_cselect_b32 s61, s40, 0
    s_cselect_b32 s62, 0, s40
    s_cselect_b32 s60, 0x800, 0
    s_or_b32 s45, s45, s60
    s_add_u32 s25, s24, s62
    s_add_u32 s24, s24, s61
    s_add_u32 s27, s26, s62
    s_add_u32 s26, s26, s61
    s_mov_b32 s28, s42
    v_mov_b32 v6, v10
    v_mov_b32 v7, v11
    s_mov_b32 s8, s30
    s_mov_b32 s9, s31
    s_mov_b32 s10, s32
    s_and_b32 s44, s44, 0xffffb7ff
    s_bitcmp1_b32 s0, 1
    s_cselect_b32 s20, s35, 0
    s_cselect_b32 s22, 0, s35
    s_cselect_b32 s60, 0x4000, 0
    s_or_b32 s44, s44, s60
    s_add_u32 s20, s20, s33
    s_add_u32 s22, s22, s33
    s_bitcmp1_b32 s0, 0
    s_cselect_b32 s61, s34, 0
    s_cselect_b32 s62, 0, s34
    s_cselect_b32 s60, 0x800, 0
    s_or_b32 s44, s44, s60
    s_add_u32 s21, s20, s62
    s_add_u32 s20, s20, s61
    s_add_u32 s23, s22, s62
    s_add_u32 s22, s22, s61
    v_mov_b32 v4, v8
    v_mov_b32 v5, v9
    s_xor_b32 m0, s45, 0
    s_nop 0
    buffer_load_dwordx4 v6, s[12:15], s24 offen lds
    s_xor_b32 m0, s45, 1024
    s_nop 0
    buffer_load_dwordx4 v7, s[12:15], s24 offen lds
    s_xor_b32 m0, s45, 2048
    s_nop 0
    buffer_load_dwordx4 v6, s[12:15], s25 offen lds
    s_xor_b32 m0, s45, 3072
    s_nop 0
    buffer_load_dwordx4 v7, s[12:15], s25 offen lds
    s_xor_b32 m0, s45, 16384
    s_nop 0
    buffer_load_dwordx4 v6, s[12:15], s26 offen lds
    s_xor_b32 m0, s45, 17408
    s_nop 0
    buffer_load_dwordx4 v7, s[12:15], s26 offen lds
    s_xor_b32 m0, s45, 18432
    s_nop 0
    buffer_load_dwordx4 v6, s[12:15], s27 offen lds
    s_xor_b32 m0, s45, 19456
    s_nop 0
    buffer_load_dwordx4 v7, s[12:15], s27 offen lds
    s_add_u32 s24, s24, s28
    s_add_u32 s25, s25, s28
    s_add_u32 s26, s26, s28
    s_add_u32 s27, s27, s28
    s_cmp_ge_u32 s45, 98304
    s_cselect_b32 s60, s6, s7
    s_add_u32 s45, s45, s60
    s_xor_b32 m0, s44, 0
    s_nop 0
    buffer_load_dwordx4 v4, s[8:11], s20 offen lds
    s_xor_b32 m0, s44, 1024
    s_nop 0
    buffer_load_dwordx4 v5, s[8:11], s20 offen lds
    s_xor_b32 m0, s44, 2048
    s_nop 0
    buffer_load_dwordx4 v4, s[8:11], s21 offen lds
    s_xor_b32 m0, s44, 3072
    s_nop 0
    buffer_load_dwordx4 v5, s[8:11], s21 offen lds
    s_xor_b32 m0, s44, 16384
    s_nop 0
    buffer_load_dwordx4 v4, s[8:11], s22 offen lds
    s_xor_b32 m0, s44, 17408
    s_nop 0
    buffer_load_dwordx4 v5, s[8:11], s22 offen lds
    s_xor_b32 m0, s44, 18432
    s_nop 0
    buffer_load_dwordx4 v4, s[8:11], s23 offen lds
    s_xor_b32 m0, s44, 19456
    s_nop 0
    buffer_load_dwordx4 v5, s[8:11], s23 offen lds
    s_add_u32 s20, s20, 128
    s_add_u32 s21, s21, 128
    s_add_u32 s22, s22, 128
    s_add_u32 s23, s23, 128
    s_cmp_ge_u32 s44, 98304
    s_cselect_b32 s60, s6, s7
    s_add_u32 s44, s44, s60
    s_xor_b32 m0, s45, 0
    s_nop 0
    buffer_load_dwordx4 v6, s[12:15], s24 offen lds
    s_xor_b32 m0, s45, 1024
    s_nop 0
    buffer_load_dwordx4 v7, s[12:15], s24 offen lds
    s_xor_b32 m0, s45, 2048
    s_nop 0
    buffer_load_dwordx4 v6, s[12:15], s25 offen lds
    s_xor_b32 m0, s45, 3072
    s_nop 0
    buffer_load_dwordx4 v7, s[12:15], s25 offen lds
    s_xor_b32 m0, s45, 16384
    s_nop 0
    buffer_load_dwordx4 v6, s[12:15], s26 offen lds
    s_xor_b32 m0, s45, 17408
    s_nop 0
    buffer_load_dwordx4 v7, s[12:15], s26 offen lds
    s_xor_b32 m0, s45, 18432
    s_nop 0
    buffer_load_dwordx4 v6, s[12:15], s27 offen lds
    s_xor_b32 m0, s45, 19456
    s_nop 0
    buffer_load_dwordx4 v7, s[12:15], s27 offen lds
    s_add_u32 s24, s24, s28
    s_add_u32 s25, s25, s28
    s_add_u32 s26, s26, s28
    s_add_u32 s27, s27, s28
    s_cmp_ge_u32 s45, 98304
    s_cselect_b32 s60, s6, s7
    s_add_u32 s45, s45, s60
    s_add_u32 s39, s39, 0x100000
    s_mov_b32 s16, s100
    s_and_b32 s17, s101, 0xffff
    s_mov_b32 s18, 0x0
    s_mov_b32 s19, 0x00020000
    s_lshr_b32 s60, s85, 2
    s_lshl_b32 s60, s60, 21
    s_add_u32 s86, s64, s60
    s_addc_u32 s87, s65, 0
    s_and_b32 s60, s57, 15
    s_lshl1_add_u32 s60, s60, s58
    s_lshl_b32 s84, s60, 16
    s_bitcmp1_b32 s85, 0
    s_cselect_b64 s[62:63], s[72:73], s[70:71]
    s_lshr_b32 s60, s85, 1
    s_lshl2_add_u32 s60, s82, s60
    s_add_u32 s60, s60, 0
    s_lshl_b32 s60, s60, 16
    s_cmp_eq_u32 s58, 2
    s_cselect_b64 s[86:87], s[62:63], s[86:87]
    s_cselect_b32 s84, s60, s84
    s_cmp_eq_u32 s58, 3
    s_cselect_b32 s84, 0x40000000, s84
    s_and_b32 s87, s87, 0xffff
    s_mov_b64 s[88:89], s[86:87]
    s_add_u32 s83, s84, 512
    s_lshr_b32 s60, s85, 2
    s_lshl_b32 s60, s60, 21
    s_add_u32 s86, s64, s60
    s_addc_u32 s87, s65, 0
    s_and_b32 s60, s57, 15
    s_lshl1_add_u32 s60, s60, s58
    s_lshl_b32 s84, s60, 16
    s_bitcmp1_b32 s85, 0
    s_cselect_b64 s[62:63], s[72:73], s[70:71]
    s_lshr_b32 s60, s85, 1
    s_lshl2_add_u32 s60, s82, s60
    s_add_u32 s60, s60, 16
    s_lshl_b32 s60, s60, 16
    s_cmp_eq_u32 s58, 2
    s_cselect_b64 s[86:87], s[62:63], s[86:87]
    s_cselect_b32 s84, s60, s84
    s_cmp_eq_u32 s58, 3
    s_cselect_b32 s84, 0x40000000, s84
    s_and_b32 s87, s87, 0xffff
    s_waitcnt vmcnt(24)
    v_lshlrev_b32 v192, 16, v192
    v_lshlrev_b32 v200, 16, v200
    v_lshlrev_b32 v208, 16, v208
    v_lshlrev_b32 v216, 16, v216
    v_lshlrev_b32 v193, 16, v193
    v_lshlrev_b32 v201, 16, v201
    v_lshlrev_b32 v209, 16, v209
    v_lshlrev_b32 v217, 16, v217
    v_lshlrev_b32 v194, 16, v194
    v_lshlrev_b32 v202, 16, v202
    v_lshlrev_b32 v210, 16, v210
    v_lshlrev_b32 v218, 16, v218
    v_mul_f32 v194, 0x3fb8aa3b, v194
    v_mul_f32 v202, 0x3fb8aa3b, v202
    v_mul_f32 v210, 0x3fb8aa3b, v210
    v_mul_f32 v218, 0x3fb8aa3b, v218
    v_exp_f32 v194, v194
    v_exp_f32 v202, v202
    v_exp_f32 v210, v210
    v_exp_f32 v218, v218
    v_cvt_pk_bf16_f32 v194, 0, v194
    v_cvt_pk_bf16_f32 v202, 0, v202
    v_cvt_pk_bf16_f32 v210, 0, v210
    v_cvt_pk_bf16_f32 v218, 0, v218
    v_mul_f32 v195, v194, v192
    v_mul_f32 v203, v202, v200
    v_mul_f32 v211, v210, v208
    v_mul_f32 v219, v218, v216
    v_mul_f32 v196, v194, v193
    v_mul_f32 v204, v202, v201
    v_mul_f32 v212, v210, v209
    v_mul_f32 v220, v218, v217
    v_mul_f32 v195, 0x3fb8aa3b, v195
    v_mul_f32 v203, 0x3fb8aa3b, v203
    v_mul_f32 v211, 0x3fb8aa3b, v211
    v_mul_f32 v219, 0x3fb8aa3b, v219
    v_exp_f32 v195, v195
    v_exp_f32 v203, v203
    v_exp_f32 v211, v211
    v_exp_f32 v219, v219
    v_mul_f32 v196, 0x3e22f983, v196
    v_mul_f32 v204, 0x3e22f983, v204
    v_mul_f32 v212, 0x3e22f983, v212
    v_mul_f32 v220, 0x3e22f983, v220
    v_fract_f32 v196, v196
    v_fract_f32 v204, v204
    v_fract_f32 v212, v212
    v_fract_f32 v220, v220
    v_cos_f32 v197, v196
    v_cos_f32 v205, v204
    v_cos_f32 v213, v212
    v_cos_f32 v221, v220
    v_sin_f32 v198, v196
    v_sin_f32 v206, v204
    v_sin_f32 v214, v212
    v_sin_f32 v222, v220
    v_mul_f32 v88, v195, v197
    v_mul_f32 v90, v203, v205
    v_mul_f32 v92, v211, v213
    v_mul_f32 v94, v219, v221
    v_mul_f32 v89, v195, v198
    v_mul_f32 v91, v203, v206
    v_mul_f32 v93, v211, v214
    v_mul_f32 v95, v219, v222
    v_add_f32 v197, -1.0, v88
    v_add_f32 v205, -1.0, v90
    v_add_f32 v213, -1.0, v92
    v_add_f32 v221, -1.0, v94
    v_mul_f32 v198, v197, v192
    v_mul_f32 v206, v205, v200
    v_mul_f32 v214, v213, v208
    v_mul_f32 v222, v221, v216
    v_fma_f32 v198, v89, v193, v198
    v_fma_f32 v206, v91, v201, v206
    v_fma_f32 v214, v93, v209, v214
    v_fma_f32 v222, v95, v217, v222
    v_mul_f32 v199, v89, v192
    v_mul_f32 v207, v91, v200
    v_mul_f32 v215, v93, v208
    v_mul_f32 v223, v95, v216
    v_fma_f32 v199, -v197, v193, v199
    v_fma_f32 v207, -v205, v201, v207
    v_fma_f32 v215, -v213, v209, v215
    v_fma_f32 v223, -v221, v217, v223
    v_mul_f32 v195, v192, v192
    v_mul_f32 v203, v200, v200
    v_mul_f32 v211, v208, v208
    v_mul_f32 v219, v216, v216
    v_fma_f32 v195, v193, v193, v195
    v_fma_f32 v203, v201, v201, v203
    v_fma_f32 v211, v209, v209, v211
    v_fma_f32 v219, v217, v217, v219
    v_rcp_f32 v195, v195
    v_rcp_f32 v203, v203
    v_rcp_f32 v211, v211
    v_rcp_f32 v219, v219
    v_add_f32 v195, v195, v195
    v_add_f32 v203, v203, v203
    v_add_f32 v211, v211, v211
    v_add_f32 v219, v219, v219
    v_mul_f32 v96, v198, v195
    v_mul_f32 v98, v206, v203
    v_mul_f32 v100, v214, v211
    v_mul_f32 v102, v222, v219
    v_mul_f32 v97, v199, v195
    v_mul_f32 v99, v207, v203
    v_mul_f32 v101, v215, v211
    v_mul_f32 v103, v223, v219
    v_pk_mul_f32 v[192:193], v[88:89], v[88:89] op_sel:[0,0] op_sel_hi:[0,1]
    v_pk_mul_f32 v[200:201], v[90:91], v[90:91] op_sel:[0,0] op_sel_hi:[0,1]
    v_pk_mul_f32 v[208:209], v[92:93], v[92:93] op_sel:[0,0] op_sel_hi:[0,1]
    v_pk_mul_f32 v[216:217], v[94:95], v[94:95] op_sel:[0,0] op_sel_hi:[0,1]
    v_pk_fma_f32 v[104:105], v[88:89], v[88:89], v[192:193] op_sel:[1,1,0] op_sel_hi:[1,0,1] neg_lo:[1,0,0]
    v_pk_fma_f32 v[106:107], v[90:91], v[90:91], v[200:201] op_sel:[1,1,0] op_sel_hi:[1,0,1] neg_lo:[1,0,0]
    v_pk_fma_f32 v[108:109], v[92:93], v[92:93], v[208:209] op_sel:[1,1,0] op_sel_hi:[1,0,1] neg_lo:[1,0,0]
    v_pk_fma_f32 v[110:111], v[94:95], v[94:95], v[216:217] op_sel:[1,1,0] op_sel_hi:[1,0,1] neg_lo:[1,0,0]
    v_pk_mul_f32 v[192:193], v[104:105], v[104:105] op_sel:[0,0] op_sel_hi:[0,1]
    v_pk_mul_f32 v[200:201], v[106:107], v[106:107] op_sel:[0,0] op_sel_hi:[0,1]
    v_pk_mul_f32 v[208:209], v[108:109], v[108:109] op_sel:[0,0] op_sel_hi:[0,1]
    v_pk_mul_f32 v[216:217], v[110:111], v[110:111] op_sel:[0,0] op_sel_hi:[0,1]
    v_pk_fma_f32 v[104:105], v[104:105], v[104:105], v[192:193] op_sel:[1,1,0] op_sel_hi:[1,0,1] neg_lo:[1,0,0]
    v_pk_fma_f32 v[106:107], v[106:107], v[106:107], v[200:201] op_sel:[1,1,0] op_sel_hi:[1,0,1] neg_lo:[1,0,0]
    v_pk_fma_f32 v[108:109], v[108:109], v[108:109], v[208:209] op_sel:[1,1,0] op_sel_hi:[1,0,1] neg_lo:[1,0,0]
    v_pk_fma_f32 v[110:111], v[110:111], v[110:111], v[216:217] op_sel:[1,1,0] op_sel_hi:[1,0,1] neg_lo:[1,0,0]
    v_pk_mul_f32 v[192:193], v[104:105], v[104:105] op_sel:[0,0] op_sel_hi:[0,1]
    v_pk_mul_f32 v[200:201], v[106:107], v[106:107] op_sel:[0,0] op_sel_hi:[0,1]
    v_pk_mul_f32 v[208:209], v[108:109], v[108:109] op_sel:[0,0] op_sel_hi:[0,1]
    v_pk_mul_f32 v[216:217], v[110:111], v[110:111] op_sel:[0,0] op_sel_hi:[0,1]
    v_pk_fma_f32 v[104:105], v[104:105], v[104:105], v[192:193] op_sel:[1,1,0] op_sel_hi:[1,0,1] neg_lo:[1,0,0]
    v_pk_fma_f32 v[106:107], v[106:107], v[106:107], v[200:201] op_sel:[1,1,0] op_sel_hi:[1,0,1] neg_lo:[1,0,0]
    v_pk_fma_f32 v[108:109], v[108:109], v[108:109], v[208:209] op_sel:[1,1,0] op_sel_hi:[1,0,1] neg_lo:[1,0,0]
    v_pk_fma_f32 v[110:111], v[110:111], v[110:111], v[216:217] op_sel:[1,1,0] op_sel_hi:[1,0,1] neg_lo:[1,0,0]
    v_pk_mul_f32 v[192:193], v[104:105], v[104:105] op_sel:[0,0] op_sel_hi:[0,1]
    v_pk_mul_f32 v[200:201], v[106:107], v[106:107] op_sel:[0,0] op_sel_hi:[0,1]
    v_pk_mul_f32 v[208:209], v[108:109], v[108:109] op_sel:[0,0] op_sel_hi:[0,1]
    v_pk_mul_f32 v[216:217], v[110:111], v[110:111] op_sel:[0,0] op_sel_hi:[0,1]
    v_pk_fma_f32 v[104:105], v[104:105], v[104:105], v[192:193] op_sel:[1,1,0] op_sel_hi:[1,0,1] neg_lo:[1,0,0]
    v_pk_fma_f32 v[106:107], v[106:107], v[106:107], v[200:201] op_sel:[1,1,0] op_sel_hi:[1,0,1] neg_lo:[1,0,0]
    v_pk_fma_f32 v[108:109], v[108:109], v[108:109], v[208:209] op_sel:[1,1,0] op_sel_hi:[1,0,1] neg_lo:[1,0,0]
    v_pk_fma_f32 v[110:111], v[110:111], v[110:111], v[216:217] op_sel:[1,1,0] op_sel_hi:[1,0,1] neg_lo:[1,0,0]
    v_pk_mul_f32 v[192:193], v[104:105], v[104:105] op_sel:[0,0] op_sel_hi:[0,1]
    v_pk_mul_f32 v[200:201], v[106:107], v[106:107] op_sel:[0,0] op_sel_hi:[0,1]
    v_pk_mul_f32 v[208:209], v[108:109], v[108:109] op_sel:[0,0] op_sel_hi:[0,1]
    v_pk_mul_f32 v[216:217], v[110:111], v[110:111] op_sel:[0,0] op_sel_hi:[0,1]
    v_pk_fma_f32 v[104:105], v[104:105], v[104:105], v[192:193] op_sel:[1,1,0] op_sel_hi:[1,0,1] neg_lo:[1,0,0]
    v_pk_fma_f32 v[106:107], v[106:107], v[106:107], v[200:201] op_sel:[1,1,0] op_sel_hi:[1,0,1] neg_lo:[1,0,0]
    v_pk_fma_f32 v[108:109], v[108:109], v[108:109], v[208:209] op_sel:[1,1,0] op_sel_hi:[1,0,1] neg_lo:[1,0,0]
    v_pk_fma_f32 v[110:111], v[110:111], v[110:111], v[216:217] op_sel:[1,1,0] op_sel_hi:[1,0,1] neg_lo:[1,0,0]
    v_pk_mul_f32 v[192:193], v[104:105], v[104:105] op_sel:[0,0] op_sel_hi:[0,1]
    v_pk_mul_f32 v[200:201], v[106:107], v[106:107] op_sel:[0,0] op_sel_hi:[0,1]
    v_pk_mul_f32 v[208:209], v[108:109], v[108:109] op_sel:[0,0] op_sel_hi:[0,1]
    v_pk_mul_f32 v[216:217], v[110:111], v[110:111] op_sel:[0,0] op_sel_hi:[0,1]
    v_pk_fma_f32 v[112:113], v[104:105], v[104:105], v[192:193] op_sel:[1,1,0] op_sel_hi:[1,0,1] neg_lo:[1,0,0]
    v_pk_fma_f32 v[114:115], v[106:107], v[106:107], v[200:201] op_sel:[1,1,0] op_sel_hi:[1,0,1] neg_lo:[1,0,0]
    v_pk_fma_f32 v[116:117], v[108:109], v[108:109], v[208:209] op_sel:[1,1,0] op_sel_hi:[1,0,1] neg_lo:[1,0,0]
    v_pk_fma_f32 v[118:119], v[110:111], v[110:111], v[216:217] op_sel:[1,1,0] op_sel_hi:[1,0,1] neg_lo:[1,0,0]
    v_pk_mul_f32 v[192:193], v[112:113], v[112:113] op_sel:[0,0] op_sel_hi:[0,1]
    v_pk_mul_f32 v[200:201], v[114:115], v[114:115] op_sel:[0,0] op_sel_hi:[0,1]
    v_pk_mul_f32 v[208:209], v[116:117], v[116:117] op_sel:[0,0] op_sel_hi:[0,1]
    v_pk_mul_f32 v[216:217], v[118:119], v[118:119] op_sel:[0,0] op_sel_hi:[0,1]
    v_pk_fma_f32 v[196:197], v[112:113], v[112:113], v[192:193] op_sel:[1,1,0] op_sel_hi:[1,0,1] neg_lo:[1,0,0]
    v_pk_fma_f32 v[204:205], v[114:115], v[114:115], v[200:201] op_sel:[1,1,0] op_sel_hi:[1,0,1] neg_lo:[1,0,0]
    v_pk_fma_f32 v[212:213], v[116:117], v[116:117], v[208:209] op_sel:[1,1,0] op_sel_hi:[1,0,1] neg_lo:[1,0,0]
    v_pk_fma_f32 v[220:221], v[118:119], v[118:119], v[216:217] op_sel:[1,1,0] op_sel_hi:[1,0,1] neg_lo:[1,0,0]
    s_mov_b32 exec_lo, 0xffffffff
    s_mov_b32 exec_hi, 0xffffffff
    v_mov_b32 v120, v196
    v_mov_b32 v121, v197
    s_mov_b32 exec_lo, 0xffff0000
    s_mov_b32 exec_hi, 0xffffffff
    v_mov_b32 v120, v204
    v_mov_b32 v121, v205
    s_mov_b32 exec_lo, 0x0
    s_mov_b32 exec_hi, 0xffffffff
    v_mov_b32 v120, v212
    v_mov_b32 v121, v213
    s_mov_b32 exec_lo, 0x0
    s_mov_b32 exec_hi, 0xffff0000
    v_mov_b32 v120, v220
    v_mov_b32 v121, v221
    s_mov_b64 exec, -1
    s_mov_b32 s1, 0
    s_mov_b32 s4, 0
    s_mov_b32 s3, 0
    s_mov_b32 s50, 0
    s_mov_b32 s5, 0
    s_mov_b32 s51, 0
    s_mov_b32 s52, 0
    s_waitcnt vmcnt(8)
    s_barrier
    s_call_b64 s[54:55], t_g1
    v_mov_b32 v24, 4
    global_load_dword v123, v24, s[98:99] sc1
    s_or_b32 s60, s2, s58
    s_cbranch_scc1 L_rw_76
    s_lshl_b32 s62, s56, 3
    s_add_u32 s62, s62, 160
    s_mov_b32 s63, 0
L_rp_77:
    s_load_dwordx2 s[60:61], s[98:99], s62 glc
    s_add_u32 s63, s63, 1
    s_cmp_gt_u32 s63, 0x100000
    s_cbranch_scc1 chain_kernel_wabort
    s_waitcnt lgkmcnt(0)
    s_cmp_lt_u32 s61, 0x2000
    s_cbranch_scc1 L_rp_77
    s_lshr_b32 s61, s95, 8
    s_cmp_eq_u32 s60, -1
    s_cselect_b32 s94, -1, s61
L_rw_76:
    s_cmp_lg_u32 s2, 0
    s_cbranch_scc1 L_rok_78
    v_mov_b32 v24, 0
    s_cmp_lg_u32 s58, 0
    s_cbranch_scc1 L_rw_79
    v_mov_b32 v25, s94
    ds_write_b32 v24, v25
    s_waitcnt lgkmcnt(0)
L_rw_79:
    s_barrier
    ds_read_b32 v25, v24
    s_waitcnt lgkmcnt(0)
    v_readfirstlane_b32 s60, v25
    s_mov_b32 s2, 1
    s_cmp_eq_u32 s60, -1
    s_cbranch_scc1 L_rok_78
    s_mov_b32 s57, s60
    s_waitcnt vmcnt(0)
    s_barrier
    s_cmp_ge_u32 s57, 32
    s_cbranch_scc1 chain_kernel_end
    s_branch L_big_37
L_rok_78:
    s_waitcnt vmcnt(0)
    s_mov_b32 s62, 0
L_pp_80:
    v_readfirstlane_b32 s59, v123
    s_and_b32 s60, s59, 0xff
    s_cmp_ge_u32 s60, 15
    s_cbranch_scc1 L_pok_81
    v_mov_b32 v24, 4
    global_load_dword v123, v24, s[98:99] sc1
    s_add_u32 s62, s62, 1
    s_cmp_gt_u32 s62, 0x200000
    s_cbranch_scc1 chain_kernel_wabort
    s_waitcnt vmcnt(0)
    s_branch L_pp_80
L_pok_81:
    s_cmp_ge_u32 s59, 0x800
    s_cselect_b32 s59, 0x2000, 0
    s_call_b64 s[54:55], t_scan
    s_add_u32 s82, s82, 4
    v_and_b32 v24, 15, v0
    v_bfe_u32 v25, v0, 7, 1
    v_lshl_add_u32 v24, v25, 6, v24
    v_lshlrev_b32 v24, 1, v24
    s_lshl_b32 s53, s82, 8
    s_mov_b32 s60, s66
    s_and_b32 s61, s67, 0xffff
    s_mov_b32 s62, 0x800
    s_mov_b32 s63, 0x00020000
    buffer_load_ushort v40, v24, s[60:63], s53 offen offset:0
    buffer_load_ushort v48, v24, s[60:63], s53 offen offset:32
    buffer_load_ushort v56, v24, s[60:63], s53 offen offset:64
    buffer_load_ushort v64, v24, s[60:63], s53 offen offset:96
    s_mov_b32 s60, s68
    s_and_b32 s61, s69, 0xffff
    s_mov_b32 s62, 0x800
    s_mov_b32 s63, 0x00020000
    buffer_load_ushort v41, v24, s[60:63], s53 offen offset:0
    buffer_load_ushort v49, v24, s[60:63], s53 offen offset:32
    buffer_load_ushort v57, v24, s[60:63], s53 offen offset:64
    buffer_load_ushort v65, v24, s[60:63], s53 offen offset:96
    s_mov_b32 s60, s78
    s_and_b32 s61, s79, 0xffff
    s_mov_b32 s62, 0x800
    s_mov_b32 s63, 0x00020000
    buffer_load_ushort v42, v24, s[60:63], s53 offen offset:0
    buffer_load_ushort v50, v24, s[60:63], s53 offen offset:32
    buffer_load_ushort v58, v24, s[60:63], s53 offen offset:64
    buffer_load_ushort v66, v24, s[60:63], s53 offen offset:96
    s_and_b32 s62, s57, 7
    s_lshr_b32 s63, s57, 3
    s_lshl_b32 s60, s63, 19
    s_add_u32 s60, s60, 0
    s_mov_b32 s30, s74
    s_and_b32 s31, s75, 0xffff
    s_mov_b32 s32, 0x200000
    s_mov_b32 s33, s60
    s_mov_b32 s34, 0x8000
    s_mov_b32 s35, 0x40000
    s_lshl_b32 s61, s62, 13
    s_andn2_b32 s61, 0x2000, s61
    s_xor_b32 s61, s61, s59
    s_lshl_b32 s60, s62, 21
    s_add_u32 s60, s60, s61
    s_add_u32 s60, s60, 0x0
    s_add_u32 s36, s100, 0xc000000
    s_addc_u32 s37, s101, 0
    s_and_b32 s37, s37, 0xffff
    s_mov_b32 s38, 0x1000000
    s_mov_b32 s39, s60
    s_mov_b32 s40, 0x800
    s_mov_b32 s41, 0x8000
    s_mov_b32 s42, 0x10000
    s_and_b32 s0, s62, 3
    s_lshl2_add_u32 s0, s63, s0
    s_mov_b64 s[86:87], s[30:31]
    s_lshl_b32 s62, s62, 16
    s_add_u32 s84, s33, s62
    s_cmp_eq_u32 s58, 0
    s_cselect_b32 s84, s84, 0x40000000
    v_bfe_u32 v24, v0, 4, 2
    v_and_b32 v25, 7, v0
    v_xor_b32 v24, v24, v25
    v_lshlrev_b32 v8, 4, v24
    v_bfe_u32 v24, v0, 3, 3
    v_lshl_add_u32 v8, v24, 11, v8
    v_bfe_u32 v24, v0, 6, 2
    v_lshl_add_u32 v8, v24, 16, v8
    v_xor_b32 v9, 64, v8
    v_add_u32 v9, 0x4000, v9
    s_lshr_b32 s61, s58, 1
    s_lshl_b32 s61, s61, 14
    v_add_u32 v10, s61, v1
    s_and_b32 s61, s58, 1
    s_lshl_b32 s61, s61, 12
    v_add_u32 v10, s61, v10
    v_add_u32 v11, 1024, v10
    s_mov_b32 s18, 0xe000000
    s_mov_b32 s4, 12
    s_mov_b32 s3, 12
    s_waitcnt vmcnt(0)
    v_lshlrev_b32 v40, 16, v40
    v_lshlrev_b32 v48, 16, v48
    v_lshlrev_b32 v56, 16, v56
    v_lshlrev_b32 v64, 16, v64
    v_lshlrev_b32 v41, 16, v41
    v_lshlrev_b32 v49, 16, v49
    v_lshlrev_b32 v57, 16, v57
    v_lshlrev_b32 v65, 16, v65
    v_lshlrev_b32 v42, 16, v42
    v_lshlrev_b32 v50, 16, v50
    v_lshlrev_b32 v58, 16, v58
    v_lshlrev_b32 v66, 16, v66
    v_mul_f32 v42, 0x3fb8aa3b, v42
    v_mul_f32 v50, 0x3fb8aa3b, v50
    v_mul_f32 v58, 0x3fb8aa3b, v58
    v_mul_f32 v66, 0x3fb8aa3b, v66
    v_exp_f32 v42, v42
    v_exp_f32 v50, v50
    v_exp_f32 v58, v58
    v_exp_f32 v66, v66
    v_cvt_pk_bf16_f32 v42, 0, v42
    v_cvt_pk_bf16_f32 v50, 0, v50
    v_cvt_pk_bf16_f32 v58, 0, v58
    v_cvt_pk_bf16_f32 v66, 0, v66
    v_mul_f32 v43, v42, v40
    v_mul_f32 v51, v50, v48
    v_mul_f32 v59, v58, v56
    v_mul_f32 v67, v66, v64
    v_mul_f32 v44, v42, v41
    v_mul_f32 v52, v50, v49
    v_mul_f32 v60, v58, v57
    v_mul_f32 v68, v66, v65
    v_mul_f32 v43, 0x3fb8aa3b, v43
    v_mul_f32 v51, 0x3fb8aa3b, v51
    v_mul_f32 v59, 0x3fb8aa3b, v59
    v_mul_f32 v67, 0x3fb8aa3b, v67
    v_exp_f32 v43, v43
    v_exp_f32 v51, v51
    v_exp_f32 v59, v59
    v_exp_f32 v67, v67
    v_mul_f32 v44, 0x3e22f983, v44
    v_mul_f32 v52, 0x3e22f983, v52
    v_mul_f32 v60, 0x3e22f983, v60
    v_mul_f32 v68, 0x3e22f983, v68
    v_fract_f32 v44, v44
    v_fract_f32 v52, v52
    v_fract_f32 v60, v60
    v_fract_f32 v68, v68
    v_cos_f32 v45, v44
    v_cos_f32 v53, v52
    v_cos_f32 v61, v60
    v_cos_f32 v69, v68
    v_sin_f32 v46, v44
    v_sin_f32 v54, v52
    v_sin_f32 v62, v60
    v_sin_f32 v70, v68
    v_mul_f32 v88, v43, v45
    v_mul_f32 v90, v51, v53
    v_mul_f32 v92, v59, v61
    v_mul_f32 v94, v67, v69
    v_mul_f32 v89, v43, v46
    v_mul_f32 v91, v51, v54
    v_mul_f32 v93, v59, v62
    v_mul_f32 v95, v67, v70
    v_add_f32 v45, -1.0, v88
    v_add_f32 v53, -1.0, v90
    v_add_f32 v61, -1.0, v92
    v_add_f32 v69, -1.0, v94
    v_mul_f32 v46, v45, v40
    v_mul_f32 v54, v53, v48
    v_mul_f32 v62, v61, v56
    v_mul_f32 v70, v69, v64
    v_fma_f32 v46, v89, v41, v46
    v_fma_f32 v54, v91, v49, v54
    v_fma_f32 v62, v93, v57, v62
    v_fma_f32 v70, v95, v65, v70
    v_mul_f32 v47, v89, v40
    v_mul_f32 v55, v91, v48
    v_mul_f32 v63, v93, v56
    v_mul_f32 v71, v95, v64
    v_fma_f32 v47, -v45, v41, v47
    v_fma_f32 v55, -v53, v49, v55
    v_fma_f32 v63, -v61, v57, v63
    v_fma_f32 v71, -v69, v65, v71
    v_mul_f32 v43, v40, v40
    v_mul_f32 v51, v48, v48
    v_mul_f32 v59, v56, v56
    v_mul_f32 v67, v64, v64
    v_fma_f32 v43, v41, v41, v43
    v_fma_f32 v51, v49, v49, v51
    v_fma_f32 v59, v57, v57, v59
    v_fma_f32 v67, v65, v65, v67
    v_rcp_f32 v43, v43
    v_rcp_f32 v51, v51
    v_rcp_f32 v59, v59
    v_rcp_f32 v67, v67
    v_add_f32 v43, v43, v43
    v_add_f32 v51, v51, v51
    v_add_f32 v59, v59, v59
    v_add_f32 v67, v67, v67
    v_mul_f32 v96, v46, v43
    v_mul_f32 v98, v54, v51
    v_mul_f32 v100, v62, v59
    v_mul_f32 v102, v70, v67
    v_mul_f32 v97, v47, v43
    v_mul_f32 v99, v55, v51
    v_mul_f32 v101, v63, v59
    v_mul_f32 v103, v71, v67
    v_pk_mul_f32 v[40:41], v[88:89], v[88:89] op_sel:[0,0] op_sel_hi:[0,1]
    v_pk_mul_f32 v[48:49], v[90:91], v[90:91] op_sel:[0,0] op_sel_hi:[0,1]
    v_pk_mul_f32 v[56:57], v[92:93], v[92:93] op_sel:[0,0] op_sel_hi:[0,1]
    v_pk_mul_f32 v[64:65], v[94:95], v[94:95] op_sel:[0,0] op_sel_hi:[0,1]
    v_pk_fma_f32 v[104:105], v[88:89], v[88:89], v[40:41] op_sel:[1,1,0] op_sel_hi:[1,0,1] neg_lo:[1,0,0]
    v_pk_fma_f32 v[106:107], v[90:91], v[90:91], v[48:49] op_sel:[1,1,0] op_sel_hi:[1,0,1] neg_lo:[1,0,0]
    v_pk_fma_f32 v[108:109], v[92:93], v[92:93], v[56:57] op_sel:[1,1,0] op_sel_hi:[1,0,1] neg_lo:[1,0,0]
    v_pk_fma_f32 v[110:111], v[94:95], v[94:95], v[64:65] op_sel:[1,1,0] op_sel_hi:[1,0,1] neg_lo:[1,0,0]
    v_pk_mul_f32 v[40:41], v[104:105], v[104:105] op_sel:[0,0] op_sel_hi:[0,1]
    v_pk_mul_f32 v[48:49], v[106:107], v[106:107] op_sel:[0,0] op_sel_hi:[0,1]
    v_pk_mul_f32 v[56:57], v[108:109], v[108:109] op_sel:[0,0] op_sel_hi:[0,1]
    v_pk_mul_f32 v[64:65], v[110:111], v[110:111] op_sel:[0,0] op_sel_hi:[0,1]
    v_pk_fma_f32 v[104:105], v[104:105], v[104:105], v[40:41] op_sel:[1,1,0] op_sel_hi:[1,0,1] neg_lo:[1,0,0]
    v_pk_fma_f32 v[106:107], v[106:107], v[106:107], v[48:49] op_sel:[1,1,0] op_sel_hi:[1,0,1] neg_lo:[1,0,0]
    v_pk_fma_f32 v[108:109], v[108:109], v[108:109], v[56:57] op_sel:[1,1,0] op_sel_hi:[1,0,1] neg_lo:[1,0,0]
    v_pk_fma_f32 v[110:111], v[110:111], v[110:111], v[64:65] op_sel:[1,1,0] op_sel_hi:[1,0,1] neg_lo:[1,0,0]
    v_pk_mul_f32 v[40:41], v[104:105], v[104:105] op_sel:[0,0] op_sel_hi:[0,1]
    v_pk_mul_f32 v[48:49], v[106:107], v[106:107] op_sel:[0,0] op_sel_hi:[0,1]
    v_pk_mul_f32 v[56:57], v[108:109], v[108:109] op_sel:[0,0] op_sel_hi:[0,1]
    v_pk_mul_f32 v[64:65], v[110:111], v[110:111] op_sel:[0,0] op_sel_hi:[0,1]
    v_pk_fma_f32 v[104:105], v[104:105], v[104:105], v[40:41] op_sel:[1,1,0] op_sel_hi:[1,0,1] neg_lo:[1,0,0]
    v_pk_fma_f32 v[106:107], v[106:107], v[106:107], v[48:49] op_sel:[1,1,0] op_sel_hi:[1,0,1] neg_lo:[1,0,0]
    v_pk_fma_f32 v[108:109], v[108:109], v[108:109], v[56:57] op_sel:[1,1,0] op_sel_hi:[1,0,1] neg_lo:[1,0,0]
    v_pk_fma_f32 v[110:111], v[110:111], v[110:111], v[64:65] op_sel:[1,1,0] op_sel_hi:[1,0,1] neg_lo:[1,0,0]
    v_pk_mul_f32 v[40:41], v[104:105], v[104:105] op_sel:[0,0] op_sel_hi:[0,1]
    v_pk_mul_f32 v[48:49], v[106:107], v[106:107] op_sel:[0,0] op_sel_hi:[0,1]
    v_pk_mul_f32 v[56:57], v[108:109], v[108:109] op_sel:[0,0] op_sel_hi:[0,1]
    v_pk_mul_f32 v[64:65], v[110:111], v[110:111] op_sel:[0,0] op_sel_hi:[0,1]
    v_pk_fma_f32 v[104:105], v[104:105], v[104:105], v[40:41] op_sel:[1,1,0] op_sel_hi:[1,0,1] neg_lo:[1,0,0]
    v_pk_fma_f32 v[106:107], v[106:107], v[106:107], v[48:49] op_sel:[1,1,0] op_sel_hi:[1,0,1] neg_lo:[1,0,0]
    v_pk_fma_f32 v[108:109], v[108:109], v[108:109], v[56:57] op_sel:[1,1,0] op_sel_hi:[1,0,1] neg_lo:[1,0,0]
    v_pk_fma_f32 v[110:111], v[110:111], v[110:111], v[64:65] op_sel:[1,1,0] op_sel_hi:[1,0,1] neg_lo:[1,0,0]
    v_pk_mul_f32 v[40:41], v[104:105], v[104:105] op_sel:[0,0] op_sel_hi:[0,1]
    v_pk_mul_f32 v[48:49], v[106:107], v[106:107] op_sel:[0,0] op_sel_hi:[0,1]
    v_pk_mul_f32 v[56:57], v[108:109], v[108:109] op_sel:[0,0] op_sel_hi:[0,1]
    v_pk_mul_f32 v[64:65], v[110:111], v[110:111] op_sel:[0,0] op_sel_hi:[0,1]
    v_pk_fma_f32 v[104:105], v[104:105], v[104:105], v[40:41] op_sel:[1,1,0] op_sel_hi:[1,0,1] neg_lo:[1,0,0]
    v_pk_fma_f32 v[106:107], v[106:107], v[106:107], v[48:49] op_sel:[1,1,0] op_sel_hi:[1,0,1] neg_lo:[1,0,0]
    v_pk_fma_f32 v[108:109], v[108:109], v[108:109], v[56:57] op_sel:[1,1,0] op_sel_hi:[1,0,1] neg_lo:[1,0,0]
    v_pk_fma_f32 v[110:111], v[110:111], v[110:111], v[64:65] op_sel:[1,1,0] op_sel_hi:[1,0,1] neg_lo:[1,0,0]
    v_pk_mul_f32 v[40:41], v[104:105], v[104:105] op_sel:[0,0] op_sel_hi:[0,1]
    v_pk_mul_f32 v[48:49], v[106:107], v[106:107] op_sel:[0,0] op_sel_hi:[0,1]
    v_pk_mul_f32 v[56:57], v[108:109], v[108:109] op_sel:[0,0] op_sel_hi:[0,1]
    v_pk_mul_f32 v[64:65], v[110:111], v[110:111] op_sel:[0,0] op_sel_hi:[0,1]
    v_pk_fma_f32 v[112:113], v[104:105], v[104:105], v[40:41] op_sel:[1,1,0] op_sel_hi:[1,0,1] neg_lo:[1,0,0]
    v_pk_fma_f32 v[114:115], v[106:107], v[106:107], v[48:49] op_sel:[1,1,0] op_sel_hi:[1,0,1] neg_lo:[1,0,0]
    v_pk_fma_f32 v[116:117], v[108:109], v[108:109], v[56:57] op_sel:[1,1,0] op_sel_hi:[1,0,1] neg_lo:[1,0,0]
    v_pk_fma_f32 v[118:119], v[110:111], v[110:111], v[64:65] op_sel:[1,1,0] op_sel_hi:[1,0,1] neg_lo:[1,0,0]
    v_pk_mul_f32 v[40:41], v[112:113], v[112:113] op_sel:[0,0] op_sel_hi:[0,1]
    v_pk_mul_f32 v[48:49], v[114:115], v[114:115] op_sel:[0,0] op_sel_hi:[0,1]
    v_pk_mul_f32 v[56:57], v[116:117], v[116:117] op_sel:[0,0] op_sel_hi:[0,1]
    v_pk_mul_f32 v[64:65], v[118:119], v[118:119] op_sel:[0,0] op_sel_hi:[0,1]
    v_pk_fma_f32 v[44:45], v[112:113], v[112:113], v[40:41] op_sel:[1,1,0] op_sel_hi:[1,0,1] neg_lo:[1,0,0]
    v_pk_fma_f32 v[52:53], v[114:115], v[114:115], v[48:49] op_sel:[1,1,0] op_sel_hi:[1,0,1] neg_lo:[1,0,0]
    v_pk_fma_f32 v[60:61], v[116:117], v[116:117], v[56:57] op_sel:[1,1,0] op_sel_hi:[1,0,1] neg_lo:[1,0,0]
    v_pk_fma_f32 v[68:69], v[118:119], v[118:119], v[64:65] op_sel:[1,1,0] op_sel_hi:[1,0,1] neg_lo:[1,0,0]
    s_mov_b32 exec_lo, 0xffffffff
    s_mov_b32 exec_hi, 0xffffffff
    v_mov_b32 v120, v44
    v_mov_b32 v121, v45
    s_mov_b32 exec_lo, 0xffff0000
    s_mov_b32 exec_hi, 0xffffffff
    v_mov_b32 v120, v52
    v_mov_b32 v121, v53
    s_mov_b32 exec_lo, 0x0
    s_mov_b32 exec_hi, 0xffffffff
    v_mov_b32 v120, v60
    v_mov_b32 v121, v61
    s_mov_b32 exec_lo, 0x0
    s_mov_b32 exec_hi, 0xffff0000
    v_mov_b32 v120, v68
    v_mov_b32 v121, v69
    s_mov_b64 exec, -1
    s_call_b64 s[54:55], t_g1
    s_call_b64 s[54:55], t_scan
    s_and_b32 s62, s57, 7
    s_lshr_b32 s63, s57, 3
    s_lshl_b32 s60, s63, 19
    s_add_u32 s60, s60, 0
    s_mov_b32 s30, s76
    s_and_b32 s31, s77, 0xffff
    s_mov_b32 s32, 0x200000
    s_mov_b32 s33, s60
    s_mov_b32 s34, 0x8000
    s_mov_b32 s35, 0x40000
    s_lshl_b32 s61, s62, 13
    s_andn2_b32 s61, 0x2000, s61
    s_xor_b32 s61, s61, s59
    s_lshl_b32 s60, s62, 21
    s_add_u32 s60, s60, s61
    s_add_u32 s60, s60, 0x80000
    s_add_u32 s36, s100, 0xc000000
    s_addc_u32 s37, s101, 0
    s_and_b32 s37, s37, 0xffff
    s_mov_b32 s38, 0x1000000
    s_mov_b32 s39, s60
    s_mov_b32 s40, 0x800
    s_mov_b32 s41, 0x8000
    s_mov_b32 s42, 0x10000
    s_and_b32 s0, s62, 3
    s_lshl2_add_u32 s0, s63, s0
    s_mov_b64 s[86:87], s[30:31]
    s_lshl_b32 s62, s62, 16
    s_add_u32 s84, s33, s62
    s_cmp_eq_u32 s58, 0
    s_cselect_b32 s84, s84, 0x40000000
    s_mov_b32 s3, 0
    s_call_b64 s[54:55], t_g2
    s_and_b32 s62, s57, 7
    s_lshr_b32 s63, s57, 3
    s_lshl_b32 s60, s63, 19
    s_add_u32 s60, s60, 1024
    s_mov_b32 s30, s74
    s_and_b32 s31, s75, 0xffff
    s_mov_b32 s32, 0x200000
    s_mov_b32 s33, s60
    s_mov_b32 s34, 0x8000
    s_mov_b32 s35, 0x40000
    s_lshl_b32 s61, s62, 13
    s_andn2_b32 s61, 0x2000, s61
    s_xor_b32 s61, s61, s59
    s_lshl_b32 s60, s62, 21
    s_add_u32 s60, s60, s61
    s_add_u32 s60, s60, 0x100000
    s_add_u32 s36, s100, 0xc000000
    s_addc_u32 s37, s101, 0
    s_and_b32 s37, s37, 0xffff
    s_mov_b32 s38, 0x1000000
    s_mov_b32 s39, s60
    s_mov_b32 s40, 0x800
    s_mov_b32 s41, 0x8000
    s_mov_b32 s42, 0x10000
    s_and_b32 s0, s62, 3
    s_lshl2_add_u32 s0, s63, s0
    s_mov_b64 s[86:87], s[30:31]
    s_lshl_b32 s62, s62, 16
    s_add_u32 s84, s33, s62
    s_cmp_eq_u32 s58, 0
    s_cselect_b32 s84, s84, 0x40000000
    s_mov_b32 s18, 0
    s_cmp_eq_u32 s58, 0
    s_cselect_b32 s1, 16, 0
    s_mov_b32 s3, 16
    s_call_b64 s[54:55], t_g2_c
    s_and_b32 s62, s57, 7
    s_lshr_b32 s63, s57, 3
    s_lshl_b32 s60, s63, 19
    s_add_u32 s60, s60, 1024
    s_mov_b32 s30, s76
    s_and_b32 s31, s77, 0xffff
    s_mov_b32 s32, 0x200000
    s_mov_b32 s33, s60
    s_mov_b32 s34, 0x8000
    s_mov_b32 s35, 0x40000
    s_lshl_b32 s61, s62, 13
    s_andn2_b32 s61, 0x2000, s61
    s_xor_b32 s61, s61, s59
    s_lshl_b32 s60, s62, 21
    s_add_u32 s60, s60, s61
    s_add_u32 s60, s60, 0x180000
    s_add_u32 s36, s100, 0xc000000
    s_addc_u32 s37, s101, 0
    s_and_b32 s37, s37, 0xffff
    s_mov_b32 s38, 0x1000000
    s_mov_b32 s39, s60
    s_mov_b32 s40, 0x800
    s_mov_b32 s41, 0x8000
    s_mov_b32 s42, 0x10000
    s_and_b32 s0, s62, 3
    s_lshl2_add_u32 s0, s63, s0
    s_mov_b64 s[86:87], s[30:31]
    s_lshl_b32 s62, s62, 16
    s_add_u32 s84, s33, s62
    s_cmp_eq_u32 s58, 0
    s_cselect_b32 s84, s84, 0x40000000
    s_mov_b32 s3, 0
    s_call_b64 s[54:55], t_g2_c
    s_mov_b32 s32, 0
    s_mov_b32 s38, 0
    s_mov_b32 s84, 0x40000000
    s_call_b64 s[54:55], t_g2_c
    s_and_b32 s85, s57, 7
    s_lshr_b32 s82, s57, 3
    s_waitcnt vmcnt(0)
    s_barrier
    v_and_b32 v26, 31, v0
    v_bfe_u32 v25, v0, 6, 1
    v_lshl_add_u32 v27, v25, 5, v26
    v_bfe_u32 v28, v0, 5, 1
    v_bfe_u32 v24, v0, 7, 1
    v_lshl_add_u32 v24, v24, 7, v28
    v_lshlrev_b32 v25, 13, v24
    v_lshl_add_u32 v25, v27, 4, v25
    v_lshlrev_b32 v24, 11, v24
    v_lshl_add_u32 v24, v27, 3, v24
    v_lshlrev_b32 v27, 3, v27
    s_mov_b32 s60, s80
    s_and_b32 s61, s81, 0xffff
    s_mov_b32 s62, 0x800
    s_mov_b32 s63, 0x00020000
    s_lshl_b32 s53, s82, 9
    buffer_load_dwordx2 v[44:45], v27, s[60:63], s53 offen
    s_mov_b32 s8, s64
    s_and_b32 s9, s65, 0xffff
    s_mov_b32 s10, 0x400000
    s_mov_b32 s11, 0x00020000
    s_mov_b32 s12, s96
    s_and_b32 s13, s97, 0xffff
    s_mov_b32 s14, 0x1000000
    s_mov_b32 s15, 0x00020000
    s_lshl_b32 s50, s85, 19
    s_add_u32 s50, s50, s53
    s_add_u32 s53, s50, 0x0
    buffer_load_dwordx2 v[128:129], v24, s[8:11], s53 offen
    s_add_u32 s53, s50, 0x1000
    buffer_load_dwordx2 v[130:131], v24, s[8:11], s53 offen
    s_add_u32 s53, s50, 0x2000
    buffer_load_dwordx2 v[132:133], v24, s[8:11], s53 offen
    s_add_u32 s53, s50, 0x3000
    buffer_load_dwordx2 v[134:135], v24, s[8:11], s53 offen
    s_add_u32 s53, s50, 0x10000
    buffer_load_dwordx2 v[136:137], v24, s[8:11], s53 offen
    s_add_u32 s53, s50, 0x11000
    buffer_load_dwordx2 v[138:139], v24, s[8:11], s53 offen
    s_add_u32 s53, s50, 0x12000
    buffer_load_dwordx2 v[140:141], v24, s[8:11], s53 offen
    s_add_u32 s53, s50, 0x13000
    buffer_load_dwordx2 v[142:143], v24, s[8:11], s53 offen
    s_add_u32 s53, s50, 0x20000
    buffer_load_dwordx2 v[144:145], v24, s[8:11], s53 offen
    s_add_u32 s53, s50, 0x21000
    buffer_load_dwordx2 v[146:147], v24, s[8:11], s53 offen
    s_add_u32 s53, s50, 0x22000
    buffer_load_dwordx2 v[148:149], v24, s[8:11], s53 offen
    s_add_u32 s53, s50, 0x23000
    buffer_load_dwordx2 v[150:151], v24, s[8:11], s53 offen
    s_add_u32 s53, s50, 0x30000
    buffer_load_dwordx2 v[152:153], v24, s[8:11], s53 offen
    s_add_u32 s53, s50, 0x31000
    buffer_load_dwordx2 v[154:155], v24, s[8:11], s53 offen
    s_add_u32 s53, s50, 0x32000
    buffer_load_dwordx2 v[156:157], v24, s[8:11], s53 offen
    s_add_u32 s53, s50, 0x33000
    buffer_load_dwordx2 v[158:159], v24, s[8:11], s53 offen
    s_add_u32 s53, s50, 0x4000
    buffer_load_dwordx2 v[160:161], v24, s[8:11], s53 offen
    s_add_u32 s53, s50, 0x5000
    buffer_load_dwordx2 v[162:163], v24, s[8:11], s53 offen
    s_add_u32 s53, s50, 0x6000
    buffer_load_dwordx2 v[164:165], v24, s[8:11], s53 offen
    s_add_u32 s53, s50, 0x7000
    buffer_load_dwordx2 v[166:167], v24, s[8:11], s53 offen
    s_add_u32 s53, s50, 0x14000
    buffer_load_dwordx2 v[168:169], v24, s[8:11], s53 offen
    s_add_u32 s53, s50, 0x15000
    buffer_load_dwordx2 v[170:171], v24, s[8:11], s53 offen
    s_add_u32 s53, s50, 0x16000
    buffer_load_dwordx2 v[172:173], v24, s[8:11], s53 offen
    s_add_u32 s53, s50, 0x17000
    buffer_load_dwordx2 v[174:175], v24, s[8:11], s53 offen
    s_add_u32 s53, s50, 0x24000
    buffer_load_dwordx2 v[176:177], v24, s[8:11], s53 offen
    s_add_u32 s53, s50, 0x25000
    buffer_load_dwordx2 v[178:179], v24, s[8:11], s53 offen
    s_add_u32 s53, s50, 0x26000
    buffer_load_dwordx2 v[180:181], v24, s[8:11], s53 offen
    s_add_u32 s53, s50, 0x27000
    buffer_load_dwordx2 v[182:183], v24, s[8:11], s53 offen
    s_add_u32 s53, s50, 0x34000
    buffer_load_dwordx2 v[184:185], v24, s[8:11], s53 offen
    s_add_u32 s53, s50, 0x35000
    buffer_load_dwordx2 v[186:187], v24, s[8:11], s53 offen
    s_add_u32 s53, s50, 0x36000
    buffer_load_dwordx2 v[188:189], v24, s[8:11], s53 offen
    s_add_u32 s53, s50, 0x37000
    buffer_load_dwordx2 v[190:191], v24, s[8:11], s53 offen
    s_mul_i32 s60, s58, 33792
    v_mul_u32_u24 v28, 528, v28
    v_lshl_add_u32 v28, v26, 4, v28
    v_add_u32 v28, s60, v28
    v_and_b32 v27, 15, v0
    v_mul_u32_u24 v27, 528, v27
    v_bfe_u32 v26, v0, 4, 2
    v_lshl_add_u32 v27, v26, 4, v27
    v_add_u32 v27, s60, v27
    s_lshl_b32 s51, s85, 21
    s_lshl_b32 s52, s82, 10
    s_add_u32 s51, s51, s52
    ds_write_b128 v27, a[0:3] offset:0
    ds_write_b128 v27, a[32:35] offset:64
    ds_write_b128 v27, a[64:67] offset:128
    ds_write_b128 v27, a[96:99] offset:192
    ds_write_b128 v27, a[128:131] offset:256
    ds_write_b128 v27, a[160:163] offset:320
    ds_write_b128 v27, a[192:195] offset:384
    ds_write_b128 v27, a[224:227] offset:448
    ds_read_b128 v[48:51], v28 offset:0
    ds_read_b128 v[52:55], v28 offset:1056
    ds_read_b128 v[56:59], v28 offset:2112
    ds_read_b128 v[60:63], v28 offset:3168
    ds_read_b128 v[64:67], v28 offset:4224
    ds_read_b128 v[68:71], v28 offset:5280
    ds_read_b128 v[72:75], v28 offset:6336
    ds_read_b128 v[76:79], v28 offset:7392
    ds_write_b128 v27, a[4:7] offset:8448
    ds_write_b128 v27, a[36:39] offset:8512
    ds_write_b128 v27, a[68:71] offset:8576
    ds_write_b128 v27, a[100:103] offset:8640
    ds_write_b128 v27, a[132:135] offset:8704
    ds_write_b128 v27, a[164:167] offset:8768
    ds_write_b128 v27, a[196:199] offset:8832
    ds_write_b128 v27, a[228:231] offset:8896
    s_waitcnt vmcnt(32)
    v_lshlrev_b32 v40, 16, v44
    v_and_b32 v41, 0xffff0000, v44
    v_lshlrev_b32 v42, 16, v45
    v_and_b32 v43, 0xffff0000, v45
    s_waitcnt vmcnt(24) lgkmcnt(8)
    ds_read_b128 v[80:83], v28 offset:8448
    ds_read_b128 v[84:87], v28 offset:9504
    ds_read_b128 v[88:91], v28 offset:10560
    ds_read_b128 v[92:95], v28 offset:11616
    ds_read_b128 v[96:99], v28 offset:12672
    ds_read_b128 v[100:103], v28 offset:13728
    ds_read_b128 v[104:107], v28 offset:14784
    ds_read_b128 v[108:111], v28 offset:15840
    ds_write_b128 v27, a[8:11] offset:16896
    ds_write_b128 v27, a[40:43] offset:16960
    ds_write_b128 v27, a[72:75] offset:17024
    ds_write_b128 v27, a[104:107] offset:17088
    ds_write_b128 v27, a[136:139] offset:17152
    ds_write_b128 v27, a[168:171] offset:17216
    ds_write_b128 v27, a[200:203] offset:17280
    ds_write_b128 v27, a[232:235] offset:17344
    v_lshlrev_b32 v112, 16, v128
    v_and_b32 v113, 0xffff0000, v128
    v_lshlrev_b32 v114, 16, v129
    v_and_b32 v115, 0xffff0000, v129
    v_pk_mul_f32 v[112:113], v[112:113], v[40:41]
    v_pk_mul_f32 v[114:115], v[114:115], v[42:43]
    s_add_u32 s52, s51, 0x0
    v_cvt_pk_bf16_f32 v112, 0, v112
    v_cvt_pk_bf16_f32 v113, 0, v113
    v_cvt_pk_bf16_f32 v114, 0, v114
    v_cvt_pk_bf16_f32 v115, 0, v115
    v_pk_add_f32 v[48:49], v[48:49], v[112:113]
    v_pk_add_f32 v[50:51], v[50:51], v[114:115]
    buffer_store_dwordx4 v[48:51], v25, s[12:15], s52 offen
    v_lshlrev_b32 v116, 16, v130
    v_and_b32 v117, 0xffff0000, v130
    v_lshlrev_b32 v118, 16, v131
    v_and_b32 v119, 0xffff0000, v131
    v_pk_mul_f32 v[116:117], v[116:117], v[40:41]
    v_pk_mul_f32 v[118:119], v[118:119], v[42:43]
    s_add_u32 s52, s51, 0x4000
    v_cvt_pk_bf16_f32 v116, 0, v116
    v_cvt_pk_bf16_f32 v117, 0, v117
    v_cvt_pk_bf16_f32 v118, 0, v118
    v_cvt_pk_bf16_f32 v119, 0, v119
    v_pk_add_f32 v[52:53], v[52:53], v[116:117]
    v_pk_add_f32 v[54:55], v[54:55], v[118:119]
    buffer_store_dwordx4 v[52:55], v25, s[12:15], s52 offen
    v_lshlrev_b32 v112, 16, v132
    v_and_b32 v113, 0xffff0000, v132
    v_lshlrev_b32 v114, 16, v133
    v_and_b32 v115, 0xffff0000, v133
    v_pk_mul_f32 v[112:113], v[112:113], v[40:41]
    v_pk_mul_f32 v[114:115], v[114:115], v[42:43]
    s_add_u32 s52, s51, 0x8000
    v_cvt_pk_bf16_f32 v112, 0, v112
    v_cvt_pk_bf16_f32 v113, 0, v113
    v_cvt_pk_bf16_f32 v114, 0, v114
    v_cvt_pk_bf16_f32 v115, 0, v115
    v_pk_add_f32 v[56:57], v[56:57], v[112:113]
    v_pk_add_f32 v[58:59], v[58:59], v[114:115]
    buffer_store_dwordx4 v[56:59], v25, s[12:15], s52 offen
    v_lshlrev_b32 v116, 16, v134
    v_and_b32 v117, 0xffff0000, v134
    v_lshlrev_b32 v118, 16, v135
    v_and_b32 v119, 0xffff0000, v135
    v_pk_mul_f32 v[116:117], v[116:117], v[40:41]
    v_pk_mul_f32 v[118:119], v[118:119], v[42:43]
    s_add_u32 s52, s51, 0xc000
    v_cvt_pk_bf16_f32 v116, 0, v116
    v_cvt_pk_bf16_f32 v117, 0, v117
    v_cvt_pk_bf16_f32 v118, 0, v118
    v_cvt_pk_bf16_f32 v119, 0, v119
    v_pk_add_f32 v[60:61], v[60:61], v[116:117]
    v_pk_add_f32 v[62:63], v[62:63], v[118:119]
    buffer_store_dwordx4 v[60:63], v25, s[12:15], s52 offen
    v_lshlrev_b32 v112, 16, v136
    v_and_b32 v113, 0xffff0000, v136
    v_lshlrev_b32 v114, 16, v137
    v_and_b32 v115, 0xffff0000, v137
    v_pk_mul_f32 v[112:113], v[112:113], v[40:41]
    v_pk_mul_f32 v[114:115], v[114:115], v[42:43]
    s_add_u32 s52, s51, 0x40000
    v_cvt_pk_bf16_f32 v112, 0, v112
    v_cvt_pk_bf16_f32 v113, 0, v113
    v_cvt_pk_bf16_f32 v114, 0, v114
    v_cvt_pk_bf16_f32 v115, 0, v115
    v_pk_add_f32 v[64:65], v[64:65], v[112:113]
    v_pk_add_f32 v[66:67], v[66:67], v[114:115]
    buffer_store_dwordx4 v[64:67], v25, s[12:15], s52 offen
    v_lshlrev_b32 v116, 16, v138
    v_and_b32 v117, 0xffff0000, v138
    v_lshlrev_b32 v118, 16, v139
    v_and_b32 v119, 0xffff0000, v139
    v_pk_mul_f32 v[116:117], v[116:117], v[40:41]
    v_pk_mul_f32 v[118:119], v[118:119], v[42:43]
    s_add_u32 s52, s51, 0x44000
    v_cvt_pk_bf16_f32 v116, 0, v116
    v_cvt_pk_bf16_f32 v117, 0, v117
    v_cvt_pk_bf16_f32 v118, 0, v118
    v_cvt_pk_bf16_f32 v119, 0, v119
    v_pk_add_f32 v[68:69], v[68:69], v[116:117]
    v_pk_add_f32 v[70:71], v[70:71], v[118:119]
    buffer_store_dwordx4 v[68:71], v25, s[12:15], s52 offen
    v_lshlrev_b32 v112, 16, v140
    v_and_b32 v113, 0xffff0000, v140
    v_lshlrev_b32 v114, 16, v141
    v_and_b32 v115, 0xffff0000, v141
    v_pk_mul_f32 v[112:113], v[112:113], v[40:41]
    v_pk_mul_f32 v[114:115], v[114:115], v[42:43]
    s_add_u32 s52, s51, 0x48000
    v_cvt_pk_bf16_f32 v112, 0, v112
    v_cvt_pk_bf16_f32 v113, 0, v113
    v_cvt_pk_bf16_f32 v114, 0, v114
    v_cvt_pk_bf16_f32 v115, 0, v115
    v_pk_add_f32 v[72:73], v[72:73], v[112:113]
    v_pk_add_f32 v[74:75], v[74:75], v[114:115]
    buffer_store_dwordx4 v[72:75], v25, s[12:15], s52 offen
    v_lshlrev_b32 v116, 16, v142
    v_and_b32 v117, 0xffff0000, v142
    v_lshlrev_b32 v118, 16, v143
    v_and_b32 v119, 0xffff0000, v143
    v_pk_mul_f32 v[116:117], v[116:117], v[40:41]
    v_pk_mul_f32 v[118:119], v[118:119], v[42:43]
    s_add_u32 s52, s51, 0x4c000
    v_cvt_pk_bf16_f32 v116, 0, v116
    v_cvt_pk_bf16_f32 v117, 0, v117
    v_cvt_pk_bf16_f32 v118, 0, v118
    v_cvt_pk_bf16_f32 v119, 0, v119
    v_pk_add_f32 v[76:77], v[76:77], v[116:117]
    v_pk_add_f32 v[78:79], v[78:79], v[118:119]
    buffer_store_dwordx4 v[76:79], v25, s[12:15], s52 offen
    s_add_u32 s53, s50, 0x8000
    buffer_load_dwordx2 v[192:193], v24, s[8:11], s53 offen
    s_add_u32 s53, s50, 0x9000
    buffer_load_dwordx2 v[194:195], v24, s[8:11], s53 offen
    s_add_u32 s53, s50, 0xa000
    buffer_load_dwordx2 v[196:197], v24, s[8:11], s53 offen
    s_add_u32 s53, s50, 0xb000
    buffer_load_dwordx2 v[198:199], v24, s[8:11], s53 offen
    s_add_u32 s53, s50, 0x18000
    buffer_load_dwordx2 v[200:201], v24, s[8:11], s53 offen
    s_add_u32 s53, s50, 0x19000
    buffer_load_dwordx2 v[202:203], v24, s[8:11], s53 offen
    s_add_u32 s53, s50, 0x1a000
    buffer_load_dwordx2 v[204:205], v24, s[8:11], s53 offen
    s_add_u32 s53, s50, 0x1b000
    buffer_load_dwordx2 v[206:207], v24, s[8:11], s53 offen
    s_waitcnt vmcnt(32) lgkmcnt(8)
    ds_read_b128 v[48:51], v28 offset:16896
    ds_read_b128 v[52:55], v28 offset:17952
    ds_read_b128 v[56:59], v28 offset:19008
    ds_read_b128 v[60:63], v28 offset:20064
    ds_read_b128 v[64:67], v28 offset:21120
    ds_read_b128 v[68:71], v28 offset:22176
    ds_read_b128 v[72:75], v28 offset:23232
    ds_read_b128 v[76:79], v28 offset:24288
    ds_write_b128 v27, a[12:15] offset:25344
    ds_write_b128 v27, a[44:47] offset:25408
    ds_write_b128 v27, a[76:79] offset:25472
    ds_write_b128 v27, a[108:111] offset:25536
    ds_write_b128 v27, a[140:143] offset:25600
    ds_write_b128 v27, a[172:175] offset:25664
    ds_write_b128 v27, a[204:207] offset:25728
    ds_write_b128 v27, a[236:239] offset:25792
    v_lshlrev_b32 v112, 16, v144
    v_and_b32 v113, 0xffff0000, v144
    v_lshlrev_b32 v114, 16, v145
    v_and_b32 v115, 0xffff0000, v145
    v_pk_mul_f32 v[112:113], v[112:113], v[40:41]
    v_pk_mul_f32 v[114:115], v[114:115], v[42:43]
    s_add_u32 s52, s51, 0x80000
    v_cvt_pk_bf16_f32 v112, 0, v112
    v_cvt_pk_bf16_f32 v113, 0, v113
    v_cvt_pk_bf16_f32 v114, 0, v114
    v_cvt_pk_bf16_f32 v115, 0, v115
    v_pk_add_f32 v[80:81], v[80:81], v[112:113]
    v_pk_add_f32 v[82:83], v[82:83], v[114:115]
    buffer_store_dwordx4 v[80:83], v25, s[12:15], s52 offen
    v_lshlrev_b32 v116, 16, v146
    v_and_b32 v117, 0xffff0000, v146
    v_lshlrev_b32 v118, 16, v147
    v_and_b32 v119, 0xffff0000, v147
    v_pk_mul_f32 v[116:117], v[116:117], v[40:41]
    v_pk_mul_f32 v[118:119], v[118:119], v[42:43]
    s_add_u32 s52, s51, 0x84000
    v_cvt_pk_bf16_f32 v116, 0, v116
    v_cvt_pk_bf16_f32 v117, 0, v117
    v_cvt_pk_bf16_f32 v118, 0, v118
    v_cvt_pk_bf16_f32 v119, 0, v119
    v_pk_add_f32 v[84:85], v[84:85], v[116:117]
    v_pk_add_f32 v[86:87], v[86:87], v[118:119]
    buffer_store_dwordx4 v[84:87], v25, s[12:15], s52 offen
    v_lshlrev_b32 v112, 16, v148
    v_and_b32 v113, 0xffff0000, v148
    v_lshlrev_b32 v114, 16, v149
    v_and_b32 v115, 0xffff0000, v149
    v_pk_mul_f32 v[112:113], v[112:113], v[40:41]
    v_pk_mul_f32 v[114:115], v[114:115], v[42:43]
    s_add_u32 s52, s51, 0x88000
    v_cvt_pk_bf16_f32 v112, 0, v112
    v_cvt_pk_bf16_f32 v113, 0, v113
    v_cvt_pk_bf16_f32 v114, 0, v114
    v_cvt_pk_bf16_f32 v115, 0, v115
    v_pk_add_f32 v[88:89], v[88:89], v[112:113]
    v_pk_add_f32 v[90:91], v[90:91], v[114:115]
    buffer_store_dwordx4 v[88:91], v25, s[12:15], s52 offen
    v_lshlrev_b32 v116, 16, v150
    v_and_b32 v117, 0xffff0000, v150
    v_lshlrev_b32 v118, 16, v151
    v_and_b32 v119, 0xffff0000, v151
    v_pk_mul_f32 v[116:117], v[116:117], v[40:41]
    v_pk_mul_f32 v[118:119], v[118:119], v[42:43]
    s_add_u32 s52, s51, 0x8c000
    v_cvt_pk_bf16_f32 v116, 0, v116
    v_cvt_pk_bf16_f32 v117, 0, v117
    v_cvt_pk_bf16_f32 v118, 0, v118
    v_cvt_pk_bf16_f32 v119, 0, v119
    v_pk_add_f32 v[92:93], v[92:93], v[116:117]
    v_pk_add_f32 v[94:95], v[94:95], v[118:119]
    buffer_store_dwordx4 v[92:95], v25, s[12:15], s52 offen
    v_lshlrev_b32 v112, 16, v152
    v_and_b32 v113, 0xffff0000, v152
    v_lshlrev_b32 v114, 16, v153
    v_and_b32 v115, 0xffff0000, v153
    v_pk_mul_f32 v[112:113], v[112:113], v[40:41]
    v_pk_mul_f32 v[114:115], v[114:115], v[42:43]
    s_add_u32 s52, s51, 0xc0000
    v_cvt_pk_bf16_f32 v112, 0, v112
    v_cvt_pk_bf16_f32 v113, 0, v113
    v_cvt_pk_bf16_f32 v114, 0, v114
    v_cvt_pk_bf16_f32 v115, 0, v115
    v_pk_add_f32 v[96:97], v[96:97], v[112:113]
    v_pk_add_f32 v[98:99], v[98:99], v[114:115]
    buffer_store_dwordx4 v[96:99], v25, s[12:15], s52 offen
    v_lshlrev_b32 v116, 16, v154
    v_and_b32 v117, 0xffff0000, v154
    v_lshlrev_b32 v118, 16, v155
    v_and_b32 v119, 0xffff0000, v155
    v_pk_mul_f32 v[116:117], v[116:117], v[40:41]
    v_pk_mul_f32 v[118:119], v[118:119], v[42:43]
    s_add_u32 s52, s51, 0xc4000
    v_cvt_pk_bf16_f32 v116, 0, v116
    v_cvt_pk_bf16_f32 v117, 0, v117
    v_cvt_pk_bf16_f32 v118, 0, v118
    v_cvt_pk_bf16_f32 v119, 0, v119
    v_pk_add_f32 v[100:101], v[100:101], v[116:117]
    v_pk_add_f32 v[102:103], v[102:103], v[118:119]
    buffer_store_dwordx4 v[100:103], v25, s[12:15], s52 offen
    v_lshlrev_b32 v112, 16, v156
    v_and_b32 v113, 0xffff0000, v156
    v_lshlrev_b32 v114, 16, v157
    v_and_b32 v115, 0xffff0000, v157
    v_pk_mul_f32 v[112:113], v[112:113], v[40:41]
    v_pk_mul_f32 v[114:115], v[114:115], v[42:43]
    s_add_u32 s52, s51, 0xc8000
    v_cvt_pk_bf16_f32 v112, 0, v112
    v_cvt_pk_bf16_f32 v113, 0, v113
    v_cvt_pk_bf16_f32 v114, 0, v114
    v_cvt_pk_bf16_f32 v115, 0, v115
    v_pk_add_f32 v[104:105], v[104:105], v[112:113]
    v_pk_add_f32 v[106:107], v[106:107], v[114:115]
    buffer_store_dwordx4 v[104:107], v25, s[12:15], s52 offen
    v_lshlrev_b32 v116, 16, v158
    v_and_b32 v117, 0xffff0000, v158
    v_lshlrev_b32 v118, 16, v159
    v_and_b32 v119, 0xffff0000, v159
    v_pk_mul_f32 v[116:117], v[116:117], v[40:41]
    v_pk_mul_f32 v[118:119], v[118:119], v[42:43]
    s_add_u32 s52, s51, 0xcc000
    v_cvt_pk_bf16_f32 v116, 0, v116
    v_cvt_pk_bf16_f32 v117, 0, v117
    v_cvt_pk_bf16_f32 v118, 0, v118
    v_cvt_pk_bf16_f32 v119, 0, v119
    v_pk_add_f32 v[108:109], v[108:109], v[116:117]
    v_pk_add_f32 v[110:111], v[110:111], v[118:119]
    buffer_store_dwordx4 v[108:111], v25, s[12:15], s52 offen
    s_add_u32 s53, s50, 0x28000
    buffer_load_dwordx2 v[208:209], v24, s[8:11], s53 offen
    s_add_u32 s53, s50, 0x29000
    buffer_load_dwordx2 v[210:211], v24, s[8:11], s53 offen
    s_add_u32 s53, s50, 0x2a000
    buffer_load_dwordx2 v[212:213], v24, s[8:11], s53 offen
    s_add_u32 s53, s50, 0x2b000
    buffer_load_dwordx2 v[214:215], v24, s[8:11], s53 offen
    s_add_u32 s53, s50, 0x38000
    buffer_load_dwordx2 v[216:217], v24, s[8:11], s53 offen
    s_add_u32 s53, s50, 0x39000
    buffer_load_dwordx2 v[218:219], v24, s[8:11], s53 offen
    s_add_u32 s53, s50, 0x3a000
    buffer_load_dwordx2 v[220:221], v24, s[8:11], s53 offen
    s_add_u32 s53, s50, 0x3b000
    buffer_load_dwordx2 v[222:223], v24, s[8:11], s53 offen
    s_waitcnt vmcnt(40) lgkmcnt(8)
    ds_read_b128 v[80:83], v28 offset:25344
    ds_read_b128 v[84:87], v28 offset:26400
    ds_read_b128 v[88:91], v28 offset:27456
    ds_read_b128 v[92:95], v28 offset:28512
    ds_read_b128 v[96:99], v28 offset:29568
    ds_read_b128 v[100:103], v28 offset:30624
    ds_read_b128 v[104:107], v28 offset:31680
    ds_read_b128 v[108:111], v28 offset:32736
    ds_write_b128 v27, a[16:19] offset:0
    ds_write_b128 v27, a[48:51] offset:64
    ds_write_b128 v27, a[80:83] offset:128
    ds_write_b128 v27, a[112:115] offset:192
    ds_write_b128 v27, a[144:147] offset:256
    ds_write_b128 v27, a[176:179] offset:320
    ds_write_b128 v27, a[208:211] offset:384
    ds_write_b128 v27, a[240:243] offset:448
    v_lshlrev_b32 v112, 16, v160
    v_and_b32 v113, 0xffff0000, v160
    v_lshlrev_b32 v114, 16, v161
    v_and_b32 v115, 0xffff0000, v161
    v_pk_mul_f32 v[112:113], v[112:113], v[40:41]
    v_pk_mul_f32 v[114:115], v[114:115], v[42:43]
    s_add_u32 s52, s51, 0x10000
    v_cvt_pk_bf16_f32 v112, 0, v112
    v_cvt_pk_bf16_f32 v113, 0, v113
    v_cvt_pk_bf16_f32 v114, 0, v114
    v_cvt_pk_bf16_f32 v115, 0, v115
    v_pk_add_f32 v[48:49], v[48:49], v[112:113]
    v_pk_add_f32 v[50:51], v[50:51], v[114:115]
    buffer_store_dwordx4 v[48:51], v25, s[12:15], s52 offen
    v_lshlrev_b32 v116, 16, v162
    v_and_b32 v117, 0xffff0000, v162
    v_lshlrev_b32 v118, 16, v163
    v_and_b32 v119, 0xffff0000, v163
    v_pk_mul_f32 v[116:117], v[116:117], v[40:41]
    v_pk_mul_f32 v[118:119], v[118:119], v[42:43]
    s_add_u32 s52, s51, 0x14000
    v_cvt_pk_bf16_f32 v116, 0, v116
    v_cvt_pk_bf16_f32 v117, 0, v117
    v_cvt_pk_bf16_f32 v118, 0, v118
    v_cvt_pk_bf16_f32 v119, 0, v119
    v_pk_add_f32 v[52:53], v[52:53], v[116:117]
    v_pk_add_f32 v[54:55], v[54:55], v[118:119]
    buffer_store_dwordx4 v[52:55], v25, s[12:15], s52 offen
    v_lshlrev_b32 v112, 16, v164
    v_and_b32 v113, 0xffff0000, v164
    v_lshlrev_b32 v114, 16, v165
    v_and_b32 v115, 0xffff0000, v165
    v_pk_mul_f32 v[112:113], v[112:113], v[40:41]
    v_pk_mul_f32 v[114:115], v[114:115], v[42:43]
    s_add_u32 s52, s51, 0x18000
    v_cvt_pk_bf16_f32 v112, 0, v112
    v_cvt_pk_bf16_f32 v113, 0, v113
    v_cvt_pk_bf16_f32 v114, 0, v114
    v_cvt_pk_bf16_f32 v115, 0, v115
    v_pk_add_f32 v[56:57], v[56:57], v[112:113]
    v_pk_add_f32 v[58:59], v[58:59], v[114:115]
    buffer_store_dwordx4 v[56:59], v25, s[12:15], s52 offen
    v_lshlrev_b32 v116, 16, v166
    v_and_b32 v117, 0xffff0000, v166
    v_lshlrev_b32 v118, 16, v167
    v_and_b32 v119, 0xffff0000, v167
    v_pk_mul_f32 v[116:117], v[116:117], v[40:41]
    v_pk_mul_f32 v[118:119], v[118:119], v[42:43]
    s_add_u32 s52, s51, 0x1c000
    v_cvt_pk_bf16_f32 v116, 0, v116
    v_cvt_pk_bf16_f32 v117, 0, v117
    v_cvt_pk_bf16_f32 v118, 0, v118
    v_cvt_pk_bf16_f32 v119, 0, v119
    v_pk_add_f32 v[60:61], v[60:61], v[116:117]
    v_pk_add_f32 v[62:63], v[62:63], v[118:119]
    buffer_store_dwordx4 v[60:63], v25, s[12:15], s52 offen
    v_lshlrev_b32 v112, 16, v168
    v_and_b32 v113, 0xffff0000, v168
    v_lshlrev_b32 v114, 16, v169
    v_and_b32 v115, 0xffff0000, v169
    v_pk_mul_f32 v[112:113], v[112:113], v[40:41]
    v_pk_mul_f32 v[114:115], v[114:115], v[42:43]
    s_add_u32 s52, s51, 0x50000
    v_cvt_pk_bf16_f32 v112, 0, v112
    v_cvt_pk_bf16_f32 v113, 0, v113
    v_cvt_pk_bf16_f32 v114, 0, v114
    v_cvt_pk_bf16_f32 v115, 0, v115
    v_pk_add_f32 v[64:65], v[64:65], v[112:113]
    v_pk_add_f32 v[66:67], v[66:67], v[114:115]
    buffer_store_dwordx4 v[64:67], v25, s[12:15], s52 offen
    v_lshlrev_b32 v116, 16, v170
    v_and_b32 v117, 0xffff0000, v170
    v_lshlrev_b32 v118, 16, v171
    v_and_b32 v119, 0xffff0000, v171
    v_pk_mul_f32 v[116:117], v[116:117], v[40:41]
    v_pk_mul_f32 v[118:119], v[118:119], v[42:43]
    s_add_u32 s52, s51, 0x54000
    v_cvt_pk_bf16_f32 v116, 0, v116
    v_cvt_pk_bf16_f32 v117, 0, v117
    v_cvt_pk_bf16_f32 v118, 0, v118
    v_cvt_pk_bf16_f32 v119, 0, v119
    v_pk_add_f32 v[68:69], v[68:69], v[116:117]
    v_pk_add_f32 v[70:71], v[70:71], v[118:119]
    buffer_store_dwordx4 v[68:71], v25, s[12:15], s52 offen
    v_lshlrev_b32 v112, 16, v172
    v_and_b32 v113, 0xffff0000, v172
    v_lshlrev_b32 v114, 16, v173
    v_and_b32 v115, 0xffff0000, v173
    v_pk_mul_f32 v[112:113], v[112:113], v[40:41]
    v_pk_mul_f32 v[114:115], v[114:115], v[42:43]
    s_add_u32 s52, s51, 0x58000
    v_cvt_pk_bf16_f32 v112, 0, v112
    v_cvt_pk_bf16_f32 v113, 0, v113
    v_cvt_pk_bf16_f32 v114, 0, v114
    v_cvt_pk_bf16_f32 v115, 0, v115
    v_pk_add_f32 v[72:73], v[72:73], v[112:113]
    v_pk_add_f32 v[74:75], v[74:75], v[114:115]
    buffer_store_dwordx4 v[72:75], v25, s[12:15], s52 offen
    v_lshlrev_b32 v116, 16, v174
    v_and_b32 v117, 0xffff0000, v174
    v_lshlrev_b32 v118, 16, v175
    v_and_b32 v119, 0xffff0000, v175
    v_pk_mul_f32 v[116:117], v[116:117], v[40:41]
    v_pk_mul_f32 v[118:119], v[118:119], v[42:43]
    s_add_u32 s52, s51, 0x5c000
    v_cvt_pk_bf16_f32 v116, 0, v116
    v_cvt_pk_bf16_f32 v117, 0, v117
    v_cvt_pk_bf16_f32 v118, 0, v118
    v_cvt_pk_bf16_f32 v119, 0, v119
    v_pk_add_f32 v[76:77], v[76:77], v[116:117]
    v_pk_add_f32 v[78:79], v[78:79], v[118:119]
    buffer_store_dwordx4 v[76:79], v25, s[12:15], s52 offen
    s_add_u32 s53, s50, 0xc000
    buffer_load_dwordx2 v[224:225], v24, s[8:11], s53 offen
    s_add_u32 s53, s50, 0xd000
    buffer_load_dwordx2 v[226:227], v24, s[8:11], s53 offen
    s_add_u32 s53, s50, 0xe000
    buffer_load_dwordx2 v[228:229], v24, s[8:11], s53 offen
    s_add_u32 s53, s50, 0xf000
    buffer_load_dwordx2 v[230:231], v24, s[8:11], s53 offen
    s_add_u32 s53, s50, 0x1c000
    buffer_load_dwordx2 v[232:233], v24, s[8:11], s53 offen
    s_add_u32 s53, s50, 0x1d000
    buffer_load_dwordx2 v[234:235], v24, s[8:11], s53 offen
    s_add_u32 s53, s50, 0x1e000
    buffer_load_dwordx2 v[236:237], v24, s[8:11], s53 offen
    s_add_u32 s53, s50, 0x1f000
    buffer_load_dwordx2 v[238:239], v24, s[8:11], s53 offen
    s_waitcnt vmcnt(48) lgkmcnt(8)
    ds_read_b128 v[48:51], v28 offset:0
    ds_read_b128 v[52:55], v28 offset:1056
    ds_read_b128 v[56:59], v28 offset:2112
    ds_read_b128 v[60:63], v28 offset:3168
    ds_read_b128 v[64:67], v28 offset:4224
    ds_read_b128 v[68:71], v28 offset:5280
    ds_read_b128 v[72:75], v28 offset:6336
    ds_read_b128 v[76:79], v28 offset:7392
    ds_write_b128 v27, a[20:23] offset:8448
    ds_write_b128 v27, a[52:55] offset:8512
    ds_write_b128 v27, a[84:87] offset:8576
    ds_write_b128 v27, a[116:119] offset:8640
    ds_write_b128 v27, a[148:151] offset:8704
    ds_write_b128 v27, a[180:183] offset:8768
    ds_write_b128 v27, a[212:215] offset:8832
    ds_write_b128 v27, a[244:247] offset:8896
    v_lshlrev_b32 v112, 16, v176
    v_and_b32 v113, 0xffff0000, v176
    v_lshlrev_b32 v114, 16, v177
    v_and_b32 v115, 0xffff0000, v177
    v_pk_mul_f32 v[112:113], v[112:113], v[40:41]
    v_pk_mul_f32 v[114:115], v[114:115], v[42:43]
    s_add_u32 s52, s51, 0x90000
    v_cvt_pk_bf16_f32 v112, 0, v112
    v_cvt_pk_bf16_f32 v113, 0, v113
    v_cvt_pk_bf16_f32 v114, 0, v114
    v_cvt_pk_bf16_f32 v115, 0, v115
    v_pk_add_f32 v[80:81], v[80:81], v[112:113]
    v_pk_add_f32 v[82:83], v[82:83], v[114:115]
    buffer_store_dwordx4 v[80:83], v25, s[12:15], s52 offen
    v_lshlrev_b32 v116, 16, v178
    v_and_b32 v117, 0xffff0000, v178
    v_lshlrev_b32 v118, 16, v179
    v_and_b32 v119, 0xffff0000, v179
    v_pk_mul_f32 v[116:117], v[116:117], v[40:41]
    v_pk_mul_f32 v[118:119], v[118:119], v[42:43]
    s_add_u32 s52, s51, 0x94000
    v_cvt_pk_bf16_f32 v116, 0, v116
    v_cvt_pk_bf16_f32 v117, 0, v117
    v_cvt_pk_bf16_f32 v118, 0, v118
    v_cvt_pk_bf16_f32 v119, 0, v119
    v_pk_add_f32 v[84:85], v[84:85], v[116:117]
    v_pk_add_f32 v[86:87], v[86:87], v[118:119]
    buffer_store_dwordx4 v[84:87], v25, s[12:15], s52 offen
    v_lshlrev_b32 v112, 16, v180
    v_and_b32 v113, 0xffff0000, v180
    v_lshlrev_b32 v114, 16, v181
    v_and_b32 v115, 0xffff0000, v181
    v_pk_mul_f32 v[112:113], v[112:113], v[40:41]
    v_pk_mul_f32 v[114:115], v[114:115], v[42:43]
    s_add_u32 s52, s51, 0x98000
    v_cvt_pk_bf16_f32 v112, 0, v112
    v_cvt_pk_bf16_f32 v113, 0, v113
    v_cvt_pk_bf16_f32 v114, 0, v114
    v_cvt_pk_bf16_f32 v115, 0, v115
    v_pk_add_f32 v[88:89], v[88:89], v[112:113]
    v_pk_add_f32 v[90:91], v[90:91], v[114:115]
    buffer_store_dwordx4 v[88:91], v25, s[12:15], s52 offen
    v_lshlrev_b32 v116, 16, v182
    v_and_b32 v117, 0xffff0000, v182
    v_lshlrev_b32 v118, 16, v183
    v_and_b32 v119, 0xffff0000, v183
    v_pk_mul_f32 v[116:117], v[116:117], v[40:41]
    v_pk_mul_f32 v[118:119], v[118:119], v[42:43]
    s_add_u32 s52, s51, 0x9c000
    v_cvt_pk_bf16_f32 v116, 0, v116
    v_cvt_pk_bf16_f32 v117, 0, v117
    v_cvt_pk_bf16_f32 v118, 0, v118
    v_cvt_pk_bf16_f32 v119, 0, v119
    v_pk_add_f32 v[92:93], v[92:93], v[116:117]
    v_pk_add_f32 v[94:95], v[94:95], v[118:119]
    buffer_store_dwordx4 v[92:95], v25, s[12:15], s52 offen
    v_lshlrev_b32 v112, 16, v184
    v_and_b32 v113, 0xffff0000, v184
    v_lshlrev_b32 v114, 16, v185
    v_and_b32 v115, 0xffff0000, v185
    v_pk_mul_f32 v[112:113], v[112:113], v[40:41]
    v_pk_mul_f32 v[114:115], v[114:115], v[42:43]
    s_add_u32 s52, s51, 0xd0000
    v_cvt_pk_bf16_f32 v112, 0, v112
    v_cvt_pk_bf16_f32 v113, 0, v113
    v_cvt_pk_bf16_f32 v114, 0, v114
    v_cvt_pk_bf16_f32 v115, 0, v115
    v_pk_add_f32 v[96:97], v[96:97], v[112:113]
    v_pk_add_f32 v[98:99], v[98:99], v[114:115]
    buffer_store_dwordx4 v[96:99], v25, s[12:15], s52 offen
    v_lshlrev_b32 v116, 16, v186
    v_and_b32 v117, 0xffff0000, v186
    v_lshlrev_b32 v118, 16, v187
    v_and_b32 v119, 0xffff0000, v187
    v_pk_mul_f32 v[116:117], v[116:117], v[40:41]
    v_pk_mul_f32 v[118:119], v[118:119], v[42:43]
    s_add_u32 s52, s51, 0xd4000
    v_cvt_pk_bf16_f32 v116, 0, v116
    v_cvt_pk_bf16_f32 v117, 0, v117
    v_cvt_pk_bf16_f32 v118, 0, v118
    v_cvt_pk_bf16_f32 v119, 0, v119
    v_pk_add_f32 v[100:101], v[100:101], v[116:117]
    v_pk_add_f32 v[102:103], v[102:103], v[118:119]
    buffer_store_dwordx4 v[100:103], v25, s[12:15], s52 offen
    v_lshlrev_b32 v112, 16, v188
    v_and_b32 v113, 0xffff0000, v188
    v_lshlrev_b32 v114, 16, v189
    v_and_b32 v115, 0xffff0000, v189
    v_pk_mul_f32 v[112:113], v[112:113], v[40:41]
    v_pk_mul_f32 v[114:115], v[114:115], v[42:43]
    s_add_u32 s52, s51, 0xd8000
    v_cvt_pk_bf16_f32 v112, 0, v112
    v_cvt_pk_bf16_f32 v113, 0, v113
    v_cvt_pk_bf16_f32 v114, 0, v114
    v_cvt_pk_bf16_f32 v115, 0, v115
    v_pk_add_f32 v[104:105], v[104:105], v[112:113]
    v_pk_add_f32 v[106:107], v[106:107], v[114:115]
    buffer_store_dwordx4 v[104:107], v25, s[12:15], s52 offen
    v_lshlrev_b32 v116, 16, v190
    v_and_b32 v117, 0xffff0000, v190
    v_lshlrev_b32 v118, 16, v191
    v_and_b32 v119, 0xffff0000, v191
    v_pk_mul_f32 v[116:117], v[116:117], v[40:41]
    v_pk_mul_f32 v[118:119], v[118:119], v[42:43]
    s_add_u32 s52, s51, 0xdc000
    v_cvt_pk_bf16_f32 v116, 0, v116
    v_cvt_pk_bf16_f32 v117, 0, v117
    v_cvt_pk_bf16_f32 v118, 0, v118
    v_cvt_pk_bf16_f32 v119, 0, v119
    v_pk_add_f32 v[108:109], v[108:109], v[116:117]
    v_pk_add_f32 v[110:111], v[110:111], v[118:119]
    buffer_store_dwordx4 v[108:111], v25, s[12:15], s52 offen
    s_add_u32 s53, s50, 0x2c000
    buffer_load_dwordx2 v[240:241], v24, s[8:11], s53 offen
    s_add_u32 s53, s50, 0x2d000
    buffer_load_dwordx2 v[242:243], v24, s[8:11], s53 offen
    s_add_u32 s53, s50, 0x2e000
    buffer_load_dwordx2 v[244:245], v24, s[8:11], s53 offen
    s_add_u32 s53, s50, 0x2f000
    buffer_load_dwordx2 v[246:247], v24, s[8:11], s53 offen
    s_add_u32 s53, s50, 0x3c000
    buffer_load_dwordx2 v[248:249], v24, s[8:11], s53 offen
    s_add_u32 s53, s50, 0x3d000
    buffer_load_dwordx2 v[250:251], v24, s[8:11], s53 offen
    s_add_u32 s53, s50, 0x3e000
    buffer_load_dwordx2 v[252:253], v24, s[8:11], s53 offen
    s_add_u32 s53, s50, 0x3f000
    buffer_load_dwordx2 v[254:255], v24, s[8:11], s53 offen
    s_waitcnt vmcnt(48) lgkmcnt(8)
    ds_read_b128 v[80:83], v28 offset:8448
    ds_read_b128 v[84:87], v28 offset:9504
    ds_read_b128 v[88:91], v28 offset:10560
    ds_read_b128 v[92:95], v28 offset:11616
    ds_read_b128 v[96:99], v28 offset:12672
    ds_read_b128 v[100:103], v28 offset:13728
    ds_read_b128 v[104:107], v28 offset:14784
    ds_read_b128 v[108:111], v28 offset:15840
    ds_write_b128 v27, a[24:27] offset:16896
    ds_write_b128 v27, a[56:59] offset:16960
    ds_write_b128 v27, a[88:91] offset:17024
    ds_write_b128 v27, a[120:123] offset:17088
    ds_write_b128 v27, a[152:155] offset:17152
    ds_write_b128 v27, a[184:187] offset:17216
    ds_write_b128 v27, a[216:219] offset:17280
    ds_write_b128 v27, a[248:251] offset:17344
    v_lshlrev_b32 v112, 16, v192
    v_and_b32 v113, 0xffff0000, v192
    v_lshlrev_b32 v114, 16, v193
    v_and_b32 v115, 0xffff0000, v193
    v_pk_mul_f32 v[112:113], v[112:113], v[40:41]
    v_pk_mul_f32 v[114:115], v[114:115], v[42:43]
    s_add_u32 s52, s51, 0x20000
    v_cvt_pk_bf16_f32 v112, 0, v112
    v_cvt_pk_bf16_f32 v113, 0, v113
    v_cvt_pk_bf16_f32 v114, 0, v114
    v_cvt_pk_bf16_f32 v115, 0, v115
    v_pk_add_f32 v[48:49], v[48:49], v[112:113]
    v_pk_add_f32 v[50:51], v[50:51], v[114:115]
    buffer_store_dwordx4 v[48:51], v25, s[12:15], s52 offen
    v_lshlrev_b32 v116, 16, v194
    v_and_b32 v117, 0xffff0000, v194
    v_lshlrev_b32 v118, 16, v195
    v_and_b32 v119, 0xffff0000, v195
    v_pk_mul_f32 v[116:117], v[116:117], v[40:41]
    v_pk_mul_f32 v[118:119], v[118:119], v[42:43]
    s_add_u32 s52, s51, 0x24000
    v_cvt_pk_bf16_f32 v116, 0, v116
    v_cvt_pk_bf16_f32 v117, 0, v117
    v_cvt_pk_bf16_f32 v118, 0, v118
    v_cvt_pk_bf16_f32 v119, 0, v119
    v_pk_add_f32 v[52:53], v[52:53], v[116:117]
    v_pk_add_f32 v[54:55], v[54:55], v[118:119]
    buffer_store_dwordx4 v[52:55], v25, s[12:15], s52 offen
    v_lshlrev_b32 v112, 16, v196
    v_and_b32 v113, 0xffff0000, v196
    v_lshlrev_b32 v114, 16, v197
    v_and_b32 v115, 0xffff0000, v197
    v_pk_mul_f32 v[112:113], v[112:113], v[40:41]
    v_pk_mul_f32 v[114:115], v[114:115], v[42:43]
    s_add_u32 s52, s51, 0x28000
    v_cvt_pk_bf16_f32 v112, 0, v112
    v_cvt_pk_bf16_f32 v113, 0, v113
    v_cvt_pk_bf16_f32 v114, 0, v114
    v_cvt_pk_bf16_f32 v115, 0, v115
    v_pk_add_f32 v[56:57], v[56:57], v[112:113]
    v_pk_add_f32 v[58:59], v[58:59], v[114:115]
    buffer_store_dwordx4 v[56:59], v25, s[12:15], s52 offen
    v_lshlrev_b32 v116, 16, v198
    v_and_b32 v117, 0xffff0000, v198
    v_lshlrev_b32 v118, 16, v199
    v_and_b32 v119, 0xffff0000, v199
    v_pk_mul_f32 v[116:117], v[116:117], v[40:41]
    v_pk_mul_f32 v[118:119], v[118:119], v[42:43]
    s_add_u32 s52, s51, 0x2c000
    v_cvt_pk_bf16_f32 v116, 0, v116
    v_cvt_pk_bf16_f32 v117, 0, v117
    v_cvt_pk_bf16_f32 v118, 0, v118
    v_cvt_pk_bf16_f32 v119, 0, v119
    v_pk_add_f32 v[60:61], v[60:61], v[116:117]
    v_pk_add_f32 v[62:63], v[62:63], v[118:119]
    buffer_store_dwordx4 v[60:63], v25, s[12:15], s52 offen
    v_lshlrev_b32 v112, 16, v200
    v_and_b32 v113, 0xffff0000, v200
    v_lshlrev_b32 v114, 16, v201
    v_and_b32 v115, 0xffff0000, v201
    v_pk_mul_f32 v[112:113], v[112:113], v[40:41]
    v_pk_mul_f32 v[114:115], v[114:115], v[42:43]
    s_add_u32 s52, s51, 0x60000
    v_cvt_pk_bf16_f32 v112, 0, v112
    v_cvt_pk_bf16_f32 v113, 0, v113
    v_cvt_pk_bf16_f32 v114, 0, v114
    v_cvt_pk_bf16_f32 v115, 0, v115
    v_pk_add_f32 v[64:65], v[64:65], v[112:113]
    v_pk_add_f32 v[66:67], v[66:67], v[114:115]
    buffer_store_dwordx4 v[64:67], v25, s[12:15], s52 offen
    v_lshlrev_b32 v116, 16, v202
    v_and_b32 v117, 0xffff0000, v202
    v_lshlrev_b32 v118, 16, v203
    v_and_b32 v119, 0xffff0000, v203
    v_pk_mul_f32 v[116:117], v[116:117], v[40:41]
    v_pk_mul_f32 v[118:119], v[118:119], v[42:43]
    s_add_u32 s52, s51, 0x64000
    v_cvt_pk_bf16_f32 v116, 0, v116
    v_cvt_pk_bf16_f32 v117, 0, v117
    v_cvt_pk_bf16_f32 v118, 0, v118
    v_cvt_pk_bf16_f32 v119, 0, v119
    v_pk_add_f32 v[68:69], v[68:69], v[116:117]
    v_pk_add_f32 v[70:71], v[70:71], v[118:119]
    buffer_store_dwordx4 v[68:71], v25, s[12:15], s52 offen
    v_lshlrev_b32 v112, 16, v204
    v_and_b32 v113, 0xffff0000, v204
    v_lshlrev_b32 v114, 16, v205
    v_and_b32 v115, 0xffff0000, v205
    v_pk_mul_f32 v[112:113], v[112:113], v[40:41]
    v_pk_mul_f32 v[114:115], v[114:115], v[42:43]
    s_add_u32 s52, s51, 0x68000
    v_cvt_pk_bf16_f32 v112, 0, v112
    v_cvt_pk_bf16_f32 v113, 0, v113
    v_cvt_pk_bf16_f32 v114, 0, v114
    v_cvt_pk_bf16_f32 v115, 0, v115
    v_pk_add_f32 v[72:73], v[72:73], v[112:113]
    v_pk_add_f32 v[74:75], v[74:75], v[114:115]
    buffer_store_dwordx4 v[72:75], v25, s[12:15], s52 offen
    v_lshlrev_b32 v116, 16, v206
    v_and_b32 v117, 0xffff0000, v206
    v_lshlrev_b32 v118, 16, v207
    v_and_b32 v119, 0xffff0000, v207
    v_pk_mul_f32 v[116:117], v[116:117], v[40:41]
    v_pk_mul_f32 v[118:119], v[118:119], v[42:43]
    s_add_u32 s52, s51, 0x6c000
    v_cvt_pk_bf16_f32 v116, 0, v116
    v_cvt_pk_bf16_f32 v117, 0, v117
    v_cvt_pk_bf16_f32 v118, 0, v118
    v_cvt_pk_bf16_f32 v119, 0, v119
    v_pk_add_f32 v[76:77], v[76:77], v[116:117]
    v_pk_add_f32 v[78:79], v[78:79], v[118:119]
    buffer_store_dwordx4 v[76:79], v25, s[12:15], s52 offen
    s_waitcnt vmcnt(40) lgkmcnt(8)
    ds_read_b128 v[48:51], v28 offset:16896
    ds_read_b128 v[52:55], v28 offset:17952
    ds_read_b128 v[56:59], v28 offset:19008
    ds_read_b128 v[60:63], v28 offset:20064
    ds_read_b128 v[64:67], v28 offset:21120
    ds_read_b128 v[68:71], v28 offset:22176
    ds_read_b128 v[72:75], v28 offset:23232
    ds_read_b128 v[76:79], v28 offset:24288
    ds_write_b128 v27, a[28:31] offset:25344
    ds_write_b128 v27, a[60:63] offset:25408
    ds_write_b128 v27, a[92:95] offset:25472
    ds_write_b128 v27, a[124:127] offset:25536
    ds_write_b128 v27, a[156:159] offset:25600
    ds_write_b128 v27, a[188:191] offset:25664
    ds_write_b128 v27, a[220:223] offset:25728
    ds_write_b128 v27, a[252:255] offset:25792
    v_lshlrev_b32 v112, 16, v208
    v_and_b32 v113, 0xffff0000, v208
    v_lshlrev_b32 v114, 16, v209
    v_and_b32 v115, 0xffff0000, v209
    v_pk_mul_f32 v[112:113], v[112:113], v[40:41]
    v_pk_mul_f32 v[114:115], v[114:115], v[42:43]
    s_add_u32 s52, s51, 0xa0000
    v_cvt_pk_bf16_f32 v112, 0, v112
    v_cvt_pk_bf16_f32 v113, 0, v113
    v_cvt_pk_bf16_f32 v114, 0, v114
    v_cvt_pk_bf16_f32 v115, 0, v115
    v_pk_add_f32 v[80:81], v[80:81], v[112:113]
    v_pk_add_f32 v[82:83], v[82:83], v[114:115]
    buffer_store_dwordx4 v[80:83], v25, s[12:15], s52 offen
    v_lshlrev_b32 v116, 16, v210
    v_and_b32 v117, 0xffff0000, v210
    v_lshlrev_b32 v118, 16, v211
    v_and_b32 v119, 0xffff0000, v211
    v_pk_mul_f32 v[116:117], v[116:117], v[40:41]
    v_pk_mul_f32 v[118:119], v[118:119], v[42:43]
    s_add_u32 s52, s51, 0xa4000
    v_cvt_pk_bf16_f32 v116, 0, v116
    v_cvt_pk_bf16_f32 v117, 0, v117
    v_cvt_pk_bf16_f32 v118, 0, v118
    v_cvt_pk_bf16_f32 v119, 0, v119
    v_pk_add_f32 v[84:85], v[84:85], v[116:117]
    v_pk_add_f32 v[86:87], v[86:87], v[118:119]
    buffer_store_dwordx4 v[84:87], v25, s[12:15], s52 offen
    v_lshlrev_b32 v112, 16, v212
    v_and_b32 v113, 0xffff0000, v212
    v_lshlrev_b32 v114, 16, v213
    v_and_b32 v115, 0xffff0000, v213
    v_pk_mul_f32 v[112:113], v[112:113], v[40:41]
    v_pk_mul_f32 v[114:115], v[114:115], v[42:43]
    s_add_u32 s52, s51, 0xa8000
    v_cvt_pk_bf16_f32 v112, 0, v112
    v_cvt_pk_bf16_f32 v113, 0, v113
    v_cvt_pk_bf16_f32 v114, 0, v114
    v_cvt_pk_bf16_f32 v115, 0, v115
    v_pk_add_f32 v[88:89], v[88:89], v[112:113]
    v_pk_add_f32 v[90:91], v[90:91], v[114:115]
    buffer_store_dwordx4 v[88:91], v25, s[12:15], s52 offen
    v_lshlrev_b32 v116, 16, v214
    v_and_b32 v117, 0xffff0000, v214
    v_lshlrev_b32 v118, 16, v215
    v_and_b32 v119, 0xffff0000, v215
    v_pk_mul_f32 v[116:117], v[116:117], v[40:41]
    v_pk_mul_f32 v[118:119], v[118:119], v[42:43]
    s_add_u32 s52, s51, 0xac000
    v_cvt_pk_bf16_f32 v116, 0, v116
    v_cvt_pk_bf16_f32 v117, 0, v117
    v_cvt_pk_bf16_f32 v118, 0, v118
    v_cvt_pk_bf16_f32 v119, 0, v119
    v_pk_add_f32 v[92:93], v[92:93], v[116:117]
    v_pk_add_f32 v[94:95], v[94:95], v[118:119]
    buffer_store_dwordx4 v[92:95], v25, s[12:15], s52 offen
    v_lshlrev_b32 v112, 16, v216
    v_and_b32 v113, 0xffff0000, v216
    v_lshlrev_b32 v114, 16, v217
    v_and_b32 v115, 0xffff0000, v217
    v_pk_mul_f32 v[112:113], v[112:113], v[40:41]
    v_pk_mul_f32 v[114:115], v[114:115], v[42:43]
    s_add_u32 s52, s51, 0xe0000
    v_cvt_pk_bf16_f32 v112, 0, v112
    v_cvt_pk_bf16_f32 v113, 0, v113
    v_cvt_pk_bf16_f32 v114, 0, v114
    v_cvt_pk_bf16_f32 v115, 0, v115
    v_pk_add_f32 v[96:97], v[96:97], v[112:113]
    v_pk_add_f32 v[98:99], v[98:99], v[114:115]
    buffer_store_dwordx4 v[96:99], v25, s[12:15], s52 offen
    v_lshlrev_b32 v116, 16, v218
    v_and_b32 v117, 0xffff0000, v218
    v_lshlrev_b32 v118, 16, v219
    v_and_b32 v119, 0xffff0000, v219
    v_pk_mul_f32 v[116:117], v[116:117], v[40:41]
    v_pk_mul_f32 v[118:119], v[118:119], v[42:43]
    s_add_u32 s52, s51, 0xe4000
    v_cvt_pk_bf16_f32 v116, 0, v116
    v_cvt_pk_bf16_f32 v117, 0, v117
    v_cvt_pk_bf16_f32 v118, 0, v118
    v_cvt_pk_bf16_f32 v119, 0, v119
    v_pk_add_f32 v[100:101], v[100:101], v[116:117]
    v_pk_add_f32 v[102:103], v[102:103], v[118:119]
    buffer_store_dwordx4 v[100:103], v25, s[12:15], s52 offen
    v_lshlrev_b32 v112, 16, v220
    v_and_b32 v113, 0xffff0000, v220
    v_lshlrev_b32 v114, 16, v221
    v_and_b32 v115, 0xffff0000, v221
    v_pk_mul_f32 v[112:113], v[112:113], v[40:41]
    v_pk_mul_f32 v[114:115], v[114:115], v[42:43]
    s_add_u32 s52, s51, 0xe8000
    v_cvt_pk_bf16_f32 v112, 0, v112
    v_cvt_pk_bf16_f32 v113, 0, v113
    v_cvt_pk_bf16_f32 v114, 0, v114
    v_cvt_pk_bf16_f32 v115, 0, v115
    v_pk_add_f32 v[104:105], v[104:105], v[112:113]
    v_pk_add_f32 v[106:107], v[106:107], v[114:115]
    buffer_store_dwordx4 v[104:107], v25, s[12:15], s52 offen
    v_lshlrev_b32 v116, 16, v222
    v_and_b32 v117, 0xffff0000, v222
    v_lshlrev_b32 v118, 16, v223
    v_and_b32 v119, 0xffff0000, v223
    v_pk_mul_f32 v[116:117], v[116:117], v[40:41]
    v_pk_mul_f32 v[118:119], v[118:119], v[42:43]
    s_add_u32 s52, s51, 0xec000
    v_cvt_pk_bf16_f32 v116, 0, v116
    v_cvt_pk_bf16_f32 v117, 0, v117
    v_cvt_pk_bf16_f32 v118, 0, v118
    v_cvt_pk_bf16_f32 v119, 0, v119
    v_pk_add_f32 v[108:109], v[108:109], v[116:117]
    v_pk_add_f32 v[110:111], v[110:111], v[118:119]
    buffer_store_dwordx4 v[108:111], v25, s[12:15], s52 offen
    s_waitcnt vmcnt(32) lgkmcnt(8)
    ds_read_b128 v[80:83], v28 offset:25344
    ds_read_b128 v[84:87], v28 offset:26400
    ds_read_b128 v[88:91], v28 offset:27456
    ds_read_b128 v[92:95], v28 offset:28512
    ds_read_b128 v[96:99], v28 offset:29568
    ds_read_b128 v[100:103], v28 offset:30624
    ds_read_b128 v[104:107], v28 offset:31680
    ds_read_b128 v[108:111], v28 offset:32736
    v_lshlrev_b32 v112, 16, v224
    v_and_b32 v113, 0xffff0000, v224
    v_lshlrev_b32 v114, 16, v225
    v_and_b32 v115, 0xffff0000, v225
    v_pk_mul_f32 v[112:113], v[112:113], v[40:41]
    v_pk_mul_f32 v[114:115], v[114:115], v[42:43]
    s_add_u32 s52, s51, 0x30000
    v_cvt_pk_bf16_f32 v112, 0, v112
    v_cvt_pk_bf16_f32 v113, 0, v113
    v_cvt_pk_bf16_f32 v114, 0, v114
    v_cvt_pk_bf16_f32 v115, 0, v115
    v_pk_add_f32 v[48:49], v[48:49], v[112:113]
    v_pk_add_f32 v[50:51], v[50:51], v[114:115]
    buffer_store_dwordx4 v[48:51], v25, s[12:15], s52 offen
    v_lshlrev_b32 v116, 16, v226
    v_and_b32 v117, 0xffff0000, v226
    v_lshlrev_b32 v118, 16, v227
    v_and_b32 v119, 0xffff0000, v227
    v_pk_mul_f32 v[116:117], v[116:117], v[40:41]
    v_pk_mul_f32 v[118:119], v[118:119], v[42:43]
    s_add_u32 s52, s51, 0x34000
    v_cvt_pk_bf16_f32 v116, 0, v116
    v_cvt_pk_bf16_f32 v117, 0, v117
    v_cvt_pk_bf16_f32 v118, 0, v118
    v_cvt_pk_bf16_f32 v119, 0, v119
    v_pk_add_f32 v[52:53], v[52:53], v[116:117]
    v_pk_add_f32 v[54:55], v[54:55], v[118:119]
    buffer_store_dwordx4 v[52:55], v25, s[12:15], s52 offen
    v_lshlrev_b32 v112, 16, v228
    v_and_b32 v113, 0xffff0000, v228
    v_lshlrev_b32 v114, 16, v229
    v_and_b32 v115, 0xffff0000, v229
    v_pk_mul_f32 v[112:113], v[112:113], v[40:41]
    v_pk_mul_f32 v[114:115], v[114:115], v[42:43]
    s_add_u32 s52, s51, 0x38000
    v_cvt_pk_bf16_f32 v112, 0, v112
    v_cvt_pk_bf16_f32 v113, 0, v113
    v_cvt_pk_bf16_f32 v114, 0, v114
    v_cvt_pk_bf16_f32 v115, 0, v115
    v_pk_add_f32 v[56:57], v[56:57], v[112:113]
    v_pk_add_f32 v[58:59], v[58:59], v[114:115]
    buffer_store_dwordx4 v[56:59], v25, s[12:15], s52 offen
    v_lshlrev_b32 v116, 16, v230
    v_and_b32 v117, 0xffff0000, v230
    v_lshlrev_b32 v118, 16, v231
    v_and_b32 v119, 0xffff0000, v231
    v_pk_mul_f32 v[116:117], v[116:117], v[40:41]
    v_pk_mul_f32 v[118:119], v[118:119], v[42:43]
    s_add_u32 s52, s51, 0x3c000
    v_cvt_pk_bf16_f32 v116, 0, v116
    v_cvt_pk_bf16_f32 v117, 0, v117
    v_cvt_pk_bf16_f32 v118, 0, v118
    v_cvt_pk_bf16_f32 v119, 0, v119
    v_pk_add_f32 v[60:61], v[60:61], v[116:117]
    v_pk_add_f32 v[62:63], v[62:63], v[118:119]
    buffer_store_dwordx4 v[60:63], v25, s[12:15], s52 offen
    v_lshlrev_b32 v112, 16, v232
    v_and_b32 v113, 0xffff0000, v232
    v_lshlrev_b32 v114, 16, v233
    v_and_b32 v115, 0xffff0000, v233
    v_pk_mul_f32 v[112:113], v[112:113], v[40:41]
    v_pk_mul_f32 v[114:115], v[114:115], v[42:43]
    s_add_u32 s52, s51, 0x70000
    v_cvt_pk_bf16_f32 v112, 0, v112
    v_cvt_pk_bf16_f32 v113, 0, v113
    v_cvt_pk_bf16_f32 v114, 0, v114
    v_cvt_pk_bf16_f32 v115, 0, v115
    v_pk_add_f32 v[64:65], v[64:65], v[112:113]
    v_pk_add_f32 v[66:67], v[66:67], v[114:115]
    buffer_store_dwordx4 v[64:67], v25, s[12:15], s52 offen
    v_lshlrev_b32 v116, 16, v234
    v_and_b32 v117, 0xffff0000, v234
    v_lshlrev_b32 v118, 16, v235
    v_and_b32 v119, 0xffff0000, v235
    v_pk_mul_f32 v[116:117], v[116:117], v[40:41]
    v_pk_mul_f32 v[118:119], v[118:119], v[42:43]
    s_add_u32 s52, s51, 0x74000
    v_cvt_pk_bf16_f32 v116, 0, v116
    v_cvt_pk_bf16_f32 v117, 0, v117
    v_cvt_pk_bf16_f32 v118, 0, v118
    v_cvt_pk_bf16_f32 v119, 0, v119
    v_pk_add_f32 v[68:69], v[68:69], v[116:117]
    v_pk_add_f32 v[70:71], v[70:71], v[118:119]
    buffer_store_dwordx4 v[68:71], v25, s[12:15], s52 offen
    v_lshlrev_b32 v112, 16, v236
    v_and_b32 v113, 0xffff0000, v236
    v_lshlrev_b32 v114, 16, v237
    v_and_b32 v115, 0xffff0000, v237
    v_pk_mul_f32 v[112:113], v[112:113], v[40:41]
    v_pk_mul_f32 v[114:115], v[114:115], v[42:43]
    s_add_u32 s52, s51, 0x78000
    v_cvt_pk_bf16_f32 v112, 0, v112
    v_cvt_pk_bf16_f32 v113, 0, v113
    v_cvt_pk_bf16_f32 v114, 0, v114
    v_cvt_pk_bf16_f32 v115, 0, v115
    v_pk_add_f32 v[72:73], v[72:73], v[112:113]
    v_pk_add_f32 v[74:75], v[74:75], v[114:115]
    buffer_store_dwordx4 v[72:75], v25, s[12:15], s52 offen
    v_lshlrev_b32 v116, 16, v238
    v_and_b32 v117, 0xffff0000, v238
    v_lshlrev_b32 v118, 16, v239
    v_and_b32 v119, 0xffff0000, v239
    v_pk_mul_f32 v[116:117], v[116:117], v[40:41]
    v_pk_mul_f32 v[118:119], v[118:119], v[42:43]
    s_add_u32 s52, s51, 0x7c000
    v_cvt_pk_bf16_f32 v116, 0, v116
    v_cvt_pk_bf16_f32 v117, 0, v117
    v_cvt_pk_bf16_f32 v118, 0, v118
    v_cvt_pk_bf16_f32 v119, 0, v119
    v_pk_add_f32 v[76:77], v[76:77], v[116:117]
    v_pk_add_f32 v[78:79], v[78:79], v[118:119]
    buffer_store_dwordx4 v[76:79], v25, s[12:15], s52 offen
    s_waitcnt vmcnt(24) lgkmcnt(0)
    v_lshlrev_b32 v112, 16, v240
    v_and_b32 v113, 0xffff0000, v240
    v_lshlrev_b32 v114, 16, v241
    v_and_b32 v115, 0xffff0000, v241
    v_pk_mul_f32 v[112:113], v[112:113], v[40:41]
    v_pk_mul_f32 v[114:115], v[114:115], v[42:43]
    s_add_u32 s52, s51, 0xb0000
    v_cvt_pk_bf16_f32 v112, 0, v112
    v_cvt_pk_bf16_f32 v113, 0, v113
    v_cvt_pk_bf16_f32 v114, 0, v114
    v_cvt_pk_bf16_f32 v115, 0, v115
    v_pk_add_f32 v[80:81], v[80:81], v[112:113]
    v_pk_add_f32 v[82:83], v[82:83], v[114:115]
    buffer_store_dwordx4 v[80:83], v25, s[12:15], s52 offen
    v_lshlrev_b32 v116, 16, v242
    v_and_b32 v117, 0xffff0000, v242
    v_lshlrev_b32 v118, 16, v243
    v_and_b32 v119, 0xffff0000, v243
    v_pk_mul_f32 v[116:117], v[116:117], v[40:41]
    v_pk_mul_f32 v[118:119], v[118:119], v[42:43]
    s_add_u32 s52, s51, 0xb4000
    v_cvt_pk_bf16_f32 v116, 0, v116
    v_cvt_pk_bf16_f32 v117, 0, v117
    v_cvt_pk_bf16_f32 v118, 0, v118
    v_cvt_pk_bf16_f32 v119, 0, v119
    v_pk_add_f32 v[84:85], v[84:85], v[116:117]
    v_pk_add_f32 v[86:87], v[86:87], v[118:119]
    buffer_store_dwordx4 v[84:87], v25, s[12:15], s52 offen
    v_lshlrev_b32 v112, 16, v244
    v_and_b32 v113, 0xffff0000, v244
    v_lshlrev_b32 v114, 16, v245
    v_and_b32 v115, 0xffff0000, v245
    v_pk_mul_f32 v[112:113], v[112:113], v[40:41]
    v_pk_mul_f32 v[114:115], v[114:115], v[42:43]
    s_add_u32 s52, s51, 0xb8000
    v_cvt_pk_bf16_f32 v112, 0, v112
    v_cvt_pk_bf16_f32 v113, 0, v113
    v_cvt_pk_bf16_f32 v114, 0, v114
    v_cvt_pk_bf16_f32 v115, 0, v115
    v_pk_add_f32 v[88:89], v[88:89], v[112:113]
    v_pk_add_f32 v[90:91], v[90:91], v[114:115]
    buffer_store_dwordx4 v[88:91], v25, s[12:15], s52 offen
    v_lshlrev_b32 v116, 16, v246
    v_and_b32 v117, 0xffff0000, v246
    v_lshlrev_b32 v118, 16, v247
    v_and_b32 v119, 0xffff0000, v247
    v_pk_mul_f32 v[116:117], v[116:117], v[40:41]
    v_pk_mul_f32 v[118:119], v[118:119], v[42:43]
    s_add_u32 s52, s51, 0xbc000
    v_cvt_pk_bf16_f32 v116, 0, v116
    v_cvt_pk_bf16_f32 v117, 0, v117
    v_cvt_pk_bf16_f32 v118, 0, v118
    v_cvt_pk_bf16_f32 v119, 0, v119
    v_pk_add_f32 v[92:93], v[92:93], v[116:117]
    v_pk_add_f32 v[94:95], v[94:95], v[118:119]
    buffer_store_dwordx4 v[92:95], v25, s[12:15], s52 offen
    v_lshlrev_b32 v112, 16, v248
    v_and_b32 v113, 0xffff0000, v248
    v_lshlrev_b32 v114, 16, v249
    v_and_b32 v115, 0xffff0000, v249
    v_pk_mul_f32 v[112:113], v[112:113], v[40:41]
    v_pk_mul_f32 v[114:115], v[114:115], v[42:43]
    s_add_u32 s52, s51, 0xf0000
    v_cvt_pk_bf16_f32 v112, 0, v112
    v_cvt_pk_bf16_f32 v113, 0, v113
    v_cvt_pk_bf16_f32 v114, 0, v114
    v_cvt_pk_bf16_f32 v115, 0, v115
    v_pk_add_f32 v[96:97], v[96:97], v[112:113]
    v_pk_add_f32 v[98:99], v[98:99], v[114:115]
    buffer_store_dwordx4 v[96:99], v25, s[12:15], s52 offen
    v_lshlrev_b32 v116, 16, v250
    v_and_b32 v117, 0xffff0000, v250
    v_lshlrev_b32 v118, 16, v251
    v_and_b32 v119, 0xffff0000, v251
    v_pk_mul_f32 v[116:117], v[116:117], v[40:41]
    v_pk_mul_f32 v[118:119], v[118:119], v[42:43]
    s_add_u32 s52, s51, 0xf4000
    v_cvt_pk_bf16_f32 v116, 0, v116
    v_cvt_pk_bf16_f32 v117, 0, v117
    v_cvt_pk_bf16_f32 v118, 0, v118
    v_cvt_pk_bf16_f32 v119, 0, v119
    v_pk_add_f32 v[100:101], v[100:101], v[116:117]
    v_pk_add_f32 v[102:103], v[102:103], v[118:119]
    buffer_store_dwordx4 v[100:103], v25, s[12:15], s52 offen
    v_lshlrev_b32 v112, 16, v252
    v_and_b32 v113, 0xffff0000, v252
    v_lshlrev_b32 v114, 16, v253
    v_and_b32 v115, 0xffff0000, v253
    v_pk_mul_f32 v[112:113], v[112:113], v[40:41]
    v_pk_mul_f32 v[114:115], v[114:115], v[42:43]
    s_add_u32 s52, s51, 0xf8000
    v_cvt_pk_bf16_f32 v112, 0, v112
    v_cvt_pk_bf16_f32 v113, 0, v113
    v_cvt_pk_bf16_f32 v114, 0, v114
    v_cvt_pk_bf16_f32 v115, 0, v115
    v_pk_add_f32 v[104:105], v[104:105], v[112:113]
    v_pk_add_f32 v[106:107], v[106:107], v[114:115]
    buffer_store_dwordx4 v[104:107], v25, s[12:15], s52 offen
    v_lshlrev_b32 v116, 16, v254
    v_and_b32 v117, 0xffff0000, v254
    v_lshlrev_b32 v118, 16, v255
    v_and_b32 v119, 0xffff0000, v255
    v_pk_mul_f32 v[116:117], v[116:117], v[40:41]
    v_pk_mul_f32 v[118:119], v[118:119], v[42:43]
    s_add_u32 s52, s51, 0xfc000
    v_cvt_pk_bf16_f32 v116, 0, v116
    v_cvt_pk_bf16_f32 v117, 0, v117
    v_cvt_pk_bf16_f32 v118, 0, v118
    v_cvt_pk_bf16_f32 v119, 0, v119
    v_pk_add_f32 v[108:109], v[108:109], v[116:117]
    v_pk_add_f32 v[110:111], v[110:111], v[118:119]
    buffer_store_dwordx4 v[108:111], v25, s[12:15], s52 offen
chain_kernel_seg:
    s_xor_b32 s57, s57, 2
    s_waitcnt vmcnt(0) lgkmcnt(0)
    s_barrier
    s_mov_b32 s12, s92
    s_and_b32 s13, s93, 0xffff
    s_mov_b32 s14, 0x800000
    s_mov_b32 s15, 0x00020000
    s_lshr_b32 s60, s57, 3
    s_lshl_b32 s28, s60, 21
    s_and_b32 s60, s57, 7
    s_lshl_b32 s60, s60, 8
    s_add_u32 s28, s28, s60
    v_bfe_u32 v24, v0, 4, 3
    v_lshlrev_b32 v24, 1, v24
    v_and_b32 v25, 15, v0
    v_xor_b32 v24, v24, v25
    v_lshlrev_b32 v6, 4, v24
    v_bfe_u32 v24, v0, 4, 2
    v_lshl_add_u32 v6, v24, 11, v6
    v_bfe_u32 v24, v0, 6, 1
    v_lshl_add_u32 v6, v24, 13, v6
    v_bfe_u32 v24, v0, 7, 1
    v_lshl_add_u32 v6, v24, 15, v6
    s_and_b32 s60, s58, 1
    s_lshl_b32 s61, s60, 11
    s_lshr_b32 s60, s58, 1
    s_lshl_b32 s60, s60, 10
    s_add_u32 s32, s60, s61
    s_andn2_b32 s60, 8, s57
    s_lshl_b32 s60, s60, 2
    v_bfe_u32 v24, v0, 2, 3
    v_lshrrev_b32 v25, 6, v0
    v_lshlrev_b32 v25, 1, v25
    v_xor_b32 v24, v24, v25
    v_lshlrev_b32 v8, 5, v24
    v_bfe_u32 v24, v0, 0, 2
    v_lshl_add_u32 v8, v24, 3, v8
    v_bfe_u32 v24, v0, 2, 2
    v_lshl_add_u32 v8, v24, 8, v8
    v_bfe_u32 v24, v0, 4, 2
    v_lshl_add_u32 v8, v24, 11, v8
    v_xor_b32 v8, s60, v8
    v_xor_b32 v9, 32, v8
    s_cmp_eq_u32 s56, 0
    s_cbranch_scc1 seg_w0
    v_and_b32 v26, 63, v0
    v_lshl_add_u32 v26, v26, 4, s32
    s_add_u32 m0, s32, 32768
    s_add_u32 s61, s28, 0x100000
    buffer_load_dwordx4 v6, s[12:15], s61 offen nt lds
    s_add_u32 m0, s32, 36864
    s_add_u32 s61, s28, 0x104000
    buffer_load_dwordx4 v6, s[12:15], s61 offen nt lds
    s_add_u32 m0, s32, 40960
    s_add_u32 s61, s28, 0x110000
    buffer_load_dwordx4 v6, s[12:15], s61 offen nt lds
    s_add_u32 m0, s32, 45056
    s_add_u32 s61, s28, 0x114000
    buffer_load_dwordx4 v6, s[12:15], s61 offen nt lds
    s_add_u32 m0, s32, 49152
    s_add_u32 s61, s28, 0x120000
    buffer_load_dwordx4 v6, s[12:15], s61 offen nt lds
    s_add_u32 m0, s32, 53248
    s_add_u32 s61, s28, 0x124000
    buffer_load_dwordx4 v6, s[12:15], s61 offen nt lds
    s_add_u32 m0, s32, 57344
    s_add_u32 s61, s28, 0x130000
    buffer_load_dwordx4 v6, s[12:15], s61 offen nt lds
    s_add_u32 m0, s32, 61440
    s_add_u32 s61, s28, 0x134000
    buffer_load_dwordx4 v6, s[12:15], s61 offen nt lds
    ds_write_b128 v26, v[128:131] offset:0
    ds_write_b128 v26, v[132:135] offset:4096
    ds_write_b128 v26, v[136:139] offset:8192
    ds_write_b128 v26, v[140:143] offset:12288
    ds_write_b128 v26, v[144:147] offset:16384
    ds_write_b128 v26, v[148:151] offset:20480
    ds_write_b128 v26, v[152:155] offset:24576
    ds_write_b128 v26, v[156:159] offset:28672
    s_waitcnt lgkmcnt(0)
    s_barrier
    ds_read_b64_tr_b16 a[0:1], v8 offset:0
    ds_read_b64_tr_b16 a[2:3], v8 offset:1024
    ds_read_b64_tr_b16 a[4:5], v9 offset:0
    ds_read_b64_tr_b16 a[6:7], v9 offset:1024
    ds_read_b64_tr_b16 a[8:9], v8 offset:8192
    ds_read_b64_tr_b16 a[10:11], v8 offset:9216
    ds_read_b64_tr_b16 a[12:13], v9 offset:8192
    ds_read_b64_tr_b16 a[14:15], v9 offset:9216
    s_waitcnt lgkmcnt(0)
    ds_read_b64_tr_b16 a[16:17], v8 offset:16384
    ds_read_b64_tr_b16 a[18:19], v8 offset:17408
    ds_read_b64_tr_b16 a[20:21], v9 offset:16384
    ds_read_b64_tr_b16 a[22:23], v9 offset:17408
    ds_read_b64_tr_b16 a[24:25], v8 offset:24576
    ds_read_b64_tr_b16 a[26:27], v8 offset:25600
    ds_read_b64_tr_b16 a[28:29], v9 offset:24576
    ds_read_b64_tr_b16 a[30:31], v9 offset:25600
    s_waitcnt lgkmcnt(0)
    s_barrier
    s_add_u32 m0, s32, 65536
    s_add_u32 s61, s28, 0x140000
    buffer_load_dwordx4 v6, s[12:15], s61 offen nt lds
    s_add_u32 m0, s32, 69632
    s_add_u32 s61, s28, 0x144000
    buffer_load_dwordx4 v6, s[12:15], s61 offen nt lds
    s_add_u32 m0, s32, 73728
    s_add_u32 s61, s28, 0x150000
    buffer_load_dwordx4 v6, s[12:15], s61 offen nt lds
    s_add_u32 m0, s32, 77824
    s_add_u32 s61, s28, 0x154000
    buffer_load_dwordx4 v6, s[12:15], s61 offen nt lds
    s_add_u32 m0, s32, 81920
    s_add_u32 s61, s28, 0x160000
    buffer_load_dwordx4 v6, s[12:15], s61 offen nt lds
    s_add_u32 m0, s32, 86016
    s_add_u32 s61, s28, 0x164000
    buffer_load_dwordx4 v6, s[12:15], s61 offen nt lds
    s_add_u32 m0, s32, 90112
    s_add_u32 s61, s28, 0x170000
    buffer_load_dwordx4 v6, s[12:15], s61 offen nt lds
    s_add_u32 m0, s32, 94208
    s_add_u32 s61, s28, 0x174000
    buffer_load_dwordx4 v6, s[12:15], s61 offen nt lds
    ds_write_b128 v26, v[160:163] offset:0
    ds_write_b128 v26, v[164:167] offset:4096
    ds_write_b128 v26, v[168:171] offset:8192
    ds_write_b128 v26, v[172:175] offset:12288
    ds_write_b128 v26, v[176:179] offset:16384
    ds_write_b128 v26, v[180:183] offset:20480
    ds_write_b128 v26, v[184:187] offset:24576
    ds_write_b128 v26, v[188:191] offset:28672
    s_waitcnt lgkmcnt(0)
    s_barrier
    ds_read_b64_tr_b16 a[32:33], v8 offset:0
    ds_read_b64_tr_b16 a[34:35], v8 offset:1024
    ds_read_b64_tr_b16 a[36:37], v9 offset:0
    ds_read_b64_tr_b16 a[38:39], v9 offset:1024
    ds_read_b64_tr_b16 a[40:41], v8 offset:8192
    ds_read_b64_tr_b16 a[42:43], v8 offset:9216
    ds_read_b64_tr_b16 a[44:45], v9 offset:8192
    ds_read_b64_tr_b16 a[46:47], v9 offset:9216
    s_waitcnt lgkmcnt(0)
    ds_read_b64_tr_b16 a[48:49], v8 offset:16384
    ds_read_b64_tr_b16 a[50:51], v8 offset:17408
    ds_read_b64_tr_b16 a[52:53], v9 offset:16384
    ds_read_b64_tr_b16 a[54:55], v9 offset:17408
    ds_read_b64_tr_b16 a[56:57], v8 offset:24576
    ds_read_b64_tr_b16 a[58:59], v8 offset:25600
    ds_read_b64_tr_b16 a[60:61], v9 offset:24576
    ds_read_b64_tr_b16 a[62:63], v9 offset:25600
    s_waitcnt lgkmcnt(0)
    s_barrier
    s_add_u32 m0, s32, 98304
    s_add_u32 s61, s28, 0x180000
    buffer_load_dwordx4 v6, s[12:15], s61 offen nt lds
    s_add_u32 m0, s32, 102400
    s_add_u32 s61, s28, 0x184000
    buffer_load_dwordx4 v6, s[12:15], s61 offen nt lds
    s_add_u32 m0, s32, 106496
    s_add_u32 s61, s28, 0x190000
    buffer_load_dwordx4 v6, s[12:15], s61 offen nt lds
    s_add_u32 m0, s32, 110592
    s_add_u32 s61, s28, 0x194000
    buffer_load_dwordx4 v6, s[12:15], s61 offen nt lds
    s_add_u32 m0, s32, 114688
    s_add_u32 s61, s28, 0x1a0000
    buffer_load_dwordx4 v6, s[12:15], s61 offen nt lds
    s_add_u32 m0, s32, 118784
    s_add_u32 s61, s28, 0x1a4000
    buffer_load_dwordx4 v6, s[12:15], s61 offen nt lds
    s_add_u32 m0, s32, 122880
    s_add_u32 s61, s28, 0x1b0000
    buffer_load_dwordx4 v6, s[12:15], s61 offen nt lds
    s_add_u32 m0, s32, 126976
    s_add_u32 s61, s28, 0x1b4000
    buffer_load_dwordx4 v6, s[12:15], s61 offen nt lds
    ds_write_b128 v26, v[192:195] offset:0
    ds_write_b128 v26, v[196:199] offset:4096
    ds_write_b128 v26, v[200:203] offset:8192
    ds_write_b128 v26, v[204:207] offset:12288
    ds_write_b128 v26, v[208:211] offset:16384
    ds_write_b128 v26, v[212:215] offset:20480
    ds_write_b128 v26, v[216:219] offset:24576
    ds_write_b128 v26, v[220:223] offset:28672
    s_waitcnt lgkmcnt(0)
    s_barrier
    ds_read_b64_tr_b16 a[64:65], v8 offset:0
    ds_read_b64_tr_b16 a[66:67], v8 offset:1024
    ds_read_b64_tr_b16 a[68:69], v9 offset:0
    ds_read_b64_tr_b16 a[70:71], v9 offset:1024
    ds_read_b64_tr_b16 a[72:73], v8 offset:8192
    ds_read_b64_tr_b16 a[74:75], v8 offset:9216
    ds_read_b64_tr_b16 a[76:77], v9 offset:8192
    ds_read_b64_tr_b16 a[78:79], v9 offset:9216
    s_waitcnt lgkmcnt(0)
    ds_read_b64_tr_b16 a[80:81], v8 offset:16384
    ds_read_b64_tr_b16 a[82:83], v8 offset:17408
    ds_read_b64_tr_b16 a[84:85], v9 offset:16384
    ds_read_b64_tr_b16 a[86:87], v9 offset:17408
    ds_read_b64_tr_b16 a[88:89], v8 offset:24576
    ds_read_b64_tr_b16 a[90:91], v8 offset:25600
    ds_read_b64_tr_b16 a[92:93], v9 offset:24576
    ds_read_b64_tr_b16 a[94:95], v9 offset:25600
    s_waitcnt lgkmcnt(0)
    s_barrier
    s_add_u32 m0, s32, 131072
    s_add_u32 s61, s28, 0x1c0000
    buffer_load_dwordx4 v6, s[12:15], s61 offen nt lds
    s_add_u32 m0, s32, 135168
    s_add_u32 s61, s28, 0x1c4000
    buffer_load_dwordx4 v6, s[12:15], s61 offen nt lds
    s_add_u32 m0, s32, 139264
    s_add_u32 s61, s28, 0x1d0000
    buffer_load_dwordx4 v6, s[12:15], s61 offen nt lds
    s_add_u32 m0, s32, 143360
    s_add_u32 s61, s28, 0x1d4000
    buffer_load_dwordx4 v6, s[12:15], s61 offen nt lds
    s_add_u32 m0, s32, 147456
    s_add_u32 s61, s28, 0x1e0000
    buffer_load_dwordx4 v6, s[12:15], s61 offen nt lds
    s_add_u32 m0, s32, 151552
    s_add_u32 s61, s28, 0x1e4000
    buffer_load_dwordx4 v6, s[12:15], s61 offen nt lds
    s_add_u32 m0, s32, 155648
    s_add_u32 s61, s28, 0x1f0000
    buffer_load_dwordx4 v6, s[12:15], s61 offen nt lds
    s_add_u32 m0, s32, 159744
    s_add_u32 s61, s28, 0x1f4000
    buffer_load_dwordx4 v6, s[12:15], s61 offen nt lds
    ds_write_b128 v26, v[224:227] offset:0
    ds_write_b128 v26, v[228:231] offset:4096
    ds_write_b128 v26, v[232:235] offset:8192
    ds_write_b128 v26, v[236:239] offset:12288
    ds_write_b128 v26, v[240:243] offset:16384
    ds_write_b128 v26, v[244:247] offset:20480
    ds_write_b128 v26, v[248:251] offset:24576
    ds_write_b128 v26, v[252:255] offset:28672
    s_waitcnt lgkmcnt(0)
    s_barrier
    ds_read_b64_tr_b16 a[96:97], v8 offset:0
    ds_read_b64_tr_b16 a[98:99], v8 offset:1024
    ds_read_b64_tr_b16 a[100:101], v9 offset:0
    ds_read_b64_tr_b16 a[102:103], v9 offset:1024
    ds_read_b64_tr_b16 a[104:105], v8 offset:8192
    ds_read_b64_tr_b16 a[106:107], v8 offset:9216
    ds_read_b64_tr_b16 a[108:109], v9 offset:8192
    ds_read_b64_tr_b16 a[110:111], v9 offset:9216
    s_waitcnt lgkmcnt(0)
    ds_read_b64_tr_b16 a[112:113], v8 offset:16384
    ds_read_b64_tr_b16 a[114:115], v8 offset:17408
    ds_read_b64_tr_b16 a[116:117], v9 offset:16384
    ds_read_b64_tr_b16 a[118:119], v9 offset:17408
    ds_read_b64_tr_b16 a[120:121], v8 offset:24576
    ds_read_b64_tr_b16 a[122:123], v8 offset:25600
    ds_read_b64_tr_b16 a[124:125], v9 offset:24576
    ds_read_b64_tr_b16 a[126:127], v9 offset:25600
    s_waitcnt lgkmcnt(0)
    s_barrier
    s_mov_b32 s8, s100
    s_and_b32 s9, s101, 0xffff
    s_mov_b32 s10, 0xe000000
    s_mov_b32 s11, 0x00020000
    s_mov_b32 s16, s96
    s_and_b32 s17, s97, 0xffff
    s_mov_b32 s18, 0x1000000
    s_mov_b32 s19, 0x00020000
    v_and_b32 v24, 63, v0
    v_lshlrev_b32 v1, 4, v24
    v_add_u32 v2, 4096, v1
    v_lshlrev_b32 v10, 7, v24
    v_mov_b32 v11, 0
    s_lshl_b32 s60, s56, 8
    s_add_u32 s60, s60, 0xd200400
    s_lshl2_add_u32 s27, s57, s60
    s_and_b32 s38, s57, 7
    s_lshl_b32 s38, s38, 16
    s_cmp_eq_u32 s58, 0
    s_cselect_b32 s27, s27, 0xe000000
    s_cselect_b32 s38, s38, 0xe000000
    s_add_u32 s60, s60, s100
    s_addc_u32 s61, s101, 0
    v_and_b32 v25, 31, v0
    v_lshlrev_b32 v25, 2, v25
    v_add_u32 v16, s60, v25
    v_mov_b32 v17, s61
    s_add_u32 s60, s98, 208
    s_addc_u32 s61, s99, 0
    v_writelane_b32 v16, s60, 32
    v_writelane_b32 v17, s61, 32
    s_mov_b32 s26, 0
    s_mov_b32 s30, 0
    s_mov_b32 s40, 0
    s_mov_b32 s29, 32768
    v_and_b32 v24, 15, v0
    v_lshlrev_b32 v15, 13, v24
    v_bfe_u32 v24, v0, 4, 2
    v_lshl_add_u32 v15, v24, 4, v15
    s_lshr_b32 s60, s57, 4
    s_lshl_b32 s60, s60, 17
    s_and_b32 s61, s57, 7
    s_lshl_b32 s61, s61, 9
    s_add_u32 s60, s60, s61
    s_lshl_b32 s61, s58, 7
    s_add_u32 s60, s60, s61
    s_and_b32 s61, s57, 8
    s_lshl_b32 s61, s61, 3
    s_add_u32 s60, s60, s61
    s_add_u32 s60, s60, 4096
    v_add_u32 v15, s60, v15
    s_lshl_b32 s61, s58, 12
    s_xor_b32 s60, s57, 24
    s_lshl_b32 s60, s60, 14
    s_add_u32 s60, s60, s61
    s_add_u32 s60, s60, 0
    v_add_u32 v20, s60, v1
    s_xor_b32 s60, s57, 16
    s_lshl_b32 s60, s60, 14
    s_add_u32 s60, s60, s61
    s_add_u32 s60, s60, 1024
    v_add_u32 v21, s60, v1
    s_xor_b32 s60, s57, 8
    s_lshl_b32 s60, s60, 14
    s_add_u32 s60, s60, s61
    s_add_u32 s60, s60, 2048
    v_add_u32 v22, s60, v1
    s_xor_b32 s60, s57, 0
    s_lshl_b32 s60, s60, 14
    s_add_u32 s60, s60, s61
    s_add_u32 s60, s60, 0
    v_add_u32 v23, s60, v1
    s_lshl_b32 s24, s56, 20
    s_add_u32 s24, s24, 0xd800000
    s_and_b32 s60, s57, 24
    s_add_u32 s60, s60, s58
    s_lshl_b32 s31, s60, 16
    s_add_u32 s31, s31, 0xc000
    s_add_u32 s31, s31, s59
    s_mul_i32 s33, s56, 8
    s_lshr_b32 s33, 0x2010012, s33
    s_and_b32 s33, s33, 255
    s_mul_i32 s39, s56, 8
    s_lshr_b32 s39, 0xf10100a, s39
    s_and_b32 s39, s39, 255
    s_cmp_eq_u32 s56, 0
    s_cmov_b32 s36, 0x3c
    s_cmp_eq_u32 s56, 1
    s_cmov_b32 s36, 0x3d39
    s_cmp_eq_u32 s56, 2
    s_cmov_b32 s36, 0x3f3b
    s_cmp_eq_u32 s56, 3
    s_cmov_b32 s36, 0x3e3a
    s_waitcnt vmcnt(24)
    s_barrier
    ds_read_b64_tr_b16 a[128:129], v8 offset:32768
    ds_read_b64_tr_b16 a[130:131], v8 offset:33792
    ds_read_b64_tr_b16 a[132:133], v9 offset:32768
    ds_read_b64_tr_b16 a[134:135], v9 offset:33792
    ds_read_b64_tr_b16 a[136:137], v8 offset:40960
    ds_read_b64_tr_b16 a[138:139], v8 offset:41984
    ds_read_b64_tr_b16 a[140:141], v9 offset:40960
    ds_read_b64_tr_b16 a[142:143], v9 offset:41984
    s_waitcnt lgkmcnt(0)
    ds_read_b64_tr_b16 a[144:145], v8 offset:49152
    ds_read_b64_tr_b16 a[146:147], v8 offset:50176
    ds_read_b64_tr_b16 a[148:149], v9 offset:49152
    ds_read_b64_tr_b16 a[150:151], v9 offset:50176
    ds_read_b64_tr_b16 a[152:153], v8 offset:57344
    ds_read_b64_tr_b16 a[154:155], v8 offset:58368
    ds_read_b64_tr_b16 a[156:157], v9 offset:57344
    ds_read_b64_tr_b16 a[158:159], v9 offset:58368
    s_waitcnt lgkmcnt(0)
    s_waitcnt vmcnt(16)
    s_barrier
    v_add_u32 v8, 0x10000, v8
    v_add_u32 v9, 0x10000, v9
    ds_read_b64_tr_b16 a[160:161], v8 offset:0
    ds_read_b64_tr_b16 a[162:163], v8 offset:1024
    ds_read_b64_tr_b16 a[164:165], v9 offset:0
    ds_read_b64_tr_b16 a[166:167], v9 offset:1024
    ds_read_b64_tr_b16 a[168:169], v8 offset:8192
    ds_read_b64_tr_b16 a[170:171], v8 offset:9216
    ds_read_b64_tr_b16 a[172:173], v9 offset:8192
    ds_read_b64_tr_b16 a[174:175], v9 offset:9216
    s_waitcnt lgkmcnt(0)
    ds_read_b64_tr_b16 a[176:177], v8 offset:16384
    ds_read_b64_tr_b16 a[178:179], v8 offset:17408
    ds_read_b64_tr_b16 a[180:181], v9 offset:16384
    ds_read_b64_tr_b16 a[182:183], v9 offset:17408
    ds_read_b64_tr_b16 a[184:185], v8 offset:24576
    ds_read_b64_tr_b16 a[186:187], v8 offset:25600
    ds_read_b64_tr_b16 a[188:189], v9 offset:24576
    ds_read_b64_tr_b16 a[190:191], v9 offset:25600
    s_waitcnt lgkmcnt(0)
    s_waitcnt vmcnt(8)
    s_barrier
    ds_read_b64_tr_b16 a[192:193], v8 offset:32768
    ds_read_b64_tr_b16 a[194:195], v8 offset:33792
    ds_read_b64_tr_b16 a[196:197], v9 offset:32768
    ds_read_b64_tr_b16 a[198:199], v9 offset:33792
    ds_read_b64_tr_b16 a[200:201], v8 offset:40960
    ds_read_b64_tr_b16 a[202:203], v8 offset:41984
    ds_read_b64_tr_b16 a[204:205], v9 offset:40960
    ds_read_b64_tr_b16 a[206:207], v9 offset:41984
    s_waitcnt lgkmcnt(0)
    ds_read_b64_tr_b16 a[208:209], v8 offset:49152
    ds_read_b64_tr_b16 a[210:211], v8 offset:50176
    ds_read_b64_tr_b16 a[212:213], v9 offset:49152
    ds_read_b64_tr_b16 a[214:215], v9 offset:50176
    ds_read_b64_tr_b16 a[216:217], v8 offset:57344
    ds_read_b64_tr_b16 a[218:219], v8 offset:58368
    ds_read_b64_tr_b16 a[220:221], v9 offset:57344
    ds_read_b64_tr_b16 a[222:223], v9 offset:58368
    s_waitcnt lgkmcnt(0)
    s_waitcnt vmcnt(0)
    s_barrier
    v_add_u32 v8, 0x10000, v8
    v_add_u32 v9, 0x10000, v9
    ds_read_b64_tr_b16 a[224:225], v8 offset:0
    ds_read_b64_tr_b16 a[226:227], v8 offset:1024
    ds_read_b64_tr_b16 a[228:229], v9 offset:0
    ds_read_b64_tr_b16 a[230:231], v9 offset:1024
    ds_read_b64_tr_b16 a[232:233], v8 offset:8192
    ds_read_b64_tr_b16 a[234:235], v8 offset:9216
    ds_read_b64_tr_b16 a[236:237], v9 offset:8192
    ds_read_b64_tr_b16 a[238:239], v9 offset:9216
    s_waitcnt lgkmcnt(0)
    ds_read_b64_tr_b16 a[240:241], v8 offset:16384
    ds_read_b64_tr_b16 a[242:243], v8 offset:17408
    ds_read_b64_tr_b16 a[244:245], v9 offset:16384
    ds_read_b64_tr_b16 a[246:247], v9 offset:17408
    ds_read_b64_tr_b16 a[248:249], v8 offset:24576
    ds_read_b64_tr_b16 a[250:251], v8 offset:25600
    ds_read_b64_tr_b16 a[252:253], v9 offset:24576
    ds_read_b64_tr_b16 a[254:255], v9 offset:25600
    s_waitcnt lgkmcnt(0)
    s_branch seg_w1
seg_w0:
    s_add_u32 m0, s32, 0
    s_add_u32 s61, s28, 0x0
    buffer_load_dwordx4 v6, s[12:15], s61 offen nt lds
    s_add_u32 m0, s32, 4096
    s_add_u32 s61, s28, 0x4000
    buffer_load_dwordx4 v6, s[12:15], s61 offen nt lds
    s_add_u32 m0, s32, 8192
    s_add_u32 s61, s28, 0x10000
    buffer_load_dwordx4 v6, s[12:15], s61 offen nt lds
    s_add_u32 m0, s32, 12288
    s_add_u32 s61, s28, 0x14000
    buffer_load_dwordx4 v6, s[12:15], s61 offen nt lds
    s_add_u32 m0, s32, 16384
    s_add_u32 s61, s28, 0x20000
    buffer_load_dwordx4 v6, s[12:15], s61 offen nt lds
    s_add_u32 m0, s32, 20480
    s_add_u32 s61, s28, 0x24000
    buffer_load_dwordx4 v6, s[12:15], s61 offen nt lds
    s_add_u32 m0, s32, 24576
    s_add_u32 s61, s28, 0x30000
    buffer_load_dwordx4 v6, s[12:15], s61 offen nt lds
    s_add_u32 m0, s32, 28672
    s_add_u32 s61, s28, 0x34000
    buffer_load_dwordx4 v6, s[12:15], s61 offen nt lds
    s_add_u32 m0, s32, 32768
    s_add_u32 s61, s28, 0x40000
    buffer_load_dwordx4 v6, s[12:15], s61 offen nt lds
    s_add_u32 m0, s32, 36864
    s_add_u32 s61, s28, 0x44000
    buffer_load_dwordx4 v6, s[12:15], s61 offen nt lds
    s_add_u32 m0, s32, 40960
    s_add_u32 s61, s28, 0x50000
    buffer_load_dwordx4 v6, s[12:15], s61 offen nt lds
    s_add_u32 m0, s32, 45056
    s_add_u32 s61, s28, 0x54000
    buffer_load_dwordx4 v6, s[12:15], s61 offen nt lds
    s_add_u32 m0, s32, 49152
    s_add_u32 s61, s28, 0x60000
    buffer_load_dwordx4 v6, s[12:15], s61 offen nt lds
    s_add_u32 m0, s32, 53248
    s_add_u32 s61, s28, 0x64000
    buffer_load_dwordx4 v6, s[12:15], s61 offen nt lds
    s_add_u32 m0, s32, 57344
    s_add_u32 s61, s28, 0x70000
    buffer_load_dwordx4 v6, s[12:15], s61 offen nt lds
    s_add_u32 m0, s32, 61440
    s_add_u32 s61, s28, 0x74000
    buffer_load_dwordx4 v6, s[12:15], s61 offen nt lds
    s_add_u32 m0, s32, 65536
    s_add_u32 s61, s28, 0x80000
    buffer_load_dwordx4 v6, s[12:15], s61 offen nt lds
    s_add_u32 m0, s32, 69632
    s_add_u32 s61, s28, 0x84000
    buffer_load_dwordx4 v6, s[12:15], s61 offen nt lds
    s_add_u32 m0, s32, 73728
    s_add_u32 s61, s28, 0x90000
    buffer_load_dwordx4 v6, s[12:15], s61 offen nt lds
    s_add_u32 m0, s32, 77824
    s_add_u32 s61, s28, 0x94000
    buffer_load_dwordx4 v6, s[12:15], s61 offen nt lds
    s_add_u32 m0, s32, 81920
    s_add_u32 s61, s28, 0xa0000
    buffer_load_dwordx4 v6, s[12:15], s61 offen nt lds
    s_add_u32 m0, s32, 86016
    s_add_u32 s61, s28, 0xa4000
    buffer_load_dwordx4 v6, s[12:15], s61 offen nt lds
    s_add_u32 m0, s32, 90112
    s_add_u32 s61, s28, 0xb0000
    buffer_load_dwordx4 v6, s[12:15], s61 offen nt lds
    s_add_u32 m0, s32, 94208
    s_add_u32 s61, s28, 0xb4000
    buffer_load_dwordx4 v6, s[12:15], s61 offen nt lds
    s_add_u32 m0, s32, 98304
    s_add_u32 s61, s28, 0xc0000
    buffer_load_dwordx4 v6, s[12:15], s61 offen nt lds
    s_add_u32 m0, s32, 102400
    s_add_u32 s61, s28, 0xc4000
    buffer_load_dwordx4 v6, s[12:15], s61 offen nt lds
    s_add_u32 m0, s32, 106496
    s_add_u32 s61, s28, 0xd0000
    buffer_load_dwordx4 v6, s[12:15], s61 offen nt lds
    s_add_u32 m0, s32, 110592
    s_add_u32 s61, s28, 0xd4000
    buffer_load_dwordx4 v6, s[12:15], s61 offen nt lds
    s_add_u32 m0, s32, 114688
    s_add_u32 s61, s28, 0xe0000
    buffer_load_dwordx4 v6, s[12:15], s61 offen nt lds
    s_add_u32 m0, s32, 118784
    s_add_u32 s61, s28, 0xe4000
    buffer_load_dwordx4 v6, s[12:15], s61 offen nt lds
    s_add_u32 m0, s32, 122880
    s_add_u32 s61, s28, 0xf0000
    buffer_load_dwordx4 v6, s[12:15], s61 offen nt lds
    s_add_u32 m0, s32, 126976
    s_add_u32 s61, s28, 0xf4000
    buffer_load_dwordx4 v6, s[12:15], s61 offen nt lds
    s_add_u32 m0, s32, 131072
    s_add_u32 s61, s28, 0x100000
    buffer_load_dwordx4 v6, s[12:15], s61 offen nt lds
    s_add_u32 m0, s32, 135168
    s_add_u32 s61, s28, 0x104000
    buffer_load_dwordx4 v6, s[12:15], s61 offen nt lds
    s_add_u32 m0, s32, 139264
    s_add_u32 s61, s28, 0x110000
    buffer_load_dwordx4 v6, s[12:15], s61 offen nt lds
    s_add_u32 m0, s32, 143360
    s_add_u32 s61, s28, 0x114000
    buffer_load_dwordx4 v6, s[12:15], s61 offen nt lds
    s_add_u32 m0, s32, 147456
    s_add_u32 s61, s28, 0x120000
    buffer_load_dwordx4 v6, s[12:15], s61 offen nt lds
    s_add_u32 m0, s32, 151552
    s_add_u32 s61, s28, 0x124000
    buffer_load_dwordx4 v6, s[12:15], s61 offen nt lds
    s_add_u32 m0, s32, 155648
    s_add_u32 s61, s28, 0x130000
    buffer_load_dwordx4 v6, s[12:15], s61 offen nt lds
    s_add_u32 m0, s32, 159744
    s_add_u32 s61, s28, 0x134000
    buffer_load_dwordx4 v6, s[12:15], s61 offen nt lds
    s_mov_b32 s8, s100
    s_and_b32 s9, s101, 0xffff
    s_mov_b32 s10, 0xe000000
    s_mov_b32 s11, 0x00020000
    s_mov_b32 s16, s96
    s_and_b32 s17, s97, 0xffff
    s_mov_b32 s18, 0x1000000
    s_mov_b32 s19, 0x00020000
    v_and_b32 v24, 63, v0
    v_lshlrev_b32 v1, 4, v24
    v_add_u32 v2, 4096, v1
    v_lshlrev_b32 v10, 7, v24
    v_mov_b32 v11, 0
    s_lshl_b32 s60, s56, 8
    s_add_u32 s60, s60, 0xd200400
    s_lshl2_add_u32 s27, s57, s60
    s_and_b32 s38, s57, 7
    s_lshl_b32 s38, s38, 16
    s_cmp_eq_u32 s58, 0
    s_cselect_b32 s27, s27, 0xe000000
    s_cselect_b32 s38, s38, 0xe000000
    s_add_u32 s60, s60, s100
    s_addc_u32 s61, s101, 0
    v_and_b32 v25, 31, v0
    v_lshlrev_b32 v25, 2, v25
    v_add_u32 v16, s60, v25
    v_mov_b32 v17, s61
    s_add_u32 s60, s98, 208
    s_addc_u32 s61, s99, 0
    v_writelane_b32 v16, s60, 32
    v_writelane_b32 v17, s61, 32
    s_mov_b32 s26, 0
    s_mov_b32 s30, 0
    s_mov_b32 s40, 0
    s_mov_b32 s29, 32768
    v_and_b32 v24, 15, v0
    v_lshlrev_b32 v15, 13, v24
    v_bfe_u32 v24, v0, 4, 2
    v_lshl_add_u32 v15, v24, 4, v15
    s_lshr_b32 s60, s57, 4
    s_lshl_b32 s60, s60, 17
    s_and_b32 s61, s57, 7
    s_lshl_b32 s61, s61, 9
    s_add_u32 s60, s60, s61
    s_lshl_b32 s61, s58, 7
    s_add_u32 s60, s60, s61
    s_and_b32 s61, s57, 8
    s_lshl_b32 s61, s61, 3
    s_add_u32 s60, s60, s61
    s_add_u32 s60, s60, 4096
    v_add_u32 v15, s60, v15
    s_lshl_b32 s61, s58, 12
    s_xor_b32 s60, s57, 24
    s_lshl_b32 s60, s60, 14
    s_add_u32 s60, s60, s61
    s_add_u32 s60, s60, 0
    v_add_u32 v20, s60, v1
    s_xor_b32 s60, s57, 16
    s_lshl_b32 s60, s60, 14
    s_add_u32 s60, s60, s61
    s_add_u32 s60, s60, 1024
    v_add_u32 v21, s60, v1
    s_xor_b32 s60, s57, 8
    s_lshl_b32 s60, s60, 14
    s_add_u32 s60, s60, s61
    s_add_u32 s60, s60, 2048
    v_add_u32 v22, s60, v1
    s_xor_b32 s60, s57, 0
    s_lshl_b32 s60, s60, 14
    s_add_u32 s60, s60, s61
    s_add_u32 s60, s60, 0
    v_add_u32 v23, s60, v1
    s_lshl_b32 s24, s56, 20
    s_add_u32 s24, s24, 0xd800000
    s_and_b32 s60, s57, 24
    s_add_u32 s60, s60, s58
    s_lshl_b32 s31, s60, 16
    s_add_u32 s31, s31, 0xc000
    s_add_u32 s31, s31, s59
    s_mul_i32 s33, s56, 8
    s_lshr_b32 s33, 0x2010012, s33
    s_and_b32 s33, s33, 255
    s_mul_i32 s39, s56, 8
    s_lshr_b32 s39, 0xf10100a, s39
    s_and_b32 s39, s39, 255
    s_cmp_eq_u32 s56, 0
    s_cmov_b32 s36, 0x3c
    s_cmp_eq_u32 s56, 1
    s_cmov_b32 s36, 0x3d39
    s_cmp_eq_u32 s56, 2
    s_cmov_b32 s36, 0x3f3b
    s_cmp_eq_u32 s56, 3
    s_cmov_b32 s36, 0x3e3a
    s_waitcnt vmcnt(32)
    s_barrier
    ds_read_b64_tr_b16 a[0:1], v8 offset:0
    ds_read_b64_tr_b16 a[2:3], v8 offset:1024
    ds_read_b64_tr_b16 a[4:5], v9 offset:0
    ds_read_b64_tr_b16 a[6:7], v9 offset:1024
    ds_read_b64_tr_b16 a[8:9], v8 offset:8192
    ds_read_b64_tr_b16 a[10:11], v8 offset:9216
    ds_read_b64_tr_b16 a[12:13], v9 offset:8192
    ds_read_b64_tr_b16 a[14:15], v9 offset:9216
    s_waitcnt lgkmcnt(0)
    ds_read_b64_tr_b16 a[16:17], v8 offset:16384
    ds_read_b64_tr_b16 a[18:19], v8 offset:17408
    ds_read_b64_tr_b16 a[20:21], v9 offset:16384
    ds_read_b64_tr_b16 a[22:23], v9 offset:17408
    ds_read_b64_tr_b16 a[24:25], v8 offset:24576
    ds_read_b64_tr_b16 a[26:27], v8 offset:25600
    ds_read_b64_tr_b16 a[28:29], v9 offset:24576
    ds_read_b64_tr_b16 a[30:31], v9 offset:25600
    s_waitcnt lgkmcnt(0)
    s_waitcnt vmcnt(24)
    s_barrier
    s_add_u32 m0, s32, 0
    s_add_u32 s61, s28, 0x140000
    buffer_load_dwordx4 v6, s[12:15], s61 offen nt lds
    s_add_u32 m0, s32, 4096
    s_add_u32 s61, s28, 0x144000
    buffer_load_dwordx4 v6, s[12:15], s61 offen nt lds
    s_add_u32 m0, s32, 8192
    s_add_u32 s61, s28, 0x150000
    buffer_load_dwordx4 v6, s[12:15], s61 offen nt lds
    s_add_u32 m0, s32, 12288
    s_add_u32 s61, s28, 0x154000
    buffer_load_dwordx4 v6, s[12:15], s61 offen nt lds
    s_add_u32 m0, s32, 16384
    s_add_u32 s61, s28, 0x160000
    buffer_load_dwordx4 v6, s[12:15], s61 offen nt lds
    s_add_u32 m0, s32, 20480
    s_add_u32 s61, s28, 0x164000
    buffer_load_dwordx4 v6, s[12:15], s61 offen nt lds
    s_add_u32 m0, s32, 24576
    s_add_u32 s61, s28, 0x170000
    buffer_load_dwordx4 v6, s[12:15], s61 offen nt lds
    s_add_u32 m0, s32, 28672
    s_add_u32 s61, s28, 0x174000
    buffer_load_dwordx4 v6, s[12:15], s61 offen nt lds
    ds_read_b64_tr_b16 a[32:33], v8 offset:32768
    ds_read_b64_tr_b16 a[34:35], v8 offset:33792
    ds_read_b64_tr_b16 a[36:37], v9 offset:32768
    ds_read_b64_tr_b16 a[38:39], v9 offset:33792
    ds_read_b64_tr_b16 a[40:41], v8 offset:40960
    ds_read_b64_tr_b16 a[42:43], v8 offset:41984
    ds_read_b64_tr_b16 a[44:45], v9 offset:40960
    ds_read_b64_tr_b16 a[46:47], v9 offset:41984
    s_waitcnt lgkmcnt(0)
    ds_read_b64_tr_b16 a[48:49], v8 offset:49152
    ds_read_b64_tr_b16 a[50:51], v8 offset:50176
    ds_read_b64_tr_b16 a[52:53], v9 offset:49152
    ds_read_b64_tr_b16 a[54:55], v9 offset:50176
    ds_read_b64_tr_b16 a[56:57], v8 offset:57344
    ds_read_b64_tr_b16 a[58:59], v8 offset:58368
    ds_read_b64_tr_b16 a[60:61], v9 offset:57344
    ds_read_b64_tr_b16 a[62:63], v9 offset:58368
    s_waitcnt lgkmcnt(0)
    s_waitcnt vmcnt(24)
    s_barrier
    s_add_u32 m0, s32, 32768
    s_add_u32 s61, s28, 0x180000
    buffer_load_dwordx4 v6, s[12:15], s61 offen nt lds
    s_add_u32 m0, s32, 36864
    s_add_u32 s61, s28, 0x184000
    buffer_load_dwordx4 v6, s[12:15], s61 offen nt lds
    s_add_u32 m0, s32, 40960
    s_add_u32 s61, s28, 0x190000
    buffer_load_dwordx4 v6, s[12:15], s61 offen nt lds
    s_add_u32 m0, s32, 45056
    s_add_u32 s61, s28, 0x194000
    buffer_load_dwordx4 v6, s[12:15], s61 offen nt lds
    s_add_u32 m0, s32, 49152
    s_add_u32 s61, s28, 0x1a0000
    buffer_load_dwordx4 v6, s[12:15], s61 offen nt lds
    s_add_u32 m0, s32, 53248
    s_add_u32 s61, s28, 0x1a4000
    buffer_load_dwordx4 v6, s[12:15], s61 offen nt lds
    s_add_u32 m0, s32, 57344
    s_add_u32 s61, s28, 0x1b0000
    buffer_load_dwordx4 v6, s[12:15], s61 offen nt lds
    s_add_u32 m0, s32, 61440
    s_add_u32 s61, s28, 0x1b4000
    buffer_load_dwordx4 v6, s[12:15], s61 offen nt lds
    v_add_u32 v8, 0x10000, v8
    v_add_u32 v9, 0x10000, v9
    ds_read_b64_tr_b16 a[64:65], v8 offset:0
    ds_read_b64_tr_b16 a[66:67], v8 offset:1024
    ds_read_b64_tr_b16 a[68:69], v9 offset:0
    ds_read_b64_tr_b16 a[70:71], v9 offset:1024
    ds_read_b64_tr_b16 a[72:73], v8 offset:8192
    ds_read_b64_tr_b16 a[74:75], v8 offset:9216
    ds_read_b64_tr_b16 a[76:77], v9 offset:8192
    ds_read_b64_tr_b16 a[78:79], v9 offset:9216
    s_waitcnt lgkmcnt(0)
    ds_read_b64_tr_b16 a[80:81], v8 offset:16384
    ds_read_b64_tr_b16 a[82:83], v8 offset:17408
    ds_read_b64_tr_b16 a[84:85], v9 offset:16384
    ds_read_b64_tr_b16 a[86:87], v9 offset:17408
    ds_read_b64_tr_b16 a[88:89], v8 offset:24576
    ds_read_b64_tr_b16 a[90:91], v8 offset:25600
    ds_read_b64_tr_b16 a[92:93], v9 offset:24576
    ds_read_b64_tr_b16 a[94:95], v9 offset:25600
    s_waitcnt lgkmcnt(0)
    s_waitcnt vmcnt(24)
    s_barrier
    s_add_u32 m0, s32, 65536
    s_add_u32 s61, s28, 0x1c0000
    buffer_load_dwordx4 v6, s[12:15], s61 offen nt lds
    s_add_u32 m0, s32, 69632
    s_add_u32 s61, s28, 0x1c4000
    buffer_load_dwordx4 v6, s[12:15], s61 offen nt lds
    s_add_u32 m0, s32, 73728
    s_add_u32 s61, s28, 0x1d0000
    buffer_load_dwordx4 v6, s[12:15], s61 offen nt lds
    s_add_u32 m0, s32, 77824
    s_add_u32 s61, s28, 0x1d4000
    buffer_load_dwordx4 v6, s[12:15], s61 offen nt lds
    s_add_u32 m0, s32, 81920
    s_add_u32 s61, s28, 0x1e0000
    buffer_load_dwordx4 v6, s[12:15], s61 offen nt lds
    s_add_u32 m0, s32, 86016
    s_add_u32 s61, s28, 0x1e4000
    buffer_load_dwordx4 v6, s[12:15], s61 offen nt lds
    s_add_u32 m0, s32, 90112
    s_add_u32 s61, s28, 0x1f0000
    buffer_load_dwordx4 v6, s[12:15], s61 offen nt lds
    s_add_u32 m0, s32, 94208
    s_add_u32 s61, s28, 0x1f4000
    buffer_load_dwordx4 v6, s[12:15], s61 offen nt lds
    ds_read_b64_tr_b16 a[96:97], v8 offset:32768
    ds_read_b64_tr_b16 a[98:99], v8 offset:33792
    ds_read_b64_tr_b16 a[100:101], v9 offset:32768
    ds_read_b64_tr_b16 a[102:103], v9 offset:33792
    ds_read_b64_tr_b16 a[104:105], v8 offset:40960
    ds_read_b64_tr_b16 a[106:107], v8 offset:41984
    ds_read_b64_tr_b16 a[108:109], v9 offset:40960
    ds_read_b64_tr_b16 a[110:111], v9 offset:41984
    s_waitcnt lgkmcnt(0)
    ds_read_b64_tr_b16 a[112:113], v8 offset:49152
    ds_read_b64_tr_b16 a[114:115], v8 offset:50176
    ds_read_b64_tr_b16 a[116:117], v9 offset:49152
    ds_read_b64_tr_b16 a[118:119], v9 offset:50176
    ds_read_b64_tr_b16 a[120:121], v8 offset:57344
    ds_read_b64_tr_b16 a[122:123], v8 offset:58368
    ds_read_b64_tr_b16 a[124:125], v9 offset:57344
    ds_read_b64_tr_b16 a[126:127], v9 offset:58368
    s_waitcnt lgkmcnt(0)
    s_waitcnt vmcnt(24)
    s_barrier
    v_add_u32 v8, 0x10000, v8
    v_add_u32 v9, 0x10000, v9
    ds_read_b64_tr_b16 a[128:129], v8 offset:0
    ds_read_b64_tr_b16 a[130:131], v8 offset:1024
    ds_read_b64_tr_b16 a[132:133], v9 offset:0
    ds_read_b64_tr_b16 a[134:135], v9 offset:1024
    ds_read_b64_tr_b16 a[136:137], v8 offset:8192
    ds_read_b64_tr_b16 a[138:139], v8 offset:9216
    ds_read_b64_tr_b16 a[140:141], v9 offset:8192
    ds_read_b64_tr_b16 a[142:143], v9 offset:9216
    s_waitcnt lgkmcnt(0)
    ds_read_b64_tr_b16 a[144:145], v8 offset:16384
    ds_read_b64_tr_b16 a[146:147], v8 offset:17408
    ds_read_b64_tr_b16 a[148:149], v9 offset:16384
    ds_read_b64_tr_b16 a[150:151], v9 offset:17408
    ds_read_b64_tr_b16 a[152:153], v8 offset:24576
    ds_read_b64_tr_b16 a[154:155], v8 offset:25600
    ds_read_b64_tr_b16 a[156:157], v9 offset:24576
    ds_read_b64_tr_b16 a[158:159], v9 offset:25600
    s_waitcnt lgkmcnt(0)
    s_waitcnt vmcnt(16)
    s_barrier
    v_add_u32 v8, 0xfffe0000, v8
    v_add_u32 v9, 0xfffe0000, v9
    ds_read_b64_tr_b16 a[160:161], v8 offset:0
    ds_read_b64_tr_b16 a[162:163], v8 offset:1024
    ds_read_b64_tr_b16 a[164:165], v9 offset:0
    ds_read_b64_tr_b16 a[166:167], v9 offset:1024
    ds_read_b64_tr_b16 a[168:169], v8 offset:8192
    ds_read_b64_tr_b16 a[170:171], v8 offset:9216
    ds_read_b64_tr_b16 a[172:173], v9 offset:8192
    ds_read_b64_tr_b16 a[174:175], v9 offset:9216
    s_waitcnt lgkmcnt(0)
    ds_read_b64_tr_b16 a[176:177], v8 offset:16384
    ds_read_b64_tr_b16 a[178:179], v8 offset:17408
    ds_read_b64_tr_b16 a[180:181], v9 offset:16384
    ds_read_b64_tr_b16 a[182:183], v9 offset:17408
    ds_read_b64_tr_b16 a[184:185], v8 offset:24576
    ds_read_b64_tr_b16 a[186:187], v8 offset:25600
    ds_read_b64_tr_b16 a[188:189], v9 offset:24576
    ds_read_b64_tr_b16 a[190:191], v9 offset:25600
    s_waitcnt lgkmcnt(0)
    s_waitcnt vmcnt(8)
    s_barrier
    ds_read_b64_tr_b16 a[192:193], v8 offset:32768
    ds_read_b64_tr_b16 a[194:195], v8 offset:33792
    ds_read_b64_tr_b16 a[196:197], v9 offset:32768
    ds_read_b64_tr_b16 a[198:199], v9 offset:33792
    ds_read_b64_tr_b16 a[200:201], v8 offset:40960
    ds_read_b64_tr_b16 a[202:203], v8 offset:41984
    ds_read_b64_tr_b16 a[204:205], v9 offset:40960
    ds_read_b64_tr_b16 a[206:207], v9 offset:41984
    s_waitcnt lgkmcnt(0)
    ds_read_b64_tr_b16 a[208:209], v8 offset:49152
    ds_read_b64_tr_b16 a[210:211], v8 offset:50176
    ds_read_b64_tr_b16 a[212:213], v9 offset:49152
    ds_read_b64_tr_b16 a[214:215], v9 offset:50176
    ds_read_b64_tr_b16 a[216:217], v8 offset:57344
    ds_read_b64_tr_b16 a[218:219], v8 offset:58368
    ds_read_b64_tr_b16 a[220:221], v9 offset:57344
    ds_read_b64_tr_b16 a[222:223], v9 offset:58368
    s_waitcnt lgkmcnt(0)
    s_waitcnt vmcnt(0)
    s_barrier
    v_add_u32 v8, 0x10000, v8
    v_add_u32 v9, 0x10000, v9
    ds_read_b64_tr_b16 a[224:225], v8 offset:0
    ds_read_b64_tr_b16 a[226:227], v8 offset:1024
    ds_read_b64_tr_b16 a[228:229], v9 offset:0
    ds_read_b64_tr_b16 a[230:231], v9 offset:1024
    ds_read_b64_tr_b16 a[232:233], v8 offset:8192
    ds_read_b64_tr_b16 a[234:235], v8 offset:9216
    ds_read_b64_tr_b16 a[236:237], v9 offset:8192
    ds_read_b64_tr_b16 a[238:239], v9 offset:9216
    s_waitcnt lgkmcnt(0)
    ds_read_b64_tr_b16 a[240:241], v8 offset:16384
    ds_read_b64_tr_b16 a[242:243], v8 offset:17408
    ds_read_b64_tr_b16 a[244:245], v9 offset:16384
    ds_read_b64_tr_b16 a[246:247], v9 offset:17408
    ds_read_b64_tr_b16 a[248:249], v8 offset:24576
    ds_read_b64_tr_b16 a[250:251], v8 offset:25600
    ds_read_b64_tr_b16 a[252:253], v9 offset:24576
    ds_read_b64_tr_b16 a[254:255], v9 offset:25600
    s_waitcnt lgkmcnt(0)
seg_w1:
    s_barrier
    s_cmp_eq_u32 s39, 0
    s_cbranch_scc1 seg_t0
    s_lshl_b32 s20, s58, 13
    s_mov_b32 s21, 0
    s_lshr_b32 s60, s57, 4
    s_lshl_b32 s60, s60, 12
    v_add_u32 v5, s60, v1
    v_xor_b32 v4, 4096, v5
    s_mul_i32 s35, s56, 8
    s_lshr_b32 s35, 0x35383736, s35
    s_and_b32 s35, s35, 255
    s_add_u32 s34, s33, 11
    s_mov_b32 s25, 0
    s_mov_b32 s42, 0
    s_mov_b32 s18, 0
    v_mov_b32 v18, s26
    v_writelane_b32 v18, s34, 32
    v_writelane_b32 v18, s40, 33
L_sp_82:
    global_load_dword v19, v[16:17], off sc1
    s_add_u32 s30, s30, 1
    s_cmp_gt_u32 s30, 0x200000
    s_cbranch_scc1 chain_kernel_wabort
    s_waitcnt vmcnt(0)
    v_cmp_lt_u32 vcc, v19, v18
    s_cbranch_vccz L_spok_83
    s_sleep 4
    s_branch L_sp_82
L_spok_83:
    s_cmp_lt_u32 s33, 15
    s_cselect_b32 s41, 3, 4
    s_add_u32 s41, s41, s33
    s_lshl_b32 s61, s33, 13
    s_and_b32 s61, s61, 0x2000
    s_xor_b32 s61, s61, s31
    s_lshl_b32 s23, s33, 21
    s_add_u32 s23, s23, s61
    s_cmp_gt_u32 s33, s35
    s_cselect_b32 s23, 0xe000000, s23
    s_add_u32 m0, s20, 0
    s_nop 0
    buffer_load_dwordx4 v1, s[8:11], s23 offen offset:0 lds
    buffer_load_dwordx4 v1, s[8:11], s23 offen offset:1024 lds
    buffer_load_dwordx4 v1, s[8:11], s23 offen offset:2048 lds
    buffer_load_dwordx4 v1, s[8:11], s23 offen offset:3072 lds
    s_add_u32 m0, s20, 4096
    s_nop 0
    buffer_load_dwordx4 v2, s[8:11], s23 offen offset:0 lds
    buffer_load_dwordx4 v2, s[8:11], s23 offen offset:1024 lds
    buffer_load_dwordx4 v2, s[8:11], s23 offen offset:2048 lds
    buffer_load_dwordx4 v2, s[8:11], s23 offen offset:3072 lds
    s_add_u32 s20, s20, 32768
    s_cmp_ge_u32 s20, 163840
    s_cselect_b32 s60, 163840, 0
    s_sub_u32 s20, s20, s60
    s_add_u32 s23, s23, 0x40000
    s_add_u32 m0, s20, 0
    s_nop 0
    buffer_load_dwordx4 v1, s[8:11], s23 offen offset:0 lds
    buffer_load_dwordx4 v1, s[8:11], s23 offen offset:1024 lds
    buffer_load_dwordx4 v1, s[8:11], s23 offen offset:2048 lds
    buffer_load_dwordx4 v1, s[8:11], s23 offen offset:3072 lds
    s_add_u32 m0, s20, 4096
    s_nop 0
    buffer_load_dwordx4 v2, s[8:11], s23 offen offset:0 lds
    buffer_load_dwordx4 v2, s[8:11], s23 offen offset:1024 lds
    buffer_load_dwordx4 v2, s[8:11], s23 offen offset:2048 lds
    buffer_load_dwordx4 v2, s[8:11], s23 offen offset:3072 lds
    s_add_u32 s20, s20, 32768
    s_cmp_ge_u32 s20, 163840
    s_cselect_b32 s60, 163840, 0
    s_sub_u32 s20, s20, s60
    s_lshl_b32 s42, s42, 8
    s_or_b32 s42, s42, s33
    s_mov_b32 s33, s41
    s_cmp_lt_u32 s33, 15
    s_cselect_b32 s41, 3, 4
    s_add_u32 s41, s41, s33
    s_lshl_b32 s61, s33, 13
    s_and_b32 s61, s61, 0x2000
    s_xor_b32 s61, s61, s31
    s_lshl_b32 s23, s33, 21
    s_add_u32 s23, s23, s61
    s_cmp_gt_u32 s33, s35
    s_cselect_b32 s23, 0xe000000, s23
    s_add_u32 m0, s20, 0
    s_nop 0
    buffer_load_dwordx4 v1, s[8:11], s23 offen offset:0 lds
    buffer_load_dwordx4 v1, s[8:11], s23 offen offset:1024 lds
    buffer_load_dwordx4 v1, s[8:11], s23 offen offset:2048 lds
    buffer_load_dwordx4 v1, s[8:11], s23 offen offset:3072 lds
    s_add_u32 m0, s20, 4096
    s_nop 0
    buffer_load_dwordx4 v2, s[8:11], s23 offen offset:0 lds
    buffer_load_dwordx4 v2, s[8:11], s23 offen offset:1024 lds
    buffer_load_dwordx4 v2, s[8:11], s23 offen offset:2048 lds
    buffer_load_dwordx4 v2, s[8:11], s23 offen offset:3072 lds
    s_add_u32 s20, s20, 32768
    s_cmp_ge_u32 s20, 163840
    s_cselect_b32 s60, 163840, 0
    s_sub_u32 s20, s20, s60
    s_add_u32 s23, s23, 0x40000
    s_mov_b32 s37, 0xe000000
    s_waitcnt vmcnt(8)
    s_barrier
    ds_read_b128 v[72:75], v4 offset:0
    ds_read_b128 v[76:79], v5 offset:0
    ds_read_b128 v[80:83], v4 offset:1024
    ds_read_b128 v[84:87], v5 offset:1024
    ds_read_b128 v[88:91], v4 offset:2048
    ds_read_b128 v[92:95], v5 offset:2048
seg_p:
    s_waitcnt lgkmcnt(4)
    v_mfma_f32_16x16x32_bf16 v[32:35], a[0:3], v[72:75], 0
    ds_read_b128 v[96:99], v4 offset:3072
    s_waitcnt vmcnt(4)
    v_mfma_f32_16x16x32_bf16 v[36:39], a[4:7], v[72:75], 0
    ds_read_b128 v[100:103], v5 offset:3072
    v_pk_add_f32 v[104:105], v[104:105], v[64:65]
    v_mfma_f32_16x16x32_bf16 v[44:47], a[4:7], v[76:79], 0
    v_pk_add_f32 v[106:107], v[106:107], v[66:67]
    s_xor_b32 s24, s24, 0x80000
    v_mfma_f32_16x16x32_bf16 v[40:43], a[0:3], v[76:79], 0
    buffer_store_dwordx4 v[48:51], v20, s[8:11], s24 offen
    s_waitcnt lgkmcnt(4)
    v_mfma_f32_16x16x32_bf16 v[32:35], a[8:11], v[80:83], v[32:35]
    ds_read_b128 v[72:75], v4 offset:8192
    v_mfma_f32_16x16x32_bf16 v[36:39], a[12:15], v[80:83], v[36:39]
    ds_read_b128 v[76:79], v5 offset:8192
    buffer_store_dwordx4 v[52:55], v21, s[8:11], s24 offen
    v_mfma_f32_16x16x32_bf16 v[44:47], a[12:15], v[84:87], v[44:47]
    v_mfma_f32_16x16x32_bf16 v[40:43], a[8:11], v[84:87], v[40:43]
    buffer_store_dwordx4 v[56:59], v22, s[8:11], s24 offen
    s_waitcnt lgkmcnt(4)
    v_mfma_f32_16x16x32_bf16 v[32:35], a[16:19], v[88:91], v[32:35]
    ds_read_b128 v[80:83], v4 offset:9216
    buffer_load_dword v13, v10, s[8:11], s37 offen
    v_mfma_f32_16x16x32_bf16 v[36:39], a[20:23], v[88:91], v[36:39]
    ds_read_b128 v[84:87], v5 offset:9216
    v_pk_add_f32 v[108:109], v[108:109], v[112:113]
    v_mfma_f32_16x16x32_bf16 v[44:47], a[20:23], v[92:95], v[44:47]
    v_pk_add_f32 v[110:111], v[110:111], v[114:115]
    v_pk_add_f32 v[104:105], v[104:105], v[108:109]
    v_mfma_f32_16x16x32_bf16 v[40:43], a[16:19], v[92:95], v[40:43]
    v_pk_add_f32 v[106:107], v[106:107], v[110:111]
    s_waitcnt lgkmcnt(4)
    v_mfma_f32_16x16x32_bf16 v[32:35], a[24:27], v[96:99], v[32:35]
    ds_read_b128 v[88:91], v4 offset:10240
    v_cvt_pk_bf16_f32 v104, 0, v104
    v_mfma_f32_16x16x32_bf16 v[36:39], a[28:31], v[96:99], v[36:39]
    ds_read_b128 v[92:95], v5 offset:10240
    v_cvt_pk_bf16_f32 v105, 0, v105
    v_mfma_f32_16x16x32_bf16 v[44:47], a[28:31], v[100:103], v[44:47]
    v_cvt_pk_bf16_f32 v106, 0, v106
    v_cvt_pk_bf16_f32 v107, 0, v107
    v_mfma_f32_16x16x32_bf16 v[40:43], a[24:27], v[100:103], v[40:43]
    buffer_store_dwordx4 v[104:107], v15, s[16:19], s25 offen
    s_waitcnt lgkmcnt(4)
    v_mfma_f32_16x16x32_bf16 v[32:35], a[32:35], v[72:75], v[32:35]
    ds_read_b128 v[96:99], v4 offset:11264
    v_mov_b32 v64, v60
    v_mfma_f32_16x16x32_bf16 v[36:39], a[36:39], v[72:75], v[36:39]
    ds_read_b128 v[100:103], v5 offset:11264
    v_mov_b32 v65, v61
    v_mfma_f32_16x16x32_bf16 v[44:47], a[36:39], v[76:79], v[44:47]
    v_mov_b32 v66, v62
    v_mov_b32 v67, v63
    v_mfma_f32_16x16x32_bf16 v[40:43], a[32:35], v[76:79], v[40:43]
    s_waitcnt lgkmcnt(4)
    v_mfma_f32_16x16x32_bf16 v[32:35], a[40:43], v[80:83], v[32:35]
    ds_read_b128 v[72:75], v4 offset:16384
    v_mfma_f32_16x16x32_bf16 v[36:39], a[44:47], v[80:83], v[36:39]
    ds_read_b128 v[76:79], v5 offset:16384
    v_mfma_f32_16x16x32_bf16 v[44:47], a[44:47], v[84:87], v[44:47]
    v_mfma_f32_16x16x32_bf16 v[40:43], a[40:43], v[84:87], v[40:43]
    s_waitcnt lgkmcnt(4)
    v_mfma_f32_16x16x32_bf16 v[32:35], a[48:51], v[88:91], v[32:35]
    ds_read_b128 v[80:83], v4 offset:17408
    s_lshl_b32 s42, s42, 8
    v_mfma_f32_16x16x32_bf16 v[36:39], a[52:55], v[88:91], v[36:39]
    ds_read_b128 v[84:87], v5 offset:17408
    s_or_b32 s42, s42, s33
    v_mfma_f32_16x16x32_bf16 v[44:47], a[52:55], v[92:95], v[44:47]
    s_mov_b32 s33, s41
    s_cmp_lt_u32 s33, 15
    v_mfma_f32_16x16x32_bf16 v[40:43], a[48:51], v[92:95], v[40:43]
    s_cselect_b32 s41, 3, 4
    s_waitcnt lgkmcnt(4)
    v_mfma_f32_16x16x32_bf16 v[32:35], a[56:59], v[96:99], v[32:35]
    ds_read_b128 v[88:91], v4 offset:18432
    s_add_u32 s41, s41, s33
    v_mfma_f32_16x16x32_bf16 v[36:39], a[60:63], v[96:99], v[36:39]
    ds_read_b128 v[92:95], v5 offset:18432
    s_cmp_ge_u32 s21, 131072
    v_mfma_f32_16x16x32_bf16 v[44:47], a[60:63], v[100:103], v[44:47]
    s_cselect_b32 s22, 0xfffe0000, s29
    s_add_u32 s21, s21, s22
    v_mfma_f32_16x16x32_bf16 v[40:43], a[56:59], v[100:103], v[40:43]
    s_min_u32 s34, s41, s35
    s_waitcnt lgkmcnt(4)
    v_mfma_f32_16x16x32_bf16 v[32:35], a[64:67], v[72:75], v[32:35]
    ds_read_b128 v[96:99], v4 offset:19456
    s_add_u32 s34, s34, 3
    v_mfma_f32_16x16x32_bf16 v[36:39], a[68:71], v[72:75], v[36:39]
    ds_read_b128 v[100:103], v5 offset:19456
    s_bfe_u32 s25, s42, 0x80010
    v_mfma_f32_16x16x32_bf16 v[44:47], a[68:71], v[76:79], v[44:47]
    s_lshl_b32 s25, s25, 18
    s_cmp_ge_u32 s26, 1
    v_mfma_f32_16x16x32_bf16 v[40:43], a[64:67], v[76:79], v[40:43]
    s_cselect_b32 s18, 0x1000000, 0
    s_waitcnt lgkmcnt(4)
    v_mfma_f32_16x16x32_bf16 v[32:35], a[72:75], v[80:83], v[32:35]
    ds_read_b128 v[72:75], v4 offset:24576
    v_mfma_f32_16x16x32_bf16 v[36:39], a[76:79], v[80:83], v[36:39]
    ds_read_b128 v[76:79], v5 offset:24576
    v_mfma_f32_16x16x32_bf16 v[44:47], a[76:79], v[84:87], v[44:47]
    v_mfma_f32_16x16x32_bf16 v[40:43], a[72:75], v[84:87], v[40:43]
    s_waitcnt lgkmcnt(4)
    v_mfma_f32_16x16x32_bf16 v[32:35], a[80:83], v[88:91], v[32:35]
    ds_read_b128 v[80:83], v4 offset:25600
    s_add_u32 m0, s20, 0
    v_mfma_f32_16x16x32_bf16 v[36:39], a[84:87], v[88:91], v[36:39]
    ds_read_b128 v[84:87], v5 offset:25600
    buffer_load_dwordx4 v1, s[8:11], s23 offen offset:0 lds
    v_mfma_f32_16x16x32_bf16 v[44:47], a[84:87], v[92:95], v[44:47]
    v_mfma_f32_16x16x32_bf16 v[40:43], a[80:83], v[92:95], v[40:43]
    s_waitcnt lgkmcnt(4)
    v_mfma_f32_16x16x32_bf16 v[32:35], a[88:91], v[96:99], v[32:35]
    ds_read_b128 v[88:91], v4 offset:26624
    v_mfma_f32_16x16x32_bf16 v[36:39], a[92:95], v[96:99], v[36:39]
    ds_read_b128 v[92:95], v5 offset:26624
    buffer_load_dwordx4 v1, s[8:11], s23 offen offset:1024 lds
    v_mfma_f32_16x16x32_bf16 v[44:47], a[92:95], v[100:103], v[44:47]
    v_mfma_f32_16x16x32_bf16 v[40:43], a[88:91], v[100:103], v[40:43]
    s_waitcnt lgkmcnt(4)
    v_mfma_f32_16x16x32_bf16 v[32:35], a[96:99], v[72:75], v[32:35]
    ds_read_b128 v[96:99], v4 offset:27648
    v_mfma_f32_16x16x32_bf16 v[36:39], a[100:103], v[72:75], v[36:39]
    ds_read_b128 v[100:103], v5 offset:27648
    v_mfma_f32_16x16x32_bf16 v[44:47], a[100:103], v[76:79], v[44:47]
    v_add_u32 v4, s22, v4
    v_add_u32 v5, s22, v5
    v_mfma_f32_16x16x32_bf16 v[40:43], a[96:99], v[76:79], v[40:43]
    buffer_load_dwordx4 v1, s[8:11], s23 offen offset:2048 lds
    s_waitcnt vmcnt(5)
    s_barrier
    s_waitcnt lgkmcnt(4)
    v_mfma_f32_16x16x32_bf16 v[32:35], a[104:107], v[80:83], v[32:35]
    ds_read_b128 v[72:75], v4 offset:0
    s_add_u32 s26, s26, 1
    v_mfma_f32_16x16x32_bf16 v[36:39], a[108:111], v[80:83], v[36:39]
    ds_read_b128 v[76:79], v5 offset:0
    v_mov_b32 v12, s26
    v_mfma_f32_16x16x32_bf16 v[44:47], a[108:111], v[84:87], v[44:47]
    buffer_store_dword v12, v11, s[8:11], s27 offen
    v_mfma_f32_16x16x32_bf16 v[40:43], a[104:107], v[84:87], v[40:43]
    buffer_load_dwordx4 v1, s[8:11], s23 offen offset:3072 lds
    s_waitcnt lgkmcnt(4)
    v_mfma_f32_16x16x32_bf16 v[32:35], a[112:115], v[88:91], v[32:35]
    ds_read_b128 v[80:83], v4 offset:1024
    v_mfma_f32_16x16x32_bf16 v[36:39], a[116:119], v[88:91], v[36:39]
    ds_read_b128 v[84:87], v5 offset:1024
    v_mov_b32 v18, s26
    v_mfma_f32_16x16x32_bf16 v[44:47], a[116:119], v[92:95], v[44:47]
    v_writelane_b32 v18, s34, 32
    v_writelane_b32 v18, s40, 33
    v_mfma_f32_16x16x32_bf16 v[40:43], a[112:115], v[92:95], v[40:43]
    s_waitcnt lgkmcnt(4)
    v_mfma_f32_16x16x32_bf16 v[32:35], a[120:123], v[96:99], v[32:35]
    ds_read_b128 v[88:91], v4 offset:2048
    s_add_u32 m0, s20, 4096
    v_mfma_f32_16x16x32_bf16 v[36:39], a[124:127], v[96:99], v[36:39]
    ds_read_b128 v[92:95], v5 offset:2048
    buffer_load_dwordx4 v2, s[8:11], s23 offen offset:0 lds
    v_mfma_f32_16x16x32_bf16 v[44:47], a[124:127], v[100:103], v[44:47]
    s_cmp_ge_u32 s21, 131072
    s_cselect_b32 s22, 0xfffe0000, s29
    v_mfma_f32_16x16x32_bf16 v[40:43], a[120:123], v[100:103], v[40:43]
    s_add_u32 s21, s21, s22
    s_waitcnt lgkmcnt(4)
    v_mfma_f32_16x16x32_bf16 v[32:35], a[128:131], v[72:75], v[32:35]
    ds_read_b128 v[96:99], v4 offset:3072
    s_lshl_b32 s61, s41, 13
    v_mfma_f32_16x16x32_bf16 v[36:39], a[132:135], v[72:75], v[36:39]
    ds_read_b128 v[100:103], v5 offset:3072
    s_and_b32 s61, s61, 0x2000
    v_mfma_f32_16x16x32_bf16 v[44:47], a[132:135], v[76:79], v[44:47]
    s_xor_b32 s61, s61, s31
    s_lshl_b32 s37, s41, 21
    v_mfma_f32_16x16x32_bf16 v[40:43], a[128:131], v[76:79], v[40:43]
    s_add_u32 s37, s37, s61
    s_waitcnt lgkmcnt(4)
    v_mfma_f32_16x16x32_bf16 v[32:35], a[136:139], v[80:83], v[32:35]
    ds_read_b128 v[72:75], v4 offset:8192
    s_cmp_gt_u32 s41, s35
    v_mfma_f32_16x16x32_bf16 v[36:39], a[140:143], v[80:83], v[36:39]
    ds_read_b128 v[76:79], v5 offset:8192
    s_cselect_b32 s37, 0xe000000, s37
    v_mfma_f32_16x16x32_bf16 v[44:47], a[140:143], v[84:87], v[44:47]
    s_add_u32 s37, s37, s38
    buffer_load_dwordx4 v2, s[8:11], s23 offen offset:1024 lds
    v_mfma_f32_16x16x32_bf16 v[40:43], a[136:139], v[84:87], v[40:43]
    buffer_load_dwordx4 v2, s[8:11], s23 offen offset:2048 lds
    s_waitcnt lgkmcnt(4)
    v_mfma_f32_16x16x32_bf16 v[32:35], a[144:147], v[88:91], v[32:35]
    ds_read_b128 v[80:83], v4 offset:9216
    global_load_dword v19, v[16:17], off sc1
    v_mfma_f32_16x16x32_bf16 v[36:39], a[148:151], v[88:91], v[36:39]
    ds_read_b128 v[84:87], v5 offset:9216
    v_mfma_f32_16x16x32_bf16 v[44:47], a[148:151], v[92:95], v[44:47]
    v_mfma_f32_16x16x32_bf16 v[40:43], a[144:147], v[92:95], v[40:43]
    buffer_load_dwordx4 v2, s[8:11], s23 offen offset:3072 lds
    s_waitcnt lgkmcnt(4)
    v_mfma_f32_16x16x32_bf16 v[32:35], a[152:155], v[96:99], v[32:35]
    ds_read_b128 v[88:91], v4 offset:10240
    s_add_u32 s20, s20, 32768
    v_mfma_f32_16x16x32_bf16 v[36:39], a[156:159], v[96:99], v[36:39]
    ds_read_b128 v[92:95], v5 offset:10240
    s_cmp_ge_u32 s20, 163840
    v_mfma_f32_16x16x32_bf16 v[44:47], a[156:159], v[100:103], v[44:47]
    s_cselect_b32 s60, 163840, 0
    s_sub_u32 s20, s20, s60
    v_mfma_f32_16x16x32_bf16 v[40:43], a[152:155], v[100:103], v[40:43]
    s_lshl_b32 s61, s33, 13
    s_waitcnt lgkmcnt(4)
    v_mfma_f32_16x16x32_bf16 v[32:35], a[160:163], v[72:75], v[32:35]
    ds_read_b128 v[96:99], v4 offset:11264
    s_and_b32 s61, s61, 0x2000
    v_mfma_f32_16x16x32_bf16 v[36:39], a[164:167], v[72:75], v[36:39]
    ds_read_b128 v[100:103], v5 offset:11264
    s_xor_b32 s61, s61, s31
    v_mfma_f32_16x16x32_bf16 v[44:47], a[164:167], v[76:79], v[44:47]
    s_lshl_b32 s23, s33, 21
    s_add_u32 s23, s23, s61
    v_mfma_f32_16x16x32_bf16 v[40:43], a[160:163], v[76:79], v[40:43]
    s_cmp_gt_u32 s33, s35
    s_waitcnt lgkmcnt(4)
    v_mfma_f32_16x16x32_bf16 v[32:35], a[168:171], v[80:83], v[32:35]
    ds_read_b128 v[72:75], v4 offset:16384
    s_cselect_b32 s23, 0xe000000, s23
    v_mfma_f32_16x16x32_bf16 v[36:39], a[172:175], v[80:83], v[36:39]
    ds_read_b128 v[76:79], v5 offset:16384
    s_add_u32 m0, s20, 0
    v_mfma_f32_16x16x32_bf16 v[44:47], a[172:175], v[84:87], v[44:47]
    buffer_load_dwordx4 v1, s[8:11], s23 offen offset:0 lds
    v_mfma_f32_16x16x32_bf16 v[40:43], a[168:171], v[84:87], v[40:43]
    buffer_load_dwordx4 v1, s[8:11], s23 offen offset:1024 lds
    s_waitcnt lgkmcnt(4)
    v_mfma_f32_16x16x32_bf16 v[32:35], a[176:179], v[88:91], v[32:35]
    ds_read_b128 v[80:83], v4 offset:17408
    v_mfma_f32_16x16x32_bf16 v[36:39], a[180:183], v[88:91], v[36:39]
    ds_read_b128 v[84:87], v5 offset:17408
    v_mfma_f32_16x16x32_bf16 v[44:47], a[180:183], v[92:95], v[44:47]
    buffer_load_dwordx4 v1, s[8:11], s23 offen offset:2048 lds
    v_mfma_f32_16x16x32_bf16 v[40:43], a[176:179], v[92:95], v[40:43]
    s_waitcnt lgkmcnt(4)
    v_mfma_f32_16x16x32_bf16 v[32:35], a[184:187], v[96:99], v[32:35]
    ds_read_b128 v[88:91], v4 offset:18432
    v_mfma_f32_16x16x32_bf16 v[36:39], a[188:191], v[96:99], v[36:39]
    ds_read_b128 v[92:95], v5 offset:18432
    v_mfma_f32_16x16x32_bf16 v[44:47], a[188:191], v[100:103], v[44:47]
    v_mfma_f32_16x16x32_bf16 v[40:43], a[184:187], v[100:103], v[40:43]
    buffer_load_dwordx4 v1, s[8:11], s23 offen offset:3072 lds
    s_waitcnt lgkmcnt(4)
    v_mfma_f32_16x16x32_bf16 v[32:35], a[192:195], v[72:75], v[32:35]
    ds_read_b128 v[96:99], v4 offset:19456
    s_waitcnt vmcnt(5)
    v_cmp_lt_u32 vcc, v19, v18
    v_mfma_f32_16x16x32_bf16 v[36:39], a[196:199], v[72:75], v[36:39]
    ds_read_b128 v[100:103], v5 offset:19456
    v_mfma_f32_16x16x32_bf16 v[44:47], a[196:199], v[76:79], v[44:47]
    v_mfma_f32_16x16x32_bf16 v[40:43], a[192:195], v[76:79], v[40:43]
    s_cbranch_vccnz seg_pslow
seg_pok:
    s_waitcnt lgkmcnt(4)
    v_mfma_f32_16x16x32_bf16 v[32:35], a[200:203], v[80:83], v[32:35]
    ds_read_b128 v[72:75], v4 offset:24576
    buffer_load_dwordx4 v[104:107], v23, s[8:11], s24 offen offset:0 sc1
    v_mfma_f32_16x16x32_bf16 v[36:39], a[204:207], v[80:83], v[36:39]
    ds_read_b128 v[76:79], v5 offset:24576
    buffer_load_dwordx4 v[108:111], v23, s[8:11], s24 offen offset:1024 sc1
    v_mfma_f32_16x16x32_bf16 v[44:47], a[204:207], v[84:87], v[44:47]
    buffer_load_dwordx4 v[112:115], v23, s[8:11], s24 offen offset:2048 sc1
    v_mfma_f32_16x16x32_bf16 v[40:43], a[200:203], v[84:87], v[40:43]
    s_add_u32 m0, s20, 4096
    s_waitcnt lgkmcnt(4)
    v_mfma_f32_16x16x32_bf16 v[32:35], a[208:211], v[88:91], v[32:35]
    ds_read_b128 v[80:83], v4 offset:25600
    buffer_load_dwordx4 v2, s[8:11], s23 offen offset:0 lds
    v_mfma_f32_16x16x32_bf16 v[36:39], a[212:215], v[88:91], v[36:39]
    ds_read_b128 v[84:87], v5 offset:25600
    buffer_load_dwordx4 v2, s[8:11], s23 offen offset:1024 lds
    v_mfma_f32_16x16x32_bf16 v[44:47], a[212:215], v[92:95], v[44:47]
    v_mfma_f32_16x16x32_bf16 v[40:43], a[208:211], v[92:95], v[40:43]
    s_waitcnt lgkmcnt(4)
    v_mfma_f32_16x16x32_bf16 v[32:35], a[216:219], v[96:99], v[32:35]
    ds_read_b128 v[88:91], v4 offset:26624
    v_mfma_f32_16x16x32_bf16 v[36:39], a[220:223], v[96:99], v[36:39]
    ds_read_b128 v[92:95], v5 offset:26624
    v_mfma_f32_16x16x32_bf16 v[44:47], a[220:223], v[100:103], v[44:47]
    buffer_load_dwordx4 v2, s[8:11], s23 offen offset:2048 lds
    v_mfma_f32_16x16x32_bf16 v[40:43], a[216:219], v[100:103], v[40:43]
    s_waitcnt lgkmcnt(4)
    v_mfma_f32_16x16x32_bf16 v[32:35], a[224:227], v[72:75], v[32:35]
    ds_read_b128 v[96:99], v4 offset:27648
    v_mfma_f32_16x16x32_bf16 v[36:39], a[228:231], v[72:75], v[36:39]
    ds_read_b128 v[100:103], v5 offset:27648
    v_mfma_f32_16x16x32_bf16 v[44:47], a[228:231], v[76:79], v[44:47]
    v_add_u32 v4, s22, v4
    v_add_u32 v5, s22, v5
    v_mfma_f32_16x16x32_bf16 v[40:43], a[224:227], v[76:79], v[40:43]
    buffer_load_dwordx4 v2, s[8:11], s23 offen offset:3072 lds
    s_waitcnt vmcnt(26)
    s_barrier
    s_waitcnt lgkmcnt(4)
    v_mfma_f32_16x16x32_bf16 v[32:35], a[232:235], v[80:83], v[32:35]
    ds_read_b128 v[72:75], v4 offset:0
    s_add_u32 s20, s20, 32768
    s_cmp_ge_u32 s20, 163840
    v_mfma_f32_16x16x32_bf16 v[36:39], a[236:239], v[80:83], v[36:39]
    ds_read_b128 v[76:79], v5 offset:0
    s_cselect_b32 s60, 163840, 0
    s_sub_u32 s20, s20, s60
    v_mfma_f32_16x16x32_bf16 v[44:47], a[236:239], v[84:87], v[44:47]
    s_add_u32 s23, s23, 0x40000
    v_mfma_f32_16x16x32_bf16 v[40:43], a[232:235], v[84:87], v[40:43]
    s_waitcnt lgkmcnt(4)
    v_mfma_f32_16x16x32_bf16 v[32:35], a[240:243], v[88:91], v[32:35]
    ds_read_b128 v[80:83], v4 offset:1024
    v_mfma_f32_16x16x32_bf16 v[36:39], a[244:247], v[88:91], v[36:39]
    ds_read_b128 v[84:87], v5 offset:1024
    v_mfma_f32_16x16x32_bf16 v[44:47], a[244:247], v[92:95], v[44:47]
    v_mfma_f32_16x16x32_bf16 v[40:43], a[240:243], v[92:95], v[40:43]
    s_waitcnt lgkmcnt(4)
    v_mfma_f32_16x16x32_bf16 v[48:51], a[248:251], v[96:99], v[32:35]
    ds_read_b128 v[88:91], v4 offset:2048
    v_mfma_f32_16x16x32_bf16 v[52:55], a[252:255], v[96:99], v[36:39]
    ds_read_b128 v[92:95], v5 offset:2048
    v_mfma_f32_16x16x32_bf16 v[60:63], a[252:255], v[100:103], v[44:47]
    s_cmp_lt_u32 s26, s39
    v_mfma_f32_16x16x32_bf16 v[56:59], a[248:251], v[100:103], v[40:43]
    s_cbranch_scc1 seg_p
    s_xor_b32 s24, s24, 0x80000
    s_waitcnt vmcnt(0)
    v_pk_add_f32 v[104:105], v[104:105], v[64:65]
    v_pk_add_f32 v[106:107], v[106:107], v[66:67]
    v_pk_add_f32 v[108:109], v[108:109], v[112:113]
    v_pk_add_f32 v[110:111], v[110:111], v[114:115]
    v_pk_add_f32 v[104:105], v[104:105], v[108:109]
    v_pk_add_f32 v[106:107], v[106:107], v[110:111]
    v_cvt_pk_bf16_f32 v104, 0, v104
    v_cvt_pk_bf16_f32 v105, 0, v105
    v_cvt_pk_bf16_f32 v106, 0, v106
    v_cvt_pk_bf16_f32 v107, 0, v107
    buffer_store_dwordx4 v[104:107], v15, s[16:19], s25 offen
    buffer_store_dwordx4 v[48:51], v20, s[8:11], s24 offen
    buffer_store_dwordx4 v[52:55], v21, s[8:11], s24 offen
    buffer_store_dwordx4 v[56:59], v22, s[8:11], s24 offen
    s_lshl_b32 s25, s35, 18
    s_waitcnt vmcnt(0)
    s_barrier
    s_add_u32 s26, s26, 1
    v_mov_b32 v12, s26
    buffer_store_dword v12, v11, s[8:11], s27 offen
    v_mov_b32 v18, s26
    v_writelane_b32 v18, s34, 32
    v_writelane_b32 v18, s40, 33
L_sp_84:
    global_load_dword v19, v[16:17], off sc1
    s_add_u32 s30, s30, 1
    s_cmp_gt_u32 s30, 0x200000
    s_cbranch_scc1 chain_kernel_wabort
    s_waitcnt vmcnt(0)
    v_cmp_lt_u32 vcc, v19, v18
    s_cbranch_vccz L_spok_85
    s_branch L_sp_84
L_spok_85:
    buffer_load_dwordx4 v[104:107], v23, s[8:11], s24 offen offset:0 sc1
    buffer_load_dwordx4 v[108:111], v23, s[8:11], s24 offen offset:1024 sc1
    buffer_load_dwordx4 v[112:115], v23, s[8:11], s24 offen offset:2048 sc1
    s_waitcnt vmcnt(0) lgkmcnt(0)
    v_pk_add_f32 v[104:105], v[104:105], v[60:61]
    v_pk_add_f32 v[106:107], v[106:107], v[62:63]
    v_pk_add_f32 v[108:109], v[108:109], v[112:113]
    v_pk_add_f32 v[110:111], v[110:111], v[114:115]
    v_pk_add_f32 v[104:105], v[104:105], v[108:109]
    v_pk_add_f32 v[106:107], v[106:107], v[110:111]
    v_cvt_pk_bf16_f32 v104, 0, v104
    v_cvt_pk_bf16_f32 v105, 0, v105
    v_cvt_pk_bf16_f32 v106, 0, v106
    v_cvt_pk_bf16_f32 v107, 0, v107
    buffer_store_dwordx4 v[104:107], v15, s[16:19], s25 offen
seg_t0:
    s_mov_b32 s35, 63
    s_lshr_b32 s60, s57, 3
    s_lshl_b32 s60, s60, 8
    s_add_u32 s60, s60, 0xd201000
    s_add_u32 s37, s60, s100
    s_addc_u32 s38, s101, 0
seg_t:
    s_and_b32 s33, s36, 0xff
    s_cbranch_scc0 seg_end
    s_lshr_b32 s36, s36, 8
    s_lshl_b32 s20, s58, 13
    s_mov_b32 s21, 0
    s_lshr_b32 s60, s57, 4
    s_lshl_b32 s60, s60, 12
    v_add_u32 v5, s60, v1
    v_xor_b32 v4, 4096, v5
    s_lshl_b32 s61, s33, 13
    s_and_b32 s61, s61, 0x2000
    s_xor_b32 s61, s61, s31
    s_lshl_b32 s23, s33, 21
    s_add_u32 s23, s23, s61
    s_cmp_gt_u32 s33, s35
    s_cselect_b32 s23, 0xe000000, s23
    s_xor_b32 s24, s24, 0x80000
    s_lshl_b32 s25, s33, 18
    s_add_u32 s34, s33, 3
    s_min_u32 s34, s34, 64
    v_mov_b32 v18, s26
    v_writelane_b32 v18, s34, 32
    v_writelane_b32 v18, s40, 33
L_sp_86:
    global_load_dword v19, v[16:17], off sc1
    s_add_u32 s30, s30, 1
    s_cmp_gt_u32 s30, 0x200000
    s_cbranch_scc1 chain_kernel_wabort
    s_waitcnt vmcnt(0)
    v_cmp_lt_u32 vcc, v19, v18
    s_cbranch_vccz L_spok_87
    s_sleep 2
    s_branch L_sp_86
L_spok_87:
    s_cmp_lt_u32 s33, 62
    s_cbranch_scc1 L_tf_88
    v_writelane_b32 v16, s37, 33
    v_writelane_b32 v17, s38, 33
    s_mov_b32 s40, 32
    v_mov_b32 v18, s26
    v_writelane_b32 v18, s34, 32
    v_writelane_b32 v18, s40, 33
L_sp_89:
    global_load_dword v19, v[16:17], off sc1
    s_add_u32 s30, s30, 1
    s_cmp_gt_u32 s30, 0x200000
    s_cbranch_scc1 chain_kernel_wabort
    s_waitcnt vmcnt(0)
    v_cmp_lt_u32 vcc, v19, v18
    s_cbranch_vccz L_spok_90
    s_branch L_sp_89
L_spok_90:
L_tf_88:
    s_add_u32 m0, s20, 0
    s_nop 0
    buffer_load_dwordx4 v1, s[8:11], s23 offen offset:0 lds
    buffer_load_dwordx4 v1, s[8:11], s23 offen offset:1024 lds
    buffer_load_dwordx4 v1, s[8:11], s23 offen offset:2048 lds
    buffer_load_dwordx4 v1, s[8:11], s23 offen offset:3072 lds
    s_add_u32 m0, s20, 4096
    s_nop 0
    buffer_load_dwordx4 v2, s[8:11], s23 offen offset:0 lds
    buffer_load_dwordx4 v2, s[8:11], s23 offen offset:1024 lds
    buffer_load_dwordx4 v2, s[8:11], s23 offen offset:2048 lds
    buffer_load_dwordx4 v2, s[8:11], s23 offen offset:3072 lds
    s_add_u32 s20, s20, 32768
    s_cmp_ge_u32 s20, 163840
    s_cselect_b32 s60, 163840, 0
    s_sub_u32 s20, s20, s60
    s_add_u32 s23, s23, 0x40000
    s_add_u32 m0, s20, 0
    s_nop 0
    buffer_load_dwordx4 v1, s[8:11], s23 offen offset:0 lds
    buffer_load_dwordx4 v1, s[8:11], s23 offen offset:1024 lds
    buffer_load_dwordx4 v1, s[8:11], s23 offen offset:2048 lds
    buffer_load_dwordx4 v1, s[8:11], s23 offen offset:3072 lds
    s_add_u32 m0, s20, 4096
    s_nop 0
    buffer_load_dwordx4 v2, s[8:11], s23 offen offset:0 lds
    buffer_load_dwordx4 v2, s[8:11], s23 offen offset:1024 lds
    buffer_load_dwordx4 v2, s[8:11], s23 offen offset:2048 lds
    buffer_load_dwordx4 v2, s[8:11], s23 offen offset:3072 lds
    s_waitcnt vmcnt(8)
    s_barrier
    ds_read_b128 v[72:75], v4 offset:0
    ds_read_b128 v[76:79], v5 offset:0
    ds_read_b128 v[80:83], v4 offset:1024
    ds_read_b128 v[84:87], v5 offset:1024
    ds_read_b128 v[88:91], v4 offset:2048
    ds_read_b128 v[92:95], v5 offset:2048
    s_waitcnt lgkmcnt(4)
    v_mfma_f32_16x16x32_bf16 v[32:35], a[0:3], v[72:75], 0
    ds_read_b128 v[96:99], v4 offset:3072
    v_mfma_f32_16x16x32_bf16 v[36:39], a[4:7], v[72:75], 0
    ds_read_b128 v[100:103], v5 offset:3072
    v_mfma_f32_16x16x32_bf16 v[44:47], a[4:7], v[76:79], 0
    v_mfma_f32_16x16x32_bf16 v[40:43], a[0:3], v[76:79], 0
    s_waitcnt lgkmcnt(4)
    v_mfma_f32_16x16x32_bf16 v[32:35], a[8:11], v[80:83], v[32:35]
    ds_read_b128 v[72:75], v4 offset:8192
    v_mfma_f32_16x16x32_bf16 v[36:39], a[12:15], v[80:83], v[36:39]
    ds_read_b128 v[76:79], v5 offset:8192
    v_mfma_f32_16x16x32_bf16 v[44:47], a[12:15], v[84:87], v[44:47]
    v_mfma_f32_16x16x32_bf16 v[40:43], a[8:11], v[84:87], v[40:43]
    s_waitcnt lgkmcnt(4)
    v_mfma_f32_16x16x32_bf16 v[32:35], a[16:19], v[88:91], v[32:35]
    ds_read_b128 v[80:83], v4 offset:9216
    v_mfma_f32_16x16x32_bf16 v[36:39], a[20:23], v[88:91], v[36:39]
    ds_read_b128 v[84:87], v5 offset:9216
    v_mfma_f32_16x16x32_bf16 v[44:47], a[20:23], v[92:95], v[44:47]
    v_mfma_f32_16x16x32_bf16 v[40:43], a[16:19], v[92:95], v[40:43]
    s_waitcnt lgkmcnt(4)
    v_mfma_f32_16x16x32_bf16 v[32:35], a[24:27], v[96:99], v[32:35]
    ds_read_b128 v[88:91], v4 offset:10240
    v_mfma_f32_16x16x32_bf16 v[36:39], a[28:31], v[96:99], v[36:39]
    ds_read_b128 v[92:95], v5 offset:10240
    v_mfma_f32_16x16x32_bf16 v[44:47], a[28:31], v[100:103], v[44:47]
    v_mfma_f32_16x16x32_bf16 v[40:43], a[24:27], v[100:103], v[40:43]
    s_waitcnt lgkmcnt(4)
    v_mfma_f32_16x16x32_bf16 v[32:35], a[32:35], v[72:75], v[32:35]
    ds_read_b128 v[96:99], v4 offset:11264
    v_mfma_f32_16x16x32_bf16 v[36:39], a[36:39], v[72:75], v[36:39]
    ds_read_b128 v[100:103], v5 offset:11264
    v_mfma_f32_16x16x32_bf16 v[44:47], a[36:39], v[76:79], v[44:47]
    v_mfma_f32_16x16x32_bf16 v[40:43], a[32:35], v[76:79], v[40:43]
    s_waitcnt lgkmcnt(4)
    v_mfma_f32_16x16x32_bf16 v[32:35], a[40:43], v[80:83], v[32:35]
    ds_read_b128 v[72:75], v4 offset:16384
    v_mfma_f32_16x16x32_bf16 v[36:39], a[44:47], v[80:83], v[36:39]
    ds_read_b128 v[76:79], v5 offset:16384
    v_mfma_f32_16x16x32_bf16 v[44:47], a[44:47], v[84:87], v[44:47]
    v_mfma_f32_16x16x32_bf16 v[40:43], a[40:43], v[84:87], v[40:43]
    s_waitcnt lgkmcnt(4)
    v_mfma_f32_16x16x32_bf16 v[32:35], a[48:51], v[88:91], v[32:35]
    ds_read_b128 v[80:83], v4 offset:17408
    v_mfma_f32_16x16x32_bf16 v[36:39], a[52:55], v[88:91], v[36:39]
    ds_read_b128 v[84:87], v5 offset:17408
    v_mfma_f32_16x16x32_bf16 v[44:47], a[52:55], v[92:95], v[44:47]
    v_mfma_f32_16x16x32_bf16 v[40:43], a[48:51], v[92:95], v[40:43]
    s_waitcnt lgkmcnt(4)
    v_mfma_f32_16x16x32_bf16 v[32:35], a[56:59], v[96:99], v[32:35]
    ds_read_b128 v[88:91], v4 offset:18432
    v_mfma_f32_16x16x32_bf16 v[36:39], a[60:63], v[96:99], v[36:39]
    ds_read_b128 v[92:95], v5 offset:18432
    v_mfma_f32_16x16x32_bf16 v[44:47], a[60:63], v[100:103], v[44:47]
    v_mfma_f32_16x16x32_bf16 v[40:43], a[56:59], v[100:103], v[40:43]
    s_waitcnt lgkmcnt(4)
    v_mfma_f32_16x16x32_bf16 v[32:35], a[64:67], v[72:75], v[32:35]
    ds_read_b128 v[96:99], v4 offset:19456
    v_mfma_f32_16x16x32_bf16 v[36:39], a[68:71], v[72:75], v[36:39]
    ds_read_b128 v[100:103], v5 offset:19456
    v_mfma_f32_16x16x32_bf16 v[44:47], a[68:71], v[76:79], v[44:47]
    v_mfma_f32_16x16x32_bf16 v[40:43], a[64:67], v[76:79], v[40:43]
    s_waitcnt lgkmcnt(4)
    v_mfma_f32_16x16x32_bf16 v[32:35], a[72:75], v[80:83], v[32:35]
    ds_read_b128 v[72:75], v4 offset:24576
    v_mfma_f32_16x16x32_bf16 v[36:39], a[76:79], v[80:83], v[36:39]
    ds_read_b128 v[76:79], v5 offset:24576
    v_mfma_f32_16x16x32_bf16 v[44:47], a[76:79], v[84:87], v[44:47]
    v_mfma_f32_16x16x32_bf16 v[40:43], a[72:75], v[84:87], v[40:43]
    s_waitcnt lgkmcnt(4)
    v_mfma_f32_16x16x32_bf16 v[32:35], a[80:83], v[88:91], v[32:35]
    ds_read_b128 v[80:83], v4 offset:25600
    v_mfma_f32_16x16x32_bf16 v[36:39], a[84:87], v[88:91], v[36:39]
    ds_read_b128 v[84:87], v5 offset:25600
    v_mfma_f32_16x16x32_bf16 v[44:47], a[84:87], v[92:95], v[44:47]
    v_mfma_f32_16x16x32_bf16 v[40:43], a[80:83], v[92:95], v[40:43]
    s_waitcnt lgkmcnt(4)
    v_mfma_f32_16x16x32_bf16 v[32:35], a[88:91], v[96:99], v[32:35]
    ds_read_b128 v[88:91], v4 offset:26624
    v_mfma_f32_16x16x32_bf16 v[36:39], a[92:95], v[96:99], v[36:39]
    ds_read_b128 v[92:95], v5 offset:26624
    v_mfma_f32_16x16x32_bf16 v[44:47], a[92:95], v[100:103], v[44:47]
    v_mfma_f32_16x16x32_bf16 v[40:43], a[88:91], v[100:103], v[40:43]
    s_waitcnt lgkmcnt(4)
    v_mfma_f32_16x16x32_bf16 v[32:35], a[96:99], v[72:75], v[32:35]
    ds_read_b128 v[96:99], v4 offset:27648
    v_mfma_f32_16x16x32_bf16 v[36:39], a[100:103], v[72:75], v[36:39]
    ds_read_b128 v[100:103], v5 offset:27648
    v_mfma_f32_16x16x32_bf16 v[44:47], a[100:103], v[76:79], v[44:47]
    v_mfma_f32_16x16x32_bf16 v[40:43], a[96:99], v[76:79], v[40:43]
    s_waitcnt vmcnt(0)
    s_barrier
    s_waitcnt lgkmcnt(4)
    v_mfma_f32_16x16x32_bf16 v[32:35], a[104:107], v[80:83], v[32:35]
    ds_read_b128 v[72:75], v4 offset:32768
    v_mfma_f32_16x16x32_bf16 v[36:39], a[108:111], v[80:83], v[36:39]
    ds_read_b128 v[76:79], v5 offset:32768
    v_mfma_f32_16x16x32_bf16 v[44:47], a[108:111], v[84:87], v[44:47]
    v_mfma_f32_16x16x32_bf16 v[40:43], a[104:107], v[84:87], v[40:43]
    s_waitcnt lgkmcnt(4)
    v_mfma_f32_16x16x32_bf16 v[32:35], a[112:115], v[88:91], v[32:35]
    ds_read_b128 v[80:83], v4 offset:33792
    v_mfma_f32_16x16x32_bf16 v[36:39], a[116:119], v[88:91], v[36:39]
    ds_read_b128 v[84:87], v5 offset:33792
    v_mfma_f32_16x16x32_bf16 v[44:47], a[116:119], v[92:95], v[44:47]
    v_mfma_f32_16x16x32_bf16 v[40:43], a[112:115], v[92:95], v[40:43]
    s_waitcnt lgkmcnt(4)
    v_mfma_f32_16x16x32_bf16 v[32:35], a[120:123], v[96:99], v[32:35]
    ds_read_b128 v[88:91], v4 offset:34816
    v_mfma_f32_16x16x32_bf16 v[36:39], a[124:127], v[96:99], v[36:39]
    ds_read_b128 v[92:95], v5 offset:34816
    v_mfma_f32_16x16x32_bf16 v[44:47], a[124:127], v[100:103], v[44:47]
    v_mfma_f32_16x16x32_bf16 v[40:43], a[120:123], v[100:103], v[40:43]
    s_waitcnt lgkmcnt(4)
    v_mfma_f32_16x16x32_bf16 v[32:35], a[128:131], v[72:75], v[32:35]
    ds_read_b128 v[96:99], v4 offset:35840
    v_mfma_f32_16x16x32_bf16 v[36:39], a[132:135], v[72:75], v[36:39]
    ds_read_b128 v[100:103], v5 offset:35840
    v_mfma_f32_16x16x32_bf16 v[44:47], a[132:135], v[76:79], v[44:47]
    v_mfma_f32_16x16x32_bf16 v[40:43], a[128:131], v[76:79], v[40:43]
    s_waitcnt lgkmcnt(4)
    v_mfma_f32_16x16x32_bf16 v[32:35], a[136:139], v[80:83], v[32:35]
    ds_read_b128 v[72:75], v4 offset:40960
    v_mfma_f32_16x16x32_bf16 v[36:39], a[140:143], v[80:83], v[36:39]
    ds_read_b128 v[76:79], v5 offset:40960
    v_mfma_f32_16x16x32_bf16 v[44:47], a[140:143], v[84:87], v[44:47]
    v_mfma_f32_16x16x32_bf16 v[40:43], a[136:139], v[84:87], v[40:43]
    s_waitcnt lgkmcnt(4)
    v_mfma_f32_16x16x32_bf16 v[32:35], a[144:147], v[88:91], v[32:35]
    ds_read_b128 v[80:83], v4 offset:41984
    v_mfma_f32_16x16x32_bf16 v[36:39], a[148:151], v[88:91], v[36:39]
    ds_read_b128 v[84:87], v5 offset:41984
    v_mfma_f32_16x16x32_bf16 v[44:47], a[148:151], v[92:95], v[44:47]
    v_mfma_f32_16x16x32_bf16 v[40:43], a[144:147], v[92:95], v[40:43]
    s_waitcnt lgkmcnt(4)
    v_mfma_f32_16x16x32_bf16 v[32:35], a[152:155], v[96:99], v[32:35]
    ds_read_b128 v[88:91], v4 offset:43008
    v_mfma_f32_16x16x32_bf16 v[36:39], a[156:159], v[96:99], v[36:39]
    ds_read_b128 v[92:95], v5 offset:43008
    v_mfma_f32_16x16x32_bf16 v[44:47], a[156:159], v[100:103], v[44:47]
    v_mfma_f32_16x16x32_bf16 v[40:43], a[152:155], v[100:103], v[40:43]
    s_waitcnt lgkmcnt(4)
    v_mfma_f32_16x16x32_bf16 v[32:35], a[160:163], v[72:75], v[32:35]
    ds_read_b128 v[96:99], v4 offset:44032
    v_mfma_f32_16x16x32_bf16 v[36:39], a[164:167], v[72:75], v[36:39]
    ds_read_b128 v[100:103], v5 offset:44032
    v_mfma_f32_16x16x32_bf16 v[44:47], a[164:167], v[76:79], v[44:47]
    v_mfma_f32_16x16x32_bf16 v[40:43], a[160:163], v[76:79], v[40:43]
    s_waitcnt lgkmcnt(4)
    v_mfma_f32_16x16x32_bf16 v[32:35], a[168:171], v[80:83], v[32:35]
    ds_read_b128 v[72:75], v4 offset:49152
    v_mfma_f32_16x16x32_bf16 v[36:39], a[172:175], v[80:83], v[36:39]
    ds_read_b128 v[76:79], v5 offset:49152
    v_mfma_f32_16x16x32_bf16 v[44:47], a[172:175], v[84:87], v[44:47]
    v_mfma_f32_16x16x32_bf16 v[40:43], a[168:171], v[84:87], v[40:43]
    s_waitcnt lgkmcnt(4)
    v_mfma_f32_16x16x32_bf16 v[32:35], a[176:179], v[88:91], v[32:35]
    ds_read_b128 v[80:83], v4 offset:50176
    v_mfma_f32_16x16x32_bf16 v[36:39], a[180:183], v[88:91], v[36:39]
    ds_read_b128 v[84:87], v5 offset:50176
    v_mfma_f32_16x16x32_bf16 v[44:47], a[180:183], v[92:95], v[44:47]
    v_mfma_f32_16x16x32_bf16 v[40:43], a[176:179], v[92:95], v[40:43]
    s_waitcnt lgkmcnt(4)
    v_mfma_f32_16x16x32_bf16 v[32:35], a[184:187], v[96:99], v[32:35]
    ds_read_b128 v[88:91], v4 offset:51200
    v_mfma_f32_16x16x32_bf16 v[36:39], a[188:191], v[96:99], v[36:39]
    ds_read_b128 v[92:95], v5 offset:51200
    v_mfma_f32_16x16x32_bf16 v[44:47], a[188:191], v[100:103], v[44:47]
    v_mfma_f32_16x16x32_bf16 v[40:43], a[184:187], v[100:103], v[40:43]
    s_waitcnt lgkmcnt(4)
    v_mfma_f32_16x16x32_bf16 v[32:35], a[192:195], v[72:75], v[32:35]
    ds_read_b128 v[96:99], v4 offset:52224
    v_mfma_f32_16x16x32_bf16 v[36:39], a[196:199], v[72:75], v[36:39]
    ds_read_b128 v[100:103], v5 offset:52224
    v_mfma_f32_16x16x32_bf16 v[44:47], a[196:199], v[76:79], v[44:47]
    v_mfma_f32_16x16x32_bf16 v[40:43], a[192:195], v[76:79], v[40:43]
    s_waitcnt lgkmcnt(4)
    v_mfma_f32_16x16x32_bf16 v[32:35], a[200:203], v[80:83], v[32:35]
    ds_read_b128 v[72:75], v4 offset:57344
    v_mfma_f32_16x16x32_bf16 v[36:39], a[204:207], v[80:83], v[36:39]
    ds_read_b128 v[76:79], v5 offset:57344
    v_mfma_f32_16x16x32_bf16 v[44:47], a[204:207], v[84:87], v[44:47]
    v_mfma_f32_16x16x32_bf16 v[40:43], a[200:203], v[84:87], v[40:43]
    s_waitcnt lgkmcnt(4)
    v_mfma_f32_16x16x32_bf16 v[32:35], a[208:211], v[88:91], v[32:35]
    ds_read_b128 v[80:83], v4 offset:58368
    v_mfma_f32_16x16x32_bf16 v[36:39], a[212:215], v[88:91], v[36:39]
    ds_read_b128 v[84:87], v5 offset:58368
    v_mfma_f32_16x16x32_bf16 v[44:47], a[212:215], v[92:95], v[44:47]
    v_mfma_f32_16x16x32_bf16 v[40:43], a[208:211], v[92:95], v[40:43]
    s_waitcnt lgkmcnt(4)
    v_mfma_f32_16x16x32_bf16 v[32:35], a[216:219], v[96:99], v[32:35]
    ds_read_b128 v[88:91], v4 offset:59392
    v_mfma_f32_16x16x32_bf16 v[36:39], a[220:223], v[96:99], v[36:39]
    ds_read_b128 v[92:95], v5 offset:59392
    v_mfma_f32_16x16x32_bf16 v[44:47], a[220:223], v[100:103], v[44:47]
    v_mfma_f32_16x16x32_bf16 v[40:43], a[216:219], v[100:103], v[40:43]
    s_waitcnt lgkmcnt(4)
    v_mfma_f32_16x16x32_bf16 v[32:35], a[224:227], v[72:75], v[32:35]
    ds_read_b128 v[96:99], v4 offset:60416
    v_mfma_f32_16x16x32_bf16 v[36:39], a[228:231], v[72:75], v[36:39]
    ds_read_b128 v[100:103], v5 offset:60416
    v_mfma_f32_16x16x32_bf16 v[44:47], a[228:231], v[76:79], v[44:47]
    v_mfma_f32_16x16x32_bf16 v[40:43], a[224:227], v[76:79], v[40:43]
    s_waitcnt lgkmcnt(4)
    v_mfma_f32_16x16x32_bf16 v[32:35], a[232:235], v[80:83], v[32:35]
    v_mfma_f32_16x16x32_bf16 v[36:39], a[236:239], v[80:83], v[36:39]
    v_mfma_f32_16x16x32_bf16 v[44:47], a[236:239], v[84:87], v[44:47]
    v_mfma_f32_16x16x32_bf16 v[40:43], a[232:235], v[84:87], v[40:43]
    s_waitcnt lgkmcnt(2)
    v_mfma_f32_16x16x32_bf16 v[32:35], a[240:243], v[88:91], v[32:35]
    v_mfma_f32_16x16x32_bf16 v[36:39], a[244:247], v[88:91], v[36:39]
    v_mfma_f32_16x16x32_bf16 v[44:47], a[244:247], v[92:95], v[44:47]
    v_mfma_f32_16x16x32_bf16 v[40:43], a[240:243], v[92:95], v[40:43]
    s_waitcnt lgkmcnt(0)
    v_mfma_f32_16x16x32_bf16 v[48:51], a[248:251], v[96:99], v[32:35]
    v_mfma_f32_16x16x32_bf16 v[52:55], a[252:255], v[96:99], v[36:39]
    v_mfma_f32_16x16x32_bf16 v[60:63], a[252:255], v[100:103], v[44:47]
    v_mfma_f32_16x16x32_bf16 v[56:59], a[248:251], v[100:103], v[40:43]
    s_nop 7
    buffer_store_dwordx4 v[48:51], v20, s[8:11], s24 offen
    buffer_store_dwordx4 v[52:55], v21, s[8:11], s24 offen
    buffer_store_dwordx4 v[56:59], v22, s[8:11], s24 offen
    s_waitcnt vmcnt(0)
    s_barrier
    s_add_u32 s26, s26, 1
    v_mov_b32 v12, s26
    buffer_store_dword v12, v11, s[8:11], s27 offen
    v_mov_b32 v18, s26
    v_writelane_b32 v18, s34, 32
    v_writelane_b32 v18, s40, 33
L_sp_91:
    global_load_dword v19, v[16:17], off sc1
    s_add_u32 s30, s30, 1
    s_cmp_gt_u32 s30, 0x200000
    s_cbranch_scc1 chain_kernel_wabort
    s_waitcnt vmcnt(0)
    v_cmp_lt_u32 vcc, v19, v18
    s_cbranch_vccz L_spok_92
    s_branch L_sp_91
L_spok_92:
    buffer_load_dwordx4 v[104:107], v23, s[8:11], s24 offen offset:0 sc1
    buffer_load_dwordx4 v[108:111], v23, s[8:11], s24 offen offset:1024 sc1
    buffer_load_dwordx4 v[112:115], v23, s[8:11], s24 offen offset:2048 sc1
    s_waitcnt vmcnt(0)
    v_pk_add_f32 v[104:105], v[104:105], v[60:61]
    v_pk_add_f32 v[106:107], v[106:107], v[62:63]
    v_pk_add_f32 v[108:109], v[108:109], v[112:113]
    v_pk_add_f32 v[110:111], v[110:111], v[114:115]
    v_pk_add_f32 v[104:105], v[104:105], v[108:109]
    v_pk_add_f32 v[106:107], v[106:107], v[110:111]
    v_cvt_pk_bf16_f32 v104, 0, v104
    v_cvt_pk_bf16_f32 v105, 0, v105
    v_cvt_pk_bf16_f32 v106, 0, v106
    v_cvt_pk_bf16_f32 v107, 0, v107
    buffer_store_dwordx4 v[104:107], v15, s[16:19], s25 offen
    s_branch seg_t
seg_end:
    s_endpgm
seg_pslow:
L_sp_93:
    global_load_dword v19, v[16:17], off sc1
    s_add_u32 s30, s30, 1
    s_cmp_gt_u32 s30, 0x200000
    s_cbranch_scc1 chain_kernel_wabort
    s_waitcnt vmcnt(0)
    v_cmp_lt_u32 vcc, v19, v18
    s_cbranch_vccz L_spok_94
    s_sleep 2
    s_branch L_sp_93
L_spok_94:
    s_branch seg_pok
    s_endpgm
chain_kernel_wabort:
    s_mov_b64 exec, 1
    v_mov_b32 v1, 0xdeadbeef
    v_mov_b32 v2, 120
    global_store_dword v2, v1, s[98:99]
    s_endpgm
t_g2_c:
    s_mov_b32 s43, 0
    v_bfe_u32 v16, v0, 5, 1
    v_lshlrev_b32 v23, 13, v16
    v_bfe_u32 v16, v0, 7, 1
    v_lshl_add_u32 v23, v16, 12, v23
    v_bfe_u32 v16, v0, 1, 1
    v_lshl_add_u32 v23, v16, 8, v23
    v_bfe_u32 v16, v0, 1, 1
    v_lshl_add_u32 v23, v16, 6, v23
    v_bfe_u32 v16, v0, 4, 1
    v_lshl_add_u32 v23, v16, 7, v23
    v_bfe_u32 v16, v0, 2, 2
    v_lshl_add_u32 v23, v16, 4, v23
    v_bfe_u32 v16, v0, 0, 1
    v_lshl_add_u32 v23, v16, 3, v23
    v_add_u32 v14, s49, v23
    v_xor_b32 v15, 64, v14
    ds_read_b64_tr_b16 v[72:73], v14 offset:0
    ds_read_b64_tr_b16 v[74:75], v15 offset:0
    ds_read_b128 v[44:47], v12 offset:2048
    ds_read_b128 v[40:43], v12 offset:0
    ds_read_b64_tr_b16 v[76:77], v14 offset:512
    ds_read_b64_tr_b16 v[78:79], v15 offset:512
    ds_read_b128 v[52:55], v12 offset:6144
    ds_read_b128 v[48:51], v12 offset:4096
    ds_read_b128 v[60:63], v12 offset:10240
    ds_read_b128 v[56:59], v12 offset:8192
    ds_read_b128 v[68:71], v12 offset:14336
    ds_read_b128 v[64:67], v12 offset:12288
    s_branch t_g2_as
t_g2:
    s_mov_b32 s43, 0
    v_bfe_u32 v16, v0, 5, 1
    v_lshlrev_b32 v23, 13, v16
    v_bfe_u32 v16, v0, 7, 1
    v_lshl_add_u32 v23, v16, 12, v23
    v_bfe_u32 v16, v0, 1, 1
    v_lshl_add_u32 v23, v16, 8, v23
    v_bfe_u32 v16, v0, 1, 1
    v_lshl_add_u32 v23, v16, 6, v23
    v_bfe_u32 v16, v0, 4, 1
    v_lshl_add_u32 v23, v16, 7, v23
    v_bfe_u32 v16, v0, 2, 2
    v_lshl_add_u32 v23, v16, 4, v23
    v_bfe_u32 v16, v0, 0, 1
    v_lshl_add_u32 v23, v16, 3, v23
    v_add_u32 v14, s49, v23
    v_xor_b32 v15, 64, v14
    ds_read_b64_tr_b16 v[72:73], v14 offset:0
    ds_read_b64_tr_b16 v[74:75], v15 offset:0
    ds_read_b128 v[44:47], v12 offset:2048
    ds_read_b128 v[40:43], v12 offset:0
    ds_read_b64_tr_b16 v[76:77], v14 offset:512
    ds_read_b64_tr_b16 v[78:79], v15 offset:512
    ds_read_b128 v[52:55], v12 offset:6144
    ds_read_b128 v[48:51], v12 offset:4096
    ds_read_b128 v[60:63], v12 offset:10240
    ds_read_b128 v[56:59], v12 offset:8192
    ds_read_b128 v[68:71], v12 offset:14336
    ds_read_b128 v[64:67], v12 offset:12288
    s_waitcnt lgkmcnt(8)
    v_mfma_f32_16x16x32_bf16 a[0:3], v[40:43], v[72:75], 0
    s_xor_b32 m0, s44, 0
    v_mfma_f32_16x16x32_bf16 a[32:35], v[44:47], v[72:75], 0
    buffer_load_dwordx4 v4, s[8:11], s20 offen lds
    s_waitcnt lgkmcnt(6)
    v_mfma_f32_16x16x32_bf16 a[36:39], v[44:47], v[76:79], 0
    ds_read_b64_tr_b16 v[80:81], v14 offset:1024
    v_mfma_f32_16x16x32_bf16 a[4:7], v[40:43], v[76:79], 0
    s_waitcnt lgkmcnt(5)
    v_mfma_f32_16x16x32_bf16 a[64:67], v[48:51], v[72:75], 0
    ds_read_b64_tr_b16 v[82:83], v15 offset:1024
    s_xor_b32 m0, s44, 1024
    v_mfma_f32_16x16x32_bf16 a[96:99], v[52:55], v[72:75], 0
    buffer_load_dwordx4 v5, s[8:11], s20 offen lds
    v_mfma_f32_16x16x32_bf16 a[100:103], v[52:55], v[76:79], 0
    ds_read_b64_tr_b16 v[84:85], v14 offset:1536
    s_add_u32 s20, s20, 128
    v_mfma_f32_16x16x32_bf16 a[68:71], v[48:51], v[76:79], 0
    s_waitcnt lgkmcnt(5)
    v_mfma_f32_16x16x32_bf16 a[128:131], v[56:59], v[72:75], 0
    ds_read_b64_tr_b16 v[86:87], v15 offset:1536
    s_mov_b64 vcc, 0
    v_mfma_f32_16x16x32_bf16 a[160:163], v[60:63], v[72:75], 0
    s_xor_b32 m0, s44, 2048
    v_mfma_f32_16x16x32_bf16 a[164:167], v[60:63], v[76:79], 0
    buffer_load_dwordx4 v4, s[8:11], s21 offen lds
    v_mfma_f32_16x16x32_bf16 a[132:135], v[56:59], v[76:79], 0
    s_bitcmp1_b32 s43, 0
    s_waitcnt lgkmcnt(4)
    v_mfma_f32_16x16x32_bf16 a[192:195], v[64:67], v[72:75], 0
    s_cselect_b32 s61, s5, 0
    s_lshl1_add_u32 s53, s61, s50
    v_mfma_f32_16x16x32_bf16 a[224:227], v[68:71], v[72:75], 0
    s_bitcmp1_b32 s43, 1
    s_cselect_b32 s61, s51, 0
    v_mfma_f32_16x16x32_bf16 a[228:231], v[68:71], v[76:79], 0
    s_add_u32 s53, s53, s61
    s_bitcmp1_b32 s43, 2
    v_mfma_f32_16x16x32_bf16 a[196:199], v[64:67], v[76:79], 0
    s_cselect_b32 s61, s52, 0
    s_waitcnt lgkmcnt(2)
    v_mfma_f32_16x16x32_bf16 a[8:11], v[40:43], v[80:83], 0
    s_add_u32 s53, s53, s61
    s_lshl_b32 s29, s43, 4
    v_mfma_f32_16x16x32_bf16 a[40:43], v[44:47], v[80:83], 0
    s_mov_b64 vcc, -1
    s_waitcnt lgkmcnt(0)
    v_mfma_f32_16x16x32_bf16 a[44:47], v[44:47], v[84:87], 0
    ds_read_b64_tr_b16 v[72:73], v14 offset:2048
    s_xor_b32 m0, s44, 3072
    v_mfma_f32_16x16x32_bf16 a[12:15], v[40:43], v[84:87], 0
    buffer_load_dwordx4 v5, s[8:11], s21 offen lds
    v_mfma_f32_16x16x32_bf16 a[72:75], v[48:51], v[80:83], 0
    ds_read_b64_tr_b16 v[74:75], v15 offset:2048
    s_add_u32 s21, s21, 128
    v_mfma_f32_16x16x32_bf16 a[104:107], v[52:55], v[80:83], 0
    s_xor_b32 m0, s44, 16384
    v_mfma_f32_16x16x32_bf16 a[108:111], v[52:55], v[84:87], 0
    ds_read_b64_tr_b16 v[76:77], v14 offset:2560
    buffer_load_dwordx4 v4, s[8:11], s22 offen lds
    v_mfma_f32_16x16x32_bf16 a[76:79], v[48:51], v[84:87], 0
    s_xor_b32 m0, s44, 17408
    v_mfma_f32_16x16x32_bf16 a[136:139], v[56:59], v[80:83], 0
    ds_read_b64_tr_b16 v[78:79], v15 offset:2560
    buffer_load_dwordx4 v5, s[8:11], s22 offen lds
    v_mfma_f32_16x16x32_bf16 a[168:171], v[60:63], v[80:83], 0
    s_add_u32 s22, s22, 128
    s_xor_b32 m0, s44, 18432
    v_mfma_f32_16x16x32_bf16 a[172:175], v[60:63], v[84:87], 0
    buffer_load_dwordx4 v4, s[8:11], s23 offen lds
    v_mfma_f32_16x16x32_bf16 a[140:143], v[56:59], v[84:87], 0
    v_mfma_f32_16x16x32_bf16 a[200:203], v[64:67], v[80:83], 0
    s_xor_b32 m0, s44, 19456
    v_mfma_f32_16x16x32_bf16 a[232:235], v[68:71], v[80:83], 0
    buffer_load_dwordx4 v5, s[8:11], s23 offen lds
    v_mfma_f32_16x16x32_bf16 a[236:239], v[68:71], v[84:87], 0
    s_add_u32 s23, s23, 128
    s_cmp_ge_u32 s44, 98304
    v_mfma_f32_16x16x32_bf16 a[204:207], v[64:67], v[84:87], 0
    s_cselect_b32 s60, s6, s7
    s_waitcnt lgkmcnt(2)
    v_mfma_f32_16x16x32_bf16 a[16:19], v[40:43], v[72:75], 0
    s_add_u32 s44, s44, s60
    v_mfma_f32_16x16x32_bf16 a[48:51], v[44:47], v[72:75], 0
    s_waitcnt lgkmcnt(0)
    v_mfma_f32_16x16x32_bf16 a[52:55], v[44:47], v[76:79], 0
    ds_read_b64_tr_b16 v[80:81], v14 offset:3072
    v_mfma_f32_16x16x32_bf16 a[20:23], v[40:43], v[76:79], 0
    v_mfma_f32_16x16x32_bf16 a[80:83], v[48:51], v[72:75], 0
    ds_read_b64_tr_b16 v[82:83], v15 offset:3072
    s_set_gpr_idx_on s29, gpr_idx(SRC0)
    v_mov_b32 v24, v128
    v_mov_b32 v25, v129
    v_mov_b32 v26, v130
    v_mov_b32 v27, v131
    s_set_gpr_idx_off
    v_mfma_f32_16x16x32_bf16 a[112:115], v[52:55], v[72:75], 0
    v_mfma_f32_16x16x32_bf16 a[116:119], v[52:55], v[76:79], 0
    ds_read_b64_tr_b16 v[84:85], v14 offset:3584
    s_set_gpr_idx_on s29, gpr_idx(SRC0)
    v_mov_b32 v28, v132
    v_mov_b32 v29, v133
    v_mov_b32 v30, v134
    v_mov_b32 v31, v135
    s_set_gpr_idx_off
    v_mfma_f32_16x16x32_bf16 a[84:87], v[48:51], v[76:79], 0
    v_mfma_f32_16x16x32_bf16 a[144:147], v[56:59], v[72:75], 0
    ds_read_b64_tr_b16 v[86:87], v15 offset:3584
    s_set_gpr_idx_on s29, gpr_idx(SRC0)
    v_mov_b32 v32, v136
    v_mov_b32 v33, v137
    v_mov_b32 v34, v138
    v_mov_b32 v35, v139
    s_set_gpr_idx_off
    v_mfma_f32_16x16x32_bf16 a[176:179], v[60:63], v[72:75], 0
    v_mfma_f32_16x16x32_bf16 a[180:183], v[60:63], v[76:79], 0
    s_set_gpr_idx_on s29, gpr_idx(SRC0)
    v_mov_b32 v36, v140
    v_mov_b32 v37, v141
    v_mov_b32 v38, v142
    v_mov_b32 v39, v143
    s_set_gpr_idx_off
    v_mfma_f32_16x16x32_bf16 a[148:151], v[56:59], v[76:79], 0
    v_mfma_f32_16x16x32_bf16 a[208:211], v[64:67], v[72:75], 0
    buffer_store_dwordx4 v[24:27], v2, s[16:19], s53 offen sc1
    v_mfma_f32_16x16x32_bf16 a[240:243], v[68:71], v[72:75], 0
    v_mfma_f32_16x16x32_bf16 a[244:247], v[68:71], v[76:79], 0
    buffer_store_dwordx4 v[28:31], v3, s[16:19], s53 offen sc1
    v_mfma_f32_16x16x32_bf16 a[212:215], v[64:67], v[76:79], 0
    s_add_u32 s53, s53, s5
    s_waitcnt lgkmcnt(2)
    v_mfma_f32_16x16x32_bf16 a[24:27], v[40:43], v[80:83], 0
    ds_read_b64_tr_b16 v[72:73], v14 offset:16384
    buffer_store_dwordx4 v[32:35], v2, s[16:19], s53 offen sc1
    v_mfma_f32_16x16x32_bf16 a[56:59], v[44:47], v[80:83], 0
    ds_read_b64_tr_b16 v[74:75], v15 offset:16384
    s_waitcnt lgkmcnt(2)
    v_mfma_f32_16x16x32_bf16 a[60:63], v[44:47], v[84:87], 0
    ds_read_b128 v[44:47], v13 offset:2048
    buffer_store_dwordx4 v[36:39], v3, s[16:19], s53 offen sc1
    v_mfma_f32_16x16x32_bf16 a[28:31], v[40:43], v[84:87], 0
    ds_read_b128 v[40:43], v13 offset:0
    v_mfma_f32_16x16x32_bf16 a[88:91], v[48:51], v[80:83], 0
    ds_read_b64_tr_b16 v[76:77], v14 offset:16896
    v_mfma_f32_16x16x32_bf16 a[120:123], v[52:55], v[80:83], 0
    ds_read_b64_tr_b16 v[78:79], v15 offset:16896
    v_mfma_f32_16x16x32_bf16 a[124:127], v[52:55], v[84:87], 0
    ds_read_b128 v[52:55], v13 offset:6144
    v_mfma_f32_16x16x32_bf16 a[92:95], v[48:51], v[84:87], 0
    ds_read_b128 v[48:51], v13 offset:4096
    v_mfma_f32_16x16x32_bf16 a[152:155], v[56:59], v[80:83], 0
    v_mfma_f32_16x16x32_bf16 a[184:187], v[60:63], v[80:83], 0
    v_mfma_f32_16x16x32_bf16 a[188:191], v[60:63], v[84:87], 0
    ds_read_b128 v[60:63], v13 offset:10240
    v_mfma_f32_16x16x32_bf16 a[156:159], v[56:59], v[84:87], 0
    ds_read_b128 v[56:59], v13 offset:8192
    v_mfma_f32_16x16x32_bf16 a[216:219], v[64:67], v[80:83], 0
    v_mfma_f32_16x16x32_bf16 a[248:251], v[68:71], v[80:83], 0
    v_mfma_f32_16x16x32_bf16 a[252:255], v[68:71], v[84:87], 0
    ds_read_b128 v[68:71], v13 offset:14336
    v_mfma_f32_16x16x32_bf16 a[220:223], v[64:67], v[84:87], 0
    ds_read_b128 v[64:67], v13 offset:12288
    s_branch t_g2_b
t_g2_hook:
    s_cmp_eq_u32 s43, 1
    s_cbranch_scc1 t_g2_sig0
    s_cmp_eq_u32 s43, 6
    s_cbranch_scc1 t_g2_sws
    s_cmp_eq_u32 s43, 7
    s_cbranch_scc1 t_g2_swp
    s_cmp_lg_u32 s58, 0
    s_cbranch_scc1 t_g2_a
t_g2_wait:
    s_cmp_eq_u32 s3, 0
    s_cbranch_scc1 t_g2_a
    s_mov_b32 s62, 0
L_sw_95:
    s_load_dword s63, s[98:99], s3 glc
    s_add_u32 s62, s62, 1
    s_cmp_gt_u32 s62, 0x200000
    s_cbranch_scc1 chain_kernel_wabort
    s_waitcnt lgkmcnt(0)
    s_cmp_ge_u32 s63, 32
    s_cbranch_scc1 L_swok_96
    s_sleep 16
    s_branch L_sw_95
L_swok_96:
    s_branch t_g2_a
t_g2_sig0:
    s_cmp_eq_u32 s1, 0
    s_cbranch_scc1 t_g2_as
    v_mov_b32 v24, s1
    v_mov_b32 v25, 1
    s_mov_b64 exec, 1
    global_atomic_add v24, v25, s[98:99] sc1
    s_mov_b64 exec, -1
    s_mov_b32 s1, 0
    s_branch t_g2_as
t_g2_sws:
    s_mov_b32 s12, s36
    s_mov_b32 s13, s37
    s_mov_b32 s14, s38
    s_and_b32 s45, s45, 0xffffb7ff
    s_bitcmp1_b32 s0, 3
    s_cselect_b32 s24, s41, 0
    s_cselect_b32 s26, 0, s41
    s_cselect_b32 s60, 0x4000, 0
    s_or_b32 s45, s45, s60
    s_add_u32 s24, s24, s39
    s_add_u32 s26, s26, s39
    s_bitcmp1_b32 s0, 2
    s_cselect_b32 s61, s40, 0
    s_cselect_b32 s62, 0, s40
    s_cselect_b32 s60, 0x800, 0
    s_or_b32 s45, s45, s60
    s_add_u32 s25, s24, s62
    s_add_u32 s24, s24, s61
    s_add_u32 s27, s26, s62
    s_add_u32 s26, s26, s61
    s_mov_b32 s28, s42
    v_mov_b32 v6, v10
    v_mov_b32 v7, v11
    s_branch t_g2_a
t_g2_swp:
    s_mov_b32 s8, s30
    s_mov_b32 s9, s31
    s_mov_b32 s10, s32
    s_and_b32 s44, s44, 0xffffb7ff
    s_bitcmp1_b32 s0, 1
    s_cselect_b32 s20, s35, 0
    s_cselect_b32 s22, 0, s35
    s_cselect_b32 s60, 0x4000, 0
    s_or_b32 s44, s44, s60
    s_add_u32 s20, s20, s33
    s_add_u32 s22, s22, s33
    s_bitcmp1_b32 s0, 0
    s_cselect_b32 s61, s34, 0
    s_cselect_b32 s62, 0, s34
    s_cselect_b32 s60, 0x800, 0
    s_or_b32 s44, s44, s60
    s_add_u32 s21, s20, s62
    s_add_u32 s20, s20, s61
    s_add_u32 s23, s22, s62
    s_add_u32 s22, s22, s61
    v_mov_b32 v4, v8
    v_mov_b32 v5, v9
t_g2_a:
t_g2_as:
    s_waitcnt lgkmcnt(8)
    v_mfma_f32_16x16x32_bf16 a[0:3], v[40:43], v[72:75], a[0:3]
    s_xor_b32 m0, s44, 0
    v_mfma_f32_16x16x32_bf16 a[32:35], v[44:47], v[72:75], a[32:35]
    buffer_load_dwordx4 v4, s[8:11], s20 offen lds
    s_waitcnt lgkmcnt(6)
    v_mfma_f32_16x16x32_bf16 a[36:39], v[44:47], v[76:79], a[36:39]
    ds_read_b64_tr_b16 v[80:81], v14 offset:1024
    v_mfma_f32_16x16x32_bf16 a[4:7], v[40:43], v[76:79], a[4:7]
    s_waitcnt lgkmcnt(5)
    v_mfma_f32_16x16x32_bf16 a[64:67], v[48:51], v[72:75], a[64:67]
    ds_read_b64_tr_b16 v[82:83], v15 offset:1024
    s_xor_b32 m0, s44, 1024
    v_mfma_f32_16x16x32_bf16 a[96:99], v[52:55], v[72:75], a[96:99]
    buffer_load_dwordx4 v5, s[8:11], s20 offen lds
    v_mfma_f32_16x16x32_bf16 a[100:103], v[52:55], v[76:79], a[100:103]
    ds_read_b64_tr_b16 v[84:85], v14 offset:1536
    s_add_u32 s20, s20, 128
    v_mfma_f32_16x16x32_bf16 a[68:71], v[48:51], v[76:79], a[68:71]
    s_waitcnt lgkmcnt(5)
    v_mfma_f32_16x16x32_bf16 a[128:131], v[56:59], v[72:75], a[128:131]
    ds_read_b64_tr_b16 v[86:87], v15 offset:1536
    s_mov_b64 vcc, 0
    v_mfma_f32_16x16x32_bf16 a[160:163], v[60:63], v[72:75], a[160:163]
    s_xor_b32 m0, s44, 2048
    v_mfma_f32_16x16x32_bf16 a[164:167], v[60:63], v[76:79], a[164:167]
    buffer_load_dwordx4 v4, s[8:11], s21 offen lds
    v_mfma_f32_16x16x32_bf16 a[132:135], v[56:59], v[76:79], a[132:135]
    s_bitcmp1_b32 s43, 0
    s_waitcnt lgkmcnt(4)
    v_mfma_f32_16x16x32_bf16 a[192:195], v[64:67], v[72:75], a[192:195]
    s_cselect_b32 s61, s5, 0
    s_lshl1_add_u32 s53, s61, s50
    v_mfma_f32_16x16x32_bf16 a[224:227], v[68:71], v[72:75], a[224:227]
    s_bitcmp1_b32 s43, 1
    s_cselect_b32 s61, s51, 0
    v_mfma_f32_16x16x32_bf16 a[228:231], v[68:71], v[76:79], a[228:231]
    s_add_u32 s53, s53, s61
    s_bitcmp1_b32 s43, 2
    v_mfma_f32_16x16x32_bf16 a[196:199], v[64:67], v[76:79], a[196:199]
    s_cselect_b32 s61, s52, 0
    s_waitcnt lgkmcnt(2)
    v_mfma_f32_16x16x32_bf16 a[8:11], v[40:43], v[80:83], a[8:11]
    s_add_u32 s53, s53, s61
    s_lshl_b32 s29, s43, 4
    v_mfma_f32_16x16x32_bf16 a[40:43], v[44:47], v[80:83], a[40:43]
    s_mov_b64 vcc, -1
    s_waitcnt lgkmcnt(0)
    v_mfma_f32_16x16x32_bf16 a[44:47], v[44:47], v[84:87], a[44:47]
    ds_read_b64_tr_b16 v[72:73], v14 offset:2048
    s_xor_b32 m0, s44, 3072
    v_mfma_f32_16x16x32_bf16 a[12:15], v[40:43], v[84:87], a[12:15]
    buffer_load_dwordx4 v5, s[8:11], s21 offen lds
    v_mfma_f32_16x16x32_bf16 a[72:75], v[48:51], v[80:83], a[72:75]
    ds_read_b64_tr_b16 v[74:75], v15 offset:2048
    s_add_u32 s21, s21, 128
    v_mfma_f32_16x16x32_bf16 a[104:107], v[52:55], v[80:83], a[104:107]
    s_xor_b32 m0, s44, 16384
    v_mfma_f32_16x16x32_bf16 a[108:111], v[52:55], v[84:87], a[108:111]
    ds_read_b64_tr_b16 v[76:77], v14 offset:2560
    buffer_load_dwordx4 v4, s[8:11], s22 offen lds
    v_mfma_f32_16x16x32_bf16 a[76:79], v[48:51], v[84:87], a[76:79]
    s_xor_b32 m0, s44, 17408
    v_mfma_f32_16x16x32_bf16 a[136:139], v[56:59], v[80:83], a[136:139]
    ds_read_b64_tr_b16 v[78:79], v15 offset:2560
    buffer_load_dwordx4 v5, s[8:11], s22 offen lds
    v_mfma_f32_16x16x32_bf16 a[168:171], v[60:63], v[80:83], a[168:171]
    s_add_u32 s22, s22, 128
    s_xor_b32 m0, s44, 18432
    v_mfma_f32_16x16x32_bf16 a[172:175], v[60:63], v[84:87], a[172:175]
    buffer_load_dwordx4 v4, s[8:11], s23 offen lds
    v_mfma_f32_16x16x32_bf16 a[140:143], v[56:59], v[84:87], a[140:143]
    v_mfma_f32_16x16x32_bf16 a[200:203], v[64:67], v[80:83], a[200:203]
    s_xor_b32 m0, s44, 19456
    v_mfma_f32_16x16x32_bf16 a[232:235], v[68:71], v[80:83], a[232:235]
    buffer_load_dwordx4 v5, s[8:11], s23 offen lds
    v_mfma_f32_16x16x32_bf16 a[236:239], v[68:71], v[84:87], a[236:239]
    s_add_u32 s23, s23, 128
    s_cmp_ge_u32 s44, 98304
    v_mfma_f32_16x16x32_bf16 a[204:207], v[64:67], v[84:87], a[204:207]
    s_cselect_b32 s60, s6, s7
    s_waitcnt lgkmcnt(2)
    v_mfma_f32_16x16x32_bf16 a[16:19], v[40:43], v[72:75], a[16:19]
    s_add_u32 s44, s44, s60
    v_mfma_f32_16x16x32_bf16 a[48:51], v[44:47], v[72:75], a[48:51]
    s_waitcnt lgkmcnt(0)
    v_mfma_f32_16x16x32_bf16 a[52:55], v[44:47], v[76:79], a[52:55]
    ds_read_b64_tr_b16 v[80:81], v14 offset:3072
    v_mfma_f32_16x16x32_bf16 a[20:23], v[40:43], v[76:79], a[20:23]
    v_mfma_f32_16x16x32_bf16 a[80:83], v[48:51], v[72:75], a[80:83]
    ds_read_b64_tr_b16 v[82:83], v15 offset:3072
    s_set_gpr_idx_on s29, gpr_idx(SRC0)
    v_mov_b32 v24, v128
    v_mov_b32 v25, v129
    v_mov_b32 v26, v130
    v_mov_b32 v27, v131
    s_set_gpr_idx_off
    v_mfma_f32_16x16x32_bf16 a[112:115], v[52:55], v[72:75], a[112:115]
    v_mfma_f32_16x16x32_bf16 a[116:119], v[52:55], v[76:79], a[116:119]
    ds_read_b64_tr_b16 v[84:85], v14 offset:3584
    s_set_gpr_idx_on s29, gpr_idx(SRC0)
    v_mov_b32 v28, v132
    v_mov_b32 v29, v133
    v_mov_b32 v30, v134
    v_mov_b32 v31, v135
    s_set_gpr_idx_off
    v_mfma_f32_16x16x32_bf16 a[84:87], v[48:51], v[76:79], a[84:87]
    v_mfma_f32_16x16x32_bf16 a[144:147], v[56:59], v[72:75], a[144:147]
    ds_read_b64_tr_b16 v[86:87], v15 offset:3584
    s_set_gpr_idx_on s29, gpr_idx(SRC0)
    v_mov_b32 v32, v136
    v_mov_b32 v33, v137
    v_mov_b32 v34, v138
    v_mov_b32 v35, v139
    s_set_gpr_idx_off
    v_mfma_f32_16x16x32_bf16 a[176:179], v[60:63], v[72:75], a[176:179]
    v_mfma_f32_16x16x32_bf16 a[180:183], v[60:63], v[76:79], a[180:183]
    s_set_gpr_idx_on s29, gpr_idx(SRC0)
    v_mov_b32 v36, v140
    v_mov_b32 v37, v141
    v_mov_b32 v38, v142
    v_mov_b32 v39, v143
    s_set_gpr_idx_off
    v_mfma_f32_16x16x32_bf16 a[148:151], v[56:59], v[76:79], a[148:151]
    v_mfma_f32_16x16x32_bf16 a[208:211], v[64:67], v[72:75], a[208:211]
    buffer_store_dwordx4 v[24:27], v2, s[16:19], s53 offen sc1
    v_mfma_f32_16x16x32_bf16 a[240:243], v[68:71], v[72:75], a[240:243]
    v_mfma_f32_16x16x32_bf16 a[244:247], v[68:71], v[76:79], a[244:247]
    buffer_store_dwordx4 v[28:31], v3, s[16:19], s53 offen sc1
    v_mfma_f32_16x16x32_bf16 a[212:215], v[64:67], v[76:79], a[212:215]
    s_add_u32 s53, s53, s5
    s_waitcnt lgkmcnt(2)
    v_mfma_f32_16x16x32_bf16 a[24:27], v[40:43], v[80:83], a[24:27]
    ds_read_b64_tr_b16 v[72:73], v14 offset:16384
    buffer_store_dwordx4 v[32:35], v2, s[16:19], s53 offen sc1
    v_mfma_f32_16x16x32_bf16 a[56:59], v[44:47], v[80:83], a[56:59]
    ds_read_b64_tr_b16 v[74:75], v15 offset:16384
    s_waitcnt lgkmcnt(2)
    v_mfma_f32_16x16x32_bf16 a[60:63], v[44:47], v[84:87], a[60:63]
    ds_read_b128 v[44:47], v13 offset:2048
    buffer_store_dwordx4 v[36:39], v3, s[16:19], s53 offen sc1
    v_mfma_f32_16x16x32_bf16 a[28:31], v[40:43], v[84:87], a[28:31]
    ds_read_b128 v[40:43], v13 offset:0
    v_mfma_f32_16x16x32_bf16 a[88:91], v[48:51], v[80:83], a[88:91]
    ds_read_b64_tr_b16 v[76:77], v14 offset:16896
    v_mfma_f32_16x16x32_bf16 a[120:123], v[52:55], v[80:83], a[120:123]
    ds_read_b64_tr_b16 v[78:79], v15 offset:16896
    v_mfma_f32_16x16x32_bf16 a[124:127], v[52:55], v[84:87], a[124:127]
    ds_read_b128 v[52:55], v13 offset:6144
    v_mfma_f32_16x16x32_bf16 a[92:95], v[48:51], v[84:87], a[92:95]
    ds_read_b128 v[48:51], v13 offset:4096
    v_mfma_f32_16x16x32_bf16 a[152:155], v[56:59], v[80:83], a[152:155]
    v_mfma_f32_16x16x32_bf16 a[184:187], v[60:63], v[80:83], a[184:187]
    v_mfma_f32_16x16x32_bf16 a[188:191], v[60:63], v[84:87], a[188:191]
    ds_read_b128 v[60:63], v13 offset:10240
    v_mfma_f32_16x16x32_bf16 a[156:159], v[56:59], v[84:87], a[156:159]
    ds_read_b128 v[56:59], v13 offset:8192
    v_mfma_f32_16x16x32_bf16 a[216:219], v[64:67], v[80:83], a[216:219]
    v_mfma_f32_16x16x32_bf16 a[248:251], v[68:71], v[80:83], a[248:251]
    v_mfma_f32_16x16x32_bf16 a[252:255], v[68:71], v[84:87], a[252:255]
    ds_read_b128 v[68:71], v13 offset:14336
    v_mfma_f32_16x16x32_bf16 a[220:223], v[64:67], v[84:87], a[220:223]
    ds_read_b128 v[64:67], v13 offset:12288
t_g2_b:
    s_waitcnt lgkmcnt(8)
    v_mfma_f32_16x16x32_bf16 a[0:3], v[40:43], v[72:75], a[0:3]
    v_mfma_f32_16x16x32_bf16 a[32:35], v[44:47], v[72:75], a[32:35]
    s_waitcnt lgkmcnt(6)
    v_mfma_f32_16x16x32_bf16 a[36:39], v[44:47], v[76:79], a[36:39]
    ds_read_b64_tr_b16 v[80:81], v14 offset:17408
    v_mfma_f32_16x16x32_bf16 a[4:7], v[40:43], v[76:79], a[4:7]
    s_cmp_ge_u32 s48, 98304
    s_waitcnt lgkmcnt(5)
    v_mfma_f32_16x16x32_bf16 a[64:67], v[48:51], v[72:75], a[64:67]
    ds_read_b64_tr_b16 v[82:83], v15 offset:17408
    s_cselect_b32 s46, s6, s7
    v_mfma_f32_16x16x32_bf16 a[96:99], v[52:55], v[72:75], a[96:99]
    s_add_u32 s48, s48, s46
    v_mfma_f32_16x16x32_bf16 a[100:103], v[52:55], v[76:79], a[100:103]
    ds_read_b64_tr_b16 v[84:85], v14 offset:17920
    v_mfma_f32_16x16x32_bf16 a[68:71], v[48:51], v[76:79], a[68:71]
    s_cmp_ge_u32 s49, 98304
    s_waitcnt lgkmcnt(5)
    v_mfma_f32_16x16x32_bf16 a[128:131], v[56:59], v[72:75], a[128:131]
    ds_read_b64_tr_b16 v[86:87], v15 offset:17920
    s_cselect_b32 s47, s6, s7
    v_mfma_f32_16x16x32_bf16 a[160:163], v[60:63], v[72:75], a[160:163]
    s_add_u32 s49, s49, s47
    v_mfma_f32_16x16x32_bf16 a[164:167], v[60:63], v[76:79], a[164:167]
    v_mfma_f32_16x16x32_bf16 a[132:135], v[56:59], v[76:79], a[132:135]
    s_waitcnt lgkmcnt(4)
    v_mfma_f32_16x16x32_bf16 a[192:195], v[64:67], v[72:75], a[192:195]
    v_mfma_f32_16x16x32_bf16 a[224:227], v[68:71], v[72:75], a[224:227]
    v_mfma_f32_16x16x32_bf16 a[228:231], v[68:71], v[76:79], a[228:231]
    v_mfma_f32_16x16x32_bf16 a[196:199], v[64:67], v[76:79], a[196:199]
    s_waitcnt lgkmcnt(2)
    v_mfma_f32_16x16x32_bf16 a[8:11], v[40:43], v[80:83], a[8:11]
    s_xor_b32 m0, s45, 0
    v_mfma_f32_16x16x32_bf16 a[40:43], v[44:47], v[80:83], a[40:43]
    buffer_load_dwordx4 v6, s[12:15], s24 offen lds
    s_waitcnt lgkmcnt(0)
    v_mfma_f32_16x16x32_bf16 a[44:47], v[44:47], v[84:87], a[44:47]
    ds_read_b64_tr_b16 v[72:73], v14 offset:18432
    v_add_u32 v12, s46, v12
    v_mfma_f32_16x16x32_bf16 a[12:15], v[40:43], v[84:87], a[12:15]
    v_add_u32 v13, s46, v13
    v_mfma_f32_16x16x32_bf16 a[72:75], v[48:51], v[80:83], a[72:75]
    ds_read_b64_tr_b16 v[74:75], v15 offset:18432
    s_xor_b32 m0, s45, 1024
    v_mfma_f32_16x16x32_bf16 a[104:107], v[52:55], v[80:83], a[104:107]
    buffer_load_dwordx4 v7, s[12:15], s24 offen lds
    v_mfma_f32_16x16x32_bf16 a[108:111], v[52:55], v[84:87], a[108:111]
    ds_read_b64_tr_b16 v[76:77], v14 offset:18944
    s_add_u32 s24, s24, s28
    v_mfma_f32_16x16x32_bf16 a[76:79], v[48:51], v[84:87], a[76:79]
    v_mfma_f32_16x16x32_bf16 a[136:139], v[56:59], v[80:83], a[136:139]
    ds_read_b64_tr_b16 v[78:79], v15 offset:18944
    s_xor_b32 m0, s45, 2048
    v_mfma_f32_16x16x32_bf16 a[168:171], v[60:63], v[80:83], a[168:171]
    buffer_load_dwordx4 v6, s[12:15], s25 offen lds
    v_mfma_f32_16x16x32_bf16 a[172:175], v[60:63], v[84:87], a[172:175]
    v_mfma_f32_16x16x32_bf16 a[140:143], v[56:59], v[84:87], a[140:143]
    v_mfma_f32_16x16x32_bf16 a[200:203], v[64:67], v[80:83], a[200:203]
    s_xor_b32 m0, s45, 3072
    v_mfma_f32_16x16x32_bf16 a[232:235], v[68:71], v[80:83], a[232:235]
    buffer_load_dwordx4 v7, s[12:15], s25 offen lds
    v_mfma_f32_16x16x32_bf16 a[236:239], v[68:71], v[84:87], a[236:239]
    s_add_u32 s25, s25, s28
    v_mfma_f32_16x16x32_bf16 a[204:207], v[64:67], v[84:87], a[204:207]
    s_waitcnt lgkmcnt(2)
    v_mfma_f32_16x16x32_bf16 a[16:19], v[40:43], v[72:75], a[16:19]
    s_xor_b32 m0, s45, 16384
    v_mfma_f32_16x16x32_bf16 a[48:51], v[44:47], v[72:75], a[48:51]
    buffer_load_dwordx4 v6, s[12:15], s26 offen lds
    s_waitcnt lgkmcnt(0)
    v_mfma_f32_16x16x32_bf16 a[52:55], v[44:47], v[76:79], a[52:55]
    ds_read_b64_tr_b16 v[80:81], v14 offset:19456
    v_mfma_f32_16x16x32_bf16 a[20:23], v[40:43], v[76:79], a[20:23]
    s_xor_b32 m0, s45, 17408
    v_mfma_f32_16x16x32_bf16 a[80:83], v[48:51], v[72:75], a[80:83]
    ds_read_b64_tr_b16 v[82:83], v15 offset:19456
    buffer_load_dwordx4 v7, s[12:15], s26 offen lds
    v_mfma_f32_16x16x32_bf16 a[112:115], v[52:55], v[72:75], a[112:115]
    s_add_u32 s26, s26, s28
    s_xor_b32 m0, s45, 18432
    v_mfma_f32_16x16x32_bf16 a[116:119], v[52:55], v[76:79], a[116:119]
    ds_read_b64_tr_b16 v[84:85], v14 offset:19968
    buffer_load_dwordx4 v6, s[12:15], s27 offen lds
    v_mfma_f32_16x16x32_bf16 a[84:87], v[48:51], v[76:79], a[84:87]
    s_xor_b32 m0, s45, 19456
    v_mfma_f32_16x16x32_bf16 a[144:147], v[56:59], v[72:75], a[144:147]
    ds_read_b64_tr_b16 v[86:87], v15 offset:19968
    buffer_load_dwordx4 v7, s[12:15], s27 offen lds
    v_mfma_f32_16x16x32_bf16 a[176:179], v[60:63], v[72:75], a[176:179]
    s_add_u32 s27, s27, s28
    s_cmp_ge_u32 s45, 98304
    v_mfma_f32_16x16x32_bf16 a[180:183], v[60:63], v[76:79], a[180:183]
    s_cselect_b32 s60, s6, s7
    s_add_u32 s45, s45, s60
    v_mfma_f32_16x16x32_bf16 a[148:151], v[56:59], v[76:79], a[148:151]
    v_add_u32 v14, s47, v14
    v_add_u32 v15, s47, v15
    v_mfma_f32_16x16x32_bf16 a[208:211], v[64:67], v[72:75], a[208:211]
    s_add_u32 s43, s43, 1
    s_cmp_eq_u32 s43, 8
    v_mfma_f32_16x16x32_bf16 a[240:243], v[68:71], v[72:75], a[240:243]
    v_mfma_f32_16x16x32_bf16 a[244:247], v[68:71], v[76:79], a[244:247]
    v_mfma_f32_16x16x32_bf16 a[212:215], v[64:67], v[76:79], a[212:215]
    s_waitcnt vmcnt(12) lgkmcnt(0)
    s_cbranch_vccnz t_g2_bar
    s_waitcnt vmcnt(8)
t_g2_bar:
    s_barrier
    s_cbranch_scc1 t_g2_last
    v_mfma_f32_16x16x32_bf16 a[24:27], v[40:43], v[80:83], a[24:27]
    ds_read_b64_tr_b16 v[72:73], v14 offset:0
    v_mfma_f32_16x16x32_bf16 a[56:59], v[44:47], v[80:83], a[56:59]
    ds_read_b64_tr_b16 v[74:75], v15 offset:0
    v_mfma_f32_16x16x32_bf16 a[60:63], v[44:47], v[84:87], a[60:63]
    ds_read_b128 v[44:47], v12 offset:2048
    v_mfma_f32_16x16x32_bf16 a[28:31], v[40:43], v[84:87], a[28:31]
    ds_read_b128 v[40:43], v12 offset:0
    v_mfma_f32_16x16x32_bf16 a[88:91], v[48:51], v[80:83], a[88:91]
    ds_read_b64_tr_b16 v[76:77], v14 offset:512
    v_mfma_f32_16x16x32_bf16 a[120:123], v[52:55], v[80:83], a[120:123]
    ds_read_b64_tr_b16 v[78:79], v15 offset:512
    v_mfma_f32_16x16x32_bf16 a[124:127], v[52:55], v[84:87], a[124:127]
    ds_read_b128 v[52:55], v12 offset:6144
    v_mfma_f32_16x16x32_bf16 a[92:95], v[48:51], v[84:87], a[92:95]
    ds_read_b128 v[48:51], v12 offset:4096
    v_mfma_f32_16x16x32_bf16 a[152:155], v[56:59], v[80:83], a[152:155]
    v_mfma_f32_16x16x32_bf16 a[184:187], v[60:63], v[80:83], a[184:187]
    v_mfma_f32_16x16x32_bf16 a[188:191], v[60:63], v[84:87], a[188:191]
    ds_read_b128 v[60:63], v12 offset:10240
    v_mfma_f32_16x16x32_bf16 a[156:159], v[56:59], v[84:87], a[156:159]
    ds_read_b128 v[56:59], v12 offset:8192
    v_mfma_f32_16x16x32_bf16 a[216:219], v[64:67], v[80:83], a[216:219]
    s_sub_u32 s61, s43, 2
    s_cmp_lt_u32 s61, 3
    v_mfma_f32_16x16x32_bf16 a[248:251], v[68:71], v[80:83], a[248:251]
    v_mfma_f32_16x16x32_bf16 a[252:255], v[68:71], v[84:87], a[252:255]
    ds_read_b128 v[68:71], v12 offset:14336
    v_mfma_f32_16x16x32_bf16 a[220:223], v[64:67], v[84:87], a[220:223]
    ds_read_b128 v[64:67], v12 offset:12288
    s_cbranch_scc1 t_g2_a
    s_branch t_g2_hook
t_g2_last:
    v_mfma_f32_16x16x32_bf16 a[24:27], v[40:43], v[80:83], a[24:27]
    v_mfma_f32_16x16x32_bf16 a[56:59], v[44:47], v[80:83], a[56:59]
    v_mfma_f32_16x16x32_bf16 a[60:63], v[44:47], v[84:87], a[60:63]
    v_mfma_f32_16x16x32_bf16 a[28:31], v[40:43], v[84:87], a[28:31]
    v_mfma_f32_16x16x32_bf16 a[88:91], v[48:51], v[80:83], a[88:91]
    v_mfma_f32_16x16x32_bf16 a[120:123], v[52:55], v[80:83], a[120:123]
    v_mfma_f32_16x16x32_bf16 a[124:127], v[52:55], v[84:87], a[124:127]
    v_mfma_f32_16x16x32_bf16 a[92:95], v[48:51], v[84:87], a[92:95]
    v_mfma_f32_16x16x32_bf16 a[152:155], v[56:59], v[80:83], a[152:155]
    v_mfma_f32_16x16x32_bf16 a[184:187], v[60:63], v[80:83], a[184:187]
    v_mfma_f32_16x16x32_bf16 a[188:191], v[60:63], v[84:87], a[188:191]
    v_mfma_f32_16x16x32_bf16 a[156:159], v[56:59], v[84:87], a[156:159]
    v_mfma_f32_16x16x32_bf16 a[216:219], v[64:67], v[80:83], a[216:219]
    v_mfma_f32_16x16x32_bf16 a[248:251], v[68:71], v[80:83], a[248:251]
    v_mfma_f32_16x16x32_bf16 a[252:255], v[68:71], v[84:87], a[252:255]
    v_mfma_f32_16x16x32_bf16 a[220:223], v[64:67], v[84:87], a[220:223]
    s_setpc_b64 s[54:55]
t_g1:
    s_mov_b32 s43, 0
    v_add_u32 v14, s49, v23
    v_xor_b32 v15, 64, v14
    ds_read_b128 v[72:75], v14 offset:0
    ds_read_b128 v[76:79], v14 offset:2048
    ds_read_b128 v[44:47], v12 offset:2048
    ds_read_b128 v[40:43], v12 offset:0
    ds_read_b128 v[52:55], v12 offset:6144
    ds_read_b128 v[48:51], v12 offset:4096
    ds_read_b128 v[60:63], v12 offset:10240
    ds_read_b128 v[56:59], v12 offset:8192
    ds_read_b128 v[68:71], v12 offset:14336
    ds_read_b128 v[64:67], v12 offset:12288
    s_waitcnt lgkmcnt(6)
    v_mfma_f32_16x16x32_bf16 a[0:3], v[40:43], v[72:75], 0
    s_xor_b32 m0, s44, 0
    v_mfma_f32_16x16x32_bf16 a[32:35], v[44:47], v[72:75], 0
    buffer_load_dwordx4 v4, s[8:11], s20 offen lds
    v_mfma_f32_16x16x32_bf16 a[36:39], v[44:47], v[76:79], 0
    ds_read_b128 v[80:83], v14 offset:4096
    v_mfma_f32_16x16x32_bf16 a[4:7], v[40:43], v[76:79], 0
    s_waitcnt lgkmcnt(5)
    v_mfma_f32_16x16x32_bf16 a[64:67], v[48:51], v[72:75], 0
    ds_read_b128 v[84:87], v14 offset:6144
    s_xor_b32 m0, s44, 1024
    v_mfma_f32_16x16x32_bf16 a[96:99], v[52:55], v[72:75], 0
    buffer_load_dwordx4 v5, s[8:11], s20 offen lds
    v_mfma_f32_16x16x32_bf16 a[100:103], v[52:55], v[76:79], 0
    s_add_u32 s20, s20, 128
    v_mfma_f32_16x16x32_bf16 a[68:71], v[48:51], v[76:79], 0
    s_waitcnt lgkmcnt(4)
    v_mfma_f32_16x16x32_bf16 a[128:131], v[56:59], v[72:75], 0
    s_mov_b64 vcc, 0
    s_xor_b32 m0, s44, 2048
    v_mfma_f32_16x16x32_bf16 a[160:163], v[60:63], v[72:75], 0
    buffer_load_dwordx4 v4, s[8:11], s21 offen lds
    v_mfma_f32_16x16x32_bf16 a[164:167], v[60:63], v[76:79], 0
    s_bitcmp1_b32 s43, 0
    s_cselect_b32 s61, s5, 0
    v_mfma_f32_16x16x32_bf16 a[132:135], v[56:59], v[76:79], 0
    s_lshl1_add_u32 s53, s61, s50
    s_waitcnt lgkmcnt(2)
    v_mfma_f32_16x16x32_bf16 a[192:195], v[64:67], v[72:75], 0
    s_bitcmp1_b32 s43, 1
    s_cselect_b32 s61, s51, 0
    v_mfma_f32_16x16x32_bf16 a[224:227], v[68:71], v[72:75], 0
    s_add_u32 s53, s53, s61
    s_bitcmp1_b32 s43, 2
    v_mfma_f32_16x16x32_bf16 a[228:231], v[68:71], v[76:79], 0
    s_cselect_b32 s61, s52, 0
    s_add_u32 s53, s53, s61
    v_mfma_f32_16x16x32_bf16 a[196:199], v[64:67], v[76:79], 0
    s_lshl_b32 s29, s43, 4
    s_waitcnt lgkmcnt(1)
    v_mfma_f32_16x16x32_bf16 a[8:11], v[40:43], v[80:83], 0
    s_mov_b64 vcc, -1
    s_xor_b32 m0, s44, 3072
    v_mfma_f32_16x16x32_bf16 a[40:43], v[44:47], v[80:83], 0
    buffer_load_dwordx4 v5, s[8:11], s21 offen lds
    s_waitcnt lgkmcnt(0)
    v_mfma_f32_16x16x32_bf16 a[44:47], v[44:47], v[84:87], 0
    ds_read_b128 v[72:75], v14 offset:8192
    s_add_u32 s21, s21, 128
    v_mfma_f32_16x16x32_bf16 a[12:15], v[40:43], v[84:87], 0
    s_xor_b32 m0, s44, 16384
    v_mfma_f32_16x16x32_bf16 a[72:75], v[48:51], v[80:83], 0
    ds_read_b128 v[76:79], v14 offset:10240
    buffer_load_dwordx4 v4, s[8:11], s22 offen lds
    v_mfma_f32_16x16x32_bf16 a[104:107], v[52:55], v[80:83], 0
    s_xor_b32 m0, s44, 17408
    v_mfma_f32_16x16x32_bf16 a[108:111], v[52:55], v[84:87], 0
    buffer_load_dwordx4 v5, s[8:11], s22 offen lds
    v_mfma_f32_16x16x32_bf16 a[76:79], v[48:51], v[84:87], 0
    s_add_u32 s22, s22, 128
    v_mfma_f32_16x16x32_bf16 a[136:139], v[56:59], v[80:83], 0
    s_xor_b32 m0, s44, 18432
    v_mfma_f32_16x16x32_bf16 a[168:171], v[60:63], v[80:83], 0
    buffer_load_dwordx4 v4, s[8:11], s23 offen lds
    v_mfma_f32_16x16x32_bf16 a[172:175], v[60:63], v[84:87], 0
    v_mfma_f32_16x16x32_bf16 a[140:143], v[56:59], v[84:87], 0
    v_mfma_f32_16x16x32_bf16 a[200:203], v[64:67], v[80:83], 0
    s_xor_b32 m0, s44, 19456
    v_mfma_f32_16x16x32_bf16 a[232:235], v[68:71], v[80:83], 0
    buffer_load_dwordx4 v5, s[8:11], s23 offen lds
    v_mfma_f32_16x16x32_bf16 a[236:239], v[68:71], v[84:87], 0
    s_add_u32 s23, s23, 128
    s_cmp_ge_u32 s44, 98304
    v_mfma_f32_16x16x32_bf16 a[204:207], v[64:67], v[84:87], 0
    s_cselect_b32 s60, s6, s7
    s_waitcnt lgkmcnt(1)
    v_mfma_f32_16x16x32_bf16 a[16:19], v[40:43], v[72:75], 0
    s_add_u32 s44, s44, s60
    v_mfma_f32_16x16x32_bf16 a[48:51], v[44:47], v[72:75], 0
    s_waitcnt lgkmcnt(0)
    v_mfma_f32_16x16x32_bf16 a[52:55], v[44:47], v[76:79], 0
    ds_read_b128 v[80:83], v14 offset:12288
    v_mfma_f32_16x16x32_bf16 a[20:23], v[40:43], v[76:79], 0
    v_mfma_f32_16x16x32_bf16 a[80:83], v[48:51], v[72:75], 0
    ds_read_b128 v[84:87], v14 offset:14336
    s_set_gpr_idx_on s29, gpr_idx(SRC0)
    v_mov_b32 v24, v128
    v_mov_b32 v25, v129
    v_mov_b32 v26, v130
    v_mov_b32 v27, v131
    s_set_gpr_idx_off
    v_mfma_f32_16x16x32_bf16 a[112:115], v[52:55], v[72:75], 0
    v_mfma_f32_16x16x32_bf16 a[116:119], v[52:55], v[76:79], 0
    s_set_gpr_idx_on s29, gpr_idx(SRC0)
    v_mov_b32 v28, v132
    v_mov_b32 v29, v133
    v_mov_b32 v30, v134
    v_mov_b32 v31, v135
    s_set_gpr_idx_off
    v_mfma_f32_16x16x32_bf16 a[84:87], v[48:51], v[76:79], 0
    v_mfma_f32_16x16x32_bf16 a[144:147], v[56:59], v[72:75], 0
    s_set_gpr_idx_on s29, gpr_idx(SRC0)
    v_mov_b32 v32, v136
    v_mov_b32 v33, v137
    v_mov_b32 v34, v138
    v_mov_b32 v35, v139
    s_set_gpr_idx_off
    v_mfma_f32_16x16x32_bf16 a[176:179], v[60:63], v[72:75], 0
    v_mfma_f32_16x16x32_bf16 a[180:183], v[60:63], v[76:79], 0
    s_set_gpr_idx_on s29, gpr_idx(SRC0)
    v_mov_b32 v36, v140
    v_mov_b32 v37, v141
    v_mov_b32 v38, v142
    v_mov_b32 v39, v143
    s_set_gpr_idx_off
    v_mfma_f32_16x16x32_bf16 a[148:151], v[56:59], v[76:79], 0
    v_mfma_f32_16x16x32_bf16 a[208:211], v[64:67], v[72:75], 0
    buffer_store_dwordx4 v[24:27], v2, s[16:19], s53 offen sc1
    v_mfma_f32_16x16x32_bf16 a[240:243], v[68:71], v[72:75], 0
    v_mfma_f32_16x16x32_bf16 a[244:247], v[68:71], v[76:79], 0
    buffer_store_dwordx4 v[28:31], v3, s[16:19], s53 offen sc1
    v_mfma_f32_16x16x32_bf16 a[212:215], v[64:67], v[76:79], 0
    s_add_u32 s53, s53, s5
    s_waitcnt lgkmcnt(1)
    v_mfma_f32_16x16x32_bf16 a[24:27], v[40:43], v[80:83], 0
    ds_read_b128 v[72:75], v15 offset:0
    buffer_store_dwordx4 v[32:35], v2, s[16:19], s53 offen sc1
    v_mfma_f32_16x16x32_bf16 a[56:59], v[44:47], v[80:83], 0
    ds_read_b128 v[76:79], v15 offset:2048
    s_waitcnt lgkmcnt(2)
    v_mfma_f32_16x16x32_bf16 a[60:63], v[44:47], v[84:87], 0
    ds_read_b128 v[44:47], v13 offset:2048
    buffer_store_dwordx4 v[36:39], v3, s[16:19], s53 offen sc1
    v_mfma_f32_16x16x32_bf16 a[28:31], v[40:43], v[84:87], 0
    ds_read_b128 v[40:43], v13 offset:0
    v_mfma_f32_16x16x32_bf16 a[88:91], v[48:51], v[80:83], 0
    v_mfma_f32_16x16x32_bf16 a[120:123], v[52:55], v[80:83], 0
    v_mfma_f32_16x16x32_bf16 a[124:127], v[52:55], v[84:87], 0
    ds_read_b128 v[52:55], v13 offset:6144
    v_mfma_f32_16x16x32_bf16 a[92:95], v[48:51], v[84:87], 0
    ds_read_b128 v[48:51], v13 offset:4096
    v_mfma_f32_16x16x32_bf16 a[152:155], v[56:59], v[80:83], 0
    v_mfma_f32_16x16x32_bf16 a[184:187], v[60:63], v[80:83], 0
    v_mfma_f32_16x16x32_bf16 a[188:191], v[60:63], v[84:87], 0
    ds_read_b128 v[60:63], v13 offset:10240
    v_mfma_f32_16x16x32_bf16 a[156:159], v[56:59], v[84:87], 0
    ds_read_b128 v[56:59], v13 offset:8192
    v_mfma_f32_16x16x32_bf16 a[216:219], v[64:67], v[80:83], 0
    v_mfma_f32_16x16x32_bf16 a[248:251], v[68:71], v[80:83], 0
    v_mfma_f32_16x16x32_bf16 a[252:255], v[68:71], v[84:87], 0
    ds_read_b128 v[68:71], v13 offset:14336
    v_mfma_f32_16x16x32_bf16 a[220:223], v[64:67], v[84:87], 0
    ds_read_b128 v[64:67], v13 offset:12288
    s_branch t_g1_b
t_g1_as:
    s_waitcnt lgkmcnt(6)
    v_mfma_f32_16x16x32_bf16 a[0:3], v[40:43], v[72:75], a[0:3]
    s_xor_b32 m0, s44, 0
    v_mfma_f32_16x16x32_bf16 a[32:35], v[44:47], v[72:75], a[32:35]
    buffer_load_dwordx4 v4, s[8:11], s20 offen lds
    v_mfma_f32_16x16x32_bf16 a[36:39], v[44:47], v[76:79], a[36:39]
    ds_read_b128 v[80:83], v14 offset:4096
    v_mfma_f32_16x16x32_bf16 a[4:7], v[40:43], v[76:79], a[4:7]
    s_waitcnt lgkmcnt(5)
    v_mfma_f32_16x16x32_bf16 a[64:67], v[48:51], v[72:75], a[64:67]
    ds_read_b128 v[84:87], v14 offset:6144
    s_xor_b32 m0, s44, 1024
    v_mfma_f32_16x16x32_bf16 a[96:99], v[52:55], v[72:75], a[96:99]
    buffer_load_dwordx4 v5, s[8:11], s20 offen lds
    v_mfma_f32_16x16x32_bf16 a[100:103], v[52:55], v[76:79], a[100:103]
    s_add_u32 s20, s20, 128
    v_mfma_f32_16x16x32_bf16 a[68:71], v[48:51], v[76:79], a[68:71]
    s_waitcnt lgkmcnt(4)
    v_mfma_f32_16x16x32_bf16 a[128:131], v[56:59], v[72:75], a[128:131]
    s_mov_b64 vcc, 0
    s_xor_b32 m0, s44, 2048
    v_mfma_f32_16x16x32_bf16 a[160:163], v[60:63], v[72:75], a[160:163]
    buffer_load_dwordx4 v4, s[8:11], s21 offen lds
    v_mfma_f32_16x16x32_bf16 a[164:167], v[60:63], v[76:79], a[164:167]
    s_bitcmp1_b32 s43, 0
    s_cselect_b32 s61, s5, 0
    v_mfma_f32_16x16x32_bf16 a[132:135], v[56:59], v[76:79], a[132:135]
    s_lshl1_add_u32 s53, s61, s50
    s_waitcnt lgkmcnt(2)
    v_mfma_f32_16x16x32_bf16 a[192:195], v[64:67], v[72:75], a[192:195]
    s_bitcmp1_b32 s43, 1
    s_cselect_b32 s61, s51, 0
    v_mfma_f32_16x16x32_bf16 a[224:227], v[68:71], v[72:75], a[224:227]
    s_add_u32 s53, s53, s61
    s_bitcmp1_b32 s43, 2
    v_mfma_f32_16x16x32_bf16 a[228:231], v[68:71], v[76:79], a[228:231]
    s_cselect_b32 s61, s52, 0
    s_add_u32 s53, s53, s61
    v_mfma_f32_16x16x32_bf16 a[196:199], v[64:67], v[76:79], a[196:199]
    s_lshl_b32 s29, s43, 4
    s_waitcnt lgkmcnt(1)
    v_mfma_f32_16x16x32_bf16 a[8:11], v[40:43], v[80:83], a[8:11]
    s_mov_b64 vcc, -1
    s_xor_b32 m0, s44, 3072
    v_mfma_f32_16x16x32_bf16 a[40:43], v[44:47], v[80:83], a[40:43]
    buffer_load_dwordx4 v5, s[8:11], s21 offen lds
    s_waitcnt lgkmcnt(0)
    v_mfma_f32_16x16x32_bf16 a[44:47], v[44:47], v[84:87], a[44:47]
    ds_read_b128 v[72:75], v14 offset:8192
    s_add_u32 s21, s21, 128
    v_mfma_f32_16x16x32_bf16 a[12:15], v[40:43], v[84:87], a[12:15]
    s_xor_b32 m0, s44, 16384
    v_mfma_f32_16x16x32_bf16 a[72:75], v[48:51], v[80:83], a[72:75]
    ds_read_b128 v[76:79], v14 offset:10240
    buffer_load_dwordx4 v4, s[8:11], s22 offen lds
    v_mfma_f32_16x16x32_bf16 a[104:107], v[52:55], v[80:83], a[104:107]
    s_xor_b32 m0, s44, 17408
    v_mfma_f32_16x16x32_bf16 a[108:111], v[52:55], v[84:87], a[108:111]
    buffer_load_dwordx4 v5, s[8:11], s22 offen lds
    v_mfma_f32_16x16x32_bf16 a[76:79], v[48:51], v[84:87], a[76:79]
    s_add_u32 s22, s22, 128
    v_mfma_f32_16x16x32_bf16 a[136:139], v[56:59], v[80:83], a[136:139]
    s_xor_b32 m0, s44, 18432
    v_mfma_f32_16x16x32_bf16 a[168:171], v[60:63], v[80:83], a[168:171]
    buffer_load_dwordx4 v4, s[8:11], s23 offen lds
    v_mfma_f32_16x16x32_bf16 a[172:175], v[60:63], v[84:87], a[172:175]
    v_mfma_f32_16x16x32_bf16 a[140:143], v[56:59], v[84:87], a[140:143]
    v_mfma_f32_16x16x32_bf16 a[200:203], v[64:67], v[80:83], a[200:203]
    s_xor_b32 m0, s44, 19456
    v_mfma_f32_16x16x32_bf16 a[232:235], v[68:71], v[80:83], a[232:235]
    buffer_load_dwordx4 v5, s[8:11], s23 offen lds
    v_mfma_f32_16x16x32_bf16 a[236:239], v[68:71], v[84:87], a[236:239]
    s_add_u32 s23, s23, 128
    s_cmp_ge_u32 s44, 98304
    v_mfma_f32_16x16x32_bf16 a[204:207], v[64:67], v[84:87], a[204:207]
    s_cselect_b32 s60, s6, s7
    s_waitcnt lgkmcnt(1)
    v_mfma_f32_16x16x32_bf16 a[16:19], v[40:43], v[72:75], a[16:19]
    s_add_u32 s44, s44, s60
    v_mfma_f32_16x16x32_bf16 a[48:51], v[44:47], v[72:75], a[48:51]
    s_waitcnt lgkmcnt(0)
    v_mfma_f32_16x16x32_bf16 a[52:55], v[44:47], v[76:79], a[52:55]
    ds_read_b128 v[80:83], v14 offset:12288
    v_mfma_f32_16x16x32_bf16 a[20:23], v[40:43], v[76:79], a[20:23]
    v_mfma_f32_16x16x32_bf16 a[80:83], v[48:51], v[72:75], a[80:83]
    ds_read_b128 v[84:87], v14 offset:14336
    s_set_gpr_idx_on s29, gpr_idx(SRC0)
    v_mov_b32 v24, v128
    v_mov_b32 v25, v129
    v_mov_b32 v26, v130
    v_mov_b32 v27, v131
    s_set_gpr_idx_off
    v_mfma_f32_16x16x32_bf16 a[112:115], v[52:55], v[72:75], a[112:115]
    v_mfma_f32_16x16x32_bf16 a[116:119], v[52:55], v[76:79], a[116:119]
    s_set_gpr_idx_on s29, gpr_idx(SRC0)
    v_mov_b32 v28, v132
    v_mov_b32 v29, v133
    v_mov_b32 v30, v134
    v_mov_b32 v31, v135
    s_set_gpr_idx_off
    v_mfma_f32_16x16x32_bf16 a[84:87], v[48:51], v[76:79], a[84:87]
    v_mfma_f32_16x16x32_bf16 a[144:147], v[56:59], v[72:75], a[144:147]
    s_set_gpr_idx_on s29, gpr_idx(SRC0)
    v_mov_b32 v32, v136
    v_mov_b32 v33, v137
    v_mov_b32 v34, v138
    v_mov_b32 v35, v139
    s_set_gpr_idx_off
    v_mfma_f32_16x16x32_bf16 a[176:179], v[60:63], v[72:75], a[176:179]
    v_mfma_f32_16x16x32_bf16 a[180:183], v[60:63], v[76:79], a[180:183]
    s_set_gpr_idx_on s29, gpr_idx(SRC0)
    v_mov_b32 v36, v140
    v_mov_b32 v37, v141
    v_mov_b32 v38, v142
    v_mov_b32 v39, v143
    s_set_gpr_idx_off
    v_mfma_f32_16x16x32_bf16 a[148:151], v[56:59], v[76:79], a[148:151]
    v_mfma_f32_16x16x32_bf16 a[208:211], v[64:67], v[72:75], a[208:211]
    buffer_store_dwordx4 v[24:27], v2, s[16:19], s53 offen sc1
    v_mfma_f32_16x16x32_bf16 a[240:243], v[68:71], v[72:75], a[240:243]
    v_mfma_f32_16x16x32_bf16 a[244:247], v[68:71], v[76:79], a[244:247]
    buffer_store_dwordx4 v[28:31], v3, s[16:19], s53 offen sc1
    v_mfma_f32_16x16x32_bf16 a[212:215], v[64:67], v[76:79], a[212:215]
    s_add_u32 s53, s53, s5
    s_waitcnt lgkmcnt(1)
    v_mfma_f32_16x16x32_bf16 a[24:27], v[40:43], v[80:83], a[24:27]
    ds_read_b128 v[72:75], v15 offset:0
    buffer_store_dwordx4 v[32:35], v2, s[16:19], s53 offen sc1
    v_mfma_f32_16x16x32_bf16 a[56:59], v[44:47], v[80:83], a[56:59]
    ds_read_b128 v[76:79], v15 offset:2048
    s_waitcnt lgkmcnt(2)
    v_mfma_f32_16x16x32_bf16 a[60:63], v[44:47], v[84:87], a[60:63]
    ds_read_b128 v[44:47], v13 offset:2048
    buffer_store_dwordx4 v[36:39], v3, s[16:19], s53 offen sc1
    v_mfma_f32_16x16x32_bf16 a[28:31], v[40:43], v[84:87], a[28:31]
    ds_read_b128 v[40:43], v13 offset:0
    v_mfma_f32_16x16x32_bf16 a[88:91], v[48:51], v[80:83], a[88:91]
    v_mfma_f32_16x16x32_bf16 a[120:123], v[52:55], v[80:83], a[120:123]
    v_mfma_f32_16x16x32_bf16 a[124:127], v[52:55], v[84:87], a[124:127]
    ds_read_b128 v[52:55], v13 offset:6144
    v_mfma_f32_16x16x32_bf16 a[92:95], v[48:51], v[84:87], a[92:95]
    ds_read_b128 v[48:51], v13 offset:4096
    v_mfma_f32_16x16x32_bf16 a[152:155], v[56:59], v[80:83], a[152:155]
    v_mfma_f32_16x16x32_bf16 a[184:187], v[60:63], v[80:83], a[184:187]
    v_mfma_f32_16x16x32_bf16 a[188:191], v[60:63], v[84:87], a[188:191]
    ds_read_b128 v[60:63], v13 offset:10240
    v_mfma_f32_16x16x32_bf16 a[156:159], v[56:59], v[84:87], a[156:159]
    ds_read_b128 v[56:59], v13 offset:8192
    v_mfma_f32_16x16x32_bf16 a[216:219], v[64:67], v[80:83], a[216:219]
    v_mfma_f32_16x16x32_bf16 a[248:251], v[68:71], v[80:83], a[248:251]
    v_mfma_f32_16x16x32_bf16 a[252:255], v[68:71], v[84:87], a[252:255]
    ds_read_b128 v[68:71], v13 offset:14336
    v_mfma_f32_16x16x32_bf16 a[220:223], v[64:67], v[84:87], a[220:223]
    ds_read_b128 v[64:67], v13 offset:12288
    s_branch t_g1_b
t_g1_hook:
    s_cmp_eq_u32 s43, 1
    s_cbranch_scc1 t_g1_sig0
    s_cmp_lt_u32 s43, 8
    s_cbranch_scc1 t_g1_as
    s_cmp_eq_u32 s43, 14
    s_cbranch_scc1 t_g1_sws
    s_cmp_eq_u32 s43, 15
    s_cbranch_scc1 t_g1_swp
    s_cmp_lg_u32 s58, 0
    s_cbranch_scc1 t_g1_a
    s_cmp_eq_u32 s43, 13
    s_cbranch_scc1 t_g1_wait
    s_cmp_lg_u32 s43, 9
    s_cbranch_scc1 t_g1_a
    s_cmp_eq_u32 s4, 0
    s_cbranch_scc1 t_g1_a
    v_mov_b32 v24, s4
    v_mov_b32 v25, 1
    s_mov_b64 exec, 1
    global_atomic_add v24, v25, s[98:99] sc1
    s_mov_b64 exec, -1
    s_branch t_g1_a
t_g1_wait:
    s_cmp_eq_u32 s3, 0
    s_cbranch_scc1 t_g1_a
    s_mov_b32 s62, 0
L_sw_97:
    s_load_dword s63, s[98:99], s3 glc
    s_add_u32 s62, s62, 1
    s_cmp_gt_u32 s62, 0x200000
    s_cbranch_scc1 chain_kernel_wabort
    s_waitcnt lgkmcnt(0)
    s_cmp_ge_u32 s63, 32
    s_cbranch_scc1 L_swok_98
    s_sleep 16
    s_branch L_sw_97
L_swok_98:
    s_branch t_g1_a
t_g1_sig0:
    s_cmp_eq_u32 s1, 0
    s_cbranch_scc1 t_g1_as
    v_mov_b32 v24, s1
    v_mov_b32 v25, 1
    s_mov_b64 exec, 1
    global_atomic_add v24, v25, s[98:99] sc1
    s_mov_b64 exec, -1
    s_mov_b32 s1, 0
    s_branch t_g1_as
t_g1_sws:
    s_mov_b32 s12, s36
    s_mov_b32 s13, s37
    s_mov_b32 s14, s38
    s_and_b32 s45, s45, 0xffffb7ff
    s_bitcmp1_b32 s0, 3
    s_cselect_b32 s24, s41, 0
    s_cselect_b32 s26, 0, s41
    s_cselect_b32 s60, 0x4000, 0
    s_or_b32 s45, s45, s60
    s_add_u32 s24, s24, s39
    s_add_u32 s26, s26, s39
    s_bitcmp1_b32 s0, 2
    s_cselect_b32 s61, s40, 0
    s_cselect_b32 s62, 0, s40
    s_cselect_b32 s60, 0x800, 0
    s_or_b32 s45, s45, s60
    s_add_u32 s25, s24, s62
    s_add_u32 s24, s24, s61
    s_add_u32 s27, s26, s62
    s_add_u32 s26, s26, s61
    s_mov_b32 s28, s42
    v_mov_b32 v6, v10
    v_mov_b32 v7, v11
    s_branch t_g1_a
t_g1_swp:
    s_mov_b32 s8, s30
    s_mov_b32 s9, s31
    s_mov_b32 s10, s32
    s_and_b32 s44, s44, 0xffffb7ff
    s_bitcmp1_b32 s0, 1
    s_cselect_b32 s20, s35, 0
    s_cselect_b32 s22, 0, s35
    s_cselect_b32 s60, 0x4000, 0
    s_or_b32 s44, s44, s60
    s_add_u32 s20, s20, s33
    s_add_u32 s22, s22, s33
    s_bitcmp1_b32 s0, 0
    s_cselect_b32 s61, s34, 0
    s_cselect_b32 s62, 0, s34
    s_cselect_b32 s60, 0x800, 0
    s_or_b32 s44, s44, s60
    s_add_u32 s21, s20, s62
    s_add_u32 s20, s20, s61
    s_add_u32 s23, s22, s62
    s_add_u32 s22, s22, s61
    v_mov_b32 v4, v8
    v_mov_b32 v5, v9
t_g1_a:
    s_waitcnt lgkmcnt(6)
    v_mfma_f32_16x16x32_bf16 a[0:3], v[40:43], v[72:75], a[0:3]
    s_xor_b32 m0, s44, 0
    v_mfma_f32_16x16x32_bf16 a[32:35], v[44:47], v[72:75], a[32:35]
    buffer_load_dwordx4 v4, s[8:11], s20 offen lds
    v_mfma_f32_16x16x32_bf16 a[36:39], v[44:47], v[76:79], a[36:39]
    ds_read_b128 v[80:83], v14 offset:4096
    v_mfma_f32_16x16x32_bf16 a[4:7], v[40:43], v[76:79], a[4:7]
    s_waitcnt lgkmcnt(5)
    v_mfma_f32_16x16x32_bf16 a[64:67], v[48:51], v[72:75], a[64:67]
    ds_read_b128 v[84:87], v14 offset:6144
    s_xor_b32 m0, s44, 1024
    v_mfma_f32_16x16x32_bf16 a[96:99], v[52:55], v[72:75], a[96:99]
    buffer_load_dwordx4 v5, s[8:11], s20 offen lds
    v_mfma_f32_16x16x32_bf16 a[100:103], v[52:55], v[76:79], a[100:103]
    s_add_u32 s20, s20, 128
    v_mfma_f32_16x16x32_bf16 a[68:71], v[48:51], v[76:79], a[68:71]
    s_waitcnt lgkmcnt(4)
    v_mfma_f32_16x16x32_bf16 a[128:131], v[56:59], v[72:75], a[128:131]
    s_mov_b64 vcc, 0
    s_xor_b32 m0, s44, 2048
    v_mfma_f32_16x16x32_bf16 a[160:163], v[60:63], v[72:75], a[160:163]
    buffer_load_dwordx4 v4, s[8:11], s21 offen lds
    v_mfma_f32_16x16x32_bf16 a[164:167], v[60:63], v[76:79], a[164:167]
    v_mfma_f32_16x16x32_bf16 a[132:135], v[56:59], v[76:79], a[132:135]
    s_waitcnt lgkmcnt(2)
    v_mfma_f32_16x16x32_bf16 a[192:195], v[64:67], v[72:75], a[192:195]
    s_xor_b32 m0, s44, 3072
    v_mfma_f32_16x16x32_bf16 a[224:227], v[68:71], v[72:75], a[224:227]
    buffer_load_dwordx4 v5, s[8:11], s21 offen lds
    v_mfma_f32_16x16x32_bf16 a[228:231], v[68:71], v[76:79], a[228:231]
    s_add_u32 s21, s21, 128
    v_mfma_f32_16x16x32_bf16 a[196:199], v[64:67], v[76:79], a[196:199]
    s_waitcnt lgkmcnt(1)
    v_mfma_f32_16x16x32_bf16 a[8:11], v[40:43], v[80:83], a[8:11]
    s_xor_b32 m0, s44, 16384
    v_mfma_f32_16x16x32_bf16 a[40:43], v[44:47], v[80:83], a[40:43]
    buffer_load_dwordx4 v4, s[8:11], s22 offen lds
    s_waitcnt lgkmcnt(0)
    v_mfma_f32_16x16x32_bf16 a[44:47], v[44:47], v[84:87], a[44:47]
    ds_read_b128 v[72:75], v14 offset:8192
    v_mfma_f32_16x16x32_bf16 a[12:15], v[40:43], v[84:87], a[12:15]
    v_mfma_f32_16x16x32_bf16 a[72:75], v[48:51], v[80:83], a[72:75]
    ds_read_b128 v[76:79], v14 offset:10240
    s_xor_b32 m0, s44, 17408
    v_mfma_f32_16x16x32_bf16 a[104:107], v[52:55], v[80:83], a[104:107]
    buffer_load_dwordx4 v5, s[8:11], s22 offen lds
    v_mfma_f32_16x16x32_bf16 a[108:111], v[52:55], v[84:87], a[108:111]
    s_add_u32 s22, s22, 128
    v_mfma_f32_16x16x32_bf16 a[76:79], v[48:51], v[84:87], a[76:79]
    v_mfma_f32_16x16x32_bf16 a[136:139], v[56:59], v[80:83], a[136:139]
    s_xor_b32 m0, s44, 18432
    v_mfma_f32_16x16x32_bf16 a[168:171], v[60:63], v[80:83], a[168:171]
    buffer_load_dwordx4 v4, s[8:11], s23 offen lds
    v_mfma_f32_16x16x32_bf16 a[172:175], v[60:63], v[84:87], a[172:175]
    v_mfma_f32_16x16x32_bf16 a[140:143], v[56:59], v[84:87], a[140:143]
    v_mfma_f32_16x16x32_bf16 a[200:203], v[64:67], v[80:83], a[200:203]
    s_xor_b32 m0, s44, 19456
    v_mfma_f32_16x16x32_bf16 a[232:235], v[68:71], v[80:83], a[232:235]
    buffer_load_dwordx4 v5, s[8:11], s23 offen lds
    v_mfma_f32_16x16x32_bf16 a[236:239], v[68:71], v[84:87], a[236:239]
    s_add_u32 s23, s23, 128
    s_cmp_ge_u32 s44, 98304
    v_mfma_f32_16x16x32_bf16 a[204:207], v[64:67], v[84:87], a[204:207]
    s_cselect_b32 s60, s6, s7
    s_waitcnt lgkmcnt(1)
    v_mfma_f32_16x16x32_bf16 a[16:19], v[40:43], v[72:75], a[16:19]
    s_add_u32 s44, s44, s60
    v_mfma_f32_16x16x32_bf16 a[48:51], v[44:47], v[72:75], a[48:51]
    s_waitcnt lgkmcnt(0)
    v_mfma_f32_16x16x32_bf16 a[52:55], v[44:47], v[76:79], a[52:55]
    ds_read_b128 v[80:83], v14 offset:12288
    v_mfma_f32_16x16x32_bf16 a[20:23], v[40:43], v[76:79], a[20:23]
    v_mfma_f32_16x16x32_bf16 a[80:83], v[48:51], v[72:75], a[80:83]
    ds_read_b128 v[84:87], v14 offset:14336
    v_mfma_f32_16x16x32_bf16 a[112:115], v[52:55], v[72:75], a[112:115]
    v_mfma_f32_16x16x32_bf16 a[116:119], v[52:55], v[76:79], a[116:119]
    v_mfma_f32_16x16x32_bf16 a[84:87], v[48:51], v[76:79], a[84:87]
    v_mfma_f32_16x16x32_bf16 a[144:147], v[56:59], v[72:75], a[144:147]
    v_mfma_f32_16x16x32_bf16 a[176:179], v[60:63], v[72:75], a[176:179]
    v_mfma_f32_16x16x32_bf16 a[180:183], v[60:63], v[76:79], a[180:183]
    v_mfma_f32_16x16x32_bf16 a[148:151], v[56:59], v[76:79], a[148:151]
    v_mfma_f32_16x16x32_bf16 a[208:211], v[64:67], v[72:75], a[208:211]
    v_mfma_f32_16x16x32_bf16 a[240:243], v[68:71], v[72:75], a[240:243]
    v_mfma_f32_16x16x32_bf16 a[244:247], v[68:71], v[76:79], a[244:247]
    v_mfma_f32_16x16x32_bf16 a[212:215], v[64:67], v[76:79], a[212:215]
    s_waitcnt lgkmcnt(1)
    v_mfma_f32_16x16x32_bf16 a[24:27], v[40:43], v[80:83], a[24:27]
    ds_read_b128 v[72:75], v15 offset:0
    v_mfma_f32_16x16x32_bf16 a[56:59], v[44:47], v[80:83], a[56:59]
    ds_read_b128 v[76:79], v15 offset:2048
    s_waitcnt lgkmcnt(2)
    v_mfma_f32_16x16x32_bf16 a[60:63], v[44:47], v[84:87], a[60:63]
    ds_read_b128 v[44:47], v13 offset:2048
    v_mfma_f32_16x16x32_bf16 a[28:31], v[40:43], v[84:87], a[28:31]
    ds_read_b128 v[40:43], v13 offset:0
    v_mfma_f32_16x16x32_bf16 a[88:91], v[48:51], v[80:83], a[88:91]
    v_mfma_f32_16x16x32_bf16 a[120:123], v[52:55], v[80:83], a[120:123]
    v_mfma_f32_16x16x32_bf16 a[124:127], v[52:55], v[84:87], a[124:127]
    ds_read_b128 v[52:55], v13 offset:6144
    v_mfma_f32_16x16x32_bf16 a[92:95], v[48:51], v[84:87], a[92:95]
    ds_read_b128 v[48:51], v13 offset:4096
    v_mfma_f32_16x16x32_bf16 a[152:155], v[56:59], v[80:83], a[152:155]
    v_mfma_f32_16x16x32_bf16 a[184:187], v[60:63], v[80:83], a[184:187]
    v_mfma_f32_16x16x32_bf16 a[188:191], v[60:63], v[84:87], a[188:191]
    ds_read_b128 v[60:63], v13 offset:10240
    v_mfma_f32_16x16x32_bf16 a[156:159], v[56:59], v[84:87], a[156:159]
    ds_read_b128 v[56:59], v13 offset:8192
    v_mfma_f32_16x16x32_bf16 a[216:219], v[64:67], v[80:83], a[216:219]
    v_mfma_f32_16x16x32_bf16 a[248:251], v[68:71], v[80:83], a[248:251]
    v_mfma_f32_16x16x32_bf16 a[252:255], v[68:71], v[84:87], a[252:255]
    ds_read_b128 v[68:71], v13 offset:14336
    v_mfma_f32_16x16x32_bf16 a[220:223], v[64:67], v[84:87], a[220:223]
    ds_read_b128 v[64:67], v13 offset:12288
t_g1_b:
    s_waitcnt lgkmcnt(6)
    v_mfma_f32_16x16x32_bf16 a[0:3], v[40:43], v[72:75], a[0:3]
    v_mfma_f32_16x16x32_bf16 a[32:35], v[44:47], v[72:75], a[32:35]
    v_mfma_f32_16x16x32_bf16 a[36:39], v[44:47], v[76:79], a[36:39]
    ds_read_b128 v[80:83], v15 offset:4096
    v_mfma_f32_16x16x32_bf16 a[4:7], v[40:43], v[76:79], a[4:7]
    s_cmp_ge_u32 s48, 98304
    s_waitcnt lgkmcnt(5)
    v_mfma_f32_16x16x32_bf16 a[64:67], v[48:51], v[72:75], a[64:67]
    ds_read_b128 v[84:87], v15 offset:6144
    s_cselect_b32 s46, s6, s7
    v_mfma_f32_16x16x32_bf16 a[96:99], v[52:55], v[72:75], a[96:99]
    s_add_u32 s48, s48, s46
    v_mfma_f32_16x16x32_bf16 a[100:103], v[52:55], v[76:79], a[100:103]
    v_mfma_f32_16x16x32_bf16 a[68:71], v[48:51], v[76:79], a[68:71]
    s_cmp_ge_u32 s49, 98304
    s_waitcnt lgkmcnt(4)
    v_mfma_f32_16x16x32_bf16 a[128:131], v[56:59], v[72:75], a[128:131]
    s_cselect_b32 s47, s6, s7
    s_add_u32 s49, s49, s47
    v_mfma_f32_16x16x32_bf16 a[160:163], v[60:63], v[72:75], a[160:163]
    v_mfma_f32_16x16x32_bf16 a[164:167], v[60:63], v[76:79], a[164:167]
    v_mfma_f32_16x16x32_bf16 a[132:135], v[56:59], v[76:79], a[132:135]
    s_waitcnt lgkmcnt(2)
    v_mfma_f32_16x16x32_bf16 a[192:195], v[64:67], v[72:75], a[192:195]
    v_mfma_f32_16x16x32_bf16 a[224:227], v[68:71], v[72:75], a[224:227]
    v_mfma_f32_16x16x32_bf16 a[228:231], v[68:71], v[76:79], a[228:231]
    v_mfma_f32_16x16x32_bf16 a[196:199], v[64:67], v[76:79], a[196:199]
    s_waitcnt lgkmcnt(1)
    v_mfma_f32_16x16x32_bf16 a[8:11], v[40:43], v[80:83], a[8:11]
    s_xor_b32 m0, s45, 0
    v_mfma_f32_16x16x32_bf16 a[40:43], v[44:47], v[80:83], a[40:43]
    buffer_load_dwordx4 v6, s[12:15], s24 offen lds
    s_waitcnt lgkmcnt(0)
    v_mfma_f32_16x16x32_bf16 a[44:47], v[44:47], v[84:87], a[44:47]
    ds_read_b128 v[72:75], v15 offset:8192
    v_add_u32 v12, s46, v12
    v_mfma_f32_16x16x32_bf16 a[12:15], v[40:43], v[84:87], a[12:15]
    v_add_u32 v13, s46, v13
    v_add_u32 v14, s47, v14
    v_mfma_f32_16x16x32_bf16 a[72:75], v[48:51], v[80:83], a[72:75]
    ds_read_b128 v[76:79], v15 offset:10240
    s_xor_b32 m0, s45, 1024
    v_mfma_f32_16x16x32_bf16 a[104:107], v[52:55], v[80:83], a[104:107]
    buffer_load_dwordx4 v7, s[12:15], s24 offen lds
    v_mfma_f32_16x16x32_bf16 a[108:111], v[52:55], v[84:87], a[108:111]
    s_add_u32 s24, s24, s28
    v_mfma_f32_16x16x32_bf16 a[76:79], v[48:51], v[84:87], a[76:79]
    v_mfma_f32_16x16x32_bf16 a[136:139], v[56:59], v[80:83], a[136:139]
    s_xor_b32 m0, s45, 2048
    v_mfma_f32_16x16x32_bf16 a[168:171], v[60:63], v[80:83], a[168:171]
    buffer_load_dwordx4 v6, s[12:15], s25 offen lds
    v_mfma_f32_16x16x32_bf16 a[172:175], v[60:63], v[84:87], a[172:175]
    v_mfma_f32_16x16x32_bf16 a[140:143], v[56:59], v[84:87], a[140:143]
    v_mfma_f32_16x16x32_bf16 a[200:203], v[64:67], v[80:83], a[200:203]
    s_xor_b32 m0, s45, 3072
    v_mfma_f32_16x16x32_bf16 a[232:235], v[68:71], v[80:83], a[232:235]
    buffer_load_dwordx4 v7, s[12:15], s25 offen lds
    v_mfma_f32_16x16x32_bf16 a[236:239], v[68:71], v[84:87], a[236:239]
    s_add_u32 s25, s25, s28
    v_mfma_f32_16x16x32_bf16 a[204:207], v[64:67], v[84:87], a[204:207]
    s_waitcnt lgkmcnt(1)
    v_mfma_f32_16x16x32_bf16 a[16:19], v[40:43], v[72:75], a[16:19]
    s_xor_b32 m0, s45, 16384
    v_mfma_f32_16x16x32_bf16 a[48:51], v[44:47], v[72:75], a[48:51]
    buffer_load_dwordx4 v6, s[12:15], s26 offen lds
    s_waitcnt lgkmcnt(0)
    v_mfma_f32_16x16x32_bf16 a[52:55], v[44:47], v[76:79], a[52:55]
    ds_read_b128 v[80:83], v15 offset:12288
    v_mfma_f32_16x16x32_bf16 a[20:23], v[40:43], v[76:79], a[20:23]
    s_xor_b32 m0, s45, 17408
    v_mfma_f32_16x16x32_bf16 a[80:83], v[48:51], v[72:75], a[80:83]
    ds_read_b128 v[84:87], v15 offset:14336
    buffer_load_dwordx4 v7, s[12:15], s26 offen lds
    v_mfma_f32_16x16x32_bf16 a[112:115], v[52:55], v[72:75], a[112:115]
    s_add_u32 s26, s26, s28
    s_xor_b32 m0, s45, 18432
    v_mfma_f32_16x16x32_bf16 a[116:119], v[52:55], v[76:79], a[116:119]
    buffer_load_dwordx4 v6, s[12:15], s27 offen lds
    v_mfma_f32_16x16x32_bf16 a[84:87], v[48:51], v[76:79], a[84:87]
    s_xor_b32 m0, s45, 19456
    v_mfma_f32_16x16x32_bf16 a[144:147], v[56:59], v[72:75], a[144:147]
    buffer_load_dwordx4 v7, s[12:15], s27 offen lds
    v_mfma_f32_16x16x32_bf16 a[176:179], v[60:63], v[72:75], a[176:179]
    s_add_u32 s27, s27, s28
    s_cmp_ge_u32 s45, 98304
    v_mfma_f32_16x16x32_bf16 a[180:183], v[60:63], v[76:79], a[180:183]
    s_cselect_b32 s60, s6, s7
    s_add_u32 s45, s45, s60
    v_mfma_f32_16x16x32_bf16 a[148:151], v[56:59], v[76:79], a[148:151]
    v_add_u32 v15, s47, v15
    v_mfma_f32_16x16x32_bf16 a[208:211], v[64:67], v[72:75], a[208:211]
    s_add_u32 s43, s43, 1
    s_cmp_eq_u32 s43, 16
    v_mfma_f32_16x16x32_bf16 a[240:243], v[68:71], v[72:75], a[240:243]
    v_mfma_f32_16x16x32_bf16 a[244:247], v[68:71], v[76:79], a[244:247]
    v_mfma_f32_16x16x32_bf16 a[212:215], v[64:67], v[76:79], a[212:215]
    s_waitcnt vmcnt(12) lgkmcnt(0)
    s_cbranch_vccnz t_g1_bar
    s_waitcnt vmcnt(8)
t_g1_bar:
    s_barrier
    s_cbranch_scc1 t_g1_last
    v_mfma_f32_16x16x32_bf16 a[24:27], v[40:43], v[80:83], a[24:27]
    ds_read_b128 v[72:75], v14 offset:0
    v_mfma_f32_16x16x32_bf16 a[56:59], v[44:47], v[80:83], a[56:59]
    ds_read_b128 v[76:79], v14 offset:2048
    v_mfma_f32_16x16x32_bf16 a[60:63], v[44:47], v[84:87], a[60:63]
    ds_read_b128 v[44:47], v12 offset:2048
    v_mfma_f32_16x16x32_bf16 a[28:31], v[40:43], v[84:87], a[28:31]
    ds_read_b128 v[40:43], v12 offset:0
    v_mfma_f32_16x16x32_bf16 a[88:91], v[48:51], v[80:83], a[88:91]
    v_mfma_f32_16x16x32_bf16 a[120:123], v[52:55], v[80:83], a[120:123]
    v_mfma_f32_16x16x32_bf16 a[124:127], v[52:55], v[84:87], a[124:127]
    ds_read_b128 v[52:55], v12 offset:6144
    v_mfma_f32_16x16x32_bf16 a[92:95], v[48:51], v[84:87], a[92:95]
    ds_read_b128 v[48:51], v12 offset:4096
    v_mfma_f32_16x16x32_bf16 a[152:155], v[56:59], v[80:83], a[152:155]
    v_mfma_f32_16x16x32_bf16 a[184:187], v[60:63], v[80:83], a[184:187]
    v_mfma_f32_16x16x32_bf16 a[188:191], v[60:63], v[84:87], a[188:191]
    ds_read_b128 v[60:63], v12 offset:10240
    v_mfma_f32_16x16x32_bf16 a[156:159], v[56:59], v[84:87], a[156:159]
    ds_read_b128 v[56:59], v12 offset:8192
    v_mfma_f32_16x16x32_bf16 a[216:219], v[64:67], v[80:83], a[216:219]
    s_sub_u32 s61, s43, 10
    s_cmp_lt_u32 s61, 3
    v_mfma_f32_16x16x32_bf16 a[248:251], v[68:71], v[80:83], a[248:251]
    v_mfma_f32_16x16x32_bf16 a[252:255], v[68:71], v[84:87], a[252:255]
    ds_read_b128 v[68:71], v12 offset:14336
    v_mfma_f32_16x16x32_bf16 a[220:223], v[64:67], v[84:87], a[220:223]
    ds_read_b128 v[64:67], v12 offset:12288
    s_cbranch_scc1 t_g1_a
    s_branch t_g1_hook
t_g1_last:
    v_mfma_f32_16x16x32_bf16 a[24:27], v[40:43], v[80:83], a[24:27]
    v_mfma_f32_16x16x32_bf16 a[56:59], v[44:47], v[80:83], a[56:59]
    v_mfma_f32_16x16x32_bf16 a[60:63], v[44:47], v[84:87], a[60:63]
    v_mfma_f32_16x16x32_bf16 a[28:31], v[40:43], v[84:87], a[28:31]
    v_mfma_f32_16x16x32_bf16 a[88:91], v[48:51], v[80:83], a[88:91]
    v_mfma_f32_16x16x32_bf16 a[120:123], v[52:55], v[80:83], a[120:123]
    v_mfma_f32_16x16x32_bf16 a[124:127], v[52:55], v[84:87], a[124:127]
    v_mfma_f32_16x16x32_bf16 a[92:95], v[48:51], v[84:87], a[92:95]
    v_mfma_f32_16x16x32_bf16 a[152:155], v[56:59], v[80:83], a[152:155]
    v_mfma_f32_16x16x32_bf16 a[184:187], v[60:63], v[80:83], a[184:187]
    v_mfma_f32_16x16x32_bf16 a[188:191], v[60:63], v[84:87], a[188:191]
    v_mfma_f32_16x16x32_bf16 a[156:159], v[56:59], v[84:87], a[156:159]
    v_mfma_f32_16x16x32_bf16 a[216:219], v[64:67], v[80:83], a[216:219]
    v_mfma_f32_16x16x32_bf16 a[248:251], v[68:71], v[80:83], a[248:251]
    v_mfma_f32_16x16x32_bf16 a[252:255], v[68:71], v[84:87], a[252:255]
    v_mfma_f32_16x16x32_bf16 a[220:223], v[64:67], v[84:87], a[220:223]
    s_setpc_b64 s[54:55]
t_scan:
    s_nop 7
    v_accvgpr_read_b32 v40, a0
    v_accvgpr_read_b32 v42, a4
    v_accvgpr_read_b32 v44, a8
    v_accvgpr_read_b32 v46, a12
    v_accvgpr_read_b32 v41, a16
    v_accvgpr_read_b32 v43, a20
    v_accvgpr_read_b32 v45, a24
    v_accvgpr_read_b32 v47, a28
    v_accvgpr_read_b32 v48, a1
    v_accvgpr_read_b32 v50, a5
    v_accvgpr_read_b32 v52, a9
    v_accvgpr_read_b32 v54, a13
    v_accvgpr_read_b32 v49, a17
    v_accvgpr_read_b32 v51, a21
    v_accvgpr_read_b32 v53, a25
    v_accvgpr_read_b32 v55, a29
    v_pk_fma_f32 v[56:57], v[88:89], v[40:41], v[48:49] op_sel:[0,0,0] op_sel_hi:[0,1,1]
    v_pk_fma_f32 v[58:59], v[90:91], v[42:43], v[50:51] op_sel:[0,0,0] op_sel_hi:[0,1,1]
    v_pk_fma_f32 v[60:61], v[92:93], v[44:45], v[52:53] op_sel:[0,0,0] op_sel_hi:[0,1,1]
    v_pk_fma_f32 v[62:63], v[94:95], v[46:47], v[54:55] op_sel:[0,0,0] op_sel_hi:[0,1,1]
    v_pk_fma_f32 v[40:41], v[88:89], v[40:41], v[56:57] op_sel:[1,1,0] op_sel_hi:[1,0,1] neg_lo:[1,0,0]
    v_pk_fma_f32 v[42:43], v[90:91], v[42:43], v[58:59] op_sel:[1,1,0] op_sel_hi:[1,0,1] neg_lo:[1,0,0]
    v_pk_fma_f32 v[44:45], v[92:93], v[44:45], v[60:61] op_sel:[1,1,0] op_sel_hi:[1,0,1] neg_lo:[1,0,0]
    v_pk_fma_f32 v[46:47], v[94:95], v[46:47], v[62:63] op_sel:[1,1,0] op_sel_hi:[1,0,1] neg_lo:[1,0,0]
    v_accvgpr_read_b32 v64, a2
    v_accvgpr_read_b32 v66, a6
    v_accvgpr_read_b32 v68, a10
    v_accvgpr_read_b32 v70, a14
    v_accvgpr_read_b32 v65, a18
    v_accvgpr_read_b32 v67, a22
    v_accvgpr_read_b32 v69, a26
    v_accvgpr_read_b32 v71, a30
    v_pk_fma_f32 v[56:57], v[88:89], v[40:41], v[64:65] op_sel:[0,0,0] op_sel_hi:[0,1,1]
    v_pk_fma_f32 v[58:59], v[90:91], v[42:43], v[66:67] op_sel:[0,0,0] op_sel_hi:[0,1,1]
    v_pk_fma_f32 v[60:61], v[92:93], v[44:45], v[68:69] op_sel:[0,0,0] op_sel_hi:[0,1,1]
    v_pk_fma_f32 v[62:63], v[94:95], v[46:47], v[70:71] op_sel:[0,0,0] op_sel_hi:[0,1,1]
    v_pk_fma_f32 v[40:41], v[88:89], v[40:41], v[56:57] op_sel:[1,1,0] op_sel_hi:[1,0,1] neg_lo:[1,0,0]
    v_pk_fma_f32 v[42:43], v[90:91], v[42:43], v[58:59] op_sel:[1,1,0] op_sel_hi:[1,0,1] neg_lo:[1,0,0]
    v_pk_fma_f32 v[44:45], v[92:93], v[44:45], v[60:61] op_sel:[1,1,0] op_sel_hi:[1,0,1] neg_lo:[1,0,0]
    v_pk_fma_f32 v[46:47], v[94:95], v[46:47], v[62:63] op_sel:[1,1,0] op_sel_hi:[1,0,1] neg_lo:[1,0,0]
    v_accvgpr_read_b32 v48, a3
    v_accvgpr_read_b32 v50, a7
    v_accvgpr_read_b32 v52, a11
    v_accvgpr_read_b32 v54, a15
    v_accvgpr_read_b32 v49, a19
    v_accvgpr_read_b32 v51, a23
    v_accvgpr_read_b32 v53, a27
    v_accvgpr_read_b32 v55, a31
    v_pk_fma_f32 v[56:57], v[88:89], v[40:41], v[48:49] op_sel:[0,0,0] op_sel_hi:[0,1,1]
    v_pk_fma_f32 v[58:59], v[90:91], v[42:43], v[50:51] op_sel:[0,0,0] op_sel_hi:[0,1,1]
    v_pk_fma_f32 v[60:61], v[92:93], v[44:45], v[52:53] op_sel:[0,0,0] op_sel_hi:[0,1,1]
    v_pk_fma_f32 v[62:63], v[94:95], v[46:47], v[54:55] op_sel:[0,0,0] op_sel_hi:[0,1,1]
    v_pk_fma_f32 v[40:41], v[88:89], v[40:41], v[56:57] op_sel:[1,1,0] op_sel_hi:[1,0,1] neg_lo:[1,0,0]
    v_pk_fma_f32 v[42:43], v[90:91], v[42:43], v[58:59] op_sel:[1,1,0] op_sel_hi:[1,0,1] neg_lo:[1,0,0]
    v_pk_fma_f32 v[44:45], v[92:93], v[44:45], v[60:61] op_sel:[1,1,0] op_sel_hi:[1,0,1] neg_lo:[1,0,0]
    v_pk_fma_f32 v[46:47], v[94:95], v[46:47], v[62:63] op_sel:[1,1,0] op_sel_hi:[1,0,1] neg_lo:[1,0,0]
    v_accvgpr_read_b32 v64, a32
    v_accvgpr_read_b32 v66, a36
    v_accvgpr_read_b32 v68, a40
    v_accvgpr_read_b32 v70, a44
    v_accvgpr_read_b32 v65, a48
    v_accvgpr_read_b32 v67, a52
    v_accvgpr_read_b32 v69, a56
    v_accvgpr_read_b32 v71, a60
    v_pk_fma_f32 v[56:57], v[88:89], v[40:41], v[64:65] op_sel:[0,0,0] op_sel_hi:[0,1,1]
    v_pk_fma_f32 v[58:59], v[90:91], v[42:43], v[66:67] op_sel:[0,0,0] op_sel_hi:[0,1,1]
    v_pk_fma_f32 v[60:61], v[92:93], v[44:45], v[68:69] op_sel:[0,0,0] op_sel_hi:[0,1,1]
    v_pk_fma_f32 v[62:63], v[94:95], v[46:47], v[70:71] op_sel:[0,0,0] op_sel_hi:[0,1,1]
    v_pk_fma_f32 v[40:41], v[88:89], v[40:41], v[56:57] op_sel:[1,1,0] op_sel_hi:[1,0,1] neg_lo:[1,0,0]
    v_pk_fma_f32 v[42:43], v[90:91], v[42:43], v[58:59] op_sel:[1,1,0] op_sel_hi:[1,0,1] neg_lo:[1,0,0]
    v_pk_fma_f32 v[44:45], v[92:93], v[44:45], v[60:61] op_sel:[1,1,0] op_sel_hi:[1,0,1] neg_lo:[1,0,0]
    v_pk_fma_f32 v[46:47], v[94:95], v[46:47], v[62:63] op_sel:[1,1,0] op_sel_hi:[1,0,1] neg_lo:[1,0,0]
    v_accvgpr_read_b32 v48, a33
    v_accvgpr_read_b32 v50, a37
    v_accvgpr_read_b32 v52, a41
    v_accvgpr_read_b32 v54, a45
    v_accvgpr_read_b32 v49, a49
    v_accvgpr_read_b32 v51, a53
    v_accvgpr_read_b32 v53, a57
    v_accvgpr_read_b32 v55, a61
    v_pk_fma_f32 v[56:57], v[88:89], v[40:41], v[48:49] op_sel:[0,0,0] op_sel_hi:[0,1,1]
    v_pk_fma_f32 v[58:59], v[90:91], v[42:43], v[50:51] op_sel:[0,0,0] op_sel_hi:[0,1,1]
    v_pk_fma_f32 v[60:61], v[92:93], v[44:45], v[52:53] op_sel:[0,0,0] op_sel_hi:[0,1,1]
    v_pk_fma_f32 v[62:63], v[94:95], v[46:47], v[54:55] op_sel:[0,0,0] op_sel_hi:[0,1,1]
    v_pk_fma_f32 v[40:41], v[88:89], v[40:41], v[56:57] op_sel:[1,1,0] op_sel_hi:[1,0,1] neg_lo:[1,0,0]
    v_pk_fma_f32 v[42:43], v[90:91], v[42:43], v[58:59] op_sel:[1,1,0] op_sel_hi:[1,0,1] neg_lo:[1,0,0]
    v_pk_fma_f32 v[44:45], v[92:93], v[44:45], v[60:61] op_sel:[1,1,0] op_sel_hi:[1,0,1] neg_lo:[1,0,0]
    v_pk_fma_f32 v[46:47], v[94:95], v[46:47], v[62:63] op_sel:[1,1,0] op_sel_hi:[1,0,1] neg_lo:[1,0,0]
    v_accvgpr_read_b32 v64, a34
    v_accvgpr_read_b32 v66, a38
    v_accvgpr_read_b32 v68, a42
    v_accvgpr_read_b32 v70, a46
    v_accvgpr_read_b32 v65, a50
    v_accvgpr_read_b32 v67, a54
    v_accvgpr_read_b32 v69, a58
    v_accvgpr_read_b32 v71, a62
    v_pk_fma_f32 v[56:57], v[88:89], v[40:41], v[64:65] op_sel:[0,0,0] op_sel_hi:[0,1,1]
    v_pk_fma_f32 v[58:59], v[90:91], v[42:43], v[66:67] op_sel:[0,0,0] op_sel_hi:[0,1,1]
    v_pk_fma_f32 v[60:61], v[92:93], v[44:45], v[68:69] op_sel:[0,0,0] op_sel_hi:[0,1,1]
    v_pk_fma_f32 v[62:63], v[94:95], v[46:47], v[70:71] op_sel:[0,0,0] op_sel_hi:[0,1,1]
    v_pk_fma_f32 v[40:41], v[88:89], v[40:41], v[56:57] op_sel:[1,1,0] op_sel_hi:[1,0,1] neg_lo:[1,0,0]
    v_pk_fma_f32 v[42:43], v[90:91], v[42:43], v[58:59] op_sel:[1,1,0] op_sel_hi:[1,0,1] neg_lo:[1,0,0]
    v_pk_fma_f32 v[44:45], v[92:93], v[44:45], v[60:61] op_sel:[1,1,0] op_sel_hi:[1,0,1] neg_lo:[1,0,0]
    v_pk_fma_f32 v[46:47], v[94:95], v[46:47], v[62:63] op_sel:[1,1,0] op_sel_hi:[1,0,1] neg_lo:[1,0,0]
    v_accvgpr_read_b32 v48, a35
    v_accvgpr_read_b32 v50, a39
    v_accvgpr_read_b32 v52, a43
    v_accvgpr_read_b32 v54, a47
    v_accvgpr_read_b32 v49, a51
    v_accvgpr_read_b32 v51, a55
    v_accvgpr_read_b32 v53, a59
    v_accvgpr_read_b32 v55, a63
    v_pk_fma_f32 v[56:57], v[88:89], v[40:41], v[48:49] op_sel:[0,0,0] op_sel_hi:[0,1,1]
    v_pk_fma_f32 v[58:59], v[90:91], v[42:43], v[50:51] op_sel:[0,0,0] op_sel_hi:[0,1,1]
    v_pk_fma_f32 v[60:61], v[92:93], v[44:45], v[52:53] op_sel:[0,0,0] op_sel_hi:[0,1,1]
    v_pk_fma_f32 v[62:63], v[94:95], v[46:47], v[54:55] op_sel:[0,0,0] op_sel_hi:[0,1,1]
    v_pk_fma_f32 v[40:41], v[88:89], v[40:41], v[56:57] op_sel:[1,1,0] op_sel_hi:[1,0,1] neg_lo:[1,0,0]
    v_pk_fma_f32 v[42:43], v[90:91], v[42:43], v[58:59] op_sel:[1,1,0] op_sel_hi:[1,0,1] neg_lo:[1,0,0]
    v_pk_fma_f32 v[44:45], v[92:93], v[44:45], v[60:61] op_sel:[1,1,0] op_sel_hi:[1,0,1] neg_lo:[1,0,0]
    v_pk_fma_f32 v[46:47], v[94:95], v[46:47], v[62:63] op_sel:[1,1,0] op_sel_hi:[1,0,1] neg_lo:[1,0,0]
    v_accvgpr_read_b32 v64, a64
    v_accvgpr_read_b32 v66, a68
    v_accvgpr_read_b32 v68, a72
    v_accvgpr_read_b32 v70, a76
    v_accvgpr_read_b32 v65, a80
    v_accvgpr_read_b32 v67, a84
    v_accvgpr_read_b32 v69, a88
    v_accvgpr_read_b32 v71, a92
    v_pk_fma_f32 v[56:57], v[88:89], v[40:41], v[64:65] op_sel:[0,0,0] op_sel_hi:[0,1,1]
    v_pk_fma_f32 v[58:59], v[90:91], v[42:43], v[66:67] op_sel:[0,0,0] op_sel_hi:[0,1,1]
    v_pk_fma_f32 v[60:61], v[92:93], v[44:45], v[68:69] op_sel:[0,0,0] op_sel_hi:[0,1,1]
    v_pk_fma_f32 v[62:63], v[94:95], v[46:47], v[70:71] op_sel:[0,0,0] op_sel_hi:[0,1,1]
    v_pk_fma_f32 v[40:41], v[88:89], v[40:41], v[56:57] op_sel:[1,1,0] op_sel_hi:[1,0,1] neg_lo:[1,0,0]
    v_pk_fma_f32 v[42:43], v[90:91], v[42:43], v[58:59] op_sel:[1,1,0] op_sel_hi:[1,0,1] neg_lo:[1,0,0]
    v_pk_fma_f32 v[44:45], v[92:93], v[44:45], v[60:61] op_sel:[1,1,0] op_sel_hi:[1,0,1] neg_lo:[1,0,0]
    v_pk_fma_f32 v[46:47], v[94:95], v[46:47], v[62:63] op_sel:[1,1,0] op_sel_hi:[1,0,1] neg_lo:[1,0,0]
    v_accvgpr_read_b32 v48, a65
    v_accvgpr_read_b32 v50, a69
    v_accvgpr_read_b32 v52, a73
    v_accvgpr_read_b32 v54, a77
    v_accvgpr_read_b32 v49, a81
    v_accvgpr_read_b32 v51, a85
    v_accvgpr_read_b32 v53, a89
    v_accvgpr_read_b32 v55, a93
    v_pk_fma_f32 v[56:57], v[88:89], v[40:41], v[48:49] op_sel:[0,0,0] op_sel_hi:[0,1,1]
    v_pk_fma_f32 v[58:59], v[90:91], v[42:43], v[50:51] op_sel:[0,0,0] op_sel_hi:[0,1,1]
    v_pk_fma_f32 v[60:61], v[92:93], v[44:45], v[52:53] op_sel:[0,0,0] op_sel_hi:[0,1,1]
    v_pk_fma_f32 v[62:63], v[94:95], v[46:47], v[54:55] op_sel:[0,0,0] op_sel_hi:[0,1,1]
    v_pk_fma_f32 v[40:41], v[88:89], v[40:41], v[56:57] op_sel:[1,1,0] op_sel_hi:[1,0,1] neg_lo:[1,0,0]
    v_pk_fma_f32 v[42:43], v[90:91], v[42:43], v[58:59] op_sel:[1,1,0] op_sel_hi:[1,0,1] neg_lo:[1,0,0]
    v_pk_fma_f32 v[44:45], v[92:93], v[44:45], v[60:61] op_sel:[1,1,0] op_sel_hi:[1,0,1] neg_lo:[1,0,0]
    v_pk_fma_f32 v[46:47], v[94:95], v[46:47], v[62:63] op_sel:[1,1,0] op_sel_hi:[1,0,1] neg_lo:[1,0,0]
    v_accvgpr_read_b32 v64, a66
    v_accvgpr_read_b32 v66, a70
    v_accvgpr_read_b32 v68, a74
    v_accvgpr_read_b32 v70, a78
    v_accvgpr_read_b32 v65, a82
    v_accvgpr_read_b32 v67, a86
    v_accvgpr_read_b32 v69, a90
    v_accvgpr_read_b32 v71, a94
    v_pk_fma_f32 v[56:57], v[88:89], v[40:41], v[64:65] op_sel:[0,0,0] op_sel_hi:[0,1,1]
    v_pk_fma_f32 v[58:59], v[90:91], v[42:43], v[66:67] op_sel:[0,0,0] op_sel_hi:[0,1,1]
    v_pk_fma_f32 v[60:61], v[92:93], v[44:45], v[68:69] op_sel:[0,0,0] op_sel_hi:[0,1,1]
    v_pk_fma_f32 v[62:63], v[94:95], v[46:47], v[70:71] op_sel:[0,0,0] op_sel_hi:[0,1,1]
    v_pk_fma_f32 v[40:41], v[88:89], v[40:41], v[56:57] op_sel:[1,1,0] op_sel_hi:[1,0,1] neg_lo:[1,0,0]
    v_pk_fma_f32 v[42:43], v[90:91], v[42:43], v[58:59] op_sel:[1,1,0] op_sel_hi:[1,0,1] neg_lo:[1,0,0]
    v_pk_fma_f32 v[44:45], v[92:93], v[44:45], v[60:61] op_sel:[1,1,0] op_sel_hi:[1,0,1] neg_lo:[1,0,0]
    v_pk_fma_f32 v[46:47], v[94:95], v[46:47], v[62:63] op_sel:[1,1,0] op_sel_hi:[1,0,1] neg_lo:[1,0,0]
    v_accvgpr_read_b32 v48, a67
    v_accvgpr_read_b32 v50, a71
    v_accvgpr_read_b32 v52, a75
    v_accvgpr_read_b32 v54, a79
    v_accvgpr_read_b32 v49, a83
    v_accvgpr_read_b32 v51, a87
    v_accvgpr_read_b32 v53, a91
    v_accvgpr_read_b32 v55, a95
    v_pk_fma_f32 v[56:57], v[88:89], v[40:41], v[48:49] op_sel:[0,0,0] op_sel_hi:[0,1,1]
    v_pk_fma_f32 v[58:59], v[90:91], v[42:43], v[50:51] op_sel:[0,0,0] op_sel_hi:[0,1,1]
    v_pk_fma_f32 v[60:61], v[92:93], v[44:45], v[52:53] op_sel:[0,0,0] op_sel_hi:[0,1,1]
    v_pk_fma_f32 v[62:63], v[94:95], v[46:47], v[54:55] op_sel:[0,0,0] op_sel_hi:[0,1,1]
    v_pk_fma_f32 v[40:41], v[88:89], v[40:41], v[56:57] op_sel:[1,1,0] op_sel_hi:[1,0,1] neg_lo:[1,0,0]
    v_pk_fma_f32 v[42:43], v[90:91], v[42:43], v[58:59] op_sel:[1,1,0] op_sel_hi:[1,0,1] neg_lo:[1,0,0]
    v_pk_fma_f32 v[44:45], v[92:93], v[44:45], v[60:61] op_sel:[1,1,0] op_sel_hi:[1,0,1] neg_lo:[1,0,0]
    v_pk_fma_f32 v[46:47], v[94:95], v[46:47], v[62:63] op_sel:[1,1,0] op_sel_hi:[1,0,1] neg_lo:[1,0,0]
    v_accvgpr_read_b32 v64, a96
    v_accvgpr_read_b32 v66, a100
    v_accvgpr_read_b32 v68, a104
    v_accvgpr_read_b32 v70, a108
    v_accvgpr_read_b32 v65, a112
    v_accvgpr_read_b32 v67, a116
    v_accvgpr_read_b32 v69, a120
    v_accvgpr_read_b32 v71, a124
    v_pk_fma_f32 v[56:57], v[88:89], v[40:41], v[64:65] op_sel:[0,0,0] op_sel_hi:[0,1,1]
    v_pk_fma_f32 v[58:59], v[90:91], v[42:43], v[66:67] op_sel:[0,0,0] op_sel_hi:[0,1,1]
    v_pk_fma_f32 v[60:61], v[92:93], v[44:45], v[68:69] op_sel:[0,0,0] op_sel_hi:[0,1,1]
    v_pk_fma_f32 v[62:63], v[94:95], v[46:47], v[70:71] op_sel:[0,0,0] op_sel_hi:[0,1,1]
    v_pk_fma_f32 v[40:41], v[88:89], v[40:41], v[56:57] op_sel:[1,1,0] op_sel_hi:[1,0,1] neg_lo:[1,0,0]
    v_pk_fma_f32 v[42:43], v[90:91], v[42:43], v[58:59] op_sel:[1,1,0] op_sel_hi:[1,0,1] neg_lo:[1,0,0]
    v_pk_fma_f32 v[44:45], v[92:93], v[44:45], v[60:61] op_sel:[1,1,0] op_sel_hi:[1,0,1] neg_lo:[1,0,0]
    v_pk_fma_f32 v[46:47], v[94:95], v[46:47], v[62:63] op_sel:[1,1,0] op_sel_hi:[1,0,1] neg_lo:[1,0,0]
    v_accvgpr_read_b32 v48, a97
    v_accvgpr_read_b32 v50, a101
    v_accvgpr_read_b32 v52, a105
    v_accvgpr_read_b32 v54, a109
    v_accvgpr_read_b32 v49, a113
    v_accvgpr_read_b32 v51, a117
    v_accvgpr_read_b32 v53, a121
    v_accvgpr_read_b32 v55, a125
    v_pk_fma_f32 v[56:57], v[88:89], v[40:41], v[48:49] op_sel:[0,0,0] op_sel_hi:[0,1,1]
    v_pk_fma_f32 v[58:59], v[90:91], v[42:43], v[50:51] op_sel:[0,0,0] op_sel_hi:[0,1,1]
    v_pk_fma_f32 v[60:61], v[92:93], v[44:45], v[52:53] op_sel:[0,0,0] op_sel_hi:[0,1,1]
    v_pk_fma_f32 v[62:63], v[94:95], v[46:47], v[54:55] op_sel:[0,0,0] op_sel_hi:[0,1,1]
    v_pk_fma_f32 v[40:41], v[88:89], v[40:41], v[56:57] op_sel:[1,1,0] op_sel_hi:[1,0,1] neg_lo:[1,0,0]
    v_pk_fma_f32 v[42:43], v[90:91], v[42:43], v[58:59] op_sel:[1,1,0] op_sel_hi:[1,0,1] neg_lo:[1,0,0]
    v_pk_fma_f32 v[44:45], v[92:93], v[44:45], v[60:61] op_sel:[1,1,0] op_sel_hi:[1,0,1] neg_lo:[1,0,0]
    v_pk_fma_f32 v[46:47], v[94:95], v[46:47], v[62:63] op_sel:[1,1,0] op_sel_hi:[1,0,1] neg_lo:[1,0,0]
    v_accvgpr_read_b32 v64, a98
    v_accvgpr_read_b32 v66, a102
    v_accvgpr_read_b32 v68, a106
    v_accvgpr_read_b32 v70, a110
    v_accvgpr_read_b32 v65, a114
    v_accvgpr_read_b32 v67, a118
    v_accvgpr_read_b32 v69, a122
    v_accvgpr_read_b32 v71, a126
    v_pk_fma_f32 v[56:57], v[88:89], v[40:41], v[64:65] op_sel:[0,0,0] op_sel_hi:[0,1,1]
    v_pk_fma_f32 v[58:59], v[90:91], v[42:43], v[66:67] op_sel:[0,0,0] op_sel_hi:[0,1,1]
    v_pk_fma_f32 v[60:61], v[92:93], v[44:45], v[68:69] op_sel:[0,0,0] op_sel_hi:[0,1,1]
    v_pk_fma_f32 v[62:63], v[94:95], v[46:47], v[70:71] op_sel:[0,0,0] op_sel_hi:[0,1,1]
    v_pk_fma_f32 v[40:41], v[88:89], v[40:41], v[56:57] op_sel:[1,1,0] op_sel_hi:[1,0,1] neg_lo:[1,0,0]
    v_pk_fma_f32 v[42:43], v[90:91], v[42:43], v[58:59] op_sel:[1,1,0] op_sel_hi:[1,0,1] neg_lo:[1,0,0]
    v_pk_fma_f32 v[44:45], v[92:93], v[44:45], v[60:61] op_sel:[1,1,0] op_sel_hi:[1,0,1] neg_lo:[1,0,0]
    v_pk_fma_f32 v[46:47], v[94:95], v[46:47], v[62:63] op_sel:[1,1,0] op_sel_hi:[1,0,1] neg_lo:[1,0,0]
    v_accvgpr_read_b32 v48, a99
    v_accvgpr_read_b32 v50, a103
    v_accvgpr_read_b32 v52, a107
    v_accvgpr_read_b32 v54, a111
    v_accvgpr_read_b32 v49, a115
    v_accvgpr_read_b32 v51, a119
    v_accvgpr_read_b32 v53, a123
    v_accvgpr_read_b32 v55, a127
    v_pk_fma_f32 v[56:57], v[88:89], v[40:41], v[48:49] op_sel:[0,0,0] op_sel_hi:[0,1,1]
    v_pk_fma_f32 v[58:59], v[90:91], v[42:43], v[50:51] op_sel:[0,0,0] op_sel_hi:[0,1,1]
    v_pk_fma_f32 v[60:61], v[92:93], v[44:45], v[52:53] op_sel:[0,0,0] op_sel_hi:[0,1,1]
    v_pk_fma_f32 v[62:63], v[94:95], v[46:47], v[54:55] op_sel:[0,0,0] op_sel_hi:[0,1,1]
    v_pk_fma_f32 v[40:41], v[88:89], v[40:41], v[56:57] op_sel:[1,1,0] op_sel_hi:[1,0,1] neg_lo:[1,0,0]
    v_pk_fma_f32 v[42:43], v[90:91], v[42:43], v[58:59] op_sel:[1,1,0] op_sel_hi:[1,0,1] neg_lo:[1,0,0]
    v_pk_fma_f32 v[44:45], v[92:93], v[44:45], v[60:61] op_sel:[1,1,0] op_sel_hi:[1,0,1] neg_lo:[1,0,0]
    v_pk_fma_f32 v[46:47], v[94:95], v[46:47], v[62:63] op_sel:[1,1,0] op_sel_hi:[1,0,1] neg_lo:[1,0,0]
    v_accvgpr_read_b32 v64, a128
    v_accvgpr_read_b32 v66, a132
    v_accvgpr_read_b32 v68, a136
    v_accvgpr_read_b32 v70, a140
    v_accvgpr_read_b32 v65, a144
    v_accvgpr_read_b32 v67, a148
    v_accvgpr_read_b32 v69, a152
    v_accvgpr_read_b32 v71, a156
    v_pk_fma_f32 v[56:57], v[88:89], v[40:41], v[64:65] op_sel:[0,0,0] op_sel_hi:[0,1,1]
    v_pk_fma_f32 v[58:59], v[90:91], v[42:43], v[66:67] op_sel:[0,0,0] op_sel_hi:[0,1,1]
    v_pk_fma_f32 v[60:61], v[92:93], v[44:45], v[68:69] op_sel:[0,0,0] op_sel_hi:[0,1,1]
    v_pk_fma_f32 v[62:63], v[94:95], v[46:47], v[70:71] op_sel:[0,0,0] op_sel_hi:[0,1,1]
    v_pk_fma_f32 v[40:41], v[88:89], v[40:41], v[56:57] op_sel:[1,1,0] op_sel_hi:[1,0,1] neg_lo:[1,0,0]
    v_pk_fma_f32 v[42:43], v[90:91], v[42:43], v[58:59] op_sel:[1,1,0] op_sel_hi:[1,0,1] neg_lo:[1,0,0]
    v_pk_fma_f32 v[44:45], v[92:93], v[44:45], v[60:61] op_sel:[1,1,0] op_sel_hi:[1,0,1] neg_lo:[1,0,0]
    v_pk_fma_f32 v[46:47], v[94:95], v[46:47], v[62:63] op_sel:[1,1,0] op_sel_hi:[1,0,1] neg_lo:[1,0,0]
    v_accvgpr_read_b32 v48, a129
    v_accvgpr_read_b32 v50, a133
    v_accvgpr_read_b32 v52, a137
    v_accvgpr_read_b32 v54, a141
    v_accvgpr_read_b32 v49, a145
    v_accvgpr_read_b32 v51, a149
    v_accvgpr_read_b32 v53, a153
    v_accvgpr_read_b32 v55, a157
    v_pk_fma_f32 v[56:57], v[88:89], v[40:41], v[48:49] op_sel:[0,0,0] op_sel_hi:[0,1,1]
    v_pk_fma_f32 v[58:59], v[90:91], v[42:43], v[50:51] op_sel:[0,0,0] op_sel_hi:[0,1,1]
    v_pk_fma_f32 v[60:61], v[92:93], v[44:45], v[52:53] op_sel:[0,0,0] op_sel_hi:[0,1,1]
    v_pk_fma_f32 v[62:63], v[94:95], v[46:47], v[54:55] op_sel:[0,0,0] op_sel_hi:[0,1,1]
    v_pk_fma_f32 v[40:41], v[88:89], v[40:41], v[56:57] op_sel:[1,1,0] op_sel_hi:[1,0,1] neg_lo:[1,0,0]
    v_pk_fma_f32 v[42:43], v[90:91], v[42:43], v[58:59] op_sel:[1,1,0] op_sel_hi:[1,0,1] neg_lo:[1,0,0]
    v_pk_fma_f32 v[44:45], v[92:93], v[44:45], v[60:61] op_sel:[1,1,0] op_sel_hi:[1,0,1] neg_lo:[1,0,0]
    v_pk_fma_f32 v[46:47], v[94:95], v[46:47], v[62:63] op_sel:[1,1,0] op_sel_hi:[1,0,1] neg_lo:[1,0,0]
    v_accvgpr_read_b32 v64, a130
    v_accvgpr_read_b32 v66, a134
    v_accvgpr_read_b32 v68, a138
    v_accvgpr_read_b32 v70, a142
    v_accvgpr_read_b32 v65, a146
    v_accvgpr_read_b32 v67, a150
    v_accvgpr_read_b32 v69, a154
    v_accvgpr_read_b32 v71, a158
    v_pk_fma_f32 v[56:57], v[88:89], v[40:41], v[64:65] op_sel:[0,0,0] op_sel_hi:[0,1,1]
    v_pk_fma_f32 v[58:59], v[90:91], v[42:43], v[66:67] op_sel:[0,0,0] op_sel_hi:[0,1,1]
    v_pk_fma_f32 v[60:61], v[92:93], v[44:45], v[68:69] op_sel:[0,0,0] op_sel_hi:[0,1,1]
    v_pk_fma_f32 v[62:63], v[94:95], v[46:47], v[70:71] op_sel:[0,0,0] op_sel_hi:[0,1,1]
    v_pk_fma_f32 v[40:41], v[88:89], v[40:41], v[56:57] op_sel:[1,1,0] op_sel_hi:[1,0,1] neg_lo:[1,0,0]
    v_pk_fma_f32 v[42:43], v[90:91], v[42:43], v[58:59] op_sel:[1,1,0] op_sel_hi:[1,0,1] neg_lo:[1,0,0]
    v_pk_fma_f32 v[44:45], v[92:93], v[44:45], v[60:61] op_sel:[1,1,0] op_sel_hi:[1,0,1] neg_lo:[1,0,0]
    v_pk_fma_f32 v[46:47], v[94:95], v[46:47], v[62:63] op_sel:[1,1,0] op_sel_hi:[1,0,1] neg_lo:[1,0,0]
    v_accvgpr_read_b32 v48, a131
    v_accvgpr_read_b32 v50, a135
    v_accvgpr_read_b32 v52, a139
    v_accvgpr_read_b32 v54, a143
    v_accvgpr_read_b32 v49, a147
    v_accvgpr_read_b32 v51, a151
    v_accvgpr_read_b32 v53, a155
    v_accvgpr_read_b32 v55, a159
    v_pk_fma_f32 v[56:57], v[88:89], v[40:41], v[48:49] op_sel:[0,0,0] op_sel_hi:[0,1,1]
    v_pk_fma_f32 v[58:59], v[90:91], v[42:43], v[50:51] op_sel:[0,0,0] op_sel_hi:[0,1,1]
    v_pk_fma_f32 v[60:61], v[92:93], v[44:45], v[52:53] op_sel:[0,0,0] op_sel_hi:[0,1,1]
    v_pk_fma_f32 v[62:63], v[94:95], v[46:47], v[54:55] op_sel:[0,0,0] op_sel_hi:[0,1,1]
    v_pk_fma_f32 v[40:41], v[88:89], v[40:41], v[56:57] op_sel:[1,1,0] op_sel_hi:[1,0,1] neg_lo:[1,0,0]
    v_pk_fma_f32 v[42:43], v[90:91], v[42:43], v[58:59] op_sel:[1,1,0] op_sel_hi:[1,0,1] neg_lo:[1,0,0]
    v_pk_fma_f32 v[44:45], v[92:93], v[44:45], v[60:61] op_sel:[1,1,0] op_sel_hi:[1,0,1] neg_lo:[1,0,0]
    v_pk_fma_f32 v[46:47], v[94:95], v[46:47], v[62:63] op_sel:[1,1,0] op_sel_hi:[1,0,1] neg_lo:[1,0,0]
    v_accvgpr_read_b32 v64, a160
    v_accvgpr_read_b32 v66, a164
    v_accvgpr_read_b32 v68, a168
    v_accvgpr_read_b32 v70, a172
    v_accvgpr_read_b32 v65, a176
    v_accvgpr_read_b32 v67, a180
    v_accvgpr_read_b32 v69, a184
    v_accvgpr_read_b32 v71, a188
    v_pk_fma_f32 v[56:57], v[88:89], v[40:41], v[64:65] op_sel:[0,0,0] op_sel_hi:[0,1,1]
    v_pk_fma_f32 v[58:59], v[90:91], v[42:43], v[66:67] op_sel:[0,0,0] op_sel_hi:[0,1,1]
    v_pk_fma_f32 v[60:61], v[92:93], v[44:45], v[68:69] op_sel:[0,0,0] op_sel_hi:[0,1,1]
    v_pk_fma_f32 v[62:63], v[94:95], v[46:47], v[70:71] op_sel:[0,0,0] op_sel_hi:[0,1,1]
    v_pk_fma_f32 v[40:41], v[88:89], v[40:41], v[56:57] op_sel:[1,1,0] op_sel_hi:[1,0,1] neg_lo:[1,0,0]
    v_pk_fma_f32 v[42:43], v[90:91], v[42:43], v[58:59] op_sel:[1,1,0] op_sel_hi:[1,0,1] neg_lo:[1,0,0]
    v_pk_fma_f32 v[44:45], v[92:93], v[44:45], v[60:61] op_sel:[1,1,0] op_sel_hi:[1,0,1] neg_lo:[1,0,0]
    v_pk_fma_f32 v[46:47], v[94:95], v[46:47], v[62:63] op_sel:[1,1,0] op_sel_hi:[1,0,1] neg_lo:[1,0,0]
    v_accvgpr_read_b32 v48, a161
    v_accvgpr_read_b32 v50, a165
    v_accvgpr_read_b32 v52, a169
    v_accvgpr_read_b32 v54, a173
    v_accvgpr_read_b32 v49, a177
    v_accvgpr_read_b32 v51, a181
    v_accvgpr_read_b32 v53, a185
    v_accvgpr_read_b32 v55, a189
    v_pk_fma_f32 v[56:57], v[88:89], v[40:41], v[48:49] op_sel:[0,0,0] op_sel_hi:[0,1,1]
    v_pk_fma_f32 v[58:59], v[90:91], v[42:43], v[50:51] op_sel:[0,0,0] op_sel_hi:[0,1,1]
    v_pk_fma_f32 v[60:61], v[92:93], v[44:45], v[52:53] op_sel:[0,0,0] op_sel_hi:[0,1,1]
    v_pk_fma_f32 v[62:63], v[94:95], v[46:47], v[54:55] op_sel:[0,0,0] op_sel_hi:[0,1,1]
    v_pk_fma_f32 v[40:41], v[88:89], v[40:41], v[56:57] op_sel:[1,1,0] op_sel_hi:[1,0,1] neg_lo:[1,0,0]
    v_pk_fma_f32 v[42:43], v[90:91], v[42:43], v[58:59] op_sel:[1,1,0] op_sel_hi:[1,0,1] neg_lo:[1,0,0]
    v_pk_fma_f32 v[44:45], v[92:93], v[44:45], v[60:61] op_sel:[1,1,0] op_sel_hi:[1,0,1] neg_lo:[1,0,0]
    v_pk_fma_f32 v[46:47], v[94:95], v[46:47], v[62:63] op_sel:[1,1,0] op_sel_hi:[1,0,1] neg_lo:[1,0,0]
    v_accvgpr_read_b32 v64, a162
    v_accvgpr_read_b32 v66, a166
    v_accvgpr_read_b32 v68, a170
    v_accvgpr_read_b32 v70, a174
    v_accvgpr_read_b32 v65, a178
    v_accvgpr_read_b32 v67, a182
    v_accvgpr_read_b32 v69, a186
    v_accvgpr_read_b32 v71, a190
    v_pk_fma_f32 v[56:57], v[88:89], v[40:41], v[64:65] op_sel:[0,0,0] op_sel_hi:[0,1,1]
    v_pk_fma_f32 v[58:59], v[90:91], v[42:43], v[66:67] op_sel:[0,0,0] op_sel_hi:[0,1,1]
    v_pk_fma_f32 v[60:61], v[92:93], v[44:45], v[68:69] op_sel:[0,0,0] op_sel_hi:[0,1,1]
    v_pk_fma_f32 v[62:63], v[94:95], v[46:47], v[70:71] op_sel:[0,0,0] op_sel_hi:[0,1,1]
    v_pk_fma_f32 v[40:41], v[88:89], v[40:41], v[56:57] op_sel:[1,1,0] op_sel_hi:[1,0,1] neg_lo:[1,0,0]
    v_pk_fma_f32 v[42:43], v[90:91], v[42:43], v[58:59] op_sel:[1,1,0] op_sel_hi:[1,0,1] neg_lo:[1,0,0]
    v_pk_fma_f32 v[44:45], v[92:93], v[44:45], v[60:61] op_sel:[1,1,0] op_sel_hi:[1,0,1] neg_lo:[1,0,0]
    v_pk_fma_f32 v[46:47], v[94:95], v[46:47], v[62:63] op_sel:[1,1,0] op_sel_hi:[1,0,1] neg_lo:[1,0,0]
    v_accvgpr_read_b32 v48, a163
    v_accvgpr_read_b32 v50, a167
    v_accvgpr_read_b32 v52, a171
    v_accvgpr_read_b32 v54, a175
    v_accvgpr_read_b32 v49, a179
    v_accvgpr_read_b32 v51, a183
    v_accvgpr_read_b32 v53, a187
    v_accvgpr_read_b32 v55, a191
    v_pk_fma_f32 v[56:57], v[88:89], v[40:41], v[48:49] op_sel:[0,0,0] op_sel_hi:[0,1,1]
    v_pk_fma_f32 v[58:59], v[90:91], v[42:43], v[50:51] op_sel:[0,0,0] op_sel_hi:[0,1,1]
    v_pk_fma_f32 v[60:61], v[92:93], v[44:45], v[52:53] op_sel:[0,0,0] op_sel_hi:[0,1,1]
    v_pk_fma_f32 v[62:63], v[94:95], v[46:47], v[54:55] op_sel:[0,0,0] op_sel_hi:[0,1,1]
    v_pk_fma_f32 v[40:41], v[88:89], v[40:41], v[56:57] op_sel:[1,1,0] op_sel_hi:[1,0,1] neg_lo:[1,0,0]
    v_pk_fma_f32 v[42:43], v[90:91], v[42:43], v[58:59] op_sel:[1,1,0] op_sel_hi:[1,0,1] neg_lo:[1,0,0]
    v_pk_fma_f32 v[44:45], v[92:93], v[44:45], v[60:61] op_sel:[1,1,0] op_sel_hi:[1,0,1] neg_lo:[1,0,0]
    v_pk_fma_f32 v[46:47], v[94:95], v[46:47], v[62:63] op_sel:[1,1,0] op_sel_hi:[1,0,1] neg_lo:[1,0,0]
    v_accvgpr_read_b32 v64, a192
    v_accvgpr_read_b32 v66, a196
    v_accvgpr_read_b32 v68, a200
    v_accvgpr_read_b32 v70, a204
    v_accvgpr_read_b32 v65, a208
    v_accvgpr_read_b32 v67, a212
    v_accvgpr_read_b32 v69, a216
    v_accvgpr_read_b32 v71, a220
    v_pk_fma_f32 v[56:57], v[88:89], v[40:41], v[64:65] op_sel:[0,0,0] op_sel_hi:[0,1,1]
    v_pk_fma_f32 v[58:59], v[90:91], v[42:43], v[66:67] op_sel:[0,0,0] op_sel_hi:[0,1,1]
    v_pk_fma_f32 v[60:61], v[92:93], v[44:45], v[68:69] op_sel:[0,0,0] op_sel_hi:[0,1,1]
    v_pk_fma_f32 v[62:63], v[94:95], v[46:47], v[70:71] op_sel:[0,0,0] op_sel_hi:[0,1,1]
    v_pk_fma_f32 v[40:41], v[88:89], v[40:41], v[56:57] op_sel:[1,1,0] op_sel_hi:[1,0,1] neg_lo:[1,0,0]
    v_pk_fma_f32 v[42:43], v[90:91], v[42:43], v[58:59] op_sel:[1,1,0] op_sel_hi:[1,0,1] neg_lo:[1,0,0]
    v_pk_fma_f32 v[44:45], v[92:93], v[44:45], v[60:61] op_sel:[1,1,0] op_sel_hi:[1,0,1] neg_lo:[1,0,0]
    v_pk_fma_f32 v[46:47], v[94:95], v[46:47], v[62:63] op_sel:[1,1,0] op_sel_hi:[1,0,1] neg_lo:[1,0,0]
    v_accvgpr_read_b32 v48, a193
    v_accvgpr_read_b32 v50, a197
    v_accvgpr_read_b32 v52, a201
    v_accvgpr_read_b32 v54, a205
    v_accvgpr_read_b32 v49, a209
    v_accvgpr_read_b32 v51, a213
    v_accvgpr_read_b32 v53, a217
    v_accvgpr_read_b32 v55, a221
    v_pk_fma_f32 v[56:57], v[88:89], v[40:41], v[48:49] op_sel:[0,0,0] op_sel_hi:[0,1,1]
    v_pk_fma_f32 v[58:59], v[90:91], v[42:43], v[50:51] op_sel:[0,0,0] op_sel_hi:[0,1,1]
    v_pk_fma_f32 v[60:61], v[92:93], v[44:45], v[52:53] op_sel:[0,0,0] op_sel_hi:[0,1,1]
    v_pk_fma_f32 v[62:63], v[94:95], v[46:47], v[54:55] op_sel:[0,0,0] op_sel_hi:[0,1,1]
    v_pk_fma_f32 v[40:41], v[88:89], v[40:41], v[56:57] op_sel:[1,1,0] op_sel_hi:[1,0,1] neg_lo:[1,0,0]
    v_pk_fma_f32 v[42:43], v[90:91], v[42:43], v[58:59] op_sel:[1,1,0] op_sel_hi:[1,0,1] neg_lo:[1,0,0]
    v_pk_fma_f32 v[44:45], v[92:93], v[44:45], v[60:61] op_sel:[1,1,0] op_sel_hi:[1,0,1] neg_lo:[1,0,0]
    v_pk_fma_f32 v[46:47], v[94:95], v[46:47], v[62:63] op_sel:[1,1,0] op_sel_hi:[1,0,1] neg_lo:[1,0,0]
    v_accvgpr_read_b32 v64, a194
    v_accvgpr_read_b32 v66, a198
    v_accvgpr_read_b32 v68, a202
    v_accvgpr_read_b32 v70, a206
    v_accvgpr_read_b32 v65, a210
    v_accvgpr_read_b32 v67, a214
    v_accvgpr_read_b32 v69, a218
    v_accvgpr_read_b32 v71, a222
    v_pk_fma_f32 v[56:57], v[88:89], v[40:41], v[64:65] op_sel:[0,0,0] op_sel_hi:[0,1,1]
    v_pk_fma_f32 v[58:59], v[90:91], v[42:43], v[66:67] op_sel:[0,0,0] op_sel_hi:[0,1,1]
    v_pk_fma_f32 v[60:61], v[92:93], v[44:45], v[68:69] op_sel:[0,0,0] op_sel_hi:[0,1,1]
    v_pk_fma_f32 v[62:63], v[94:95], v[46:47], v[70:71] op_sel:[0,0,0] op_sel_hi:[0,1,1]
    v_pk_fma_f32 v[40:41], v[88:89], v[40:41], v[56:57] op_sel:[1,1,0] op_sel_hi:[1,0,1] neg_lo:[1,0,0]
    v_pk_fma_f32 v[42:43], v[90:91], v[42:43], v[58:59] op_sel:[1,1,0] op_sel_hi:[1,0,1] neg_lo:[1,0,0]
    v_pk_fma_f32 v[44:45], v[92:93], v[44:45], v[60:61] op_sel:[1,1,0] op_sel_hi:[1,0,1] neg_lo:[1,0,0]
    v_pk_fma_f32 v[46:47], v[94:95], v[46:47], v[62:63] op_sel:[1,1,0] op_sel_hi:[1,0,1] neg_lo:[1,0,0]
    v_accvgpr_read_b32 v48, a195
    v_accvgpr_read_b32 v50, a199
    v_accvgpr_read_b32 v52, a203
    v_accvgpr_read_b32 v54, a207
    v_accvgpr_read_b32 v49, a211
    v_accvgpr_read_b32 v51, a215
    v_accvgpr_read_b32 v53, a219
    v_accvgpr_read_b32 v55, a223
    v_pk_fma_f32 v[56:57], v[88:89], v[40:41], v[48:49] op_sel:[0,0,0] op_sel_hi:[0,1,1]
    v_pk_fma_f32 v[58:59], v[90:91], v[42:43], v[50:51] op_sel:[0,0,0] op_sel_hi:[0,1,1]
    v_pk_fma_f32 v[60:61], v[92:93], v[44:45], v[52:53] op_sel:[0,0,0] op_sel_hi:[0,1,1]
    v_pk_fma_f32 v[62:63], v[94:95], v[46:47], v[54:55] op_sel:[0,0,0] op_sel_hi:[0,1,1]
    v_pk_fma_f32 v[40:41], v[88:89], v[40:41], v[56:57] op_sel:[1,1,0] op_sel_hi:[1,0,1] neg_lo:[1,0,0]
    v_pk_fma_f32 v[42:43], v[90:91], v[42:43], v[58:59] op_sel:[1,1,0] op_sel_hi:[1,0,1] neg_lo:[1,0,0]
    v_pk_fma_f32 v[44:45], v[92:93], v[44:45], v[60:61] op_sel:[1,1,0] op_sel_hi:[1,0,1] neg_lo:[1,0,0]
    v_pk_fma_f32 v[46:47], v[94:95], v[46:47], v[62:63] op_sel:[1,1,0] op_sel_hi:[1,0,1] neg_lo:[1,0,0]
    v_accvgpr_read_b32 v64, a224
    v_accvgpr_read_b32 v66, a228
    v_accvgpr_read_b32 v68, a232
    v_accvgpr_read_b32 v70, a236
    v_accvgpr_read_b32 v65, a240
    v_accvgpr_read_b32 v67, a244
    v_accvgpr_read_b32 v69, a248
    v_accvgpr_read_b32 v71, a252
    v_pk_fma_f32 v[56:57], v[88:89], v[40:41], v[64:65] op_sel:[0,0,0] op_sel_hi:[0,1,1]
    v_pk_fma_f32 v[58:59], v[90:91], v[42:43], v[66:67] op_sel:[0,0,0] op_sel_hi:[0,1,1]
    v_pk_fma_f32 v[60:61], v[92:93], v[44:45], v[68:69] op_sel:[0,0,0] op_sel_hi:[0,1,1]
    v_pk_fma_f32 v[62:63], v[94:95], v[46:47], v[70:71] op_sel:[0,0,0] op_sel_hi:[0,1,1]
    v_pk_fma_f32 v[40:41], v[88:89], v[40:41], v[56:57] op_sel:[1,1,0] op_sel_hi:[1,0,1] neg_lo:[1,0,0]
    v_pk_fma_f32 v[42:43], v[90:91], v[42:43], v[58:59] op_sel:[1,1,0] op_sel_hi:[1,0,1] neg_lo:[1,0,0]
    v_pk_fma_f32 v[44:45], v[92:93], v[44:45], v[60:61] op_sel:[1,1,0] op_sel_hi:[1,0,1] neg_lo:[1,0,0]
    v_pk_fma_f32 v[46:47], v[94:95], v[46:47], v[62:63] op_sel:[1,1,0] op_sel_hi:[1,0,1] neg_lo:[1,0,0]
    v_accvgpr_read_b32 v48, a225
    v_accvgpr_read_b32 v50, a229
    v_accvgpr_read_b32 v52, a233
    v_accvgpr_read_b32 v54, a237
    v_accvgpr_read_b32 v49, a241
    v_accvgpr_read_b32 v51, a245
    v_accvgpr_read_b32 v53, a249
    v_accvgpr_read_b32 v55, a253
    v_pk_fma_f32 v[56:57], v[88:89], v[40:41], v[48:49] op_sel:[0,0,0] op_sel_hi:[0,1,1]
    v_pk_fma_f32 v[58:59], v[90:91], v[42:43], v[50:51] op_sel:[0,0,0] op_sel_hi:[0,1,1]
    v_pk_fma_f32 v[60:61], v[92:93], v[44:45], v[52:53] op_sel:[0,0,0] op_sel_hi:[0,1,1]
    v_pk_fma_f32 v[62:63], v[94:95], v[46:47], v[54:55] op_sel:[0,0,0] op_sel_hi:[0,1,1]
    v_pk_fma_f32 v[40:41], v[88:89], v[40:41], v[56:57] op_sel:[1,1,0] op_sel_hi:[1,0,1] neg_lo:[1,0,0]
    v_pk_fma_f32 v[42:43], v[90:91], v[42:43], v[58:59] op_sel:[1,1,0] op_sel_hi:[1,0,1] neg_lo:[1,0,0]
    v_pk_fma_f32 v[44:45], v[92:93], v[44:45], v[60:61] op_sel:[1,1,0] op_sel_hi:[1,0,1] neg_lo:[1,0,0]
    v_pk_fma_f32 v[46:47], v[94:95], v[46:47], v[62:63] op_sel:[1,1,0] op_sel_hi:[1,0,1] neg_lo:[1,0,0]
    v_accvgpr_read_b32 v64, a226
    v_accvgpr_read_b32 v66, a230
    v_accvgpr_read_b32 v68, a234
    v_accvgpr_read_b32 v70, a238
    v_accvgpr_read_b32 v65, a242
    v_accvgpr_read_b32 v67, a246
    v_accvgpr_read_b32 v69, a250
    v_accvgpr_read_b32 v71, a254
    v_pk_fma_f32 v[56:57], v[88:89], v[40:41], v[64:65] op_sel:[0,0,0] op_sel_hi:[0,1,1]
    v_pk_fma_f32 v[58:59], v[90:91], v[42:43], v[66:67] op_sel:[0,0,0] op_sel_hi:[0,1,1]
    v_pk_fma_f32 v[60:61], v[92:93], v[44:45], v[68:69] op_sel:[0,0,0] op_sel_hi:[0,1,1]
    v_pk_fma_f32 v[62:63], v[94:95], v[46:47], v[70:71] op_sel:[0,0,0] op_sel_hi:[0,1,1]
    v_pk_fma_f32 v[40:41], v[88:89], v[40:41], v[56:57] op_sel:[1,1,0] op_sel_hi:[1,0,1] neg_lo:[1,0,0]
    v_pk_fma_f32 v[42:43], v[90:91], v[42:43], v[58:59] op_sel:[1,1,0] op_sel_hi:[1,0,1] neg_lo:[1,0,0]
    v_pk_fma_f32 v[44:45], v[92:93], v[44:45], v[60:61] op_sel:[1,1,0] op_sel_hi:[1,0,1] neg_lo:[1,0,0]
    v_pk_fma_f32 v[46:47], v[94:95], v[46:47], v[62:63] op_sel:[1,1,0] op_sel_hi:[1,0,1] neg_lo:[1,0,0]
    v_accvgpr_read_b32 v48, a227
    v_accvgpr_read_b32 v50, a231
    v_accvgpr_read_b32 v52, a235
    v_accvgpr_read_b32 v54, a239
    v_accvgpr_read_b32 v49, a243
    v_accvgpr_read_b32 v51, a247
    v_accvgpr_read_b32 v53, a251
    v_accvgpr_read_b32 v55, a255
    v_pk_fma_f32 v[56:57], v[88:89], v[40:41], v[48:49] op_sel:[0,0,0] op_sel_hi:[0,1,1]
    v_pk_fma_f32 v[58:59], v[90:91], v[42:43], v[50:51] op_sel:[0,0,0] op_sel_hi:[0,1,1]
    v_pk_fma_f32 v[60:61], v[92:93], v[44:45], v[52:53] op_sel:[0,0,0] op_sel_hi:[0,1,1]
    v_pk_fma_f32 v[62:63], v[94:95], v[46:47], v[54:55] op_sel:[0,0,0] op_sel_hi:[0,1,1]
    v_pk_fma_f32 v[40:41], v[88:89], v[40:41], v[56:57] op_sel:[1,1,0] op_sel_hi:[1,0,1] neg_lo:[1,0,0]
    v_pk_fma_f32 v[42:43], v[90:91], v[42:43], v[58:59] op_sel:[1,1,0] op_sel_hi:[1,0,1] neg_lo:[1,0,0]
    v_pk_fma_f32 v[44:45], v[92:93], v[44:45], v[60:61] op_sel:[1,1,0] op_sel_hi:[1,0,1] neg_lo:[1,0,0]
    v_pk_fma_f32 v[46:47], v[94:95], v[46:47], v[62:63] op_sel:[1,1,0] op_sel_hi:[1,0,1] neg_lo:[1,0,0]
    v_mov_b32 v64, v40
    v_mov_b32 v72, v40
    v_mov_b32 v65, v41
    v_mov_b32 v73, v41
    v_mov_b32 v66, v42
    v_mov_b32 v74, v42
    v_mov_b32 v67, v43
    v_mov_b32 v75, v43
    v_mov_b32 v68, v44
    v_mov_b32 v76, v44
    v_mov_b32 v69, v45
    v_mov_b32 v77, v45
    v_mov_b32 v70, v46
    v_mov_b32 v78, v46
    v_mov_b32 v71, v47
    v_mov_b32 v79, v47
    s_nop 1
    v_permlane16_swap_b32 v64, v72
    v_permlane16_swap_b32 v65, v73
    v_permlane16_swap_b32 v66, v74
    v_permlane16_swap_b32 v67, v75
    v_permlane16_swap_b32 v68, v76
    v_permlane16_swap_b32 v69, v77
    v_permlane16_swap_b32 v70, v78
    v_permlane16_swap_b32 v71, v79
    v_pk_fma_f32 v[56:57], v[104:105], v[64:65], v[72:73] op_sel:[0,0,0] op_sel_hi:[0,1,1]
    v_pk_fma_f32 v[58:59], v[106:107], v[66:67], v[74:75] op_sel:[0,0,0] op_sel_hi:[0,1,1]
    v_pk_fma_f32 v[60:61], v[108:109], v[68:69], v[76:77] op_sel:[0,0,0] op_sel_hi:[0,1,1]
    v_pk_fma_f32 v[62:63], v[110:111], v[70:71], v[78:79] op_sel:[0,0,0] op_sel_hi:[0,1,1]
    v_pk_fma_f32 v[80:81], v[104:105], v[64:65], v[56:57] op_sel:[1,1,0] op_sel_hi:[1,0,1] neg_lo:[1,0,0]
    v_pk_fma_f32 v[82:83], v[106:107], v[66:67], v[58:59] op_sel:[1,1,0] op_sel_hi:[1,0,1] neg_lo:[1,0,0]
    v_pk_fma_f32 v[84:85], v[108:109], v[68:69], v[60:61] op_sel:[1,1,0] op_sel_hi:[1,0,1] neg_lo:[1,0,0]
    v_pk_fma_f32 v[86:87], v[110:111], v[70:71], v[62:63] op_sel:[1,1,0] op_sel_hi:[1,0,1] neg_lo:[1,0,0]
    v_mov_b32 v24, v80
    v_mov_b32 v25, v81
    v_mov_b32 v26, v82
    v_mov_b32 v27, v83
    v_mov_b32 v28, v84
    v_mov_b32 v29, v85
    v_mov_b32 v30, v86
    v_mov_b32 v31, v87
    s_nop 1
    v_permlane32_swap_b32 v80, v24
    v_permlane32_swap_b32 v81, v25
    v_permlane32_swap_b32 v82, v26
    v_permlane32_swap_b32 v83, v27
    v_permlane32_swap_b32 v84, v28
    v_permlane32_swap_b32 v85, v29
    v_permlane32_swap_b32 v86, v30
    v_permlane32_swap_b32 v87, v31
    v_pk_fma_f32 v[56:57], v[112:113], v[80:81], v[24:25] op_sel:[0,0,0] op_sel_hi:[0,1,1]
    v_pk_fma_f32 v[58:59], v[114:115], v[82:83], v[26:27] op_sel:[0,0,0] op_sel_hi:[0,1,1]
    v_pk_fma_f32 v[60:61], v[116:117], v[84:85], v[28:29] op_sel:[0,0,0] op_sel_hi:[0,1,1]
    v_pk_fma_f32 v[62:63], v[118:119], v[86:87], v[30:31] op_sel:[0,0,0] op_sel_hi:[0,1,1]
    v_pk_fma_f32 v[40:41], v[112:113], v[80:81], v[56:57] op_sel:[1,1,0] op_sel_hi:[1,0,1] neg_lo:[1,0,0]
    v_pk_fma_f32 v[42:43], v[114:115], v[82:83], v[58:59] op_sel:[1,1,0] op_sel_hi:[1,0,1] neg_lo:[1,0,0]
    v_pk_fma_f32 v[44:45], v[116:117], v[84:85], v[60:61] op_sel:[1,1,0] op_sel_hi:[1,0,1] neg_lo:[1,0,0]
    v_pk_fma_f32 v[46:47], v[118:119], v[86:87], v[62:63] op_sel:[1,1,0] op_sel_hi:[1,0,1] neg_lo:[1,0,0]
    s_mov_b32 exec_lo, 0xffffffff
    s_mov_b32 exec_hi, 0xffffffff
    v_mov_b32 v122, v40
    v_mov_b32 v123, v41
    s_mov_b32 exec_lo, 0xffff0000
    s_mov_b32 exec_hi, 0xffffffff
    v_mov_b32 v122, v42
    v_mov_b32 v123, v43
    s_mov_b32 exec_lo, 0x0
    s_mov_b32 exec_hi, 0xffffffff
    v_mov_b32 v122, v44
    v_mov_b32 v123, v45
    s_mov_b32 exec_lo, 0x0
    s_mov_b32 exec_hi, 0xffff0000
    v_mov_b32 v122, v46
    v_mov_b32 v123, v47
    s_mov_b64 exec, -1
    s_and_b32 s53, s58, 1
    s_lshl1_add_u32 s53, s85, s53
    s_lshl_b32 s53, s53, 13
    s_lshr_b32 s29, s58, 1
    s_lshl1_add_u32 s29, s82, s29
    s_lshl_b32 s29, s29, 9
    s_add_u32 s53, s53, s29
    v_lshrrev_b32 v126, 1, v1
    v_add_u32 v126, s53, v126
    s_add_u32 s60, s100, 0xd100000
    s_addc_u32 s61, s101, 0
    s_and_b32 s61, s61, 0xffff
    s_mov_b32 s62, 0x20000
    s_mov_b32 s63, 0x00020000
    buffer_store_dwordx2 v[122:123], v126, s[60:63], 0 offen
    v_subrev_u32 v160, 8192, v126
    v_subrev_u32 v161, 16384, v126
    v_subrev_u32 v162, 24576, v126
    v_subrev_u32 v163, 32768, v126
    v_subrev_u32 v164, 40960, v126
    v_subrev_u32 v165, 49152, v126
    v_subrev_u32 v166, 57344, v126
    v_subrev_u32 v167, 65536, v126
    v_subrev_u32 v168, 73728, v126
    v_subrev_u32 v169, 81920, v126
    v_subrev_u32 v170, 90112, v126
    v_subrev_u32 v171, 98304, v126
    v_subrev_u32 v172, 106496, v126
    v_subrev_u32 v173, 114688, v126
    v_subrev_u32 v174, 122880, v126
    s_lshr_b32 s53, s82, 2
    s_add_u32 s53, s53, 1
    v_mov_b32 v177, s53
    s_lshl_b32 s50, s57, 2
    s_add_u32 s50, s50, 0xd200480
    v_mov_b32 v176, s50
    s_waitcnt vmcnt(0)
    s_barrier
    global_store_dword v176, v177, s[100:101]
    v_and_b32 v178, 7, v0
    v_min_u32 v178, s85, v178
    v_lshlrev_b32 v178, 4, v178
    v_sub_u32 v176, v176, v178
    s_mov_b32 s50, 0
L_lb_99:
    global_load_dword v178, v176, s[100:101] sc1
    s_add_u32 s50, s50, 1
    s_cmp_gt_u32 s50, 0x200000
    s_cbranch_scc1 chain_kernel_wabort
    s_waitcnt vmcnt(0)
    v_cmp_lt_u32 vcc, v178, v177
    s_cbranch_vccnz L_lb_99
    buffer_load_dwordx2 v[128:129], v160, s[60:63], 0 offen sc1
    buffer_load_dwordx2 v[130:131], v161, s[60:63], 0 offen sc1
    buffer_load_dwordx2 v[132:133], v162, s[60:63], 0 offen sc1
    buffer_load_dwordx2 v[134:135], v163, s[60:63], 0 offen sc1
    buffer_load_dwordx2 v[136:137], v164, s[60:63], 0 offen sc1
    buffer_load_dwordx2 v[138:139], v165, s[60:63], 0 offen sc1
    buffer_load_dwordx2 v[140:141], v166, s[60:63], 0 offen sc1
    buffer_load_dwordx2 v[142:143], v167, s[60:63], 0 offen sc1
    buffer_load_dwordx2 v[144:145], v168, s[60:63], 0 offen sc1
    buffer_load_dwordx2 v[146:147], v169, s[60:63], 0 offen sc1
    buffer_load_dwordx2 v[148:149], v170, s[60:63], 0 offen sc1
    buffer_load_dwordx2 v[150:151], v171, s[60:63], 0 offen sc1
    buffer_load_dwordx2 v[152:153], v172, s[60:63], 0 offen sc1
    buffer_load_dwordx2 v[154:155], v173, s[60:63], 0 offen sc1
    buffer_load_dwordx2 v[156:157], v174, s[60:63], 0 offen sc1
    s_waitcnt vmcnt(0)
    v_pk_fma_f32 v[56:57], v[120:121], v[156:157], v[154:155] op_sel:[0,0,0] op_sel_hi:[0,1,1]
    v_pk_fma_f32 v[154:155], v[120:121], v[156:157], v[56:57] op_sel:[1,1,0] op_sel_hi:[1,0,1] neg_lo:[1,0,0]
    v_pk_fma_f32 v[56:57], v[120:121], v[154:155], v[152:153] op_sel:[0,0,0] op_sel_hi:[0,1,1]
    v_pk_fma_f32 v[152:153], v[120:121], v[154:155], v[56:57] op_sel:[1,1,0] op_sel_hi:[1,0,1] neg_lo:[1,0,0]
    v_pk_fma_f32 v[56:57], v[120:121], v[152:153], v[150:151] op_sel:[0,0,0] op_sel_hi:[0,1,1]
    v_pk_fma_f32 v[150:151], v[120:121], v[152:153], v[56:57] op_sel:[1,1,0] op_sel_hi:[1,0,1] neg_lo:[1,0,0]
    v_pk_fma_f32 v[56:57], v[120:121], v[150:151], v[148:149] op_sel:[0,0,0] op_sel_hi:[0,1,1]
    v_pk_fma_f32 v[148:149], v[120:121], v[150:151], v[56:57] op_sel:[1,1,0] op_sel_hi:[1,0,1] neg_lo:[1,0,0]
    v_pk_fma_f32 v[56:57], v[120:121], v[148:149], v[146:147] op_sel:[0,0,0] op_sel_hi:[0,1,1]
    v_pk_fma_f32 v[146:147], v[120:121], v[148:149], v[56:57] op_sel:[1,1,0] op_sel_hi:[1,0,1] neg_lo:[1,0,0]
    v_pk_fma_f32 v[56:57], v[120:121], v[146:147], v[144:145] op_sel:[0,0,0] op_sel_hi:[0,1,1]
    v_pk_fma_f32 v[144:145], v[120:121], v[146:147], v[56:57] op_sel:[1,1,0] op_sel_hi:[1,0,1] neg_lo:[1,0,0]
    v_pk_fma_f32 v[56:57], v[120:121], v[144:145], v[142:143] op_sel:[0,0,0] op_sel_hi:[0,1,1]
    v_pk_fma_f32 v[142:143], v[120:121], v[144:145], v[56:57] op_sel:[1,1,0] op_sel_hi:[1,0,1] neg_lo:[1,0,0]
    v_pk_fma_f32 v[56:57], v[120:121], v[142:143], v[140:141] op_sel:[0,0,0] op_sel_hi:[0,1,1]
    v_pk_fma_f32 v[140:141], v[120:121], v[142:143], v[56:57] op_sel:[1,1,0] op_sel_hi:[1,0,1] neg_lo:[1,0,0]
    v_pk_fma_f32 v[56:57], v[120:121], v[140:141], v[138:139] op_sel:[0,0,0] op_sel_hi:[0,1,1]
    v_pk_fma_f32 v[138:139], v[120:121], v[140:141], v[56:57] op_sel:[1,1,0] op_sel_hi:[1,0,1] neg_lo:[1,0,0]
    v_pk_fma_f32 v[56:57], v[120:121], v[138:139], v[136:137] op_sel:[0,0,0] op_sel_hi:[0,1,1]
    v_pk_fma_f32 v[136:137], v[120:121], v[138:139], v[56:57] op_sel:[1,1,0] op_sel_hi:[1,0,1] neg_lo:[1,0,0]
    v_pk_fma_f32 v[56:57], v[120:121], v[136:137], v[134:135] op_sel:[0,0,0] op_sel_hi:[0,1,1]
    v_pk_fma_f32 v[134:135], v[120:121], v[136:137], v[56:57] op_sel:[1,1,0] op_sel_hi:[1,0,1] neg_lo:[1,0,0]
    v_pk_fma_f32 v[56:57], v[120:121], v[134:135], v[132:133] op_sel:[0,0,0] op_sel_hi:[0,1,1]
    v_pk_fma_f32 v[132:133], v[120:121], v[134:135], v[56:57] op_sel:[1,1,0] op_sel_hi:[1,0,1] neg_lo:[1,0,0]
    v_pk_fma_f32 v[56:57], v[120:121], v[132:133], v[130:131] op_sel:[0,0,0] op_sel_hi:[0,1,1]
    v_pk_fma_f32 v[130:131], v[120:121], v[132:133], v[56:57] op_sel:[1,1,0] op_sel_hi:[1,0,1] neg_lo:[1,0,0]
    v_pk_fma_f32 v[56:57], v[120:121], v[130:131], v[128:129] op_sel:[0,0,0] op_sel_hi:[0,1,1]
    v_pk_fma_f32 v[128:129], v[120:121], v[130:131], v[56:57] op_sel:[1,1,0] op_sel_hi:[1,0,1] neg_lo:[1,0,0]
    v_mov_b32 v32, v128
    v_mov_b32 v34, v128
    v_mov_b32 v33, v129
    v_mov_b32 v35, v129
    s_nop 1
    v_permlane16_swap_b32 v32, v34
    v_permlane16_swap_b32 v33, v35
    v_mov_b32 v36, v32
    v_mov_b32 v37, v33
    v_mov_b32 v38, v34
    v_mov_b32 v39, v35
    s_nop 1
    v_permlane32_swap_b32 v32, v36
    v_permlane32_swap_b32 v33, v37
    v_permlane32_swap_b32 v34, v38
    v_permlane32_swap_b32 v35, v39
    s_mov_b32 exec_lo, 0
    v_pk_fma_f32 v[56:57], v[112:113], v[32:33], v[80:81] op_sel:[0,0,0] op_sel_hi:[0,1,1]
    v_pk_fma_f32 v[58:59], v[114:115], v[34:35], v[82:83] op_sel:[0,0,0] op_sel_hi:[0,1,1]
    v_pk_fma_f32 v[60:61], v[116:117], v[36:37], v[84:85] op_sel:[0,0,0] op_sel_hi:[0,1,1]
    v_pk_fma_f32 v[62:63], v[118:119], v[38:39], v[86:87] op_sel:[0,0,0] op_sel_hi:[0,1,1]
    v_pk_fma_f32 v[32:33], v[112:113], v[32:33], v[56:57] op_sel:[1,1,0] op_sel_hi:[1,0,1] neg_lo:[1,0,0]
    v_pk_fma_f32 v[34:35], v[114:115], v[34:35], v[58:59] op_sel:[1,1,0] op_sel_hi:[1,0,1] neg_lo:[1,0,0]
    v_pk_fma_f32 v[36:37], v[116:117], v[36:37], v[60:61] op_sel:[1,1,0] op_sel_hi:[1,0,1] neg_lo:[1,0,0]
    v_pk_fma_f32 v[38:39], v[118:119], v[38:39], v[62:63] op_sel:[1,1,0] op_sel_hi:[1,0,1] neg_lo:[1,0,0]
    s_mov_b32 exec_lo, 0xffff0000
    s_mov_b32 exec_hi, 0xffff0000
    v_pk_fma_f32 v[56:57], v[104:105], v[32:33], v[64:65] op_sel:[0,0,0] op_sel_hi:[0,1,1]
    v_pk_fma_f32 v[58:59], v[106:107], v[34:35], v[66:67] op_sel:[0,0,0] op_sel_hi:[0,1,1]
    v_pk_fma_f32 v[60:61], v[108:109], v[36:37], v[68:69] op_sel:[0,0,0] op_sel_hi:[0,1,1]
    v_pk_fma_f32 v[62:63], v[110:111], v[38:39], v[70:71] op_sel:[0,0,0] op_sel_hi:[0,1,1]
    v_pk_fma_f32 v[32:33], v[104:105], v[32:33], v[56:57] op_sel:[1,1,0] op_sel_hi:[1,0,1] neg_lo:[1,0,0]
    v_pk_fma_f32 v[34:35], v[106:107], v[34:35], v[58:59] op_sel:[1,1,0] op_sel_hi:[1,0,1] neg_lo:[1,0,0]
    v_pk_fma_f32 v[36:37], v[108:109], v[36:37], v[60:61] op_sel:[1,1,0] op_sel_hi:[1,0,1] neg_lo:[1,0,0]
    v_pk_fma_f32 v[38:39], v[110:111], v[38:39], v[62:63] op_sel:[1,1,0] op_sel_hi:[1,0,1] neg_lo:[1,0,0]
    s_mov_b64 exec, -1
    v_accvgpr_read_b32 v64, a0
    v_accvgpr_read_b32 v66, a4
    v_accvgpr_read_b32 v68, a8
    v_accvgpr_read_b32 v70, a12
    v_accvgpr_read_b32 v65, a16
    v_accvgpr_read_b32 v67, a20
    v_accvgpr_read_b32 v69, a24
    v_accvgpr_read_b32 v71, a28
    v_pk_fma_f32 v[56:57], v[88:89], v[32:33], v[64:65] op_sel:[0,0,0] op_sel_hi:[0,1,1]
    v_pk_fma_f32 v[58:59], v[90:91], v[34:35], v[66:67] op_sel:[0,0,0] op_sel_hi:[0,1,1]
    v_pk_fma_f32 v[60:61], v[92:93], v[36:37], v[68:69] op_sel:[0,0,0] op_sel_hi:[0,1,1]
    v_pk_fma_f32 v[62:63], v[94:95], v[38:39], v[70:71] op_sel:[0,0,0] op_sel_hi:[0,1,1]
    v_pk_fma_f32 v[32:33], v[88:89], v[32:33], v[56:57] op_sel:[1,1,0] op_sel_hi:[1,0,1] neg_lo:[1,0,0]
    v_pk_fma_f32 v[34:35], v[90:91], v[34:35], v[58:59] op_sel:[1,1,0] op_sel_hi:[1,0,1] neg_lo:[1,0,0]
    v_pk_fma_f32 v[36:37], v[92:93], v[36:37], v[60:61] op_sel:[1,1,0] op_sel_hi:[1,0,1] neg_lo:[1,0,0]
    v_pk_fma_f32 v[38:39], v[94:95], v[38:39], v[62:63] op_sel:[1,1,0] op_sel_hi:[1,0,1] neg_lo:[1,0,0]
    v_pk_mul_f32 v[40:41], v[96:97], v[32:33] op_sel:[0,0] op_sel_hi:[0,1]
    v_pk_mul_f32 v[42:43], v[98:99], v[34:35] op_sel:[0,0] op_sel_hi:[0,1]
    v_pk_mul_f32 v[44:45], v[100:101], v[36:37] op_sel:[0,0] op_sel_hi:[0,1]
    v_pk_mul_f32 v[46:47], v[102:103], v[38:39] op_sel:[0,0] op_sel_hi:[0,1]
    v_pk_fma_f32 v[72:73], v[96:97], v[32:33], v[40:41] op_sel:[1,1,0] op_sel_hi:[1,0,1] neg_lo:[1,0,0] neg_hi:[1,0,1]
    v_pk_fma_f32 v[74:75], v[98:99], v[34:35], v[42:43] op_sel:[1,1,0] op_sel_hi:[1,0,1] neg_lo:[1,0,0] neg_hi:[1,0,1]
    v_pk_fma_f32 v[76:77], v[100:101], v[36:37], v[44:45] op_sel:[1,1,0] op_sel_hi:[1,0,1] neg_lo:[1,0,0] neg_hi:[1,0,1]
    v_pk_fma_f32 v[78:79], v[102:103], v[38:39], v[46:47] op_sel:[1,1,0] op_sel_hi:[1,0,1] neg_lo:[1,0,0] neg_hi:[1,0,1]
    v_accvgpr_read_b32 v48, a1
    v_accvgpr_read_b32 v50, a5
    v_accvgpr_read_b32 v52, a9
    v_accvgpr_read_b32 v54, a13
    v_accvgpr_read_b32 v49, a17
    v_accvgpr_read_b32 v51, a21
    v_accvgpr_read_b32 v53, a25
    v_accvgpr_read_b32 v55, a29
    v_pk_fma_f32 v[56:57], v[88:89], v[32:33], v[48:49] op_sel:[0,0,0] op_sel_hi:[0,1,1]
    v_pk_fma_f32 v[58:59], v[90:91], v[34:35], v[50:51] op_sel:[0,0,0] op_sel_hi:[0,1,1]
    v_pk_fma_f32 v[60:61], v[92:93], v[36:37], v[52:53] op_sel:[0,0,0] op_sel_hi:[0,1,1]
    v_pk_fma_f32 v[62:63], v[94:95], v[38:39], v[54:55] op_sel:[0,0,0] op_sel_hi:[0,1,1]
    v_pk_fma_f32 v[32:33], v[88:89], v[32:33], v[56:57] op_sel:[1,1,0] op_sel_hi:[1,0,1] neg_lo:[1,0,0]
    v_pk_fma_f32 v[34:35], v[90:91], v[34:35], v[58:59] op_sel:[1,1,0] op_sel_hi:[1,0,1] neg_lo:[1,0,0]
    v_pk_fma_f32 v[36:37], v[92:93], v[36:37], v[60:61] op_sel:[1,1,0] op_sel_hi:[1,0,1] neg_lo:[1,0,0]
    v_pk_fma_f32 v[38:39], v[94:95], v[38:39], v[62:63] op_sel:[1,1,0] op_sel_hi:[1,0,1] neg_lo:[1,0,0]
    v_pk_mul_f32 v[40:41], v[96:97], v[32:33] op_sel:[0,0] op_sel_hi:[0,1]
    v_pk_mul_f32 v[42:43], v[98:99], v[34:35] op_sel:[0,0] op_sel_hi:[0,1]
    v_pk_mul_f32 v[44:45], v[100:101], v[36:37] op_sel:[0,0] op_sel_hi:[0,1]
    v_pk_mul_f32 v[46:47], v[102:103], v[38:39] op_sel:[0,0] op_sel_hi:[0,1]
    v_pk_fma_f32 v[80:81], v[96:97], v[32:33], v[40:41] op_sel:[1,1,0] op_sel_hi:[1,0,1] neg_lo:[1,0,0] neg_hi:[1,0,1]
    v_pk_fma_f32 v[82:83], v[98:99], v[34:35], v[42:43] op_sel:[1,1,0] op_sel_hi:[1,0,1] neg_lo:[1,0,0] neg_hi:[1,0,1]
    v_pk_fma_f32 v[84:85], v[100:101], v[36:37], v[44:45] op_sel:[1,1,0] op_sel_hi:[1,0,1] neg_lo:[1,0,0] neg_hi:[1,0,1]
    v_pk_fma_f32 v[86:87], v[102:103], v[38:39], v[46:47] op_sel:[1,1,0] op_sel_hi:[1,0,1] neg_lo:[1,0,0] neg_hi:[1,0,1]
    v_cvt_pk_bf16_f32 v128, v72, v80
    v_cvt_pk_bf16_f32 v136, v74, v82
    v_cvt_pk_bf16_f32 v144, v76, v84
    v_cvt_pk_bf16_f32 v152, v78, v86
    v_cvt_pk_bf16_f32 v192, v73, v81
    v_cvt_pk_bf16_f32 v200, v75, v83
    v_cvt_pk_bf16_f32 v208, v77, v85
    v_cvt_pk_bf16_f32 v216, v79, v87
    v_accvgpr_read_b32 v64, a2
    v_accvgpr_read_b32 v66, a6
    v_accvgpr_read_b32 v68, a10
    v_accvgpr_read_b32 v70, a14
    v_accvgpr_read_b32 v65, a18
    v_accvgpr_read_b32 v67, a22
    v_accvgpr_read_b32 v69, a26
    v_accvgpr_read_b32 v71, a30
    v_pk_fma_f32 v[56:57], v[88:89], v[32:33], v[64:65] op_sel:[0,0,0] op_sel_hi:[0,1,1]
    v_pk_fma_f32 v[58:59], v[90:91], v[34:35], v[66:67] op_sel:[0,0,0] op_sel_hi:[0,1,1]
    v_pk_fma_f32 v[60:61], v[92:93], v[36:37], v[68:69] op_sel:[0,0,0] op_sel_hi:[0,1,1]
    v_pk_fma_f32 v[62:63], v[94:95], v[38:39], v[70:71] op_sel:[0,0,0] op_sel_hi:[0,1,1]
    v_pk_fma_f32 v[32:33], v[88:89], v[32:33], v[56:57] op_sel:[1,1,0] op_sel_hi:[1,0,1] neg_lo:[1,0,0]
    v_pk_fma_f32 v[34:35], v[90:91], v[34:35], v[58:59] op_sel:[1,1,0] op_sel_hi:[1,0,1] neg_lo:[1,0,0]
    v_pk_fma_f32 v[36:37], v[92:93], v[36:37], v[60:61] op_sel:[1,1,0] op_sel_hi:[1,0,1] neg_lo:[1,0,0]
    v_pk_fma_f32 v[38:39], v[94:95], v[38:39], v[62:63] op_sel:[1,1,0] op_sel_hi:[1,0,1] neg_lo:[1,0,0]
    v_pk_mul_f32 v[40:41], v[96:97], v[32:33] op_sel:[0,0] op_sel_hi:[0,1]
    v_pk_mul_f32 v[42:43], v[98:99], v[34:35] op_sel:[0,0] op_sel_hi:[0,1]
    v_pk_mul_f32 v[44:45], v[100:101], v[36:37] op_sel:[0,0] op_sel_hi:[0,1]
    v_pk_mul_f32 v[46:47], v[102:103], v[38:39] op_sel:[0,0] op_sel_hi:[0,1]
    v_pk_fma_f32 v[72:73], v[96:97], v[32:33], v[40:41] op_sel:[1,1,0] op_sel_hi:[1,0,1] neg_lo:[1,0,0] neg_hi:[1,0,1]
    v_pk_fma_f32 v[74:75], v[98:99], v[34:35], v[42:43] op_sel:[1,1,0] op_sel_hi:[1,0,1] neg_lo:[1,0,0] neg_hi:[1,0,1]
    v_pk_fma_f32 v[76:77], v[100:101], v[36:37], v[44:45] op_sel:[1,1,0] op_sel_hi:[1,0,1] neg_lo:[1,0,0] neg_hi:[1,0,1]
    v_pk_fma_f32 v[78:79], v[102:103], v[38:39], v[46:47] op_sel:[1,1,0] op_sel_hi:[1,0,1] neg_lo:[1,0,0] neg_hi:[1,0,1]
    v_accvgpr_read_b32 v48, a3
    v_accvgpr_read_b32 v50, a7
    v_accvgpr_read_b32 v52, a11
    v_accvgpr_read_b32 v54, a15
    v_accvgpr_read_b32 v49, a19
    v_accvgpr_read_b32 v51, a23
    v_accvgpr_read_b32 v53, a27
    v_accvgpr_read_b32 v55, a31
    v_pk_fma_f32 v[56:57], v[88:89], v[32:33], v[48:49] op_sel:[0,0,0] op_sel_hi:[0,1,1]
    v_pk_fma_f32 v[58:59], v[90:91], v[34:35], v[50:51] op_sel:[0,0,0] op_sel_hi:[0,1,1]
    v_pk_fma_f32 v[60:61], v[92:93], v[36:37], v[52:53] op_sel:[0,0,0] op_sel_hi:[0,1,1]
    v_pk_fma_f32 v[62:63], v[94:95], v[38:39], v[54:55] op_sel:[0,0,0] op_sel_hi:[0,1,1]
    v_pk_fma_f32 v[32:33], v[88:89], v[32:33], v[56:57] op_sel:[1,1,0] op_sel_hi:[1,0,1] neg_lo:[1,0,0]
    v_pk_fma_f32 v[34:35], v[90:91], v[34:35], v[58:59] op_sel:[1,1,0] op_sel_hi:[1,0,1] neg_lo:[1,0,0]
    v_pk_fma_f32 v[36:37], v[92:93], v[36:37], v[60:61] op_sel:[1,1,0] op_sel_hi:[1,0,1] neg_lo:[1,0,0]
    v_pk_fma_f32 v[38:39], v[94:95], v[38:39], v[62:63] op_sel:[1,1,0] op_sel_hi:[1,0,1] neg_lo:[1,0,0]
    v_pk_mul_f32 v[40:41], v[96:97], v[32:33] op_sel:[0,0] op_sel_hi:[0,1]
    v_pk_mul_f32 v[42:43], v[98:99], v[34:35] op_sel:[0,0] op_sel_hi:[0,1]
    v_pk_mul_f32 v[44:45], v[100:101], v[36:37] op_sel:[0,0] op_sel_hi:[0,1]
    v_pk_mul_f32 v[46:47], v[102:103], v[38:39] op_sel:[0,0] op_sel_hi:[0,1]
    v_pk_fma_f32 v[80:81], v[96:97], v[32:33], v[40:41] op_sel:[1,1,0] op_sel_hi:[1,0,1] neg_lo:[1,0,0] neg_hi:[1,0,1]
    v_pk_fma_f32 v[82:83], v[98:99], v[34:35], v[42:43] op_sel:[1,1,0] op_sel_hi:[1,0,1] neg_lo:[1,0,0] neg_hi:[1,0,1]
    v_pk_fma_f32 v[84:85], v[100:101], v[36:37], v[44:45] op_sel:[1,1,0] op_sel_hi:[1,0,1] neg_lo:[1,0,0] neg_hi:[1,0,1]
    v_pk_fma_f32 v[86:87], v[102:103], v[38:39], v[46:47] op_sel:[1,1,0] op_sel_hi:[1,0,1] neg_lo:[1,0,0] neg_hi:[1,0,1]
    v_cvt_pk_bf16_f32 v129, v72, v80
    v_cvt_pk_bf16_f32 v137, v74, v82
    v_cvt_pk_bf16_f32 v145, v76, v84
    v_cvt_pk_bf16_f32 v153, v78, v86
    v_cvt_pk_bf16_f32 v193, v73, v81
    v_cvt_pk_bf16_f32 v201, v75, v83
    v_cvt_pk_bf16_f32 v209, v77, v85
    v_cvt_pk_bf16_f32 v217, v79, v87
    v_accvgpr_read_b32 v64, a32
    v_accvgpr_read_b32 v66, a36
    v_accvgpr_read_b32 v68, a40
    v_accvgpr_read_b32 v70, a44
    v_accvgpr_read_b32 v65, a48
    v_accvgpr_read_b32 v67, a52
    v_accvgpr_read_b32 v69, a56
    v_accvgpr_read_b32 v71, a60
    v_pk_fma_f32 v[56:57], v[88:89], v[32:33], v[64:65] op_sel:[0,0,0] op_sel_hi:[0,1,1]
    v_pk_fma_f32 v[58:59], v[90:91], v[34:35], v[66:67] op_sel:[0,0,0] op_sel_hi:[0,1,1]
    v_pk_fma_f32 v[60:61], v[92:93], v[36:37], v[68:69] op_sel:[0,0,0] op_sel_hi:[0,1,1]
    v_pk_fma_f32 v[62:63], v[94:95], v[38:39], v[70:71] op_sel:[0,0,0] op_sel_hi:[0,1,1]
    v_pk_fma_f32 v[32:33], v[88:89], v[32:33], v[56:57] op_sel:[1,1,0] op_sel_hi:[1,0,1] neg_lo:[1,0,0]
    v_pk_fma_f32 v[34:35], v[90:91], v[34:35], v[58:59] op_sel:[1,1,0] op_sel_hi:[1,0,1] neg_lo:[1,0,0]
    v_pk_fma_f32 v[36:37], v[92:93], v[36:37], v[60:61] op_sel:[1,1,0] op_sel_hi:[1,0,1] neg_lo:[1,0,0]
    v_pk_fma_f32 v[38:39], v[94:95], v[38:39], v[62:63] op_sel:[1,1,0] op_sel_hi:[1,0,1] neg_lo:[1,0,0]
    v_pk_mul_f32 v[40:41], v[96:97], v[32:33] op_sel:[0,0] op_sel_hi:[0,1]
    v_pk_mul_f32 v[42:43], v[98:99], v[34:35] op_sel:[0,0] op_sel_hi:[0,1]
    v_pk_mul_f32 v[44:45], v[100:101], v[36:37] op_sel:[0,0] op_sel_hi:[0,1]
    v_pk_mul_f32 v[46:47], v[102:103], v[38:39] op_sel:[0,0] op_sel_hi:[0,1]
    v_pk_fma_f32 v[72:73], v[96:97], v[32:33], v[40:41] op_sel:[1,1,0] op_sel_hi:[1,0,1] neg_lo:[1,0,0] neg_hi:[1,0,1]
    v_pk_fma_f32 v[74:75], v[98:99], v[34:35], v[42:43] op_sel:[1,1,0] op_sel_hi:[1,0,1] neg_lo:[1,0,0] neg_hi:[1,0,1]
    v_pk_fma_f32 v[76:77], v[100:101], v[36:37], v[44:45] op_sel:[1,1,0] op_sel_hi:[1,0,1] neg_lo:[1,0,0] neg_hi:[1,0,1]
    v_pk_fma_f32 v[78:79], v[102:103], v[38:39], v[46:47] op_sel:[1,1,0] op_sel_hi:[1,0,1] neg_lo:[1,0,0] neg_hi:[1,0,1]
    v_accvgpr_read_b32 v48, a33
    v_accvgpr_read_b32 v50, a37
    v_accvgpr_read_b32 v52, a41
    v_accvgpr_read_b32 v54, a45
    v_accvgpr_read_b32 v49, a49
    v_accvgpr_read_b32 v51, a53
    v_accvgpr_read_b32 v53, a57
    v_accvgpr_read_b32 v55, a61
    v_pk_fma_f32 v[56:57], v[88:89], v[32:33], v[48:49] op_sel:[0,0,0] op_sel_hi:[0,1,1]
    v_pk_fma_f32 v[58:59], v[90:91], v[34:35], v[50:51] op_sel:[0,0,0] op_sel_hi:[0,1,1]
    v_pk_fma_f32 v[60:61], v[92:93], v[36:37], v[52:53] op_sel:[0,0,0] op_sel_hi:[0,1,1]
    v_pk_fma_f32 v[62:63], v[94:95], v[38:39], v[54:55] op_sel:[0,0,0] op_sel_hi:[0,1,1]
    v_pk_fma_f32 v[32:33], v[88:89], v[32:33], v[56:57] op_sel:[1,1,0] op_sel_hi:[1,0,1] neg_lo:[1,0,0]
    v_pk_fma_f32 v[34:35], v[90:91], v[34:35], v[58:59] op_sel:[1,1,0] op_sel_hi:[1,0,1] neg_lo:[1,0,0]
    v_pk_fma_f32 v[36:37], v[92:93], v[36:37], v[60:61] op_sel:[1,1,0] op_sel_hi:[1,0,1] neg_lo:[1,0,0]
    v_pk_fma_f32 v[38:39], v[94:95], v[38:39], v[62:63] op_sel:[1,1,0] op_sel_hi:[1,0,1] neg_lo:[1,0,0]
    v_pk_mul_f32 v[40:41], v[96:97], v[32:33] op_sel:[0,0] op_sel_hi:[0,1]
    v_pk_mul_f32 v[42:43], v[98:99], v[34:35] op_sel:[0,0] op_sel_hi:[0,1]
    v_pk_mul_f32 v[44:45], v[100:101], v[36:37] op_sel:[0,0] op_sel_hi:[0,1]
    v_pk_mul_f32 v[46:47], v[102:103], v[38:39] op_sel:[0,0] op_sel_hi:[0,1]
    v_pk_fma_f32 v[80:81], v[96:97], v[32:33], v[40:41] op_sel:[1,1,0] op_sel_hi:[1,0,1] neg_lo:[1,0,0] neg_hi:[1,0,1]
    v_pk_fma_f32 v[82:83], v[98:99], v[34:35], v[42:43] op_sel:[1,1,0] op_sel_hi:[1,0,1] neg_lo:[1,0,0] neg_hi:[1,0,1]
    v_pk_fma_f32 v[84:85], v[100:101], v[36:37], v[44:45] op_sel:[1,1,0] op_sel_hi:[1,0,1] neg_lo:[1,0,0] neg_hi:[1,0,1]
    v_pk_fma_f32 v[86:87], v[102:103], v[38:39], v[46:47] op_sel:[1,1,0] op_sel_hi:[1,0,1] neg_lo:[1,0,0] neg_hi:[1,0,1]
    v_cvt_pk_bf16_f32 v130, v72, v80
    v_cvt_pk_bf16_f32 v138, v74, v82
    v_cvt_pk_bf16_f32 v146, v76, v84
    v_cvt_pk_bf16_f32 v154, v78, v86
    v_cvt_pk_bf16_f32 v194, v73, v81
    v_cvt_pk_bf16_f32 v202, v75, v83
    v_cvt_pk_bf16_f32 v210, v77, v85
    v_cvt_pk_bf16_f32 v218, v79, v87
    v_accvgpr_read_b32 v64, a34
    v_accvgpr_read_b32 v66, a38
    v_accvgpr_read_b32 v68, a42
    v_accvgpr_read_b32 v70, a46
    v_accvgpr_read_b32 v65, a50
    v_accvgpr_read_b32 v67, a54
    v_accvgpr_read_b32 v69, a58
    v_accvgpr_read_b32 v71, a62
    v_pk_fma_f32 v[56:57], v[88:89], v[32:33], v[64:65] op_sel:[0,0,0] op_sel_hi:[0,1,1]
    v_pk_fma_f32 v[58:59], v[90:91], v[34:35], v[66:67] op_sel:[0,0,0] op_sel_hi:[0,1,1]
    v_pk_fma_f32 v[60:61], v[92:93], v[36:37], v[68:69] op_sel:[0,0,0] op_sel_hi:[0,1,1]
    v_pk_fma_f32 v[62:63], v[94:95], v[38:39], v[70:71] op_sel:[0,0,0] op_sel_hi:[0,1,1]
    v_pk_fma_f32 v[32:33], v[88:89], v[32:33], v[56:57] op_sel:[1,1,0] op_sel_hi:[1,0,1] neg_lo:[1,0,0]
    v_pk_fma_f32 v[34:35], v[90:91], v[34:35], v[58:59] op_sel:[1,1,0] op_sel_hi:[1,0,1] neg_lo:[1,0,0]
    v_pk_fma_f32 v[36:37], v[92:93], v[36:37], v[60:61] op_sel:[1,1,0] op_sel_hi:[1,0,1] neg_lo:[1,0,0]
    v_pk_fma_f32 v[38:39], v[94:95], v[38:39], v[62:63] op_sel:[1,1,0] op_sel_hi:[1,0,1] neg_lo:[1,0,0]
    v_pk_mul_f32 v[40:41], v[96:97], v[32:33] op_sel:[0,0] op_sel_hi:[0,1]
    v_pk_mul_f32 v[42:43], v[98:99], v[34:35] op_sel:[0,0] op_sel_hi:[0,1]
    v_pk_mul_f32 v[44:45], v[100:101], v[36:37] op_sel:[0,0] op_sel_hi:[0,1]
    v_pk_mul_f32 v[46:47], v[102:103], v[38:39] op_sel:[0,0] op_sel_hi:[0,1]
    v_pk_fma_f32 v[72:73], v[96:97], v[32:33], v[40:41] op_sel:[1,1,0] op_sel_hi:[1,0,1] neg_lo:[1,0,0] neg_hi:[1,0,1]
    v_pk_fma_f32 v[74:75], v[98:99], v[34:35], v[42:43] op_sel:[1,1,0] op_sel_hi:[1,0,1] neg_lo:[1,0,0] neg_hi:[1,0,1]
    v_pk_fma_f32 v[76:77], v[100:101], v[36:37], v[44:45] op_sel:[1,1,0] op_sel_hi:[1,0,1] neg_lo:[1,0,0] neg_hi:[1,0,1]
    v_pk_fma_f32 v[78:79], v[102:103], v[38:39], v[46:47] op_sel:[1,1,0] op_sel_hi:[1,0,1] neg_lo:[1,0,0] neg_hi:[1,0,1]
    v_accvgpr_read_b32 v48, a35
    v_accvgpr_read_b32 v50, a39
    v_accvgpr_read_b32 v52, a43
    v_accvgpr_read_b32 v54, a47
    v_accvgpr_read_b32 v49, a51
    v_accvgpr_read_b32 v51, a55
    v_accvgpr_read_b32 v53, a59
    v_accvgpr_read_b32 v55, a63
    v_pk_fma_f32 v[56:57], v[88:89], v[32:33], v[48:49] op_sel:[0,0,0] op_sel_hi:[0,1,1]
    v_pk_fma_f32 v[58:59], v[90:91], v[34:35], v[50:51] op_sel:[0,0,0] op_sel_hi:[0,1,1]
    v_pk_fma_f32 v[60:61], v[92:93], v[36:37], v[52:53] op_sel:[0,0,0] op_sel_hi:[0,1,1]
    v_pk_fma_f32 v[62:63], v[94:95], v[38:39], v[54:55] op_sel:[0,0,0] op_sel_hi:[0,1,1]
    v_pk_fma_f32 v[32:33], v[88:89], v[32:33], v[56:57] op_sel:[1,1,0] op_sel_hi:[1,0,1] neg_lo:[1,0,0]
    v_pk_fma_f32 v[34:35], v[90:91], v[34:35], v[58:59] op_sel:[1,1,0] op_sel_hi:[1,0,1] neg_lo:[1,0,0]
    v_pk_fma_f32 v[36:37], v[92:93], v[36:37], v[60:61] op_sel:[1,1,0] op_sel_hi:[1,0,1] neg_lo:[1,0,0]
    v_pk_fma_f32 v[38:39], v[94:95], v[38:39], v[62:63] op_sel:[1,1,0] op_sel_hi:[1,0,1] neg_lo:[1,0,0]
    v_pk_mul_f32 v[40:41], v[96:97], v[32:33] op_sel:[0,0] op_sel_hi:[0,1]
    v_pk_mul_f32 v[42:43], v[98:99], v[34:35] op_sel:[0,0] op_sel_hi:[0,1]
    v_pk_mul_f32 v[44:45], v[100:101], v[36:37] op_sel:[0,0] op_sel_hi:[0,1]
    v_pk_mul_f32 v[46:47], v[102:103], v[38:39] op_sel:[0,0] op_sel_hi:[0,1]
    v_pk_fma_f32 v[80:81], v[96:97], v[32:33], v[40:41] op_sel:[1,1,0] op_sel_hi:[1,0,1] neg_lo:[1,0,0] neg_hi:[1,0,1]
    v_pk_fma_f32 v[82:83], v[98:99], v[34:35], v[42:43] op_sel:[1,1,0] op_sel_hi:[1,0,1] neg_lo:[1,0,0] neg_hi:[1,0,1]
    v_pk_fma_f32 v[84:85], v[100:101], v[36:37], v[44:45] op_sel:[1,1,0] op_sel_hi:[1,0,1] neg_lo:[1,0,0] neg_hi:[1,0,1]
    v_pk_fma_f32 v[86:87], v[102:103], v[38:39], v[46:47] op_sel:[1,1,0] op_sel_hi:[1,0,1] neg_lo:[1,0,0] neg_hi:[1,0,1]
    v_cvt_pk_bf16_f32 v131, v72, v80
    v_cvt_pk_bf16_f32 v139, v74, v82
    v_cvt_pk_bf16_f32 v147, v76, v84
    v_cvt_pk_bf16_f32 v155, v78, v86
    v_cvt_pk_bf16_f32 v195, v73, v81
    v_cvt_pk_bf16_f32 v203, v75, v83
    v_cvt_pk_bf16_f32 v211, v77, v85
    v_cvt_pk_bf16_f32 v219, v79, v87
    v_accvgpr_read_b32 v64, a64
    v_accvgpr_read_b32 v66, a68
    v_accvgpr_read_b32 v68, a72
    v_accvgpr_read_b32 v70, a76
    v_accvgpr_read_b32 v65, a80
    v_accvgpr_read_b32 v67, a84
    v_accvgpr_read_b32 v69, a88
    v_accvgpr_read_b32 v71, a92
    v_pk_fma_f32 v[56:57], v[88:89], v[32:33], v[64:65] op_sel:[0,0,0] op_sel_hi:[0,1,1]
    v_pk_fma_f32 v[58:59], v[90:91], v[34:35], v[66:67] op_sel:[0,0,0] op_sel_hi:[0,1,1]
    v_pk_fma_f32 v[60:61], v[92:93], v[36:37], v[68:69] op_sel:[0,0,0] op_sel_hi:[0,1,1]
    v_pk_fma_f32 v[62:63], v[94:95], v[38:39], v[70:71] op_sel:[0,0,0] op_sel_hi:[0,1,1]
    v_pk_fma_f32 v[32:33], v[88:89], v[32:33], v[56:57] op_sel:[1,1,0] op_sel_hi:[1,0,1] neg_lo:[1,0,0]
    v_pk_fma_f32 v[34:35], v[90:91], v[34:35], v[58:59] op_sel:[1,1,0] op_sel_hi:[1,0,1] neg_lo:[1,0,0]
    v_pk_fma_f32 v[36:37], v[92:93], v[36:37], v[60:61] op_sel:[1,1,0] op_sel_hi:[1,0,1] neg_lo:[1,0,0]
    v_pk_fma_f32 v[38:39], v[94:95], v[38:39], v[62:63] op_sel:[1,1,0] op_sel_hi:[1,0,1] neg_lo:[1,0,0]
    v_pk_mul_f32 v[40:41], v[96:97], v[32:33] op_sel:[0,0] op_sel_hi:[0,1]
    v_pk_mul_f32 v[42:43], v[98:99], v[34:35] op_sel:[0,0] op_sel_hi:[0,1]
    v_pk_mul_f32 v[44:45], v[100:101], v[36:37] op_sel:[0,0] op_sel_hi:[0,1]
    v_pk_mul_f32 v[46:47], v[102:103], v[38:39] op_sel:[0,0] op_sel_hi:[0,1]
    v_pk_fma_f32 v[72:73], v[96:97], v[32:33], v[40:41] op_sel:[1,1,0] op_sel_hi:[1,0,1] neg_lo:[1,0,0] neg_hi:[1,0,1]
    v_pk_fma_f32 v[74:75], v[98:99], v[34:35], v[42:43] op_sel:[1,1,0] op_sel_hi:[1,0,1] neg_lo:[1,0,0] neg_hi:[1,0,1]
    v_pk_fma_f32 v[76:77], v[100:101], v[36:37], v[44:45] op_sel:[1,1,0] op_sel_hi:[1,0,1] neg_lo:[1,0,0] neg_hi:[1,0,1]
    v_pk_fma_f32 v[78:79], v[102:103], v[38:39], v[46:47] op_sel:[1,1,0] op_sel_hi:[1,0,1] neg_lo:[1,0,0] neg_hi:[1,0,1]
    v_accvgpr_read_b32 v48, a65
    v_accvgpr_read_b32 v50, a69
    v_accvgpr_read_b32 v52, a73
    v_accvgpr_read_b32 v54, a77
    v_accvgpr_read_b32 v49, a81
    v_accvgpr_read_b32 v51, a85
    v_accvgpr_read_b32 v53, a89
    v_accvgpr_read_b32 v55, a93
    v_pk_fma_f32 v[56:57], v[88:89], v[32:33], v[48:49] op_sel:[0,0,0] op_sel_hi:[0,1,1]
    v_pk_fma_f32 v[58:59], v[90:91], v[34:35], v[50:51] op_sel:[0,0,0] op_sel_hi:[0,1,1]
    v_pk_fma_f32 v[60:61], v[92:93], v[36:37], v[52:53] op_sel:[0,0,0] op_sel_hi:[0,1,1]
    v_pk_fma_f32 v[62:63], v[94:95], v[38:39], v[54:55] op_sel:[0,0,0] op_sel_hi:[0,1,1]
    v_pk_fma_f32 v[32:33], v[88:89], v[32:33], v[56:57] op_sel:[1,1,0] op_sel_hi:[1,0,1] neg_lo:[1,0,0]
    v_pk_fma_f32 v[34:35], v[90:91], v[34:35], v[58:59] op_sel:[1,1,0] op_sel_hi:[1,0,1] neg_lo:[1,0,0]
    v_pk_fma_f32 v[36:37], v[92:93], v[36:37], v[60:61] op_sel:[1,1,0] op_sel_hi:[1,0,1] neg_lo:[1,0,0]
    v_pk_fma_f32 v[38:39], v[94:95], v[38:39], v[62:63] op_sel:[1,1,0] op_sel_hi:[1,0,1] neg_lo:[1,0,0]
    v_pk_mul_f32 v[40:41], v[96:97], v[32:33] op_sel:[0,0] op_sel_hi:[0,1]
    v_pk_mul_f32 v[42:43], v[98:99], v[34:35] op_sel:[0,0] op_sel_hi:[0,1]
    v_pk_mul_f32 v[44:45], v[100:101], v[36:37] op_sel:[0,0] op_sel_hi:[0,1]
    v_pk_mul_f32 v[46:47], v[102:103], v[38:39] op_sel:[0,0] op_sel_hi:[0,1]
    v_pk_fma_f32 v[80:81], v[96:97], v[32:33], v[40:41] op_sel:[1,1,0] op_sel_hi:[1,0,1] neg_lo:[1,0,0] neg_hi:[1,0,1]
    v_pk_fma_f32 v[82:83], v[98:99], v[34:35], v[42:43] op_sel:[1,1,0] op_sel_hi:[1,0,1] neg_lo:[1,0,0] neg_hi:[1,0,1]
    v_pk_fma_f32 v[84:85], v[100:101], v[36:37], v[44:45] op_sel:[1,1,0] op_sel_hi:[1,0,1] neg_lo:[1,0,0] neg_hi:[1,0,1]
    v_pk_fma_f32 v[86:87], v[102:103], v[38:39], v[46:47] op_sel:[1,1,0] op_sel_hi:[1,0,1] neg_lo:[1,0,0] neg_hi:[1,0,1]
    v_cvt_pk_bf16_f32 v132, v72, v80
    v_cvt_pk_bf16_f32 v140, v74, v82
    v_cvt_pk_bf16_f32 v148, v76, v84
    v_cvt_pk_bf16_f32 v156, v78, v86
    v_cvt_pk_bf16_f32 v196, v73, v81
    v_cvt_pk_bf16_f32 v204, v75, v83
    v_cvt_pk_bf16_f32 v212, v77, v85
    v_cvt_pk_bf16_f32 v220, v79, v87
    v_accvgpr_read_b32 v64, a66
    v_accvgpr_read_b32 v66, a70
    v_accvgpr_read_b32 v68, a74
    v_accvgpr_read_b32 v70, a78
    v_accvgpr_read_b32 v65, a82
    v_accvgpr_read_b32 v67, a86
    v_accvgpr_read_b32 v69, a90
    v_accvgpr_read_b32 v71, a94
    v_pk_fma_f32 v[56:57], v[88:89], v[32:33], v[64:65] op_sel:[0,0,0] op_sel_hi:[0,1,1]
    v_pk_fma_f32 v[58:59], v[90:91], v[34:35], v[66:67] op_sel:[0,0,0] op_sel_hi:[0,1,1]
    v_pk_fma_f32 v[60:61], v[92:93], v[36:37], v[68:69] op_sel:[0,0,0] op_sel_hi:[0,1,1]
    v_pk_fma_f32 v[62:63], v[94:95], v[38:39], v[70:71] op_sel:[0,0,0] op_sel_hi:[0,1,1]
    v_pk_fma_f32 v[32:33], v[88:89], v[32:33], v[56:57] op_sel:[1,1,0] op_sel_hi:[1,0,1] neg_lo:[1,0,0]
    v_pk_fma_f32 v[34:35], v[90:91], v[34:35], v[58:59] op_sel:[1,1,0] op_sel_hi:[1,0,1] neg_lo:[1,0,0]
    v_pk_fma_f32 v[36:37], v[92:93], v[36:37], v[60:61] op_sel:[1,1,0] op_sel_hi:[1,0,1] neg_lo:[1,0,0]
    v_pk_fma_f32 v[38:39], v[94:95], v[38:39], v[62:63] op_sel:[1,1,0] op_sel_hi:[1,0,1] neg_lo:[1,0,0]
    v_pk_mul_f32 v[40:41], v[96:97], v[32:33] op_sel:[0,0] op_sel_hi:[0,1]
    v_pk_mul_f32 v[42:43], v[98:99], v[34:35] op_sel:[0,0] op_sel_hi:[0,1]
    v_pk_mul_f32 v[44:45], v[100:101], v[36:37] op_sel:[0,0] op_sel_hi:[0,1]
    v_pk_mul_f32 v[46:47], v[102:103], v[38:39] op_sel:[0,0] op_sel_hi:[0,1]
    v_pk_fma_f32 v[72:73], v[96:97], v[32:33], v[40:41] op_sel:[1,1,0] op_sel_hi:[1,0,1] neg_lo:[1,0,0] neg_hi:[1,0,1]
    v_pk_fma_f32 v[74:75], v[98:99], v[34:35], v[42:43] op_sel:[1,1,0] op_sel_hi:[1,0,1] neg_lo:[1,0,0] neg_hi:[1,0,1]
    v_pk_fma_f32 v[76:77], v[100:101], v[36:37], v[44:45] op_sel:[1,1,0] op_sel_hi:[1,0,1] neg_lo:[1,0,0] neg_hi:[1,0,1]
    v_pk_fma_f32 v[78:79], v[102:103], v[38:39], v[46:47] op_sel:[1,1,0] op_sel_hi:[1,0,1] neg_lo:[1,0,0] neg_hi:[1,0,1]
    v_accvgpr_read_b32 v48, a67
    v_accvgpr_read_b32 v50, a71
    v_accvgpr_read_b32 v52, a75
    v_accvgpr_read_b32 v54, a79
    v_accvgpr_read_b32 v49, a83
    v_accvgpr_read_b32 v51, a87
    v_accvgpr_read_b32 v53, a91
    v_accvgpr_read_b32 v55, a95
    v_pk_fma_f32 v[56:57], v[88:89], v[32:33], v[48:49] op_sel:[0,0,0] op_sel_hi:[0,1,1]
    v_pk_fma_f32 v[58:59], v[90:91], v[34:35], v[50:51] op_sel:[0,0,0] op_sel_hi:[0,1,1]
    v_pk_fma_f32 v[60:61], v[92:93], v[36:37], v[52:53] op_sel:[0,0,0] op_sel_hi:[0,1,1]
    v_pk_fma_f32 v[62:63], v[94:95], v[38:39], v[54:55] op_sel:[0,0,0] op_sel_hi:[0,1,1]
    v_pk_fma_f32 v[32:33], v[88:89], v[32:33], v[56:57] op_sel:[1,1,0] op_sel_hi:[1,0,1] neg_lo:[1,0,0]
    v_pk_fma_f32 v[34:35], v[90:91], v[34:35], v[58:59] op_sel:[1,1,0] op_sel_hi:[1,0,1] neg_lo:[1,0,0]
    v_pk_fma_f32 v[36:37], v[92:93], v[36:37], v[60:61] op_sel:[1,1,0] op_sel_hi:[1,0,1] neg_lo:[1,0,0]
    v_pk_fma_f32 v[38:39], v[94:95], v[38:39], v[62:63] op_sel:[1,1,0] op_sel_hi:[1,0,1] neg_lo:[1,0,0]
    v_pk_mul_f32 v[40:41], v[96:97], v[32:33] op_sel:[0,0] op_sel_hi:[0,1]
    v_pk_mul_f32 v[42:43], v[98:99], v[34:35] op_sel:[0,0] op_sel_hi:[0,1]
    v_pk_mul_f32 v[44:45], v[100:101], v[36:37] op_sel:[0,0] op_sel_hi:[0,1]
    v_pk_mul_f32 v[46:47], v[102:103], v[38:39] op_sel:[0,0] op_sel_hi:[0,1]
    v_pk_fma_f32 v[80:81], v[96:97], v[32:33], v[40:41] op_sel:[1,1,0] op_sel_hi:[1,0,1] neg_lo:[1,0,0] neg_hi:[1,0,1]
    v_pk_fma_f32 v[82:83], v[98:99], v[34:35], v[42:43] op_sel:[1,1,0] op_sel_hi:[1,0,1] neg_lo:[1,0,0] neg_hi:[1,0,1]
    v_pk_fma_f32 v[84:85], v[100:101], v[36:37], v[44:45] op_sel:[1,1,0] op_sel_hi:[1,0,1] neg_lo:[1,0,0] neg_hi:[1,0,1]
    v_pk_fma_f32 v[86:87], v[102:103], v[38:39], v[46:47] op_sel:[1,1,0] op_sel_hi:[1,0,1] neg_lo:[1,0,0] neg_hi:[1,0,1]
    v_cvt_pk_bf16_f32 v133, v72, v80
    v_cvt_pk_bf16_f32 v141, v74, v82
    v_cvt_pk_bf16_f32 v149, v76, v84
    v_cvt_pk_bf16_f32 v157, v78, v86
    v_cvt_pk_bf16_f32 v197, v73, v81
    v_cvt_pk_bf16_f32 v205, v75, v83
    v_cvt_pk_bf16_f32 v213, v77, v85
    v_cvt_pk_bf16_f32 v221, v79, v87
    v_accvgpr_read_b32 v64, a96
    v_accvgpr_read_b32 v66, a100
    v_accvgpr_read_b32 v68, a104
    v_accvgpr_read_b32 v70, a108
    v_accvgpr_read_b32 v65, a112
    v_accvgpr_read_b32 v67, a116
    v_accvgpr_read_b32 v69, a120
    v_accvgpr_read_b32 v71, a124
    v_pk_fma_f32 v[56:57], v[88:89], v[32:33], v[64:65] op_sel:[0,0,0] op_sel_hi:[0,1,1]
    v_pk_fma_f32 v[58:59], v[90:91], v[34:35], v[66:67] op_sel:[0,0,0] op_sel_hi:[0,1,1]
    v_pk_fma_f32 v[60:61], v[92:93], v[36:37], v[68:69] op_sel:[0,0,0] op_sel_hi:[0,1,1]
    v_pk_fma_f32 v[62:63], v[94:95], v[38:39], v[70:71] op_sel:[0,0,0] op_sel_hi:[0,1,1]
    v_pk_fma_f32 v[32:33], v[88:89], v[32:33], v[56:57] op_sel:[1,1,0] op_sel_hi:[1,0,1] neg_lo:[1,0,0]
    v_pk_fma_f32 v[34:35], v[90:91], v[34:35], v[58:59] op_sel:[1,1,0] op_sel_hi:[1,0,1] neg_lo:[1,0,0]
    v_pk_fma_f32 v[36:37], v[92:93], v[36:37], v[60:61] op_sel:[1,1,0] op_sel_hi:[1,0,1] neg_lo:[1,0,0]
    v_pk_fma_f32 v[38:39], v[94:95], v[38:39], v[62:63] op_sel:[1,1,0] op_sel_hi:[1,0,1] neg_lo:[1,0,0]
    v_pk_mul_f32 v[40:41], v[96:97], v[32:33] op_sel:[0,0] op_sel_hi:[0,1]
    v_pk_mul_f32 v[42:43], v[98:99], v[34:35] op_sel:[0,0] op_sel_hi:[0,1]
    v_pk_mul_f32 v[44:45], v[100:101], v[36:37] op_sel:[0,0] op_sel_hi:[0,1]
    v_pk_mul_f32 v[46:47], v[102:103], v[38:39] op_sel:[0,0] op_sel_hi:[0,1]
    v_pk_fma_f32 v[72:73], v[96:97], v[32:33], v[40:41] op_sel:[1,1,0] op_sel_hi:[1,0,1] neg_lo:[1,0,0] neg_hi:[1,0,1]
    v_pk_fma_f32 v[74:75], v[98:99], v[34:35], v[42:43] op_sel:[1,1,0] op_sel_hi:[1,0,1] neg_lo:[1,0,0] neg_hi:[1,0,1]
    v_pk_fma_f32 v[76:77], v[100:101], v[36:37], v[44:45] op_sel:[1,1,0] op_sel_hi:[1,0,1] neg_lo:[1,0,0] neg_hi:[1,0,1]
    v_pk_fma_f32 v[78:79], v[102:103], v[38:39], v[46:47] op_sel:[1,1,0] op_sel_hi:[1,0,1] neg_lo:[1,0,0] neg_hi:[1,0,1]
    v_accvgpr_read_b32 v48, a97
    v_accvgpr_read_b32 v50, a101
    v_accvgpr_read_b32 v52, a105
    v_accvgpr_read_b32 v54, a109
    v_accvgpr_read_b32 v49, a113
    v_accvgpr_read_b32 v51, a117
    v_accvgpr_read_b32 v53, a121
    v_accvgpr_read_b32 v55, a125
    v_pk_fma_f32 v[56:57], v[88:89], v[32:33], v[48:49] op_sel:[0,0,0] op_sel_hi:[0,1,1]
    v_pk_fma_f32 v[58:59], v[90:91], v[34:35], v[50:51] op_sel:[0,0,0] op_sel_hi:[0,1,1]
    v_pk_fma_f32 v[60:61], v[92:93], v[36:37], v[52:53] op_sel:[0,0,0] op_sel_hi:[0,1,1]
    v_pk_fma_f32 v[62:63], v[94:95], v[38:39], v[54:55] op_sel:[0,0,0] op_sel_hi:[0,1,1]
    v_pk_fma_f32 v[32:33], v[88:89], v[32:33], v[56:57] op_sel:[1,1,0] op_sel_hi:[1,0,1] neg_lo:[1,0,0]
    v_pk_fma_f32 v[34:35], v[90:91], v[34:35], v[58:59] op_sel:[1,1,0] op_sel_hi:[1,0,1] neg_lo:[1,0,0]
    v_pk_fma_f32 v[36:37], v[92:93], v[36:37], v[60:61] op_sel:[1,1,0] op_sel_hi:[1,0,1] neg_lo:[1,0,0]
    v_pk_fma_f32 v[38:39], v[94:95], v[38:39], v[62:63] op_sel:[1,1,0] op_sel_hi:[1,0,1] neg_lo:[1,0,0]
    v_pk_mul_f32 v[40:41], v[96:97], v[32:33] op_sel:[0,0] op_sel_hi:[0,1]
    v_pk_mul_f32 v[42:43], v[98:99], v[34:35] op_sel:[0,0] op_sel_hi:[0,1]
    v_pk_mul_f32 v[44:45], v[100:101], v[36:37] op_sel:[0,0] op_sel_hi:[0,1]
    v_pk_mul_f32 v[46:47], v[102:103], v[38:39] op_sel:[0,0] op_sel_hi:[0,1]
    v_pk_fma_f32 v[80:81], v[96:97], v[32:33], v[40:41] op_sel:[1,1,0] op_sel_hi:[1,0,1] neg_lo:[1,0,0] neg_hi:[1,0,1]
    v_pk_fma_f32 v[82:83], v[98:99], v[34:35], v[42:43] op_sel:[1,1,0] op_sel_hi:[1,0,1] neg_lo:[1,0,0] neg_hi:[1,0,1]
    v_pk_fma_f32 v[84:85], v[100:101], v[36:37], v[44:45] op_sel:[1,1,0] op_sel_hi:[1,0,1] neg_lo:[1,0,0] neg_hi:[1,0,1]
    v_pk_fma_f32 v[86:87], v[102:103], v[38:39], v[46:47] op_sel:[1,1,0] op_sel_hi:[1,0,1] neg_lo:[1,0,0] neg_hi:[1,0,1]
    v_cvt_pk_bf16_f32 v134, v72, v80
    v_cvt_pk_bf16_f32 v142, v74, v82
    v_cvt_pk_bf16_f32 v150, v76, v84
    v_cvt_pk_bf16_f32 v158, v78, v86
    v_cvt_pk_bf16_f32 v198, v73, v81
    v_cvt_pk_bf16_f32 v206, v75, v83
    v_cvt_pk_bf16_f32 v214, v77, v85
    v_cvt_pk_bf16_f32 v222, v79, v87
    v_accvgpr_read_b32 v64, a98
    v_accvgpr_read_b32 v66, a102
    v_accvgpr_read_b32 v68, a106
    v_accvgpr_read_b32 v70, a110
    v_accvgpr_read_b32 v65, a114
    v_accvgpr_read_b32 v67, a118
    v_accvgpr_read_b32 v69, a122
    v_accvgpr_read_b32 v71, a126
    v_pk_fma_f32 v[56:57], v[88:89], v[32:33], v[64:65] op_sel:[0,0,0] op_sel_hi:[0,1,1]
    v_pk_fma_f32 v[58:59], v[90:91], v[34:35], v[66:67] op_sel:[0,0,0] op_sel_hi:[0,1,1]
    v_pk_fma_f32 v[60:61], v[92:93], v[36:37], v[68:69] op_sel:[0,0,0] op_sel_hi:[0,1,1]
    v_pk_fma_f32 v[62:63], v[94:95], v[38:39], v[70:71] op_sel:[0,0,0] op_sel_hi:[0,1,1]
    v_pk_fma_f32 v[32:33], v[88:89], v[32:33], v[56:57] op_sel:[1,1,0] op_sel_hi:[1,0,1] neg_lo:[1,0,0]
    v_pk_fma_f32 v[34:35], v[90:91], v[34:35], v[58:59] op_sel:[1,1,0] op_sel_hi:[1,0,1] neg_lo:[1,0,0]
    v_pk_fma_f32 v[36:37], v[92:93], v[36:37], v[60:61] op_sel:[1,1,0] op_sel_hi:[1,0,1] neg_lo:[1,0,0]
    v_pk_fma_f32 v[38:39], v[94:95], v[38:39], v[62:63] op_sel:[1,1,0] op_sel_hi:[1,0,1] neg_lo:[1,0,0]
    v_pk_mul_f32 v[40:41], v[96:97], v[32:33] op_sel:[0,0] op_sel_hi:[0,1]
    v_pk_mul_f32 v[42:43], v[98:99], v[34:35] op_sel:[0,0] op_sel_hi:[0,1]
    v_pk_mul_f32 v[44:45], v[100:101], v[36:37] op_sel:[0,0] op_sel_hi:[0,1]
    v_pk_mul_f32 v[46:47], v[102:103], v[38:39] op_sel:[0,0] op_sel_hi:[0,1]
    v_pk_fma_f32 v[72:73], v[96:97], v[32:33], v[40:41] op_sel:[1,1,0] op_sel_hi:[1,0,1] neg_lo:[1,0,0] neg_hi:[1,0,1]
    v_pk_fma_f32 v[74:75], v[98:99], v[34:35], v[42:43] op_sel:[1,1,0] op_sel_hi:[1,0,1] neg_lo:[1,0,0] neg_hi:[1,0,1]
    v_pk_fma_f32 v[76:77], v[100:101], v[36:37], v[44:45] op_sel:[1,1,0] op_sel_hi:[1,0,1] neg_lo:[1,0,0] neg_hi:[1,0,1]
    v_pk_fma_f32 v[78:79], v[102:103], v[38:39], v[46:47] op_sel:[1,1,0] op_sel_hi:[1,0,1] neg_lo:[1,0,0] neg_hi:[1,0,1]
    v_accvgpr_read_b32 v48, a99
    v_accvgpr_read_b32 v50, a103
    v_accvgpr_read_b32 v52, a107
    v_accvgpr_read_b32 v54, a111
    v_accvgpr_read_b32 v49, a115
    v_accvgpr_read_b32 v51, a119
    v_accvgpr_read_b32 v53, a123
    v_accvgpr_read_b32 v55, a127
    v_pk_fma_f32 v[56:57], v[88:89], v[32:33], v[48:49] op_sel:[0,0,0] op_sel_hi:[0,1,1]
    v_pk_fma_f32 v[58:59], v[90:91], v[34:35], v[50:51] op_sel:[0,0,0] op_sel_hi:[0,1,1]
    v_pk_fma_f32 v[60:61], v[92:93], v[36:37], v[52:53] op_sel:[0,0,0] op_sel_hi:[0,1,1]
    v_pk_fma_f32 v[62:63], v[94:95], v[38:39], v[54:55] op_sel:[0,0,0] op_sel_hi:[0,1,1]
    v_pk_fma_f32 v[32:33], v[88:89], v[32:33], v[56:57] op_sel:[1,1,0] op_sel_hi:[1,0,1] neg_lo:[1,0,0]
    v_pk_fma_f32 v[34:35], v[90:91], v[34:35], v[58:59] op_sel:[1,1,0] op_sel_hi:[1,0,1] neg_lo:[1,0,0]
    v_pk_fma_f32 v[36:37], v[92:93], v[36:37], v[60:61] op_sel:[1,1,0] op_sel_hi:[1,0,1] neg_lo:[1,0,0]
    v_pk_fma_f32 v[38:39], v[94:95], v[38:39], v[62:63] op_sel:[1,1,0] op_sel_hi:[1,0,1] neg_lo:[1,0,0]
    v_pk_mul_f32 v[40:41], v[96:97], v[32:33] op_sel:[0,0] op_sel_hi:[0,1]
    v_pk_mul_f32 v[42:43], v[98:99], v[34:35] op_sel:[0,0] op_sel_hi:[0,1]
    v_pk_mul_f32 v[44:45], v[100:101], v[36:37] op_sel:[0,0] op_sel_hi:[0,1]
    v_pk_mul_f32 v[46:47], v[102:103], v[38:39] op_sel:[0,0] op_sel_hi:[0,1]
    v_pk_fma_f32 v[80:81], v[96:97], v[32:33], v[40:41] op_sel:[1,1,0] op_sel_hi:[1,0,1] neg_lo:[1,0,0] neg_hi:[1,0,1]
    v_pk_fma_f32 v[82:83], v[98:99], v[34:35], v[42:43] op_sel:[1,1,0] op_sel_hi:[1,0,1] neg_lo:[1,0,0] neg_hi:[1,0,1]
    v_pk_fma_f32 v[84:85], v[100:101], v[36:37], v[44:45] op_sel:[1,1,0] op_sel_hi:[1,0,1] neg_lo:[1,0,0] neg_hi:[1,0,1]
    v_pk_fma_f32 v[86:87], v[102:103], v[38:39], v[46:47] op_sel:[1,1,0] op_sel_hi:[1,0,1] neg_lo:[1,0,0] neg_hi:[1,0,1]
    v_cvt_pk_bf16_f32 v135, v72, v80
    v_cvt_pk_bf16_f32 v143, v74, v82
    v_cvt_pk_bf16_f32 v151, v76, v84
    v_cvt_pk_bf16_f32 v159, v78, v86
    v_cvt_pk_bf16_f32 v199, v73, v81
    v_cvt_pk_bf16_f32 v207, v75, v83
    v_cvt_pk_bf16_f32 v215, v77, v85
    v_cvt_pk_bf16_f32 v223, v79, v87
    v_accvgpr_read_b32 v64, a128
    v_accvgpr_read_b32 v66, a132
    v_accvgpr_read_b32 v68, a136
    v_accvgpr_read_b32 v70, a140
    v_accvgpr_read_b32 v65, a144
    v_accvgpr_read_b32 v67, a148
    v_accvgpr_read_b32 v69, a152
    v_accvgpr_read_b32 v71, a156
    v_pk_fma_f32 v[56:57], v[88:89], v[32:33], v[64:65] op_sel:[0,0,0] op_sel_hi:[0,1,1]
    v_pk_fma_f32 v[58:59], v[90:91], v[34:35], v[66:67] op_sel:[0,0,0] op_sel_hi:[0,1,1]
    v_pk_fma_f32 v[60:61], v[92:93], v[36:37], v[68:69] op_sel:[0,0,0] op_sel_hi:[0,1,1]
    v_pk_fma_f32 v[62:63], v[94:95], v[38:39], v[70:71] op_sel:[0,0,0] op_sel_hi:[0,1,1]
    v_pk_fma_f32 v[32:33], v[88:89], v[32:33], v[56:57] op_sel:[1,1,0] op_sel_hi:[1,0,1] neg_lo:[1,0,0]
    v_pk_fma_f32 v[34:35], v[90:91], v[34:35], v[58:59] op_sel:[1,1,0] op_sel_hi:[1,0,1] neg_lo:[1,0,0]
    v_pk_fma_f32 v[36:37], v[92:93], v[36:37], v[60:61] op_sel:[1,1,0] op_sel_hi:[1,0,1] neg_lo:[1,0,0]
    v_pk_fma_f32 v[38:39], v[94:95], v[38:39], v[62:63] op_sel:[1,1,0] op_sel_hi:[1,0,1] neg_lo:[1,0,0]
    v_pk_mul_f32 v[40:41], v[96:97], v[32:33] op_sel:[0,0] op_sel_hi:[0,1]
    v_pk_mul_f32 v[42:43], v[98:99], v[34:35] op_sel:[0,0] op_sel_hi:[0,1]
    v_pk_mul_f32 v[44:45], v[100:101], v[36:37] op_sel:[0,0] op_sel_hi:[0,1]
    v_pk_mul_f32 v[46:47], v[102:103], v[38:39] op_sel:[0,0] op_sel_hi:[0,1]
    v_pk_fma_f32 v[72:73], v[96:97], v[32:33], v[40:41] op_sel:[1,1,0] op_sel_hi:[1,0,1] neg_lo:[1,0,0] neg_hi:[1,0,1]
    v_pk_fma_f32 v[74:75], v[98:99], v[34:35], v[42:43] op_sel:[1,1,0] op_sel_hi:[1,0,1] neg_lo:[1,0,0] neg_hi:[1,0,1]
    v_pk_fma_f32 v[76:77], v[100:101], v[36:37], v[44:45] op_sel:[1,1,0] op_sel_hi:[1,0,1] neg_lo:[1,0,0] neg_hi:[1,0,1]
    v_pk_fma_f32 v[78:79], v[102:103], v[38:39], v[46:47] op_sel:[1,1,0] op_sel_hi:[1,0,1] neg_lo:[1,0,0] neg_hi:[1,0,1]
    v_accvgpr_read_b32 v48, a129
    v_accvgpr_read_b32 v50, a133
    v_accvgpr_read_b32 v52, a137
    v_accvgpr_read_b32 v54, a141
    v_accvgpr_read_b32 v49, a145
    v_accvgpr_read_b32 v51, a149
    v_accvgpr_read_b32 v53, a153
    v_accvgpr_read_b32 v55, a157
    v_pk_fma_f32 v[56:57], v[88:89], v[32:33], v[48:49] op_sel:[0,0,0] op_sel_hi:[0,1,1]
    v_pk_fma_f32 v[58:59], v[90:91], v[34:35], v[50:51] op_sel:[0,0,0] op_sel_hi:[0,1,1]
    v_pk_fma_f32 v[60:61], v[92:93], v[36:37], v[52:53] op_sel:[0,0,0] op_sel_hi:[0,1,1]
    v_pk_fma_f32 v[62:63], v[94:95], v[38:39], v[54:55] op_sel:[0,0,0] op_sel_hi:[0,1,1]
    v_pk_fma_f32 v[32:33], v[88:89], v[32:33], v[56:57] op_sel:[1,1,0] op_sel_hi:[1,0,1] neg_lo:[1,0,0]
    v_pk_fma_f32 v[34:35], v[90:91], v[34:35], v[58:59] op_sel:[1,1,0] op_sel_hi:[1,0,1] neg_lo:[1,0,0]
    v_pk_fma_f32 v[36:37], v[92:93], v[36:37], v[60:61] op_sel:[1,1,0] op_sel_hi:[1,0,1] neg_lo:[1,0,0]
    v_pk_fma_f32 v[38:39], v[94:95], v[38:39], v[62:63] op_sel:[1,1,0] op_sel_hi:[1,0,1] neg_lo:[1,0,0]
    v_pk_mul_f32 v[40:41], v[96:97], v[32:33] op_sel:[0,0] op_sel_hi:[0,1]
    v_pk_mul_f32 v[42:43], v[98:99], v[34:35] op_sel:[0,0] op_sel_hi:[0,1]
    v_pk_mul_f32 v[44:45], v[100:101], v[36:37] op_sel:[0,0] op_sel_hi:[0,1]
    v_pk_mul_f32 v[46:47], v[102:103], v[38:39] op_sel:[0,0] op_sel_hi:[0,1]
    v_pk_fma_f32 v[80:81], v[96:97], v[32:33], v[40:41] op_sel:[1,1,0] op_sel_hi:[1,0,1] neg_lo:[1,0,0] neg_hi:[1,0,1]
    v_pk_fma_f32 v[82:83], v[98:99], v[34:35], v[42:43] op_sel:[1,1,0] op_sel_hi:[1,0,1] neg_lo:[1,0,0] neg_hi:[1,0,1]
    v_pk_fma_f32 v[84:85], v[100:101], v[36:37], v[44:45] op_sel:[1,1,0] op_sel_hi:[1,0,1] neg_lo:[1,0,0] neg_hi:[1,0,1]
    v_pk_fma_f32 v[86:87], v[102:103], v[38:39], v[46:47] op_sel:[1,1,0] op_sel_hi:[1,0,1] neg_lo:[1,0,0] neg_hi:[1,0,1]
    v_cvt_pk_bf16_f32 v160, v72, v80
    v_cvt_pk_bf16_f32 v168, v74, v82
    v_cvt_pk_bf16_f32 v176, v76, v84
    v_cvt_pk_bf16_f32 v184, v78, v86
    v_cvt_pk_bf16_f32 v224, v73, v81
    v_cvt_pk_bf16_f32 v232, v75, v83
    v_cvt_pk_bf16_f32 v240, v77, v85
    v_cvt_pk_bf16_f32 v248, v79, v87
    v_accvgpr_read_b32 v64, a130
    v_accvgpr_read_b32 v66, a134
    v_accvgpr_read_b32 v68, a138
    v_accvgpr_read_b32 v70, a142
    v_accvgpr_read_b32 v65, a146
    v_accvgpr_read_b32 v67, a150
    v_accvgpr_read_b32 v69, a154
    v_accvgpr_read_b32 v71, a158
    v_pk_fma_f32 v[56:57], v[88:89], v[32:33], v[64:65] op_sel:[0,0,0] op_sel_hi:[0,1,1]
    v_pk_fma_f32 v[58:59], v[90:91], v[34:35], v[66:67] op_sel:[0,0,0] op_sel_hi:[0,1,1]
    v_pk_fma_f32 v[60:61], v[92:93], v[36:37], v[68:69] op_sel:[0,0,0] op_sel_hi:[0,1,1]
    v_pk_fma_f32 v[62:63], v[94:95], v[38:39], v[70:71] op_sel:[0,0,0] op_sel_hi:[0,1,1]
    v_pk_fma_f32 v[32:33], v[88:89], v[32:33], v[56:57] op_sel:[1,1,0] op_sel_hi:[1,0,1] neg_lo:[1,0,0]
    v_pk_fma_f32 v[34:35], v[90:91], v[34:35], v[58:59] op_sel:[1,1,0] op_sel_hi:[1,0,1] neg_lo:[1,0,0]
    v_pk_fma_f32 v[36:37], v[92:93], v[36:37], v[60:61] op_sel:[1,1,0] op_sel_hi:[1,0,1] neg_lo:[1,0,0]
    v_pk_fma_f32 v[38:39], v[94:95], v[38:39], v[62:63] op_sel:[1,1,0] op_sel_hi:[1,0,1] neg_lo:[1,0,0]
    v_pk_mul_f32 v[40:41], v[96:97], v[32:33] op_sel:[0,0] op_sel_hi:[0,1]
    v_pk_mul_f32 v[42:43], v[98:99], v[34:35] op_sel:[0,0] op_sel_hi:[0,1]
    v_pk_mul_f32 v[44:45], v[100:101], v[36:37] op_sel:[0,0] op_sel_hi:[0,1]
    v_pk_mul_f32 v[46:47], v[102:103], v[38:39] op_sel:[0,0] op_sel_hi:[0,1]
    v_pk_fma_f32 v[72:73], v[96:97], v[32:33], v[40:41] op_sel:[1,1,0] op_sel_hi:[1,0,1] neg_lo:[1,0,0] neg_hi:[1,0,1]
    v_pk_fma_f32 v[74:75], v[98:99], v[34:35], v[42:43] op_sel:[1,1,0] op_sel_hi:[1,0,1] neg_lo:[1,0,0] neg_hi:[1,0,1]
    v_pk_fma_f32 v[76:77], v[100:101], v[36:37], v[44:45] op_sel:[1,1,0] op_sel_hi:[1,0,1] neg_lo:[1,0,0] neg_hi:[1,0,1]
    v_pk_fma_f32 v[78:79], v[102:103], v[38:39], v[46:47] op_sel:[1,1,0] op_sel_hi:[1,0,1] neg_lo:[1,0,0] neg_hi:[1,0,1]
    v_accvgpr_read_b32 v48, a131
    v_accvgpr_read_b32 v50, a135
    v_accvgpr_read_b32 v52, a139
    v_accvgpr_read_b32 v54, a143
    v_accvgpr_read_b32 v49, a147
    v_accvgpr_read_b32 v51, a151
    v_accvgpr_read_b32 v53, a155
    v_accvgpr_read_b32 v55, a159
    v_pk_fma_f32 v[56:57], v[88:89], v[32:33], v[48:49] op_sel:[0,0,0] op_sel_hi:[0,1,1]
    v_pk_fma_f32 v[58:59], v[90:91], v[34:35], v[50:51] op_sel:[0,0,0] op_sel_hi:[0,1,1]
    v_pk_fma_f32 v[60:61], v[92:93], v[36:37], v[52:53] op_sel:[0,0,0] op_sel_hi:[0,1,1]
    v_pk_fma_f32 v[62:63], v[94:95], v[38:39], v[54:55] op_sel:[0,0,0] op_sel_hi:[0,1,1]
    v_pk_fma_f32 v[32:33], v[88:89], v[32:33], v[56:57] op_sel:[1,1,0] op_sel_hi:[1,0,1] neg_lo:[1,0,0]
    v_pk_fma_f32 v[34:35], v[90:91], v[34:35], v[58:59] op_sel:[1,1,0] op_sel_hi:[1,0,1] neg_lo:[1,0,0]
    v_pk_fma_f32 v[36:37], v[92:93], v[36:37], v[60:61] op_sel:[1,1,0] op_sel_hi:[1,0,1] neg_lo:[1,0,0]
    v_pk_fma_f32 v[38:39], v[94:95], v[38:39], v[62:63] op_sel:[1,1,0] op_sel_hi:[1,0,1] neg_lo:[1,0,0]
    v_pk_mul_f32 v[40:41], v[96:97], v[32:33] op_sel:[0,0] op_sel_hi:[0,1]
    v_pk_mul_f32 v[42:43], v[98:99], v[34:35] op_sel:[0,0] op_sel_hi:[0,1]
    v_pk_mul_f32 v[44:45], v[100:101], v[36:37] op_sel:[0,0] op_sel_hi:[0,1]
    v_pk_mul_f32 v[46:47], v[102:103], v[38:39] op_sel:[0,0] op_sel_hi:[0,1]
    v_pk_fma_f32 v[80:81], v[96:97], v[32:33], v[40:41] op_sel:[1,1,0] op_sel_hi:[1,0,1] neg_lo:[1,0,0] neg_hi:[1,0,1]
    v_pk_fma_f32 v[82:83], v[98:99], v[34:35], v[42:43] op_sel:[1,1,0] op_sel_hi:[1,0,1] neg_lo:[1,0,0] neg_hi:[1,0,1]
    v_pk_fma_f32 v[84:85], v[100:101], v[36:37], v[44:45] op_sel:[1,1,0] op_sel_hi:[1,0,1] neg_lo:[1,0,0] neg_hi:[1,0,1]
    v_pk_fma_f32 v[86:87], v[102:103], v[38:39], v[46:47] op_sel:[1,1,0] op_sel_hi:[1,0,1] neg_lo:[1,0,0] neg_hi:[1,0,1]
    v_cvt_pk_bf16_f32 v161, v72, v80
    v_cvt_pk_bf16_f32 v169, v74, v82
    v_cvt_pk_bf16_f32 v177, v76, v84
    v_cvt_pk_bf16_f32 v185, v78, v86
    v_cvt_pk_bf16_f32 v225, v73, v81
    v_cvt_pk_bf16_f32 v233, v75, v83
    v_cvt_pk_bf16_f32 v241, v77, v85
    v_cvt_pk_bf16_f32 v249, v79, v87
    v_accvgpr_read_b32 v64, a160
    v_accvgpr_read_b32 v66, a164
    v_accvgpr_read_b32 v68, a168
    v_accvgpr_read_b32 v70, a172
    v_accvgpr_read_b32 v65, a176
    v_accvgpr_read_b32 v67, a180
    v_accvgpr_read_b32 v69, a184
    v_accvgpr_read_b32 v71, a188
    v_pk_fma_f32 v[56:57], v[88:89], v[32:33], v[64:65] op_sel:[0,0,0] op_sel_hi:[0,1,1]
    v_pk_fma_f32 v[58:59], v[90:91], v[34:35], v[66:67] op_sel:[0,0,0] op_sel_hi:[0,1,1]
    v_pk_fma_f32 v[60:61], v[92:93], v[36:37], v[68:69] op_sel:[0,0,0] op_sel_hi:[0,1,1]
    v_pk_fma_f32 v[62:63], v[94:95], v[38:39], v[70:71] op_sel:[0,0,0] op_sel_hi:[0,1,1]
    v_pk_fma_f32 v[32:33], v[88:89], v[32:33], v[56:57] op_sel:[1,1,0] op_sel_hi:[1,0,1] neg_lo:[1,0,0]
    v_pk_fma_f32 v[34:35], v[90:91], v[34:35], v[58:59] op_sel:[1,1,0] op_sel_hi:[1,0,1] neg_lo:[1,0,0]
    v_pk_fma_f32 v[36:37], v[92:93], v[36:37], v[60:61] op_sel:[1,1,0] op_sel_hi:[1,0,1] neg_lo:[1,0,0]
    v_pk_fma_f32 v[38:39], v[94:95], v[38:39], v[62:63] op_sel:[1,1,0] op_sel_hi:[1,0,1] neg_lo:[1,0,0]
    v_pk_mul_f32 v[40:41], v[96:97], v[32:33] op_sel:[0,0] op_sel_hi:[0,1]
    v_pk_mul_f32 v[42:43], v[98:99], v[34:35] op_sel:[0,0] op_sel_hi:[0,1]
    v_pk_mul_f32 v[44:45], v[100:101], v[36:37] op_sel:[0,0] op_sel_hi:[0,1]
    v_pk_mul_f32 v[46:47], v[102:103], v[38:39] op_sel:[0,0] op_sel_hi:[0,1]
    v_pk_fma_f32 v[72:73], v[96:97], v[32:33], v[40:41] op_sel:[1,1,0] op_sel_hi:[1,0,1] neg_lo:[1,0,0] neg_hi:[1,0,1]
    v_pk_fma_f32 v[74:75], v[98:99], v[34:35], v[42:43] op_sel:[1,1,0] op_sel_hi:[1,0,1] neg_lo:[1,0,0] neg_hi:[1,0,1]
    v_pk_fma_f32 v[76:77], v[100:101], v[36:37], v[44:45] op_sel:[1,1,0] op_sel_hi:[1,0,1] neg_lo:[1,0,0] neg_hi:[1,0,1]
    v_pk_fma_f32 v[78:79], v[102:103], v[38:39], v[46:47] op_sel:[1,1,0] op_sel_hi:[1,0,1] neg_lo:[1,0,0] neg_hi:[1,0,1]
    v_accvgpr_read_b32 v48, a161
    v_accvgpr_read_b32 v50, a165
    v_accvgpr_read_b32 v52, a169
    v_accvgpr_read_b32 v54, a173
    v_accvgpr_read_b32 v49, a177
    v_accvgpr_read_b32 v51, a181
    v_accvgpr_read_b32 v53, a185
    v_accvgpr_read_b32 v55, a189
    v_pk_fma_f32 v[56:57], v[88:89], v[32:33], v[48:49] op_sel:[0,0,0] op_sel_hi:[0,1,1]
    v_pk_fma_f32 v[58:59], v[90:91], v[34:35], v[50:51] op_sel:[0,0,0] op_sel_hi:[0,1,1]
    v_pk_fma_f32 v[60:61], v[92:93], v[36:37], v[52:53] op_sel:[0,0,0] op_sel_hi:[0,1,1]
    v_pk_fma_f32 v[62:63], v[94:95], v[38:39], v[54:55] op_sel:[0,0,0] op_sel_hi:[0,1,1]
    v_pk_fma_f32 v[32:33], v[88:89], v[32:33], v[56:57] op_sel:[1,1,0] op_sel_hi:[1,0,1] neg_lo:[1,0,0]
    v_pk_fma_f32 v[34:35], v[90:91], v[34:35], v[58:59] op_sel:[1,1,0] op_sel_hi:[1,0,1] neg_lo:[1,0,0]
    v_pk_fma_f32 v[36:37], v[92:93], v[36:37], v[60:61] op_sel:[1,1,0] op_sel_hi:[1,0,1] neg_lo:[1,0,0]
    v_pk_fma_f32 v[38:39], v[94:95], v[38:39], v[62:63] op_sel:[1,1,0] op_sel_hi:[1,0,1] neg_lo:[1,0,0]
    v_pk_mul_f32 v[40:41], v[96:97], v[32:33] op_sel:[0,0] op_sel_hi:[0,1]
    v_pk_mul_f32 v[42:43], v[98:99], v[34:35] op_sel:[0,0] op_sel_hi:[0,1]
    v_pk_mul_f32 v[44:45], v[100:101], v[36:37] op_sel:[0,0] op_sel_hi:[0,1]
    v_pk_mul_f32 v[46:47], v[102:103], v[38:39] op_sel:[0,0] op_sel_hi:[0,1]
    v_pk_fma_f32 v[80:81], v[96:97], v[32:33], v[40:41] op_sel:[1,1,0] op_sel_hi:[1,0,1] neg_lo:[1,0,0] neg_hi:[1,0,1]
    v_pk_fma_f32 v[82:83], v[98:99], v[34:35], v[42:43] op_sel:[1,1,0] op_sel_hi:[1,0,1] neg_lo:[1,0,0] neg_hi:[1,0,1]
    v_pk_fma_f32 v[84:85], v[100:101], v[36:37], v[44:45] op_sel:[1,1,0] op_sel_hi:[1,0,1] neg_lo:[1,0,0] neg_hi:[1,0,1]
    v_pk_fma_f32 v[86:87], v[102:103], v[38:39], v[46:47] op_sel:[1,1,0] op_sel_hi:[1,0,1] neg_lo:[1,0,0] neg_hi:[1,0,1]
    v_cvt_pk_bf16_f32 v162, v72, v80
    v_cvt_pk_bf16_f32 v170, v74, v82
    v_cvt_pk_bf16_f32 v178, v76, v84
    v_cvt_pk_bf16_f32 v186, v78, v86
    v_cvt_pk_bf16_f32 v226, v73, v81
    v_cvt_pk_bf16_f32 v234, v75, v83
    v_cvt_pk_bf16_f32 v242, v77, v85
    v_cvt_pk_bf16_f32 v250, v79, v87
    v_accvgpr_read_b32 v64, a162
    v_accvgpr_read_b32 v66, a166
    v_accvgpr_read_b32 v68, a170
    v_accvgpr_read_b32 v70, a174
    v_accvgpr_read_b32 v65, a178
    v_accvgpr_read_b32 v67, a182
    v_accvgpr_read_b32 v69, a186
    v_accvgpr_read_b32 v71, a190
    v_pk_fma_f32 v[56:57], v[88:89], v[32:33], v[64:65] op_sel:[0,0,0] op_sel_hi:[0,1,1]
    v_pk_fma_f32 v[58:59], v[90:91], v[34:35], v[66:67] op_sel:[0,0,0] op_sel_hi:[0,1,1]
    v_pk_fma_f32 v[60:61], v[92:93], v[36:37], v[68:69] op_sel:[0,0,0] op_sel_hi:[0,1,1]
    v_pk_fma_f32 v[62:63], v[94:95], v[38:39], v[70:71] op_sel:[0,0,0] op_sel_hi:[0,1,1]
    v_pk_fma_f32 v[32:33], v[88:89], v[32:33], v[56:57] op_sel:[1,1,0] op_sel_hi:[1,0,1] neg_lo:[1,0,0]
    v_pk_fma_f32 v[34:35], v[90:91], v[34:35], v[58:59] op_sel:[1,1,0] op_sel_hi:[1,0,1] neg_lo:[1,0,0]
    v_pk_fma_f32 v[36:37], v[92:93], v[36:37], v[60:61] op_sel:[1,1,0] op_sel_hi:[1,0,1] neg_lo:[1,0,0]
    v_pk_fma_f32 v[38:39], v[94:95], v[38:39], v[62:63] op_sel:[1,1,0] op_sel_hi:[1,0,1] neg_lo:[1,0,0]
    v_pk_mul_f32 v[40:41], v[96:97], v[32:33] op_sel:[0,0] op_sel_hi:[0,1]
    v_pk_mul_f32 v[42:43], v[98:99], v[34:35] op_sel:[0,0] op_sel_hi:[0,1]
    v_pk_mul_f32 v[44:45], v[100:101], v[36:37] op_sel:[0,0] op_sel_hi:[0,1]
    v_pk_mul_f32 v[46:47], v[102:103], v[38:39] op_sel:[0,0] op_sel_hi:[0,1]
    v_pk_fma_f32 v[72:73], v[96:97], v[32:33], v[40:41] op_sel:[1,1,0] op_sel_hi:[1,0,1] neg_lo:[1,0,0] neg_hi:[1,0,1]
    v_pk_fma_f32 v[74:75], v[98:99], v[34:35], v[42:43] op_sel:[1,1,0] op_sel_hi:[1,0,1] neg_lo:[1,0,0] neg_hi:[1,0,1]
    v_pk_fma_f32 v[76:77], v[100:101], v[36:37], v[44:45] op_sel:[1,1,0] op_sel_hi:[1,0,1] neg_lo:[1,0,0] neg_hi:[1,0,1]
    v_pk_fma_f32 v[78:79], v[102:103], v[38:39], v[46:47] op_sel:[1,1,0] op_sel_hi:[1,0,1] neg_lo:[1,0,0] neg_hi:[1,0,1]
    v_accvgpr_read_b32 v48, a163
    v_accvgpr_read_b32 v50, a167
    v_accvgpr_read_b32 v52, a171
    v_accvgpr_read_b32 v54, a175
    v_accvgpr_read_b32 v49, a179
    v_accvgpr_read_b32 v51, a183
    v_accvgpr_read_b32 v53, a187
    v_accvgpr_read_b32 v55, a191
    v_pk_fma_f32 v[56:57], v[88:89], v[32:33], v[48:49] op_sel:[0,0,0] op_sel_hi:[0,1,1]
    v_pk_fma_f32 v[58:59], v[90:91], v[34:35], v[50:51] op_sel:[0,0,0] op_sel_hi:[0,1,1]
    v_pk_fma_f32 v[60:61], v[92:93], v[36:37], v[52:53] op_sel:[0,0,0] op_sel_hi:[0,1,1]
    v_pk_fma_f32 v[62:63], v[94:95], v[38:39], v[54:55] op_sel:[0,0,0] op_sel_hi:[0,1,1]
    v_pk_fma_f32 v[32:33], v[88:89], v[32:33], v[56:57] op_sel:[1,1,0] op_sel_hi:[1,0,1] neg_lo:[1,0,0]
    v_pk_fma_f32 v[34:35], v[90:91], v[34:35], v[58:59] op_sel:[1,1,0] op_sel_hi:[1,0,1] neg_lo:[1,0,0]
    v_pk_fma_f32 v[36:37], v[92:93], v[36:37], v[60:61] op_sel:[1,1,0] op_sel_hi:[1,0,1] neg_lo:[1,0,0]
    v_pk_fma_f32 v[38:39], v[94:95], v[38:39], v[62:63] op_sel:[1,1,0] op_sel_hi:[1,0,1] neg_lo:[1,0,0]
    v_pk_mul_f32 v[40:41], v[96:97], v[32:33] op_sel:[0,0] op_sel_hi:[0,1]
    v_pk_mul_f32 v[42:43], v[98:99], v[34:35] op_sel:[0,0] op_sel_hi:[0,1]
    v_pk_mul_f32 v[44:45], v[100:101], v[36:37] op_sel:[0,0] op_sel_hi:[0,1]
    v_pk_mul_f32 v[46:47], v[102:103], v[38:39] op_sel:[0,0] op_sel_hi:[0,1]
    v_pk_fma_f32 v[80:81], v[96:97], v[32:33], v[40:41] op_sel:[1,1,0] op_sel_hi:[1,0,1] neg_lo:[1,0,0] neg_hi:[1,0,1]
    v_pk_fma_f32 v[82:83], v[98:99], v[34:35], v[42:43] op_sel:[1,1,0] op_sel_hi:[1,0,1] neg_lo:[1,0,0] neg_hi:[1,0,1]
    v_pk_fma_f32 v[84:85], v[100:101], v[36:37], v[44:45] op_sel:[1,1,0] op_sel_hi:[1,0,1] neg_lo:[1,0,0] neg_hi:[1,0,1]
    v_pk_fma_f32 v[86:87], v[102:103], v[38:39], v[46:47] op_sel:[1,1,0] op_sel_hi:[1,0,1] neg_lo:[1,0,0] neg_hi:[1,0,1]
    v_cvt_pk_bf16_f32 v163, v72, v80
    v_cvt_pk_bf16_f32 v171, v74, v82
    v_cvt_pk_bf16_f32 v179, v76, v84
    v_cvt_pk_bf16_f32 v187, v78, v86
    v_cvt_pk_bf16_f32 v227, v73, v81
    v_cvt_pk_bf16_f32 v235, v75, v83
    v_cvt_pk_bf16_f32 v243, v77, v85
    v_cvt_pk_bf16_f32 v251, v79, v87
    v_accvgpr_read_b32 v64, a192
    v_accvgpr_read_b32 v66, a196
    v_accvgpr_read_b32 v68, a200
    v_accvgpr_read_b32 v70, a204
    v_accvgpr_read_b32 v65, a208
    v_accvgpr_read_b32 v67, a212
    v_accvgpr_read_b32 v69, a216
    v_accvgpr_read_b32 v71, a220
    v_pk_fma_f32 v[56:57], v[88:89], v[32:33], v[64:65] op_sel:[0,0,0] op_sel_hi:[0,1,1]
    v_pk_fma_f32 v[58:59], v[90:91], v[34:35], v[66:67] op_sel:[0,0,0] op_sel_hi:[0,1,1]
    v_pk_fma_f32 v[60:61], v[92:93], v[36:37], v[68:69] op_sel:[0,0,0] op_sel_hi:[0,1,1]
    v_pk_fma_f32 v[62:63], v[94:95], v[38:39], v[70:71] op_sel:[0,0,0] op_sel_hi:[0,1,1]
    v_pk_fma_f32 v[32:33], v[88:89], v[32:33], v[56:57] op_sel:[1,1,0] op_sel_hi:[1,0,1] neg_lo:[1,0,0]
    v_pk_fma_f32 v[34:35], v[90:91], v[34:35], v[58:59] op_sel:[1,1,0] op_sel_hi:[1,0,1] neg_lo:[1,0,0]
    v_pk_fma_f32 v[36:37], v[92:93], v[36:37], v[60:61] op_sel:[1,1,0] op_sel_hi:[1,0,1] neg_lo:[1,0,0]
    v_pk_fma_f32 v[38:39], v[94:95], v[38:39], v[62:63] op_sel:[1,1,0] op_sel_hi:[1,0,1] neg_lo:[1,0,0]
    v_pk_mul_f32 v[40:41], v[96:97], v[32:33] op_sel:[0,0] op_sel_hi:[0,1]
    v_pk_mul_f32 v[42:43], v[98:99], v[34:35] op_sel:[0,0] op_sel_hi:[0,1]
    v_pk_mul_f32 v[44:45], v[100:101], v[36:37] op_sel:[0,0] op_sel_hi:[0,1]
    v_pk_mul_f32 v[46:47], v[102:103], v[38:39] op_sel:[0,0] op_sel_hi:[0,1]
    v_pk_fma_f32 v[72:73], v[96:97], v[32:33], v[40:41] op_sel:[1,1,0] op_sel_hi:[1,0,1] neg_lo:[1,0,0] neg_hi:[1,0,1]
    v_pk_fma_f32 v[74:75], v[98:99], v[34:35], v[42:43] op_sel:[1,1,0] op_sel_hi:[1,0,1] neg_lo:[1,0,0] neg_hi:[1,0,1]
    v_pk_fma_f32 v[76:77], v[100:101], v[36:37], v[44:45] op_sel:[1,1,0] op_sel_hi:[1,0,1] neg_lo:[1,0,0] neg_hi:[1,0,1]
    v_pk_fma_f32 v[78:79], v[102:103], v[38:39], v[46:47] op_sel:[1,1,0] op_sel_hi:[1,0,1] neg_lo:[1,0,0] neg_hi:[1,0,1]
    v_accvgpr_read_b32 v48, a193
    v_accvgpr_read_b32 v50, a197
    v_accvgpr_read_b32 v52, a201
    v_accvgpr_read_b32 v54, a205
    v_accvgpr_read_b32 v49, a209
    v_accvgpr_read_b32 v51, a213
    v_accvgpr_read_b32 v53, a217
    v_accvgpr_read_b32 v55, a221
    v_pk_fma_f32 v[56:57], v[88:89], v[32:33], v[48:49] op_sel:[0,0,0] op_sel_hi:[0,1,1]
    v_pk_fma_f32 v[58:59], v[90:91], v[34:35], v[50:51] op_sel:[0,0,0] op_sel_hi:[0,1,1]
    v_pk_fma_f32 v[60:61], v[92:93], v[36:37], v[52:53] op_sel:[0,0,0] op_sel_hi:[0,1,1]
    v_pk_fma_f32 v[62:63], v[94:95], v[38:39], v[54:55] op_sel:[0,0,0] op_sel_hi:[0,1,1]
    v_pk_fma_f32 v[32:33], v[88:89], v[32:33], v[56:57] op_sel:[1,1,0] op_sel_hi:[1,0,1] neg_lo:[1,0,0]
    v_pk_fma_f32 v[34:35], v[90:91], v[34:35], v[58:59] op_sel:[1,1,0] op_sel_hi:[1,0,1] neg_lo:[1,0,0]
    v_pk_fma_f32 v[36:37], v[92:93], v[36:37], v[60:61] op_sel:[1,1,0] op_sel_hi:[1,0,1] neg_lo:[1,0,0]
    v_pk_fma_f32 v[38:39], v[94:95], v[38:39], v[62:63] op_sel:[1,1,0] op_sel_hi:[1,0,1] neg_lo:[1,0,0]
    v_pk_mul_f32 v[40:41], v[96:97], v[32:33] op_sel:[0,0] op_sel_hi:[0,1]
    v_pk_mul_f32 v[42:43], v[98:99], v[34:35] op_sel:[0,0] op_sel_hi:[0,1]
    v_pk_mul_f32 v[44:45], v[100:101], v[36:37] op_sel:[0,0] op_sel_hi:[0,1]
    v_pk_mul_f32 v[46:47], v[102:103], v[38:39] op_sel:[0,0] op_sel_hi:[0,1]
    v_pk_fma_f32 v[80:81], v[96:97], v[32:33], v[40:41] op_sel:[1,1,0] op_sel_hi:[1,0,1] neg_lo:[1,0,0] neg_hi:[1,0,1]
    v_pk_fma_f32 v[82:83], v[98:99], v[34:35], v[42:43] op_sel:[1,1,0] op_sel_hi:[1,0,1] neg_lo:[1,0,0] neg_hi:[1,0,1]
    v_pk_fma_f32 v[84:85], v[100:101], v[36:37], v[44:45] op_sel:[1,1,0] op_sel_hi:[1,0,1] neg_lo:[1,0,0] neg_hi:[1,0,1]
    v_pk_fma_f32 v[86:87], v[102:103], v[38:39], v[46:47] op_sel:[1,1,0] op_sel_hi:[1,0,1] neg_lo:[1,0,0] neg_hi:[1,0,1]
    v_cvt_pk_bf16_f32 v164, v72, v80
    v_cvt_pk_bf16_f32 v172, v74, v82
    v_cvt_pk_bf16_f32 v180, v76, v84
    v_cvt_pk_bf16_f32 v188, v78, v86
    v_cvt_pk_bf16_f32 v228, v73, v81
    v_cvt_pk_bf16_f32 v236, v75, v83
    v_cvt_pk_bf16_f32 v244, v77, v85
    v_cvt_pk_bf16_f32 v252, v79, v87
    v_accvgpr_read_b32 v64, a194
    v_accvgpr_read_b32 v66, a198
    v_accvgpr_read_b32 v68, a202
    v_accvgpr_read_b32 v70, a206
    v_accvgpr_read_b32 v65, a210
    v_accvgpr_read_b32 v67, a214
    v_accvgpr_read_b32 v69, a218
    v_accvgpr_read_b32 v71, a222
    v_pk_fma_f32 v[56:57], v[88:89], v[32:33], v[64:65] op_sel:[0,0,0] op_sel_hi:[0,1,1]
    v_pk_fma_f32 v[58:59], v[90:91], v[34:35], v[66:67] op_sel:[0,0,0] op_sel_hi:[0,1,1]
    v_pk_fma_f32 v[60:61], v[92:93], v[36:37], v[68:69] op_sel:[0,0,0] op_sel_hi:[0,1,1]
    v_pk_fma_f32 v[62:63], v[94:95], v[38:39], v[70:71] op_sel:[0,0,0] op_sel_hi:[0,1,1]
    v_pk_fma_f32 v[32:33], v[88:89], v[32:33], v[56:57] op_sel:[1,1,0] op_sel_hi:[1,0,1] neg_lo:[1,0,0]
    v_pk_fma_f32 v[34:35], v[90:91], v[34:35], v[58:59] op_sel:[1,1,0] op_sel_hi:[1,0,1] neg_lo:[1,0,0]
    v_pk_fma_f32 v[36:37], v[92:93], v[36:37], v[60:61] op_sel:[1,1,0] op_sel_hi:[1,0,1] neg_lo:[1,0,0]
    v_pk_fma_f32 v[38:39], v[94:95], v[38:39], v[62:63] op_sel:[1,1,0] op_sel_hi:[1,0,1] neg_lo:[1,0,0]
    v_pk_mul_f32 v[40:41], v[96:97], v[32:33] op_sel:[0,0] op_sel_hi:[0,1]
    v_pk_mul_f32 v[42:43], v[98:99], v[34:35] op_sel:[0,0] op_sel_hi:[0,1]
    v_pk_mul_f32 v[44:45], v[100:101], v[36:37] op_sel:[0,0] op_sel_hi:[0,1]
    v_pk_mul_f32 v[46:47], v[102:103], v[38:39] op_sel:[0,0] op_sel_hi:[0,1]
    v_pk_fma_f32 v[72:73], v[96:97], v[32:33], v[40:41] op_sel:[1,1,0] op_sel_hi:[1,0,1] neg_lo:[1,0,0] neg_hi:[1,0,1]
    v_pk_fma_f32 v[74:75], v[98:99], v[34:35], v[42:43] op_sel:[1,1,0] op_sel_hi:[1,0,1] neg_lo:[1,0,0] neg_hi:[1,0,1]
    v_pk_fma_f32 v[76:77], v[100:101], v[36:37], v[44:45] op_sel:[1,1,0] op_sel_hi:[1,0,1] neg_lo:[1,0,0] neg_hi:[1,0,1]
    v_pk_fma_f32 v[78:79], v[102:103], v[38:39], v[46:47] op_sel:[1,1,0] op_sel_hi:[1,0,1] neg_lo:[1,0,0] neg_hi:[1,0,1]
    v_accvgpr_read_b32 v48, a195
    v_accvgpr_read_b32 v50, a199
    v_accvgpr_read_b32 v52, a203
    v_accvgpr_read_b32 v54, a207
    v_accvgpr_read_b32 v49, a211
    v_accvgpr_read_b32 v51, a215
    v_accvgpr_read_b32 v53, a219
    v_accvgpr_read_b32 v55, a223
    v_pk_fma_f32 v[56:57], v[88:89], v[32:33], v[48:49] op_sel:[0,0,0] op_sel_hi:[0,1,1]
    v_pk_fma_f32 v[58:59], v[90:91], v[34:35], v[50:51] op_sel:[0,0,0] op_sel_hi:[0,1,1]
    v_pk_fma_f32 v[60:61], v[92:93], v[36:37], v[52:53] op_sel:[0,0,0] op_sel_hi:[0,1,1]
    v_pk_fma_f32 v[62:63], v[94:95], v[38:39], v[54:55] op_sel:[0,0,0] op_sel_hi:[0,1,1]
    v_pk_fma_f32 v[32:33], v[88:89], v[32:33], v[56:57] op_sel:[1,1,0] op_sel_hi:[1,0,1] neg_lo:[1,0,0]
    v_pk_fma_f32 v[34:35], v[90:91], v[34:35], v[58:59] op_sel:[1,1,0] op_sel_hi:[1,0,1] neg_lo:[1,0,0]
    v_pk_fma_f32 v[36:37], v[92:93], v[36:37], v[60:61] op_sel:[1,1,0] op_sel_hi:[1,0,1] neg_lo:[1,0,0]
    v_pk_fma_f32 v[38:39], v[94:95], v[38:39], v[62:63] op_sel:[1,1,0] op_sel_hi:[1,0,1] neg_lo:[1,0,0]
    v_pk_mul_f32 v[40:41], v[96:97], v[32:33] op_sel:[0,0] op_sel_hi:[0,1]
    v_pk_mul_f32 v[42:43], v[98:99], v[34:35] op_sel:[0,0] op_sel_hi:[0,1]
    v_pk_mul_f32 v[44:45], v[100:101], v[36:37] op_sel:[0,0] op_sel_hi:[0,1]
    v_pk_mul_f32 v[46:47], v[102:103], v[38:39] op_sel:[0,0] op_sel_hi:[0,1]
    v_pk_fma_f32 v[80:81], v[96:97], v[32:33], v[40:41] op_sel:[1,1,0] op_sel_hi:[1,0,1] neg_lo:[1,0,0] neg_hi:[1,0,1]
    v_pk_fma_f32 v[82:83], v[98:99], v[34:35], v[42:43] op_sel:[1,1,0] op_sel_hi:[1,0,1] neg_lo:[1,0,0] neg_hi:[1,0,1]
    v_pk_fma_f32 v[84:85], v[100:101], v[36:37], v[44:45] op_sel:[1,1,0] op_sel_hi:[1,0,1] neg_lo:[1,0,0] neg_hi:[1,0,1]
    v_pk_fma_f32 v[86:87], v[102:103], v[38:39], v[46:47] op_sel:[1,1,0] op_sel_hi:[1,0,1] neg_lo:[1,0,0] neg_hi:[1,0,1]
    v_cvt_pk_bf16_f32 v165, v72, v80
    v_cvt_pk_bf16_f32 v173, v74, v82
    v_cvt_pk_bf16_f32 v181, v76, v84
    v_cvt_pk_bf16_f32 v189, v78, v86
    v_cvt_pk_bf16_f32 v229, v73, v81
    v_cvt_pk_bf16_f32 v237, v75, v83
    v_cvt_pk_bf16_f32 v245, v77, v85
    v_cvt_pk_bf16_f32 v253, v79, v87
    v_accvgpr_read_b32 v64, a224
    v_accvgpr_read_b32 v66, a228
    v_accvgpr_read_b32 v68, a232
    v_accvgpr_read_b32 v70, a236
    v_accvgpr_read_b32 v65, a240
    v_accvgpr_read_b32 v67, a244
    v_accvgpr_read_b32 v69, a248
    v_accvgpr_read_b32 v71, a252
    v_pk_fma_f32 v[56:57], v[88:89], v[32:33], v[64:65] op_sel:[0,0,0] op_sel_hi:[0,1,1]
    v_pk_fma_f32 v[58:59], v[90:91], v[34:35], v[66:67] op_sel:[0,0,0] op_sel_hi:[0,1,1]
    v_pk_fma_f32 v[60:61], v[92:93], v[36:37], v[68:69] op_sel:[0,0,0] op_sel_hi:[0,1,1]
    v_pk_fma_f32 v[62:63], v[94:95], v[38:39], v[70:71] op_sel:[0,0,0] op_sel_hi:[0,1,1]
    v_pk_fma_f32 v[32:33], v[88:89], v[32:33], v[56:57] op_sel:[1,1,0] op_sel_hi:[1,0,1] neg_lo:[1,0,0]
    v_pk_fma_f32 v[34:35], v[90:91], v[34:35], v[58:59] op_sel:[1,1,0] op_sel_hi:[1,0,1] neg_lo:[1,0,0]
    v_pk_fma_f32 v[36:37], v[92:93], v[36:37], v[60:61] op_sel:[1,1,0] op_sel_hi:[1,0,1] neg_lo:[1,0,0]
    v_pk_fma_f32 v[38:39], v[94:95], v[38:39], v[62:63] op_sel:[1,1,0] op_sel_hi:[1,0,1] neg_lo:[1,0,0]
    v_pk_mul_f32 v[40:41], v[96:97], v[32:33] op_sel:[0,0] op_sel_hi:[0,1]
    v_pk_mul_f32 v[42:43], v[98:99], v[34:35] op_sel:[0,0] op_sel_hi:[0,1]
    v_pk_mul_f32 v[44:45], v[100:101], v[36:37] op_sel:[0,0] op_sel_hi:[0,1]
    v_pk_mul_f32 v[46:47], v[102:103], v[38:39] op_sel:[0,0] op_sel_hi:[0,1]
    v_pk_fma_f32 v[72:73], v[96:97], v[32:33], v[40:41] op_sel:[1,1,0] op_sel_hi:[1,0,1] neg_lo:[1,0,0] neg_hi:[1,0,1]
    v_pk_fma_f32 v[74:75], v[98:99], v[34:35], v[42:43] op_sel:[1,1,0] op_sel_hi:[1,0,1] neg_lo:[1,0,0] neg_hi:[1,0,1]
    v_pk_fma_f32 v[76:77], v[100:101], v[36:37], v[44:45] op_sel:[1,1,0] op_sel_hi:[1,0,1] neg_lo:[1,0,0] neg_hi:[1,0,1]
    v_pk_fma_f32 v[78:79], v[102:103], v[38:39], v[46:47] op_sel:[1,1,0] op_sel_hi:[1,0,1] neg_lo:[1,0,0] neg_hi:[1,0,1]
    v_accvgpr_read_b32 v48, a225
    v_accvgpr_read_b32 v50, a229
    v_accvgpr_read_b32 v52, a233
    v_accvgpr_read_b32 v54, a237
    v_accvgpr_read_b32 v49, a241
    v_accvgpr_read_b32 v51, a245
    v_accvgpr_read_b32 v53, a249
    v_accvgpr_read_b32 v55, a253
    v_pk_fma_f32 v[56:57], v[88:89], v[32:33], v[48:49] op_sel:[0,0,0] op_sel_hi:[0,1,1]
    v_pk_fma_f32 v[58:59], v[90:91], v[34:35], v[50:51] op_sel:[0,0,0] op_sel_hi:[0,1,1]
    v_pk_fma_f32 v[60:61], v[92:93], v[36:37], v[52:53] op_sel:[0,0,0] op_sel_hi:[0,1,1]
    v_pk_fma_f32 v[62:63], v[94:95], v[38:39], v[54:55] op_sel:[0,0,0] op_sel_hi:[0,1,1]
    v_pk_fma_f32 v[32:33], v[88:89], v[32:33], v[56:57] op_sel:[1,1,0] op_sel_hi:[1,0,1] neg_lo:[1,0,0]
    v_pk_fma_f32 v[34:35], v[90:91], v[34:35], v[58:59] op_sel:[1,1,0] op_sel_hi:[1,0,1] neg_lo:[1,0,0]
    v_pk_fma_f32 v[36:37], v[92:93], v[36:37], v[60:61] op_sel:[1,1,0] op_sel_hi:[1,0,1] neg_lo:[1,0,0]
    v_pk_fma_f32 v[38:39], v[94:95], v[38:39], v[62:63] op_sel:[1,1,0] op_sel_hi:[1,0,1] neg_lo:[1,0,0]
    v_pk_mul_f32 v[40:41], v[96:97], v[32:33] op_sel:[0,0] op_sel_hi:[0,1]
    v_pk_mul_f32 v[42:43], v[98:99], v[34:35] op_sel:[0,0] op_sel_hi:[0,1]
    v_pk_mul_f32 v[44:45], v[100:101], v[36:37] op_sel:[0,0] op_sel_hi:[0,1]
    v_pk_mul_f32 v[46:47], v[102:103], v[38:39] op_sel:[0,0] op_sel_hi:[0,1]
    v_pk_fma_f32 v[80:81], v[96:97], v[32:33], v[40:41] op_sel:[1,1,0] op_sel_hi:[1,0,1] neg_lo:[1,0,0] neg_hi:[1,0,1]
    v_pk_fma_f32 v[82:83], v[98:99], v[34:35], v[42:43] op_sel:[1,1,0] op_sel_hi:[1,0,1] neg_lo:[1,0,0] neg_hi:[1,0,1]
    v_pk_fma_f32 v[84:85], v[100:101], v[36:37], v[44:45] op_sel:[1,1,0] op_sel_hi:[1,0,1] neg_lo:[1,0,0] neg_hi:[1,0,1]
    v_pk_fma_f32 v[86:87], v[102:103], v[38:39], v[46:47] op_sel:[1,1,0] op_sel_hi:[1,0,1] neg_lo:[1,0,0] neg_hi:[1,0,1]
    v_cvt_pk_bf16_f32 v166, v72, v80
    v_cvt_pk_bf16_f32 v174, v74, v82
    v_cvt_pk_bf16_f32 v182, v76, v84
    v_cvt_pk_bf16_f32 v190, v78, v86
    v_cvt_pk_bf16_f32 v230, v73, v81
    v_cvt_pk_bf16_f32 v238, v75, v83
    v_cvt_pk_bf16_f32 v246, v77, v85
    v_cvt_pk_bf16_f32 v254, v79, v87
    v_accvgpr_read_b32 v64, a226
    v_accvgpr_read_b32 v66, a230
    v_accvgpr_read_b32 v68, a234
    v_accvgpr_read_b32 v70, a238
    v_accvgpr_read_b32 v65, a242
    v_accvgpr_read_b32 v67, a246
    v_accvgpr_read_b32 v69, a250
    v_accvgpr_read_b32 v71, a254
    v_pk_fma_f32 v[56:57], v[88:89], v[32:33], v[64:65] op_sel:[0,0,0] op_sel_hi:[0,1,1]
    v_pk_fma_f32 v[58:59], v[90:91], v[34:35], v[66:67] op_sel:[0,0,0] op_sel_hi:[0,1,1]
    v_pk_fma_f32 v[60:61], v[92:93], v[36:37], v[68:69] op_sel:[0,0,0] op_sel_hi:[0,1,1]
    v_pk_fma_f32 v[62:63], v[94:95], v[38:39], v[70:71] op_sel:[0,0,0] op_sel_hi:[0,1,1]
    v_pk_fma_f32 v[32:33], v[88:89], v[32:33], v[56:57] op_sel:[1,1,0] op_sel_hi:[1,0,1] neg_lo:[1,0,0]
    v_pk_fma_f32 v[34:35], v[90:91], v[34:35], v[58:59] op_sel:[1,1,0] op_sel_hi:[1,0,1] neg_lo:[1,0,0]
    v_pk_fma_f32 v[36:37], v[92:93], v[36:37], v[60:61] op_sel:[1,1,0] op_sel_hi:[1,0,1] neg_lo:[1,0,0]
    v_pk_fma_f32 v[38:39], v[94:95], v[38:39], v[62:63] op_sel:[1,1,0] op_sel_hi:[1,0,1] neg_lo:[1,0,0]
    v_pk_mul_f32 v[40:41], v[96:97], v[32:33] op_sel:[0,0] op_sel_hi:[0,1]
    v_pk_mul_f32 v[42:43], v[98:99], v[34:35] op_sel:[0,0] op_sel_hi:[0,1]
    v_pk_mul_f32 v[44:45], v[100:101], v[36:37] op_sel:[0,0] op_sel_hi:[0,1]
    v_pk_mul_f32 v[46:47], v[102:103], v[38:39] op_sel:[0,0] op_sel_hi:[0,1]
    v_pk_fma_f32 v[72:73], v[96:97], v[32:33], v[40:41] op_sel:[1,1,0] op_sel_hi:[1,0,1] neg_lo:[1,0,0] neg_hi:[1,0,1]
    v_pk_fma_f32 v[74:75], v[98:99], v[34:35], v[42:43] op_sel:[1,1,0] op_sel_hi:[1,0,1] neg_lo:[1,0,0] neg_hi:[1,0,1]
    v_pk_fma_f32 v[76:77], v[100:101], v[36:37], v[44:45] op_sel:[1,1,0] op_sel_hi:[1,0,1] neg_lo:[1,0,0] neg_hi:[1,0,1]
    v_pk_fma_f32 v[78:79], v[102:103], v[38:39], v[46:47] op_sel:[1,1,0] op_sel_hi:[1,0,1] neg_lo:[1,0,0] neg_hi:[1,0,1]
    v_accvgpr_read_b32 v48, a227
    v_accvgpr_read_b32 v50, a231
    v_accvgpr_read_b32 v52, a235
    v_accvgpr_read_b32 v54, a239
    v_accvgpr_read_b32 v49, a243
    v_accvgpr_read_b32 v51, a247
    v_accvgpr_read_b32 v53, a251
    v_accvgpr_read_b32 v55, a255
    v_pk_fma_f32 v[56:57], v[88:89], v[32:33], v[48:49] op_sel:[0,0,0] op_sel_hi:[0,1,1]
    v_pk_fma_f32 v[58:59], v[90:91], v[34:35], v[50:51] op_sel:[0,0,0] op_sel_hi:[0,1,1]
    v_pk_fma_f32 v[60:61], v[92:93], v[36:37], v[52:53] op_sel:[0,0,0] op_sel_hi:[0,1,1]
    v_pk_fma_f32 v[62:63], v[94:95], v[38:39], v[54:55] op_sel:[0,0,0] op_sel_hi:[0,1,1]
    v_pk_fma_f32 v[32:33], v[88:89], v[32:33], v[56:57] op_sel:[1,1,0] op_sel_hi:[1,0,1] neg_lo:[1,0,0]
    v_pk_fma_f32 v[34:35], v[90:91], v[34:35], v[58:59] op_sel:[1,1,0] op_sel_hi:[1,0,1] neg_lo:[1,0,0]
    v_pk_fma_f32 v[36:37], v[92:93], v[36:37], v[60:61] op_sel:[1,1,0] op_sel_hi:[1,0,1] neg_lo:[1,0,0]
    v_pk_fma_f32 v[38:39], v[94:95], v[38:39], v[62:63] op_sel:[1,1,0] op_sel_hi:[1,0,1] neg_lo:[1,0,0]
    v_pk_mul_f32 v[40:41], v[96:97], v[32:33] op_sel:[0,0] op_sel_hi:[0,1]
    v_pk_mul_f32 v[42:43], v[98:99], v[34:35] op_sel:[0,0] op_sel_hi:[0,1]
    v_pk_mul_f32 v[44:45], v[100:101], v[36:37] op_sel:[0,0] op_sel_hi:[0,1]
    v_pk_mul_f32 v[46:47], v[102:103], v[38:39] op_sel:[0,0] op_sel_hi:[0,1]
    v_pk_fma_f32 v[80:81], v[96:97], v[32:33], v[40:41] op_sel:[1,1,0] op_sel_hi:[1,0,1] neg_lo:[1,0,0] neg_hi:[1,0,1]
    v_pk_fma_f32 v[82:83], v[98:99], v[34:35], v[42:43] op_sel:[1,1,0] op_sel_hi:[1,0,1] neg_lo:[1,0,0] neg_hi:[1,0,1]
    v_pk_fma_f32 v[84:85], v[100:101], v[36:37], v[44:45] op_sel:[1,1,0] op_sel_hi:[1,0,1] neg_lo:[1,0,0] neg_hi:[1,0,1]
    v_pk_fma_f32 v[86:87], v[102:103], v[38:39], v[46:47] op_sel:[1,1,0] op_sel_hi:[1,0,1] neg_lo:[1,0,0] neg_hi:[1,0,1]
    v_cvt_pk_bf16_f32 v167, v72, v80
    v_cvt_pk_bf16_f32 v175, v74, v82
    v_cvt_pk_bf16_f32 v183, v76, v84
    v_cvt_pk_bf16_f32 v191, v78, v86
    v_cvt_pk_bf16_f32 v231, v73, v81
    v_cvt_pk_bf16_f32 v239, v75, v83
    v_cvt_pk_bf16_f32 v247, v77, v85
    v_cvt_pk_bf16_f32 v255, v79, v87
    s_lshl_b32 s61, s85, 13
    s_andn2_b32 s61, 0x2000, s61
    s_xor_b32 s61, s61, s59
    s_lshl_b32 s50, s85, 21
    s_add_u32 s50, s50, s61
    s_lshr_b32 s60, s82, 2
    s_lshl_b32 s60, s60, 20
    s_add_u32 s50, s50, s60
    s_lshl_b32 s29, s29, 7
    s_and_b32 s29, s29, 0x7ffff
    s_add_u32 s50, s50, s29
    s_and_b32 s60, s58, 1
    s_lshl_b32 s60, s60, 12
    s_add_u32 s50, s50, s60
    s_add_u32 s50, s50, 0xc000000
    s_mov_b32 s5, 16384
    s_mov_b32 s51, 2048
    s_mov_b32 s52, 0x80000
    v_bfe_u32 v2, v0, 4, 1
    v_lshlrev_b32 v2, 6, v2
    v_xor_b32 v2, v2, v1
    v_add_u32 v3, 1024, v2
    s_setpc_b64 s[54:55]
code_end:
    s_endpgm
.section .rodata,"a"
.p2align 6
.amdhsa_kernel chain_kernel
  .amdhsa_next_free_vgpr 512
  .amdhsa_next_free_sgpr 102
  .amdhsa_accum_offset 256
  .amdhsa_group_segment_fixed_size 0
  .amdhsa_kernarg_size 152
  .amdhsa_user_sgpr_count 2
  .amdhsa_user_sgpr_kernarg_segment_ptr 1
  .amdhsa_system_sgpr_workgroup_id_x 1
  .amdhsa_float_denorm_mode_32 3
  .amdhsa_float_denorm_mode_16_64 3
.end_amdhsa_kernel
```

```asm
; @launch kernel=chain_kernel grid=(256,1,1) block=(256,1,1) lds=163840
.amdgcn_target "amdgcn-amd-amdhsa--gfx950"
.text
.globl chain_kernel
.p2align 8
.type chain_kernel,@function
chain_kernel:
    s_cmp_ge_u32 s2, 256
    s_cbranch_scc1 chain_kernel_end
    s_load_dwordx4 s[96:99], s[0:1], 128
    s_load_dwordx2 s[100:101], s[0:1], 144
    s_load_dwordx16 s[64:79], s[0:1], 0
    s_load_dwordx16 s[80:95], s[0:1], 64
    s_getpc_b64 s[8:9]
code_base:
    s_and_b32 s9, s9, 0xffff
    s_mov_b32 s10, code_end - code_base
    s_mov_b32 s11, 0x00020000
    s_bfe_u32 s12, s2, 0x20003
    s_lshl_b32 s12, s12, 15
    v_lshlrev_b32 v1, 7, v0
    buffer_load_dword v255, v1, s[8:11], s12 offen
    s_getreg_b32 s16, hwreg(HW_REG_XCC_ID)
    s_and_b32 s16, s16, 7
    v_lshrrev_b32 v1, 6, v0
    s_nop 0
    v_readfirstlane_b32 s18, v1
    s_waitcnt lgkmcnt(0)
    s_lshr_b32 s17, s2, 3
    s_mov_b32 s2, 0
    s_cmp_lg_u32 s18, 0
    s_cbranch_scc1 L_role_1
    s_lshl_b32 s12, s16, 8
    s_add_u32 s12, s12, 0xd200000
    v_lshl_add_u32 v1, v0, 2, s12
    v_mov_b32 v2, 0
    global_store_dword v1, v2, s[100:101]
    s_lshl_b32 s12, s16, 3
    s_add_u32 s12, s12, 128
    s_lshl_b32 s94, 1, s17
    s_mov_b32 s95, 0x100
    s_waitcnt vmcnt(0)
    s_atomic_add_x2 s[94:95], s[98:99], s12 glc
L_role_1:
    s_cmp_ge_u32 s16, 4
    s_cbranch_scc1 chain_kernel_worker
chain_start:
    s_mov_b32 s8, s100
    s_and_b32 s9, s101, 0xffff
    s_mov_b32 s10, 0x10000000
    s_mov_b32 s11, 0x00020000
    s_mov_b32 s33, 0
    s_xor_b32 s29, s17, 8
    s_and_b32 s28, s17, 1
    s_bfe_u32 s20, s17, 0x10001
    s_xor_b32 s20, s20, 1
    s_lshl1_add_u32 s28, s28, s20
    s_lshl_b32 s20, s16, 10
    s_lshr_b32 s21, s17, 2
    s_lshl_b32 s21, s21, 7
    s_add_u32 s20, s20, s21
    v_bfe_u32 v160, v0, 5, 1
    v_lshlrev_b32 v162, 1, v160
    v_bfe_u32 v160, v0, 3, 1
    v_add_u32 v162, v162, v160
    v_bfe_u32 v160, v0, 4, 1
    v_lshl_add_u32 v162, v160, 3, v162
    v_lshrrev_b32 v160, 6, v0
    v_lshl_add_u32 v162, v160, 8, v162
    v_and_b32 v161, 7, v0
    v_lshlrev_b32 v163, 13, v162
    v_lshl_add_u32 v163, v161, 4, v163
    s_and_b32 s21, s28, 1
    s_lshl_b32 s21, s21, 6
    s_add_u32 s21, s21, s20
    s_lshl_b32 s21, s21, 1
    v_add_u32 v163, s21, v163
    v_add_u32 v164, 0x8000, v163
    v_bfe_u32 v160, v0, 4, 2
    v_lshlrev_b32 v162, 1, v160
    v_bfe_u32 v160, v0, 2, 1
    v_add_u32 v162, v162, v160
    v_bfe_u32 v160, v0, 3, 1
    v_lshl_add_u32 v162, v160, 3, v162
    v_lshrrev_b32 v160, 6, v0
    v_lshl_add_u32 v162, v160, 8, v162
    v_and_b32 v161, 3, v0
    v_lshlrev_b32 v165, 13, v162
    v_lshl_add_u32 v165, v161, 4, v165
    s_and_b32 s21, s17, 3
    s_lshl_b32 s21, s21, 5
    s_add_u32 s21, s21, s20
    s_lshl_b32 s21, s21, 1
    v_add_u32 v165, s21, v165
    v_bfe_u32 v166, v0, 2, 1
    v_bfe_u32 v160, v0, 4, 1
    v_lshl_add_u32 v166, v160, 1, v166
    v_bfe_u32 v160, v0, 3, 1
    v_lshl_add_u32 v166, v160, 2, v166
    v_bfe_u32 v160, v0, 5, 1
    v_lshl_add_u32 v166, v160, 4, v166
    v_lshrrev_b32 v160, 6, v0
    v_lshl_add_u32 v166, v160, 8, v166
    s_lshl_b32 s21, s16, 10
    v_add_u32 v166, s21, v166
    v_lshlrev_b32 v166, 11, v166
    v_lshl_add_u32 v166, v161, 4, v166
    s_lshl_b32 s21, s29, 6
    v_add_u32 v166, s21, v166
    s_lshl_b32 s80, s18, 15
    s_add_u32 s80, s80, 32768
    s_bitcmp1_b32 s28, 1
    s_cselect_b32 s12, s88, s86
    s_cselect_b32 s13, s89, s87
    s_and_b32 s13, s13, 0xffff
    s_mov_b32 s14, 0x800000
    s_mov_b32 s15, 0x00020000
    s_mov_b32 s4, s90
    s_and_b32 s5, s91, 0xffff
    s_mov_b32 s6, 0x800000
    s_mov_b32 s7, 0x00020000
    s_mov_b32 s40, s92
    s_and_b32 s41, s93, 0xffff
    s_mov_b32 s42, 0x800000
    s_mov_b32 s43, 0x00020000
    s_add_u32 m0, s80, 0
    s_mov_b32 s81, 0
    buffer_load_dwordx4 v163, s[12:15], s81 offen nt lds
    s_add_u32 m0, s80, 1024
    s_mov_b32 s81, 0
    buffer_load_dwordx4 v164, s[12:15], s81 offen nt lds
    s_add_u32 m0, s80, 2048
    s_mov_b32 s81, 131072
    buffer_load_dwordx4 v163, s[12:15], s81 offen nt lds
    s_add_u32 m0, s80, 3072
    s_mov_b32 s81, 131072
    buffer_load_dwordx4 v164, s[12:15], s81 offen nt lds
    s_mov_b32 s81, 0
    buffer_load_dwordx4 v[32:35], v165, s[4:7], s81 offen nt
    s_mov_b32 s81, 0
    buffer_load_dwordx4 v[96:99], v166, s[40:43], s81 offen nt
    s_mov_b32 s81, 131072
    buffer_load_dwordx4 v[36:39], v165, s[4:7], s81 offen nt
    s_mov_b32 s81, 16384
    buffer_load_dwordx4 v[100:103], v166, s[40:43], s81 offen nt
    s_mov_b32 s24, 0x00ff00ff
    s_mov_b32 s25, 0x00ff00ff
    s_mov_b32 s26, 0x55555555
    s_mov_b32 s27, 0x55555555
    s_mov_b32 s56, 0x3fb8aa3b
    s_mov_b32 s57, 0x3fb8aa3b
    s_mov_b32 s58, 0x3db504f3
    s_mov_b32 s59, 0x3db504f3
    s_lshl_b32 s53, s16, 16
    s_add_u32 s53, s53, 0xd000000
    s_lshl_b32 s47, s16, 5
    s_add_u32 s47, s47, s17
    s_mov_b64 s[60:61], s[98:99]
    v_mov_b32 v28, -1
    v_mov_b32 v29, -1
    v_mov_b32 v30, -1
    v_mov_b32 v31, -1
    v_and_b32 v210, 63, v0
    v_and_b32 v208, 15, v0
    v_bfe_u32 v209, v0, 4, 2
    v_lshlrev_b32 v1, 4, v210
    v_lshlrev_b32 v26, 3, v210
    s_lshl_b32 s21, s18, 12
    v_add_u32 v2, s21, v1
    s_xor_b32 s22, s18, 3
    s_lshl_b32 s22, s22, 4
    v_xor_b32 v3, s22, v2
    v_add_u32 v3, 16384, v3
    s_and_b32 s22, s22, 16
    s_lshl_b32 s22, s22, 1
    v_xor_b32 v2, s22, v2
    v_mov_b32 v19, 0xeeeeeeee
    v_mov_b32 v212, 0x44444444
    v_cndmask_b32 v19, v19, v212, s[24:25]
    v_mov_b32 v18, 0x03020706
    v_mov_b32 v212, 0x05040100
    v_cndmask_b32 v18, v18, v212, s[26:27]
    s_lshr_b32 s21, s17, 2
    s_lshl_b32 s21, s21, 12
    s_add_u32 s21, s21, 32768
    v_add_u32 v5, s21, v1
    s_and_b32 s22, s28, 1
    s_lshl_b32 s22, s22, 11
    s_add_u32 s21, s21, s22
    s_bfe_u32 s22, s28, 0x10001
    s_lshl_b32 s22, s22, 7
    s_add_u32 s23, s21, s22
    v_and_b32 v212, 1, v209
    s_mov_b64 exec, 0
    s_cmp_eq_u32 s18, 1
    s_cbranch_scc1 ct_c0
    s_cmp_eq_u32 s18, 2
    s_cbranch_scc1 ct_c1
    s_cmp_eq_u32 s18, 3
    s_cbranch_scc1 ct_c2
ct_ret1:
    s_mov_b64 exec, -1
    s_add_u32 m0, s80, 4096
    s_mov_b32 s81, 262144
    buffer_load_dwordx4 v163, s[12:15], s81 offen nt lds
    s_add_u32 m0, s80, 5120
    s_mov_b32 s81, 262144
    buffer_load_dwordx4 v164, s[12:15], s81 offen nt lds
    s_add_u32 m0, s80, 6144
    s_mov_b32 s81, 393216
    buffer_load_dwordx4 v163, s[12:15], s81 offen nt lds
    s_add_u32 m0, s80, 7168
    s_mov_b32 s81, 393216
    buffer_load_dwordx4 v164, s[12:15], s81 offen nt lds
    s_mov_b32 s81, 262144
    buffer_load_dwordx4 v[40:43], v165, s[4:7], s81 offen nt
    s_mov_b32 s81, 65536
    buffer_load_dwordx4 v[104:107], v166, s[40:43], s81 offen nt
    s_mov_b32 s81, 393216
    buffer_load_dwordx4 v[44:47], v165, s[4:7], s81 offen nt
    s_mov_b32 s81, 81920
    buffer_load_dwordx4 v[108:111], v166, s[40:43], s81 offen nt
    v_lshlrev_b32 v234, 5, v212
    v_and_b32 v212, 1, v208
    v_lshl_add_u32 v234, v212, 4, v234
    v_bfe_u32 v212, v208, 1, 2
    v_lshl_add_u32 v234, v212, 2, v234
    s_and_b32 s22, s18, 1
    s_lshl_b32 s22, s22, 6
    v_add_u32 v234, s22, v234
    v_lshrrev_b32 v212, 3, v208
    v_and_b32 v213, 2, v209
    v_add_u32 v212, v212, v213
    s_and_b32 s22, s18, 2
    s_lshl_b32 s22, s22, 1
    v_add_u32 v212, s22, v212
    v_lshl_add_u32 v4, v212, 8, v234
    v_lshlrev_b32 v234, 3, v208
    v_and_b32 v212, 1, v209
    v_lshl_add_u32 v234, v212, 8, v234
    v_lshrrev_b32 v212, 1, v209
    v_lshl_add_u32 v234, v212, 7, v234
    v_add_u32 v4, s23, v4
    v_lshrrev_b32 v212, 3, v210
    v_and_b32 v213, 7, v210
    v_lshlrev_b32 v22, 8, v212
    s_mov_b64 exec, 0
    s_cmp_eq_u32 s18, 1
    s_cbranch_scc1 ct_c3
    s_cmp_eq_u32 s18, 2
    s_cbranch_scc1 ct_c4
    s_cmp_eq_u32 s18, 3
    s_cbranch_scc1 ct_c5
ct_ret2:
    s_mov_b64 exec, -1
    s_or_b32 s76, s16, s18
    s_or_b32 s76, s76, s2
    s_cbranch_scc1 L_cal_2
    s_waitcnt lgkmcnt(0)
    s_lshr_b32 s74, s95, 8
    s_cmp_ge_u32 s74, 15
    s_cbranch_scc1 L_cal_2
    s_lshl_b32 s76, s74, 14
    s_add_u32 s76, s76, 0xd400000
    s_add_u32 s64, s100, s76
    s_addc_u32 s65, s101, 0
    s_mov_b32 s76, 0
    s_atomic_or s76, s[64:65], 0
    s_atomic_or s76, s[64:65], 0x2000
    s_waitcnt lgkmcnt(0)
    s_mov_b32 s77, -1
    s_mov_b32 s78, -1
    s_memtime s[66:67]
    s_atomic_or s76, s[64:65], 0
    s_waitcnt lgkmcnt(0)
    s_memtime s[68:69]
    s_atomic_or s76, s[64:65], 0x2000
    s_waitcnt lgkmcnt(0)
    s_sub_u32 s79, s68, s66
    s_memtime s[66:67]
    s_min_u32 s77, s77, s79
    s_waitcnt lgkmcnt(0)
    s_sub_u32 s79, s66, s68
    s_min_u32 s78, s78, s79
    s_memtime s[66:67]
    s_atomic_or s76, s[64:65], 0
    s_waitcnt lgkmcnt(0)
    s_memtime s[68:69]
    s_atomic_or s76, s[64:65], 0x2000
    s_waitcnt lgkmcnt(0)
    s_sub_u32 s79, s68, s66
    s_memtime s[66:67]
    s_min_u32 s77, s77, s79
    s_waitcnt lgkmcnt(0)
    s_sub_u32 s79, s66, s68
    s_min_u32 s78, s78, s79
    s_memtime s[66:67]
    s_atomic_or s76, s[64:65], 0
    s_waitcnt lgkmcnt(0)
    s_memtime s[68:69]
    s_atomic_or s76, s[64:65], 0x2000
    s_waitcnt lgkmcnt(0)
    s_sub_u32 s79, s68, s66
    s_memtime s[66:67]
    s_min_u32 s77, s77, s79
    s_waitcnt lgkmcnt(0)
    s_sub_u32 s79, s66, s68
    s_min_u32 s78, s78, s79
    s_memtime s[66:67]
    s_atomic_or s76, s[64:65], 0
    s_waitcnt lgkmcnt(0)
    s_memtime s[68:69]
    s_atomic_or s76, s[64:65], 0x2000
    s_waitcnt lgkmcnt(0)
    s_sub_u32 s79, s68, s66
    s_memtime s[66:67]
    s_min_u32 s77, s77, s79
    s_waitcnt lgkmcnt(0)
    s_sub_u32 s79, s66, s68
    s_min_u32 s78, s78, s79
    s_cmp_lt_u32 s78, s77
    s_cselect_b32 s76, 0x101, 1
    s_atomic_add s76, s[98:99], 4
    s_waitcnt lgkmcnt(0)
L_cal_2:
    s_add_u32 m0, s80, 8192
    s_mov_b32 s81, 524288
    buffer_load_dwordx4 v163, s[12:15], s81 offen nt lds
    s_add_u32 m0, s80, 9216
    s_mov_b32 s81, 524288
    buffer_load_dwordx4 v164, s[12:15], s81 offen nt lds
    s_add_u32 m0, s80, 10240
    s_mov_b32 s81, 655360
    buffer_load_dwordx4 v163, s[12:15], s81 offen nt lds
    s_add_u32 m0, s80, 11264
    s_mov_b32 s81, 655360
    buffer_load_dwordx4 v164, s[12:15], s81 offen nt lds
    s_mov_b32 s81, 524288
    buffer_load_dwordx4 v[48:51], v165, s[4:7], s81 offen nt
    s_mov_b32 s81, 131072
    buffer_load_dwordx4 v[112:115], v166, s[40:43], s81 offen nt
    s_mov_b32 s81, 655360
    buffer_load_dwordx4 v[52:55], v165, s[4:7], s81 offen nt
    s_mov_b32 s81, 147456
    buffer_load_dwordx4 v[116:119], v166, s[40:43], s81 offen nt
    v_lshl_add_u32 v22, v213, 4, v22
    v_add_u32 v22, s23, v22
    s_lshr_b32 s20, s47, 2
    s_lshl_b32 s48, s20, 16
    s_and_b32 s21, s17, 3
    s_lshl_b32 s22, s21, 11
    s_add_u32 s22, s22, 0x4000
    v_add_u32 v237, s22, v1
    v_lshlrev_b32 v236, 7, v208
    v_and_b32 v212, 1, v209
    v_lshl_add_u32 v236, v212, 15, v236
    s_lshl_b32 s22, s21, 11
    v_add_u32 v236, s22, v236
    v_mov_b32 v25, v236
    s_cmp_lt_u32 s18, 2
    s_cselect_b32 s38, 0xf0000000, 0
    s_cmp_lg_u32 s18, 1
    s_cselect_b32 s39, 0xf0000000, 0
    s_lshr_b32 s22, s18, 1
    s_mul_i32 s54, s22, 10240
    s_lshl_b32 s22, s22, 15
    s_and_b32 s23, s18, 1
    s_lshl_b32 s23, s23, 12
    s_add_u32 s54, s54, s23
    s_add_u32 s54, s54, 32768
    s_mov_b64 exec, 0
    s_cmp_eq_u32 s18, 1
    s_cbranch_scc1 ct_c6
    s_cmp_eq_u32 s18, 2
    s_cbranch_scc1 ct_c7
    s_cmp_eq_u32 s18, 3
    s_cbranch_scc1 ct_c8
ct_ret3:
    s_mov_b64 exec, -1
    s_add_u32 m0, s80, 12288
    s_mov_b32 s81, 786432
    buffer_load_dwordx4 v163, s[12:15], s81 offen nt lds
    s_add_u32 m0, s80, 13312
    s_mov_b32 s81, 786432
    buffer_load_dwordx4 v164, s[12:15], s81 offen nt lds
    s_add_u32 m0, s80, 14336
    s_mov_b32 s81, 917504
    buffer_load_dwordx4 v163, s[12:15], s81 offen nt lds
    s_add_u32 m0, s80, 15360
    s_mov_b32 s81, 917504
    buffer_load_dwordx4 v164, s[12:15], s81 offen nt lds
    s_mov_b32 s81, 786432
    buffer_load_dwordx4 v[56:59], v165, s[4:7], s81 offen nt
    s_mov_b32 s81, 196608
    buffer_load_dwordx4 v[120:123], v166, s[40:43], s81 offen nt
    s_mov_b32 s81, 917504
    buffer_load_dwordx4 v[60:63], v165, s[4:7], s81 offen nt
    s_mov_b32 s81, 212992
    buffer_load_dwordx4 v[124:127], v166, s[40:43], s81 offen nt
    s_add_u32 s22, s22, s23
    v_add_u32 v235, s22, v1
    s_lshl_b32 s51, s18, 11
    v_add_u32 v243, s51, v1
    v_add_u32 v244, 0x8000, v243
    v_lshrrev_b32 v212, 3, v210
    v_lshl_add_u32 v24, v212, 7, v5
    v_add_u32 v24, 128, v24
    s_and_b32 s22, s18, 1
    s_lshl_b32 s22, s22, 12
    v_add_u32 v242, s22, v1
    s_lshl_b32 s21, s21, 10
    s_add_u32 s21, s21, 0xc000
    v_add_u32 v23, s21, v242
    v_lshlrev_b32 v241, 7, v209
    v_bfe_u32 v212, v0, 2, 1
    v_lshl_add_u32 v241, v212, 6, v241
    v_bfe_u32 v212, v0, 3, 1
    v_lshl_add_u32 v241, v212, 5, v241
    v_bfe_u32 v212, v0, 0, 1
    v_lshl_add_u32 v241, v212, 4, v241
    v_and_b32 v212, 7, v208
    v_lshlrev_b32 v6, 4, v212
    v_lshl_add_u32 v6, v209, 7, v6
    s_lshl_b32 s21, s17, 9
    s_mov_b64 exec, 0
    s_cmp_eq_u32 s18, 1
    s_cbranch_scc1 ct_c9
    s_cmp_eq_u32 s18, 2
    s_cbranch_scc1 ct_c10
    s_cmp_eq_u32 s18, 3
    s_cbranch_scc1 ct_c11
ct_ret4:
    s_mov_b64 exec, -1
    s_add_u32 m0, s80, 16384
    s_mov_b32 s81, 1048576
    buffer_load_dwordx4 v163, s[12:15], s81 offen nt lds
    s_add_u32 m0, s80, 17408
    s_mov_b32 s81, 1048576
    buffer_load_dwordx4 v164, s[12:15], s81 offen nt lds
    s_add_u32 m0, s80, 18432
    s_mov_b32 s81, 1179648
    buffer_load_dwordx4 v163, s[12:15], s81 offen nt lds
    s_add_u32 m0, s80, 19456
    s_mov_b32 s81, 1179648
    buffer_load_dwordx4 v164, s[12:15], s81 offen nt lds
    s_mov_b32 s81, 1048576
    buffer_load_dwordx4 v[64:67], v165, s[4:7], s81 offen nt
    s_mov_b32 s81, 262144
    buffer_load_dwordx4 v[128:131], v166, s[40:43], s81 offen nt
    s_mov_b32 s81, 1179648
    buffer_load_dwordx4 v[68:71], v165, s[4:7], s81 offen nt
    s_mov_b32 s81, 278528
    buffer_load_dwordx4 v[132:135], v166, s[40:43], s81 offen nt
    s_add_u32 s22, s21, 16384
    v_add_u32 v6, s22, v6
    v_lshrrev_b32 v212, 3, v208
    v_and_b32 v213, 2, v209
    v_add_u32 v212, v212, v213
    v_lshlrev_b32 v7, 7, v212
    v_and_b32 v212, 1, v209
    v_lshl_add_u32 v7, v212, 4, v7
    v_bfe_u32 v212, v208, 1, 2
    v_lshl_add_u32 v7, v212, 2, v7
    s_lshl_b32 s21, s29, 9
    s_lshl_b32 s22, s18, 5
    s_add_u32 s21, s21, s22
    v_add_u32 v7, s21, v7
    v_bfe_u32 v212, v210, 1, 3
    v_and_b32 v213, 1, v210
    v_lshlrev_b32 v27, 11, v212
    v_lshl_add_u32 v27, v213, 3, v27
    v_lshl_add_u32 v27, v209, 4, v27
    s_lshl_b32 s21, s29, 6
    v_add_u32 v27, s21, v27
    v_lshlrev_b32 v212, 2, v210
    s_xor_b32 s21, s18, 3
    s_mul_i32 s21, s21, 768
    s_add_u32 m0, s80, 20480
    s_mov_b32 s81, 1310720
    buffer_load_dwordx4 v163, s[12:15], s81 offen nt lds
    s_add_u32 m0, s80, 21504
    s_mov_b32 s81, 1310720
    buffer_load_dwordx4 v164, s[12:15], s81 offen nt lds
    s_add_u32 m0, s80, 22528
    s_mov_b32 s81, 1441792
    buffer_load_dwordx4 v163, s[12:15], s81 offen nt lds
    s_add_u32 m0, s80, 23552
    s_mov_b32 s81, 1441792
    buffer_load_dwordx4 v164, s[12:15], s81 offen nt lds
    s_mov_b32 s81, 1310720
    buffer_load_dwordx4 v[72:75], v165, s[4:7], s81 offen nt
    s_mov_b32 s81, 327680
    buffer_load_dwordx4 v[136:139], v166, s[40:43], s81 offen nt
    s_mov_b32 s81, 1441792
    buffer_load_dwordx4 v[76:79], v165, s[4:7], s81 offen nt
    s_mov_b32 s81, 344064
    buffer_load_dwordx4 v[140:143], v166, s[40:43], s81 offen nt
    s_add_u32 s21, s21, 0
    v_add_u32 v238, s21, v212
    v_lshlrev_b32 v12, 1, v238
    s_xor_b32 s21, s18, 2
    s_mul_i32 s21, s21, 768
    s_add_u32 s21, s21, 256
    v_add_u32 v239, s21, v212
    v_lshlrev_b32 v13, 1, v239
    s_xor_b32 s21, s18, 1
    s_mul_i32 s21, s21, 768
    s_add_u32 s21, s21, 512
    v_add_u32 v240, s21, v212
    v_lshlrev_b32 v14, 1, v240
    s_mul_i32 s21, s18, 768
    v_add_u32 v17, s21, v212
    v_lshlrev_b32 v15, 1, v17
    s_lshl_b32 s21, s18, 10
    v_add_u32 v16, s21, v1
    global_load_dwordx2 v[246:247], v27, s[84:85]
    v_and_b32 v208, 15, v0
    v_bfe_u32 v209, v0, 6, 1
    v_lshl_add_u32 v208, v209, 4, v208
    v_bfe_u32 v209, v0, 4, 2
    v_lshlrev_b32 v209, 2, v209
    v_sub_u32 v208, v208, v209
    s_or_b32 s76, s2, s18
    s_cbranch_scc1 L_rw_3
    s_lshl_b32 s78, s16, 3
    s_add_u32 s78, s78, 128
    s_mov_b32 s79, 0
L_rp_4:
    s_load_dwordx2 s[76:77], s[98:99], s78 glc
    s_add_u32 s79, s79, 1
    s_cmp_gt_u32 s79, 0x100000
    s_cbranch_scc1 chain_kernel_abort
    s_waitcnt lgkmcnt(0)
    s_cmp_lt_u32 s77, 0x2000
    s_cbranch_scc1 L_rp_4
    s_lshr_b32 s77, s95, 8
    s_cmp_eq_u32 s76, -1
    s_cselect_b32 s94, -1, s77
L_rw_3:
    s_waitcnt vmcnt(44)
    s_add_u32 m0, s80, 24576
    s_mov_b32 s81, 1572864
    buffer_load_dwordx4 v163, s[12:15], s81 offen nt lds
    s_add_u32 m0, s80, 25600
    s_mov_b32 s81, 1572864
    buffer_load_dwordx4 v164, s[12:15], s81 offen nt lds
    s_add_u32 m0, s80, 26624
    s_mov_b32 s81, 1703936
    buffer_load_dwordx4 v163, s[12:15], s81 offen nt lds
    s_add_u32 m0, s80, 27648
    s_mov_b32 s81, 1703936
    buffer_load_dwordx4 v164, s[12:15], s81 offen nt lds
    s_mov_b32 s81, 1572864
    buffer_load_dwordx4 v[80:83], v165, s[4:7], s81 offen nt
    s_mov_b32 s81, 393216
    buffer_load_dwordx4 v[144:147], v166, s[40:43], s81 offen nt
    s_mov_b32 s81, 1703936
    buffer_load_dwordx4 v[84:87], v165, s[4:7], s81 offen nt
    s_mov_b32 s81, 409600
    buffer_load_dwordx4 v[148:151], v166, s[40:43], s81 offen nt
    v_mov_b32 v209, 0xff800000
    v_cmp_gt_i32 vcc, 0, v208
    s_nop 1
    v_cndmask_b32 v226, 0, v209, vcc
    v_cmp_gt_i32 vcc, 1, v208
    s_nop 1
    v_cndmask_b32 v227, 0, v209, vcc
    v_cmp_gt_i32 vcc, 2, v208
    s_nop 1
    v_cndmask_b32 v228, 0, v209, vcc
    v_cmp_gt_i32 vcc, 3, v208
    s_nop 1
    v_cndmask_b32 v229, 0, v209, vcc
    v_cmp_gt_i32 vcc, 16, v208
    s_nop 1
    v_cndmask_b32 v230, 0, v209, vcc
    v_cmp_gt_i32 vcc, 17, v208
    s_nop 1
    v_cndmask_b32 v231, 0, v209, vcc
    v_cmp_gt_i32 vcc, 18, v208
    s_nop 1
    v_cndmask_b32 v232, 0, v209, vcc
    v_cmp_gt_i32 vcc, 19, v208
    s_nop 1
    v_cndmask_b32 v233, 0, v209, vcc
    s_waitcnt vmcnt(44)
    s_add_u32 m0, s80, 28672
    s_mov_b32 s81, 1835008
    buffer_load_dwordx4 v163, s[12:15], s81 offen nt lds
    s_add_u32 m0, s80, 29696
    s_mov_b32 s81, 1835008
    buffer_load_dwordx4 v164, s[12:15], s81 offen nt lds
    s_add_u32 m0, s80, 30720
    s_mov_b32 s81, 1966080
    buffer_load_dwordx4 v163, s[12:15], s81 offen nt lds
    s_add_u32 m0, s80, 31744
    s_mov_b32 s81, 1966080
    buffer_load_dwordx4 v164, s[12:15], s81 offen nt lds
    s_mov_b32 s81, 1835008
    buffer_load_dwordx4 v[88:91], v165, s[4:7], s81 offen nt
    s_mov_b32 s81, 458752
    buffer_load_dwordx4 v[152:155], v166, s[40:43], s81 offen nt
    s_mov_b32 s81, 1966080
    buffer_load_dwordx4 v[92:95], v165, s[4:7], s81 offen nt
    s_mov_b32 s81, 475136
    buffer_load_dwordx4 v[156:159], v166, s[40:43], s81 offen nt
ct_from:
ct_c0:
ct_p1:
    s_cbranch_execz ct_p24
    s_cmp_lg_u32 s2, 0
    s_cbranch_scc1 L_rok_5
    v_mov_b32 v208, 31744
    s_cmp_lg_u32 s18, 0
    s_cbranch_scc1 L_rw_6
    v_mov_b32 v209, s94
    ds_write_b32 v208, v209
    s_waitcnt lgkmcnt(0)
L_rw_6:
    s_barrier
    ds_read_b32 v209, v208
    s_waitcnt lgkmcnt(0)
    v_readfirstlane_b32 s20, v209
    s_mov_b32 s2, 1
    s_cmp_eq_u32 s20, -1
    s_cbranch_scc1 L_rok_5
    s_mov_b32 s17, s20
    s_waitcnt vmcnt(0)
    s_barrier
    s_cmp_ge_u32 s17, 32
    s_cbranch_scc1 chain_kernel_end
    s_branch chain_start
ct_p24:
    s_cbranch_execz ct_p47
L_rok_5:
    s_lshl_b32 s42, s18, 18
    s_add_u32 s42, s42, s53
    buffer_store_dwordx4 v[28:31], v22, s[8:11], s42 offen
    s_lshl_b32 s21, s29, 9
    s_add_u32 s21, s21, s42
    buffer_store_dwordx2 v[28:29], v26, s[8:11], s21 offen
    s_xor_b32 s21, s21, 20480
    buffer_store_dwordx2 v[28:29], v26, s[8:11], s21 offen
    s_lshl_b32 s62, s16, 8
    s_add_u32 s62, s62, 0xd200000
    s_cmp_eq_u32 s17, 1
    s_cselect_b32 s21, s62, 0x10000000
    v_mov_b32 v248, 0
    s_add_u32 s21, s21, 4096
    buffer_store_dword v248, v248, s[8:11], s21 offen sc1
    v_mov_b32 v249, 4
    global_load_dword v249, v249, s[60:61] sc1
    v_bfe_u32 v160, v0, 4, 2
    v_lshlrev_b32 v160, 3, v160
    v_bfe_u32 v162, v0, 2, 2
    v_add_u32 v160, v160, v162
ct_p47:
    s_cbranch_execz ct_p71
    v_and_b32 v161, 3, v0
    v_bfe_u32 v163, v0, 3, 1
    v_lshlrev_b32 v162, 7, v160
    v_and_b32 v164, 1, v0
    v_lshl_add_u32 v162, v164, 5, v162
    v_bfe_u32 v164, v0, 1, 1
    v_lshl_add_u32 v162, v164, 3, v162
    v_lshl_add_u32 v162, v163, 4, v162
    s_lshr_b32 s21, s18, 1
    s_xor_b32 s21, s21, 1
    s_lshl_b32 s21, s21, 6
    s_add_u32 s21, s21, s80
    v_add_u32 v167, s21, v162
    v_xor_b32 v168, 256, v167
    s_lshr_b32 s21, s18, 1
    s_xor_b32 s21, s21, 0
    s_lshl_b32 s21, s21, 6
    s_add_u32 s21, s21, s80
    v_add_u32 v169, s21, v162
    v_xor_b32 v170, 256, v169
    s_waitcnt vmcnt(44)
    ds_read_b64_tr_b16 a[0:1], v167 offset:0
    ds_read_b64_tr_b16 a[2:3], v167 offset:512
ct_p71:
    s_cbranch_execz ct_p90
    ds_read_b64_tr_b16 a[4:5], v167 offset:4096
    ds_read_b64_tr_b16 a[6:7], v167 offset:4608
    ds_read_b64_tr_b16 a[32:33], v168 offset:0
    ds_read_b64_tr_b16 a[34:35], v168 offset:512
    ds_read_b64_tr_b16 a[36:37], v168 offset:4096
    ds_read_b64_tr_b16 a[38:39], v168 offset:4608
    s_waitcnt lgkmcnt(0)
    ds_read_b64_tr_b16 a[64:65], v169 offset:0
    ds_read_b64_tr_b16 a[66:67], v169 offset:512
    ds_read_b64_tr_b16 a[68:69], v169 offset:4096
    ds_read_b64_tr_b16 a[70:71], v169 offset:4608
    ds_read_b64_tr_b16 a[96:97], v170 offset:0
    ds_read_b64_tr_b16 a[98:99], v170 offset:512
    ds_read_b64_tr_b16 a[100:101], v170 offset:4096
    ds_read_b64_tr_b16 a[102:103], v170 offset:4608
    s_waitcnt lgkmcnt(0)
    s_waitcnt vmcnt(41)
    ds_read_b64_tr_b16 a[8:9], v167 offset:8192
ct_p90:
    s_cbranch_execz ct_p108
    ds_read_b64_tr_b16 a[10:11], v167 offset:8704
    ds_read_b64_tr_b16 a[12:13], v167 offset:12288
    ds_read_b64_tr_b16 a[14:15], v167 offset:12800
    ds_read_b64_tr_b16 a[40:41], v168 offset:8192
    ds_read_b64_tr_b16 a[42:43], v168 offset:8704
    ds_read_b64_tr_b16 a[44:45], v168 offset:12288
    ds_read_b64_tr_b16 a[46:47], v168 offset:12800
    s_waitcnt lgkmcnt(0)
    ds_read_b64_tr_b16 a[72:73], v169 offset:8192
    ds_read_b64_tr_b16 a[74:75], v169 offset:8704
    ds_read_b64_tr_b16 a[76:77], v169 offset:12288
    ds_read_b64_tr_b16 a[78:79], v169 offset:12800
    ds_read_b64_tr_b16 a[104:105], v170 offset:8192
    ds_read_b64_tr_b16 a[106:107], v170 offset:8704
    ds_read_b64_tr_b16 a[108:109], v170 offset:12288
    ds_read_b64_tr_b16 a[110:111], v170 offset:12800
    s_waitcnt lgkmcnt(0)
ct_p108:
    s_cbranch_execz ct_p126
    s_waitcnt vmcnt(25)
    ds_read_b64_tr_b16 a[16:17], v167 offset:16384
    ds_read_b64_tr_b16 a[18:19], v167 offset:16896
    ds_read_b64_tr_b16 a[20:21], v167 offset:20480
    ds_read_b64_tr_b16 a[22:23], v167 offset:20992
    ds_read_b64_tr_b16 a[48:49], v168 offset:16384
    ds_read_b64_tr_b16 a[50:51], v168 offset:16896
    ds_read_b64_tr_b16 a[52:53], v168 offset:20480
    ds_read_b64_tr_b16 a[54:55], v168 offset:20992
    s_waitcnt lgkmcnt(0)
    ds_read_b64_tr_b16 a[80:81], v169 offset:16384
    ds_read_b64_tr_b16 a[82:83], v169 offset:16896
    ds_read_b64_tr_b16 a[84:85], v169 offset:20480
    ds_read_b64_tr_b16 a[86:87], v169 offset:20992
    ds_read_b64_tr_b16 a[112:113], v170 offset:16384
    ds_read_b64_tr_b16 a[114:115], v170 offset:16896
    ds_read_b64_tr_b16 a[116:117], v170 offset:20480
ct_p126:
    s_cbranch_execz ct_p145
    ds_read_b64_tr_b16 a[118:119], v170 offset:20992
    s_waitcnt lgkmcnt(0)
    s_waitcnt vmcnt(9)
    ds_read_b64_tr_b16 a[24:25], v167 offset:24576
    ds_read_b64_tr_b16 a[26:27], v167 offset:25088
    ds_read_b64_tr_b16 a[28:29], v167 offset:28672
    ds_read_b64_tr_b16 a[30:31], v167 offset:29184
    ds_read_b64_tr_b16 a[56:57], v168 offset:24576
    ds_read_b64_tr_b16 a[58:59], v168 offset:25088
    ds_read_b64_tr_b16 a[60:61], v168 offset:28672
    ds_read_b64_tr_b16 a[62:63], v168 offset:29184
    s_waitcnt lgkmcnt(0)
    ds_read_b64_tr_b16 a[88:89], v169 offset:24576
    ds_read_b64_tr_b16 a[90:91], v169 offset:25088
    ds_read_b64_tr_b16 a[92:93], v169 offset:28672
    ds_read_b64_tr_b16 a[94:95], v169 offset:29184
    ds_read_b64_tr_b16 a[120:121], v170 offset:24576
    ds_read_b64_tr_b16 a[122:123], v170 offset:25088
ct_p145:
    s_cbranch_execz ct_p169
    ds_read_b64_tr_b16 a[124:125], v170 offset:28672
    ds_read_b64_tr_b16 a[126:127], v170 offset:29184
    s_waitcnt lgkmcnt(0)
    v_add_u32 v171, s80, v1
    v_lshlrev_b32 v162, 6, v160
    v_add_u32 v162, s80, v162
    v_lshl_add_u32 v169, v161, 3, v162
    v_lshl_add_u32 v169, v163, 5, v169
    v_xor_b32 v170, 128, v169
    s_waitcnt vmcnt(0)
    s_barrier
    s_load_dwordx16 s[64:79], s[0:1], 0
    v_lshlrev_b32 v208, 3, v1
    s_lshl2_add_u32 s20, s47, s18
    s_lshl_b32 s20, s20, 13
    s_and_b32 s21, s20, 0x1fffff
    s_waitcnt lgkmcnt(0)
    s_bitcmp1_b32 s20, 21
    s_cselect_b64 s[22:23], s[72:73], s[70:71]
    s_mov_b32 s12, s22
    s_and_b32 s13, s23, 0xffff
    s_mov_b32 s14, 0x200000
    s_mov_b32 s15, 0x00020000
ct_p169:
    s_cbranch_execz ct_p192
    buffer_load_dword v250, v208, s[12:15], s21 offen
    s_bitcmp1_b32 s20, 21
    s_cselect_b64 s[22:23], s[76:77], s[74:75]
    s_mov_b32 s12, s22
    s_and_b32 s13, s23, 0xffff
    s_mov_b32 s14, 0x200000
    s_mov_b32 s15, 0x00020000
    buffer_load_dword v250, v208, s[12:15], s21 offen
    s_mov_b32 s12, s82
    s_and_b32 s13, s83, 0xffff
    s_mov_b32 s14, 0x400000
    s_mov_b32 s15, 0x00020000
    buffer_load_dword v250, v208, s[12:15], s20 offen
    v_and_b32 v208, 15, v0
    v_lshlrev_b32 v208, 7, v208
    s_lshl_b32 s21, s17, 11
    s_add_u32 s21, s21, s42
    buffer_load_dword v250, v208, s[8:11], s21 offen sc1
    s_cmp_lg_u32 s18, 0
    s_cbranch_scc1 L_m0_7
    s_lshl2_add_u32 s21, s17, s62
    buffer_store_dword v28, v248, s[8:11], s21 offen
ct_p192:
    s_cbranch_execz ct_p212
    s_lshl_b32 s21, s29, 9
    s_add_u32 s21, s21, s53
    v_min_u32 v246, 0xfffffffe, v246
    v_min_u32 v247, 0xfffffffe, v247
    buffer_store_dwordx2 v[246:247], v26, s[8:11], s21 offen
L_m0_7:
    ds_write_b128 v171, v[32:35] offset:0
    ds_write_b128 v171, v[36:39] offset:1024
    ds_write_b128 v171, v[40:43] offset:2048
    ds_write_b128 v171, v[44:47] offset:3072
    ds_write_b128 v171, v[48:51] offset:4096
    ds_write_b128 v171, v[52:55] offset:5120
    ds_write_b128 v171, v[56:59] offset:6144
    ds_write_b128 v171, v[60:63] offset:7168
    ds_write_b128 v171, v[64:67] offset:8192
    ds_write_b128 v171, v[68:71] offset:9216
    ds_write_b128 v171, v[72:75] offset:10240
    ds_write_b128 v171, v[76:79] offset:11264
    ds_write_b128 v171, v[80:83] offset:12288
ct_p212:
    s_cbranch_execz ct_p230
    ds_write_b128 v171, v[84:87] offset:13312
    ds_write_b128 v171, v[88:91] offset:14336
    ds_write_b128 v171, v[92:95] offset:15360
    s_waitcnt lgkmcnt(0)
    ds_read_b64_tr_b16 a[128:129], v169 offset:0
    ds_read_b64_tr_b16 a[130:131], v169 offset:256
    ds_read_b64_tr_b16 a[132:133], v169 offset:2048
    ds_read_b64_tr_b16 a[134:135], v169 offset:2304
    ds_read_b64_tr_b16 a[160:161], v170 offset:0
    ds_read_b64_tr_b16 a[162:163], v170 offset:256
    ds_read_b64_tr_b16 a[164:165], v170 offset:2048
    ds_read_b64_tr_b16 a[166:167], v170 offset:2304
    s_waitcnt lgkmcnt(0)
    ds_read_b64_tr_b16 a[136:137], v169 offset:4096
    ds_read_b64_tr_b16 a[138:139], v169 offset:4352
    ds_read_b64_tr_b16 a[140:141], v169 offset:6144
    ds_read_b64_tr_b16 a[142:143], v169 offset:6400
ct_p230:
    s_cbranch_execz ct_ret1
    ds_read_b64_tr_b16 a[168:169], v170 offset:4096
    ds_read_b64_tr_b16 a[170:171], v170 offset:4352
    ds_read_b64_tr_b16 a[172:173], v170 offset:6144
    ds_read_b64_tr_b16 a[174:175], v170 offset:6400
    s_waitcnt lgkmcnt(0)
    ds_read_b64_tr_b16 a[144:145], v169 offset:8192
    ds_read_b64_tr_b16 a[146:147], v169 offset:8448
    ds_read_b64_tr_b16 a[148:149], v169 offset:10240
    ds_read_b64_tr_b16 a[150:151], v169 offset:10496
    ds_read_b64_tr_b16 a[176:177], v170 offset:8192
    ds_read_b64_tr_b16 a[178:179], v170 offset:8448
    ds_read_b64_tr_b16 a[180:181], v170 offset:10240
    ds_read_b64_tr_b16 a[182:183], v170 offset:10496
    s_waitcnt lgkmcnt(0)
    ds_read_b64_tr_b16 a[152:153], v169 offset:12288
    ds_read_b64_tr_b16 a[154:155], v169 offset:12544
    ds_read_b64_tr_b16 a[156:157], v169 offset:14336
ct_c1:
ct_p248:
    s_cbranch_execz ct_p266
    ds_read_b64_tr_b16 a[158:159], v169 offset:14592
    ds_read_b64_tr_b16 a[184:185], v170 offset:12288
    ds_read_b64_tr_b16 a[186:187], v170 offset:12544
    ds_read_b64_tr_b16 a[188:189], v170 offset:14336
    ds_read_b64_tr_b16 a[190:191], v170 offset:14592
    s_waitcnt lgkmcnt(0)
    ds_write_b128 v171, v[96:99] offset:16384
    ds_write_b128 v171, v[100:103] offset:17408
    ds_write_b128 v171, v[104:107] offset:18432
    ds_write_b128 v171, v[108:111] offset:19456
    ds_write_b128 v171, v[112:115] offset:20480
    ds_write_b128 v171, v[116:119] offset:21504
    ds_write_b128 v171, v[120:123] offset:22528
    ds_write_b128 v171, v[124:127] offset:23552
    ds_write_b128 v171, v[128:131] offset:24576
    ds_write_b128 v171, v[132:135] offset:25600
    ds_write_b128 v171, v[136:139] offset:26624
ct_p266:
    s_cbranch_execz ct_p284
    ds_write_b128 v171, v[140:143] offset:27648
    ds_write_b128 v171, v[144:147] offset:28672
    ds_write_b128 v171, v[148:151] offset:29696
    ds_write_b128 v171, v[152:155] offset:30720
    ds_write_b128 v171, v[156:159] offset:31744
    s_waitcnt lgkmcnt(0)
    ds_read_b64_tr_b16 a[192:193], v169 offset:16384
    ds_read_b64_tr_b16 a[194:195], v169 offset:16640
    ds_read_b64_tr_b16 a[196:197], v169 offset:18432
    ds_read_b64_tr_b16 a[198:199], v169 offset:18688
    ds_read_b64_tr_b16 a[224:225], v170 offset:16384
    ds_read_b64_tr_b16 a[226:227], v170 offset:16640
    ds_read_b64_tr_b16 a[228:229], v170 offset:18432
    ds_read_b64_tr_b16 a[230:231], v170 offset:18688
    s_waitcnt lgkmcnt(0)
    ds_read_b64_tr_b16 a[200:201], v169 offset:20480
    ds_read_b64_tr_b16 a[202:203], v169 offset:20736
ct_p284:
    s_cbranch_execz ct_p302
    ds_read_b64_tr_b16 a[204:205], v169 offset:22528
    ds_read_b64_tr_b16 a[206:207], v169 offset:22784
    ds_read_b64_tr_b16 a[232:233], v170 offset:20480
    ds_read_b64_tr_b16 a[234:235], v170 offset:20736
    ds_read_b64_tr_b16 a[236:237], v170 offset:22528
    ds_read_b64_tr_b16 a[238:239], v170 offset:22784
    s_waitcnt lgkmcnt(0)
    ds_read_b64_tr_b16 a[208:209], v169 offset:24576
    ds_read_b64_tr_b16 a[210:211], v169 offset:24832
    ds_read_b64_tr_b16 a[212:213], v169 offset:26624
    ds_read_b64_tr_b16 a[214:215], v169 offset:26880
    ds_read_b64_tr_b16 a[240:241], v170 offset:24576
    ds_read_b64_tr_b16 a[242:243], v170 offset:24832
    ds_read_b64_tr_b16 a[244:245], v170 offset:26624
    ds_read_b64_tr_b16 a[246:247], v170 offset:26880
    s_waitcnt lgkmcnt(0)
    ds_read_b64_tr_b16 a[216:217], v169 offset:28672
ct_p302:
    s_cbranch_execz ct_p319
    ds_read_b64_tr_b16 a[218:219], v169 offset:28928
    ds_read_b64_tr_b16 a[220:221], v169 offset:30720
    ds_read_b64_tr_b16 a[222:223], v169 offset:30976
    ds_read_b64_tr_b16 a[248:249], v170 offset:28672
    ds_read_b64_tr_b16 a[250:251], v170 offset:28928
    ds_read_b64_tr_b16 a[252:253], v170 offset:30720
    ds_read_b64_tr_b16 a[254:255], v170 offset:30976
    s_waitcnt lgkmcnt(0)
    v_mov_b32 v197, 0
    v_mov_b32 v198, 0
    v_mov_b32 v216, 0x3f803f80
    v_mov_b32 v217, 0x3f803f80
    v_mov_b32 v218, 0x3f803f80
    v_mov_b32 v219, 0x3f803f80
    v_mov_b32 v248, 4
    s_branch L_kvw_8_c
ct_p319:
    s_cbranch_execz ct_p349
L_kvw_8:
    global_load_dword v249, v248, s[60:61] sc1
    s_add_u32 s33, s33, 1
    s_cmp_gt_u32 s33, 0x100000
    s_cbranch_scc1 chain_kernel_abort
    s_waitcnt vmcnt(0)
L_kvw_8_c:
    v_readfirstlane_b32 s20, v249
    s_and_b32 s21, s20, 0xff
    s_cmp_ge_u32 s21, 15
    s_cbranch_scc1 L_kvok_9
    s_sleep 16
    s_branch L_kvw_8
L_kvok_9:
    s_cmp_ge_u32 s20, 0x800
    s_cselect_b32 s50, 0x2000, 0
    s_add_u32 s52, s50, 0x8000000
    s_add_u32 s48, s48, s50
    v_and_b32 v208, 63, v0
    v_lshlrev_b32 v208, 1, v208
    s_lshr_b32 s22, s17, 4
    s_lshl_b32 s22, s22, 14
    s_and_b32 s23, s17, 15
    s_lshl2_add_u32 s23, s23, s18
    s_lshl_b32 s23, s23, 7
    s_add_u32 s22, s22, s23
    s_xor_b32 s21, s16, 0
    s_lshl_b32 s21, s21, 15
    s_add_u32 s21, s21, s22
ct_p349:
    s_cbranch_execz ct_p381
    v_add_u32 v8, s21, v208
    s_xor_b32 s21, s16, 1
    s_lshl_b32 s21, s21, 15
    s_add_u32 s21, s21, s22
    v_add_u32 v9, s21, v208
    s_xor_b32 s21, s16, 2
    s_lshl_b32 s21, s21, 15
    s_add_u32 s21, s21, s22
    v_add_u32 v10, s21, v208
    s_xor_b32 s21, s16, 3
    s_lshl_b32 s21, s21, 15
    s_add_u32 s21, s21, s22
    v_add_u32 v11, s21, v208
    s_mov_b32 s55, 0
    s_barrier
    s_mov_b32 s19, 0
    s_mov_b32 s30, 0xc0000
    s_mov_b32 s41, s53
    v_mov_b32 v64, 0
    v_mov_b32 v65, 0
    v_mov_b32 v66, 0
    v_mov_b32 v67, 0
    v_mov_b32 v68, 0
    v_mov_b32 v69, 0
    v_mov_b32 v70, 0
    v_mov_b32 v71, 0
    v_mov_b32 v72, 0
    v_mov_b32 v73, 0
    v_mov_b32 v74, 0
    v_mov_b32 v75, 0
    v_mov_b32 v76, 0
ct_p381:
    s_cbranch_execz ct_p409
    v_mov_b32 v77, 0
    v_mov_b32 v78, 0
    v_mov_b32 v79, 0
    s_add_u32 s21, s19, 0
    s_min_u32 s21, s21, 63
    s_lshl_b32 s31, s21, 21
    s_lshl_b32 s21, s21, 13
    s_and_b32 s21, s21, 0x2000
    s_xor_b32 s21, s21, s48
    s_add_u32 s31, s31, s21
    s_cmp_lg_u32 s18, 1
    s_cbranch_scc1 L_init0_10
    v_mov_b32 v248, 0
    s_lshl2_add_u32 s20, s17, s18
    s_cmp_lg_u32 s20, 5
    s_cbranch_scc1 L_rlo_12
L_rl_11:
    s_load_dword s20, s[60:61], 64 glc
    s_add_u32 s33, s33, 1
    s_cmp_gt_u32 s33, 0x100000
    s_cbranch_scc1 chain_kernel_abort
    s_waitcnt lgkmcnt(0)
    s_cmp_lt_u32 s20, 96
    s_cbranch_scc1 L_rl_11
    v_mov_b32 v249, 1
    buffer_store_dword v249, v248, s[8:11], s62 offen offset:128
    s_branch L_rlok_13
ct_p409:
    s_cbranch_execz ct_p439
L_rlo_12:
    buffer_load_dword v249, v248, s[8:11], s62 offen offset:128 sc1
    s_add_u32 s33, s33, 1
    s_cmp_gt_u32 s33, 0x100000
    s_cbranch_scc1 chain_kernel_abort
    s_waitcnt vmcnt(0)
    v_readfirstlane_b32 s20, v249
    s_cmp_ge_u32 s20, 1
    s_cbranch_scc1 L_rlok_13
    s_sleep 1
    s_branch L_rlo_12
L_rlok_13:
    s_mov_b32 m0, 40960
    s_nop 0
    buffer_load_dwordx4 v237, s[8:11], s31 offen offset:0 lds
    buffer_load_dwordx4 v237, s[8:11], s31 offen offset:1024 lds
L_init0_10:
    s_cmp_lg_u32 s18, 2
    s_cbranch_scc1 L_init2_14
    v_and_b32 v248, 31, v0
    v_lshlrev_b32 v248, 2, v248
L_initp_15:
    buffer_load_dword v249, v248, s[8:11], s62 offen sc1
    s_add_u32 s33, s33, 1
    s_cmp_gt_u32 s33, 0x100000
    s_cbranch_scc1 chain_kernel_abort
    s_waitcnt vmcnt(0)
    v_cmp_eq_u32 vcc, 0, v249
    s_cbranch_vccz L_init2_14
ct_p439:
    s_cbranch_execz ct_p453
    s_sleep 2
    s_branch L_initp_15
L_init2_14:
    s_barrier
    s_mov_b32 m0, s54
    s_nop 0
    buffer_load_dwordx4 v235, s[8:11], s31 offen offset:0 lds
    buffer_load_dwordx4 v235, s[8:11], s31 offen offset:1024 lds
    buffer_load_dwordx4 v235, s[8:11], s31 offen offset:2048 lds
    buffer_load_dwordx4 v235, s[8:11], s31 offen offset:3072 lds
    s_waitcnt vmcnt(0) lgkmcnt(0)
    s_barrier
    s_branch chain_kernel_loop
ct_p453:
    s_cbranch_execz ct_p488
.p2align 8
chain_kernel_loop:
    s_mov_b32 s40, s41
    v_mov_b32 v64, 0
    v_mov_b32 v65, 0
    v_mov_b32 v66, 0
    v_mov_b32 v67, 0
    v_mov_b32 v68, 0
    v_mov_b32 v69, 0
    v_mov_b32 v70, 0
    v_mov_b32 v71, 0
    v_mov_b32 v72, 0
    v_mov_b32 v73, 0
    v_mov_b32 v74, 0
    v_mov_b32 v75, 0
    v_mov_b32 v76, 0
    v_mov_b32 v77, 0
    v_mov_b32 v78, 0
    v_mov_b32 v79, 0
    s_add_u32 s30, s30, 0x40000
    s_and_b32 s30, s30, 0xc0000
    s_xor_b32 s20, s30, 0x80000
    s_add_u32 s42, s53, s20
    s_lshl_b32 s43, s19, 18
    s_lshl_b32 s20, s19, 10
    s_and_b32 s20, s20, 0x2000
    s_xor_b32 s20, s20, s52
    s_add_u32 s43, s43, s20
    s_add_u32 s44, s43, 0x20000
    s_add_u32 s20, s30, 0x40000
    s_and_b32 s20, s20, 0xc0000
    s_add_u32 s41, s53, s20
    s_nop 12
ct_p488:
    s_cbranch_execz ct_p561
    buffer_load_dwordx4 v[32:35], v2, s[8:11], s40 offen offset:0 sc1
    s_nop 13
    buffer_load_dwordx4 v[36:39], v2, s[8:11], s40 offen offset:1024 sc1
    s_nop 13
    buffer_load_dwordx4 v[40:43], v2, s[8:11], s40 offen offset:2048 sc1
    s_nop 13
    buffer_load_dwordx4 v[44:47], v2, s[8:11], s40 offen offset:3072 sc1
Gq_18_s0123:
    s_waitcnt vmcnt(3)
    v_cmp_eq_u32 vcc, -1, v32
    v_mov_b32_dpp v48, v32 row_ror:8 row_mask:0xf bank_mask:0xf
    v_mov_b32_dpp v49, v33 row_ror:8 row_mask:0xf bank_mask:0xf
    v_mov_b32_dpp v50, v34 row_ror:8 row_mask:0xf bank_mask:0xf
    v_mov_b32_dpp v51, v35 row_ror:8 row_mask:0xf bank_mask:0xf
    s_cbranch_vccnz Gq_18_f0123
    v_smfmac_f32_16x16x64_bf16 v[64:67], v[32:35], a[0:7], v19
    v_smfmac_f32_16x16x64_bf16 v[68:71], v[32:35], a[64:71], v19
Gq_18_s123p0:
    s_waitcnt vmcnt(2)
    v_cmp_eq_u32_e64 vcc, -1, v36
    v_smfmac_f32_16x16x64_bf16 v[64:67], v[48:51], a[32:39], v19
    v_mov_b32_dpp v52, v36 row_ror:8 row_mask:0xf bank_mask:0xf
    v_mov_b32_dpp v53, v37 row_ror:8 row_mask:0xf bank_mask:0xf
    v_smfmac_f32_16x16x64_bf16 v[68:71], v[48:51], a[96:103], v19
    v_mov_b32_dpp v54, v38 row_ror:8 row_mask:0xf bank_mask:0xf
    v_mov_b32_dpp v55, v39 row_ror:8 row_mask:0xf bank_mask:0xf
    s_cbranch_vccnz Gq_18_f123p0
    v_smfmac_f32_16x16x64_bf16 v[64:67], v[36:39], a[8:15], v19
    v_smfmac_f32_16x16x64_bf16 v[68:71], v[36:39], a[72:79], v19
Gq_18_s23p1:
    s_waitcnt vmcnt(1)
    v_cmp_eq_u32_e64 vcc, -1, v40
    v_smfmac_f32_16x16x64_bf16 v[64:67], v[52:55], a[40:47], v19
    v_mov_b32_dpp v56, v40 row_ror:8 row_mask:0xf bank_mask:0xf
    v_mov_b32_dpp v57, v41 row_ror:8 row_mask:0xf bank_mask:0xf
    v_smfmac_f32_16x16x64_bf16 v[68:71], v[52:55], a[104:111], v19
    v_mov_b32_dpp v58, v42 row_ror:8 row_mask:0xf bank_mask:0xf
    v_mov_b32_dpp v59, v43 row_ror:8 row_mask:0xf bank_mask:0xf
    s_cbranch_vccnz Gq_18_f23p1
    v_smfmac_f32_16x16x64_bf16 v[64:67], v[40:43], a[16:23], v19
    v_smfmac_f32_16x16x64_bf16 v[68:71], v[40:43], a[80:87], v19
Gq_18_s3p2:
    s_waitcnt vmcnt(0)
    v_cmp_eq_u32 vcc, -1, v44
    v_smfmac_f32_16x16x64_bf16 v[64:67], v[56:59], a[48:55], v19
    v_mov_b32_dpp v60, v44 row_ror:8 row_mask:0xf bank_mask:0xf
    v_mov_b32_dpp v61, v45 row_ror:8 row_mask:0xf bank_mask:0xf
    v_smfmac_f32_16x16x64_bf16 v[68:71], v[56:59], a[112:119], v19
    v_mov_b32_dpp v62, v46 row_ror:8 row_mask:0xf bank_mask:0xf
    v_mov_b32_dpp v63, v47 row_ror:8 row_mask:0xf bank_mask:0xf
    s_cbranch_vccnz Gq_18_f3p2
    v_smfmac_f32_16x16x64_bf16 v[64:67], v[44:47], a[24:31], v19
    v_smfmac_f32_16x16x64_bf16 v[68:71], v[44:47], a[88:95], v19
    v_smfmac_f32_16x16x64_bf16 v[64:67], v[60:63], a[56:63], v19
    v_smfmac_f32_16x16x64_bf16 v[68:71], v[60:63], a[120:127], v19
Gq_18_done:
    v_max3_u32 v20, v33, v34, v35
    v_max3_u32 v208, v37, v38, v39
    v_max3_u32 v209, v41, v42, v43
    v_max3_u32 v210, v45, v46, v47
    ds_write_b64 v12, v[64:65] offset:0
    ds_write_b64 v13, v[66:67] offset:0
    v_max_u32_e64 v20, v20, v208
    v_max3_u32 v20, v20, v209, v210
    ds_write_b64 v14, v[68:69] offset:0
    s_add_u32 m0, s51, 32768
    v_cmp_eq_u32 vcc, -1, v20
    buffer_load_dwordx4 v243, s[8:11], s31 offen offset:0 lds
    buffer_load_dwordx4 v243, s[8:11], s31 offen offset:1024 lds
    v_smfmac_f32_16x16x64_bf16 v[72:75], v[32:35], a[128:135], v19
    v_smfmac_f32_16x16x64_bf16 v[72:75], v[48:51], a[160:167], v19
ct_p561:
    s_cbranch_execz ct_ret1
    s_cbranch_vccnz Gq_18_redo
    s_waitcnt lgkmcnt(0)
    s_barrier
    ds_read_b64 v[80:81], v15 offset:0
    ds_read_b64 v[82:83], v15 offset:512
    ds_read_b64 v[84:85], v15 offset:1024
    v_smfmac_f32_16x16x64_bf16 v[72:75], v[36:39], a[136:143], v19
    v_smfmac_f32_16x16x64_bf16 v[72:75], v[52:55], a[168:175], v19
    s_waitcnt lgkmcnt(2)
    v_pk_add_f32 v[70:71], v[70:71], v[80:81]
    s_waitcnt lgkmcnt(0)
    v_pk_add_f32 v[82:83], v[82:83], v[84:85]
    v_pk_add_f32 v[70:71], v[70:71], v[82:83]
    v_cvt_pk_bf16_f32 v70, v70, v71
    s_cmp_lg_u32 s18, 0
ct_c2:
ct_p578:
    s_cbranch_execz ct_p608
    v_mov_b32_dpp v71, v70 quad_perm:[1,0,3,2] row_mask:0xf bank_mask:0xf
    v_perm_b32 v70, v71, v70, v18
    v_min_u32 v70, 0xfffffffe, v70
    buffer_store_dword v70, v4, s[8:11], s40 offen
    v_smfmac_f32_16x16x64_bf16 v[72:75], v[40:43], a[144:151], v19
    v_smfmac_f32_16x16x64_bf16 v[72:75], v[56:59], a[176:183], v19
    v_smfmac_f32_16x16x64_bf16 v[72:75], v[44:47], a[152:159], v19
    v_smfmac_f32_16x16x64_bf16 v[72:75], v[60:63], a[184:191], v19
    s_nop 7
    ds_write_b128 v16, v[72:75] offset:12288
    s_cbranch_scc1 L_help_16
    s_waitcnt vmcnt(1) lgkmcnt(0)
    s_barrier
    ds_read_b128 v[104:107], v1 offset:32768
    ds_read_b128 v[108:111], v1 offset:33792
    ds_read_b128 v[112:115], v1 offset:34816
    ds_read_b128 v[116:119], v1 offset:35840
    buffer_load_dwordx4 v[148:151], v5, s[8:11], s40 offen offset:0 sc1
    buffer_load_dwordx4 v[152:155], v5, s[8:11], s40 offen offset:1024 sc1
    buffer_load_dwordx4 v[156:159], v5, s[8:11], s40 offen offset:2048 sc1
    buffer_load_dwordx4 v[160:163], v5, s[8:11], s40 offen offset:3072 sc1
    ds_read_b128 v[120:123], v1 offset:36864
    ds_read_b128 v[124:127], v1 offset:37888
    ds_read_b128 v[128:131], v1 offset:38912
    ds_read_b128 v[132:135], v1 offset:39936
    ds_read_b128 v[136:139], v1 offset:40960
    ds_read_b128 v[140:143], v1 offset:41984
    s_nop 6
ct_p608:
    s_cbranch_execz ct_p619
    buffer_load_dwordx4 v[164:167], v5, s[8:11], s40 offen offset:0 sc1
    buffer_load_dwordx4 v[168:171], v5, s[8:11], s40 offen offset:1024 sc1
    buffer_load_dwordx4 v[172:175], v5, s[8:11], s40 offen offset:2048 sc1
    buffer_load_dwordx4 v[176:179], v5, s[8:11], s40 offen offset:3072 sc1
    s_nop 13
    buffer_load_dwordx4 v[32:35], v5, s[8:11], s40 offen offset:0 sc1
    buffer_load_dwordx4 v[36:39], v5, s[8:11], s40 offen offset:1024 sc1
    buffer_load_dwordx4 v[40:43], v5, s[8:11], s40 offen offset:2048 sc1
    buffer_load_dwordx4 v[44:47], v5, s[8:11], s40 offen offset:3072 sc1
    s_waitcnt lgkmcnt(0)
ct_p619:
    s_cbranch_execz ct_p714
L_sd_19_0_0:
    s_waitcnt vmcnt(11)
    v_max3_u32 v20, v148, v149, v150
    v_mfma_f32_16x16x32_bf16 v[88:91], v[148:151], v[148:151], 0
    v_max_u32 v20, v20, v151
    v_cmp_eq_u32 vcc, -1, v20
    v_mfma_f32_16x16x32_bf16 v[84:87], v[120:123], v[148:151], 0
    v_mfma_f32_16x16x32_bf16 v[80:83], v[104:107], v[148:151], 0
    s_cbranch_vccnz L_sd_19_1_0
L_sd_19_0_1:
    s_waitcnt vmcnt(10)
    v_max3_u32 v20, v152, v153, v154
    v_mfma_f32_16x16x32_bf16 v[100:103], v[152:155], v[152:155], v[88:91]
    v_max_u32 v20, v20, v155
    v_cmp_eq_u32 vcc, -1, v20
    v_mfma_f32_16x16x32_bf16 v[96:99], v[124:127], v[152:155], v[84:87]
    v_mfma_f32_16x16x32_bf16 v[92:95], v[108:111], v[152:155], v[80:83]
    s_cbranch_vccnz L_sd_19_1_1
L_sd_19_0_2:
    s_waitcnt vmcnt(9)
    v_max3_u32 v20, v156, v157, v158
    v_mfma_f32_16x16x32_bf16 v[228:231], v[156:159], v[156:159], v[100:103]
    v_max_u32 v20, v20, v159
    v_cmp_eq_u32 vcc, -1, v20
    v_mfma_f32_16x16x32_bf16 v[224:227], v[128:131], v[156:159], v[96:99]
    v_mfma_f32_16x16x32_bf16 v[220:223], v[112:115], v[156:159], v[92:95]
    s_cbranch_vccnz L_sd_19_1_2
L_sd_19_0_3:
    s_waitcnt vmcnt(8)
    v_max3_u32 v20, v160, v161, v162
    v_mfma_f32_16x16x32_bf16 v[188:191], v[160:163], v[160:163], v[228:231]
    v_max_u32_e64 v20, v20, v163
    v_cmp_eq_u32 vcc, -1, v20
    v_mfma_f32_16x16x32_bf16 v[184:187], v[132:135], v[160:163], v[224:227]
    v_mfma_f32_16x16x32_bf16 v[180:183], v[116:119], v[160:163], v[220:223]
    v_mov_b32_dpp v188, v189 row_ror:8 row_mask:0xf bank_mask:0xc
    v_mov_b32_dpp v190, v191 row_ror:8 row_mask:0xf bank_mask:0xc
    s_cbranch_vccnz L_sd_19_1_3
L_sd_19:
    s_barrier
    v_permlane32_swap_b32 v188, v190
    ds_read_b64 v[144:145], v26 offset:28672
    s_cmp_eq_u32 s19, 63
    s_cbranch_scc1 chain_kernel_fin
    v_mov_b32_dpp v180, v184 row_ror:8 row_mask:0xf bank_mask:0xc
    v_mov_b32_dpp v181, v185 row_ror:8 row_mask:0xf bank_mask:0xc
    v_mov_b32_dpp v182, v186 row_ror:8 row_mask:0xf bank_mask:0xc
    v_mov_b32_dpp v183, v187 row_ror:8 row_mask:0xf bank_mask:0xc
    v_max3_f32 v208, v190, v180, v181
    v_max3_f32 v208, v208, v182, v183
    v_cvt_pk_bf16_f32 v180, 0, v180
    v_cvt_pk_bf16_f32 v181, 0, v181
    v_max_f32_dpp v208, v208, v208 row_ror:8 row_mask:0xf bank_mask:0xf
    v_mov_b32_e64 v209, v208
    v_cvt_pk_bf16_f32 v182, 0, v182
    v_cvt_pk_bf16_f32 v183, 0, v183
    v_permlane16_swap_b32 v208, v209
    v_cvt_pk_bf16_f32 v190, 0, v190
    v_max_f32 v208, v208, v209
    v_mov_b32_e64 v209, v208
    v_pk_mul_f32 v[180:181], v[180:181], s[58:59]
    v_pk_mul_f32 v[182:183], v[182:183], s[58:59]
    v_permlane32_swap_b32 v208, v209
    v_mul_f32 v190, s58, v190
    v_max_f32_e64 v208, v208, v209
    v_cvt_pk_bf16_f32 v190, 0, v190
    v_cvt_pk_bf16_f32 v208, 0, v208
    v_cvt_pk_bf16_f32 v180, 0, v180
    v_mul_f32_e64 v208, s58, v208
    v_cvt_pk_bf16_f32 v181, 0, v181
    v_cvt_pk_bf16_f32 v208, 0, v208
    v_cvt_pk_bf16_f32 v182, 0, v182
    v_mul_f32_e64 v208, s56, v208
    v_cvt_pk_bf16_f32 v183, 0, v183
    v_fma_f32 v190, v190, s56, -v208
    v_pk_fma_f32 v[180:181], v[180:181], s[56:57], v[208:209] op_sel_hi:[1,1,0] neg_lo:[0,0,1] neg_hi:[0,0,1]
    v_exp_f32_e64 v190, v190
    v_pk_fma_f32 v[182:183], v[182:183], s[56:57], v[208:209] op_sel_hi:[1,1,0] neg_lo:[0,0,1] neg_hi:[0,0,1]
    v_exp_f32 v180, v180
    v_mov_b32_dpp v209, v190 row_ror:8 row_mask:0xf bank_mask:0xf
    v_exp_f32 v181, v181
    v_cvt_pk_bf16_f32 v196, v190, v209
    v_cvt_pk_bf16_f32 v199, v190, v209
    v_exp_f32_e64 v182, v182
    v_mfma_f32_16x16x16_bf16 v[184:187], v[216:217], v[196:197], 0
    v_exp_f32 v183, v183
    s_waitcnt lgkmcnt(0)
    v_mfma_f32_16x16x16_bf16 v[200:203], v[144:145], v[196:197], 0
    v_cvt_pk_bf16_f32 v192, v180, v181
    v_cvt_pk_bf16_f32 v193, v182, v183
    v_mfma_f32_16x16x16_bf16 v[204:207], v[144:145], v[198:199], 0
    v_mov_b32_dpp v194, v192 row_ror:8 row_mask:0xf bank_mask:0xf
    v_mov_b32_dpp v195, v193 row_ror:8 row_mask:0xf bank_mask:0xf
    s_mov_b64 exec, s[24:25]
ct_p714:
    s_cbranch_execz ct_p747
    v_mfma_f32_16x16x32_bf16 v[184:187], v[216:219], v[192:195], v[184:187]
    v_mfma_f32_16x16x32_bf16 v[200:203], v[136:139], v[192:195], v[200:203]
    v_mfma_f32_16x16x32_bf16 v[204:207], v[140:143], v[192:195], v[204:207]
    s_nop 0
    v_rcp_f32_e64 v184, v184
    s_nop 1
    v_pk_mul_f32 v[200:201], v[200:201], v[184:185] op_sel_hi:[1,0]
    v_pk_mul_f32 v[202:203], v[202:203], v[184:185] op_sel_hi:[1,0]
    v_cvt_pk_bf16_f32 v200, v200, v201
    v_cvt_pk_bf16_f32 v201, v202, v203
    v_pk_mul_f32 v[204:205], v[204:205], v[184:185] op_sel_hi:[1,0]
    v_pk_mul_f32 v[206:207], v[206:207], v[184:185] op_sel_hi:[1,0]
    v_cvt_pk_bf16_f32 v202, v204, v205
    v_cvt_pk_bf16_f32 v203, v206, v207
    v_min_u32 v200, 0xfffffffe, v200
    v_min_u32 v201, 0xfffffffe, v201
    v_min_u32 v202, 0xfffffffe, v202
    v_min_u32 v203, 0xfffffffe, v203
    buffer_store_dwordx4 v[200:203], v6, s[8:11], s40 offen
    s_mov_b64 exec, -1
L_b4_17:
    s_barrier
    s_add_u32 s21, s19, 1
    s_min_u32 s21, s21, 63
    s_lshl_b32 s31, s21, 21
    s_lshl_b32 s21, s21, 13
    s_and_b32 s21, s21, 0x2000
    s_xor_b32 s21, s21, s48
    s_add_u32 s31, s31, s21
    s_add_u32 s19, s19, 1
    s_nop 14
ct_p747:
    s_cbranch_execz ct_p805
    s_nop 11
    buffer_load_dwordx4 v[32:35], v3, s[8:11], s40 offen offset:0 sc1
    s_nop 13
    buffer_load_dwordx4 v[36:39], v3, s[8:11], s40 offen offset:1024 sc1
    s_nop 13
    buffer_load_dwordx4 v[40:43], v3, s[8:11], s40 offen offset:2048 sc1
    s_nop 13
    buffer_load_dwordx4 v[44:47], v3, s[8:11], s40 offen offset:3072 sc1
Go_20_s0123:
    s_waitcnt vmcnt(3)
    v_cmp_eq_u32_e64 vcc, -1, v32
    v_mov_b32_dpp v48, v32 row_ror:8 row_mask:0xf bank_mask:0xf
    v_mov_b32_dpp v49, v33 row_ror:8 row_mask:0xf bank_mask:0xf
    v_mov_b32_dpp v50, v34 row_ror:8 row_mask:0xf bank_mask:0xf
    v_mov_b32_dpp v51, v35 row_ror:8 row_mask:0xf bank_mask:0xf
    s_cbranch_vccnz Go_20_f0123
    v_smfmac_f32_16x16x64_bf16 v[76:79], v[32:35], a[192:199], v19
    v_smfmac_f32_16x16x64_bf16 v[76:79], v[48:51], a[224:231], v19
Go_20_s123:
    s_waitcnt vmcnt(2)
    v_cmp_eq_u32_e64 vcc, -1, v36
    v_mov_b32_dpp v52, v36 row_ror:8 row_mask:0xf bank_mask:0xf
    v_mov_b32_dpp v53, v37 row_ror:8 row_mask:0xf bank_mask:0xf
    v_mov_b32_dpp v54, v38 row_ror:8 row_mask:0xf bank_mask:0xf
    v_mov_b32_dpp v55, v39 row_ror:8 row_mask:0xf bank_mask:0xf
    s_cbranch_vccnz Go_20_f123
    v_smfmac_f32_16x16x64_bf16 v[76:79], v[36:39], a[200:207], v19
    v_smfmac_f32_16x16x64_bf16 v[76:79], v[52:55], a[232:239], v19
Go_20_s23:
    s_waitcnt vmcnt(1)
    v_cmp_eq_u32_e64 vcc, -1, v40
    v_mov_b32_dpp v56, v40 row_ror:8 row_mask:0xf bank_mask:0xf
    v_mov_b32_dpp v57, v41 row_ror:8 row_mask:0xf bank_mask:0xf
    v_mov_b32_dpp v58, v42 row_ror:8 row_mask:0xf bank_mask:0xf
    v_mov_b32_dpp v59, v43 row_ror:8 row_mask:0xf bank_mask:0xf
    s_cbranch_vccnz Go_20_f23
    v_smfmac_f32_16x16x64_bf16 v[76:79], v[40:43], a[208:215], v19
    v_smfmac_f32_16x16x64_bf16 v[76:79], v[56:59], a[240:247], v19
Go_20_s3:
    s_waitcnt vmcnt(0)
    v_cmp_eq_u32 vcc, -1, v44
    v_mov_b32_dpp v60, v44 row_ror:8 row_mask:0xf bank_mask:0xf
    v_mov_b32_dpp v61, v45 row_ror:8 row_mask:0xf bank_mask:0xf
    v_mov_b32_dpp v62, v46 row_ror:8 row_mask:0xf bank_mask:0xf
    v_mov_b32_dpp v63, v47 row_ror:8 row_mask:0xf bank_mask:0xf
    s_cbranch_vccnz Go_20_f3
    v_smfmac_f32_16x16x64_bf16 v[76:79], v[44:47], a[216:223], v19
    v_smfmac_f32_16x16x64_bf16 v[76:79], v[60:63], a[248:255], v19
Go_20_done:
    v_max3_u32 v20, v33, v34, v35
    v_max3_u32 v208, v37, v38, v39
    v_max3_u32 v209, v41, v42, v43
    v_max3_u32 v210, v45, v46, v47
    v_max_u32 v20, v20, v208
    v_max3_u32 v20, v20, v209, v210
    v_cmp_eq_u32 vcc, -1, v20
ct_p805:
    s_cbranch_execz ct_p846
    ds_write_b32 v238, v76 offset:20480
    ds_write_b32 v239, v77 offset:20480
    ds_write_b32 v240, v78 offset:20480
    s_cbranch_vccnz Go_20_redo
    s_waitcnt lgkmcnt(0)
    s_barrier
    ds_read_b32 v80, v17 offset:20480
    ds_read_b32 v81, v17 offset:20736
    ds_read_b32 v82, v17 offset:20992
    s_cmp_lt_u32 s18, 2
    s_waitcnt lgkmcnt(2)
    v_add_f32 v80, v80, v79
    s_waitcnt lgkmcnt(0)
    v_add_f32 v81, v81, v82
    v_add_f32 v80, v80, v81
    v_cvt_pk_bf16_f32 v80, 0, v80
    v_min_u32 v80, 0xfffe0000, v80
    buffer_store_short_d16_hi v80, v8, s[8:11], s43 offen sc1
    buffer_store_short_d16_hi v80, v8, s[8:11], s44 offen sc1
    ds_read_b128 v[164:167], v241 offset:51200
    ds_read_b128 v[168:171], v241 offset:51712
    ds_read_b128 v[172:175], v241 offset:52224
    v_mov_b32 v220, 0
    v_mov_b32 v221, 0
    v_mov_b32 v222, 0
    v_mov_b32 v223, 0
    v_mov_b32 v224, 0
    v_mov_b32 v225, 0
    ds_read_b128 v[176:179], v241 offset:52736
    s_waitcnt lgkmcnt(3)
    v_mfma_f32_16x16x32_bf16 v[188:191], v[164:167], v[148:151], 0
    s_waitcnt lgkmcnt(2)
    v_mfma_f32_16x16x32_bf16 v[188:191], v[168:171], v[152:155], v[188:191]
    s_waitcnt lgkmcnt(1)
    v_mfma_f32_16x16x32_bf16 v[188:191], v[172:175], v[156:159], v[188:191]
    s_waitcnt lgkmcnt(0)
    v_mfma_f32_16x16x32_bf16 v[188:191], v[176:179], v[160:163], v[188:191]
    s_nop 6
ct_p846:
    s_cbranch_execz ct_p862
    v_cvt_pk_bf16_f32 v188, 0, v188
    v_cvt_pk_bf16_f32 v189, 0, v189
    v_pk_mul_f32 v[188:189], v[188:189], s[58:59]
    v_cvt_pk_bf16_f32 v188, 0, v188
    v_cvt_pk_bf16_f32 v189, 0, v189
    v_max3_f32 v86, v86, v188, v189
    v_mov_b32 v87, v86
    s_nop 1
    v_permlane16_swap_b32 v86, v87
    v_max_f32 v86, v86, v87
    buffer_load_short_d16_hi v220, v9, s[8:11], s43 offen sc1
    buffer_load_short_d16_hi v221, v10, s[8:11], s43 offen sc1
    buffer_load_short_d16_hi v222, v11, s[8:11], s43 offen sc1
    v_mov_b32 v87, v86
    s_nop 0
ct_p862:
    s_cbranch_execz ct_p892
    v_permlane32_swap_b32 v86, v87
    v_max_f32 v86, v86, v87
    v_mul_f32 v86, s56, v86
    v_pk_fma_f32 v[180:181], v[180:181], s[56:57], v[86:87] op_sel_hi:[1,1,0] neg_lo:[0,0,1] neg_hi:[0,0,1]
    v_pk_fma_f32 v[182:183], v[182:183], s[56:57], v[86:87] op_sel_hi:[1,1,0] neg_lo:[0,0,1] neg_hi:[0,0,1]
    v_pk_fma_f32 v[184:185], v[184:185], s[56:57], v[86:87] op_sel_hi:[1,1,0] neg_lo:[0,0,1] neg_hi:[0,0,1]
    v_pk_fma_f32 v[186:187], v[186:187], s[56:57], v[86:87] op_sel_hi:[1,1,0] neg_lo:[0,0,1] neg_hi:[0,0,1]
    v_pk_fma_f32 v[188:189], v[188:189], s[56:57], v[86:87] op_sel_hi:[1,1,0] neg_lo:[0,0,1] neg_hi:[0,0,1]
    v_exp_f32 v180, v180
    v_exp_f32 v181, v181
    v_exp_f32 v182, v182
    v_exp_f32 v183, v183
    v_exp_f32 v184, v184
    v_exp_f32 v185, v185
    v_exp_f32 v186, v186
    v_exp_f32 v187, v187
    v_exp_f32 v188, v188
    v_exp_f32 v189, v189
    v_pk_add_f32 v[88:89], v[180:181], v[182:183]
    v_pk_add_f32 v[90:91], v[184:185], v[186:187]
    buffer_load_short_d16_hi v223, v9, s[8:11], s44 offen sc1
    buffer_load_short_d16_hi v224, v10, s[8:11], s44 offen sc1
    buffer_load_short_d16_hi v225, v11, s[8:11], s44 offen sc1
    s_add_u32 m0, s51, 43008
    v_pk_add_f32 v[88:89], v[88:89], v[188:189]
    v_pk_add_f32 v[88:89], v[88:89], v[90:91]
    v_add_f32 v88, v88, v89
    v_mov_b32 v87, v88
    s_nop 0
ct_p892:
    s_cbranch_execz ct_p918
    v_permlane16_swap_b32 v88, v87
    buffer_load_dwordx4 v244, s[8:11], s31 offen offset:0 lds
    v_add_f32 v88, v88, v87
    v_mov_b32 v87, v88
    s_nop 1
    v_permlane32_swap_b32 v88, v87
    v_add_f32 v88, v88, v87
    v_rcp_f32 v88, v88
    buffer_load_dwordx4 v244, s[8:11], s31 offen offset:1024 lds
    s_nop 0
    v_pk_mul_f32 v[180:181], v[180:181], v[88:89] op_sel_hi:[1,0]
    v_pk_mul_f32 v[182:183], v[182:183], v[88:89] op_sel_hi:[1,0]
    v_pk_mul_f32 v[184:185], v[184:185], v[88:89] op_sel_hi:[1,0]
    v_pk_mul_f32 v[186:187], v[186:187], v[88:89] op_sel_hi:[1,0]
    v_pk_mul_f32 v[188:189], v[188:189], v[88:89] op_sel_hi:[1,0]
    v_cvt_pk_bf16_f32 v192, v180, v181
    v_cvt_pk_bf16_f32 v193, v182, v183
    v_cvt_pk_bf16_f32 v194, v184, v185
    v_cvt_pk_bf16_f32 v195, v186, v187
    v_cvt_pk_bf16_f32 v196, v188, v189
    v_cvt_pk_bf16_f32 v199, v188, v189
    v_mfma_f32_16x16x32_bf16 v[200:203], v[136:139], v[192:195], 0
    v_mfma_f32_16x16x32_bf16 v[204:207], v[140:143], v[192:195], 0
    v_mfma_f32_16x16x16_bf16 v[200:203], v[144:145], v[196:197], v[200:203]
    v_mfma_f32_16x16x16_bf16 v[204:207], v[144:145], v[198:199], v[204:207]
ct_p918:
    s_cbranch_execz ct_p936
    s_waitcnt vmcnt(7)
    v_add_f32 v208, v80, v220
    s_waitcnt vmcnt(5)
    v_max3_u32 v20, v220, v221, v222
    v_add_f32 v209, v221, v222
    v_cmp_eq_u32 vcc, 0xffff0000, v20
    v_add_f32 v208, v208, v209
    s_nop 1
    v_mov_b32_dpp v209, v208 quad_perm:[1,0,3,2] row_mask:0xf bank_mask:0xf
    s_mov_b64 exec, s[26:27]
    v_cvt_pk_bf16_f32 v208, v208, v209
    v_min_u32 v208, 0xfffffffe, v208
    s_cbranch_vccnz L_pf_22
L_pd_21:
    buffer_store_dword v208, v7, s[8:11], s41 offen
    s_mov_b64 exec, -1
    s_branch chain_kernel_loop
ct_p936:
    s_cbranch_execz ct_p958
L_help_16:
    s_waitcnt vmcnt(1) lgkmcnt(0)
    s_barrier
    s_cmp_ge_u32 s18, 2
    s_cbranch_scc1 L_w2_26
    ds_read_b128 v[80:83], v1 offset:12288
    ds_read_b128 v[84:87], v1 offset:14336
    ds_read_b128 v[88:91], v1 offset:15360
    s_waitcnt lgkmcnt(2)
    v_pk_add_f32 v[72:73], v[72:73], v[82:83]
    v_pk_add_f32 v[74:75], v[74:75], v[80:81]
    s_waitcnt lgkmcnt(1)
    v_pk_add_f32 v[72:73], v[72:73], v[86:87]
    v_pk_add_f32 v[74:75], v[74:75], v[84:85]
    s_waitcnt lgkmcnt(0)
    v_pk_add_f32 v[72:73], v[72:73], v[88:89]
    v_pk_add_f32 v[74:75], v[74:75], v[90:91]
    v_cvt_pk_bf16_f32 v144, v72, v73
    v_cvt_pk_bf16_f32 v145, v74, v75
    s_nop 0
ct_p958:
    s_cbranch_execz ct_ret1
    v_permlane32_swap_b32 v144, v145
    s_nop 1
    ds_write_b64 v234, v[144:145] offset:28672
    s_add_u32 s21, s19, 1
    s_min_u32 s21, s21, 63
    s_lshl_b32 s63, s21, 21
    s_lshl_b32 s21, s21, 13
    s_and_b32 s21, s21, 0x2000
    s_xor_b32 s21, s21, s48
    s_add_u32 s63, s63, s21
    s_nop 15
    s_nop 15
    s_nop 0
    buffer_load_dword v250, v25, s[8:11], s63 offen sc1
    s_add_u32 s20, s19, 2
    s_min_u32 s20, s20, 63
    s_bfm_b64 s[22:23], s20, 0
    s_and_b32 s22, s22, 0x204225f
    s_and_b32 s23, s23, 0x80004004
    s_bcnt1_i32_b64 s32, s[22:23]
    s_lshl_b32 s32, s32, 2
    s_add_u32 s32, s32, 64
    s_cmp_eq_u32 s47, 1
    s_cselect_b32 s32, s32, s55
    s_add_u32 s21, s19, 1
    s_min_u32 s21, s21, 63
    s_lshl_b32 s31, s21, 21
    s_lshl_b32 s21, s21, 13
    s_and_b32 s21, s21, 0x2000
    s_xor_b32 s21, s21, s48
    s_add_u32 s31, s31, s21
    s_waitcnt lgkmcnt(0)
    s_cmp_eq_u32 s32, s55
    s_cbranch_scc1 L_nog_29
    s_load_dword s22, s[60:61], s32 glc
L_nog_29:
    s_mov_b32 s23, 1
    s_barrier
    s_cmp_lg_u32 s19, 0
    s_cbranch_scc1 L_ns0_32
    v_mov_b32 v248, 0
    s_lshl2_add_u32 s20, s17, s18
    s_cmp_lg_u32 s20, 5
    s_cbranch_scc1 L_rlo_34
L_rl_33:
    s_load_dword s20, s[60:61], 68 glc
    s_add_u32 s33, s33, 1
    s_cmp_gt_u32 s33, 0x100000
    s_cbranch_scc1 chain_kernel_abort
    s_waitcnt lgkmcnt(0)
    s_cmp_lt_u32 s20, 96
    s_cbranch_scc1 L_rl_33
    v_mov_b32 v249, 2
    buffer_store_dword v249, v248, s[8:11], s62 offen offset:128
    s_branch L_rlok_35
ct_c3:
ct_p1014:
    s_cbranch_execz ct_p1054
L_rlo_34:
    buffer_load_dword v249, v248, s[8:11], s62 offen offset:128 sc1
    s_add_u32 s33, s33, 1
    s_cmp_gt_u32 s33, 0x100000
    s_cbranch_scc1 chain_kernel_abort
    s_waitcnt vmcnt(0)
    v_readfirstlane_b32 s20, v249
    s_cmp_ge_u32 s20, 2
    s_cbranch_scc1 L_rlok_35
    s_sleep 1
    s_branch L_rlo_34
L_rlok_35:
L_ns0_32:
    s_mov_b32 m0, 40960
    s_nop 0
    buffer_load_dwordx4 v237, s[8:11], s31 offen offset:0 lds
    buffer_load_dwordx4 v237, s[8:11], s31 offen offset:1024 lds
    s_cmp_lg_u32 s47, 0
    s_cbranch_scc1 L_nof_31
    s_atomic_add s23, s[60:61], 208
L_nof_31:
    buffer_store_dwordx4 v[28:31], v22, s[8:11], s42 offen
    s_lshl_b32 s21, s29, 9
    s_add_u32 s21, s21, s42
    buffer_store_dwordx2 v[28:29], v26, s[8:11], s21 offen
    s_xor_b32 s21, s21, 20480
    buffer_store_dwordx2 v[28:29], v26, s[8:11], s21 offen
    s_cmp_eq_u32 s32, s55
    s_cbranch_scc1 L_he_28
    s_mov_b32 s55, s32
L_gr_30:
    s_waitcnt lgkmcnt(0)
    s_cmp_ge_u32 s22, 96
    s_cbranch_scc1 L_he_28
    s_add_u32 s33, s33, 1
    s_cmp_gt_u32 s33, 0x100000
    s_cbranch_scc1 chain_kernel_abort
    s_load_dword s22, s[60:61], s32 glc
    s_branch L_gr_30
ct_p1054:
    s_cbranch_execz ct_p1095
L_w2_26:
    ds_read_b128 v[148:151], v242 offset:43008
    ds_read_b128 v[104:107], v1 offset:32768
    ds_read_b128 v[108:111], v1 offset:36864
    ds_read_b128 v[152:155], v242 offset:44032
    ds_read_b128 v[112:115], v1 offset:33792
    ds_read_b128 v[116:119], v1 offset:37888
    ds_read_b128 v[156:159], v242 offset:45056
    ds_read_b128 v[120:123], v1 offset:34816
    ds_read_b128 v[124:127], v1 offset:38912
    ds_read_b128 v[160:163], v242 offset:46080
    ds_read_b128 v[128:131], v1 offset:35840
    ds_read_b128 v[132:135], v1 offset:39936
    ds_read_b128 v[136:139], v1 offset:40960
    ds_read_b128 v[140:143], v1 offset:41984
    v_cvt_pk_bf16_f32 v200, v200, v201
    v_cvt_pk_bf16_f32 v201, v202, v203
    v_cvt_pk_bf16_f32 v202, v204, v205
    v_cvt_pk_bf16_f32 v203, v206, v207
    s_add_u32 s21, s19, -1
    s_lshl_b32 s32, s21, 21
    s_lshl_b32 s21, s21, 13
    s_and_b32 s21, s21, 0x2000
    s_xor_b32 s21, s21, s48
    s_add_u32 s32, s32, s21
    s_waitcnt lgkmcnt(11)
    v_mfma_f32_16x16x32_bf16 v[180:183], v[104:107], v[148:151], 0
    v_mfma_f32_16x16x32_bf16 v[184:187], v[108:111], v[148:151], 0
    s_waitcnt lgkmcnt(8)
    v_mfma_f32_16x16x32_bf16 v[180:183], v[112:115], v[152:155], v[180:183]
    v_mfma_f32_16x16x32_bf16 v[184:187], v[116:119], v[152:155], v[184:187]
    s_waitcnt lgkmcnt(5)
    v_mfma_f32_16x16x32_bf16 v[180:183], v[120:123], v[156:159], v[180:183]
    v_mfma_f32_16x16x32_bf16 v[184:187], v[124:127], v[156:159], v[184:187]
    s_waitcnt lgkmcnt(2)
    v_mfma_f32_16x16x32_bf16 v[180:183], v[128:131], v[160:163], v[180:183]
    v_mfma_f32_16x16x32_bf16 v[184:187], v[132:135], v[160:163], v[184:187]
    buffer_store_dwordx4 v[200:203], v23, s[8:11], s32 offen sc1
    s_nop 5
ct_p1095:
    s_cbranch_execz ct_p1130
    v_cvt_pk_bf16_f32 v180, 0, v180
    v_cvt_pk_bf16_f32 v181, 0, v181
    v_cvt_pk_bf16_f32 v182, 0, v182
    v_cvt_pk_bf16_f32 v183, 0, v183
    v_cvt_pk_bf16_f32 v184, 0, v184
    v_cvt_pk_bf16_f32 v185, 0, v185
    v_cvt_pk_bf16_f32 v186, 0, v186
    v_cvt_pk_bf16_f32 v187, 0, v187
    v_pk_mul_f32 v[180:181], v[180:181], s[58:59]
    v_pk_mul_f32 v[182:183], v[182:183], s[58:59]
    v_pk_mul_f32 v[184:185], v[184:185], s[58:59]
    v_pk_mul_f32 v[186:187], v[186:187], s[58:59]
    v_cvt_pk_bf16_f32 v180, 0, v180
    v_cvt_pk_bf16_f32 v181, 0, v181
    v_cvt_pk_bf16_f32 v182, 0, v182
    v_cvt_pk_bf16_f32 v183, 0, v183
    v_cvt_pk_bf16_f32 v184, 0, v184
    v_cvt_pk_bf16_f32 v185, 0, v185
    v_cvt_pk_bf16_f32 v186, 0, v186
    v_cvt_pk_bf16_f32 v187, 0, v187
    v_pk_add_f32 v[180:181], v[180:181], v[226:227]
    v_pk_add_f32 v[182:183], v[182:183], v[228:229]
    v_pk_add_f32 v[184:185], v[184:185], v[230:231]
    v_pk_add_f32 v[186:187], v[186:187], v[232:233]
    v_max3_f32 v86, v180, v181, v182
    v_max3_f32 v87, v183, v184, v185
    v_max3_f32 v86, v86, v186, v187
    v_max_f32_e64 v86, v86, v87
    s_cmp_eq_u32 s18, 3
    s_waitcnt lgkmcnt(0)
    s_barrier
    ds_read_b64 v[144:145], v26 offset:28672
    s_cbranch_scc0 L_w3_27
    s_mov_b32 m0, 51200
ct_p1130:
    s_cbranch_execz ct_p1157
    buffer_load_dwordx4 v24, s[8:11], s40 offen offset:0 sc1 lds
    s_mov_b32 m0, 50176
    s_nop 0
    buffer_load_dwordx4 v24, s[8:11], s40 offen offset:2048 sc1 lds
L_w3_27:
L_he_28:
    s_cmp_lg_u32 s19, 63
    s_cbranch_scc1 L_b4_17
chain_kernel_fin:
    s_waitcnt vmcnt(0) lgkmcnt(0)
    s_barrier
    s_cmp_lt_u32 s18, 2
    s_cbranch_scc1 L_f2_36
    ds_read_b128 v[164:167], v241 offset:51200
    ds_read_b128 v[168:171], v241 offset:51712
    ds_read_b128 v[172:175], v241 offset:52224
    ds_read_b128 v[176:179], v241 offset:52736
    s_waitcnt lgkmcnt(3)
    v_mfma_f32_16x16x32_bf16 v[188:191], v[164:167], v[148:151], 0
    s_waitcnt lgkmcnt(2)
    v_mfma_f32_16x16x32_bf16 v[188:191], v[168:171], v[152:155], v[188:191]
    s_waitcnt lgkmcnt(1)
    v_mfma_f32_16x16x32_bf16 v[188:191], v[172:175], v[156:159], v[188:191]
    s_waitcnt lgkmcnt(0)
    v_mfma_f32_16x16x32_bf16 v[188:191], v[176:179], v[160:163], v[188:191]
    s_nop 6
ct_p1157:
    s_cbranch_execz ct_p1170
    v_cvt_pk_bf16_f32 v188, 0, v188
    v_cvt_pk_bf16_f32 v189, 0, v189
    v_pk_mul_f32 v[188:189], v[188:189], s[58:59]
    v_cvt_pk_bf16_f32 v188, 0, v188
    v_cvt_pk_bf16_f32 v189, 0, v189
    v_max3_f32 v86, v86, v188, v189
    v_mov_b32 v87, v86
    s_nop 1
    v_permlane16_swap_b32 v86, v87
    v_max_f32 v86, v86, v87
    v_mov_b32 v87, v86
    s_nop 0
ct_p1170:
    s_cbranch_execz ct_p1196
    v_permlane32_swap_b32 v86, v87
    v_max_f32 v86, v86, v87
    v_mul_f32 v86, s56, v86
    v_pk_fma_f32 v[180:181], v[180:181], s[56:57], v[86:87] op_sel_hi:[1,1,0] neg_lo:[0,0,1] neg_hi:[0,0,1]
    v_pk_fma_f32 v[182:183], v[182:183], s[56:57], v[86:87] op_sel_hi:[1,1,0] neg_lo:[0,0,1] neg_hi:[0,0,1]
    v_pk_fma_f32 v[184:185], v[184:185], s[56:57], v[86:87] op_sel_hi:[1,1,0] neg_lo:[0,0,1] neg_hi:[0,0,1]
    v_pk_fma_f32 v[186:187], v[186:187], s[56:57], v[86:87] op_sel_hi:[1,1,0] neg_lo:[0,0,1] neg_hi:[0,0,1]
    v_pk_fma_f32 v[188:189], v[188:189], s[56:57], v[86:87] op_sel_hi:[1,1,0] neg_lo:[0,0,1] neg_hi:[0,0,1]
    v_exp_f32 v180, v180
    v_exp_f32 v181, v181
    v_exp_f32 v182, v182
    v_exp_f32 v183, v183
    v_exp_f32 v184, v184
    v_exp_f32 v185, v185
    v_exp_f32 v186, v186
    v_exp_f32 v187, v187
    v_exp_f32 v188, v188
    v_exp_f32 v189, v189
    v_pk_add_f32 v[88:89], v[180:181], v[182:183]
    v_pk_add_f32 v[90:91], v[184:185], v[186:187]
    v_pk_add_f32 v[88:89], v[88:89], v[188:189]
    v_pk_add_f32 v[88:89], v[88:89], v[90:91]
    v_add_f32 v88, v88, v89
    v_mov_b32 v87, v88
    s_nop 0
ct_p1196:
    s_cbranch_execz ct_p1228
    v_permlane16_swap_b32 v88, v87
    v_add_f32 v88, v88, v87
    v_mov_b32 v87, v88
    s_nop 1
    v_permlane32_swap_b32 v88, v87
    v_add_f32 v88, v88, v87
    v_rcp_f32 v88, v88
    s_nop 0
    v_pk_mul_f32 v[180:181], v[180:181], v[88:89] op_sel_hi:[1,0]
    v_pk_mul_f32 v[182:183], v[182:183], v[88:89] op_sel_hi:[1,0]
    v_pk_mul_f32 v[184:185], v[184:185], v[88:89] op_sel_hi:[1,0]
    v_pk_mul_f32 v[186:187], v[186:187], v[88:89] op_sel_hi:[1,0]
    v_pk_mul_f32 v[188:189], v[188:189], v[88:89] op_sel_hi:[1,0]
    v_cvt_pk_bf16_f32 v192, v180, v181
    v_cvt_pk_bf16_f32 v193, v182, v183
    v_cvt_pk_bf16_f32 v194, v184, v185
    v_cvt_pk_bf16_f32 v195, v186, v187
    v_cvt_pk_bf16_f32 v196, v188, v189
    v_cvt_pk_bf16_f32 v199, v188, v189
    v_mfma_f32_16x16x32_bf16 v[200:203], v[136:139], v[192:195], 0
    v_mfma_f32_16x16x32_bf16 v[204:207], v[140:143], v[192:195], 0
    v_mfma_f32_16x16x16_bf16 v[200:203], v[144:145], v[196:197], v[200:203]
    v_mfma_f32_16x16x16_bf16 v[204:207], v[144:145], v[198:199], v[204:207]
    s_add_u32 s21, s19, 0
    s_min_u32 s21, s21, 63
    s_lshl_b32 s32, s21, 21
    s_lshl_b32 s21, s21, 13
    s_and_b32 s21, s21, 0x2000
    s_xor_b32 s21, s21, s48
    s_add_u32 s32, s32, s21
    s_nop 0
ct_p1228:
    s_cbranch_execz ct_p1243
    v_cvt_pk_bf16_f32 v200, v200, v201
    v_cvt_pk_bf16_f32 v201, v202, v203
    v_cvt_pk_bf16_f32 v202, v204, v205
    v_cvt_pk_bf16_f32 v203, v206, v207
    buffer_store_dwordx4 v[200:203], v23, s[8:11], s32 offen sc1
    s_waitcnt vmcnt(0)
L_f2_36:
    s_barrier
    s_cmp_lg_u32 s18, 0
    s_cbranch_scc1 chain_kernel_done
    s_add_u32 s20, s62, 4096
    s_mov_b32 s21, 1
    s_atomic_add s21, s[100:101], s20
    s_branch chain_kernel_done
ct_p1243:
    s_cbranch_execz ct_p1245
Gq_18_f0123:
ct_p1245:
    s_cbranch_execz ct_p1260
    buffer_load_dwordx4 v[32:35], v2, s[8:11], s40 offen offset:0 sc1
    s_branch Gq_18_s1230
Gq_18_f123p0:
    buffer_load_dwordx4 v[36:39], v2, s[8:11], s40 offen offset:1024 sc1
    s_add_u32 s33, s33, 1
    s_cmp_gt_u32 s33, 0x100000
    s_cbranch_scc1 chain_kernel_abort
    s_branch Gq_18_s231
Gq_18_f23p1:
    buffer_load_dwordx4 v[40:43], v2, s[8:11], s40 offen offset:2048 sc1
    s_add_u32 s33, s33, 1
    s_cmp_gt_u32 s33, 0x100000
    s_cbranch_scc1 chain_kernel_abort
    s_branch Gq_18_s32
ct_p1260:
    s_cbranch_execz ct_p1288
Gq_18_f3p2:
    buffer_load_dwordx4 v[44:47], v2, s[8:11], s40 offen offset:3072 sc1
    s_add_u32 s33, s33, 1
    s_cmp_gt_u32 s33, 0x100000
    s_cbranch_scc1 chain_kernel_abort
    s_branch Gq_18_s3
    s_nop 0
Gq_18_redo:
    buffer_load_dwordx4 v[32:35], v2, s[8:11], s40 offen offset:0 sc1
    buffer_load_dwordx4 v[36:39], v2, s[8:11], s40 offen offset:1024 sc1
    buffer_load_dwordx4 v[40:43], v2, s[8:11], s40 offen offset:2048 sc1
    buffer_load_dwordx4 v[44:47], v2, s[8:11], s40 offen offset:3072 sc1
    s_add_u32 s33, s33, 1
    s_cmp_gt_u32 s33, 0x100000
    s_cbranch_scc1 chain_kernel_abort
    s_nop 5
    v_mov_b32_e64 v64, 0
    v_mov_b32 v65, 0
    v_mov_b32 v66, 0
    v_mov_b32 v67, 0
    v_mov_b32 v68, 0
    v_mov_b32 v69, 0
    v_mov_b32 v70, 0
    v_mov_b32 v71, 0
    v_mov_b32 v72, 0
    v_mov_b32 v73, 0
    v_mov_b32 v74, 0
    v_mov_b32 v75, 0
ct_p1288:
    s_cbranch_execz ct_ret2
    s_branch Gq_18_s0123
Gq_18_s1230:
    s_waitcnt vmcnt(3)
    v_cmp_eq_u32 vcc, -1, v36
    v_mov_b32_dpp v52, v36 row_ror:8 row_mask:0xf bank_mask:0xf
    v_mov_b32_dpp v53, v37 row_ror:8 row_mask:0xf bank_mask:0xf
    v_mov_b32_dpp v54, v38 row_ror:8 row_mask:0xf bank_mask:0xf
    v_mov_b32_dpp v55, v39 row_ror:8 row_mask:0xf bank_mask:0xf
    s_cbranch_vccnz Gq_18_f1230
    v_smfmac_f32_16x16x64_bf16 v[64:67], v[36:39], a[8:15], v19
    v_smfmac_f32_16x16x64_bf16 v[68:71], v[36:39], a[72:79], v19
Gq_18_s230p1:
    s_waitcnt vmcnt(2)
    v_cmp_eq_u32_e64 vcc, -1, v40
    v_smfmac_f32_16x16x64_bf16 v[64:67], v[52:55], a[40:47], v19
    v_mov_b32_dpp v56, v40 row_ror:8 row_mask:0xf bank_mask:0xf
    v_mov_b32_dpp v57, v41 row_ror:8 row_mask:0xf bank_mask:0xf
    v_smfmac_f32_16x16x64_bf16 v[68:71], v[52:55], a[104:111], v19
    v_mov_b32_dpp v58, v42 row_ror:8 row_mask:0xf bank_mask:0xf
    v_mov_b32_dpp v59, v43 row_ror:8 row_mask:0xf bank_mask:0xf
    s_cbranch_vccnz Gq_18_f230p1
    v_smfmac_f32_16x16x64_bf16 v[64:67], v[40:43], a[16:23], v19
ct_c4:
ct_p1311:
    s_cbranch_execz ct_p1333
    v_smfmac_f32_16x16x64_bf16 v[68:71], v[40:43], a[80:87], v19
Gq_18_s30p2:
    s_waitcnt vmcnt(1)
    v_cmp_eq_u32 vcc, -1, v44
    v_smfmac_f32_16x16x64_bf16 v[64:67], v[56:59], a[48:55], v19
    v_mov_b32_dpp v60, v44 row_ror:8 row_mask:0xf bank_mask:0xf
    v_mov_b32_dpp v61, v45 row_ror:8 row_mask:0xf bank_mask:0xf
    v_smfmac_f32_16x16x64_bf16 v[68:71], v[56:59], a[112:119], v19
    v_mov_b32_dpp v62, v46 row_ror:8 row_mask:0xf bank_mask:0xf
    v_mov_b32_dpp v63, v47 row_ror:8 row_mask:0xf bank_mask:0xf
    s_cbranch_vccnz Gq_18_f30p2
    v_smfmac_f32_16x16x64_bf16 v[64:67], v[44:47], a[24:31], v19
    v_smfmac_f32_16x16x64_bf16 v[68:71], v[44:47], a[88:95], v19
Gq_18_s0p3:
    s_waitcnt vmcnt(0)
    v_cmp_eq_u32_e64 vcc, -1, v32
    v_smfmac_f32_16x16x64_bf16 v[64:67], v[60:63], a[56:63], v19
    v_mov_b32_dpp v48, v32 row_ror:8 row_mask:0xf bank_mask:0xf
    v_mov_b32_dpp v49, v33 row_ror:8 row_mask:0xf bank_mask:0xf
    v_smfmac_f32_16x16x64_bf16 v[68:71], v[60:63], a[120:127], v19
    v_mov_b32_dpp v50, v34 row_ror:8 row_mask:0xf bank_mask:0xf
ct_p1333:
    s_cbranch_execz ct_p1347
    v_mov_b32_dpp v51, v35 row_ror:8 row_mask:0xf bank_mask:0xf
    s_cbranch_vccnz Gq_18_f0p3
    v_smfmac_f32_16x16x64_bf16 v[64:67], v[32:35], a[0:7], v19
    v_smfmac_f32_16x16x64_bf16 v[68:71], v[32:35], a[64:71], v19
    v_smfmac_f32_16x16x64_bf16 v[64:67], v[48:51], a[32:39], v19
    v_smfmac_f32_16x16x64_bf16 v[68:71], v[48:51], a[96:103], v19
    s_branch Gq_18_done
Gq_18_f1230:
    buffer_load_dwordx4 v[36:39], v2, s[8:11], s40 offen offset:1024 sc1
    s_add_u32 s33, s33, 1
    s_cmp_gt_u32 s33, 0x100000
    s_cbranch_scc1 chain_kernel_abort
    s_branch Gq_18_s2301
ct_p1347:
    s_cbranch_execz ct_p1366
Gq_18_f230p1:
    buffer_load_dwordx4 v[40:43], v2, s[8:11], s40 offen offset:2048 sc1
    s_add_u32 s33, s33, 1
    s_cmp_gt_u32 s33, 0x100000
    s_cbranch_scc1 chain_kernel_abort
    s_branch Gq_18_s302
Gq_18_f30p2:
    buffer_load_dwordx4 v[44:47], v2, s[8:11], s40 offen offset:3072 sc1
    s_add_u32 s33, s33, 1
    s_cmp_gt_u32 s33, 0x100000
    s_cbranch_scc1 chain_kernel_abort
    s_branch Gq_18_s03
Gq_18_f0p3:
    buffer_load_dwordx4 v[32:35], v2, s[8:11], s40 offen offset:0 sc1
    s_add_u32 s33, s33, 1
    s_cmp_gt_u32 s33, 0x100000
    s_cbranch_scc1 chain_kernel_abort
    s_branch Gq_18_s0
ct_p1366:
    s_cbranch_execz ct_p1388
Gq_18_s231:
    s_waitcnt vmcnt(2)
    v_cmp_eq_u32_e64 vcc, -1, v40
    v_mov_b32_dpp v56, v40 row_ror:8 row_mask:0xf bank_mask:0xf
    v_mov_b32_dpp v57, v41 row_ror:8 row_mask:0xf bank_mask:0xf
    v_mov_b32_dpp v58, v42 row_ror:8 row_mask:0xf bank_mask:0xf
    v_mov_b32_dpp v59, v43 row_ror:8 row_mask:0xf bank_mask:0xf
    s_cbranch_vccnz Gq_18_f231
    v_smfmac_f32_16x16x64_bf16 v[64:67], v[40:43], a[16:23], v19
    v_smfmac_f32_16x16x64_bf16 v[68:71], v[40:43], a[80:87], v19
Gq_18_s31p2:
    s_waitcnt vmcnt(1)
    v_cmp_eq_u32_e64 vcc, -1, v44
    v_smfmac_f32_16x16x64_bf16 v[64:67], v[56:59], a[48:55], v19
    v_mov_b32_dpp v60, v44 row_ror:8 row_mask:0xf bank_mask:0xf
    v_mov_b32_dpp v61, v45 row_ror:8 row_mask:0xf bank_mask:0xf
    v_smfmac_f32_16x16x64_bf16 v[68:71], v[56:59], a[112:119], v19
    v_mov_b32_dpp v62, v46 row_ror:8 row_mask:0xf bank_mask:0xf
    v_mov_b32_dpp v63, v47 row_ror:8 row_mask:0xf bank_mask:0xf
    s_cbranch_vccnz Gq_18_f31p2
    v_smfmac_f32_16x16x64_bf16 v[64:67], v[44:47], a[24:31], v19
ct_p1388:
    s_cbranch_execz ct_p1405
    v_smfmac_f32_16x16x64_bf16 v[68:71], v[44:47], a[88:95], v19
Gq_18_s1p3:
    s_waitcnt vmcnt(0)
    v_cmp_eq_u32 vcc, -1, v36
    v_smfmac_f32_16x16x64_bf16 v[64:67], v[60:63], a[56:63], v19
    v_mov_b32_dpp v52, v36 row_ror:8 row_mask:0xf bank_mask:0xf
    v_mov_b32_dpp v53, v37 row_ror:8 row_mask:0xf bank_mask:0xf
    v_smfmac_f32_16x16x64_bf16 v[68:71], v[60:63], a[120:127], v19
    v_mov_b32_dpp v54, v38 row_ror:8 row_mask:0xf bank_mask:0xf
    v_mov_b32_dpp v55, v39 row_ror:8 row_mask:0xf bank_mask:0xf
    s_cbranch_vccnz Gq_18_f1p3
    v_smfmac_f32_16x16x64_bf16 v[64:67], v[36:39], a[8:15], v19
    v_smfmac_f32_16x16x64_bf16 v[68:71], v[36:39], a[72:79], v19
    v_smfmac_f32_16x16x64_bf16 v[64:67], v[52:55], a[40:47], v19
    v_smfmac_f32_16x16x64_bf16 v[68:71], v[52:55], a[104:111], v19
    s_branch Gq_18_done
ct_p1405:
    s_cbranch_execz ct_p1424
Gq_18_f231:
    buffer_load_dwordx4 v[40:43], v2, s[8:11], s40 offen offset:2048 sc1
    s_add_u32 s33, s33, 1
    s_cmp_gt_u32 s33, 0x100000
    s_cbranch_scc1 chain_kernel_abort
    s_branch Gq_18_s312
Gq_18_f31p2:
    buffer_load_dwordx4 v[44:47], v2, s[8:11], s40 offen offset:3072 sc1
    s_add_u32 s33, s33, 1
    s_cmp_gt_u32 s33, 0x100000
    s_cbranch_scc1 chain_kernel_abort
    s_branch Gq_18_s13
Gq_18_f1p3:
    buffer_load_dwordx4 v[36:39], v2, s[8:11], s40 offen offset:1024 sc1
    s_add_u32 s33, s33, 1
    s_cmp_gt_u32 s33, 0x100000
    s_cbranch_scc1 chain_kernel_abort
    s_branch Gq_18_s1
ct_p1424:
    s_cbranch_execz ct_p1446
Gq_18_s32:
    s_waitcnt vmcnt(1)
    v_cmp_eq_u32_e64 vcc, -1, v44
    v_mov_b32_dpp v60, v44 row_ror:8 row_mask:0xf bank_mask:0xf
    v_mov_b32_dpp v61, v45 row_ror:8 row_mask:0xf bank_mask:0xf
    v_mov_b32_dpp v62, v46 row_ror:8 row_mask:0xf bank_mask:0xf
    v_mov_b32_dpp v63, v47 row_ror:8 row_mask:0xf bank_mask:0xf
    s_cbranch_vccnz Gq_18_f32
    v_smfmac_f32_16x16x64_bf16 v[64:67], v[44:47], a[24:31], v19
    v_smfmac_f32_16x16x64_bf16 v[68:71], v[44:47], a[88:95], v19
Gq_18_s2p3:
    s_waitcnt vmcnt(0)
    v_cmp_eq_u32_e64 vcc, -1, v40
    v_smfmac_f32_16x16x64_bf16 v[64:67], v[60:63], a[56:63], v19
    v_mov_b32_dpp v56, v40 row_ror:8 row_mask:0xf bank_mask:0xf
    v_mov_b32_dpp v57, v41 row_ror:8 row_mask:0xf bank_mask:0xf
    v_smfmac_f32_16x16x64_bf16 v[68:71], v[60:63], a[120:127], v19
    v_mov_b32_dpp v58, v42 row_ror:8 row_mask:0xf bank_mask:0xf
    v_mov_b32_dpp v59, v43 row_ror:8 row_mask:0xf bank_mask:0xf
    s_cbranch_vccnz Gq_18_f2p3
    v_smfmac_f32_16x16x64_bf16 v[64:67], v[40:43], a[16:23], v19
ct_p1446:
    s_cbranch_execz ct_p1463
    v_smfmac_f32_16x16x64_bf16 v[68:71], v[40:43], a[80:87], v19
    v_smfmac_f32_16x16x64_bf16 v[64:67], v[56:59], a[48:55], v19
    v_smfmac_f32_16x16x64_bf16 v[68:71], v[56:59], a[112:119], v19
    s_branch Gq_18_done
Gq_18_f32:
    buffer_load_dwordx4 v[44:47], v2, s[8:11], s40 offen offset:3072 sc1
    s_add_u32 s33, s33, 1
    s_cmp_gt_u32 s33, 0x100000
    s_cbranch_scc1 chain_kernel_abort
    s_branch Gq_18_s23
Gq_18_f2p3:
    buffer_load_dwordx4 v[40:43], v2, s[8:11], s40 offen offset:2048 sc1
    s_add_u32 s33, s33, 1
    s_cmp_gt_u32 s33, 0x100000
    s_cbranch_scc1 chain_kernel_abort
    s_branch Gq_18_s2
ct_p1463:
    s_cbranch_execz ct_p1477
Gq_18_s3:
    s_waitcnt vmcnt(0)
    v_cmp_eq_u32 vcc, -1, v44
    v_mov_b32_dpp v60, v44 row_ror:8 row_mask:0xf bank_mask:0xf
    v_mov_b32_dpp v61, v45 row_ror:8 row_mask:0xf bank_mask:0xf
    v_mov_b32_dpp v62, v46 row_ror:8 row_mask:0xf bank_mask:0xf
    v_mov_b32_dpp v63, v47 row_ror:8 row_mask:0xf bank_mask:0xf
    s_cbranch_vccnz Gq_18_f3
    v_smfmac_f32_16x16x64_bf16 v[64:67], v[44:47], a[24:31], v19
    v_smfmac_f32_16x16x64_bf16 v[68:71], v[44:47], a[88:95], v19
    v_smfmac_f32_16x16x64_bf16 v[64:67], v[60:63], a[56:63], v19
    v_smfmac_f32_16x16x64_bf16 v[68:71], v[60:63], a[120:127], v19
    s_branch Gq_18_done
ct_p1477:
    s_cbranch_execz ct_p1501
Gq_18_f3:
    buffer_load_dwordx4 v[44:47], v2, s[8:11], s40 offen offset:3072 sc1
    s_add_u32 s33, s33, 1
    s_cmp_gt_u32 s33, 0x100000
    s_cbranch_scc1 chain_kernel_abort
    s_branch Gq_18_s3
Gq_18_s2301:
    s_waitcnt vmcnt(3)
    v_cmp_eq_u32 vcc, -1, v40
    v_mov_b32_dpp v56, v40 row_ror:8 row_mask:0xf bank_mask:0xf
    v_mov_b32_dpp v57, v41 row_ror:8 row_mask:0xf bank_mask:0xf
    v_mov_b32_dpp v58, v42 row_ror:8 row_mask:0xf bank_mask:0xf
    v_mov_b32_dpp v59, v43 row_ror:8 row_mask:0xf bank_mask:0xf
    s_cbranch_vccnz Gq_18_f2301
    v_smfmac_f32_16x16x64_bf16 v[64:67], v[40:43], a[16:23], v19
    v_smfmac_f32_16x16x64_bf16 v[68:71], v[40:43], a[80:87], v19
Gq_18_s301p2:
    s_waitcnt vmcnt(2)
    v_cmp_eq_u32_e64 vcc, -1, v44
    v_smfmac_f32_16x16x64_bf16 v[64:67], v[56:59], a[48:55], v19
    v_mov_b32_dpp v60, v44 row_ror:8 row_mask:0xf bank_mask:0xf
    v_mov_b32_dpp v61, v45 row_ror:8 row_mask:0xf bank_mask:0xf
    v_smfmac_f32_16x16x64_bf16 v[68:71], v[56:59], a[112:119], v19
ct_p1501:
    s_cbranch_execz ct_p1523
    v_mov_b32_dpp v62, v46 row_ror:8 row_mask:0xf bank_mask:0xf
    v_mov_b32_dpp v63, v47 row_ror:8 row_mask:0xf bank_mask:0xf
    s_cbranch_vccnz Gq_18_f301p2
    v_smfmac_f32_16x16x64_bf16 v[64:67], v[44:47], a[24:31], v19
    v_smfmac_f32_16x16x64_bf16 v[68:71], v[44:47], a[88:95], v19
Gq_18_s01p3:
    s_waitcnt vmcnt(1)
    v_cmp_eq_u32 vcc, -1, v32
    v_smfmac_f32_16x16x64_bf16 v[64:67], v[60:63], a[56:63], v19
    v_mov_b32_dpp v48, v32 row_ror:8 row_mask:0xf bank_mask:0xf
    v_mov_b32_dpp v49, v33 row_ror:8 row_mask:0xf bank_mask:0xf
    v_smfmac_f32_16x16x64_bf16 v[68:71], v[60:63], a[120:127], v19
    v_mov_b32_dpp v50, v34 row_ror:8 row_mask:0xf bank_mask:0xf
    v_mov_b32_dpp v51, v35 row_ror:8 row_mask:0xf bank_mask:0xf
    s_cbranch_vccnz Gq_18_f01p3
    v_smfmac_f32_16x16x64_bf16 v[64:67], v[32:35], a[0:7], v19
    v_smfmac_f32_16x16x64_bf16 v[68:71], v[32:35], a[64:71], v19
Gq_18_s1p0:
    s_waitcnt vmcnt(0)
    v_cmp_eq_u32 vcc, -1, v36
    v_smfmac_f32_16x16x64_bf16 v[64:67], v[48:51], a[32:39], v19
ct_p1523:
    s_cbranch_execz ct_ret2
    v_mov_b32_dpp v52, v36 row_ror:8 row_mask:0xf bank_mask:0xf
    v_mov_b32_dpp v53, v37 row_ror:8 row_mask:0xf bank_mask:0xf
    v_smfmac_f32_16x16x64_bf16 v[68:71], v[48:51], a[96:103], v19
    v_mov_b32_dpp v54, v38 row_ror:8 row_mask:0xf bank_mask:0xf
    v_mov_b32_dpp v55, v39 row_ror:8 row_mask:0xf bank_mask:0xf
    s_cbranch_vccnz Gq_18_f1p0
    v_smfmac_f32_16x16x64_bf16 v[64:67], v[36:39], a[8:15], v19
    v_smfmac_f32_16x16x64_bf16 v[68:71], v[36:39], a[72:79], v19
    v_smfmac_f32_16x16x64_bf16 v[64:67], v[52:55], a[40:47], v19
    v_smfmac_f32_16x16x64_bf16 v[68:71], v[52:55], a[104:111], v19
    s_branch Gq_18_done
ct_c5:
ct_p1535:
    s_cbranch_execz ct_p1554
Gq_18_f2301:
    buffer_load_dwordx4 v[40:43], v2, s[8:11], s40 offen offset:2048 sc1
    s_add_u32 s33, s33, 1
    s_cmp_gt_u32 s33, 0x100000
    s_cbranch_scc1 chain_kernel_abort
    s_branch Gq_18_s3012
Gq_18_f301p2:
    buffer_load_dwordx4 v[44:47], v2, s[8:11], s40 offen offset:3072 sc1
    s_add_u32 s33, s33, 1
    s_cmp_gt_u32 s33, 0x100000
    s_cbranch_scc1 chain_kernel_abort
    s_branch Gq_18_s013
Gq_18_f01p3:
    buffer_load_dwordx4 v[32:35], v2, s[8:11], s40 offen offset:0 sc1
    s_add_u32 s33, s33, 1
    s_cmp_gt_u32 s33, 0x100000
    s_cbranch_scc1 chain_kernel_abort
    s_branch Gq_18_s10
ct_p1554:
    s_cbranch_execz ct_p1578
Gq_18_f1p0:
    buffer_load_dwordx4 v[36:39], v2, s[8:11], s40 offen offset:1024 sc1
    s_add_u32 s33, s33, 1
    s_cmp_gt_u32 s33, 0x100000
    s_cbranch_scc1 chain_kernel_abort
    s_branch Gq_18_s1
Gq_18_s302:
    s_waitcnt vmcnt(2)
    v_cmp_eq_u32 vcc, -1, v44
    v_mov_b32_dpp v60, v44 row_ror:8 row_mask:0xf bank_mask:0xf
    v_mov_b32_dpp v61, v45 row_ror:8 row_mask:0xf bank_mask:0xf
    v_mov_b32_dpp v62, v46 row_ror:8 row_mask:0xf bank_mask:0xf
    v_mov_b32_dpp v63, v47 row_ror:8 row_mask:0xf bank_mask:0xf
    s_cbranch_vccnz Gq_18_f302
    v_smfmac_f32_16x16x64_bf16 v[64:67], v[44:47], a[24:31], v19
    v_smfmac_f32_16x16x64_bf16 v[68:71], v[44:47], a[88:95], v19
Gq_18_s02p3:
    s_waitcnt vmcnt(1)
    v_cmp_eq_u32_e64 vcc, -1, v32
    v_smfmac_f32_16x16x64_bf16 v[64:67], v[60:63], a[56:63], v19
    v_mov_b32_dpp v48, v32 row_ror:8 row_mask:0xf bank_mask:0xf
    v_mov_b32_dpp v49, v33 row_ror:8 row_mask:0xf bank_mask:0xf
    v_smfmac_f32_16x16x64_bf16 v[68:71], v[60:63], a[120:127], v19
ct_p1578:
    s_cbranch_execz ct_p1598
    v_mov_b32_dpp v50, v34 row_ror:8 row_mask:0xf bank_mask:0xf
    v_mov_b32_dpp v51, v35 row_ror:8 row_mask:0xf bank_mask:0xf
    s_cbranch_vccnz Gq_18_f02p3
    v_smfmac_f32_16x16x64_bf16 v[64:67], v[32:35], a[0:7], v19
    v_smfmac_f32_16x16x64_bf16 v[68:71], v[32:35], a[64:71], v19
Gq_18_s2p0:
    s_waitcnt vmcnt(0)
    v_cmp_eq_u32 vcc, -1, v40
    v_smfmac_f32_16x16x64_bf16 v[64:67], v[48:51], a[32:39], v19
    v_mov_b32_dpp v56, v40 row_ror:8 row_mask:0xf bank_mask:0xf
    v_mov_b32_dpp v57, v41 row_ror:8 row_mask:0xf bank_mask:0xf
    v_smfmac_f32_16x16x64_bf16 v[68:71], v[48:51], a[96:103], v19
    v_mov_b32_dpp v58, v42 row_ror:8 row_mask:0xf bank_mask:0xf
    v_mov_b32_dpp v59, v43 row_ror:8 row_mask:0xf bank_mask:0xf
    s_cbranch_vccnz Gq_18_f2p0
    v_smfmac_f32_16x16x64_bf16 v[64:67], v[40:43], a[16:23], v19
    v_smfmac_f32_16x16x64_bf16 v[68:71], v[40:43], a[80:87], v19
    v_smfmac_f32_16x16x64_bf16 v[64:67], v[56:59], a[48:55], v19
    v_smfmac_f32_16x16x64_bf16 v[68:71], v[56:59], a[112:119], v19
ct_p1598:
    s_cbranch_execz ct_p1618
    s_branch Gq_18_done
Gq_18_f302:
    buffer_load_dwordx4 v[44:47], v2, s[8:11], s40 offen offset:3072 sc1
    s_add_u32 s33, s33, 1
    s_cmp_gt_u32 s33, 0x100000
    s_cbranch_scc1 chain_kernel_abort
    s_branch Gq_18_s023
Gq_18_f02p3:
    buffer_load_dwordx4 v[32:35], v2, s[8:11], s40 offen offset:0 sc1
    s_add_u32 s33, s33, 1
    s_cmp_gt_u32 s33, 0x100000
    s_cbranch_scc1 chain_kernel_abort
    s_branch Gq_18_s20
Gq_18_f2p0:
    buffer_load_dwordx4 v[40:43], v2, s[8:11], s40 offen offset:2048 sc1
    s_add_u32 s33, s33, 1
    s_cmp_gt_u32 s33, 0x100000
    s_cbranch_scc1 chain_kernel_abort
    s_branch Gq_18_s2
ct_p1618:
    s_cbranch_execz ct_p1640
Gq_18_s03:
    s_waitcnt vmcnt(1)
    v_cmp_eq_u32_e64 vcc, -1, v32
    v_mov_b32_dpp v48, v32 row_ror:8 row_mask:0xf bank_mask:0xf
    v_mov_b32_dpp v49, v33 row_ror:8 row_mask:0xf bank_mask:0xf
    v_mov_b32_dpp v50, v34 row_ror:8 row_mask:0xf bank_mask:0xf
    v_mov_b32_dpp v51, v35 row_ror:8 row_mask:0xf bank_mask:0xf
    s_cbranch_vccnz Gq_18_f03
    v_smfmac_f32_16x16x64_bf16 v[64:67], v[32:35], a[0:7], v19
    v_smfmac_f32_16x16x64_bf16 v[68:71], v[32:35], a[64:71], v19
Gq_18_s3p0:
    s_waitcnt vmcnt(0)
    v_cmp_eq_u32_e64 vcc, -1, v44
    v_smfmac_f32_16x16x64_bf16 v[64:67], v[48:51], a[32:39], v19
    v_mov_b32_dpp v60, v44 row_ror:8 row_mask:0xf bank_mask:0xf
    v_mov_b32_dpp v61, v45 row_ror:8 row_mask:0xf bank_mask:0xf
    v_smfmac_f32_16x16x64_bf16 v[68:71], v[48:51], a[96:103], v19
    v_mov_b32_dpp v62, v46 row_ror:8 row_mask:0xf bank_mask:0xf
    v_mov_b32_dpp v63, v47 row_ror:8 row_mask:0xf bank_mask:0xf
    s_cbranch_vccnz Gq_18_f3p0
    v_smfmac_f32_16x16x64_bf16 v[64:67], v[44:47], a[24:31], v19
ct_p1640:
    s_cbranch_execz ct_p1657
    v_smfmac_f32_16x16x64_bf16 v[68:71], v[44:47], a[88:95], v19
    v_smfmac_f32_16x16x64_bf16 v[64:67], v[60:63], a[56:63], v19
    v_smfmac_f32_16x16x64_bf16 v[68:71], v[60:63], a[120:127], v19
    s_branch Gq_18_done
Gq_18_f03:
    buffer_load_dwordx4 v[32:35], v2, s[8:11], s40 offen offset:0 sc1
    s_add_u32 s33, s33, 1
    s_cmp_gt_u32 s33, 0x100000
    s_cbranch_scc1 chain_kernel_abort
    s_branch Gq_18_s30
Gq_18_f3p0:
    buffer_load_dwordx4 v[44:47], v2, s[8:11], s40 offen offset:3072 sc1
    s_add_u32 s33, s33, 1
    s_cmp_gt_u32 s33, 0x100000
    s_cbranch_scc1 chain_kernel_abort
    s_branch Gq_18_s3
ct_p1657:
    s_cbranch_execz ct_p1671
Gq_18_s0:
    s_waitcnt vmcnt(0)
    v_cmp_eq_u32 vcc, -1, v32
    v_mov_b32_dpp v48, v32 row_ror:8 row_mask:0xf bank_mask:0xf
    v_mov_b32_dpp v49, v33 row_ror:8 row_mask:0xf bank_mask:0xf
    v_mov_b32_dpp v50, v34 row_ror:8 row_mask:0xf bank_mask:0xf
    v_mov_b32_dpp v51, v35 row_ror:8 row_mask:0xf bank_mask:0xf
    s_cbranch_vccnz Gq_18_f0
    v_smfmac_f32_16x16x64_bf16 v[64:67], v[32:35], a[0:7], v19
    v_smfmac_f32_16x16x64_bf16 v[68:71], v[32:35], a[64:71], v19
    v_smfmac_f32_16x16x64_bf16 v[64:67], v[48:51], a[32:39], v19
    v_smfmac_f32_16x16x64_bf16 v[68:71], v[48:51], a[96:103], v19
    s_branch Gq_18_done
ct_p1671:
    s_cbranch_execz ct_p1695
Gq_18_f0:
    buffer_load_dwordx4 v[32:35], v2, s[8:11], s40 offen offset:0 sc1
    s_add_u32 s33, s33, 1
    s_cmp_gt_u32 s33, 0x100000
    s_cbranch_scc1 chain_kernel_abort
    s_branch Gq_18_s0
Gq_18_s312:
    s_waitcnt vmcnt(2)
    v_cmp_eq_u32 vcc, -1, v44
    v_mov_b32_dpp v60, v44 row_ror:8 row_mask:0xf bank_mask:0xf
    v_mov_b32_dpp v61, v45 row_ror:8 row_mask:0xf bank_mask:0xf
    v_mov_b32_dpp v62, v46 row_ror:8 row_mask:0xf bank_mask:0xf
    v_mov_b32_dpp v63, v47 row_ror:8 row_mask:0xf bank_mask:0xf
    s_cbranch_vccnz Gq_18_f312
    v_smfmac_f32_16x16x64_bf16 v[64:67], v[44:47], a[24:31], v19
    v_smfmac_f32_16x16x64_bf16 v[68:71], v[44:47], a[88:95], v19
Gq_18_s12p3:
    s_waitcnt vmcnt(1)
    v_cmp_eq_u32_e64 vcc, -1, v36
    v_smfmac_f32_16x16x64_bf16 v[64:67], v[60:63], a[56:63], v19
    v_mov_b32_dpp v52, v36 row_ror:8 row_mask:0xf bank_mask:0xf
    v_mov_b32_dpp v53, v37 row_ror:8 row_mask:0xf bank_mask:0xf
    v_smfmac_f32_16x16x64_bf16 v[68:71], v[60:63], a[120:127], v19
ct_p1695:
    s_cbranch_execz ct_p1715
    v_mov_b32_dpp v54, v38 row_ror:8 row_mask:0xf bank_mask:0xf
    v_mov_b32_dpp v55, v39 row_ror:8 row_mask:0xf bank_mask:0xf
    s_cbranch_vccnz Gq_18_f12p3
    v_smfmac_f32_16x16x64_bf16 v[64:67], v[36:39], a[8:15], v19
    v_smfmac_f32_16x16x64_bf16 v[68:71], v[36:39], a[72:79], v19
Gq_18_s2p1:
    s_waitcnt vmcnt(0)
    v_cmp_eq_u32 vcc, -1, v40
    v_smfmac_f32_16x16x64_bf16 v[64:67], v[52:55], a[40:47], v19
    v_mov_b32_dpp v56, v40 row_ror:8 row_mask:0xf bank_mask:0xf
    v_mov_b32_dpp v57, v41 row_ror:8 row_mask:0xf bank_mask:0xf
    v_smfmac_f32_16x16x64_bf16 v[68:71], v[52:55], a[104:111], v19
    v_mov_b32_dpp v58, v42 row_ror:8 row_mask:0xf bank_mask:0xf
    v_mov_b32_dpp v59, v43 row_ror:8 row_mask:0xf bank_mask:0xf
    s_cbranch_vccnz Gq_18_f2p1
    v_smfmac_f32_16x16x64_bf16 v[64:67], v[40:43], a[16:23], v19
    v_smfmac_f32_16x16x64_bf16 v[68:71], v[40:43], a[80:87], v19
    v_smfmac_f32_16x16x64_bf16 v[64:67], v[56:59], a[48:55], v19
    v_smfmac_f32_16x16x64_bf16 v[68:71], v[56:59], a[112:119], v19
ct_p1715:
    s_cbranch_execz ct_p1735
    s_branch Gq_18_done
    s_nop 0
Gq_18_f312:
    buffer_load_dwordx4 v[44:47], v2, s[8:11], s40 offen offset:3072 sc1
    s_add_u32 s33, s33, 1
    s_cmp_gt_u32 s33, 0x100000
    s_cbranch_scc1 chain_kernel_abort
    s_branch Gq_18_s123
Gq_18_f12p3:
    buffer_load_dwordx4 v[36:39], v2, s[8:11], s40 offen offset:1024 sc1
    s_add_u32 s33, s33, 1
    s_cmp_gt_u32 s33, 0x100000
    s_cbranch_scc1 chain_kernel_abort
    s_branch Gq_18_s21
Gq_18_f2p1:
    buffer_load_dwordx4 v[40:43], v2, s[8:11], s40 offen offset:2048 sc1
    s_add_u32 s33, s33, 1
    s_cmp_gt_u32 s33, 0x100000
    s_cbranch_scc1 chain_kernel_abort
    s_branch Gq_18_s2
ct_p1735:
    s_cbranch_execz ct_p1757
Gq_18_s13:
    s_waitcnt vmcnt(1)
    v_cmp_eq_u32 vcc, -1, v36
    v_mov_b32_dpp v52, v36 row_ror:8 row_mask:0xf bank_mask:0xf
    v_mov_b32_dpp v53, v37 row_ror:8 row_mask:0xf bank_mask:0xf
    v_mov_b32_dpp v54, v38 row_ror:8 row_mask:0xf bank_mask:0xf
    v_mov_b32_dpp v55, v39 row_ror:8 row_mask:0xf bank_mask:0xf
    s_cbranch_vccnz Gq_18_f13
    v_smfmac_f32_16x16x64_bf16 v[64:67], v[36:39], a[8:15], v19
    v_smfmac_f32_16x16x64_bf16 v[68:71], v[36:39], a[72:79], v19
Gq_18_s3p1:
    s_waitcnt vmcnt(0)
    v_cmp_eq_u32_e64 vcc, -1, v44
    v_smfmac_f32_16x16x64_bf16 v[64:67], v[52:55], a[40:47], v19
    v_mov_b32_dpp v60, v44 row_ror:8 row_mask:0xf bank_mask:0xf
    v_mov_b32_dpp v61, v45 row_ror:8 row_mask:0xf bank_mask:0xf
    v_smfmac_f32_16x16x64_bf16 v[68:71], v[52:55], a[104:111], v19
    v_mov_b32_dpp v62, v46 row_ror:8 row_mask:0xf bank_mask:0xf
    v_mov_b32_dpp v63, v47 row_ror:8 row_mask:0xf bank_mask:0xf
    s_cbranch_vccnz Gq_18_f3p1
    v_smfmac_f32_16x16x64_bf16 v[64:67], v[44:47], a[24:31], v19
ct_p1757:
    s_cbranch_execz ct_ret2
    v_smfmac_f32_16x16x64_bf16 v[68:71], v[44:47], a[88:95], v19
    v_smfmac_f32_16x16x64_bf16 v[64:67], v[60:63], a[56:63], v19
    v_smfmac_f32_16x16x64_bf16 v[68:71], v[60:63], a[120:127], v19
    s_branch Gq_18_done
Gq_18_f13:
    buffer_load_dwordx4 v[36:39], v2, s[8:11], s40 offen offset:1024 sc1
    s_add_u32 s33, s33, 1
    s_cmp_gt_u32 s33, 0x100000
    s_cbranch_scc1 chain_kernel_abort
    s_branch Gq_18_s31
Gq_18_f3p1:
    buffer_load_dwordx4 v[44:47], v2, s[8:11], s40 offen offset:3072 sc1
    s_add_u32 s33, s33, 1
    s_cmp_gt_u32 s33, 0x100000
    s_cbranch_scc1 chain_kernel_abort
    s_branch Gq_18_s3
ct_c6:
ct_p1774:
    s_cbranch_execz ct_p1788
Gq_18_s1:
    s_waitcnt vmcnt(0)
    v_cmp_eq_u32 vcc, -1, v36
    v_mov_b32_dpp v52, v36 row_ror:8 row_mask:0xf bank_mask:0xf
    v_mov_b32_dpp v53, v37 row_ror:8 row_mask:0xf bank_mask:0xf
    v_mov_b32_dpp v54, v38 row_ror:8 row_mask:0xf bank_mask:0xf
    v_mov_b32_dpp v55, v39 row_ror:8 row_mask:0xf bank_mask:0xf
    s_cbranch_vccnz Gq_18_f1
    v_smfmac_f32_16x16x64_bf16 v[64:67], v[36:39], a[8:15], v19
    v_smfmac_f32_16x16x64_bf16 v[68:71], v[36:39], a[72:79], v19
    v_smfmac_f32_16x16x64_bf16 v[64:67], v[52:55], a[40:47], v19
    v_smfmac_f32_16x16x64_bf16 v[68:71], v[52:55], a[104:111], v19
    s_branch Gq_18_done
ct_p1788:
    s_cbranch_execz ct_p1806
Gq_18_f1:
    buffer_load_dwordx4 v[36:39], v2, s[8:11], s40 offen offset:1024 sc1
    s_add_u32 s33, s33, 1
    s_cmp_gt_u32 s33, 0x100000
    s_cbranch_scc1 chain_kernel_abort
    s_branch Gq_18_s1
Gq_18_s23:
    s_waitcnt vmcnt(1)
    v_cmp_eq_u32 vcc, -1, v40
    v_mov_b32_dpp v56, v40 row_ror:8 row_mask:0xf bank_mask:0xf
    v_mov_b32_dpp v57, v41 row_ror:8 row_mask:0xf bank_mask:0xf
    v_mov_b32_dpp v58, v42 row_ror:8 row_mask:0xf bank_mask:0xf
    v_mov_b32_dpp v59, v43 row_ror:8 row_mask:0xf bank_mask:0xf
    s_cbranch_vccnz Gq_18_f23
    v_smfmac_f32_16x16x64_bf16 v[64:67], v[40:43], a[16:23], v19
    v_smfmac_f32_16x16x64_bf16 v[68:71], v[40:43], a[80:87], v19
    s_branch Gq_18_s3p2
ct_p1806:
    s_cbranch_execz ct_p1826
Gq_18_f23:
    buffer_load_dwordx4 v[40:43], v2, s[8:11], s40 offen offset:2048 sc1
    s_add_u32 s33, s33, 1
    s_cmp_gt_u32 s33, 0x100000
    s_cbranch_scc1 chain_kernel_abort
    s_branch Gq_18_s32
Gq_18_s2:
    s_waitcnt vmcnt(0)
    v_cmp_eq_u32 vcc, -1, v40
    v_mov_b32_dpp v56, v40 row_ror:8 row_mask:0xf bank_mask:0xf
    v_mov_b32_dpp v57, v41 row_ror:8 row_mask:0xf bank_mask:0xf
    v_mov_b32_dpp v58, v42 row_ror:8 row_mask:0xf bank_mask:0xf
    v_mov_b32_dpp v59, v43 row_ror:8 row_mask:0xf bank_mask:0xf
    s_cbranch_vccnz Gq_18_f2
    v_smfmac_f32_16x16x64_bf16 v[64:67], v[40:43], a[16:23], v19
    v_smfmac_f32_16x16x64_bf16 v[68:71], v[40:43], a[80:87], v19
    v_smfmac_f32_16x16x64_bf16 v[64:67], v[56:59], a[48:55], v19
    v_smfmac_f32_16x16x64_bf16 v[68:71], v[56:59], a[112:119], v19
    s_branch Gq_18_done
ct_p1826:
    s_cbranch_execz ct_p1850
Gq_18_f2:
    buffer_load_dwordx4 v[40:43], v2, s[8:11], s40 offen offset:2048 sc1
    s_add_u32 s33, s33, 1
    s_cmp_gt_u32 s33, 0x100000
    s_cbranch_scc1 chain_kernel_abort
    s_branch Gq_18_s2
Gq_18_s3012:
    s_waitcnt vmcnt(3)
    v_cmp_eq_u32 vcc, -1, v44
    v_mov_b32_dpp v60, v44 row_ror:8 row_mask:0xf bank_mask:0xf
    v_mov_b32_dpp v61, v45 row_ror:8 row_mask:0xf bank_mask:0xf
    v_mov_b32_dpp v62, v46 row_ror:8 row_mask:0xf bank_mask:0xf
    v_mov_b32_dpp v63, v47 row_ror:8 row_mask:0xf bank_mask:0xf
    s_cbranch_vccnz Gq_18_f3012
    v_smfmac_f32_16x16x64_bf16 v[64:67], v[44:47], a[24:31], v19
    v_smfmac_f32_16x16x64_bf16 v[68:71], v[44:47], a[88:95], v19
Gq_18_s012p3:
    s_waitcnt vmcnt(2)
    v_cmp_eq_u32_e64 vcc, -1, v32
    v_smfmac_f32_16x16x64_bf16 v[64:67], v[60:63], a[56:63], v19
    v_mov_b32_dpp v48, v32 row_ror:8 row_mask:0xf bank_mask:0xf
    v_mov_b32_dpp v49, v33 row_ror:8 row_mask:0xf bank_mask:0xf
    v_smfmac_f32_16x16x64_bf16 v[68:71], v[60:63], a[120:127], v19
ct_p1850:
    s_cbranch_execz ct_p1869
    v_mov_b32_dpp v50, v34 row_ror:8 row_mask:0xf bank_mask:0xf
    v_mov_b32_dpp v51, v35 row_ror:8 row_mask:0xf bank_mask:0xf
    s_cbranch_vccnz Gq_18_f012p3
    v_smfmac_f32_16x16x64_bf16 v[64:67], v[32:35], a[0:7], v19
    v_smfmac_f32_16x16x64_bf16 v[68:71], v[32:35], a[64:71], v19
Gq_18_s12p0:
    s_waitcnt vmcnt(1)
    v_cmp_eq_u32 vcc, -1, v36
    v_smfmac_f32_16x16x64_bf16 v[64:67], v[48:51], a[32:39], v19
    v_mov_b32_dpp v52, v36 row_ror:8 row_mask:0xf bank_mask:0xf
    v_mov_b32_dpp v53, v37 row_ror:8 row_mask:0xf bank_mask:0xf
    v_smfmac_f32_16x16x64_bf16 v[68:71], v[48:51], a[96:103], v19
    v_mov_b32_dpp v54, v38 row_ror:8 row_mask:0xf bank_mask:0xf
    v_mov_b32_dpp v55, v39 row_ror:8 row_mask:0xf bank_mask:0xf
    s_cbranch_vccnz Gq_18_f12p0
    v_smfmac_f32_16x16x64_bf16 v[64:67], v[36:39], a[8:15], v19
    v_smfmac_f32_16x16x64_bf16 v[68:71], v[36:39], a[72:79], v19
    s_branch Gq_18_s2p1
ct_p1869:
    s_cbranch_execz ct_p1888
Gq_18_f3012:
    buffer_load_dwordx4 v[44:47], v2, s[8:11], s40 offen offset:3072 sc1
    s_add_u32 s33, s33, 1
    s_cmp_gt_u32 s33, 0x100000
    s_cbranch_scc1 chain_kernel_abort
    s_branch Gq_18_s0123
Gq_18_f012p3:
    buffer_load_dwordx4 v[32:35], v2, s[8:11], s40 offen offset:0 sc1
    s_add_u32 s33, s33, 1
    s_cmp_gt_u32 s33, 0x100000
    s_cbranch_scc1 chain_kernel_abort
    s_branch Gq_18_s120
Gq_18_f12p0:
    buffer_load_dwordx4 v[36:39], v2, s[8:11], s40 offen offset:1024 sc1
    s_add_u32 s33, s33, 1
    s_cmp_gt_u32 s33, 0x100000
    s_cbranch_scc1 chain_kernel_abort
    s_branch Gq_18_s21
ct_p1888:
    s_cbranch_execz ct_p1910
Gq_18_s013:
    s_waitcnt vmcnt(2)
    v_cmp_eq_u32_e64 vcc, -1, v32
    v_mov_b32_dpp v48, v32 row_ror:8 row_mask:0xf bank_mask:0xf
    v_mov_b32_dpp v49, v33 row_ror:8 row_mask:0xf bank_mask:0xf
    v_mov_b32_dpp v50, v34 row_ror:8 row_mask:0xf bank_mask:0xf
    v_mov_b32_dpp v51, v35 row_ror:8 row_mask:0xf bank_mask:0xf
    s_cbranch_vccnz Gq_18_f013
    v_smfmac_f32_16x16x64_bf16 v[64:67], v[32:35], a[0:7], v19
    v_smfmac_f32_16x16x64_bf16 v[68:71], v[32:35], a[64:71], v19
Gq_18_s13p0:
    s_waitcnt vmcnt(1)
    v_cmp_eq_u32_e64 vcc, -1, v36
    v_smfmac_f32_16x16x64_bf16 v[64:67], v[48:51], a[32:39], v19
    v_mov_b32_dpp v52, v36 row_ror:8 row_mask:0xf bank_mask:0xf
    v_mov_b32_dpp v53, v37 row_ror:8 row_mask:0xf bank_mask:0xf
    v_smfmac_f32_16x16x64_bf16 v[68:71], v[48:51], a[96:103], v19
    v_mov_b32_dpp v54, v38 row_ror:8 row_mask:0xf bank_mask:0xf
    v_mov_b32_dpp v55, v39 row_ror:8 row_mask:0xf bank_mask:0xf
    s_cbranch_vccnz Gq_18_f13p0
    v_smfmac_f32_16x16x64_bf16 v[64:67], v[36:39], a[8:15], v19
ct_p1910:
    s_cbranch_execz ct_p1925
    v_smfmac_f32_16x16x64_bf16 v[68:71], v[36:39], a[72:79], v19
    s_branch Gq_18_s3p1
Gq_18_f013:
    buffer_load_dwordx4 v[32:35], v2, s[8:11], s40 offen offset:0 sc1
    s_add_u32 s33, s33, 1
    s_cmp_gt_u32 s33, 0x100000
    s_cbranch_scc1 chain_kernel_abort
    s_branch Gq_18_s130
Gq_18_f13p0:
    buffer_load_dwordx4 v[36:39], v2, s[8:11], s40 offen offset:1024 sc1
    s_add_u32 s33, s33, 1
    s_cmp_gt_u32 s33, 0x100000
    s_cbranch_scc1 chain_kernel_abort
    s_branch Gq_18_s31
ct_p1925:
    s_cbranch_execz ct_p1947
Gq_18_s10:
    s_waitcnt vmcnt(1)
    v_cmp_eq_u32 vcc, -1, v36
    v_mov_b32_dpp v52, v36 row_ror:8 row_mask:0xf bank_mask:0xf
    v_mov_b32_dpp v53, v37 row_ror:8 row_mask:0xf bank_mask:0xf
    v_mov_b32_dpp v54, v38 row_ror:8 row_mask:0xf bank_mask:0xf
    v_mov_b32_dpp v55, v39 row_ror:8 row_mask:0xf bank_mask:0xf
    s_cbranch_vccnz Gq_18_f10
    v_smfmac_f32_16x16x64_bf16 v[64:67], v[36:39], a[8:15], v19
    v_smfmac_f32_16x16x64_bf16 v[68:71], v[36:39], a[72:79], v19
Gq_18_s0p1:
    s_waitcnt vmcnt(0)
    v_cmp_eq_u32_e64 vcc, -1, v32
    v_smfmac_f32_16x16x64_bf16 v[64:67], v[52:55], a[40:47], v19
    v_mov_b32_dpp v48, v32 row_ror:8 row_mask:0xf bank_mask:0xf
    v_mov_b32_dpp v49, v33 row_ror:8 row_mask:0xf bank_mask:0xf
    v_smfmac_f32_16x16x64_bf16 v[68:71], v[52:55], a[104:111], v19
    v_mov_b32_dpp v50, v34 row_ror:8 row_mask:0xf bank_mask:0xf
    v_mov_b32_dpp v51, v35 row_ror:8 row_mask:0xf bank_mask:0xf
    s_cbranch_vccnz Gq_18_f0p1
    v_smfmac_f32_16x16x64_bf16 v[64:67], v[32:35], a[0:7], v19
ct_p1947:
    s_cbranch_execz ct_p1964
    v_smfmac_f32_16x16x64_bf16 v[68:71], v[32:35], a[64:71], v19
    v_smfmac_f32_16x16x64_bf16 v[64:67], v[48:51], a[32:39], v19
    v_smfmac_f32_16x16x64_bf16 v[68:71], v[48:51], a[96:103], v19
    s_branch Gq_18_done
Gq_18_f10:
    buffer_load_dwordx4 v[36:39], v2, s[8:11], s40 offen offset:1024 sc1
    s_add_u32 s33, s33, 1
    s_cmp_gt_u32 s33, 0x100000
    s_cbranch_scc1 chain_kernel_abort
    s_branch Gq_18_s01
Gq_18_f0p1:
    buffer_load_dwordx4 v[32:35], v2, s[8:11], s40 offen offset:0 sc1
    s_add_u32 s33, s33, 1
    s_cmp_gt_u32 s33, 0x100000
    s_cbranch_scc1 chain_kernel_abort
    s_branch Gq_18_s0
ct_p1964:
    s_cbranch_execz ct_p1986
Gq_18_s023:
    s_waitcnt vmcnt(2)
    v_cmp_eq_u32 vcc, -1, v32
    v_mov_b32_dpp v48, v32 row_ror:8 row_mask:0xf bank_mask:0xf
    v_mov_b32_dpp v49, v33 row_ror:8 row_mask:0xf bank_mask:0xf
    v_mov_b32_dpp v50, v34 row_ror:8 row_mask:0xf bank_mask:0xf
    v_mov_b32_dpp v51, v35 row_ror:8 row_mask:0xf bank_mask:0xf
    s_cbranch_vccnz Gq_18_f023
    v_smfmac_f32_16x16x64_bf16 v[64:67], v[32:35], a[0:7], v19
    v_smfmac_f32_16x16x64_bf16 v[68:71], v[32:35], a[64:71], v19
Gq_18_s23p0:
    s_waitcnt vmcnt(1)
    v_cmp_eq_u32_e64 vcc, -1, v40
    v_smfmac_f32_16x16x64_bf16 v[64:67], v[48:51], a[32:39], v19
    v_mov_b32_dpp v56, v40 row_ror:8 row_mask:0xf bank_mask:0xf
    v_mov_b32_dpp v57, v41 row_ror:8 row_mask:0xf bank_mask:0xf
    v_smfmac_f32_16x16x64_bf16 v[68:71], v[48:51], a[96:103], v19
    v_mov_b32_dpp v58, v42 row_ror:8 row_mask:0xf bank_mask:0xf
    v_mov_b32_dpp v59, v43 row_ror:8 row_mask:0xf bank_mask:0xf
    s_cbranch_vccnz Gq_18_f23p0
    v_smfmac_f32_16x16x64_bf16 v[64:67], v[40:43], a[16:23], v19
ct_p1986:
    s_cbranch_execz ct_ret3
    v_smfmac_f32_16x16x64_bf16 v[68:71], v[40:43], a[80:87], v19
    s_branch Gq_18_s3p2
Gq_18_f023:
    buffer_load_dwordx4 v[32:35], v2, s[8:11], s40 offen offset:0 sc1
    s_add_u32 s33, s33, 1
    s_cmp_gt_u32 s33, 0x100000
    s_cbranch_scc1 chain_kernel_abort
    s_branch Gq_18_s230
Gq_18_f23p0:
    buffer_load_dwordx4 v[40:43], v2, s[8:11], s40 offen offset:2048 sc1
    s_add_u32 s33, s33, 1
    s_cmp_gt_u32 s33, 0x100000
    s_cbranch_scc1 chain_kernel_abort
    s_branch Gq_18_s32
ct_c7:
ct_p2001:
    s_cbranch_execz ct_p2023
Gq_18_s20:
    s_waitcnt vmcnt(1)
    v_cmp_eq_u32 vcc, -1, v40
    v_mov_b32_dpp v56, v40 row_ror:8 row_mask:0xf bank_mask:0xf
    v_mov_b32_dpp v57, v41 row_ror:8 row_mask:0xf bank_mask:0xf
    v_mov_b32_dpp v58, v42 row_ror:8 row_mask:0xf bank_mask:0xf
    v_mov_b32_dpp v59, v43 row_ror:8 row_mask:0xf bank_mask:0xf
    s_cbranch_vccnz Gq_18_f20
    v_smfmac_f32_16x16x64_bf16 v[64:67], v[40:43], a[16:23], v19
    v_smfmac_f32_16x16x64_bf16 v[68:71], v[40:43], a[80:87], v19
Gq_18_s0p2:
    s_waitcnt vmcnt(0)
    v_cmp_eq_u32_e64 vcc, -1, v32
    v_smfmac_f32_16x16x64_bf16 v[64:67], v[56:59], a[48:55], v19
    v_mov_b32_dpp v48, v32 row_ror:8 row_mask:0xf bank_mask:0xf
    v_mov_b32_dpp v49, v33 row_ror:8 row_mask:0xf bank_mask:0xf
    v_smfmac_f32_16x16x64_bf16 v[68:71], v[56:59], a[112:119], v19
    v_mov_b32_dpp v50, v34 row_ror:8 row_mask:0xf bank_mask:0xf
    v_mov_b32_dpp v51, v35 row_ror:8 row_mask:0xf bank_mask:0xf
    s_cbranch_vccnz Gq_18_f0p2
    v_smfmac_f32_16x16x64_bf16 v[64:67], v[32:35], a[0:7], v19
ct_p2023:
    s_cbranch_execz ct_p2040
    v_smfmac_f32_16x16x64_bf16 v[68:71], v[32:35], a[64:71], v19
    v_smfmac_f32_16x16x64_bf16 v[64:67], v[48:51], a[32:39], v19
    v_smfmac_f32_16x16x64_bf16 v[68:71], v[48:51], a[96:103], v19
    s_branch Gq_18_done
Gq_18_f20:
    buffer_load_dwordx4 v[40:43], v2, s[8:11], s40 offen offset:2048 sc1
    s_add_u32 s33, s33, 1
    s_cmp_gt_u32 s33, 0x100000
    s_cbranch_scc1 chain_kernel_abort
    s_branch Gq_18_s02
Gq_18_f0p2:
    buffer_load_dwordx4 v[32:35], v2, s[8:11], s40 offen offset:0 sc1
    s_add_u32 s33, s33, 1
    s_cmp_gt_u32 s33, 0x100000
    s_cbranch_scc1 chain_kernel_abort
    s_branch Gq_18_s0
ct_p2040:
    s_cbranch_execz ct_p2052
Gq_18_s30:
    s_waitcnt vmcnt(1)
    v_cmp_eq_u32 vcc, -1, v44
    v_mov_b32_dpp v60, v44 row_ror:8 row_mask:0xf bank_mask:0xf
    v_mov_b32_dpp v61, v45 row_ror:8 row_mask:0xf bank_mask:0xf
    v_mov_b32_dpp v62, v46 row_ror:8 row_mask:0xf bank_mask:0xf
    v_mov_b32_dpp v63, v47 row_ror:8 row_mask:0xf bank_mask:0xf
    s_cbranch_vccnz Gq_18_f30
    v_smfmac_f32_16x16x64_bf16 v[64:67], v[44:47], a[24:31], v19
    v_smfmac_f32_16x16x64_bf16 v[68:71], v[44:47], a[88:95], v19
    s_branch Gq_18_s0p3
ct_p2052:
    s_cbranch_execz ct_p2070
Gq_18_f30:
    buffer_load_dwordx4 v[44:47], v2, s[8:11], s40 offen offset:3072 sc1
    s_add_u32 s33, s33, 1
    s_cmp_gt_u32 s33, 0x100000
    s_cbranch_scc1 chain_kernel_abort
    s_branch Gq_18_s03
Gq_18_s123:
    s_waitcnt vmcnt(2)
    v_cmp_eq_u32 vcc, -1, v36
    v_mov_b32_dpp v52, v36 row_ror:8 row_mask:0xf bank_mask:0xf
    v_mov_b32_dpp v53, v37 row_ror:8 row_mask:0xf bank_mask:0xf
    v_mov_b32_dpp v54, v38 row_ror:8 row_mask:0xf bank_mask:0xf
    v_mov_b32_dpp v55, v39 row_ror:8 row_mask:0xf bank_mask:0xf
    s_cbranch_vccnz Gq_18_f123
    v_smfmac_f32_16x16x64_bf16 v[64:67], v[36:39], a[8:15], v19
    v_smfmac_f32_16x16x64_bf16 v[68:71], v[36:39], a[72:79], v19
    s_branch Gq_18_s23p1
ct_p2070:
    s_cbranch_execz ct_p2094
Gq_18_f123:
    buffer_load_dwordx4 v[36:39], v2, s[8:11], s40 offen offset:1024 sc1
    s_add_u32 s33, s33, 1
    s_cmp_gt_u32 s33, 0x100000
    s_cbranch_scc1 chain_kernel_abort
    s_branch Gq_18_s231
Gq_18_s21:
    s_waitcnt vmcnt(1)
    v_cmp_eq_u32 vcc, -1, v40
    v_mov_b32_dpp v56, v40 row_ror:8 row_mask:0xf bank_mask:0xf
    v_mov_b32_dpp v57, v41 row_ror:8 row_mask:0xf bank_mask:0xf
    v_mov_b32_dpp v58, v42 row_ror:8 row_mask:0xf bank_mask:0xf
    v_mov_b32_dpp v59, v43 row_ror:8 row_mask:0xf bank_mask:0xf
    s_cbranch_vccnz Gq_18_f21
    v_smfmac_f32_16x16x64_bf16 v[64:67], v[40:43], a[16:23], v19
    v_smfmac_f32_16x16x64_bf16 v[68:71], v[40:43], a[80:87], v19
Gq_18_s1p2:
    s_waitcnt vmcnt(0)
    v_cmp_eq_u32_e64 vcc, -1, v36
    v_smfmac_f32_16x16x64_bf16 v[64:67], v[56:59], a[48:55], v19
    v_mov_b32_dpp v52, v36 row_ror:8 row_mask:0xf bank_mask:0xf
    v_mov_b32_dpp v53, v37 row_ror:8 row_mask:0xf bank_mask:0xf
    v_smfmac_f32_16x16x64_bf16 v[68:71], v[56:59], a[112:119], v19
ct_p2094:
    s_cbranch_execz ct_p2109
    v_mov_b32_dpp v54, v38 row_ror:8 row_mask:0xf bank_mask:0xf
    v_mov_b32_dpp v55, v39 row_ror:8 row_mask:0xf bank_mask:0xf
    s_cbranch_vccnz Gq_18_f1p2
    v_smfmac_f32_16x16x64_bf16 v[64:67], v[36:39], a[8:15], v19
    v_smfmac_f32_16x16x64_bf16 v[68:71], v[36:39], a[72:79], v19
    v_smfmac_f32_16x16x64_bf16 v[64:67], v[52:55], a[40:47], v19
    v_smfmac_f32_16x16x64_bf16 v[68:71], v[52:55], a[104:111], v19
    s_branch Gq_18_done
Gq_18_f21:
    buffer_load_dwordx4 v[40:43], v2, s[8:11], s40 offen offset:2048 sc1
    s_add_u32 s33, s33, 1
    s_cmp_gt_u32 s33, 0x100000
    s_cbranch_scc1 chain_kernel_abort
    s_branch Gq_18_s12
ct_p2109:
    s_cbranch_execz ct_p2127
Gq_18_f1p2:
    buffer_load_dwordx4 v[36:39], v2, s[8:11], s40 offen offset:1024 sc1
    s_add_u32 s33, s33, 1
    s_cmp_gt_u32 s33, 0x100000
    s_cbranch_scc1 chain_kernel_abort
    s_branch Gq_18_s1
Gq_18_s31:
    s_waitcnt vmcnt(1)
    v_cmp_eq_u32 vcc, -1, v44
    v_mov_b32_dpp v60, v44 row_ror:8 row_mask:0xf bank_mask:0xf
    v_mov_b32_dpp v61, v45 row_ror:8 row_mask:0xf bank_mask:0xf
    v_mov_b32_dpp v62, v46 row_ror:8 row_mask:0xf bank_mask:0xf
    v_mov_b32_dpp v63, v47 row_ror:8 row_mask:0xf bank_mask:0xf
    s_cbranch_vccnz Gq_18_f31
    v_smfmac_f32_16x16x64_bf16 v[64:67], v[44:47], a[24:31], v19
    v_smfmac_f32_16x16x64_bf16 v[68:71], v[44:47], a[88:95], v19
    s_branch Gq_18_s1p3
ct_p2127:
    s_cbranch_execz ct_p2151
Gq_18_f31:
    buffer_load_dwordx4 v[44:47], v2, s[8:11], s40 offen offset:3072 sc1
    s_add_u32 s33, s33, 1
    s_cmp_gt_u32 s33, 0x100000
    s_cbranch_scc1 chain_kernel_abort
    s_branch Gq_18_s13
Gq_18_s120:
    s_waitcnt vmcnt(2)
    v_cmp_eq_u32 vcc, -1, v36
    v_mov_b32_dpp v52, v36 row_ror:8 row_mask:0xf bank_mask:0xf
    v_mov_b32_dpp v53, v37 row_ror:8 row_mask:0xf bank_mask:0xf
    v_mov_b32_dpp v54, v38 row_ror:8 row_mask:0xf bank_mask:0xf
    v_mov_b32_dpp v55, v39 row_ror:8 row_mask:0xf bank_mask:0xf
    s_cbranch_vccnz Gq_18_f120
    v_smfmac_f32_16x16x64_bf16 v[64:67], v[36:39], a[8:15], v19
    v_smfmac_f32_16x16x64_bf16 v[68:71], v[36:39], a[72:79], v19
Gq_18_s20p1:
    s_waitcnt vmcnt(1)
    v_cmp_eq_u32_e64 vcc, -1, v40
    v_smfmac_f32_16x16x64_bf16 v[64:67], v[52:55], a[40:47], v19
    v_mov_b32_dpp v56, v40 row_ror:8 row_mask:0xf bank_mask:0xf
    v_mov_b32_dpp v57, v41 row_ror:8 row_mask:0xf bank_mask:0xf
    v_smfmac_f32_16x16x64_bf16 v[68:71], v[52:55], a[104:111], v19
ct_p2151:
    s_cbranch_execz ct_p2164
    v_mov_b32_dpp v58, v42 row_ror:8 row_mask:0xf bank_mask:0xf
    v_mov_b32_dpp v59, v43 row_ror:8 row_mask:0xf bank_mask:0xf
    s_cbranch_vccnz Gq_18_f20p1
    v_smfmac_f32_16x16x64_bf16 v[64:67], v[40:43], a[16:23], v19
    v_smfmac_f32_16x16x64_bf16 v[68:71], v[40:43], a[80:87], v19
    s_branch Gq_18_s0p2
Gq_18_f120:
    buffer_load_dwordx4 v[36:39], v2, s[8:11], s40 offen offset:1024 sc1
    s_add_u32 s33, s33, 1
    s_cmp_gt_u32 s33, 0x100000
    s_cbranch_scc1 chain_kernel_abort
    s_branch Gq_18_s201
ct_p2164:
    s_cbranch_execz ct_p2188
Gq_18_f20p1:
    buffer_load_dwordx4 v[40:43], v2, s[8:11], s40 offen offset:2048 sc1
    s_add_u32 s33, s33, 1
    s_cmp_gt_u32 s33, 0x100000
    s_cbranch_scc1 chain_kernel_abort
    s_branch Gq_18_s02
Gq_18_s130:
    s_waitcnt vmcnt(2)
    v_cmp_eq_u32 vcc, -1, v36
    v_mov_b32_dpp v52, v36 row_ror:8 row_mask:0xf bank_mask:0xf
    v_mov_b32_dpp v53, v37 row_ror:8 row_mask:0xf bank_mask:0xf
    v_mov_b32_dpp v54, v38 row_ror:8 row_mask:0xf bank_mask:0xf
    v_mov_b32_dpp v55, v39 row_ror:8 row_mask:0xf bank_mask:0xf
    s_cbranch_vccnz Gq_18_f130
    v_smfmac_f32_16x16x64_bf16 v[64:67], v[36:39], a[8:15], v19
    v_smfmac_f32_16x16x64_bf16 v[68:71], v[36:39], a[72:79], v19
Gq_18_s30p1:
    s_waitcnt vmcnt(1)
    v_cmp_eq_u32_e64 vcc, -1, v44
    v_smfmac_f32_16x16x64_bf16 v[64:67], v[52:55], a[40:47], v19
    v_mov_b32_dpp v60, v44 row_ror:8 row_mask:0xf bank_mask:0xf
    v_mov_b32_dpp v61, v45 row_ror:8 row_mask:0xf bank_mask:0xf
    v_smfmac_f32_16x16x64_bf16 v[68:71], v[52:55], a[104:111], v19
ct_p2188:
    s_cbranch_execz ct_p2201
    v_mov_b32_dpp v62, v46 row_ror:8 row_mask:0xf bank_mask:0xf
    v_mov_b32_dpp v63, v47 row_ror:8 row_mask:0xf bank_mask:0xf
    s_cbranch_vccnz Gq_18_f30p1
    v_smfmac_f32_16x16x64_bf16 v[64:67], v[44:47], a[24:31], v19
    v_smfmac_f32_16x16x64_bf16 v[68:71], v[44:47], a[88:95], v19
    s_branch Gq_18_s0p3
Gq_18_f130:
    buffer_load_dwordx4 v[36:39], v2, s[8:11], s40 offen offset:1024 sc1
    s_add_u32 s33, s33, 1
    s_cmp_gt_u32 s33, 0x100000
    s_cbranch_scc1 chain_kernel_abort
    s_branch Gq_18_s301
ct_p2201:
    s_cbranch_execz ct_ret3
Gq_18_f30p1:
    buffer_load_dwordx4 v[44:47], v2, s[8:11], s40 offen offset:3072 sc1
    s_add_u32 s33, s33, 1
    s_cmp_gt_u32 s33, 0x100000
    s_cbranch_scc1 chain_kernel_abort
    s_branch Gq_18_s03
Gq_18_s01:
    s_waitcnt vmcnt(1)
    v_cmp_eq_u32 vcc, -1, v32
    v_mov_b32_dpp v48, v32 row_ror:8 row_mask:0xf bank_mask:0xf
    v_mov_b32_dpp v49, v33 row_ror:8 row_mask:0xf bank_mask:0xf
    v_mov_b32_dpp v50, v34 row_ror:8 row_mask:0xf bank_mask:0xf
    v_mov_b32_dpp v51, v35 row_ror:8 row_mask:0xf bank_mask:0xf
    s_cbranch_vccnz Gq_18_f01
    v_smfmac_f32_16x16x64_bf16 v[64:67], v[32:35], a[0:7], v19
    v_smfmac_f32_16x16x64_bf16 v[68:71], v[32:35], a[64:71], v19
    s_branch Gq_18_s1p0
ct_c8:
ct_p2219:
    s_cbranch_execz ct_p2237
Gq_18_f01:
    buffer_load_dwordx4 v[32:35], v2, s[8:11], s40 offen offset:0 sc1
    s_add_u32 s33, s33, 1
    s_cmp_gt_u32 s33, 0x100000
    s_cbranch_scc1 chain_kernel_abort
    s_branch Gq_18_s10
Gq_18_s230:
    s_waitcnt vmcnt(2)
    v_cmp_eq_u32 vcc, -1, v40
    v_mov_b32_dpp v56, v40 row_ror:8 row_mask:0xf bank_mask:0xf
    v_mov_b32_dpp v57, v41 row_ror:8 row_mask:0xf bank_mask:0xf
    v_mov_b32_dpp v58, v42 row_ror:8 row_mask:0xf bank_mask:0xf
    v_mov_b32_dpp v59, v43 row_ror:8 row_mask:0xf bank_mask:0xf
    s_cbranch_vccnz Gq_18_f230
    v_smfmac_f32_16x16x64_bf16 v[64:67], v[40:43], a[16:23], v19
    v_smfmac_f32_16x16x64_bf16 v[68:71], v[40:43], a[80:87], v19
    s_branch Gq_18_s30p2
ct_p2237:
    s_cbranch_execz ct_p2255
Gq_18_f230:
    buffer_load_dwordx4 v[40:43], v2, s[8:11], s40 offen offset:2048 sc1
    s_add_u32 s33, s33, 1
    s_cmp_gt_u32 s33, 0x100000
    s_cbranch_scc1 chain_kernel_abort
    s_branch Gq_18_s302
Gq_18_s02:
    s_waitcnt vmcnt(1)
    v_cmp_eq_u32 vcc, -1, v32
    v_mov_b32_dpp v48, v32 row_ror:8 row_mask:0xf bank_mask:0xf
    v_mov_b32_dpp v49, v33 row_ror:8 row_mask:0xf bank_mask:0xf
    v_mov_b32_dpp v50, v34 row_ror:8 row_mask:0xf bank_mask:0xf
    v_mov_b32_dpp v51, v35 row_ror:8 row_mask:0xf bank_mask:0xf
    s_cbranch_vccnz Gq_18_f02
    v_smfmac_f32_16x16x64_bf16 v[64:67], v[32:35], a[0:7], v19
    v_smfmac_f32_16x16x64_bf16 v[68:71], v[32:35], a[64:71], v19
    s_branch Gq_18_s2p0
ct_p2255:
    s_cbranch_execz ct_p2273
Gq_18_f02:
    buffer_load_dwordx4 v[32:35], v2, s[8:11], s40 offen offset:0 sc1
    s_add_u32 s33, s33, 1
    s_cmp_gt_u32 s33, 0x100000
    s_cbranch_scc1 chain_kernel_abort
    s_branch Gq_18_s20
Gq_18_s12:
    s_waitcnt vmcnt(1)
    v_cmp_eq_u32 vcc, -1, v36
    v_mov_b32_dpp v52, v36 row_ror:8 row_mask:0xf bank_mask:0xf
    v_mov_b32_dpp v53, v37 row_ror:8 row_mask:0xf bank_mask:0xf
    v_mov_b32_dpp v54, v38 row_ror:8 row_mask:0xf bank_mask:0xf
    v_mov_b32_dpp v55, v39 row_ror:8 row_mask:0xf bank_mask:0xf
    s_cbranch_vccnz Gq_18_f12
    v_smfmac_f32_16x16x64_bf16 v[64:67], v[36:39], a[8:15], v19
    v_smfmac_f32_16x16x64_bf16 v[68:71], v[36:39], a[72:79], v19
    s_branch Gq_18_s2p1
ct_p2273:
    s_cbranch_execz ct_p2297
Gq_18_f12:
    buffer_load_dwordx4 v[36:39], v2, s[8:11], s40 offen offset:1024 sc1
    s_add_u32 s33, s33, 1
    s_cmp_gt_u32 s33, 0x100000
    s_cbranch_scc1 chain_kernel_abort
    s_branch Gq_18_s21
Gq_18_s201:
    s_waitcnt vmcnt(2)
    v_cmp_eq_u32 vcc, -1, v40
    v_mov_b32_dpp v56, v40 row_ror:8 row_mask:0xf bank_mask:0xf
    v_mov_b32_dpp v57, v41 row_ror:8 row_mask:0xf bank_mask:0xf
    v_mov_b32_dpp v58, v42 row_ror:8 row_mask:0xf bank_mask:0xf
    v_mov_b32_dpp v59, v43 row_ror:8 row_mask:0xf bank_mask:0xf
    s_cbranch_vccnz Gq_18_f201
    v_smfmac_f32_16x16x64_bf16 v[64:67], v[40:43], a[16:23], v19
    v_smfmac_f32_16x16x64_bf16 v[68:71], v[40:43], a[80:87], v19
Gq_18_s01p2:
    s_waitcnt vmcnt(1)
    v_cmp_eq_u32_e64 vcc, -1, v32
    v_smfmac_f32_16x16x64_bf16 v[64:67], v[56:59], a[48:55], v19
    v_mov_b32_dpp v48, v32 row_ror:8 row_mask:0xf bank_mask:0xf
    v_mov_b32_dpp v49, v33 row_ror:8 row_mask:0xf bank_mask:0xf
    v_smfmac_f32_16x16x64_bf16 v[68:71], v[56:59], a[112:119], v19
ct_p2297:
    s_cbranch_execz ct_p2310
    v_mov_b32_dpp v50, v34 row_ror:8 row_mask:0xf bank_mask:0xf
    v_mov_b32_dpp v51, v35 row_ror:8 row_mask:0xf bank_mask:0xf
    s_cbranch_vccnz Gq_18_f01p2
    v_smfmac_f32_16x16x64_bf16 v[64:67], v[32:35], a[0:7], v19
    v_smfmac_f32_16x16x64_bf16 v[68:71], v[32:35], a[64:71], v19
    s_branch Gq_18_s1p0
Gq_18_f201:
    buffer_load_dwordx4 v[40:43], v2, s[8:11], s40 offen offset:2048 sc1
    s_add_u32 s33, s33, 1
    s_cmp_gt_u32 s33, 0x100000
    s_cbranch_scc1 chain_kernel_abort
    s_branch Gq_18_s012
ct_p2310:
    s_cbranch_execz ct_p2328
Gq_18_f01p2:
    buffer_load_dwordx4 v[32:35], v2, s[8:11], s40 offen offset:0 sc1
    s_add_u32 s33, s33, 1
    s_cmp_gt_u32 s33, 0x100000
    s_cbranch_scc1 chain_kernel_abort
    s_branch Gq_18_s10
Gq_18_s301:
    s_waitcnt vmcnt(2)
    v_cmp_eq_u32 vcc, -1, v44
    v_mov_b32_dpp v60, v44 row_ror:8 row_mask:0xf bank_mask:0xf
    v_mov_b32_dpp v61, v45 row_ror:8 row_mask:0xf bank_mask:0xf
    v_mov_b32_dpp v62, v46 row_ror:8 row_mask:0xf bank_mask:0xf
    v_mov_b32_dpp v63, v47 row_ror:8 row_mask:0xf bank_mask:0xf
    s_cbranch_vccnz Gq_18_f301
    v_smfmac_f32_16x16x64_bf16 v[64:67], v[44:47], a[24:31], v19
    v_smfmac_f32_16x16x64_bf16 v[68:71], v[44:47], a[88:95], v19
    s_branch Gq_18_s01p3
ct_p2328:
    s_cbranch_execz ct_p2346
Gq_18_f301:
    buffer_load_dwordx4 v[44:47], v2, s[8:11], s40 offen offset:3072 sc1
    s_add_u32 s33, s33, 1
    s_cmp_gt_u32 s33, 0x100000
    s_cbranch_scc1 chain_kernel_abort
    s_branch Gq_18_s013
Gq_18_s012:
    s_waitcnt vmcnt(2)
    v_cmp_eq_u32 vcc, -1, v32
    v_mov_b32_dpp v48, v32 row_ror:8 row_mask:0xf bank_mask:0xf
    v_mov_b32_dpp v49, v33 row_ror:8 row_mask:0xf bank_mask:0xf
    v_mov_b32_dpp v50, v34 row_ror:8 row_mask:0xf bank_mask:0xf
    v_mov_b32_dpp v51, v35 row_ror:8 row_mask:0xf bank_mask:0xf
    s_cbranch_vccnz Gq_18_f012
    v_smfmac_f32_16x16x64_bf16 v[64:67], v[32:35], a[0:7], v19
    v_smfmac_f32_16x16x64_bf16 v[68:71], v[32:35], a[64:71], v19
    s_branch Gq_18_s12p0
    s_nop 0
ct_p2346:
    s_cbranch_execz ct_p2377
Gq_18_f012:
    buffer_load_dwordx4 v[32:35], v2, s[8:11], s40 offen offset:0 sc1
    s_add_u32 s33, s33, 1
    s_cmp_gt_u32 s33, 0x100000
    s_cbranch_scc1 chain_kernel_abort
    s_branch Gq_18_s120
L_sd_19_0_0f:
    s_branch L_sd_19_1_0
L_sd_19_0_1f:
    s_branch L_sd_19_1_1
L_sd_19_0_2f:
    s_branch L_sd_19_1_2
L_sd_19_0_3f:
    s_branch L_sd_19_1_3
L_sd_19_1_0:
    s_waitcnt vmcnt(7)
    v_max3_u32 v20, v164, v165, v166
    v_mfma_f32_16x16x32_bf16 v[88:91], v[164:167], v[164:167], 0
    v_max_u32 v20, v20, v167
    v_cmp_eq_u32 vcc, -1, v20
    v_mfma_f32_16x16x32_bf16 v[84:87], v[120:123], v[164:167], 0
    v_mfma_f32_16x16x32_bf16 v[80:83], v[104:107], v[164:167], 0
    s_cbranch_vccnz L_sd_19_2_0
L_sd_19_1_1:
    s_waitcnt vmcnt(6)
    v_max3_u32 v20, v168, v169, v170
    v_mfma_f32_16x16x32_bf16 v[100:103], v[168:171], v[168:171], v[88:91]
    v_max_u32_e64 v20, v20, v171
    v_cmp_eq_u32 vcc, -1, v20
    v_mfma_f32_16x16x32_bf16 v[96:99], v[124:127], v[168:171], v[84:87]
ct_p2377:
    s_cbranch_execz ct_p2401
    v_mfma_f32_16x16x32_bf16 v[92:95], v[108:111], v[168:171], v[80:83]
    s_cbranch_vccnz L_sd_19_2_1
L_sd_19_1_2:
    s_waitcnt vmcnt(5)
    v_max3_u32 v20, v172, v173, v174
    v_mfma_f32_16x16x32_bf16 v[228:231], v[172:175], v[172:175], v[100:103]
    v_max_u32 v20, v20, v175
    v_cmp_eq_u32 vcc, -1, v20
    v_mfma_f32_16x16x32_bf16 v[224:227], v[128:131], v[172:175], v[96:99]
    v_mfma_f32_16x16x32_bf16 v[220:223], v[112:115], v[172:175], v[92:95]
    s_cbranch_vccnz L_sd_19_2_2
L_sd_19_1_3:
    s_waitcnt vmcnt(4)
    v_max3_u32 v20, v176, v177, v178
    v_mfma_f32_16x16x32_bf16 v[188:191], v[176:179], v[176:179], v[228:231]
    v_max_u32 v20, v20, v179
    v_cmp_eq_u32 vcc, -1, v20
    v_mfma_f32_16x16x32_bf16 v[184:187], v[132:135], v[176:179], v[224:227]
    v_mfma_f32_16x16x32_bf16 v[180:183], v[116:119], v[176:179], v[220:223]
    v_mov_b32_dpp v188, v189 row_ror:8 row_mask:0xf bank_mask:0xc
    v_mov_b32_dpp v190, v191 row_ror:8 row_mask:0xf bank_mask:0xc
    s_cbranch_vccnz L_sd_19_2_3
    s_branch L_sd_19
ct_p2401:
    s_cbranch_execz ct_p2432
L_sd_19_1_0f:
    s_branch L_sd_19_2_0
L_sd_19_1_1f:
    s_branch L_sd_19_2_1
L_sd_19_1_2f:
    s_branch L_sd_19_2_2
L_sd_19_1_3f:
    s_branch L_sd_19_2_3
L_sd_19_2_0:
    s_waitcnt vmcnt(3)
    v_max3_u32 v20, v32, v33, v34
    v_mfma_f32_16x16x32_bf16 v[88:91], v[32:35], v[32:35], 0
    v_max_u32 v20, v20, v35
    v_cmp_eq_u32 vcc, -1, v20
    v_mfma_f32_16x16x32_bf16 v[84:87], v[120:123], v[32:35], 0
    v_mfma_f32_16x16x32_bf16 v[80:83], v[104:107], v[32:35], 0
    s_cbranch_vccnz L_sd_19_2_0f
L_sd_19_2_1:
    s_waitcnt vmcnt(2)
    v_max3_u32 v20, v36, v37, v38
    v_mfma_f32_16x16x32_bf16 v[100:103], v[36:39], v[36:39], v[88:91]
    v_max_u32 v20, v20, v39
    v_cmp_eq_u32 vcc, -1, v20
    v_mfma_f32_16x16x32_bf16 v[96:99], v[124:127], v[36:39], v[84:87]
    v_mfma_f32_16x16x32_bf16 v[92:95], v[108:111], v[36:39], v[80:83]
    s_cbranch_vccnz L_sd_19_2_1f
L_sd_19_2_2:
    s_waitcnt vmcnt(1)
    v_max3_u32 v20, v40, v41, v42
    v_mfma_f32_16x16x32_bf16 v[228:231], v[40:43], v[40:43], v[100:103]
ct_p2432:
    s_cbranch_execz ct_p2450
    v_max_u32_e64 v20, v20, v43
    v_cmp_eq_u32 vcc, -1, v20
    v_mfma_f32_16x16x32_bf16 v[224:227], v[128:131], v[40:43], v[96:99]
    v_mfma_f32_16x16x32_bf16 v[220:223], v[112:115], v[40:43], v[92:95]
    s_cbranch_vccnz L_sd_19_2_2f
L_sd_19_2_3:
    s_waitcnt vmcnt(0)
    v_max3_u32 v20, v44, v45, v46
    v_mfma_f32_16x16x32_bf16 v[188:191], v[44:47], v[44:47], v[228:231]
    v_max_u32 v20, v20, v47
    v_cmp_eq_u32 vcc, -1, v20
    v_mfma_f32_16x16x32_bf16 v[184:187], v[132:135], v[44:47], v[224:227]
    v_mfma_f32_16x16x32_bf16 v[180:183], v[116:119], v[44:47], v[220:223]
    v_mov_b32_dpp v188, v189 row_ror:8 row_mask:0xf bank_mask:0xc
    v_mov_b32_dpp v190, v191 row_ror:8 row_mask:0xf bank_mask:0xc
    s_cbranch_vccnz L_sd_19_2_3f
    s_branch L_sd_19
    s_nop 0
ct_p2450:
    s_cbranch_execz ct_ret3
L_sd_19_2_0f:
    buffer_load_dwordx4 v[148:151], v5, s[8:11], s40 offen offset:0 sc1
    buffer_load_dwordx4 v[152:155], v5, s[8:11], s40 offen offset:1024 sc1
    buffer_load_dwordx4 v[156:159], v5, s[8:11], s40 offen offset:2048 sc1
    buffer_load_dwordx4 v[160:163], v5, s[8:11], s40 offen offset:3072 sc1
    s_add_u32 s33, s33, 1
    s_cmp_gt_u32 s33, 0x100000
    s_cbranch_scc1 chain_kernel_abort
    s_branch L_sd_19_3_0
    s_nop 0
L_sd_19_2_1f:
    buffer_load_dwordx4 v[152:155], v5, s[8:11], s40 offen offset:1024 sc1
    buffer_load_dwordx4 v[156:159], v5, s[8:11], s40 offen offset:2048 sc1
    buffer_load_dwordx4 v[160:163], v5, s[8:11], s40 offen offset:3072 sc1
    s_add_u32 s33, s33, 1
    s_cmp_gt_u32 s33, 0x100000
    s_cbranch_scc1 chain_kernel_abort
    s_branch L_sd_19_3_1
ct_c9:
ct_p2468:
    s_cbranch_execz ct_p2482
L_sd_19_2_2f:
    buffer_load_dwordx4 v[156:159], v5, s[8:11], s40 offen offset:2048 sc1
    buffer_load_dwordx4 v[160:163], v5, s[8:11], s40 offen offset:3072 sc1
    s_add_u32 s33, s33, 1
    s_cmp_gt_u32 s33, 0x100000
    s_cbranch_scc1 chain_kernel_abort
    s_branch L_sd_19_3_2
L_sd_19_2_3f:
    buffer_load_dwordx4 v[160:163], v5, s[8:11], s40 offen offset:3072 sc1
    s_add_u32 s33, s33, 1
    s_cmp_gt_u32 s33, 0x100000
    s_cbranch_scc1 chain_kernel_abort
    s_branch L_sd_19_3_3
ct_p2482:
    s_cbranch_execz ct_p2508
L_sd_19_3_0:
    s_waitcnt vmcnt(3)
    v_max3_u32 v20, v148, v149, v150
    v_mfma_f32_16x16x32_bf16 v[88:91], v[148:151], v[148:151], 0
    v_max_u32 v20, v20, v151
    v_cmp_eq_u32 vcc, -1, v20
    v_mfma_f32_16x16x32_bf16 v[84:87], v[120:123], v[148:151], 0
    v_mfma_f32_16x16x32_bf16 v[80:83], v[104:107], v[148:151], 0
    s_cbranch_vccnz L_sd_19_3_0f
L_sd_19_3_1:
    s_waitcnt vmcnt(2)
    v_max3_u32 v20, v152, v153, v154
    v_mfma_f32_16x16x32_bf16 v[100:103], v[152:155], v[152:155], v[88:91]
    v_max_u32 v20, v20, v155
    v_cmp_eq_u32 vcc, -1, v20
    v_mfma_f32_16x16x32_bf16 v[96:99], v[124:127], v[152:155], v[84:87]
    v_mfma_f32_16x16x32_bf16 v[92:95], v[108:111], v[152:155], v[80:83]
    s_cbranch_vccnz L_sd_19_3_1f
L_sd_19_3_2:
    s_waitcnt vmcnt(1)
    v_max3_u32 v20, v156, v157, v158
    v_mfma_f32_16x16x32_bf16 v[228:231], v[156:159], v[156:159], v[100:103]
    v_max_u32_e64 v20, v20, v159
    v_cmp_eq_u32 vcc, -1, v20
    v_mfma_f32_16x16x32_bf16 v[224:227], v[128:131], v[156:159], v[96:99]
ct_p2508:
    s_cbranch_execz ct_p2523
    v_mfma_f32_16x16x32_bf16 v[220:223], v[112:115], v[156:159], v[92:95]
    s_cbranch_vccnz L_sd_19_3_2f
L_sd_19_3_3:
    s_waitcnt vmcnt(0)
    v_max3_u32 v20, v160, v161, v162
    v_mfma_f32_16x16x32_bf16 v[188:191], v[160:163], v[160:163], v[228:231]
    v_max_u32 v20, v20, v163
    v_cmp_eq_u32 vcc, -1, v20
    v_mfma_f32_16x16x32_bf16 v[184:187], v[132:135], v[160:163], v[224:227]
    v_mfma_f32_16x16x32_bf16 v[180:183], v[116:119], v[160:163], v[220:223]
    v_mov_b32_dpp v188, v189 row_ror:8 row_mask:0xf bank_mask:0xc
    v_mov_b32_dpp v190, v191 row_ror:8 row_mask:0xf bank_mask:0xc
    s_cbranch_vccnz L_sd_19_3_3f
    s_branch L_sd_19
    s_nop 0
ct_p2523:
    s_cbranch_execz ct_p2541
L_sd_19_3_0f:
    buffer_load_dwordx4 v[148:151], v5, s[8:11], s40 offen offset:0 sc1
    buffer_load_dwordx4 v[152:155], v5, s[8:11], s40 offen offset:1024 sc1
    buffer_load_dwordx4 v[156:159], v5, s[8:11], s40 offen offset:2048 sc1
    buffer_load_dwordx4 v[160:163], v5, s[8:11], s40 offen offset:3072 sc1
    s_add_u32 s33, s33, 1
    s_cmp_gt_u32 s33, 0x100000
    s_cbranch_scc1 chain_kernel_abort
    s_branch L_sd_19_3_0
    s_nop 0
L_sd_19_3_1f:
    buffer_load_dwordx4 v[152:155], v5, s[8:11], s40 offen offset:1024 sc1
    buffer_load_dwordx4 v[156:159], v5, s[8:11], s40 offen offset:2048 sc1
    buffer_load_dwordx4 v[160:163], v5, s[8:11], s40 offen offset:3072 sc1
    s_add_u32 s33, s33, 1
    s_cmp_gt_u32 s33, 0x100000
    s_cbranch_scc1 chain_kernel_abort
    s_branch L_sd_19_3_1
ct_p2541:
    s_cbranch_execz ct_p2555
L_sd_19_3_2f:
    buffer_load_dwordx4 v[156:159], v5, s[8:11], s40 offen offset:2048 sc1
    buffer_load_dwordx4 v[160:163], v5, s[8:11], s40 offen offset:3072 sc1
    s_add_u32 s33, s33, 1
    s_cmp_gt_u32 s33, 0x100000
    s_cbranch_scc1 chain_kernel_abort
    s_branch L_sd_19_3_2
L_sd_19_3_3f:
    buffer_load_dwordx4 v[160:163], v5, s[8:11], s40 offen offset:3072 sc1
    s_add_u32 s33, s33, 1
    s_cmp_gt_u32 s33, 0x100000
    s_cbranch_scc1 chain_kernel_abort
    s_branch L_sd_19_3_3
ct_p2555:
    s_cbranch_execz ct_p2571
Go_20_f0123:
    buffer_load_dwordx4 v[32:35], v3, s[8:11], s40 offen offset:0 sc1
    s_branch Go_20_s1230
Go_20_f123:
    buffer_load_dwordx4 v[36:39], v3, s[8:11], s40 offen offset:1024 sc1
    s_add_u32 s33, s33, 1
    s_cmp_gt_u32 s33, 0x100000
    s_cbranch_scc1 chain_kernel_abort
    s_branch Go_20_s231
Go_20_f23:
    buffer_load_dwordx4 v[40:43], v3, s[8:11], s40 offen offset:2048 sc1
    s_add_u32 s33, s33, 1
    s_cmp_gt_u32 s33, 0x100000
    s_cbranch_scc1 chain_kernel_abort
    s_branch Go_20_s32
ct_p2571:
    s_cbranch_execz ct_p2592
Go_20_f3:
    buffer_load_dwordx4 v[44:47], v3, s[8:11], s40 offen offset:3072 sc1
    s_add_u32 s33, s33, 1
    s_cmp_gt_u32 s33, 0x100000
    s_cbranch_scc1 chain_kernel_abort
    s_branch Go_20_s3
Go_20_redo:
    buffer_load_dwordx4 v[32:35], v3, s[8:11], s40 offen offset:0 sc1
    buffer_load_dwordx4 v[36:39], v3, s[8:11], s40 offen offset:1024 sc1
    buffer_load_dwordx4 v[40:43], v3, s[8:11], s40 offen offset:2048 sc1
    buffer_load_dwordx4 v[44:47], v3, s[8:11], s40 offen offset:3072 sc1
    s_add_u32 s33, s33, 1
    s_cmp_gt_u32 s33, 0x100000
    s_cbranch_scc1 chain_kernel_abort
    s_nop 5
    v_mov_b32_e64 v76, 0
    v_mov_b32 v77, 0
    v_mov_b32 v78, 0
    v_mov_b32 v79, 0
    s_branch Go_20_s0123
ct_p2592:
    s_cbranch_execz ct_p2616
Go_20_s1230:
    s_waitcnt vmcnt(3)
    v_cmp_eq_u32 vcc, -1, v36
    v_mov_b32_dpp v52, v36 row_ror:8 row_mask:0xf bank_mask:0xf
    v_mov_b32_dpp v53, v37 row_ror:8 row_mask:0xf bank_mask:0xf
    v_mov_b32_dpp v54, v38 row_ror:8 row_mask:0xf bank_mask:0xf
    v_mov_b32_dpp v55, v39 row_ror:8 row_mask:0xf bank_mask:0xf
    s_cbranch_vccnz Go_20_f1230
    v_smfmac_f32_16x16x64_bf16 v[76:79], v[36:39], a[200:207], v19
    v_smfmac_f32_16x16x64_bf16 v[76:79], v[52:55], a[232:239], v19
Go_20_s230:
    s_waitcnt vmcnt(2)
    v_cmp_eq_u32_e64 vcc, -1, v40
    v_mov_b32_dpp v56, v40 row_ror:8 row_mask:0xf bank_mask:0xf
    v_mov_b32_dpp v57, v41 row_ror:8 row_mask:0xf bank_mask:0xf
    v_mov_b32_dpp v58, v42 row_ror:8 row_mask:0xf bank_mask:0xf
    v_mov_b32_dpp v59, v43 row_ror:8 row_mask:0xf bank_mask:0xf
    s_cbranch_vccnz Go_20_f230
    v_smfmac_f32_16x16x64_bf16 v[76:79], v[40:43], a[208:215], v19
    v_smfmac_f32_16x16x64_bf16 v[76:79], v[56:59], a[240:247], v19
Go_20_s30:
    s_waitcnt vmcnt(1)
    v_cmp_eq_u32 vcc, -1, v44
ct_p2616:
    s_cbranch_execz ct_p2635
    v_mov_b32_dpp v60, v44 row_ror:8 row_mask:0xf bank_mask:0xf
    v_mov_b32_dpp v61, v45 row_ror:8 row_mask:0xf bank_mask:0xf
    v_mov_b32_dpp v62, v46 row_ror:8 row_mask:0xf bank_mask:0xf
    v_mov_b32_dpp v63, v47 row_ror:8 row_mask:0xf bank_mask:0xf
    s_cbranch_vccnz Go_20_f30
    v_smfmac_f32_16x16x64_bf16 v[76:79], v[44:47], a[216:223], v19
    v_smfmac_f32_16x16x64_bf16 v[76:79], v[60:63], a[248:255], v19
Go_20_s0:
    s_waitcnt vmcnt(0)
    v_cmp_eq_u32_e64 vcc, -1, v32
    v_mov_b32_dpp v48, v32 row_ror:8 row_mask:0xf bank_mask:0xf
    v_mov_b32_dpp v49, v33 row_ror:8 row_mask:0xf bank_mask:0xf
    v_mov_b32_dpp v50, v34 row_ror:8 row_mask:0xf bank_mask:0xf
    v_mov_b32_dpp v51, v35 row_ror:8 row_mask:0xf bank_mask:0xf
    s_cbranch_vccnz Go_20_f0
    v_smfmac_f32_16x16x64_bf16 v[76:79], v[32:35], a[192:199], v19
    v_smfmac_f32_16x16x64_bf16 v[76:79], v[48:51], a[224:231], v19
    s_branch Go_20_done
ct_p2635:
    s_cbranch_execz ct_p2654
Go_20_f1230:
    buffer_load_dwordx4 v[36:39], v3, s[8:11], s40 offen offset:1024 sc1
    s_add_u32 s33, s33, 1
    s_cmp_gt_u32 s33, 0x100000
    s_cbranch_scc1 chain_kernel_abort
    s_branch Go_20_s2301
Go_20_f230:
    buffer_load_dwordx4 v[40:43], v3, s[8:11], s40 offen offset:2048 sc1
    s_add_u32 s33, s33, 1
    s_cmp_gt_u32 s33, 0x100000
    s_cbranch_scc1 chain_kernel_abort
    s_branch Go_20_s302
Go_20_f30:
    buffer_load_dwordx4 v[44:47], v3, s[8:11], s40 offen offset:3072 sc1
    s_add_u32 s33, s33, 1
    s_cmp_gt_u32 s33, 0x100000
    s_cbranch_scc1 chain_kernel_abort
    s_branch Go_20_s03
ct_p2654:
    s_cbranch_execz ct_p2678
Go_20_f0:
    buffer_load_dwordx4 v[32:35], v3, s[8:11], s40 offen offset:0 sc1
    s_add_u32 s33, s33, 1
    s_cmp_gt_u32 s33, 0x100000
    s_cbranch_scc1 chain_kernel_abort
    s_branch Go_20_s0
Go_20_s231:
    s_waitcnt vmcnt(2)
    v_cmp_eq_u32 vcc, -1, v40
    v_mov_b32_dpp v56, v40 row_ror:8 row_mask:0xf bank_mask:0xf
    v_mov_b32_dpp v57, v41 row_ror:8 row_mask:0xf bank_mask:0xf
    v_mov_b32_dpp v58, v42 row_ror:8 row_mask:0xf bank_mask:0xf
    v_mov_b32_dpp v59, v43 row_ror:8 row_mask:0xf bank_mask:0xf
    s_cbranch_vccnz Go_20_f231
    v_smfmac_f32_16x16x64_bf16 v[76:79], v[40:43], a[208:215], v19
    v_smfmac_f32_16x16x64_bf16 v[76:79], v[56:59], a[240:247], v19
Go_20_s31:
    s_waitcnt vmcnt(1)
    v_cmp_eq_u32_e64 vcc, -1, v44
    v_mov_b32_dpp v60, v44 row_ror:8 row_mask:0xf bank_mask:0xf
    v_mov_b32_dpp v61, v45 row_ror:8 row_mask:0xf bank_mask:0xf
    v_mov_b32_dpp v62, v46 row_ror:8 row_mask:0xf bank_mask:0xf
    v_mov_b32_dpp v63, v47 row_ror:8 row_mask:0xf bank_mask:0xf
ct_p2678:
    s_cbranch_execz ct_ret4
    s_cbranch_vccnz Go_20_f31
    v_smfmac_f32_16x16x64_bf16 v[76:79], v[44:47], a[216:223], v19
    v_smfmac_f32_16x16x64_bf16 v[76:79], v[60:63], a[248:255], v19
Go_20_s1:
    s_waitcnt vmcnt(0)
    v_cmp_eq_u32 vcc, -1, v36
    v_mov_b32_dpp v52, v36 row_ror:8 row_mask:0xf bank_mask:0xf
    v_mov_b32_dpp v53, v37 row_ror:8 row_mask:0xf bank_mask:0xf
    v_mov_b32_dpp v54, v38 row_ror:8 row_mask:0xf bank_mask:0xf
    v_mov_b32_dpp v55, v39 row_ror:8 row_mask:0xf bank_mask:0xf
    s_cbranch_vccnz Go_20_f1
    v_smfmac_f32_16x16x64_bf16 v[76:79], v[36:39], a[200:207], v19
    v_smfmac_f32_16x16x64_bf16 v[76:79], v[52:55], a[232:239], v19
    s_branch Go_20_done
    s_nop 0
ct_c10:
ct_p2693:
    s_cbranch_execz ct_p2712
Go_20_f231:
    buffer_load_dwordx4 v[40:43], v3, s[8:11], s40 offen offset:2048 sc1
    s_add_u32 s33, s33, 1
    s_cmp_gt_u32 s33, 0x100000
    s_cbranch_scc1 chain_kernel_abort
    s_branch Go_20_s312
Go_20_f31:
    buffer_load_dwordx4 v[44:47], v3, s[8:11], s40 offen offset:3072 sc1
    s_add_u32 s33, s33, 1
    s_cmp_gt_u32 s33, 0x100000
    s_cbranch_scc1 chain_kernel_abort
    s_branch Go_20_s13
Go_20_f1:
    buffer_load_dwordx4 v[36:39], v3, s[8:11], s40 offen offset:1024 sc1
    s_add_u32 s33, s33, 1
    s_cmp_gt_u32 s33, 0x100000
    s_cbranch_scc1 chain_kernel_abort
    s_branch Go_20_s1
ct_p2712:
    s_cbranch_execz ct_p2734
Go_20_s32:
    s_waitcnt vmcnt(1)
    v_cmp_eq_u32 vcc, -1, v44
    v_mov_b32_dpp v60, v44 row_ror:8 row_mask:0xf bank_mask:0xf
    v_mov_b32_dpp v61, v45 row_ror:8 row_mask:0xf bank_mask:0xf
    v_mov_b32_dpp v62, v46 row_ror:8 row_mask:0xf bank_mask:0xf
    v_mov_b32_dpp v63, v47 row_ror:8 row_mask:0xf bank_mask:0xf
    s_cbranch_vccnz Go_20_f32
    v_smfmac_f32_16x16x64_bf16 v[76:79], v[44:47], a[216:223], v19
    v_smfmac_f32_16x16x64_bf16 v[76:79], v[60:63], a[248:255], v19
Go_20_s2:
    s_waitcnt vmcnt(0)
    v_cmp_eq_u32_e64 vcc, -1, v40
    v_mov_b32_dpp v56, v40 row_ror:8 row_mask:0xf bank_mask:0xf
    v_mov_b32_dpp v57, v41 row_ror:8 row_mask:0xf bank_mask:0xf
    v_mov_b32_dpp v58, v42 row_ror:8 row_mask:0xf bank_mask:0xf
    v_mov_b32_dpp v59, v43 row_ror:8 row_mask:0xf bank_mask:0xf
    s_cbranch_vccnz Go_20_f2
    v_smfmac_f32_16x16x64_bf16 v[76:79], v[40:43], a[208:215], v19
    v_smfmac_f32_16x16x64_bf16 v[76:79], v[56:59], a[240:247], v19
    s_branch Go_20_done
    s_nop 0
ct_p2734:
    s_cbranch_execz ct_p2761
Go_20_f32:
    buffer_load_dwordx4 v[44:47], v3, s[8:11], s40 offen offset:3072 sc1
    s_add_u32 s33, s33, 1
    s_cmp_gt_u32 s33, 0x100000
    s_cbranch_scc1 chain_kernel_abort
    s_branch Go_20_s23
Go_20_f2:
    buffer_load_dwordx4 v[40:43], v3, s[8:11], s40 offen offset:2048 sc1
    s_add_u32 s33, s33, 1
    s_cmp_gt_u32 s33, 0x100000
    s_cbranch_scc1 chain_kernel_abort
    s_branch Go_20_s2
Go_20_s2301:
    s_waitcnt vmcnt(3)
    v_cmp_eq_u32 vcc, -1, v40
    v_mov_b32_dpp v56, v40 row_ror:8 row_mask:0xf bank_mask:0xf
    v_mov_b32_dpp v57, v41 row_ror:8 row_mask:0xf bank_mask:0xf
    v_mov_b32_dpp v58, v42 row_ror:8 row_mask:0xf bank_mask:0xf
    v_mov_b32_dpp v59, v43 row_ror:8 row_mask:0xf bank_mask:0xf
    s_cbranch_vccnz Go_20_f2301
    v_smfmac_f32_16x16x64_bf16 v[76:79], v[40:43], a[208:215], v19
    v_smfmac_f32_16x16x64_bf16 v[76:79], v[56:59], a[240:247], v19
Go_20_s301:
    s_waitcnt vmcnt(2)
    v_cmp_eq_u32 vcc, -1, v44
    v_mov_b32_dpp v60, v44 row_ror:8 row_mask:0xf bank_mask:0xf
ct_p2761:
    s_cbranch_execz ct_p2779
    v_mov_b32_dpp v61, v45 row_ror:8 row_mask:0xf bank_mask:0xf
    v_mov_b32_dpp v62, v46 row_ror:8 row_mask:0xf bank_mask:0xf
    v_mov_b32_dpp v63, v47 row_ror:8 row_mask:0xf bank_mask:0xf
    s_cbranch_vccnz Go_20_f301
    v_smfmac_f32_16x16x64_bf16 v[76:79], v[44:47], a[216:223], v19
    v_smfmac_f32_16x16x64_bf16 v[76:79], v[60:63], a[248:255], v19
Go_20_s01:
    s_waitcnt vmcnt(1)
    v_cmp_eq_u32_e64 vcc, -1, v32
    v_mov_b32_dpp v48, v32 row_ror:8 row_mask:0xf bank_mask:0xf
    v_mov_b32_dpp v49, v33 row_ror:8 row_mask:0xf bank_mask:0xf
    v_mov_b32_dpp v50, v34 row_ror:8 row_mask:0xf bank_mask:0xf
    v_mov_b32_dpp v51, v35 row_ror:8 row_mask:0xf bank_mask:0xf
    s_cbranch_vccnz Go_20_f01
    v_smfmac_f32_16x16x64_bf16 v[76:79], v[32:35], a[192:199], v19
    v_smfmac_f32_16x16x64_bf16 v[76:79], v[48:51], a[224:231], v19
    s_branch Go_20_s1
    s_nop 0
ct_p2779:
    s_cbranch_execz ct_p2798
Go_20_f2301:
    buffer_load_dwordx4 v[40:43], v3, s[8:11], s40 offen offset:2048 sc1
    s_add_u32 s33, s33, 1
    s_cmp_gt_u32 s33, 0x100000
    s_cbranch_scc1 chain_kernel_abort
    s_branch Go_20_s3012
Go_20_f301:
    buffer_load_dwordx4 v[44:47], v3, s[8:11], s40 offen offset:3072 sc1
    s_add_u32 s33, s33, 1
    s_cmp_gt_u32 s33, 0x100000
    s_cbranch_scc1 chain_kernel_abort
    s_branch Go_20_s013
Go_20_f01:
    buffer_load_dwordx4 v[32:35], v3, s[8:11], s40 offen offset:0 sc1
    s_add_u32 s33, s33, 1
    s_cmp_gt_u32 s33, 0x100000
    s_cbranch_scc1 chain_kernel_abort
    s_branch Go_20_s10
ct_p2798:
    s_cbranch_execz ct_p2820
Go_20_s302:
    s_waitcnt vmcnt(2)
    v_cmp_eq_u32 vcc, -1, v44
    v_mov_b32_dpp v60, v44 row_ror:8 row_mask:0xf bank_mask:0xf
    v_mov_b32_dpp v61, v45 row_ror:8 row_mask:0xf bank_mask:0xf
    v_mov_b32_dpp v62, v46 row_ror:8 row_mask:0xf bank_mask:0xf
    v_mov_b32_dpp v63, v47 row_ror:8 row_mask:0xf bank_mask:0xf
    s_cbranch_vccnz Go_20_f302
    v_smfmac_f32_16x16x64_bf16 v[76:79], v[44:47], a[216:223], v19
    v_smfmac_f32_16x16x64_bf16 v[76:79], v[60:63], a[248:255], v19
Go_20_s02:
    s_waitcnt vmcnt(1)
    v_cmp_eq_u32_e64 vcc, -1, v32
    v_mov_b32_dpp v48, v32 row_ror:8 row_mask:0xf bank_mask:0xf
    v_mov_b32_dpp v49, v33 row_ror:8 row_mask:0xf bank_mask:0xf
    v_mov_b32_dpp v50, v34 row_ror:8 row_mask:0xf bank_mask:0xf
    v_mov_b32_dpp v51, v35 row_ror:8 row_mask:0xf bank_mask:0xf
    s_cbranch_vccnz Go_20_f02
    v_smfmac_f32_16x16x64_bf16 v[76:79], v[32:35], a[192:199], v19
    v_smfmac_f32_16x16x64_bf16 v[76:79], v[48:51], a[224:231], v19
    s_branch Go_20_s2
    s_nop 0
ct_p2820:
    s_cbranch_execz ct_p2844
Go_20_f302:
    buffer_load_dwordx4 v[44:47], v3, s[8:11], s40 offen offset:3072 sc1
    s_add_u32 s33, s33, 1
    s_cmp_gt_u32 s33, 0x100000
    s_cbranch_scc1 chain_kernel_abort
    s_branch Go_20_s023
Go_20_f02:
    buffer_load_dwordx4 v[32:35], v3, s[8:11], s40 offen offset:0 sc1
    s_add_u32 s33, s33, 1
    s_cmp_gt_u32 s33, 0x100000
    s_cbranch_scc1 chain_kernel_abort
    s_branch Go_20_s20
Go_20_s03:
    s_waitcnt vmcnt(1)
    v_cmp_eq_u32 vcc, -1, v32
    v_mov_b32_dpp v48, v32 row_ror:8 row_mask:0xf bank_mask:0xf
    v_mov_b32_dpp v49, v33 row_ror:8 row_mask:0xf bank_mask:0xf
    v_mov_b32_dpp v50, v34 row_ror:8 row_mask:0xf bank_mask:0xf
    v_mov_b32_dpp v51, v35 row_ror:8 row_mask:0xf bank_mask:0xf
    s_cbranch_vccnz Go_20_f03
    v_smfmac_f32_16x16x64_bf16 v[76:79], v[32:35], a[192:199], v19
    v_smfmac_f32_16x16x64_bf16 v[76:79], v[48:51], a[224:231], v19
    s_branch Go_20_s3
ct_p2844:
    s_cbranch_execz ct_p2868
Go_20_f03:
    buffer_load_dwordx4 v[32:35], v3, s[8:11], s40 offen offset:0 sc1
    s_add_u32 s33, s33, 1
    s_cmp_gt_u32 s33, 0x100000
    s_cbranch_scc1 chain_kernel_abort
    s_branch Go_20_s30
Go_20_s312:
    s_waitcnt vmcnt(2)
    v_cmp_eq_u32 vcc, -1, v44
    v_mov_b32_dpp v60, v44 row_ror:8 row_mask:0xf bank_mask:0xf
    v_mov_b32_dpp v61, v45 row_ror:8 row_mask:0xf bank_mask:0xf
    v_mov_b32_dpp v62, v46 row_ror:8 row_mask:0xf bank_mask:0xf
    v_mov_b32_dpp v63, v47 row_ror:8 row_mask:0xf bank_mask:0xf
    s_cbranch_vccnz Go_20_f312
    v_smfmac_f32_16x16x64_bf16 v[76:79], v[44:47], a[216:223], v19
    v_smfmac_f32_16x16x64_bf16 v[76:79], v[60:63], a[248:255], v19
Go_20_s12:
    s_waitcnt vmcnt(1)
    v_cmp_eq_u32_e64 vcc, -1, v36
    v_mov_b32_dpp v52, v36 row_ror:8 row_mask:0xf bank_mask:0xf
    v_mov_b32_dpp v53, v37 row_ror:8 row_mask:0xf bank_mask:0xf
    v_mov_b32_dpp v54, v38 row_ror:8 row_mask:0xf bank_mask:0xf
    v_mov_b32_dpp v55, v39 row_ror:8 row_mask:0xf bank_mask:0xf
ct_p2868:
    s_cbranch_execz ct_p2885
    s_cbranch_vccnz Go_20_f12
    v_smfmac_f32_16x16x64_bf16 v[76:79], v[36:39], a[200:207], v19
    v_smfmac_f32_16x16x64_bf16 v[76:79], v[52:55], a[232:239], v19
    s_branch Go_20_s2
Go_20_f312:
    buffer_load_dwordx4 v[44:47], v3, s[8:11], s40 offen offset:3072 sc1
    s_add_u32 s33, s33, 1
    s_cmp_gt_u32 s33, 0x100000
    s_cbranch_scc1 chain_kernel_abort
    s_branch Go_20_s123
Go_20_f12:
    buffer_load_dwordx4 v[36:39], v3, s[8:11], s40 offen offset:1024 sc1
    s_add_u32 s33, s33, 1
    s_cmp_gt_u32 s33, 0x100000
    s_cbranch_scc1 chain_kernel_abort
    s_branch Go_20_s21
ct_p2885:
    s_cbranch_execz ct_p2897
Go_20_s13:
    s_waitcnt vmcnt(1)
    v_cmp_eq_u32 vcc, -1, v36
    v_mov_b32_dpp v52, v36 row_ror:8 row_mask:0xf bank_mask:0xf
    v_mov_b32_dpp v53, v37 row_ror:8 row_mask:0xf bank_mask:0xf
    v_mov_b32_dpp v54, v38 row_ror:8 row_mask:0xf bank_mask:0xf
    v_mov_b32_dpp v55, v39 row_ror:8 row_mask:0xf bank_mask:0xf
    s_cbranch_vccnz Go_20_f13
    v_smfmac_f32_16x16x64_bf16 v[76:79], v[36:39], a[200:207], v19
    v_smfmac_f32_16x16x64_bf16 v[76:79], v[52:55], a[232:239], v19
    s_branch Go_20_s3
ct_p2897:
    s_cbranch_execz ct_p2921
Go_20_f13:
    buffer_load_dwordx4 v[36:39], v3, s[8:11], s40 offen offset:1024 sc1
    s_add_u32 s33, s33, 1
    s_cmp_gt_u32 s33, 0x100000
    s_cbranch_scc1 chain_kernel_abort
    s_branch Go_20_s31
Go_20_s3012:
    s_waitcnt vmcnt(3)
    v_cmp_eq_u32 vcc, -1, v44
    v_mov_b32_dpp v60, v44 row_ror:8 row_mask:0xf bank_mask:0xf
    v_mov_b32_dpp v61, v45 row_ror:8 row_mask:0xf bank_mask:0xf
    v_mov_b32_dpp v62, v46 row_ror:8 row_mask:0xf bank_mask:0xf
    v_mov_b32_dpp v63, v47 row_ror:8 row_mask:0xf bank_mask:0xf
    s_cbranch_vccnz Go_20_f3012
    v_smfmac_f32_16x16x64_bf16 v[76:79], v[44:47], a[216:223], v19
    v_smfmac_f32_16x16x64_bf16 v[76:79], v[60:63], a[248:255], v19
Go_20_s012:
    s_waitcnt vmcnt(2)
    v_cmp_eq_u32_e64 vcc, -1, v32
    v_mov_b32_dpp v48, v32 row_ror:8 row_mask:0xf bank_mask:0xf
    v_mov_b32_dpp v49, v33 row_ror:8 row_mask:0xf bank_mask:0xf
    v_mov_b32_dpp v50, v34 row_ror:8 row_mask:0xf bank_mask:0xf
    v_mov_b32_dpp v51, v35 row_ror:8 row_mask:0xf bank_mask:0xf
ct_p2921:
    s_cbranch_execz ct_ret4
    s_cbranch_vccnz Go_20_f012
    v_smfmac_f32_16x16x64_bf16 v[76:79], v[32:35], a[192:199], v19
    v_smfmac_f32_16x16x64_bf16 v[76:79], v[48:51], a[224:231], v19
    s_branch Go_20_s12
Go_20_f3012:
    buffer_load_dwordx4 v[44:47], v3, s[8:11], s40 offen offset:3072 sc1
    s_add_u32 s33, s33, 1
    s_cmp_gt_u32 s33, 0x100000
    s_cbranch_scc1 chain_kernel_abort
    s_branch Go_20_s0123
Go_20_f012:
    buffer_load_dwordx4 v[32:35], v3, s[8:11], s40 offen offset:0 sc1
    s_add_u32 s33, s33, 1
    s_cmp_gt_u32 s33, 0x100000
    s_cbranch_scc1 chain_kernel_abort
    s_branch Go_20_s120
ct_c11:
ct_p2938:
    s_cbranch_execz ct_p2950
Go_20_s013:
    s_waitcnt vmcnt(2)
    v_cmp_eq_u32 vcc, -1, v32
    v_mov_b32_dpp v48, v32 row_ror:8 row_mask:0xf bank_mask:0xf
    v_mov_b32_dpp v49, v33 row_ror:8 row_mask:0xf bank_mask:0xf
    v_mov_b32_dpp v50, v34 row_ror:8 row_mask:0xf bank_mask:0xf
    v_mov_b32_dpp v51, v35 row_ror:8 row_mask:0xf bank_mask:0xf
    s_cbranch_vccnz Go_20_f013
    v_smfmac_f32_16x16x64_bf16 v[76:79], v[32:35], a[192:199], v19
    v_smfmac_f32_16x16x64_bf16 v[76:79], v[48:51], a[224:231], v19
    s_branch Go_20_s13
ct_p2950:
    s_cbranch_execz ct_p2968
Go_20_f013:
    buffer_load_dwordx4 v[32:35], v3, s[8:11], s40 offen offset:0 sc1
    s_add_u32 s33, s33, 1
    s_cmp_gt_u32 s33, 0x100000
    s_cbranch_scc1 chain_kernel_abort
    s_branch Go_20_s130
Go_20_s10:
    s_waitcnt vmcnt(1)
    v_cmp_eq_u32 vcc, -1, v36
    v_mov_b32_dpp v52, v36 row_ror:8 row_mask:0xf bank_mask:0xf
    v_mov_b32_dpp v53, v37 row_ror:8 row_mask:0xf bank_mask:0xf
    v_mov_b32_dpp v54, v38 row_ror:8 row_mask:0xf bank_mask:0xf
    v_mov_b32_dpp v55, v39 row_ror:8 row_mask:0xf bank_mask:0xf
    s_cbranch_vccnz Go_20_f10
    v_smfmac_f32_16x16x64_bf16 v[76:79], v[36:39], a[200:207], v19
    v_smfmac_f32_16x16x64_bf16 v[76:79], v[52:55], a[232:239], v19
    s_branch Go_20_s0
ct_p2968:
    s_cbranch_execz ct_p2986
Go_20_f10:
    buffer_load_dwordx4 v[36:39], v3, s[8:11], s40 offen offset:1024 sc1
    s_add_u32 s33, s33, 1
    s_cmp_gt_u32 s33, 0x100000
    s_cbranch_scc1 chain_kernel_abort
    s_branch Go_20_s01
Go_20_s023:
    s_waitcnt vmcnt(2)
    v_cmp_eq_u32 vcc, -1, v32
    v_mov_b32_dpp v48, v32 row_ror:8 row_mask:0xf bank_mask:0xf
    v_mov_b32_dpp v49, v33 row_ror:8 row_mask:0xf bank_mask:0xf
    v_mov_b32_dpp v50, v34 row_ror:8 row_mask:0xf bank_mask:0xf
    v_mov_b32_dpp v51, v35 row_ror:8 row_mask:0xf bank_mask:0xf
    s_cbranch_vccnz Go_20_f023
    v_smfmac_f32_16x16x64_bf16 v[76:79], v[32:35], a[192:199], v19
    v_smfmac_f32_16x16x64_bf16 v[76:79], v[48:51], a[224:231], v19
    s_branch Go_20_s23
ct_p2986:
    s_cbranch_execz ct_p3004
Go_20_f023:
    buffer_load_dwordx4 v[32:35], v3, s[8:11], s40 offen offset:0 sc1
    s_add_u32 s33, s33, 1
    s_cmp_gt_u32 s33, 0x100000
    s_cbranch_scc1 chain_kernel_abort
    s_branch Go_20_s230
Go_20_s20:
    s_waitcnt vmcnt(1)
    v_cmp_eq_u32 vcc, -1, v40
    v_mov_b32_dpp v56, v40 row_ror:8 row_mask:0xf bank_mask:0xf
    v_mov_b32_dpp v57, v41 row_ror:8 row_mask:0xf bank_mask:0xf
    v_mov_b32_dpp v58, v42 row_ror:8 row_mask:0xf bank_mask:0xf
    v_mov_b32_dpp v59, v43 row_ror:8 row_mask:0xf bank_mask:0xf
    s_cbranch_vccnz Go_20_f20
    v_smfmac_f32_16x16x64_bf16 v[76:79], v[40:43], a[208:215], v19
    v_smfmac_f32_16x16x64_bf16 v[76:79], v[56:59], a[240:247], v19
    s_branch Go_20_s0
ct_p3004:
    s_cbranch_execz ct_p3022
Go_20_f20:
    buffer_load_dwordx4 v[40:43], v3, s[8:11], s40 offen offset:2048 sc1
    s_add_u32 s33, s33, 1
    s_cmp_gt_u32 s33, 0x100000
    s_cbranch_scc1 chain_kernel_abort
    s_branch Go_20_s02
Go_20_s21:
    s_waitcnt vmcnt(1)
    v_cmp_eq_u32 vcc, -1, v40
    v_mov_b32_dpp v56, v40 row_ror:8 row_mask:0xf bank_mask:0xf
    v_mov_b32_dpp v57, v41 row_ror:8 row_mask:0xf bank_mask:0xf
    v_mov_b32_dpp v58, v42 row_ror:8 row_mask:0xf bank_mask:0xf
    v_mov_b32_dpp v59, v43 row_ror:8 row_mask:0xf bank_mask:0xf
    s_cbranch_vccnz Go_20_f21
    v_smfmac_f32_16x16x64_bf16 v[76:79], v[40:43], a[208:215], v19
    v_smfmac_f32_16x16x64_bf16 v[76:79], v[56:59], a[240:247], v19
    s_branch Go_20_s1
ct_p3022:
    s_cbranch_execz ct_p3040
Go_20_f21:
    buffer_load_dwordx4 v[40:43], v3, s[8:11], s40 offen offset:2048 sc1
    s_add_u32 s33, s33, 1
    s_cmp_gt_u32 s33, 0x100000
    s_cbranch_scc1 chain_kernel_abort
    s_branch Go_20_s12
Go_20_s120:
    s_waitcnt vmcnt(2)
    v_cmp_eq_u32 vcc, -1, v36
    v_mov_b32_dpp v52, v36 row_ror:8 row_mask:0xf bank_mask:0xf
    v_mov_b32_dpp v53, v37 row_ror:8 row_mask:0xf bank_mask:0xf
    v_mov_b32_dpp v54, v38 row_ror:8 row_mask:0xf bank_mask:0xf
    v_mov_b32_dpp v55, v39 row_ror:8 row_mask:0xf bank_mask:0xf
    s_cbranch_vccnz Go_20_f120
    v_smfmac_f32_16x16x64_bf16 v[76:79], v[36:39], a[200:207], v19
    v_smfmac_f32_16x16x64_bf16 v[76:79], v[52:55], a[232:239], v19
    s_branch Go_20_s20
ct_p3040:
    s_cbranch_execz ct_p3058
Go_20_f120:
    buffer_load_dwordx4 v[36:39], v3, s[8:11], s40 offen offset:1024 sc1
    s_add_u32 s33, s33, 1
    s_cmp_gt_u32 s33, 0x100000
    s_cbranch_scc1 chain_kernel_abort
    s_branch Go_20_s201
Go_20_s130:
    s_waitcnt vmcnt(2)
    v_cmp_eq_u32 vcc, -1, v36
    v_mov_b32_dpp v52, v36 row_ror:8 row_mask:0xf bank_mask:0xf
    v_mov_b32_dpp v53, v37 row_ror:8 row_mask:0xf bank_mask:0xf
    v_mov_b32_dpp v54, v38 row_ror:8 row_mask:0xf bank_mask:0xf
    v_mov_b32_dpp v55, v39 row_ror:8 row_mask:0xf bank_mask:0xf
    s_cbranch_vccnz Go_20_f130
    v_smfmac_f32_16x16x64_bf16 v[76:79], v[36:39], a[200:207], v19
    v_smfmac_f32_16x16x64_bf16 v[76:79], v[52:55], a[232:239], v19
    s_branch Go_20_s30
ct_p3058:
    s_cbranch_execz ct_p3076
Go_20_f130:
    buffer_load_dwordx4 v[36:39], v3, s[8:11], s40 offen offset:1024 sc1
    s_add_u32 s33, s33, 1
    s_cmp_gt_u32 s33, 0x100000
    s_cbranch_scc1 chain_kernel_abort
    s_branch Go_20_s301
Go_20_s201:
    s_waitcnt vmcnt(2)
    v_cmp_eq_u32 vcc, -1, v40
    v_mov_b32_dpp v56, v40 row_ror:8 row_mask:0xf bank_mask:0xf
    v_mov_b32_dpp v57, v41 row_ror:8 row_mask:0xf bank_mask:0xf
    v_mov_b32_dpp v58, v42 row_ror:8 row_mask:0xf bank_mask:0xf
    v_mov_b32_dpp v59, v43 row_ror:8 row_mask:0xf bank_mask:0xf
    s_cbranch_vccnz Go_20_f201
    v_smfmac_f32_16x16x64_bf16 v[76:79], v[40:43], a[208:215], v19
    v_smfmac_f32_16x16x64_bf16 v[76:79], v[56:59], a[240:247], v19
    s_branch Go_20_s01
ct_p3076:
    s_cbranch_execz ct_p3092
Go_20_f201:
    buffer_load_dwordx4 v[40:43], v3, s[8:11], s40 offen offset:2048 sc1
    s_add_u32 s33, s33, 1
    s_cmp_gt_u32 s33, 0x100000
    s_cbranch_scc1 chain_kernel_abort
    s_branch Go_20_s012
    s_nop 0
L_pf_22:
    s_mov_b64 exec, -1
    buffer_load_short_d16_hi v220, v9, s[8:11], s43 offen sc1
    buffer_load_short_d16_hi v221, v10, s[8:11], s43 offen sc1
    buffer_load_short_d16_hi v222, v11, s[8:11], s43 offen sc1
    s_add_u32 s33, s33, 1
    s_cmp_gt_u32 s33, 0x100000
    s_cbranch_scc1 chain_kernel_abort
    s_branch L_pd_21_1
ct_p3092:
    s_cbranch_execz ct_p3108
L_pd_21_1:
    s_waitcnt vmcnt(7)
    v_add_f32 v208, v80, v223
    s_waitcnt vmcnt(5)
    v_max3_u32 v20, v223, v224, v225
    v_add_f32 v209, v224, v225
    v_cmp_eq_u32 vcc, 0xffff0000, v20
    v_add_f32 v208, v208, v209
    s_nop 1
    v_mov_b32_dpp v209, v208 quad_perm:[1,0,3,2] row_mask:0xf bank_mask:0xf
    s_mov_b64 exec, s[26:27]
    v_cvt_pk_bf16_f32 v208, v208, v209
    v_min_u32 v208, 0xfffffffe, v208
    s_cbranch_vccnz L_pf_23
    s_branch L_pd_21
ct_p3108:
    s_cbranch_execz ct_p3133
L_pf_23:
    s_mov_b64 exec, -1
    buffer_load_short_d16_hi v223, v9, s[8:11], s44 offen sc1
    buffer_load_short_d16_hi v224, v10, s[8:11], s44 offen sc1
    buffer_load_short_d16_hi v225, v11, s[8:11], s44 offen sc1
    s_add_u32 s33, s33, 1
    s_cmp_gt_u32 s33, 0x100000
    s_cbranch_scc1 chain_kernel_abort
    s_branch L_pd_21_2
    s_nop 0
L_pd_21_2:
    s_waitcnt vmcnt(5)
    v_add_f32 v208, v80, v220
    s_waitcnt vmcnt(3)
    v_max3_u32 v20, v220, v221, v222
    v_add_f32 v209, v221, v222
    v_cmp_eq_u32 vcc, 0xffff0000, v20
    v_add_f32 v208, v208, v209
    s_nop 1
    v_mov_b32_dpp v209, v208 quad_perm:[1,0,3,2] row_mask:0xf bank_mask:0xf
    s_mov_b64 exec, s[26:27]
    v_cvt_pk_bf16_f32 v208, v208, v209
    v_min_u32 v208, 0xfffffffe, v208
    s_cbranch_vccnz L_pf_24
    s_branch L_pd_21
ct_p3133:
    s_cbranch_execz ct_p3158
L_pf_24:
    s_mov_b64 exec, -1
    buffer_load_short_d16_hi v220, v9, s[8:11], s43 offen sc1
    buffer_load_short_d16_hi v221, v10, s[8:11], s43 offen sc1
    buffer_load_short_d16_hi v222, v11, s[8:11], s43 offen sc1
    s_add_u32 s33, s33, 1
    s_cmp_gt_u32 s33, 0x100000
    s_cbranch_scc1 chain_kernel_abort
    s_branch L_pd_21_3
L_pd_21_3:
    s_waitcnt vmcnt(5)
    v_add_f32 v208, v80, v223
    s_waitcnt vmcnt(3)
    v_max3_u32 v20, v223, v224, v225
    v_add_f32 v209, v224, v225
    v_cmp_eq_u32 vcc, 0xffff0000, v20
    v_add_f32 v208, v208, v209
    s_nop 1
    v_mov_b32_dpp v209, v208 quad_perm:[1,0,3,2] row_mask:0xf bank_mask:0xf
    s_mov_b64 exec, s[26:27]
    v_cvt_pk_bf16_f32 v208, v208, v209
    v_min_u32 v208, 0xfffffffe, v208
    s_cbranch_vccnz L_pf_25
    s_branch L_pd_21
    s_nop 0
ct_p3158:
    s_cbranch_execz ct_ret4
L_pf_25:
    s_mov_b64 exec, -1
    buffer_load_short_d16_hi v223, v9, s[8:11], s44 offen sc1
    buffer_load_short_d16_hi v224, v10, s[8:11], s44 offen sc1
    buffer_load_short_d16_hi v225, v11, s[8:11], s44 offen sc1
    s_add_u32 s33, s33, 1
    s_cmp_gt_u32 s33, 0x100000
    s_cbranch_scc1 chain_kernel_abort
    s_branch L_pd_21_2
chain_kernel_abort:
    s_mov_b32 s12, s98
    s_and_b32 s13, s99, 0xffff
    s_mov_b32 s14, 0x100
    s_mov_b32 s15, 0x00020000
    s_mov_b64 exec, 1
    v_mov_b32 v1, s19
    v_or_b32 v1, 0xdead0000, v1
    v_mov_b32 v2, 124
    buffer_store_dword v1, v2, s[12:15], 0 offen
chain_kernel_done:
    s_endpgm
chain_kernel_end:
    s_endpgm
chain_kernel_worker:
    s_sub_u32 s56, s16, 4
    s_mov_b32 s57, s17
    s_mov_b32 s58, s18
    s_cmp_eq_u32 s56, 0
    s_cbranch_scc1 L_big_37
kvs_start:
    s_cmp_eq_u32 s56, 3
    s_cselect_b64 s[12:13], s[90:91], s[88:89]
    s_cmp_eq_u32 s56, 1
    s_cselect_b64 s[12:13], s[86:87], s[12:13]
    s_and_b32 s13, s13, 0xffff
    s_mov_b32 s14, 0x800000
    s_mov_b32 s15, 0x00020000
    s_lshl_b32 s28, s57, 8
    v_bfe_u32 v24, v0, 4, 3
    v_lshlrev_b32 v24, 1, v24
    v_and_b32 v25, 15, v0
    v_xor_b32 v24, v24, v25
    v_lshlrev_b32 v6, 4, v24
    v_bfe_u32 v24, v0, 4, 2
    v_lshl_add_u32 v6, v24, 13, v6
    v_bfe_u32 v24, v0, 6, 1
    v_lshl_add_u32 v6, v24, 16, v6
    v_bfe_u32 v24, v0, 7, 1
    v_lshl_add_u32 v6, v24, 15, v6
    s_and_b32 s60, s58, 1
    s_lshl_b32 s61, s60, 11
    s_lshr_b32 s60, s58, 1
    s_lshl_b32 s60, s60, 10
    s_add_u32 s32, s60, s61
    s_add_u32 m0, s32, 0
    s_add_u32 s61, s28, 0x0
    buffer_load_dwordx4 v6, s[12:15], s61 offen nt lds
    s_add_u32 m0, s32, 4096
    s_add_u32 s61, s28, 0x20000
    buffer_load_dwordx4 v6, s[12:15], s61 offen nt lds
    s_add_u32 m0, s32, 8192
    s_add_u32 s61, s28, 0x40000
    buffer_load_dwordx4 v6, s[12:15], s61 offen nt lds
    s_add_u32 m0, s32, 12288
    s_add_u32 s61, s28, 0x60000
    buffer_load_dwordx4 v6, s[12:15], s61 offen nt lds
    s_add_u32 m0, s32, 16384
    s_add_u32 s61, s28, 0x80000
    buffer_load_dwordx4 v6, s[12:15], s61 offen nt lds
    s_add_u32 m0, s32, 20480
    s_add_u32 s61, s28, 0xa0000
    buffer_load_dwordx4 v6, s[12:15], s61 offen nt lds
    s_add_u32 m0, s32, 24576
    s_add_u32 s61, s28, 0xc0000
    buffer_load_dwordx4 v6, s[12:15], s61 offen nt lds
    s_add_u32 m0, s32, 28672
    s_add_u32 s61, s28, 0xe0000
    buffer_load_dwordx4 v6, s[12:15], s61 offen nt lds
    s_mov_b32 s8, s82
    s_and_b32 s9, s83, 0xffff
    s_mov_b32 s10, 0x400000
    s_mov_b32 s11, 0x00020000
    s_mov_b32 s16, s100
    s_and_b32 s17, s101, 0xffff
    s_mov_b32 s18, 0xc000000
    s_mov_b32 s19, 0x00020000
    v_and_b32 v24, 63, v0
    v_lshlrev_b32 v1, 4, v24
    v_add_u32 v12, 4096, v1
    v_lshlrev_b32 v10, 7, v24
    s_lshl_b32 s27, s57, 13
    s_add_u32 m0, s32, 32768
    s_add_u32 s61, s28, 0x100000
    buffer_load_dwordx4 v6, s[12:15], s61 offen nt lds
    s_add_u32 m0, s32, 36864
    s_add_u32 s61, s28, 0x120000
    buffer_load_dwordx4 v6, s[12:15], s61 offen nt lds
    s_add_u32 m0, s32, 40960
    s_add_u32 s61, s28, 0x140000
    buffer_load_dwordx4 v6, s[12:15], s61 offen nt lds
    s_add_u32 m0, s32, 45056
    s_add_u32 s61, s28, 0x160000
    buffer_load_dwordx4 v6, s[12:15], s61 offen nt lds
    s_add_u32 m0, s32, 49152
    s_add_u32 s61, s28, 0x180000
    buffer_load_dwordx4 v6, s[12:15], s61 offen nt lds
    s_add_u32 m0, s32, 53248
    s_add_u32 s61, s28, 0x1a0000
    buffer_load_dwordx4 v6, s[12:15], s61 offen nt lds
    s_add_u32 m0, s32, 57344
    s_add_u32 s61, s28, 0x1c0000
    buffer_load_dwordx4 v6, s[12:15], s61 offen nt lds
    s_add_u32 m0, s32, 61440
    s_add_u32 s61, s28, 0x1e0000
    buffer_load_dwordx4 v6, s[12:15], s61 offen nt lds
    v_bfe_u32 v24, v0, 4, 3
    v_and_b32 v25, 7, v0
    v_xor_b32 v24, v24, v25
    v_lshlrev_b32 v2, 4, v24
    v_lshrrev_b32 v24, 3, v0
    v_lshl_add_u32 v2, v24, 11, v2
    v_bfe_u32 v24, v0, 1, 3
    v_bfe_u32 v25, v0, 4, 2
    v_xor_b32 v24, v24, v25
    v_lshlrev_b32 v4, 4, v24
    v_and_b32 v25, 15, v0
    v_lshl_add_u32 v4, v25, 7, v4
    v_add_u32 v4, 98304, v4
    v_xor_b32 v5, 64, v4
    s_add_u32 m0, s32, 65536
    s_add_u32 s61, s28, 0x200000
    buffer_load_dwordx4 v6, s[12:15], s61 offen nt lds
    s_add_u32 m0, s32, 69632
    s_add_u32 s61, s28, 0x220000
    buffer_load_dwordx4 v6, s[12:15], s61 offen nt lds
    s_add_u32 m0, s32, 73728
    s_add_u32 s61, s28, 0x240000
    buffer_load_dwordx4 v6, s[12:15], s61 offen nt lds
    s_add_u32 m0, s32, 77824
    s_add_u32 s61, s28, 0x260000
    buffer_load_dwordx4 v6, s[12:15], s61 offen nt lds
    s_add_u32 m0, s32, 81920
    s_add_u32 s61, s28, 0x280000
    buffer_load_dwordx4 v6, s[12:15], s61 offen nt lds
    s_add_u32 m0, s32, 86016
    s_add_u32 s61, s28, 0x2a0000
    buffer_load_dwordx4 v6, s[12:15], s61 offen nt lds
    s_add_u32 m0, s32, 90112
    s_add_u32 s61, s28, 0x2c0000
    buffer_load_dwordx4 v6, s[12:15], s61 offen nt lds
    s_add_u32 m0, s32, 94208
    s_add_u32 s61, s28, 0x2e0000
    buffer_load_dwordx4 v6, s[12:15], s61 offen nt lds
    v_bfe_u32 v24, v0, 2, 3
    v_lshrrev_b32 v25, 6, v0
    v_lshlrev_b32 v25, 1, v25
    v_xor_b32 v24, v24, v25
    v_lshlrev_b32 v8, 5, v24
    v_bfe_u32 v24, v0, 0, 2
    v_lshl_add_u32 v8, v24, 3, v8
    v_bfe_u32 v24, v0, 2, 2
    v_lshl_add_u32 v8, v24, 8, v8
    v_bfe_u32 v24, v0, 4, 2
    v_lshl_add_u32 v8, v24, 11, v8
    v_xor_b32 v9, 32, v8
    v_mov_b32 v28, -1
    v_mov_b32 v29, -1
    v_mov_b32 v30, -1
    v_mov_b32 v31, -1
    s_lshl_b32 s20, s58, 10
    s_add_u32 s20, s20, 98304
    s_mov_b32 s21, 98304
    s_mov_b32 s23, 0
    s_mov_b32 s29, 32768
    s_add_u32 m0, s32, 98304
    s_add_u32 s61, s28, 0x300000
    buffer_load_dwordx4 v6, s[12:15], s61 offen nt lds
    s_add_u32 m0, s32, 102400
    s_add_u32 s61, s28, 0x320000
    buffer_load_dwordx4 v6, s[12:15], s61 offen nt lds
    s_add_u32 m0, s32, 106496
    s_add_u32 s61, s28, 0x340000
    buffer_load_dwordx4 v6, s[12:15], s61 offen nt lds
    s_add_u32 m0, s32, 110592
    s_add_u32 s61, s28, 0x360000
    buffer_load_dwordx4 v6, s[12:15], s61 offen nt lds
    s_add_u32 m0, s32, 114688
    s_add_u32 s61, s28, 0x380000
    buffer_load_dwordx4 v6, s[12:15], s61 offen nt lds
    s_add_u32 m0, s32, 118784
    s_add_u32 s61, s28, 0x3a0000
    buffer_load_dwordx4 v6, s[12:15], s61 offen nt lds
    s_add_u32 m0, s32, 122880
    s_add_u32 s61, s28, 0x3c0000
    buffer_load_dwordx4 v6, s[12:15], s61 offen nt lds
    s_add_u32 m0, s32, 126976
    s_add_u32 s61, s28, 0x3e0000
    buffer_load_dwordx4 v6, s[12:15], s61 offen nt lds
    s_lshl_b32 s30, s57, 16
    s_cmp_eq_u32 s56, 3
    s_cselect_b32 s60, 11, 10
    s_cselect_b32 s61, 0x4000, 0
    s_lshl_b32 s60, s58, s60
    s_add_u32 s30, s30, s60
    s_add_u32 s30, s30, s61
    s_lshr_b32 s31, s57, 1
    s_lshl_b32 s31, s31, 14
    s_and_b32 s61, s57, 1
    s_lshl2_add_u32 s60, s61, s58
    s_lshl_b32 s60, s60, 10
    s_add_u32 s31, s31, s60
    s_mov_b32 s61, 0xc000000
    s_cmp_eq_u32 s56, 1
    s_cmov_b32 s61, 0x8000000
    s_add_u32 s31, s31, s61
    s_cmp_eq_u32 s56, 1
    s_cselect_b32 s60, 0x8000, 0
    s_add_u32 s30, s30, s60
kt_from:
    s_add_u32 m0, s32, 131072
    s_add_u32 s61, s28, 0x400000
    buffer_load_dwordx4 v6, s[12:15], s61 offen nt lds
    s_add_u32 m0, s32, 135168
    s_add_u32 s61, s28, 0x420000
    buffer_load_dwordx4 v6, s[12:15], s61 offen nt lds
    s_add_u32 m0, s32, 139264
    s_add_u32 s61, s28, 0x440000
    buffer_load_dwordx4 v6, s[12:15], s61 offen nt lds
    s_add_u32 m0, s32, 143360
    s_add_u32 s61, s28, 0x460000
    buffer_load_dwordx4 v6, s[12:15], s61 offen nt lds
    s_add_u32 m0, s32, 147456
    s_add_u32 s61, s28, 0x480000
    buffer_load_dwordx4 v6, s[12:15], s61 offen nt lds
    s_add_u32 m0, s32, 151552
    s_add_u32 s61, s28, 0x4a0000
    buffer_load_dwordx4 v6, s[12:15], s61 offen nt lds
    s_add_u32 m0, s32, 155648
    s_add_u32 s61, s28, 0x4c0000
    buffer_load_dwordx4 v6, s[12:15], s61 offen nt lds
    s_add_u32 m0, s32, 159744
    s_add_u32 s61, s28, 0x4e0000
    buffer_load_dwordx4 v6, s[12:15], s61 offen nt lds
    s_waitcnt vmcnt(32)
    s_barrier
    ds_read_b64_tr_b16 a[0:1], v8 offset:0
    ds_read_b64_tr_b16 a[2:3], v8 offset:1024
    ds_read_b64_tr_b16 a[4:5], v9 offset:0
    ds_read_b64_tr_b16 a[6:7], v9 offset:1024
    ds_read_b64_tr_b16 a[8:9], v8 offset:8192
    ds_read_b64_tr_b16 a[10:11], v8 offset:9216
    ds_read_b64_tr_b16 a[12:13], v9 offset:8192
    ds_read_b64_tr_b16 a[14:15], v9 offset:9216
    s_waitcnt lgkmcnt(0)
    ds_read_b64_tr_b16 a[16:17], v8 offset:16384
    ds_read_b64_tr_b16 a[18:19], v8 offset:17408
    ds_read_b64_tr_b16 a[20:21], v9 offset:16384
    ds_read_b64_tr_b16 a[22:23], v9 offset:17408
    ds_read_b64_tr_b16 a[24:25], v8 offset:24576
    ds_read_b64_tr_b16 a[26:27], v8 offset:25600
    ds_read_b64_tr_b16 a[28:29], v9 offset:24576
    ds_read_b64_tr_b16 a[30:31], v9 offset:25600
    s_waitcnt lgkmcnt(0)
    s_waitcnt vmcnt(24)
    s_barrier
    s_add_u32 m0, s32, 0
    s_add_u32 s61, s28, 0x500000
    buffer_load_dwordx4 v6, s[12:15], s61 offen nt lds
    s_add_u32 m0, s32, 4096
    s_add_u32 s61, s28, 0x520000
    buffer_load_dwordx4 v6, s[12:15], s61 offen nt lds
    s_add_u32 m0, s32, 8192
    s_add_u32 s61, s28, 0x540000
    buffer_load_dwordx4 v6, s[12:15], s61 offen nt lds
    s_add_u32 m0, s32, 12288
    s_add_u32 s61, s28, 0x560000
    buffer_load_dwordx4 v6, s[12:15], s61 offen nt lds
    s_add_u32 m0, s32, 16384
    s_add_u32 s61, s28, 0x580000
    buffer_load_dwordx4 v6, s[12:15], s61 offen nt lds
    s_add_u32 m0, s32, 20480
    s_add_u32 s61, s28, 0x5a0000
    buffer_load_dwordx4 v6, s[12:15], s61 offen nt lds
    s_add_u32 m0, s32, 24576
    s_add_u32 s61, s28, 0x5c0000
    buffer_load_dwordx4 v6, s[12:15], s61 offen nt lds
    s_add_u32 m0, s32, 28672
    s_add_u32 s61, s28, 0x5e0000
    buffer_load_dwordx4 v6, s[12:15], s61 offen nt lds
    ds_read_b64_tr_b16 a[32:33], v8 offset:32768
    ds_read_b64_tr_b16 a[34:35], v8 offset:33792
    ds_read_b64_tr_b16 a[36:37], v9 offset:32768
    ds_read_b64_tr_b16 a[38:39], v9 offset:33792
    ds_read_b64_tr_b16 a[40:41], v8 offset:40960
    ds_read_b64_tr_b16 a[42:43], v8 offset:41984
    ds_read_b64_tr_b16 a[44:45], v9 offset:40960
    ds_read_b64_tr_b16 a[46:47], v9 offset:41984
    s_waitcnt lgkmcnt(0)
    ds_read_b64_tr_b16 a[48:49], v8 offset:49152
    ds_read_b64_tr_b16 a[50:51], v8 offset:50176
    ds_read_b64_tr_b16 a[52:53], v9 offset:49152
    ds_read_b64_tr_b16 a[54:55], v9 offset:50176
    ds_read_b64_tr_b16 a[56:57], v8 offset:57344
    ds_read_b64_tr_b16 a[58:59], v8 offset:58368
    ds_read_b64_tr_b16 a[60:61], v9 offset:57344
    ds_read_b64_tr_b16 a[62:63], v9 offset:58368
    s_waitcnt lgkmcnt(0)
    s_waitcnt vmcnt(24)
    s_barrier
    s_add_u32 m0, s32, 32768
    s_add_u32 s61, s28, 0x600000
    buffer_load_dwordx4 v6, s[12:15], s61 offen nt lds
    s_add_u32 m0, s32, 36864
    s_add_u32 s61, s28, 0x620000
    buffer_load_dwordx4 v6, s[12:15], s61 offen nt lds
    s_add_u32 m0, s32, 40960
    s_add_u32 s61, s28, 0x640000
    buffer_load_dwordx4 v6, s[12:15], s61 offen nt lds
    s_add_u32 m0, s32, 45056
    s_add_u32 s61, s28, 0x660000
    buffer_load_dwordx4 v6, s[12:15], s61 offen nt lds
    s_add_u32 m0, s32, 49152
    s_add_u32 s61, s28, 0x680000
    buffer_load_dwordx4 v6, s[12:15], s61 offen nt lds
    s_add_u32 m0, s32, 53248
    s_add_u32 s61, s28, 0x6a0000
    buffer_load_dwordx4 v6, s[12:15], s61 offen nt lds
    s_add_u32 m0, s32, 57344
    s_add_u32 s61, s28, 0x6c0000
    buffer_load_dwordx4 v6, s[12:15], s61 offen nt lds
    s_add_u32 m0, s32, 61440
    s_add_u32 s61, s28, 0x6e0000
    buffer_load_dwordx4 v6, s[12:15], s61 offen nt lds
    s_and_b32 s60, s58, 1
    s_lshl_b32 s60, s60, 18
    s_add_u32 s60, s60, s27
    buffer_load_dword v13, v10, s[8:11], s60 offen
    s_add_u32 s27, s27, 0x80000
    v_add_u32 v8, 0x10000, v8
    v_add_u32 v9, 0x10000, v9
    ds_read_b64_tr_b16 a[64:65], v8 offset:0
    ds_read_b64_tr_b16 a[66:67], v8 offset:1024
    ds_read_b64_tr_b16 a[68:69], v9 offset:0
    ds_read_b64_tr_b16 a[70:71], v9 offset:1024
    ds_read_b64_tr_b16 a[72:73], v8 offset:8192
    ds_read_b64_tr_b16 a[74:75], v8 offset:9216
    ds_read_b64_tr_b16 a[76:77], v9 offset:8192
    ds_read_b64_tr_b16 a[78:79], v9 offset:9216
    s_waitcnt lgkmcnt(0)
    ds_read_b64_tr_b16 a[80:81], v8 offset:16384
    ds_read_b64_tr_b16 a[82:83], v8 offset:17408
    ds_read_b64_tr_b16 a[84:85], v9 offset:16384
    ds_read_b64_tr_b16 a[86:87], v9 offset:17408
    ds_read_b64_tr_b16 a[88:89], v8 offset:24576
    ds_read_b64_tr_b16 a[90:91], v8 offset:25600
    ds_read_b64_tr_b16 a[92:93], v9 offset:24576
    ds_read_b64_tr_b16 a[94:95], v9 offset:25600
    s_waitcnt lgkmcnt(0)
    s_waitcnt vmcnt(24)
    s_barrier
    s_add_u32 m0, s32, 65536
    s_add_u32 s61, s28, 0x700000
    buffer_load_dwordx4 v6, s[12:15], s61 offen nt lds
    s_add_u32 m0, s32, 69632
    s_add_u32 s61, s28, 0x720000
    buffer_load_dwordx4 v6, s[12:15], s61 offen nt lds
    s_add_u32 m0, s32, 73728
    s_add_u32 s61, s28, 0x740000
    buffer_load_dwordx4 v6, s[12:15], s61 offen nt lds
    s_add_u32 m0, s32, 77824
    s_add_u32 s61, s28, 0x760000
    buffer_load_dwordx4 v6, s[12:15], s61 offen nt lds
    s_add_u32 m0, s32, 81920
    s_add_u32 s61, s28, 0x780000
    buffer_load_dwordx4 v6, s[12:15], s61 offen nt lds
    s_add_u32 m0, s32, 86016
    s_add_u32 s61, s28, 0x7a0000
    buffer_load_dwordx4 v6, s[12:15], s61 offen nt lds
    s_add_u32 m0, s32, 90112
    s_add_u32 s61, s28, 0x7c0000
    buffer_load_dwordx4 v6, s[12:15], s61 offen nt lds
    s_add_u32 m0, s32, 94208
    s_add_u32 s61, s28, 0x7e0000
    buffer_load_dwordx4 v6, s[12:15], s61 offen nt lds
    v_mov_b32 v24, 4
    global_load_dword v11, v24, s[98:99] sc1
    s_or_b32 s60, s2, s58
    s_cbranch_scc1 L_rw_38
    s_lshl_b32 s62, s56, 3
    s_add_u32 s62, s62, 160
    s_mov_b32 s63, 0
L_rp_39:
    s_load_dwordx2 s[60:61], s[98:99], s62 glc
    s_add_u32 s63, s63, 1
    s_cmp_gt_u32 s63, 0x100000
    s_cbranch_scc1 chain_kernel_wabort
    s_waitcnt lgkmcnt(0)
    s_cmp_lt_u32 s61, 0x2000
    s_cbranch_scc1 L_rp_39
    s_lshr_b32 s61, s95, 8
    s_cmp_eq_u32 s60, -1
    s_cselect_b32 s94, -1, s61
L_rw_38:
    ds_read_b64_tr_b16 a[96:97], v8 offset:32768
    ds_read_b64_tr_b16 a[98:99], v8 offset:33792
    ds_read_b64_tr_b16 a[100:101], v9 offset:32768
    ds_read_b64_tr_b16 a[102:103], v9 offset:33792
    ds_read_b64_tr_b16 a[104:105], v8 offset:40960
    ds_read_b64_tr_b16 a[106:107], v8 offset:41984
    ds_read_b64_tr_b16 a[108:109], v9 offset:40960
    ds_read_b64_tr_b16 a[110:111], v9 offset:41984
    s_waitcnt lgkmcnt(0)
    ds_read_b64_tr_b16 a[112:113], v8 offset:49152
    ds_read_b64_tr_b16 a[114:115], v8 offset:50176
    ds_read_b64_tr_b16 a[116:117], v9 offset:49152
    ds_read_b64_tr_b16 a[118:119], v9 offset:50176
    ds_read_b64_tr_b16 a[120:121], v8 offset:57344
    ds_read_b64_tr_b16 a[122:123], v8 offset:58368
    ds_read_b64_tr_b16 a[124:125], v9 offset:57344
    ds_read_b64_tr_b16 a[126:127], v9 offset:58368
    s_waitcnt lgkmcnt(0)
    s_waitcnt vmcnt(24)
    s_barrier
    s_add_u32 m0, s20, 0
    s_nop 0
    buffer_load_dwordx4 v2, s[8:11], s23 offen offset:0 lds
    s_add_u32 m0, s20, 3968
    s_nop 0
    buffer_load_dwordx4 v2, s[8:11], s23 offen offset:128 lds
    s_add_u32 m0, s20, 7936
    s_nop 0
    buffer_load_dwordx4 v2, s[8:11], s23 offen offset:256 lds
    s_add_u32 m0, s20, 11904
    s_nop 0
    buffer_load_dwordx4 v2, s[8:11], s23 offen offset:384 lds
    s_add_u32 m0, s20, 15872
    s_nop 0
    buffer_load_dwordx4 v2, s[8:11], s23 offen offset:512 lds
    s_add_u32 m0, s20, 19840
    s_nop 0
    buffer_load_dwordx4 v2, s[8:11], s23 offen offset:640 lds
    s_add_u32 m0, s20, 23808
    s_nop 0
    buffer_load_dwordx4 v2, s[8:11], s23 offen offset:768 lds
    s_add_u32 m0, s20, 27776
    s_nop 0
    buffer_load_dwordx4 v2, s[8:11], s23 offen offset:896 lds
    s_add_u32 s23, s23, 1024
    s_bitcmp1_b32 s23, 11
    s_cselect_b32 s60, 0xf800, 0
    s_add_u32 s23, s23, s60
    s_add_u32 s20, s20, 32768
    s_cmp_ge_u32 s20, 163840
    s_cselect_b32 s60, 163840, 0
    s_sub_u32 s20, s20, s60
    v_add_u32 v8, 0x10000, v8
    v_add_u32 v9, 0x10000, v9
    ds_read_b64_tr_b16 a[128:129], v8 offset:0
    ds_read_b64_tr_b16 a[130:131], v8 offset:1024
    ds_read_b64_tr_b16 a[132:133], v9 offset:0
    ds_read_b64_tr_b16 a[134:135], v9 offset:1024
    ds_read_b64_tr_b16 a[136:137], v8 offset:8192
    ds_read_b64_tr_b16 a[138:139], v8 offset:9216
    ds_read_b64_tr_b16 a[140:141], v9 offset:8192
    ds_read_b64_tr_b16 a[142:143], v9 offset:9216
    s_waitcnt lgkmcnt(0)
    ds_read_b64_tr_b16 a[144:145], v8 offset:16384
    ds_read_b64_tr_b16 a[146:147], v8 offset:17408
    ds_read_b64_tr_b16 a[148:149], v9 offset:16384
    ds_read_b64_tr_b16 a[150:151], v9 offset:17408
    ds_read_b64_tr_b16 a[152:153], v8 offset:24576
    ds_read_b64_tr_b16 a[154:155], v8 offset:25600
    ds_read_b64_tr_b16 a[156:157], v9 offset:24576
    ds_read_b64_tr_b16 a[158:159], v9 offset:25600
    s_waitcnt lgkmcnt(0)
    s_waitcnt vmcnt(24)
    s_barrier
    s_add_u32 m0, s20, 0
    s_nop 0
    buffer_load_dwordx4 v2, s[8:11], s23 offen offset:0 lds
    s_add_u32 m0, s20, 3968
    s_nop 0
    buffer_load_dwordx4 v2, s[8:11], s23 offen offset:128 lds
    s_add_u32 m0, s20, 7936
    s_nop 0
    buffer_load_dwordx4 v2, s[8:11], s23 offen offset:256 lds
    s_add_u32 m0, s20, 11904
    s_nop 0
    buffer_load_dwordx4 v2, s[8:11], s23 offen offset:384 lds
    s_add_u32 m0, s20, 15872
    s_nop 0
    buffer_load_dwordx4 v2, s[8:11], s23 offen offset:512 lds
    s_add_u32 m0, s20, 19840
    s_nop 0
    buffer_load_dwordx4 v2, s[8:11], s23 offen offset:640 lds
    s_add_u32 m0, s20, 23808
    s_nop 0
    buffer_load_dwordx4 v2, s[8:11], s23 offen offset:768 lds
    s_add_u32 m0, s20, 27776
    s_nop 0
    buffer_load_dwordx4 v2, s[8:11], s23 offen offset:896 lds
    s_add_u32 s23, s23, 1024
    s_bitcmp1_b32 s23, 11
    s_cselect_b32 s60, 0xf800, 0
    s_add_u32 s23, s23, s60
    s_add_u32 s20, s20, 32768
    s_cmp_ge_u32 s20, 163840
    s_cselect_b32 s60, 163840, 0
    s_sub_u32 s20, s20, s60
    v_add_u32 v8, 0xfffe0000, v8
    v_add_u32 v9, 0xfffe0000, v9
    ds_read_b64_tr_b16 a[160:161], v8 offset:0
    ds_read_b64_tr_b16 a[162:163], v8 offset:1024
    ds_read_b64_tr_b16 a[164:165], v9 offset:0
    ds_read_b64_tr_b16 a[166:167], v9 offset:1024
    ds_read_b64_tr_b16 a[168:169], v8 offset:8192
    ds_read_b64_tr_b16 a[170:171], v8 offset:9216
    ds_read_b64_tr_b16 a[172:173], v9 offset:8192
    ds_read_b64_tr_b16 a[174:175], v9 offset:9216
    s_waitcnt lgkmcnt(0)
    ds_read_b64_tr_b16 a[176:177], v8 offset:16384
    ds_read_b64_tr_b16 a[178:179], v8 offset:17408
    ds_read_b64_tr_b16 a[180:181], v9 offset:16384
    ds_read_b64_tr_b16 a[182:183], v9 offset:17408
    ds_read_b64_tr_b16 a[184:185], v8 offset:24576
    ds_read_b64_tr_b16 a[186:187], v8 offset:25600
    ds_read_b64_tr_b16 a[188:189], v9 offset:24576
    ds_read_b64_tr_b16 a[190:191], v9 offset:25600
    s_waitcnt lgkmcnt(0)
    s_waitcnt vmcnt(24)
    s_barrier
    s_add_u32 m0, s20, 0
    s_nop 0
    buffer_load_dwordx4 v2, s[8:11], s23 offen offset:0 lds
    s_add_u32 m0, s20, 3968
    s_nop 0
    buffer_load_dwordx4 v2, s[8:11], s23 offen offset:128 lds
    s_add_u32 m0, s20, 7936
    s_nop 0
    buffer_load_dwordx4 v2, s[8:11], s23 offen offset:256 lds
    s_add_u32 m0, s20, 11904
    s_nop 0
    buffer_load_dwordx4 v2, s[8:11], s23 offen offset:384 lds
    s_add_u32 m0, s20, 15872
    s_nop 0
    buffer_load_dwordx4 v2, s[8:11], s23 offen offset:512 lds
    s_add_u32 m0, s20, 19840
    s_nop 0
    buffer_load_dwordx4 v2, s[8:11], s23 offen offset:640 lds
    s_add_u32 m0, s20, 23808
    s_nop 0
    buffer_load_dwordx4 v2, s[8:11], s23 offen offset:768 lds
    s_add_u32 m0, s20, 27776
    s_nop 0
    buffer_load_dwordx4 v2, s[8:11], s23 offen offset:896 lds
    s_add_u32 s23, s23, 1024
    s_bitcmp1_b32 s23, 11
    s_cselect_b32 s60, 0xf800, 0
    s_add_u32 s23, s23, s60
    s_add_u32 s20, s20, 32768
    s_cmp_ge_u32 s20, 163840
    s_cselect_b32 s60, 163840, 0
    s_sub_u32 s20, s20, s60
    ds_read_b64_tr_b16 a[192:193], v8 offset:32768
    ds_read_b64_tr_b16 a[194:195], v8 offset:33792
    ds_read_b64_tr_b16 a[196:197], v9 offset:32768
    ds_read_b64_tr_b16 a[198:199], v9 offset:33792
    ds_read_b64_tr_b16 a[200:201], v8 offset:40960
    ds_read_b64_tr_b16 a[202:203], v8 offset:41984
    ds_read_b64_tr_b16 a[204:205], v9 offset:40960
    ds_read_b64_tr_b16 a[206:207], v9 offset:41984
    s_waitcnt lgkmcnt(0)
    ds_read_b64_tr_b16 a[208:209], v8 offset:49152
    ds_read_b64_tr_b16 a[210:211], v8 offset:50176
    ds_read_b64_tr_b16 a[212:213], v9 offset:49152
    ds_read_b64_tr_b16 a[214:215], v9 offset:50176
    ds_read_b64_tr_b16 a[216:217], v8 offset:57344
    ds_read_b64_tr_b16 a[218:219], v8 offset:58368
    ds_read_b64_tr_b16 a[220:221], v9 offset:57344
    ds_read_b64_tr_b16 a[222:223], v9 offset:58368
    s_waitcnt lgkmcnt(0)
    s_waitcnt vmcnt(24)
    s_barrier
    s_cmp_lg_u32 s2, 0
    s_cbranch_scc1 L_rok_40
    v_mov_b32 v24, 32768
    s_cmp_lg_u32 s58, 0
    s_cbranch_scc1 L_rw_41
    v_mov_b32 v25, s94
    ds_write_b32 v24, v25
    s_waitcnt lgkmcnt(0)
L_rw_41:
    s_barrier
    ds_read_b32 v25, v24
    s_waitcnt lgkmcnt(0)
    v_readfirstlane_b32 s60, v25
    s_mov_b32 s2, 1
    s_cmp_eq_u32 s60, -1
    s_cbranch_scc1 L_rok_40
    s_mov_b32 s57, s60
    s_waitcnt vmcnt(0)
    s_barrier
    s_cmp_ge_u32 s57, 32
    s_cbranch_scc1 chain_kernel_end
    s_branch kvs_start
L_rok_40:
    v_add_u32 v8, 0x10000, v8
    v_add_u32 v9, 0x10000, v9
    ds_read_b64_tr_b16 a[224:225], v8 offset:0
    ds_read_b64_tr_b16 a[226:227], v8 offset:1024
    ds_read_b64_tr_b16 a[228:229], v9 offset:0
    ds_read_b64_tr_b16 a[230:231], v9 offset:1024
    ds_read_b64_tr_b16 a[232:233], v8 offset:8192
    ds_read_b64_tr_b16 a[234:235], v8 offset:9216
    ds_read_b64_tr_b16 a[236:237], v9 offset:8192
    ds_read_b64_tr_b16 a[238:239], v9 offset:9216
    s_waitcnt lgkmcnt(0)
    ds_read_b64_tr_b16 a[240:241], v8 offset:16384
    ds_read_b64_tr_b16 a[242:243], v8 offset:17408
    ds_read_b64_tr_b16 a[244:245], v9 offset:16384
    ds_read_b64_tr_b16 a[246:247], v9 offset:17408
    ds_read_b64_tr_b16 a[248:249], v8 offset:24576
    ds_read_b64_tr_b16 a[250:251], v8 offset:25600
    ds_read_b64_tr_b16 a[252:253], v9 offset:24576
    ds_read_b64_tr_b16 a[254:255], v9 offset:25600
    s_waitcnt lgkmcnt(0)
    s_waitcnt vmcnt(16)
    s_barrier
    s_mov_b32 s62, 0
L_pp_42:
    v_readfirstlane_b32 s59, v11
    s_and_b32 s60, s59, 0xff
    s_cmp_ge_u32 s60, 15
    s_cbranch_scc1 L_pok_43
    v_mov_b32 v24, 4
    global_load_dword v11, v24, s[98:99] sc1
    s_add_u32 s62, s62, 1
    s_cmp_gt_u32 s62, 0x200000
    s_cbranch_scc1 chain_kernel_wabort
    s_waitcnt vmcnt(0)
    s_branch L_pp_42
L_pok_43:
    s_cmp_ge_u32 s59, 0x800
    s_cselect_b32 s59, 0x2000, 0
    s_xor_b32 s31, s31, s59
    s_xor_b32 s30, s30, s59
    s_xor_b32 s63, s57, 2
    s_mov_b32 s12, s92
    s_and_b32 s13, s93, 0xffff
    s_mov_b32 s14, 0x800000
    s_mov_b32 s15, 0x00020000
    s_lshr_b32 s60, s63, 3
    s_lshl_b32 s28, s60, 21
    s_and_b32 s60, s63, 7
    s_lshl_b32 s60, s60, 8
    s_add_u32 s28, s28, s60
    v_bfe_u32 v24, v0, 4, 3
    v_lshlrev_b32 v24, 1, v24
    v_and_b32 v25, 15, v0
    v_xor_b32 v24, v24, v25
    v_lshlrev_b32 v6, 4, v24
    v_bfe_u32 v24, v0, 4, 2
    v_lshl_add_u32 v6, v24, 11, v6
    v_bfe_u32 v24, v0, 6, 1
    v_lshl_add_u32 v6, v24, 13, v6
    v_bfe_u32 v24, v0, 7, 1
    v_lshl_add_u32 v6, v24, 15, v6
    s_and_b32 s60, s58, 1
    s_lshl_b32 s61, s60, 11
    s_lshr_b32 s60, s58, 1
    s_lshl_b32 s60, s60, 10
    s_add_u32 s32, s60, s61
    s_mov_b32 s24, 0
    s_mov_b32 s18, 0
    s_cmp_eq_u32 s56, 3
    s_cbranch_scc1 L_kvv_44
    ds_read_b128 v[72:75], v4 offset:0
    ds_read_b128 v[76:79], v4 offset:2048
    ds_read_b128 v[80:83], v5 offset:0
    ds_read_b128 v[84:87], v5 offset:2048
    ds_read_b128 v[88:91], v4 offset:4096
    ds_read_b128 v[92:95], v4 offset:6144
    s_mov_b32 s34, 0x2042258
    s_mov_b32 s35, 0x4ffff004
    s_cmp_eq_u32 s58, 0
    s_cselect_b32 s33, s27, 0x400000
    s_mov_b32 s25, 0
    s_mov_b32 s26, 0
kvsk:
    s_waitcnt lgkmcnt(4)
    v_mfma_f32_16x16x32_bf16 v[32:35], a[0:3], v[72:75], 0
    ds_read_b128 v[96:99], v5 offset:4096
    v_mfma_f32_16x16x32_bf16 v[36:39], a[4:7], v[72:75], 0
    ds_read_b128 v[100:103], v5 offset:6144
    v_mfma_f32_16x16x32_bf16 v[44:47], a[4:7], v[76:79], 0
    v_mfma_f32_16x16x32_bf16 v[40:43], a[0:3], v[76:79], 0
    v_cvt_pk_bf16_f32 v64, v48, v49
    s_waitcnt lgkmcnt(4)
    v_mfma_f32_16x16x32_bf16 v[32:35], a[8:11], v[80:83], v[32:35]
    ds_read_b128 v[72:75], v4 offset:8192
    v_cvt_pk_bf16_f32 v65, v50, v51
    v_mfma_f32_16x16x32_bf16 v[36:39], a[12:15], v[80:83], v[36:39]
    ds_read_b128 v[76:79], v4 offset:10240
    v_cvt_pk_bf16_f32 v66, v52, v53
    v_mfma_f32_16x16x32_bf16 v[44:47], a[12:15], v[84:87], v[44:47]
    v_cvt_pk_bf16_f32 v67, v54, v55
    v_cvt_pk_bf16_f32 v68, v56, v57
    v_mfma_f32_16x16x32_bf16 v[40:43], a[8:11], v[84:87], v[40:43]
    v_cvt_pk_bf16_f32 v69, v58, v59
    s_waitcnt lgkmcnt(4)
    v_mfma_f32_16x16x32_bf16 v[32:35], a[16:19], v[88:91], v[32:35]
    ds_read_b128 v[80:83], v5 offset:8192
    v_cvt_pk_bf16_f32 v70, v60, v61
    v_mfma_f32_16x16x32_bf16 v[36:39], a[20:23], v[88:91], v[36:39]
    ds_read_b128 v[84:87], v5 offset:10240
    v_cvt_pk_bf16_f32 v71, v62, v63
    v_mfma_f32_16x16x32_bf16 v[44:47], a[20:23], v[92:95], v[44:47]
    buffer_store_dwordx4 v[64:67], v1, s[16:19], s25 offen sc1
    v_mfma_f32_16x16x32_bf16 v[40:43], a[16:19], v[92:95], v[40:43]
    buffer_store_dwordx4 v[68:71], v12, s[16:19], s25 offen sc1
    s_waitcnt lgkmcnt(4)
    v_mfma_f32_16x16x32_bf16 v[32:35], a[24:27], v[96:99], v[32:35]
    ds_read_b128 v[88:91], v4 offset:12288
    buffer_store_dwordx4 v[28:31], v1, s[16:19], s26 offen sc1
    v_mfma_f32_16x16x32_bf16 v[36:39], a[28:31], v[96:99], v[36:39]
    ds_read_b128 v[92:95], v4 offset:14336
    v_mfma_f32_16x16x32_bf16 v[44:47], a[28:31], v[100:103], v[44:47]
    v_mfma_f32_16x16x32_bf16 v[40:43], a[24:27], v[100:103], v[40:43]
    buffer_load_dword v13, v10, s[8:11], s33 offen
    s_waitcnt lgkmcnt(4)
    v_mfma_f32_16x16x32_bf16 v[32:35], a[32:35], v[72:75], v[32:35]
    ds_read_b128 v[96:99], v5 offset:12288
    v_mfma_f32_16x16x32_bf16 v[36:39], a[36:39], v[72:75], v[36:39]
    ds_read_b128 v[100:103], v5 offset:14336
    v_mfma_f32_16x16x32_bf16 v[44:47], a[36:39], v[76:79], v[44:47]
    s_mov_b32 s18, 0xc000000
    s_lshl_b32 s25, s24, 21
    v_mfma_f32_16x16x32_bf16 v[40:43], a[32:35], v[76:79], v[40:43]
    s_lshl_b32 s62, s24, 13
    s_waitcnt lgkmcnt(4)
    v_mfma_f32_16x16x32_bf16 v[32:35], a[40:43], v[80:83], v[32:35]
    ds_read_b128 v[72:75], v4 offset:16384
    s_and_b32 s62, s62, 0x2000
    v_mfma_f32_16x16x32_bf16 v[36:39], a[44:47], v[80:83], v[36:39]
    ds_read_b128 v[76:79], v4 offset:18432
    s_xor_b32 s62, s62, s30
    v_mfma_f32_16x16x32_bf16 v[44:47], a[44:47], v[84:87], v[44:47]
    s_add_u32 s25, s25, s62
    s_lshl_b32 s26, s24, 18
    v_mfma_f32_16x16x32_bf16 v[40:43], a[40:43], v[84:87], v[40:43]
    s_lshl_b32 s62, s24, 10
    s_waitcnt lgkmcnt(4)
    v_mfma_f32_16x16x32_bf16 v[32:35], a[48:51], v[88:91], v[32:35]
    ds_read_b128 v[80:83], v5 offset:16384
    s_and_b32 s62, s62, 0x2000
    v_mfma_f32_16x16x32_bf16 v[36:39], a[52:55], v[88:91], v[36:39]
    ds_read_b128 v[84:87], v5 offset:18432
    s_xor_b32 s62, s62, s31
    v_mfma_f32_16x16x32_bf16 v[44:47], a[52:55], v[92:95], v[44:47]
    s_add_u32 s26, s26, s62
    s_cmp_ge_u32 s21, 131072
    v_mfma_f32_16x16x32_bf16 v[40:43], a[48:51], v[92:95], v[40:43]
    s_cselect_b32 s22, 0xfffe0000, s29
    s_waitcnt lgkmcnt(4)
    v_mfma_f32_16x16x32_bf16 v[32:35], a[56:59], v[96:99], v[32:35]
    ds_read_b128 v[88:91], v4 offset:20480
    s_add_u32 s21, s21, s22
    v_mfma_f32_16x16x32_bf16 v[36:39], a[60:63], v[96:99], v[36:39]
    ds_read_b128 v[92:95], v4 offset:22528
    s_add_u32 s27, s27, 0x10000
    v_mfma_f32_16x16x32_bf16 v[44:47], a[60:63], v[100:103], v[44:47]
    s_andn2_b32 s61, 3, s24
    s_or_b32 s61, s61, s58
    v_mfma_f32_16x16x32_bf16 v[40:43], a[56:59], v[100:103], v[40:43]
    s_cselect_b32 s33, 0x400000, s27
    s_waitcnt lgkmcnt(4)
    v_mfma_f32_16x16x32_bf16 v[32:35], a[64:67], v[72:75], v[32:35]
    ds_read_b128 v[96:99], v5 offset:20480
    s_cmp_lt_u32 s24, 4
    v_mfma_f32_16x16x32_bf16 v[36:39], a[68:71], v[72:75], v[36:39]
    ds_read_b128 v[100:103], v5 offset:22528
    s_cselect_b64 vcc, -1, 0
    v_mfma_f32_16x16x32_bf16 v[44:47], a[68:71], v[76:79], v[44:47]
    v_mfma_f32_16x16x32_bf16 v[40:43], a[64:67], v[76:79], v[40:43]
    s_waitcnt lgkmcnt(4)
    v_mfma_f32_16x16x32_bf16 v[32:35], a[72:75], v[80:83], v[32:35]
    ds_read_b128 v[72:75], v4 offset:24576
    v_mfma_f32_16x16x32_bf16 v[36:39], a[76:79], v[80:83], v[36:39]
    ds_read_b128 v[76:79], v4 offset:26624
    v_mfma_f32_16x16x32_bf16 v[44:47], a[76:79], v[84:87], v[44:47]
    v_mfma_f32_16x16x32_bf16 v[40:43], a[72:75], v[84:87], v[40:43]
    s_waitcnt lgkmcnt(4)
    v_mfma_f32_16x16x32_bf16 v[32:35], a[80:83], v[88:91], v[32:35]
    ds_read_b128 v[80:83], v5 offset:24576
    s_add_u32 m0, s20, 0
    v_mfma_f32_16x16x32_bf16 v[36:39], a[84:87], v[88:91], v[36:39]
    ds_read_b128 v[84:87], v5 offset:26624
    buffer_load_dwordx4 v2, s[8:11], s23 offen offset:0 lds
    v_mfma_f32_16x16x32_bf16 v[44:47], a[84:87], v[92:95], v[44:47]
    v_mfma_f32_16x16x32_bf16 v[40:43], a[80:83], v[92:95], v[40:43]
    s_waitcnt lgkmcnt(4)
    v_mfma_f32_16x16x32_bf16 v[32:35], a[88:91], v[96:99], v[32:35]
    ds_read_b128 v[88:91], v4 offset:28672
    v_mfma_f32_16x16x32_bf16 v[36:39], a[92:95], v[96:99], v[36:39]
    ds_read_b128 v[92:95], v4 offset:30720
    s_add_u32 m0, s20, 3968
    v_mfma_f32_16x16x32_bf16 v[44:47], a[92:95], v[100:103], v[44:47]
    buffer_load_dwordx4 v2, s[8:11], s23 offen offset:128 lds
    v_mfma_f32_16x16x32_bf16 v[40:43], a[88:91], v[100:103], v[40:43]
    v_add_u32 v4, s22, v4
    s_waitcnt lgkmcnt(4)
    v_mfma_f32_16x16x32_bf16 v[32:35], a[96:99], v[72:75], v[32:35]
    ds_read_b128 v[96:99], v5 offset:28672
    v_mfma_f32_16x16x32_bf16 v[36:39], a[100:103], v[72:75], v[36:39]
    ds_read_b128 v[100:103], v5 offset:30720
    v_mfma_f32_16x16x32_bf16 v[44:47], a[100:103], v[76:79], v[44:47]
    v_add_u32 v5, s22, v5
    s_add_u32 m0, s20, 7936
    v_mfma_f32_16x16x32_bf16 v[40:43], a[96:99], v[76:79], v[40:43]
    buffer_load_dwordx4 v2, s[8:11], s23 offen offset:256 lds
    s_waitcnt vmcnt(15)
    s_cbranch_vccnz kvsk_early
    s_barrier
kvsk_mid:
    s_waitcnt lgkmcnt(4)
    v_mfma_f32_16x16x32_bf16 v[32:35], a[104:107], v[80:83], v[32:35]
    ds_read_b128 v[72:75], v4 offset:0
    v_mfma_f32_16x16x32_bf16 v[36:39], a[108:111], v[80:83], v[36:39]
    ds_read_b128 v[76:79], v4 offset:2048
    v_mfma_f32_16x16x32_bf16 v[44:47], a[108:111], v[84:87], v[44:47]
    v_mfma_f32_16x16x32_bf16 v[40:43], a[104:107], v[84:87], v[40:43]
    s_add_u32 m0, s20, 11904
    s_waitcnt lgkmcnt(4)
    v_mfma_f32_16x16x32_bf16 v[32:35], a[112:115], v[88:91], v[32:35]
    ds_read_b128 v[80:83], v5 offset:0
    buffer_load_dwordx4 v2, s[8:11], s23 offen offset:384 lds
    v_mfma_f32_16x16x32_bf16 v[36:39], a[116:119], v[88:91], v[36:39]
    ds_read_b128 v[84:87], v5 offset:2048
    v_mfma_f32_16x16x32_bf16 v[44:47], a[116:119], v[92:95], v[44:47]
    v_mfma_f32_16x16x32_bf16 v[40:43], a[112:115], v[92:95], v[40:43]
    s_waitcnt lgkmcnt(4)
    v_mfma_f32_16x16x32_bf16 v[32:35], a[120:123], v[96:99], v[32:35]
    ds_read_b128 v[88:91], v4 offset:4096
    s_add_u32 m0, s20, 15872
    v_mfma_f32_16x16x32_bf16 v[36:39], a[124:127], v[96:99], v[36:39]
    ds_read_b128 v[92:95], v4 offset:6144
    buffer_load_dwordx4 v2, s[8:11], s23 offen offset:512 lds
    v_mfma_f32_16x16x32_bf16 v[44:47], a[124:127], v[100:103], v[44:47]
    s_cmp_ge_u32 s21, 131072
    s_cselect_b32 s22, 0xfffe0000, s29
    v_mfma_f32_16x16x32_bf16 v[40:43], a[120:123], v[100:103], v[40:43]
    s_add_u32 s21, s21, s22
    s_waitcnt lgkmcnt(4)
    v_mfma_f32_16x16x32_bf16 v[32:35], a[128:131], v[72:75], v[32:35]
    ds_read_b128 v[96:99], v5 offset:4096
    v_mfma_f32_16x16x32_bf16 v[36:39], a[132:135], v[72:75], v[36:39]
    ds_read_b128 v[100:103], v5 offset:6144
    s_add_u32 m0, s20, 19840
    v_mfma_f32_16x16x32_bf16 v[44:47], a[132:135], v[76:79], v[44:47]
    buffer_load_dwordx4 v2, s[8:11], s23 offen offset:640 lds
    v_mfma_f32_16x16x32_bf16 v[40:43], a[128:131], v[76:79], v[40:43]
    s_waitcnt lgkmcnt(4)
    v_mfma_f32_16x16x32_bf16 v[32:35], a[136:139], v[80:83], v[32:35]
    ds_read_b128 v[72:75], v4 offset:8192
    v_mfma_f32_16x16x32_bf16 v[36:39], a[140:143], v[80:83], v[36:39]
    ds_read_b128 v[76:79], v4 offset:10240
    v_mfma_f32_16x16x32_bf16 v[44:47], a[140:143], v[84:87], v[44:47]
    s_add_u32 m0, s20, 23808
    v_mfma_f32_16x16x32_bf16 v[40:43], a[136:139], v[84:87], v[40:43]
    buffer_load_dwordx4 v2, s[8:11], s23 offen offset:768 lds
    s_waitcnt lgkmcnt(4)
    v_mfma_f32_16x16x32_bf16 v[32:35], a[144:147], v[88:91], v[32:35]
    ds_read_b128 v[80:83], v5 offset:8192
    v_mfma_f32_16x16x32_bf16 v[36:39], a[148:151], v[88:91], v[36:39]
    ds_read_b128 v[84:87], v5 offset:10240
    v_mfma_f32_16x16x32_bf16 v[44:47], a[148:151], v[92:95], v[44:47]
    v_mfma_f32_16x16x32_bf16 v[40:43], a[144:147], v[92:95], v[40:43]
    s_add_u32 m0, s20, 27776
    s_waitcnt lgkmcnt(4)
    v_mfma_f32_16x16x32_bf16 v[32:35], a[152:155], v[96:99], v[32:35]
    ds_read_b128 v[88:91], v4 offset:12288
    buffer_load_dwordx4 v2, s[8:11], s23 offen offset:896 lds
    v_mfma_f32_16x16x32_bf16 v[36:39], a[156:159], v[96:99], v[36:39]
    ds_read_b128 v[92:95], v4 offset:14336
    s_add_u32 s23, s23, 1024
    v_mfma_f32_16x16x32_bf16 v[44:47], a[156:159], v[100:103], v[44:47]
    s_bitcmp1_b32 s23, 11
    s_cselect_b32 s60, 0xf800, 0
    v_mfma_f32_16x16x32_bf16 v[40:43], a[152:155], v[100:103], v[40:43]
    s_add_u32 s23, s23, s60
    s_waitcnt lgkmcnt(4)
    v_mfma_f32_16x16x32_bf16 v[32:35], a[160:163], v[72:75], v[32:35]
    ds_read_b128 v[96:99], v5 offset:12288
    s_add_u32 s20, s20, 32768
    v_mfma_f32_16x16x32_bf16 v[36:39], a[164:167], v[72:75], v[36:39]
    ds_read_b128 v[100:103], v5 offset:14336
    s_cmp_ge_u32 s20, 163840
    v_mfma_f32_16x16x32_bf16 v[44:47], a[164:167], v[76:79], v[44:47]
    s_cselect_b32 s60, 163840, 0
    s_sub_u32 s20, s20, s60
    v_mfma_f32_16x16x32_bf16 v[40:43], a[160:163], v[76:79], v[40:43]
    s_add_u32 m0, s20, 0
    s_waitcnt lgkmcnt(4)
    v_mfma_f32_16x16x32_bf16 v[32:35], a[168:171], v[80:83], v[32:35]
    ds_read_b128 v[72:75], v4 offset:16384
    buffer_load_dwordx4 v2, s[8:11], s23 offen offset:0 lds
    v_mfma_f32_16x16x32_bf16 v[36:39], a[172:175], v[80:83], v[36:39]
    ds_read_b128 v[76:79], v4 offset:18432
    s_add_u32 m0, s20, 3968
    v_mfma_f32_16x16x32_bf16 v[44:47], a[172:175], v[84:87], v[44:47]
    buffer_load_dwordx4 v2, s[8:11], s23 offen offset:128 lds
    v_mfma_f32_16x16x32_bf16 v[40:43], a[168:171], v[84:87], v[40:43]
    s_waitcnt lgkmcnt(4)
    v_mfma_f32_16x16x32_bf16 v[32:35], a[176:179], v[88:91], v[32:35]
    ds_read_b128 v[80:83], v5 offset:16384
    v_mfma_f32_16x16x32_bf16 v[36:39], a[180:183], v[88:91], v[36:39]
    ds_read_b128 v[84:87], v5 offset:18432
    v_mfma_f32_16x16x32_bf16 v[44:47], a[180:183], v[92:95], v[44:47]
    s_add_u32 m0, s20, 7936
    v_mfma_f32_16x16x32_bf16 v[40:43], a[176:179], v[92:95], v[40:43]
    buffer_load_dwordx4 v2, s[8:11], s23 offen offset:256 lds
    s_waitcnt lgkmcnt(4)
    v_mfma_f32_16x16x32_bf16 v[32:35], a[184:187], v[96:99], v[32:35]
    ds_read_b128 v[88:91], v4 offset:20480
    v_mfma_f32_16x16x32_bf16 v[36:39], a[188:191], v[96:99], v[36:39]
    ds_read_b128 v[92:95], v4 offset:22528
    v_mfma_f32_16x16x32_bf16 v[44:47], a[188:191], v[100:103], v[44:47]
    v_mfma_f32_16x16x32_bf16 v[40:43], a[184:187], v[100:103], v[40:43]
    s_add_u32 m0, s20, 11904
    s_waitcnt lgkmcnt(4)
    v_mfma_f32_16x16x32_bf16 v[32:35], a[192:195], v[72:75], v[32:35]
    ds_read_b128 v[96:99], v5 offset:20480
    buffer_load_dwordx4 v2, s[8:11], s23 offen offset:384 lds
    v_mfma_f32_16x16x32_bf16 v[36:39], a[196:199], v[72:75], v[36:39]
    ds_read_b128 v[100:103], v5 offset:22528
    v_mfma_f32_16x16x32_bf16 v[44:47], a[196:199], v[76:79], v[44:47]
    v_mfma_f32_16x16x32_bf16 v[40:43], a[192:195], v[76:79], v[40:43]
    s_waitcnt lgkmcnt(4)
    v_mfma_f32_16x16x32_bf16 v[32:35], a[200:203], v[80:83], v[32:35]
    ds_read_b128 v[72:75], v4 offset:24576
    s_add_u32 m0, s20, 15872
    v_mfma_f32_16x16x32_bf16 v[36:39], a[204:207], v[80:83], v[36:39]
    ds_read_b128 v[76:79], v4 offset:26624
    buffer_load_dwordx4 v2, s[8:11], s23 offen offset:512 lds
    v_mfma_f32_16x16x32_bf16 v[44:47], a[204:207], v[84:87], v[44:47]
    v_mfma_f32_16x16x32_bf16 v[40:43], a[200:203], v[84:87], v[40:43]
    s_waitcnt lgkmcnt(4)
    v_mfma_f32_16x16x32_bf16 v[32:35], a[208:211], v[88:91], v[32:35]
    ds_read_b128 v[80:83], v5 offset:24576
    v_mfma_f32_16x16x32_bf16 v[36:39], a[212:215], v[88:91], v[36:39]
    ds_read_b128 v[84:87], v5 offset:26624
    s_add_u32 m0, s20, 19840
    v_mfma_f32_16x16x32_bf16 v[44:47], a[212:215], v[92:95], v[44:47]
    buffer_load_dwordx4 v2, s[8:11], s23 offen offset:640 lds
    v_mfma_f32_16x16x32_bf16 v[40:43], a[208:211], v[92:95], v[40:43]
    s_waitcnt lgkmcnt(4)
    v_mfma_f32_16x16x32_bf16 v[32:35], a[216:219], v[96:99], v[32:35]
    ds_read_b128 v[88:91], v4 offset:28672
    v_mfma_f32_16x16x32_bf16 v[36:39], a[220:223], v[96:99], v[36:39]
    ds_read_b128 v[92:95], v4 offset:30720
    v_mfma_f32_16x16x32_bf16 v[44:47], a[220:223], v[100:103], v[44:47]
    v_add_u32 v4, s22, v4
    s_add_u32 m0, s20, 23808
    v_mfma_f32_16x16x32_bf16 v[40:43], a[216:219], v[100:103], v[40:43]
    buffer_load_dwordx4 v2, s[8:11], s23 offen offset:768 lds
    s_waitcnt lgkmcnt(4)
    v_mfma_f32_16x16x32_bf16 v[32:35], a[224:227], v[72:75], v[32:35]
    ds_read_b128 v[96:99], v5 offset:28672
    v_mfma_f32_16x16x32_bf16 v[36:39], a[228:231], v[72:75], v[36:39]
    ds_read_b128 v[100:103], v5 offset:30720
    v_mfma_f32_16x16x32_bf16 v[44:47], a[228:231], v[76:79], v[44:47]
    v_add_u32 v5, s22, v5
    v_mfma_f32_16x16x32_bf16 v[40:43], a[224:227], v[76:79], v[40:43]
    s_add_u32 m0, s20, 27776
    s_waitcnt vmcnt(16)
    s_barrier
    s_waitcnt lgkmcnt(4)
    v_mfma_f32_16x16x32_bf16 v[32:35], a[232:235], v[80:83], v[32:35]
    ds_read_b128 v[72:75], v4 offset:0
    buffer_load_dwordx4 v2, s[8:11], s23 offen offset:896 lds
    v_mfma_f32_16x16x32_bf16 v[36:39], a[236:239], v[80:83], v[36:39]
    ds_read_b128 v[76:79], v4 offset:2048
    s_add_u32 s23, s23, 1024
    v_mfma_f32_16x16x32_bf16 v[44:47], a[236:239], v[84:87], v[44:47]
    s_bitcmp1_b32 s23, 11
    s_cselect_b32 s60, 0xf800, 0
    v_mfma_f32_16x16x32_bf16 v[40:43], a[232:235], v[84:87], v[40:43]
    s_add_u32 s23, s23, s60
    s_waitcnt lgkmcnt(4)
    v_mfma_f32_16x16x32_bf16 v[32:35], a[240:243], v[88:91], v[32:35]
    ds_read_b128 v[80:83], v5 offset:0
    s_add_u32 s20, s20, 32768
    s_cmp_ge_u32 s20, 163840
    v_mfma_f32_16x16x32_bf16 v[36:39], a[244:247], v[88:91], v[36:39]
    ds_read_b128 v[84:87], v5 offset:2048
    s_cselect_b32 s60, 163840, 0
    s_sub_u32 s20, s20, s60
    v_mfma_f32_16x16x32_bf16 v[44:47], a[244:247], v[92:95], v[44:47]
    v_mfma_f32_16x16x32_bf16 v[40:43], a[240:243], v[92:95], v[40:43]
    s_waitcnt lgkmcnt(4)
    v_mfma_f32_16x16x32_bf16 v[48:51], a[248:251], v[96:99], v[32:35]
    ds_read_b128 v[88:91], v4 offset:4096
    s_add_u32 s24, s24, 1
    s_sub_u32 s61, s24, 2
    v_mfma_f32_16x16x32_bf16 v[52:55], a[252:255], v[96:99], v[36:39]
    ds_read_b128 v[92:95], v4 offset:6144
    s_bitcmp1_b64 s[34:35], s61
    v_mfma_f32_16x16x32_bf16 v[60:63], a[252:255], v[100:103], v[44:47]
    v_mfma_f32_16x16x32_bf16 v[56:59], a[248:251], v[100:103], v[40:43]
    s_cbranch_scc0 kvsk
    s_cmp_eq_u32 s24, 64
    s_cbranch_scc1 kvsk_fin
    s_sub_u32 s62, s24, 46
    s_cmp_ge_u32 s62, 16
    s_cbranch_scc1 kvsk_sig
    s_cmp_ge_u32 s24, 54
    s_cbranch_scc1 L_wp_46
    s_cmp_ge_u32 s24, 50
    s_cbranch_scc1 L_wp_47
    s_cmp_ge_u32 s24, 48
    s_cbranch_scc1 L_wp_48
    s_cmp_ge_u32 s24, 47
    s_cbranch_scc1 L_wp_49
    s_add_u32 s62, s28, 0x0
    buffer_load_dwordx4 v[128:131], v6, s[12:15], s62 offen nt
    s_add_u32 s62, s28, 0x4000
    buffer_load_dwordx4 v[132:135], v6, s[12:15], s62 offen nt
    s_branch kvsk_sig
L_wp_49:
    s_add_u32 s62, s28, 0x10000
    buffer_load_dwordx4 v[136:139], v6, s[12:15], s62 offen nt
    s_add_u32 s62, s28, 0x14000
    buffer_load_dwordx4 v[140:143], v6, s[12:15], s62 offen nt
    s_branch kvsk_sig
L_wp_48:
    s_cmp_ge_u32 s24, 49
    s_cbranch_scc1 L_wp_50
    s_add_u32 s62, s28, 0x20000
    buffer_load_dwordx4 v[144:147], v6, s[12:15], s62 offen nt
    s_add_u32 s62, s28, 0x24000
    buffer_load_dwordx4 v[148:151], v6, s[12:15], s62 offen nt
    s_branch kvsk_sig
L_wp_50:
    s_add_u32 s62, s28, 0x30000
    buffer_load_dwordx4 v[152:155], v6, s[12:15], s62 offen nt
    s_add_u32 s62, s28, 0x34000
    buffer_load_dwordx4 v[156:159], v6, s[12:15], s62 offen nt
    s_branch kvsk_sig
L_wp_47:
    s_cmp_ge_u32 s24, 52
    s_cbranch_scc1 L_wp_51
    s_cmp_ge_u32 s24, 51
    s_cbranch_scc1 L_wp_52
    s_add_u32 s62, s28, 0x40000
    buffer_load_dwordx4 v[160:163], v6, s[12:15], s62 offen nt
    s_add_u32 s62, s28, 0x44000
    buffer_load_dwordx4 v[164:167], v6, s[12:15], s62 offen nt
    s_branch kvsk_sig
L_wp_52:
    s_add_u32 s62, s28, 0x50000
    buffer_load_dwordx4 v[168:171], v6, s[12:15], s62 offen nt
    s_add_u32 s62, s28, 0x54000
    buffer_load_dwordx4 v[172:175], v6, s[12:15], s62 offen nt
    s_branch kvsk_sig
L_wp_51:
    s_cmp_ge_u32 s24, 53
    s_cbranch_scc1 L_wp_53
    s_add_u32 s62, s28, 0x60000
    buffer_load_dwordx4 v[176:179], v6, s[12:15], s62 offen nt
    s_add_u32 s62, s28, 0x64000
    buffer_load_dwordx4 v[180:183], v6, s[12:15], s62 offen nt
    s_branch kvsk_sig
L_wp_53:
    s_add_u32 s62, s28, 0x70000
    buffer_load_dwordx4 v[184:187], v6, s[12:15], s62 offen nt
    s_add_u32 s62, s28, 0x74000
    buffer_load_dwordx4 v[188:191], v6, s[12:15], s62 offen nt
    s_branch kvsk_sig
L_wp_46:
    s_cmp_ge_u32 s24, 58
    s_cbranch_scc1 L_wp_54
    s_cmp_ge_u32 s24, 56
    s_cbranch_scc1 L_wp_55
    s_cmp_ge_u32 s24, 55
    s_cbranch_scc1 L_wp_56
    s_add_u32 s62, s28, 0x80000
    buffer_load_dwordx4 v[192:195], v6, s[12:15], s62 offen nt
    s_add_u32 s62, s28, 0x84000
    buffer_load_dwordx4 v[196:199], v6, s[12:15], s62 offen nt
    s_branch kvsk_sig
L_wp_56:
    s_add_u32 s62, s28, 0x90000
    buffer_load_dwordx4 v[200:203], v6, s[12:15], s62 offen nt
    s_add_u32 s62, s28, 0x94000
    buffer_load_dwordx4 v[204:207], v6, s[12:15], s62 offen nt
    s_branch kvsk_sig
L_wp_55:
    s_cmp_ge_u32 s24, 57
    s_cbranch_scc1 L_wp_57
    s_add_u32 s62, s28, 0xa0000
    buffer_load_dwordx4 v[208:211], v6, s[12:15], s62 offen nt
    s_add_u32 s62, s28, 0xa4000
    buffer_load_dwordx4 v[212:215], v6, s[12:15], s62 offen nt
    s_branch kvsk_sig
L_wp_57:
    s_add_u32 s62, s28, 0xb0000
    buffer_load_dwordx4 v[216:219], v6, s[12:15], s62 offen nt
    s_add_u32 s62, s28, 0xb4000
    buffer_load_dwordx4 v[220:223], v6, s[12:15], s62 offen nt
    s_branch kvsk_sig
L_wp_54:
    s_cmp_ge_u32 s24, 60
    s_cbranch_scc1 L_wp_58
    s_cmp_ge_u32 s24, 59
    s_cbranch_scc1 L_wp_59
    s_add_u32 s62, s28, 0xc0000
    buffer_load_dwordx4 v[224:227], v6, s[12:15], s62 offen nt
    s_add_u32 s62, s28, 0xc4000
    buffer_load_dwordx4 v[228:231], v6, s[12:15], s62 offen nt
    s_branch kvsk_sig
L_wp_59:
    s_add_u32 s62, s28, 0xd0000
    buffer_load_dwordx4 v[232:235], v6, s[12:15], s62 offen nt
    s_add_u32 s62, s28, 0xd4000
    buffer_load_dwordx4 v[236:239], v6, s[12:15], s62 offen nt
    s_branch kvsk_sig
L_wp_58:
    s_cmp_ge_u32 s24, 61
    s_cbranch_scc1 L_wp_60
    s_add_u32 s62, s28, 0xe0000
    buffer_load_dwordx4 v[240:243], v6, s[12:15], s62 offen nt
    s_add_u32 s62, s28, 0xe4000
    buffer_load_dwordx4 v[244:247], v6, s[12:15], s62 offen nt
    s_branch kvsk_sig
L_wp_60:
    s_add_u32 s62, s28, 0xf0000
    buffer_load_dwordx4 v[248:251], v6, s[12:15], s62 offen nt
    s_add_u32 s62, s28, 0xf4000
    buffer_load_dwordx4 v[252:255], v6, s[12:15], s62 offen nt
    s_branch kvsk_sig
kvsk_sig:
    s_cmp_lg_u32 s58, 0
    s_cbranch_scc1 kvsk
    s_mov_b32 s62, 0x2042258
    s_mov_b32 s63, 0x4004
    s_bitcmp1_b64 s[62:63], s61
    s_cbranch_scc0 kvsk
    s_bfm_b64 s[62:63], s61, 0
    s_and_b32 s62, s62, 0x204225f
    s_and_b32 s63, s63, 0x80004004
    s_bcnt1_i32_b64 s60, s[62:63]
    s_lshl_b32 s60, s60, 2
    s_add_u32 s60, s60, 64
    v_mov_b32 v24, s60
    v_mov_b32 v25, 1
    s_mov_b64 exec, 1
    global_atomic_add v24, v25, s[98:99] sc1
    s_mov_b64 exec, -1
    s_branch kvsk
kvsk_early:
    s_waitcnt vmcnt(4)
    s_barrier
    s_cmp_eq_u32 s24, 0
    s_cbranch_scc1 kvsk_mid
    s_cmp_lg_u32 s58, 0
    s_cbranch_scc1 kvsk_mid
    s_lshl_b32 s60, s24, 2
    s_add_u32 s60, s60, 60
    v_mov_b32 v24, s60
    v_mov_b32 v25, 1
    s_mov_b64 exec, 1
    global_atomic_add v24, v25, s[98:99] sc1
    s_mov_b64 exec, -1
    s_branch kvsk_mid
kvsk_fin:
    s_nop 7
    v_cvt_pk_bf16_f32 v64, v48, v49
    v_cvt_pk_bf16_f32 v65, v50, v51
    v_cvt_pk_bf16_f32 v66, v52, v53
    v_cvt_pk_bf16_f32 v67, v54, v55
    v_cvt_pk_bf16_f32 v68, v56, v57
    v_cvt_pk_bf16_f32 v69, v58, v59
    v_cvt_pk_bf16_f32 v70, v60, v61
    v_cvt_pk_bf16_f32 v71, v62, v63
    buffer_store_dwordx4 v[64:67], v1, s[16:19], s25 offen sc1
    buffer_store_dwordx4 v[68:71], v12, s[16:19], s25 offen sc1
    buffer_store_dwordx4 v[28:31], v1, s[16:19], s26 offen sc1
    s_waitcnt vmcnt(0) lgkmcnt(0)
    s_barrier
    s_cmp_lg_u32 s58, 0
    s_cbranch_scc1 L_kve_45
    s_mov_b32 s60, 112
    v_mov_b32 v24, s60
    v_mov_b32 v25, 1
    s_mov_b64 exec, 1
    global_atomic_add v24, v25, s[98:99] sc1
    s_mov_b64 exec, -1
    s_branch L_kve_45
L_kvv_44:
    ds_read_b128 v[72:75], v4 offset:0
    ds_read_b128 v[76:79], v4 offset:2048
    ds_read_b128 v[80:83], v5 offset:0
    ds_read_b128 v[84:87], v5 offset:2048
    ds_read_b128 v[88:91], v4 offset:4096
    ds_read_b128 v[92:95], v4 offset:6144
    s_mov_b32 s34, 0x2042258
    s_mov_b32 s35, 0x4ffff004
    s_cmp_eq_u32 s58, 0
    s_cselect_b32 s33, s27, 0x400000
    s_mov_b32 s25, 0
    s_mov_b32 s26, 0
kvsv:
    s_waitcnt lgkmcnt(4)
    v_mfma_f32_16x16x32_bf16 v[32:35], v[72:75], a[0:3], 0
    ds_read_b128 v[96:99], v5 offset:4096
    v_mfma_f32_16x16x32_bf16 v[40:43], v[72:75], a[4:7], 0
    ds_read_b128 v[100:103], v5 offset:6144
    v_mfma_f32_16x16x32_bf16 v[44:47], v[76:79], a[4:7], 0
    v_mfma_f32_16x16x32_bf16 v[36:39], v[76:79], a[0:3], 0
    v_cvt_pk_bf16_f32 v64, v48, v49
    s_waitcnt lgkmcnt(4)
    v_mfma_f32_16x16x32_bf16 v[32:35], v[80:83], a[8:11], v[32:35]
    ds_read_b128 v[72:75], v4 offset:8192
    v_cvt_pk_bf16_f32 v65, v50, v51
    v_mfma_f32_16x16x32_bf16 v[40:43], v[80:83], a[12:15], v[40:43]
    ds_read_b128 v[76:79], v4 offset:10240
    v_cvt_pk_bf16_f32 v66, v52, v53
    v_mfma_f32_16x16x32_bf16 v[44:47], v[84:87], a[12:15], v[44:47]
    v_cvt_pk_bf16_f32 v67, v54, v55
    v_cvt_pk_bf16_f32 v68, v56, v57
    v_mfma_f32_16x16x32_bf16 v[36:39], v[84:87], a[8:11], v[36:39]
    v_cvt_pk_bf16_f32 v69, v58, v59
    s_waitcnt lgkmcnt(4)
    v_mfma_f32_16x16x32_bf16 v[32:35], v[88:91], a[16:19], v[32:35]
    ds_read_b128 v[80:83], v5 offset:8192
    v_cvt_pk_bf16_f32 v70, v60, v61
    v_mfma_f32_16x16x32_bf16 v[40:43], v[88:91], a[20:23], v[40:43]
    ds_read_b128 v[84:87], v5 offset:10240
    v_cvt_pk_bf16_f32 v71, v62, v63
    v_mfma_f32_16x16x32_bf16 v[44:47], v[92:95], a[20:23], v[44:47]
    buffer_store_dwordx4 v[64:67], v1, s[16:19], s25 offen sc1
    v_mfma_f32_16x16x32_bf16 v[36:39], v[92:95], a[16:19], v[36:39]
    buffer_store_dwordx4 v[68:71], v1, s[16:19], s25 offen offset:1024 sc1
    s_waitcnt lgkmcnt(4)
    v_mfma_f32_16x16x32_bf16 v[32:35], v[96:99], a[24:27], v[32:35]
    ds_read_b128 v[88:91], v4 offset:12288
    buffer_store_dwordx4 v[28:31], v1, s[16:19], s26 offen sc1
    v_mfma_f32_16x16x32_bf16 v[40:43], v[96:99], a[28:31], v[40:43]
    ds_read_b128 v[92:95], v4 offset:14336
    v_mfma_f32_16x16x32_bf16 v[44:47], v[100:103], a[28:31], v[44:47]
    v_mfma_f32_16x16x32_bf16 v[36:39], v[100:103], a[24:27], v[36:39]
    buffer_load_dword v13, v10, s[8:11], s33 offen
    s_waitcnt lgkmcnt(4)
    v_mfma_f32_16x16x32_bf16 v[32:35], v[72:75], a[32:35], v[32:35]
    ds_read_b128 v[96:99], v5 offset:12288
    v_mfma_f32_16x16x32_bf16 v[40:43], v[72:75], a[36:39], v[40:43]
    ds_read_b128 v[100:103], v5 offset:14336
    v_mfma_f32_16x16x32_bf16 v[44:47], v[76:79], a[36:39], v[44:47]
    s_mov_b32 s18, 0xc000000
    s_lshl_b32 s25, s24, 21
    v_mfma_f32_16x16x32_bf16 v[36:39], v[76:79], a[32:35], v[36:39]
    s_lshl_b32 s62, s24, 13
    s_waitcnt lgkmcnt(4)
    v_mfma_f32_16x16x32_bf16 v[32:35], v[80:83], a[40:43], v[32:35]
    ds_read_b128 v[72:75], v4 offset:16384
    s_and_b32 s62, s62, 0x2000
    v_mfma_f32_16x16x32_bf16 v[40:43], v[80:83], a[44:47], v[40:43]
    ds_read_b128 v[76:79], v4 offset:18432
    s_xor_b32 s62, s62, s30
    v_mfma_f32_16x16x32_bf16 v[44:47], v[84:87], a[44:47], v[44:47]
    s_add_u32 s25, s25, s62
    s_lshl_b32 s26, s24, 18
    v_mfma_f32_16x16x32_bf16 v[36:39], v[84:87], a[40:43], v[36:39]
    s_lshl_b32 s62, s24, 10
    s_waitcnt lgkmcnt(4)
    v_mfma_f32_16x16x32_bf16 v[32:35], v[88:91], a[48:51], v[32:35]
    ds_read_b128 v[80:83], v5 offset:16384
    s_and_b32 s62, s62, 0x2000
    v_mfma_f32_16x16x32_bf16 v[40:43], v[88:91], a[52:55], v[40:43]
    ds_read_b128 v[84:87], v5 offset:18432
    s_xor_b32 s62, s62, s31
    v_mfma_f32_16x16x32_bf16 v[44:47], v[92:95], a[52:55], v[44:47]
    s_add_u32 s26, s26, s62
    s_cmp_ge_u32 s21, 131072
    v_mfma_f32_16x16x32_bf16 v[36:39], v[92:95], a[48:51], v[36:39]
    s_cselect_b32 s22, 0xfffe0000, s29
    s_waitcnt lgkmcnt(4)
    v_mfma_f32_16x16x32_bf16 v[32:35], v[96:99], a[56:59], v[32:35]
    ds_read_b128 v[88:91], v4 offset:20480
    s_add_u32 s21, s21, s22
    v_mfma_f32_16x16x32_bf16 v[40:43], v[96:99], a[60:63], v[40:43]
    ds_read_b128 v[92:95], v4 offset:22528
    s_add_u32 s27, s27, 0x10000
    v_mfma_f32_16x16x32_bf16 v[44:47], v[100:103], a[60:63], v[44:47]
    s_andn2_b32 s61, 3, s24
    s_or_b32 s61, s61, s58
    v_mfma_f32_16x16x32_bf16 v[36:39], v[100:103], a[56:59], v[36:39]
    s_cselect_b32 s33, 0x400000, s27
    s_waitcnt lgkmcnt(4)
    v_mfma_f32_16x16x32_bf16 v[32:35], v[72:75], a[64:67], v[32:35]
    ds_read_b128 v[96:99], v5 offset:20480
    s_cmp_lt_u32 s24, 4
    v_mfma_f32_16x16x32_bf16 v[40:43], v[72:75], a[68:71], v[40:43]
    ds_read_b128 v[100:103], v5 offset:22528
    s_cselect_b64 vcc, -1, 0
    v_mfma_f32_16x16x32_bf16 v[44:47], v[76:79], a[68:71], v[44:47]
    v_mfma_f32_16x16x32_bf16 v[36:39], v[76:79], a[64:67], v[36:39]
    s_waitcnt lgkmcnt(4)
    v_mfma_f32_16x16x32_bf16 v[32:35], v[80:83], a[72:75], v[32:35]
    ds_read_b128 v[72:75], v4 offset:24576
    v_mfma_f32_16x16x32_bf16 v[40:43], v[80:83], a[76:79], v[40:43]
    ds_read_b128 v[76:79], v4 offset:26624
    v_mfma_f32_16x16x32_bf16 v[44:47], v[84:87], a[76:79], v[44:47]
    v_mfma_f32_16x16x32_bf16 v[36:39], v[84:87], a[72:75], v[36:39]
    s_waitcnt lgkmcnt(4)
    v_mfma_f32_16x16x32_bf16 v[32:35], v[88:91], a[80:83], v[32:35]
    ds_read_b128 v[80:83], v5 offset:24576
    s_add_u32 m0, s20, 0
    v_mfma_f32_16x16x32_bf16 v[40:43], v[88:91], a[84:87], v[40:43]
    ds_read_b128 v[84:87], v5 offset:26624
    buffer_load_dwordx4 v2, s[8:11], s23 offen offset:0 lds
    v_mfma_f32_16x16x32_bf16 v[44:47], v[92:95], a[84:87], v[44:47]
    v_mfma_f32_16x16x32_bf16 v[36:39], v[92:95], a[80:83], v[36:39]
    s_waitcnt lgkmcnt(4)
    v_mfma_f32_16x16x32_bf16 v[32:35], v[96:99], a[88:91], v[32:35]
    ds_read_b128 v[88:91], v4 offset:28672
    v_mfma_f32_16x16x32_bf16 v[40:43], v[96:99], a[92:95], v[40:43]
    ds_read_b128 v[92:95], v4 offset:30720
    s_add_u32 m0, s20, 3968
    v_mfma_f32_16x16x32_bf16 v[44:47], v[100:103], a[92:95], v[44:47]
    buffer_load_dwordx4 v2, s[8:11], s23 offen offset:128 lds
    v_mfma_f32_16x16x32_bf16 v[36:39], v[100:103], a[88:91], v[36:39]
    v_add_u32 v4, s22, v4
    s_waitcnt lgkmcnt(4)
    v_mfma_f32_16x16x32_bf16 v[32:35], v[72:75], a[96:99], v[32:35]
    ds_read_b128 v[96:99], v5 offset:28672
    v_mfma_f32_16x16x32_bf16 v[40:43], v[72:75], a[100:103], v[40:43]
    ds_read_b128 v[100:103], v5 offset:30720
    v_mfma_f32_16x16x32_bf16 v[44:47], v[76:79], a[100:103], v[44:47]
    v_add_u32 v5, s22, v5
    s_add_u32 m0, s20, 7936
    v_mfma_f32_16x16x32_bf16 v[36:39], v[76:79], a[96:99], v[36:39]
    buffer_load_dwordx4 v2, s[8:11], s23 offen offset:256 lds
    s_waitcnt vmcnt(15)
    s_cbranch_vccnz kvsv_early
    s_barrier
kvsv_mid:
    s_waitcnt lgkmcnt(4)
    v_mfma_f32_16x16x32_bf16 v[32:35], v[80:83], a[104:107], v[32:35]
    ds_read_b128 v[72:75], v4 offset:0
    v_mfma_f32_16x16x32_bf16 v[40:43], v[80:83], a[108:111], v[40:43]
    ds_read_b128 v[76:79], v4 offset:2048
    v_mfma_f32_16x16x32_bf16 v[44:47], v[84:87], a[108:111], v[44:47]
    v_mfma_f32_16x16x32_bf16 v[36:39], v[84:87], a[104:107], v[36:39]
    s_add_u32 m0, s20, 11904
    s_waitcnt lgkmcnt(4)
    v_mfma_f32_16x16x32_bf16 v[32:35], v[88:91], a[112:115], v[32:35]
    ds_read_b128 v[80:83], v5 offset:0
    buffer_load_dwordx4 v2, s[8:11], s23 offen offset:384 lds
    v_mfma_f32_16x16x32_bf16 v[40:43], v[88:91], a[116:119], v[40:43]
    ds_read_b128 v[84:87], v5 offset:2048
    v_mfma_f32_16x16x32_bf16 v[44:47], v[92:95], a[116:119], v[44:47]
    v_mfma_f32_16x16x32_bf16 v[36:39], v[92:95], a[112:115], v[36:39]
    s_waitcnt lgkmcnt(4)
    v_mfma_f32_16x16x32_bf16 v[32:35], v[96:99], a[120:123], v[32:35]
    ds_read_b128 v[88:91], v4 offset:4096
    s_add_u32 m0, s20, 15872
    v_mfma_f32_16x16x32_bf16 v[40:43], v[96:99], a[124:127], v[40:43]
    ds_read_b128 v[92:95], v4 offset:6144
    buffer_load_dwordx4 v2, s[8:11], s23 offen offset:512 lds
    v_mfma_f32_16x16x32_bf16 v[44:47], v[100:103], a[124:127], v[44:47]
    s_cmp_ge_u32 s21, 131072
    s_cselect_b32 s22, 0xfffe0000, s29
    v_mfma_f32_16x16x32_bf16 v[36:39], v[100:103], a[120:123], v[36:39]
    s_add_u32 s21, s21, s22
    s_waitcnt lgkmcnt(4)
    v_mfma_f32_16x16x32_bf16 v[32:35], v[72:75], a[128:131], v[32:35]
    ds_read_b128 v[96:99], v5 offset:4096
    v_mfma_f32_16x16x32_bf16 v[40:43], v[72:75], a[132:135], v[40:43]
    ds_read_b128 v[100:103], v5 offset:6144
    s_add_u32 m0, s20, 19840
    v_mfma_f32_16x16x32_bf16 v[44:47], v[76:79], a[132:135], v[44:47]
    buffer_load_dwordx4 v2, s[8:11], s23 offen offset:640 lds
    v_mfma_f32_16x16x32_bf16 v[36:39], v[76:79], a[128:131], v[36:39]
    s_waitcnt lgkmcnt(4)
    v_mfma_f32_16x16x32_bf16 v[32:35], v[80:83], a[136:139], v[32:35]
    ds_read_b128 v[72:75], v4 offset:8192
    v_mfma_f32_16x16x32_bf16 v[40:43], v[80:83], a[140:143], v[40:43]
    ds_read_b128 v[76:79], v4 offset:10240
    v_mfma_f32_16x16x32_bf16 v[44:47], v[84:87], a[140:143], v[44:47]
    s_add_u32 m0, s20, 23808
    v_mfma_f32_16x16x32_bf16 v[36:39], v[84:87], a[136:139], v[36:39]
    buffer_load_dwordx4 v2, s[8:11], s23 offen offset:768 lds
    s_waitcnt lgkmcnt(4)
    v_mfma_f32_16x16x32_bf16 v[32:35], v[88:91], a[144:147], v[32:35]
    ds_read_b128 v[80:83], v5 offset:8192
    v_mfma_f32_16x16x32_bf16 v[40:43], v[88:91], a[148:151], v[40:43]
    ds_read_b128 v[84:87], v5 offset:10240
    v_mfma_f32_16x16x32_bf16 v[44:47], v[92:95], a[148:151], v[44:47]
    v_mfma_f32_16x16x32_bf16 v[36:39], v[92:95], a[144:147], v[36:39]
    s_add_u32 m0, s20, 27776
    s_waitcnt lgkmcnt(4)
    v_mfma_f32_16x16x32_bf16 v[32:35], v[96:99], a[152:155], v[32:35]
    ds_read_b128 v[88:91], v4 offset:12288
    buffer_load_dwordx4 v2, s[8:11], s23 offen offset:896 lds
    v_mfma_f32_16x16x32_bf16 v[40:43], v[96:99], a[156:159], v[40:43]
    ds_read_b128 v[92:95], v4 offset:14336
    s_add_u32 s23, s23, 1024
    v_mfma_f32_16x16x32_bf16 v[44:47], v[100:103], a[156:159], v[44:47]
    s_bitcmp1_b32 s23, 11
    s_cselect_b32 s60, 0xf800, 0
    v_mfma_f32_16x16x32_bf16 v[36:39], v[100:103], a[152:155], v[36:39]
    s_add_u32 s23, s23, s60
    s_waitcnt lgkmcnt(4)
    v_mfma_f32_16x16x32_bf16 v[32:35], v[72:75], a[160:163], v[32:35]
    ds_read_b128 v[96:99], v5 offset:12288
    s_add_u32 s20, s20, 32768
    v_mfma_f32_16x16x32_bf16 v[40:43], v[72:75], a[164:167], v[40:43]
    ds_read_b128 v[100:103], v5 offset:14336
    s_cmp_ge_u32 s20, 163840
    v_mfma_f32_16x16x32_bf16 v[44:47], v[76:79], a[164:167], v[44:47]
    s_cselect_b32 s60, 163840, 0
    s_sub_u32 s20, s20, s60
    v_mfma_f32_16x16x32_bf16 v[36:39], v[76:79], a[160:163], v[36:39]
    s_add_u32 m0, s20, 0
    s_waitcnt lgkmcnt(4)
    v_mfma_f32_16x16x32_bf16 v[32:35], v[80:83], a[168:171], v[32:35]
    ds_read_b128 v[72:75], v4 offset:16384
    buffer_load_dwordx4 v2, s[8:11], s23 offen offset:0 lds
    v_mfma_f32_16x16x32_bf16 v[40:43], v[80:83], a[172:175], v[40:43]
    ds_read_b128 v[76:79], v4 offset:18432
    s_add_u32 m0, s20, 3968
    v_mfma_f32_16x16x32_bf16 v[44:47], v[84:87], a[172:175], v[44:47]
    buffer_load_dwordx4 v2, s[8:11], s23 offen offset:128 lds
    v_mfma_f32_16x16x32_bf16 v[36:39], v[84:87], a[168:171], v[36:39]
    s_waitcnt lgkmcnt(4)
    v_mfma_f32_16x16x32_bf16 v[32:35], v[88:91], a[176:179], v[32:35]
    ds_read_b128 v[80:83], v5 offset:16384
    v_mfma_f32_16x16x32_bf16 v[40:43], v[88:91], a[180:183], v[40:43]
    ds_read_b128 v[84:87], v5 offset:18432
    v_mfma_f32_16x16x32_bf16 v[44:47], v[92:95], a[180:183], v[44:47]
    s_add_u32 m0, s20, 7936
    v_mfma_f32_16x16x32_bf16 v[36:39], v[92:95], a[176:179], v[36:39]
    buffer_load_dwordx4 v2, s[8:11], s23 offen offset:256 lds
    s_waitcnt lgkmcnt(4)
    v_mfma_f32_16x16x32_bf16 v[32:35], v[96:99], a[184:187], v[32:35]
    ds_read_b128 v[88:91], v4 offset:20480
    v_mfma_f32_16x16x32_bf16 v[40:43], v[96:99], a[188:191], v[40:43]
    ds_read_b128 v[92:95], v4 offset:22528
    v_mfma_f32_16x16x32_bf16 v[44:47], v[100:103], a[188:191], v[44:47]
    v_mfma_f32_16x16x32_bf16 v[36:39], v[100:103], a[184:187], v[36:39]
    s_add_u32 m0, s20, 11904
    s_waitcnt lgkmcnt(4)
    v_mfma_f32_16x16x32_bf16 v[32:35], v[72:75], a[192:195], v[32:35]
    ds_read_b128 v[96:99], v5 offset:20480
    buffer_load_dwordx4 v2, s[8:11], s23 offen offset:384 lds
    v_mfma_f32_16x16x32_bf16 v[40:43], v[72:75], a[196:199], v[40:43]
    ds_read_b128 v[100:103], v5 offset:22528
    v_mfma_f32_16x16x32_bf16 v[44:47], v[76:79], a[196:199], v[44:47]
    v_mfma_f32_16x16x32_bf16 v[36:39], v[76:79], a[192:195], v[36:39]
    s_waitcnt lgkmcnt(4)
    v_mfma_f32_16x16x32_bf16 v[32:35], v[80:83], a[200:203], v[32:35]
    ds_read_b128 v[72:75], v4 offset:24576
    s_add_u32 m0, s20, 15872
    v_mfma_f32_16x16x32_bf16 v[40:43], v[80:83], a[204:207], v[40:43]
    ds_read_b128 v[76:79], v4 offset:26624
    buffer_load_dwordx4 v2, s[8:11], s23 offen offset:512 lds
    v_mfma_f32_16x16x32_bf16 v[44:47], v[84:87], a[204:207], v[44:47]
    v_mfma_f32_16x16x32_bf16 v[36:39], v[84:87], a[200:203], v[36:39]
    s_waitcnt lgkmcnt(4)
    v_mfma_f32_16x16x32_bf16 v[32:35], v[88:91], a[208:211], v[32:35]
    ds_read_b128 v[80:83], v5 offset:24576
    v_mfma_f32_16x16x32_bf16 v[40:43], v[88:91], a[212:215], v[40:43]
    ds_read_b128 v[84:87], v5 offset:26624
    s_add_u32 m0, s20, 19840
    v_mfma_f32_16x16x32_bf16 v[44:47], v[92:95], a[212:215], v[44:47]
    buffer_load_dwordx4 v2, s[8:11], s23 offen offset:640 lds
    v_mfma_f32_16x16x32_bf16 v[36:39], v[92:95], a[208:211], v[36:39]
    s_waitcnt lgkmcnt(4)
    v_mfma_f32_16x16x32_bf16 v[32:35], v[96:99], a[216:219], v[32:35]
    ds_read_b128 v[88:91], v4 offset:28672
    v_mfma_f32_16x16x32_bf16 v[40:43], v[96:99], a[220:223], v[40:43]
    ds_read_b128 v[92:95], v4 offset:30720
    v_mfma_f32_16x16x32_bf16 v[44:47], v[100:103], a[220:223], v[44:47]
    v_add_u32 v4, s22, v4
    s_add_u32 m0, s20, 23808
    v_mfma_f32_16x16x32_bf16 v[36:39], v[100:103], a[216:219], v[36:39]
    buffer_load_dwordx4 v2, s[8:11], s23 offen offset:768 lds
    s_waitcnt lgkmcnt(4)
    v_mfma_f32_16x16x32_bf16 v[32:35], v[72:75], a[224:227], v[32:35]
    ds_read_b128 v[96:99], v5 offset:28672
    v_mfma_f32_16x16x32_bf16 v[40:43], v[72:75], a[228:231], v[40:43]
    ds_read_b128 v[100:103], v5 offset:30720
    v_mfma_f32_16x16x32_bf16 v[44:47], v[76:79], a[228:231], v[44:47]
    v_add_u32 v5, s22, v5
    v_mfma_f32_16x16x32_bf16 v[36:39], v[76:79], a[224:227], v[36:39]
    s_add_u32 m0, s20, 27776
    s_waitcnt vmcnt(16)
    s_barrier
    s_waitcnt lgkmcnt(4)
    v_mfma_f32_16x16x32_bf16 v[32:35], v[80:83], a[232:235], v[32:35]
    ds_read_b128 v[72:75], v4 offset:0
    buffer_load_dwordx4 v2, s[8:11], s23 offen offset:896 lds
    v_mfma_f32_16x16x32_bf16 v[40:43], v[80:83], a[236:239], v[40:43]
    ds_read_b128 v[76:79], v4 offset:2048
    s_add_u32 s23, s23, 1024
    v_mfma_f32_16x16x32_bf16 v[44:47], v[84:87], a[236:239], v[44:47]
    s_bitcmp1_b32 s23, 11
    s_cselect_b32 s60, 0xf800, 0
    v_mfma_f32_16x16x32_bf16 v[36:39], v[84:87], a[232:235], v[36:39]
    s_add_u32 s23, s23, s60
    s_waitcnt lgkmcnt(4)
    v_mfma_f32_16x16x32_bf16 v[32:35], v[88:91], a[240:243], v[32:35]
    ds_read_b128 v[80:83], v5 offset:0
    s_add_u32 s20, s20, 32768
    s_cmp_ge_u32 s20, 163840
    v_mfma_f32_16x16x32_bf16 v[40:43], v[88:91], a[244:247], v[40:43]
    ds_read_b128 v[84:87], v5 offset:2048
    s_cselect_b32 s60, 163840, 0
    s_sub_u32 s20, s20, s60
    v_mfma_f32_16x16x32_bf16 v[44:47], v[92:95], a[244:247], v[44:47]
    v_mfma_f32_16x16x32_bf16 v[36:39], v[92:95], a[240:243], v[36:39]
    s_waitcnt lgkmcnt(4)
    v_mfma_f32_16x16x32_bf16 v[48:51], v[96:99], a[248:251], v[32:35]
    ds_read_b128 v[88:91], v4 offset:4096
    s_add_u32 s24, s24, 1
    s_sub_u32 s61, s24, 2
    v_mfma_f32_16x16x32_bf16 v[56:59], v[96:99], a[252:255], v[40:43]
    ds_read_b128 v[92:95], v4 offset:6144
    s_bitcmp1_b64 s[34:35], s61
    v_mfma_f32_16x16x32_bf16 v[60:63], v[100:103], a[252:255], v[44:47]
    v_mfma_f32_16x16x32_bf16 v[52:55], v[100:103], a[248:251], v[36:39]
    s_cbranch_scc0 kvsv
    s_cmp_eq_u32 s24, 64
    s_cbranch_scc1 kvsv_fin
    s_sub_u32 s62, s24, 46
    s_cmp_ge_u32 s62, 16
    s_cbranch_scc1 kvsv_sig
    s_cmp_ge_u32 s24, 54
    s_cbranch_scc1 L_wp_61
    s_cmp_ge_u32 s24, 50
    s_cbranch_scc1 L_wp_62
    s_cmp_ge_u32 s24, 48
    s_cbranch_scc1 L_wp_63
    s_cmp_ge_u32 s24, 47
    s_cbranch_scc1 L_wp_64
    s_add_u32 s62, s28, 0x0
    buffer_load_dwordx4 v[128:131], v6, s[12:15], s62 offen nt
    s_add_u32 s62, s28, 0x4000
    buffer_load_dwordx4 v[132:135], v6, s[12:15], s62 offen nt
    s_branch kvsv_sig
L_wp_64:
    s_add_u32 s62, s28, 0x10000
    buffer_load_dwordx4 v[136:139], v6, s[12:15], s62 offen nt
    s_add_u32 s62, s28, 0x14000
    buffer_load_dwordx4 v[140:143], v6, s[12:15], s62 offen nt
    s_branch kvsv_sig
L_wp_63:
    s_cmp_ge_u32 s24, 49
    s_cbranch_scc1 L_wp_65
    s_add_u32 s62, s28, 0x20000
    buffer_load_dwordx4 v[144:147], v6, s[12:15], s62 offen nt
    s_add_u32 s62, s28, 0x24000
    buffer_load_dwordx4 v[148:151], v6, s[12:15], s62 offen nt
    s_branch kvsv_sig
L_wp_65:
    s_add_u32 s62, s28, 0x30000
    buffer_load_dwordx4 v[152:155], v6, s[12:15], s62 offen nt
    s_add_u32 s62, s28, 0x34000
    buffer_load_dwordx4 v[156:159], v6, s[12:15], s62 offen nt
    s_branch kvsv_sig
L_wp_62:
    s_cmp_ge_u32 s24, 52
    s_cbranch_scc1 L_wp_66
    s_cmp_ge_u32 s24, 51
    s_cbranch_scc1 L_wp_67
    s_add_u32 s62, s28, 0x40000
    buffer_load_dwordx4 v[160:163], v6, s[12:15], s62 offen nt
    s_add_u32 s62, s28, 0x44000
    buffer_load_dwordx4 v[164:167], v6, s[12:15], s62 offen nt
    s_branch kvsv_sig
L_wp_67:
    s_add_u32 s62, s28, 0x50000
    buffer_load_dwordx4 v[168:171], v6, s[12:15], s62 offen nt
    s_add_u32 s62, s28, 0x54000
    buffer_load_dwordx4 v[172:175], v6, s[12:15], s62 offen nt
    s_branch kvsv_sig
L_wp_66:
    s_cmp_ge_u32 s24, 53
    s_cbranch_scc1 L_wp_68
    s_add_u32 s62, s28, 0x60000
    buffer_load_dwordx4 v[176:179], v6, s[12:15], s62 offen nt
    s_add_u32 s62, s28, 0x64000
    buffer_load_dwordx4 v[180:183], v6, s[12:15], s62 offen nt
    s_branch kvsv_sig
L_wp_68:
    s_add_u32 s62, s28, 0x70000
    buffer_load_dwordx4 v[184:187], v6, s[12:15], s62 offen nt
    s_add_u32 s62, s28, 0x74000
    buffer_load_dwordx4 v[188:191], v6, s[12:15], s62 offen nt
    s_branch kvsv_sig
L_wp_61:
    s_cmp_ge_u32 s24, 58
    s_cbranch_scc1 L_wp_69
    s_cmp_ge_u32 s24, 56
    s_cbranch_scc1 L_wp_70
    s_cmp_ge_u32 s24, 55
    s_cbranch_scc1 L_wp_71
    s_add_u32 s62, s28, 0x80000
    buffer_load_dwordx4 v[192:195], v6, s[12:15], s62 offen nt
    s_add_u32 s62, s28, 0x84000
    buffer_load_dwordx4 v[196:199], v6, s[12:15], s62 offen nt
    s_branch kvsv_sig
L_wp_71:
    s_add_u32 s62, s28, 0x90000
    buffer_load_dwordx4 v[200:203], v6, s[12:15], s62 offen nt
    s_add_u32 s62, s28, 0x94000
    buffer_load_dwordx4 v[204:207], v6, s[12:15], s62 offen nt
    s_branch kvsv_sig
L_wp_70:
    s_cmp_ge_u32 s24, 57
    s_cbranch_scc1 L_wp_72
    s_add_u32 s62, s28, 0xa0000
    buffer_load_dwordx4 v[208:211], v6, s[12:15], s62 offen nt
    s_add_u32 s62, s28, 0xa4000
    buffer_load_dwordx4 v[212:215], v6, s[12:15], s62 offen nt
    s_branch kvsv_sig
L_wp_72:
    s_add_u32 s62, s28, 0xb0000
    buffer_load_dwordx4 v[216:219], v6, s[12:15], s62 offen nt
    s_add_u32 s62, s28, 0xb4000
    buffer_load_dwordx4 v[220:223], v6, s[12:15], s62 offen nt
    s_branch kvsv_sig
L_wp_69:
    s_cmp_ge_u32 s24, 60
    s_cbranch_scc1 L_wp_73
    s_cmp_ge_u32 s24, 59
    s_cbranch_scc1 L_wp_74
    s_add_u32 s62, s28, 0xc0000
    buffer_load_dwordx4 v[224:227], v6, s[12:15], s62 offen nt
    s_add_u32 s62, s28, 0xc4000
    buffer_load_dwordx4 v[228:231], v6, s[12:15], s62 offen nt
    s_branch kvsv_sig
L_wp_74:
    s_add_u32 s62, s28, 0xd0000
    buffer_load_dwordx4 v[232:235], v6, s[12:15], s62 offen nt
    s_add_u32 s62, s28, 0xd4000
    buffer_load_dwordx4 v[236:239], v6, s[12:15], s62 offen nt
    s_branch kvsv_sig
L_wp_73:
    s_cmp_ge_u32 s24, 61
    s_cbranch_scc1 L_wp_75
    s_add_u32 s62, s28, 0xe0000
    buffer_load_dwordx4 v[240:243], v6, s[12:15], s62 offen nt
    s_add_u32 s62, s28, 0xe4000
    buffer_load_dwordx4 v[244:247], v6, s[12:15], s62 offen nt
    s_branch kvsv_sig
L_wp_75:
    s_add_u32 s62, s28, 0xf0000
    buffer_load_dwordx4 v[248:251], v6, s[12:15], s62 offen nt
    s_add_u32 s62, s28, 0xf4000
    buffer_load_dwordx4 v[252:255], v6, s[12:15], s62 offen nt
    s_branch kvsv_sig
kvsv_sig:
    s_cmp_lg_u32 s58, 0
    s_cbranch_scc1 kvsv
    s_mov_b32 s62, 0x2042258
    s_mov_b32 s63, 0x4004
    s_bitcmp1_b64 s[62:63], s61
    s_cbranch_scc0 kvsv
    s_bfm_b64 s[62:63], s61, 0
    s_and_b32 s62, s62, 0x204225f
    s_and_b32 s63, s63, 0x80004004
    s_bcnt1_i32_b64 s60, s[62:63]
    s_lshl_b32 s60, s60, 2
    s_add_u32 s60, s60, 64
    v_mov_b32 v24, s60
    v_mov_b32 v25, 1
    s_mov_b64 exec, 1
    global_atomic_add v24, v25, s[98:99] sc1
    s_mov_b64 exec, -1
    s_branch kvsv
kvsv_early:
    s_waitcnt vmcnt(4)
    s_barrier
    s_cmp_eq_u32 s24, 0
    s_cbranch_scc1 kvsv_mid
    s_cmp_lg_u32 s58, 0
    s_cbranch_scc1 kvsv_mid
    s_lshl_b32 s60, s24, 2
    s_add_u32 s60, s60, 60
    v_mov_b32 v24, s60
    v_mov_b32 v25, 1
    s_mov_b64 exec, 1
    global_atomic_add v24, v25, s[98:99] sc1
    s_mov_b64 exec, -1
    s_branch kvsv_mid
kvsv_fin:
    s_nop 7
    v_cvt_pk_bf16_f32 v64, v48, v49
    v_cvt_pk_bf16_f32 v65, v50, v51
    v_cvt_pk_bf16_f32 v66, v52, v53
    v_cvt_pk_bf16_f32 v67, v54, v55
    v_cvt_pk_bf16_f32 v68, v56, v57
    v_cvt_pk_bf16_f32 v69, v58, v59
    v_cvt_pk_bf16_f32 v70, v60, v61
    v_cvt_pk_bf16_f32 v71, v62, v63
    buffer_store_dwordx4 v[64:67], v1, s[16:19], s25 offen sc1
    buffer_store_dwordx4 v[68:71], v1, s[16:19], s25 offen offset:1024 sc1
    buffer_store_dwordx4 v[28:31], v1, s[16:19], s26 offen sc1
    s_waitcnt vmcnt(0) lgkmcnt(0)
    s_barrier
    s_cmp_lg_u32 s58, 0
    s_cbranch_scc1 L_kve_45
    s_mov_b32 s60, 112
    v_mov_b32 v24, s60
    v_mov_b32 v25, 1
    s_mov_b64 exec, 1
    global_atomic_add v24, v25, s[98:99] sc1
    s_mov_b64 exec, -1
    s_branch L_kve_45
L_kve_45:
    s_branch chain_kernel_seg
L_big_37:
    v_and_b32 v24, 63, v0
    v_lshlrev_b32 v1, 4, v24
    v_mov_b32 v2, v1
    v_add_u32 v3, 1024, v1
    v_bfe_u32 v24, v0, 1, 3
    v_bfe_u32 v25, v0, 4, 2
    v_xor_b32 v24, v24, v25
    v_lshlrev_b32 v24, 4, v24
    v_and_b32 v25, 15, v0
    v_lshl_add_u32 v24, v25, 7, v24
    s_lshr_b32 s60, s58, 1
    s_lshl_b32 s60, s60, 14
    v_add_u32 v23, s60, v24
    s_and_b32 s60, s58, 1
    s_lshl_b32 s60, s60, 14
    s_add_u32 s60, s60, 32768
    v_add_u32 v12, s60, v24
    v_xor_b32 v13, 64, v12
    v_bfe_u32 v24, v0, 2, 3
    v_lshlrev_b32 v22, 5, v24
    v_and_b32 v24, 3, v0
    v_lshl_add_u32 v22, v24, 3, v22
    v_bfe_u32 v24, v0, 2, 2
    v_lshl_add_u32 v22, v24, 9, v22
    v_bfe_u32 v24, v0, 4, 2
    v_lshl_add_u32 v22, v24, 12, v22
    v_bfe_u32 v24, v0, 7, 1
    v_lshl_add_u32 v22, v24, 8, v22
    s_mov_b32 s49, 0
    s_mov_b32 s48, 32768
    s_lshl_b32 s45, s58, 12
    s_add_u32 s44, s45, 32768
    s_mov_b32 s11, 0x00020000
    s_mov_b32 s15, 0x00020000
    s_mov_b32 s19, 0x00020000
    s_mov_b32 s91, 0x00020000
    s_mov_b32 s90, 0x200000
    v_bfe_u32 v24, v0, 2, 3
    v_lshlrev_b32 v125, 11, v24
    v_and_b32 v24, 3, v0
    v_lshl_add_u32 v125, v24, 7, v125
    s_and_b32 s82, s57, 3
    s_lshr_b32 s85, s57, 2
    s_and_b32 s0, s82, 3
    s_lshl2_add_u32 s0, s85, s0
    s_lshl_b32 s60, s85, 19
    s_mov_b32 s30, s64
    s_and_b32 s31, s65, 0xffff
    s_mov_b32 s32, 0x400000
    s_mov_b32 s33, s60
    s_mov_b32 s34, 0x2000
    s_mov_b32 s35, 0x40000
    s_lshl_b32 s60, s82, 18
    s_mov_b32 s36, s70
    s_and_b32 s37, s71, 0xffff
    s_mov_b32 s38, 0x200000
    s_mov_b32 s39, s60
    s_mov_b32 s40, 0x8000
    s_mov_b32 s41, 0x20000
    s_mov_b32 s42, 0x80
    s_cmp_ge_u32 s58, 2
    s_cselect_b32 s36, s72, s70
    s_cselect_b32 s37, s73, s71
    s_and_b32 s37, s37, 0xffff
    v_bfe_u32 v24, v0, 4, 2
    v_and_b32 v25, 7, v0
    v_xor_b32 v24, v24, v25
    v_lshlrev_b32 v8, 4, v24
    v_bfe_u32 v24, v0, 3, 2
    v_lshl_add_u32 v8, v24, 11, v8
    v_bfe_u32 v24, v0, 5, 1
    v_lshl_add_u32 v8, v24, 16, v8
    v_lshrrev_b32 v24, 6, v0
    v_lshl_add_u32 v8, v24, 14, v8
    v_xor_b32 v9, 64, v8
    v_add_u32 v9, 0x20000, v9
    v_bfe_u32 v24, v0, 4, 2
    v_and_b32 v25, 7, v0
    v_xor_b32 v24, v24, v25
    v_lshlrev_b32 v10, 4, v24
    v_bfe_u32 v24, v0, 3, 3
    v_lshl_add_u32 v10, v24, 11, v10
    v_bfe_u32 v24, v0, 6, 1
    v_lshl_add_u32 v10, v24, 16, v10
    v_xor_b32 v11, 64, v10
    v_add_u32 v11, 0x4000, v11
    v_and_b32 v24, 15, v0
    v_bfe_u32 v25, v0, 7, 1
    v_lshl_add_u32 v24, v25, 6, v24
    v_lshlrev_b32 v24, 1, v24
    s_lshl_b32 s53, s82, 8
    s_mov_b32 s60, s66
    s_and_b32 s61, s67, 0xffff
    s_mov_b32 s62, 0x800
    s_mov_b32 s63, 0x00020000
    buffer_load_ushort v192, v24, s[60:63], s53 offen offset:0
    buffer_load_ushort v200, v24, s[60:63], s53 offen offset:32
    buffer_load_ushort v208, v24, s[60:63], s53 offen offset:64
    buffer_load_ushort v216, v24, s[60:63], s53 offen offset:96
    s_mov_b32 s60, s68
    s_and_b32 s61, s69, 0xffff
    s_mov_b32 s62, 0x800
    s_mov_b32 s63, 0x00020000
    buffer_load_ushort v193, v24, s[60:63], s53 offen offset:0
    buffer_load_ushort v201, v24, s[60:63], s53 offen offset:32
    buffer_load_ushort v209, v24, s[60:63], s53 offen offset:64
    buffer_load_ushort v217, v24, s[60:63], s53 offen offset:96
    s_mov_b32 s60, s78
    s_and_b32 s61, s79, 0xffff
    s_mov_b32 s62, 0x800
    s_mov_b32 s63, 0x00020000
    buffer_load_ushort v194, v24, s[60:63], s53 offen offset:0
    buffer_load_ushort v202, v24, s[60:63], s53 offen offset:32
    buffer_load_ushort v210, v24, s[60:63], s53 offen offset:64
    buffer_load_ushort v218, v24, s[60:63], s53 offen offset:96
    s_mov_b32 s6, 0xfffe8000
    s_mov_b32 s7, 65536
    s_mov_b32 s12, s36
    s_mov_b32 s13, s37
    s_mov_b32 s14, s38
    s_and_b32 s45, s45, 0xffffb7ff
    s_bitcmp1_b32 s0, 3
    s_cselect_b32 s24, s41, 0
    s_cselect_b32 s26, 0, s41
    s_cselect_b32 s60, 0x4000, 0
    s_or_b32 s45, s45, s60
    s_add_u32 s24, s24, s39
    s_add_u32 s26, s26, s39
    s_bitcmp1_b32 s0, 2
    s_cselect_b32 s61, s40, 0
    s_cselect_b32 s62, 0, s40
    s_cselect_b32 s60, 0x800, 0
    s_or_b32 s45, s45, s60
    s_add_u32 s25, s24, s62
    s_add_u32 s24, s24, s61
    s_add_u32 s27, s26, s62
    s_add_u32 s26, s26, s61
    s_mov_b32 s28, s42
    v_mov_b32 v6, v10
    v_mov_b32 v7, v11
    s_mov_b32 s8, s30
    s_mov_b32 s9, s31
    s_mov_b32 s10, s32
    s_and_b32 s44, s44, 0xffffb7ff
    s_bitcmp1_b32 s0, 1
    s_cselect_b32 s20, s35, 0
    s_cselect_b32 s22, 0, s35
    s_cselect_b32 s60, 0x4000, 0
    s_or_b32 s44, s44, s60
    s_add_u32 s20, s20, s33
    s_add_u32 s22, s22, s33
    s_bitcmp1_b32 s0, 0
    s_cselect_b32 s61, s34, 0
    s_cselect_b32 s62, 0, s34
    s_cselect_b32 s60, 0x800, 0
    s_or_b32 s44, s44, s60
    s_add_u32 s21, s20, s62
    s_add_u32 s20, s20, s61
    s_add_u32 s23, s22, s62
    s_add_u32 s22, s22, s61
    v_mov_b32 v4, v8
    v_mov_b32 v5, v9
    s_xor_b32 m0, s45, 0
    s_nop 0
    buffer_load_dwordx4 v6, s[12:15], s24 offen lds
    s_xor_b32 m0, s45, 1024
    s_nop 0
    buffer_load_dwordx4 v7, s[12:15], s24 offen lds
    s_xor_b32 m0, s45, 2048
    s_nop 0
    buffer_load_dwordx4 v6, s[12:15], s25 offen lds
    s_xor_b32 m0, s45, 3072
    s_nop 0
    buffer_load_dwordx4 v7, s[12:15], s25 offen lds
    s_xor_b32 m0, s45, 16384
    s_nop 0
    buffer_load_dwordx4 v6, s[12:15], s26 offen lds
    s_xor_b32 m0, s45, 17408
    s_nop 0
    buffer_load_dwordx4 v7, s[12:15], s26 offen lds
    s_xor_b32 m0, s45, 18432
    s_nop 0
    buffer_load_dwordx4 v6, s[12:15], s27 offen lds
    s_xor_b32 m0, s45, 19456
    s_nop 0
    buffer_load_dwordx4 v7, s[12:15], s27 offen lds
    s_add_u32 s24, s24, s28
    s_add_u32 s25, s25, s28
    s_add_u32 s26, s26, s28
    s_add_u32 s27, s27, s28
    s_cmp_ge_u32 s45, 98304
    s_cselect_b32 s60, s6, s7
    s_add_u32 s45, s45, s60
    s_xor_b32 m0, s44, 0
    s_nop 0
    buffer_load_dwordx4 v4, s[8:11], s20 offen lds
    s_xor_b32 m0, s44, 1024
    s_nop 0
    buffer_load_dwordx4 v5, s[8:11], s20 offen lds
    s_xor_b32 m0, s44, 2048
    s_nop 0
    buffer_load_dwordx4 v4, s[8:11], s21 offen lds
    s_xor_b32 m0, s44, 3072
    s_nop 0
    buffer_load_dwordx4 v5, s[8:11], s21 offen lds
    s_xor_b32 m0, s44, 16384
    s_nop 0
    buffer_load_dwordx4 v4, s[8:11], s22 offen lds
    s_xor_b32 m0, s44, 17408
    s_nop 0
    buffer_load_dwordx4 v5, s[8:11], s22 offen lds
    s_xor_b32 m0, s44, 18432
    s_nop 0
    buffer_load_dwordx4 v4, s[8:11], s23 offen lds
    s_xor_b32 m0, s44, 19456
    s_nop 0
    buffer_load_dwordx4 v5, s[8:11], s23 offen lds
    s_add_u32 s20, s20, 128
    s_add_u32 s21, s21, 128
    s_add_u32 s22, s22, 128
    s_add_u32 s23, s23, 128
    s_cmp_ge_u32 s44, 98304
    s_cselect_b32 s60, s6, s7
    s_add_u32 s44, s44, s60
    s_xor_b32 m0, s45, 0
    s_nop 0
    buffer_load_dwordx4 v6, s[12:15], s24 offen lds
    s_xor_b32 m0, s45, 1024
    s_nop 0
    buffer_load_dwordx4 v7, s[12:15], s24 offen lds
    s_xor_b32 m0, s45, 2048
    s_nop 0
    buffer_load_dwordx4 v6, s[12:15], s25 offen lds
    s_xor_b32 m0, s45, 3072
    s_nop 0
    buffer_load_dwordx4 v7, s[12:15], s25 offen lds
    s_xor_b32 m0, s45, 16384
    s_nop 0
    buffer_load_dwordx4 v6, s[12:15], s26 offen lds
    s_xor_b32 m0, s45, 17408
    s_nop 0
    buffer_load_dwordx4 v7, s[12:15], s26 offen lds
    s_xor_b32 m0, s45, 18432
    s_nop 0
    buffer_load_dwordx4 v6, s[12:15], s27 offen lds
    s_xor_b32 m0, s45, 19456
    s_nop 0
    buffer_load_dwordx4 v7, s[12:15], s27 offen lds
    s_add_u32 s24, s24, s28
    s_add_u32 s25, s25, s28
    s_add_u32 s26, s26, s28
    s_add_u32 s27, s27, s28
    s_cmp_ge_u32 s45, 98304
    s_cselect_b32 s60, s6, s7
    s_add_u32 s45, s45, s60
    s_add_u32 s39, s39, 0x100000
    s_mov_b32 s16, s100
    s_and_b32 s17, s101, 0xffff
    s_mov_b32 s18, 0x0
    s_mov_b32 s19, 0x00020000
    s_lshr_b32 s60, s85, 2
    s_lshl_b32 s60, s60, 21
    s_add_u32 s86, s64, s60
    s_addc_u32 s87, s65, 0
    s_and_b32 s60, s57, 15
    s_lshl1_add_u32 s60, s60, s58
    s_lshl_b32 s84, s60, 16
    s_bitcmp1_b32 s85, 0
    s_cselect_b64 s[62:63], s[72:73], s[70:71]
    s_lshr_b32 s60, s85, 1
    s_lshl2_add_u32 s60, s82, s60
    s_add_u32 s60, s60, 0
    s_lshl_b32 s60, s60, 16
    s_cmp_eq_u32 s58, 2
    s_cselect_b64 s[86:87], s[62:63], s[86:87]
    s_cselect_b32 s84, s60, s84
    s_cmp_eq_u32 s58, 3
    s_cselect_b32 s84, 0x40000000, s84
    s_and_b32 s87, s87, 0xffff
    s_mov_b64 s[88:89], s[86:87]
    s_add_u32 s83, s84, 512
    s_lshr_b32 s60, s85, 2
    s_lshl_b32 s60, s60, 21
    s_add_u32 s86, s64, s60
    s_addc_u32 s87, s65, 0
    s_and_b32 s60, s57, 15
    s_lshl1_add_u32 s60, s60, s58
    s_lshl_b32 s84, s60, 16
    s_bitcmp1_b32 s85, 0
    s_cselect_b64 s[62:63], s[72:73], s[70:71]
    s_lshr_b32 s60, s85, 1
    s_lshl2_add_u32 s60, s82, s60
    s_add_u32 s60, s60, 16
    s_lshl_b32 s60, s60, 16
    s_cmp_eq_u32 s58, 2
    s_cselect_b64 s[86:87], s[62:63], s[86:87]
    s_cselect_b32 s84, s60, s84
    s_cmp_eq_u32 s58, 3
    s_cselect_b32 s84, 0x40000000, s84
    s_and_b32 s87, s87, 0xffff
    s_waitcnt vmcnt(24)
    v_lshlrev_b32 v192, 16, v192
    v_lshlrev_b32 v200, 16, v200
    v_lshlrev_b32 v208, 16, v208
    v_lshlrev_b32 v216, 16, v216
    v_lshlrev_b32 v193, 16, v193
    v_lshlrev_b32 v201, 16, v201
    v_lshlrev_b32 v209, 16, v209
    v_lshlrev_b32 v217, 16, v217
    v_lshlrev_b32 v194, 16, v194
    v_lshlrev_b32 v202, 16, v202
    v_lshlrev_b32 v210, 16, v210
    v_lshlrev_b32 v218, 16, v218
    v_mul_f32 v194, 0x3fb8aa3b, v194
    v_mul_f32 v202, 0x3fb8aa3b, v202
    v_mul_f32 v210, 0x3fb8aa3b, v210
    v_mul_f32 v218, 0x3fb8aa3b, v218
    v_exp_f32 v194, v194
    v_exp_f32 v202, v202
    v_exp_f32 v210, v210
    v_exp_f32 v218, v218
    v_cvt_pk_bf16_f32 v194, 0, v194
    v_cvt_pk_bf16_f32 v202, 0, v202
    v_cvt_pk_bf16_f32 v210, 0, v210
    v_cvt_pk_bf16_f32 v218, 0, v218
    v_mul_f32 v195, v194, v192
    v_mul_f32 v203, v202, v200
    v_mul_f32 v211, v210, v208
    v_mul_f32 v219, v218, v216
    v_mul_f32 v196, v194, v193
    v_mul_f32 v204, v202, v201
    v_mul_f32 v212, v210, v209
    v_mul_f32 v220, v218, v217
    v_mul_f32 v195, 0x3fb8aa3b, v195
    v_mul_f32 v203, 0x3fb8aa3b, v203
    v_mul_f32 v211, 0x3fb8aa3b, v211
    v_mul_f32 v219, 0x3fb8aa3b, v219
    v_exp_f32 v195, v195
    v_exp_f32 v203, v203
    v_exp_f32 v211, v211
    v_exp_f32 v219, v219
    v_mul_f32 v196, 0x3e22f983, v196
    v_mul_f32 v204, 0x3e22f983, v204
    v_mul_f32 v212, 0x3e22f983, v212
    v_mul_f32 v220, 0x3e22f983, v220
    v_fract_f32 v196, v196
    v_fract_f32 v204, v204
    v_fract_f32 v212, v212
    v_fract_f32 v220, v220
    v_cos_f32 v197, v196
    v_cos_f32 v205, v204
    v_cos_f32 v213, v212
    v_cos_f32 v221, v220
    v_sin_f32 v198, v196
    v_sin_f32 v206, v204
    v_sin_f32 v214, v212
    v_sin_f32 v222, v220
    v_mul_f32 v88, v195, v197
    v_mul_f32 v90, v203, v205
    v_mul_f32 v92, v211, v213
    v_mul_f32 v94, v219, v221
    v_mul_f32 v89, v195, v198
    v_mul_f32 v91, v203, v206
    v_mul_f32 v93, v211, v214
    v_mul_f32 v95, v219, v222
    v_add_f32 v197, -1.0, v88
    v_add_f32 v205, -1.0, v90
    v_add_f32 v213, -1.0, v92
    v_add_f32 v221, -1.0, v94
    v_mul_f32 v198, v197, v192
    v_mul_f32 v206, v205, v200
    v_mul_f32 v214, v213, v208
    v_mul_f32 v222, v221, v216
    v_fma_f32 v198, v89, v193, v198
    v_fma_f32 v206, v91, v201, v206
    v_fma_f32 v214, v93, v209, v214
    v_fma_f32 v222, v95, v217, v222
    v_mul_f32 v199, v89, v192
    v_mul_f32 v207, v91, v200
    v_mul_f32 v215, v93, v208
    v_mul_f32 v223, v95, v216
    v_fma_f32 v199, -v197, v193, v199
    v_fma_f32 v207, -v205, v201, v207
    v_fma_f32 v215, -v213, v209, v215
    v_fma_f32 v223, -v221, v217, v223
    v_mul_f32 v195, v192, v192
    v_mul_f32 v203, v200, v200
    v_mul_f32 v211, v208, v208
    v_mul_f32 v219, v216, v216
    v_fma_f32 v195, v193, v193, v195
    v_fma_f32 v203, v201, v201, v203
    v_fma_f32 v211, v209, v209, v211
    v_fma_f32 v219, v217, v217, v219
    v_rcp_f32 v195, v195
    v_rcp_f32 v203, v203
    v_rcp_f32 v211, v211
    v_rcp_f32 v219, v219
    v_add_f32 v195, v195, v195
    v_add_f32 v203, v203, v203
    v_add_f32 v211, v211, v211
    v_add_f32 v219, v219, v219
    v_mul_f32 v96, v198, v195
    v_mul_f32 v98, v206, v203
    v_mul_f32 v100, v214, v211
    v_mul_f32 v102, v222, v219
    v_mul_f32 v97, v199, v195
    v_mul_f32 v99, v207, v203
    v_mul_f32 v101, v215, v211
    v_mul_f32 v103, v223, v219
    v_pk_mul_f32 v[192:193], v[88:89], v[88:89] op_sel:[0,0] op_sel_hi:[0,1]
    v_pk_mul_f32 v[200:201], v[90:91], v[90:91] op_sel:[0,0] op_sel_hi:[0,1]
    v_pk_mul_f32 v[208:209], v[92:93], v[92:93] op_sel:[0,0] op_sel_hi:[0,1]
    v_pk_mul_f32 v[216:217], v[94:95], v[94:95] op_sel:[0,0] op_sel_hi:[0,1]
    v_pk_fma_f32 v[104:105], v[88:89], v[88:89], v[192:193] op_sel:[1,1,0] op_sel_hi:[1,0,1] neg_lo:[1,0,0]
    v_pk_fma_f32 v[106:107], v[90:91], v[90:91], v[200:201] op_sel:[1,1,0] op_sel_hi:[1,0,1] neg_lo:[1,0,0]
    v_pk_fma_f32 v[108:109], v[92:93], v[92:93], v[208:209] op_sel:[1,1,0] op_sel_hi:[1,0,1] neg_lo:[1,0,0]
    v_pk_fma_f32 v[110:111], v[94:95], v[94:95], v[216:217] op_sel:[1,1,0] op_sel_hi:[1,0,1] neg_lo:[1,0,0]
    v_pk_mul_f32 v[192:193], v[104:105], v[104:105] op_sel:[0,0] op_sel_hi:[0,1]
    v_pk_mul_f32 v[200:201], v[106:107], v[106:107] op_sel:[0,0] op_sel_hi:[0,1]
    v_pk_mul_f32 v[208:209], v[108:109], v[108:109] op_sel:[0,0] op_sel_hi:[0,1]
    v_pk_mul_f32 v[216:217], v[110:111], v[110:111] op_sel:[0,0] op_sel_hi:[0,1]
    v_pk_fma_f32 v[104:105], v[104:105], v[104:105], v[192:193] op_sel:[1,1,0] op_sel_hi:[1,0,1] neg_lo:[1,0,0]
    v_pk_fma_f32 v[106:107], v[106:107], v[106:107], v[200:201] op_sel:[1,1,0] op_sel_hi:[1,0,1] neg_lo:[1,0,0]
    v_pk_fma_f32 v[108:109], v[108:109], v[108:109], v[208:209] op_sel:[1,1,0] op_sel_hi:[1,0,1] neg_lo:[1,0,0]
    v_pk_fma_f32 v[110:111], v[110:111], v[110:111], v[216:217] op_sel:[1,1,0] op_sel_hi:[1,0,1] neg_lo:[1,0,0]
    v_pk_mul_f32 v[192:193], v[104:105], v[104:105] op_sel:[0,0] op_sel_hi:[0,1]
    v_pk_mul_f32 v[200:201], v[106:107], v[106:107] op_sel:[0,0] op_sel_hi:[0,1]
    v_pk_mul_f32 v[208:209], v[108:109], v[108:109] op_sel:[0,0] op_sel_hi:[0,1]
    v_pk_mul_f32 v[216:217], v[110:111], v[110:111] op_sel:[0,0] op_sel_hi:[0,1]
    v_pk_fma_f32 v[104:105], v[104:105], v[104:105], v[192:193] op_sel:[1,1,0] op_sel_hi:[1,0,1] neg_lo:[1,0,0]
    v_pk_fma_f32 v[106:107], v[106:107], v[106:107], v[200:201] op_sel:[1,1,0] op_sel_hi:[1,0,1] neg_lo:[1,0,0]
    v_pk_fma_f32 v[108:109], v[108:109], v[108:109], v[208:209] op_sel:[1,1,0] op_sel_hi:[1,0,1] neg_lo:[1,0,0]
    v_pk_fma_f32 v[110:111], v[110:111], v[110:111], v[216:217] op_sel:[1,1,0] op_sel_hi:[1,0,1] neg_lo:[1,0,0]
    v_pk_mul_f32 v[192:193], v[104:105], v[104:105] op_sel:[0,0] op_sel_hi:[0,1]
    v_pk_mul_f32 v[200:201], v[106:107], v[106:107] op_sel:[0,0] op_sel_hi:[0,1]
    v_pk_mul_f32 v[208:209], v[108:109], v[108:109] op_sel:[0,0] op_sel_hi:[0,1]
    v_pk_mul_f32 v[216:217], v[110:111], v[110:111] op_sel:[0,0] op_sel_hi:[0,1]
    v_pk_fma_f32 v[104:105], v[104:105], v[104:105], v[192:193] op_sel:[1,1,0] op_sel_hi:[1,0,1] neg_lo:[1,0,0]
    v_pk_fma_f32 v[106:107], v[106:107], v[106:107], v[200:201] op_sel:[1,1,0] op_sel_hi:[1,0,1] neg_lo:[1,0,0]
    v_pk_fma_f32 v[108:109], v[108:109], v[108:109], v[208:209] op_sel:[1,1,0] op_sel_hi:[1,0,1] neg_lo:[1,0,0]
    v_pk_fma_f32 v[110:111], v[110:111], v[110:111], v[216:217] op_sel:[1,1,0] op_sel_hi:[1,0,1] neg_lo:[1,0,0]
    v_pk_mul_f32 v[192:193], v[104:105], v[104:105] op_sel:[0,0] op_sel_hi:[0,1]
    v_pk_mul_f32 v[200:201], v[106:107], v[106:107] op_sel:[0,0] op_sel_hi:[0,1]
    v_pk_mul_f32 v[208:209], v[108:109], v[108:109] op_sel:[0,0] op_sel_hi:[0,1]
    v_pk_mul_f32 v[216:217], v[110:111], v[110:111] op_sel:[0,0] op_sel_hi:[0,1]
    v_pk_fma_f32 v[104:105], v[104:105], v[104:105], v[192:193] op_sel:[1,1,0] op_sel_hi:[1,0,1] neg_lo:[1,0,0]
    v_pk_fma_f32 v[106:107], v[106:107], v[106:107], v[200:201] op_sel:[1,1,0] op_sel_hi:[1,0,1] neg_lo:[1,0,0]
    v_pk_fma_f32 v[108:109], v[108:109], v[108:109], v[208:209] op_sel:[1,1,0] op_sel_hi:[1,0,1] neg_lo:[1,0,0]
    v_pk_fma_f32 v[110:111], v[110:111], v[110:111], v[216:217] op_sel:[1,1,0] op_sel_hi:[1,0,1] neg_lo:[1,0,0]
    v_pk_mul_f32 v[192:193], v[104:105], v[104:105] op_sel:[0,0] op_sel_hi:[0,1]
    v_pk_mul_f32 v[200:201], v[106:107], v[106:107] op_sel:[0,0] op_sel_hi:[0,1]
    v_pk_mul_f32 v[208:209], v[108:109], v[108:109] op_sel:[0,0] op_sel_hi:[0,1]
    v_pk_mul_f32 v[216:217], v[110:111], v[110:111] op_sel:[0,0] op_sel_hi:[0,1]
    v_pk_fma_f32 v[112:113], v[104:105], v[104:105], v[192:193] op_sel:[1,1,0] op_sel_hi:[1,0,1] neg_lo:[1,0,0]
    v_pk_fma_f32 v[114:115], v[106:107], v[106:107], v[200:201] op_sel:[1,1,0] op_sel_hi:[1,0,1] neg_lo:[1,0,0]
    v_pk_fma_f32 v[116:117], v[108:109], v[108:109], v[208:209] op_sel:[1,1,0] op_sel_hi:[1,0,1] neg_lo:[1,0,0]
    v_pk_fma_f32 v[118:119], v[110:111], v[110:111], v[216:217] op_sel:[1,1,0] op_sel_hi:[1,0,1] neg_lo:[1,0,0]
    v_pk_mul_f32 v[192:193], v[112:113], v[112:113] op_sel:[0,0] op_sel_hi:[0,1]
    v_pk_mul_f32 v[200:201], v[114:115], v[114:115] op_sel:[0,0] op_sel_hi:[0,1]
    v_pk_mul_f32 v[208:209], v[116:117], v[116:117] op_sel:[0,0] op_sel_hi:[0,1]
    v_pk_mul_f32 v[216:217], v[118:119], v[118:119] op_sel:[0,0] op_sel_hi:[0,1]
    v_pk_fma_f32 v[196:197], v[112:113], v[112:113], v[192:193] op_sel:[1,1,0] op_sel_hi:[1,0,1] neg_lo:[1,0,0]
    v_pk_fma_f32 v[204:205], v[114:115], v[114:115], v[200:201] op_sel:[1,1,0] op_sel_hi:[1,0,1] neg_lo:[1,0,0]
    v_pk_fma_f32 v[212:213], v[116:117], v[116:117], v[208:209] op_sel:[1,1,0] op_sel_hi:[1,0,1] neg_lo:[1,0,0]
    v_pk_fma_f32 v[220:221], v[118:119], v[118:119], v[216:217] op_sel:[1,1,0] op_sel_hi:[1,0,1] neg_lo:[1,0,0]
    s_mov_b32 exec_lo, 0xffffffff
    s_mov_b32 exec_hi, 0xffffffff
    v_mov_b32 v120, v196
    v_mov_b32 v121, v197
    s_mov_b32 exec_lo, 0xffff0000
    s_mov_b32 exec_hi, 0xffffffff
    v_mov_b32 v120, v204
    v_mov_b32 v121, v205
    s_mov_b32 exec_lo, 0x0
    s_mov_b32 exec_hi, 0xffffffff
    v_mov_b32 v120, v212
    v_mov_b32 v121, v213
    s_mov_b32 exec_lo, 0x0
    s_mov_b32 exec_hi, 0xffff0000
    v_mov_b32 v120, v220
    v_mov_b32 v121, v221
    s_mov_b64 exec, -1
    s_mov_b32 s1, 0
    s_mov_b32 s4, 0
    s_mov_b32 s3, 0
    s_mov_b32 s50, 0
    s_mov_b32 s5, 0
    s_mov_b32 s51, 0
    s_mov_b32 s52, 0
    s_waitcnt vmcnt(8)
    s_barrier
    s_call_b64 s[54:55], t_g1
    v_mov_b32 v24, 4
    global_load_dword v123, v24, s[98:99] sc1
    s_or_b32 s60, s2, s58
    s_cbranch_scc1 L_rw_76
    s_lshl_b32 s62, s56, 3
    s_add_u32 s62, s62, 160
    s_mov_b32 s63, 0
L_rp_77:
    s_load_dwordx2 s[60:61], s[98:99], s62 glc
    s_add_u32 s63, s63, 1
    s_cmp_gt_u32 s63, 0x100000
    s_cbranch_scc1 chain_kernel_wabort
    s_waitcnt lgkmcnt(0)
    s_cmp_lt_u32 s61, 0x2000
    s_cbranch_scc1 L_rp_77
    s_lshr_b32 s61, s95, 8
    s_cmp_eq_u32 s60, -1
    s_cselect_b32 s94, -1, s61
L_rw_76:
    s_cmp_lg_u32 s2, 0
    s_cbranch_scc1 L_rok_78
    v_mov_b32 v24, 0
    s_cmp_lg_u32 s58, 0
    s_cbranch_scc1 L_rw_79
    v_mov_b32 v25, s94
    ds_write_b32 v24, v25
    s_waitcnt lgkmcnt(0)
L_rw_79:
    s_barrier
    ds_read_b32 v25, v24
    s_waitcnt lgkmcnt(0)
    v_readfirstlane_b32 s60, v25
    s_mov_b32 s2, 1
    s_cmp_eq_u32 s60, -1
    s_cbranch_scc1 L_rok_78
    s_mov_b32 s57, s60
    s_waitcnt vmcnt(0)
    s_barrier
    s_cmp_ge_u32 s57, 32
    s_cbranch_scc1 chain_kernel_end
    s_branch L_big_37
L_rok_78:
    s_waitcnt vmcnt(0)
    s_mov_b32 s62, 0
L_pp_80:
    v_readfirstlane_b32 s59, v123
    s_and_b32 s60, s59, 0xff
    s_cmp_ge_u32 s60, 15
    s_cbranch_scc1 L_pok_81
    v_mov_b32 v24, 4
    global_load_dword v123, v24, s[98:99] sc1
    s_add_u32 s62, s62, 1
    s_cmp_gt_u32 s62, 0x200000
    s_cbranch_scc1 chain_kernel_wabort
    s_waitcnt vmcnt(0)
    s_branch L_pp_80
L_pok_81:
    s_cmp_ge_u32 s59, 0x800
    s_cselect_b32 s59, 0x2000, 0
    s_call_b64 s[54:55], t_scan
    s_add_u32 s82, s82, 4
    v_and_b32 v24, 15, v0
    v_bfe_u32 v25, v0, 7, 1
    v_lshl_add_u32 v24, v25, 6, v24
    v_lshlrev_b32 v24, 1, v24
    s_lshl_b32 s53, s82, 8
    s_mov_b32 s60, s66
    s_and_b32 s61, s67, 0xffff
    s_mov_b32 s62, 0x800
    s_mov_b32 s63, 0x00020000
    buffer_load_ushort v40, v24, s[60:63], s53 offen offset:0
    buffer_load_ushort v48, v24, s[60:63], s53 offen offset:32
    buffer_load_ushort v56, v24, s[60:63], s53 offen offset:64
    buffer_load_ushort v64, v24, s[60:63], s53 offen offset:96
    s_mov_b32 s60, s68
    s_and_b32 s61, s69, 0xffff
    s_mov_b32 s62, 0x800
    s_mov_b32 s63, 0x00020000
    buffer_load_ushort v41, v24, s[60:63], s53 offen offset:0
    buffer_load_ushort v49, v24, s[60:63], s53 offen offset:32
    buffer_load_ushort v57, v24, s[60:63], s53 offen offset:64
    buffer_load_ushort v65, v24, s[60:63], s53 offen offset:96
    s_mov_b32 s60, s78
    s_and_b32 s61, s79, 0xffff
    s_mov_b32 s62, 0x800
    s_mov_b32 s63, 0x00020000
    buffer_load_ushort v42, v24, s[60:63], s53 offen offset:0
    buffer_load_ushort v50, v24, s[60:63], s53 offen offset:32
    buffer_load_ushort v58, v24, s[60:63], s53 offen offset:64
    buffer_load_ushort v66, v24, s[60:63], s53 offen offset:96
    s_and_b32 s62, s57, 7
    s_lshr_b32 s63, s57, 3
    s_lshl_b32 s60, s63, 19
    s_add_u32 s60, s60, 0
    s_mov_b32 s30, s74
    s_and_b32 s31, s75, 0xffff
    s_mov_b32 s32, 0x200000
    s_mov_b32 s33, s60
    s_mov_b32 s34, 0x8000
    s_mov_b32 s35, 0x40000
    s_lshl_b32 s61, s62, 13
    s_andn2_b32 s61, 0x2000, s61
    s_xor_b32 s61, s61, s59
    s_lshl_b32 s60, s62, 21
    s_add_u32 s60, s60, s61
    s_add_u32 s60, s60, 0x0
    s_add_u32 s36, s100, 0xc000000
    s_addc_u32 s37, s101, 0
    s_and_b32 s37, s37, 0xffff
    s_mov_b32 s38, 0x1000000
    s_mov_b32 s39, s60
    s_mov_b32 s40, 0x800
    s_mov_b32 s41, 0x8000
    s_mov_b32 s42, 0x10000
    s_and_b32 s0, s62, 3
    s_lshl2_add_u32 s0, s63, s0
    s_mov_b64 s[86:87], s[30:31]
    s_lshl_b32 s62, s62, 16
    s_add_u32 s84, s33, s62
    s_cmp_eq_u32 s58, 0
    s_cselect_b32 s84, s84, 0x40000000
    v_bfe_u32 v24, v0, 4, 2
    v_and_b32 v25, 7, v0
    v_xor_b32 v24, v24, v25
    v_lshlrev_b32 v8, 4, v24
    v_bfe_u32 v24, v0, 3, 3
    v_lshl_add_u32 v8, v24, 11, v8
    v_bfe_u32 v24, v0, 6, 2
    v_lshl_add_u32 v8, v24, 16, v8
    v_xor_b32 v9, 64, v8
    v_add_u32 v9, 0x4000, v9
    s_lshr_b32 s61, s58, 1
    s_lshl_b32 s61, s61, 14
    v_add_u32 v10, s61, v1
    s_and_b32 s61, s58, 1
    s_lshl_b32 s61, s61, 12
    v_add_u32 v10, s61, v10
    v_add_u32 v11, 1024, v10
    s_mov_b32 s18, 0xe000000
    s_mov_b32 s4, 12
    s_mov_b32 s3, 12
    s_waitcnt vmcnt(0)
    v_lshlrev_b32 v40, 16, v40
    v_lshlrev_b32 v48, 16, v48
    v_lshlrev_b32 v56, 16, v56
    v_lshlrev_b32 v64, 16, v64
    v_lshlrev_b32 v41, 16, v41
    v_lshlrev_b32 v49, 16, v49
    v_lshlrev_b32 v57, 16, v57
    v_lshlrev_b32 v65, 16, v65
    v_lshlrev_b32 v42, 16, v42
    v_lshlrev_b32 v50, 16, v50
    v_lshlrev_b32 v58, 16, v58
    v_lshlrev_b32 v66, 16, v66
    v_mul_f32 v42, 0x3fb8aa3b, v42
    v_mul_f32 v50, 0x3fb8aa3b, v50
    v_mul_f32 v58, 0x3fb8aa3b, v58
    v_mul_f32 v66, 0x3fb8aa3b, v66
    v_exp_f32 v42, v42
    v_exp_f32 v50, v50
    v_exp_f32 v58, v58
    v_exp_f32 v66, v66
    v_cvt_pk_bf16_f32 v42, 0, v42
    v_cvt_pk_bf16_f32 v50, 0, v50
    v_cvt_pk_bf16_f32 v58, 0, v58
    v_cvt_pk_bf16_f32 v66, 0, v66
    v_mul_f32 v43, v42, v40
    v_mul_f32 v51, v50, v48
    v_mul_f32 v59, v58, v56
    v_mul_f32 v67, v66, v64
    v_mul_f32 v44, v42, v41
    v_mul_f32 v52, v50, v49
    v_mul_f32 v60, v58, v57
    v_mul_f32 v68, v66, v65
    v_mul_f32 v43, 0x3fb8aa3b, v43
    v_mul_f32 v51, 0x3fb8aa3b, v51
    v_mul_f32 v59, 0x3fb8aa3b, v59
    v_mul_f32 v67, 0x3fb8aa3b, v67
    v_exp_f32 v43, v43
    v_exp_f32 v51, v51
    v_exp_f32 v59, v59
    v_exp_f32 v67, v67
    v_mul_f32 v44, 0x3e22f983, v44
    v_mul_f32 v52, 0x3e22f983, v52
    v_mul_f32 v60, 0x3e22f983, v60
    v_mul_f32 v68, 0x3e22f983, v68
    v_fract_f32 v44, v44
    v_fract_f32 v52, v52
    v_fract_f32 v60, v60
    v_fract_f32 v68, v68
    v_cos_f32 v45, v44
    v_cos_f32 v53, v52
    v_cos_f32 v61, v60
    v_cos_f32 v69, v68
    v_sin_f32 v46, v44
    v_sin_f32 v54, v52
    v_sin_f32 v62, v60
    v_sin_f32 v70, v68
    v_mul_f32 v88, v43, v45
    v_mul_f32 v90, v51, v53
    v_mul_f32 v92, v59, v61
    v_mul_f32 v94, v67, v69
    v_mul_f32 v89, v43, v46
    v_mul_f32 v91, v51, v54
    v_mul_f32 v93, v59, v62
    v_mul_f32 v95, v67, v70
    v_add_f32 v45, -1.0, v88
    v_add_f32 v53, -1.0, v90
    v_add_f32 v61, -1.0, v92
    v_add_f32 v69, -1.0, v94
    v_mul_f32 v46, v45, v40
    v_mul_f32 v54, v53, v48
    v_mul_f32 v62, v61, v56
    v_mul_f32 v70, v69, v64
    v_fma_f32 v46, v89, v41, v46
    v_fma_f32 v54, v91, v49, v54
    v_fma_f32 v62, v93, v57, v62
    v_fma_f32 v70, v95, v65, v70
    v_mul_f32 v47, v89, v40
    v_mul_f32 v55, v91, v48
    v_mul_f32 v63, v93, v56
    v_mul_f32 v71, v95, v64
    v_fma_f32 v47, -v45, v41, v47
    v_fma_f32 v55, -v53, v49, v55
    v_fma_f32 v63, -v61, v57, v63
    v_fma_f32 v71, -v69, v65, v71
    v_mul_f32 v43, v40, v40
    v_mul_f32 v51, v48, v48
    v_mul_f32 v59, v56, v56
    v_mul_f32 v67, v64, v64
    v_fma_f32 v43, v41, v41, v43
    v_fma_f32 v51, v49, v49, v51
    v_fma_f32 v59, v57, v57, v59
    v_fma_f32 v67, v65, v65, v67
    v_rcp_f32 v43, v43
    v_rcp_f32 v51, v51
    v_rcp_f32 v59, v59
    v_rcp_f32 v67, v67
    v_add_f32 v43, v43, v43
    v_add_f32 v51, v51, v51
    v_add_f32 v59, v59, v59
    v_add_f32 v67, v67, v67
    v_mul_f32 v96, v46, v43
    v_mul_f32 v98, v54, v51
    v_mul_f32 v100, v62, v59
    v_mul_f32 v102, v70, v67
    v_mul_f32 v97, v47, v43
    v_mul_f32 v99, v55, v51
    v_mul_f32 v101, v63, v59
    v_mul_f32 v103, v71, v67
    v_pk_mul_f32 v[40:41], v[88:89], v[88:89] op_sel:[0,0] op_sel_hi:[0,1]
    v_pk_mul_f32 v[48:49], v[90:91], v[90:91] op_sel:[0,0] op_sel_hi:[0,1]
    v_pk_mul_f32 v[56:57], v[92:93], v[92:93] op_sel:[0,0] op_sel_hi:[0,1]
    v_pk_mul_f32 v[64:65], v[94:95], v[94:95] op_sel:[0,0] op_sel_hi:[0,1]
    v_pk_fma_f32 v[104:105], v[88:89], v[88:89], v[40:41] op_sel:[1,1,0] op_sel_hi:[1,0,1] neg_lo:[1,0,0]
    v_pk_fma_f32 v[106:107], v[90:91], v[90:91], v[48:49] op_sel:[1,1,0] op_sel_hi:[1,0,1] neg_lo:[1,0,0]
    v_pk_fma_f32 v[108:109], v[92:93], v[92:93], v[56:57] op_sel:[1,1,0] op_sel_hi:[1,0,1] neg_lo:[1,0,0]
    v_pk_fma_f32 v[110:111], v[94:95], v[94:95], v[64:65] op_sel:[1,1,0] op_sel_hi:[1,0,1] neg_lo:[1,0,0]
    v_pk_mul_f32 v[40:41], v[104:105], v[104:105] op_sel:[0,0] op_sel_hi:[0,1]
    v_pk_mul_f32 v[48:49], v[106:107], v[106:107] op_sel:[0,0] op_sel_hi:[0,1]
    v_pk_mul_f32 v[56:57], v[108:109], v[108:109] op_sel:[0,0] op_sel_hi:[0,1]
    v_pk_mul_f32 v[64:65], v[110:111], v[110:111] op_sel:[0,0] op_sel_hi:[0,1]
    v_pk_fma_f32 v[104:105], v[104:105], v[104:105], v[40:41] op_sel:[1,1,0] op_sel_hi:[1,0,1] neg_lo:[1,0,0]
    v_pk_fma_f32 v[106:107], v[106:107], v[106:107], v[48:49] op_sel:[1,1,0] op_sel_hi:[1,0,1] neg_lo:[1,0,0]
    v_pk_fma_f32 v[108:109], v[108:109], v[108:109], v[56:57] op_sel:[1,1,0] op_sel_hi:[1,0,1] neg_lo:[1,0,0]
    v_pk_fma_f32 v[110:111], v[110:111], v[110:111], v[64:65] op_sel:[1,1,0] op_sel_hi:[1,0,1] neg_lo:[1,0,0]
    v_pk_mul_f32 v[40:41], v[104:105], v[104:105] op_sel:[0,0] op_sel_hi:[0,1]
    v_pk_mul_f32 v[48:49], v[106:107], v[106:107] op_sel:[0,0] op_sel_hi:[0,1]
    v_pk_mul_f32 v[56:57], v[108:109], v[108:109] op_sel:[0,0] op_sel_hi:[0,1]
    v_pk_mul_f32 v[64:65], v[110:111], v[110:111] op_sel:[0,0] op_sel_hi:[0,1]
    v_pk_fma_f32 v[104:105], v[104:105], v[104:105], v[40:41] op_sel:[1,1,0] op_sel_hi:[1,0,1] neg_lo:[1,0,0]
    v_pk_fma_f32 v[106:107], v[106:107], v[106:107], v[48:49] op_sel:[1,1,0] op_sel_hi:[1,0,1] neg_lo:[1,0,0]
    v_pk_fma_f32 v[108:109], v[108:109], v[108:109], v[56:57] op_sel:[1,1,0] op_sel_hi:[1,0,1] neg_lo:[1,0,0]
    v_pk_fma_f32 v[110:111], v[110:111], v[110:111], v[64:65] op_sel:[1,1,0] op_sel_hi:[1,0,1] neg_lo:[1,0,0]
    v_pk_mul_f32 v[40:41], v[104:105], v[104:105] op_sel:[0,0] op_sel_hi:[0,1]
    v_pk_mul_f32 v[48:49], v[106:107], v[106:107] op_sel:[0,0] op_sel_hi:[0,1]
    v_pk_mul_f32 v[56:57], v[108:109], v[108:109] op_sel:[0,0] op_sel_hi:[0,1]
    v_pk_mul_f32 v[64:65], v[110:111], v[110:111] op_sel:[0,0] op_sel_hi:[0,1]
    v_pk_fma_f32 v[104:105], v[104:105], v[104:105], v[40:41] op_sel:[1,1,0] op_sel_hi:[1,0,1] neg_lo:[1,0,0]
    v_pk_fma_f32 v[106:107], v[106:107], v[106:107], v[48:49] op_sel:[1,1,0] op_sel_hi:[1,0,1] neg_lo:[1,0,0]
    v_pk_fma_f32 v[108:109], v[108:109], v[108:109], v[56:57] op_sel:[1,1,0] op_sel_hi:[1,0,1] neg_lo:[1,0,0]
    v_pk_fma_f32 v[110:111], v[110:111], v[110:111], v[64:65] op_sel:[1,1,0] op_sel_hi:[1,0,1] neg_lo:[1,0,0]
    v_pk_mul_f32 v[40:41], v[104:105], v[104:105] op_sel:[0,0] op_sel_hi:[0,1]
    v_pk_mul_f32 v[48:49], v[106:107], v[106:107] op_sel:[0,0] op_sel_hi:[0,1]
    v_pk_mul_f32 v[56:57], v[108:109], v[108:109] op_sel:[0,0] op_sel_hi:[0,1]
    v_pk_mul_f32 v[64:65], v[110:111], v[110:111] op_sel:[0,0] op_sel_hi:[0,1]
    v_pk_fma_f32 v[104:105], v[104:105], v[104:105], v[40:41] op_sel:[1,1,0] op_sel_hi:[1,0,1] neg_lo:[1,0,0]
    v_pk_fma_f32 v[106:107], v[106:107], v[106:107], v[48:49] op_sel:[1,1,0] op_sel_hi:[1,0,1] neg_lo:[1,0,0]
    v_pk_fma_f32 v[108:109], v[108:109], v[108:109], v[56:57] op_sel:[1,1,0] op_sel_hi:[1,0,1] neg_lo:[1,0,0]
    v_pk_fma_f32 v[110:111], v[110:111], v[110:111], v[64:65] op_sel:[1,1,0] op_sel_hi:[1,0,1] neg_lo:[1,0,0]
    v_pk_mul_f32 v[40:41], v[104:105], v[104:105] op_sel:[0,0] op_sel_hi:[0,1]
    v_pk_mul_f32 v[48:49], v[106:107], v[106:107] op_sel:[0,0] op_sel_hi:[0,1]
    v_pk_mul_f32 v[56:57], v[108:109], v[108:109] op_sel:[0,0] op_sel_hi:[0,1]
    v_pk_mul_f32 v[64:65], v[110:111], v[110:111] op_sel:[0,0] op_sel_hi:[0,1]
    v_pk_fma_f32 v[112:113], v[104:105], v[104:105], v[40:41] op_sel:[1,1,0] op_sel_hi:[1,0,1] neg_lo:[1,0,0]
    v_pk_fma_f32 v[114:115], v[106:107], v[106:107], v[48:49] op_sel:[1,1,0] op_sel_hi:[1,0,1] neg_lo:[1,0,0]
    v_pk_fma_f32 v[116:117], v[108:109], v[108:109], v[56:57] op_sel:[1,1,0] op_sel_hi:[1,0,1] neg_lo:[1,0,0]
    v_pk_fma_f32 v[118:119], v[110:111], v[110:111], v[64:65] op_sel:[1,1,0] op_sel_hi:[1,0,1] neg_lo:[1,0,0]
    v_pk_mul_f32 v[40:41], v[112:113], v[112:113] op_sel:[0,0] op_sel_hi:[0,1]
    v_pk_mul_f32 v[48:49], v[114:115], v[114:115] op_sel:[0,0] op_sel_hi:[0,1]
    v_pk_mul_f32 v[56:57], v[116:117], v[116:117] op_sel:[0,0] op_sel_hi:[0,1]
    v_pk_mul_f32 v[64:65], v[118:119], v[118:119] op_sel:[0,0] op_sel_hi:[0,1]
    v_pk_fma_f32 v[44:45], v[112:113], v[112:113], v[40:41] op_sel:[1,1,0] op_sel_hi:[1,0,1] neg_lo:[1,0,0]
    v_pk_fma_f32 v[52:53], v[114:115], v[114:115], v[48:49] op_sel:[1,1,0] op_sel_hi:[1,0,1] neg_lo:[1,0,0]
    v_pk_fma_f32 v[60:61], v[116:117], v[116:117], v[56:57] op_sel:[1,1,0] op_sel_hi:[1,0,1] neg_lo:[1,0,0]
    v_pk_fma_f32 v[68:69], v[118:119], v[118:119], v[64:65] op_sel:[1,1,0] op_sel_hi:[1,0,1] neg_lo:[1,0,0]
    s_mov_b32 exec_lo, 0xffffffff
    s_mov_b32 exec_hi, 0xffffffff
    v_mov_b32 v120, v44
    v_mov_b32 v121, v45
    s_mov_b32 exec_lo, 0xffff0000
    s_mov_b32 exec_hi, 0xffffffff
    v_mov_b32 v120, v52
    v_mov_b32 v121, v53
    s_mov_b32 exec_lo, 0x0
    s_mov_b32 exec_hi, 0xffffffff
    v_mov_b32 v120, v60
    v_mov_b32 v121, v61
    s_mov_b32 exec_lo, 0x0
    s_mov_b32 exec_hi, 0xffff0000
    v_mov_b32 v120, v68
    v_mov_b32 v121, v69
    s_mov_b64 exec, -1
    s_call_b64 s[54:55], t_g1
    s_call_b64 s[54:55], t_scan
    s_and_b32 s62, s57, 7
    s_lshr_b32 s63, s57, 3
    s_lshl_b32 s60, s63, 19
    s_add_u32 s60, s60, 0
    s_mov_b32 s30, s76
    s_and_b32 s31, s77, 0xffff
    s_mov_b32 s32, 0x200000
    s_mov_b32 s33, s60
    s_mov_b32 s34, 0x8000
    s_mov_b32 s35, 0x40000
    s_lshl_b32 s61, s62, 13
    s_andn2_b32 s61, 0x2000, s61
    s_xor_b32 s61, s61, s59
    s_lshl_b32 s60, s62, 21
    s_add_u32 s60, s60, s61
    s_add_u32 s60, s60, 0x80000
    s_add_u32 s36, s100, 0xc000000
    s_addc_u32 s37, s101, 0
    s_and_b32 s37, s37, 0xffff
    s_mov_b32 s38, 0x1000000
    s_mov_b32 s39, s60
    s_mov_b32 s40, 0x800
    s_mov_b32 s41, 0x8000
    s_mov_b32 s42, 0x10000
    s_and_b32 s0, s62, 3
    s_lshl2_add_u32 s0, s63, s0
    s_mov_b64 s[86:87], s[30:31]
    s_lshl_b32 s62, s62, 16
    s_add_u32 s84, s33, s62
    s_cmp_eq_u32 s58, 0
    s_cselect_b32 s84, s84, 0x40000000
    s_mov_b32 s3, 0
    s_call_b64 s[54:55], t_g2
    s_and_b32 s62, s57, 7
    s_lshr_b32 s63, s57, 3
    s_lshl_b32 s60, s63, 19
    s_add_u32 s60, s60, 1024
    s_mov_b32 s30, s74
    s_and_b32 s31, s75, 0xffff
    s_mov_b32 s32, 0x200000
    s_mov_b32 s33, s60
    s_mov_b32 s34, 0x8000
    s_mov_b32 s35, 0x40000
    s_lshl_b32 s61, s62, 13
    s_andn2_b32 s61, 0x2000, s61
    s_xor_b32 s61, s61, s59
    s_lshl_b32 s60, s62, 21
    s_add_u32 s60, s60, s61
    s_add_u32 s60, s60, 0x100000
    s_add_u32 s36, s100, 0xc000000
    s_addc_u32 s37, s101, 0
    s_and_b32 s37, s37, 0xffff
    s_mov_b32 s38, 0x1000000
    s_mov_b32 s39, s60
    s_mov_b32 s40, 0x800
    s_mov_b32 s41, 0x8000
    s_mov_b32 s42, 0x10000
    s_and_b32 s0, s62, 3
    s_lshl2_add_u32 s0, s63, s0
    s_mov_b64 s[86:87], s[30:31]
    s_lshl_b32 s62, s62, 16
    s_add_u32 s84, s33, s62
    s_cmp_eq_u32 s58, 0
    s_cselect_b32 s84, s84, 0x40000000
    s_mov_b32 s18, 0
    s_cmp_eq_u32 s58, 0
    s_cselect_b32 s1, 16, 0
    s_mov_b32 s3, 16
    s_call_b64 s[54:55], t_g2_c
    s_and_b32 s62, s57, 7
    s_lshr_b32 s63, s57, 3
    s_lshl_b32 s60, s63, 19
    s_add_u32 s60, s60, 1024
    s_mov_b32 s30, s76
    s_and_b32 s31, s77, 0xffff
    s_mov_b32 s32, 0x200000
    s_mov_b32 s33, s60
    s_mov_b32 s34, 0x8000
    s_mov_b32 s35, 0x40000
    s_lshl_b32 s61, s62, 13
    s_andn2_b32 s61, 0x2000, s61
    s_xor_b32 s61, s61, s59
    s_lshl_b32 s60, s62, 21
    s_add_u32 s60, s60, s61
    s_add_u32 s60, s60, 0x180000
    s_add_u32 s36, s100, 0xc000000
    s_addc_u32 s37, s101, 0
    s_and_b32 s37, s37, 0xffff
    s_mov_b32 s38, 0x1000000
    s_mov_b32 s39, s60
    s_mov_b32 s40, 0x800
    s_mov_b32 s41, 0x8000
    s_mov_b32 s42, 0x10000
    s_and_b32 s0, s62, 3
    s_lshl2_add_u32 s0, s63, s0
    s_mov_b64 s[86:87], s[30:31]
    s_lshl_b32 s62, s62, 16
    s_add_u32 s84, s33, s62
    s_cmp_eq_u32 s58, 0
    s_cselect_b32 s84, s84, 0x40000000
    s_mov_b32 s3, 0
    s_call_b64 s[54:55], t_g2_c
    s_mov_b32 s32, 0
    s_mov_b32 s38, 0
    s_mov_b32 s84, 0x40000000
    s_call_b64 s[54:55], t_g2_c
    s_and_b32 s85, s57, 7
    s_lshr_b32 s82, s57, 3
    s_waitcnt vmcnt(0)
    s_barrier
    v_and_b32 v26, 31, v0
    v_bfe_u32 v25, v0, 6, 1
    v_lshl_add_u32 v27, v25, 5, v26
    v_bfe_u32 v28, v0, 5, 1
    v_bfe_u32 v24, v0, 7, 1
    v_lshl_add_u32 v24, v24, 7, v28
    v_lshlrev_b32 v25, 13, v24
    v_lshl_add_u32 v25, v27, 4, v25
    v_lshlrev_b32 v24, 11, v24
    v_lshl_add_u32 v24, v27, 3, v24
    v_lshlrev_b32 v27, 3, v27
    s_mov_b32 s60, s80
    s_and_b32 s61, s81, 0xffff
    s_mov_b32 s62, 0x800
    s_mov_b32 s63, 0x00020000
    s_lshl_b32 s53, s82, 9
    buffer_load_dwordx2 v[44:45], v27, s[60:63], s53 offen
    s_mov_b32 s8, s64
    s_and_b32 s9, s65, 0xffff
    s_mov_b32 s10, 0x400000
    s_mov_b32 s11, 0x00020000
    s_mov_b32 s12, s96
    s_and_b32 s13, s97, 0xffff
    s_mov_b32 s14, 0x1000000
    s_mov_b32 s15, 0x00020000
    s_lshl_b32 s50, s85, 19
    s_add_u32 s50, s50, s53
    s_add_u32 s53, s50, 0x0
    buffer_load_dwordx2 v[128:129], v24, s[8:11], s53 offen
    s_add_u32 s53, s50, 0x1000
    buffer_load_dwordx2 v[130:131], v24, s[8:11], s53 offen
    s_add_u32 s53, s50, 0x2000
    buffer_load_dwordx2 v[132:133], v24, s[8:11], s53 offen
    s_add_u32 s53, s50, 0x3000
    buffer_load_dwordx2 v[134:135], v24, s[8:11], s53 offen
    s_add_u32 s53, s50, 0x10000
    buffer_load_dwordx2 v[136:137], v24, s[8:11], s53 offen
    s_add_u32 s53, s50, 0x11000
    buffer_load_dwordx2 v[138:139], v24, s[8:11], s53 offen
    s_add_u32 s53, s50, 0x12000
    buffer_load_dwordx2 v[140:141], v24, s[8:11], s53 offen
    s_add_u32 s53, s50, 0x13000
    buffer_load_dwordx2 v[142:143], v24, s[8:11], s53 offen
    s_add_u32 s53, s50, 0x20000
    buffer_load_dwordx2 v[144:145], v24, s[8:11], s53 offen
    s_add_u32 s53, s50, 0x21000
    buffer_load_dwordx2 v[146:147], v24, s[8:11], s53 offen
    s_add_u32 s53, s50, 0x22000
    buffer_load_dwordx2 v[148:149], v24, s[8:11], s53 offen
    s_add_u32 s53, s50, 0x23000
    buffer_load_dwordx2 v[150:151], v24, s[8:11], s53 offen
    s_add_u32 s53, s50, 0x30000
    buffer_load_dwordx2 v[152:153], v24, s[8:11], s53 offen
    s_add_u32 s53, s50, 0x31000
    buffer_load_dwordx2 v[154:155], v24, s[8:11], s53 offen
    s_add_u32 s53, s50, 0x32000
    buffer_load_dwordx2 v[156:157], v24, s[8:11], s53 offen
    s_add_u32 s53, s50, 0x33000
    buffer_load_dwordx2 v[158:159], v24, s[8:11], s53 offen
    s_add_u32 s53, s50, 0x4000
    buffer_load_dwordx2 v[160:161], v24, s[8:11], s53 offen
    s_add_u32 s53, s50, 0x5000
    buffer_load_dwordx2 v[162:163], v24, s[8:11], s53 offen
    s_add_u32 s53, s50, 0x6000
    buffer_load_dwordx2 v[164:165], v24, s[8:11], s53 offen
    s_add_u32 s53, s50, 0x7000
    buffer_load_dwordx2 v[166:167], v24, s[8:11], s53 offen
    s_add_u32 s53, s50, 0x14000
    buffer_load_dwordx2 v[168:169], v24, s[8:11], s53 offen
    s_add_u32 s53, s50, 0x15000
    buffer_load_dwordx2 v[170:171], v24, s[8:11], s53 offen
    s_add_u32 s53, s50, 0x16000
    buffer_load_dwordx2 v[172:173], v24, s[8:11], s53 offen
    s_add_u32 s53, s50, 0x17000
    buffer_load_dwordx2 v[174:175], v24, s[8:11], s53 offen
    s_add_u32 s53, s50, 0x24000
    buffer_load_dwordx2 v[176:177], v24, s[8:11], s53 offen
    s_add_u32 s53, s50, 0x25000
    buffer_load_dwordx2 v[178:179], v24, s[8:11], s53 offen
    s_add_u32 s53, s50, 0x26000
    buffer_load_dwordx2 v[180:181], v24, s[8:11], s53 offen
    s_add_u32 s53, s50, 0x27000
    buffer_load_dwordx2 v[182:183], v24, s[8:11], s53 offen
    s_add_u32 s53, s50, 0x34000
    buffer_load_dwordx2 v[184:185], v24, s[8:11], s53 offen
    s_add_u32 s53, s50, 0x35000
    buffer_load_dwordx2 v[186:187], v24, s[8:11], s53 offen
    s_add_u32 s53, s50, 0x36000
    buffer_load_dwordx2 v[188:189], v24, s[8:11], s53 offen
    s_add_u32 s53, s50, 0x37000
    buffer_load_dwordx2 v[190:191], v24, s[8:11], s53 offen
    s_mul_i32 s60, s58, 33792
    v_mul_u32_u24 v28, 528, v28
    v_lshl_add_u32 v28, v26, 4, v28
    v_add_u32 v28, s60, v28
    v_and_b32 v27, 15, v0
    v_mul_u32_u24 v27, 528, v27
    v_bfe_u32 v26, v0, 4, 2
    v_lshl_add_u32 v27, v26, 4, v27
    v_add_u32 v27, s60, v27
    s_lshl_b32 s51, s85, 21
    s_lshl_b32 s52, s82, 10
    s_add_u32 s51, s51, s52
    ds_write_b128 v27, a[0:3] offset:0
    ds_write_b128 v27, a[32:35] offset:64
    ds_write_b128 v27, a[64:67] offset:128
    ds_write_b128 v27, a[96:99] offset:192
    ds_write_b128 v27, a[128:131] offset:256
    ds_write_b128 v27, a[160:163] offset:320
    ds_write_b128 v27, a[192:195] offset:384
    ds_write_b128 v27, a[224:227] offset:448
    ds_read_b128 v[48:51], v28 offset:0
    ds_read_b128 v[52:55], v28 offset:1056
    ds_read_b128 v[56:59], v28 offset:2112
    ds_read_b128 v[60:63], v28 offset:3168
    ds_read_b128 v[64:67], v28 offset:4224
    ds_read_b128 v[68:71], v28 offset:5280
    ds_read_b128 v[72:75], v28 offset:6336
    ds_read_b128 v[76:79], v28 offset:7392
    ds_write_b128 v27, a[4:7] offset:8448
    ds_write_b128 v27, a[36:39] offset:8512
    ds_write_b128 v27, a[68:71] offset:8576
    ds_write_b128 v27, a[100:103] offset:8640
    ds_write_b128 v27, a[132:135] offset:8704
    ds_write_b128 v27, a[164:167] offset:8768
    ds_write_b128 v27, a[196:199] offset:8832
    ds_write_b128 v27, a[228:231] offset:8896
    s_waitcnt vmcnt(32)
    v_lshlrev_b32 v40, 16, v44
    v_and_b32 v41, 0xffff0000, v44
    v_lshlrev_b32 v42, 16, v45
    v_and_b32 v43, 0xffff0000, v45
    s_waitcnt vmcnt(24) lgkmcnt(8)
    ds_read_b128 v[80:83], v28 offset:8448
    ds_read_b128 v[84:87], v28 offset:9504
    ds_read_b128 v[88:91], v28 offset:10560
    ds_read_b128 v[92:95], v28 offset:11616
    ds_read_b128 v[96:99], v28 offset:12672
    ds_read_b128 v[100:103], v28 offset:13728
    ds_read_b128 v[104:107], v28 offset:14784
    ds_read_b128 v[108:111], v28 offset:15840
    ds_write_b128 v27, a[8:11] offset:16896
    ds_write_b128 v27, a[40:43] offset:16960
    ds_write_b128 v27, a[72:75] offset:17024
    ds_write_b128 v27, a[104:107] offset:17088
    ds_write_b128 v27, a[136:139] offset:17152
    ds_write_b128 v27, a[168:171] offset:17216
    ds_write_b128 v27, a[200:203] offset:17280
    ds_write_b128 v27, a[232:235] offset:17344
    v_lshlrev_b32 v112, 16, v128
    v_and_b32 v113, 0xffff0000, v128
    v_lshlrev_b32 v114, 16, v129
    v_and_b32 v115, 0xffff0000, v129
    v_pk_mul_f32 v[112:113], v[112:113], v[40:41]
    v_pk_mul_f32 v[114:115], v[114:115], v[42:43]
    s_add_u32 s52, s51, 0x0
    v_cvt_pk_bf16_f32 v112, 0, v112
    v_cvt_pk_bf16_f32 v113, 0, v113
    v_cvt_pk_bf16_f32 v114, 0, v114
    v_cvt_pk_bf16_f32 v115, 0, v115
    v_pk_add_f32 v[48:49], v[48:49], v[112:113]
    v_pk_add_f32 v[50:51], v[50:51], v[114:115]
    buffer_store_dwordx4 v[48:51], v25, s[12:15], s52 offen
    v_lshlrev_b32 v116, 16, v130
    v_and_b32 v117, 0xffff0000, v130
    v_lshlrev_b32 v118, 16, v131
    v_and_b32 v119, 0xffff0000, v131
    v_pk_mul_f32 v[116:117], v[116:117], v[40:41]
    v_pk_mul_f32 v[118:119], v[118:119], v[42:43]
    s_add_u32 s52, s51, 0x4000
    v_cvt_pk_bf16_f32 v116, 0, v116
    v_cvt_pk_bf16_f32 v117, 0, v117
    v_cvt_pk_bf16_f32 v118, 0, v118
    v_cvt_pk_bf16_f32 v119, 0, v119
    v_pk_add_f32 v[52:53], v[52:53], v[116:117]
    v_pk_add_f32 v[54:55], v[54:55], v[118:119]
    buffer_store_dwordx4 v[52:55], v25, s[12:15], s52 offen
    v_lshlrev_b32 v112, 16, v132
    v_and_b32 v113, 0xffff0000, v132
    v_lshlrev_b32 v114, 16, v133
    v_and_b32 v115, 0xffff0000, v133
    v_pk_mul_f32 v[112:113], v[112:113], v[40:41]
    v_pk_mul_f32 v[114:115], v[114:115], v[42:43]
    s_add_u32 s52, s51, 0x8000
    v_cvt_pk_bf16_f32 v112, 0, v112
    v_cvt_pk_bf16_f32 v113, 0, v113
    v_cvt_pk_bf16_f32 v114, 0, v114
    v_cvt_pk_bf16_f32 v115, 0, v115
    v_pk_add_f32 v[56:57], v[56:57], v[112:113]
    v_pk_add_f32 v[58:59], v[58:59], v[114:115]
    buffer_store_dwordx4 v[56:59], v25, s[12:15], s52 offen
    v_lshlrev_b32 v116, 16, v134
    v_and_b32 v117, 0xffff0000, v134
    v_lshlrev_b32 v118, 16, v135
    v_and_b32 v119, 0xffff0000, v135
    v_pk_mul_f32 v[116:117], v[116:117], v[40:41]
    v_pk_mul_f32 v[118:119], v[118:119], v[42:43]
    s_add_u32 s52, s51, 0xc000
    v_cvt_pk_bf16_f32 v116, 0, v116
    v_cvt_pk_bf16_f32 v117, 0, v117
    v_cvt_pk_bf16_f32 v118, 0, v118
    v_cvt_pk_bf16_f32 v119, 0, v119
    v_pk_add_f32 v[60:61], v[60:61], v[116:117]
    v_pk_add_f32 v[62:63], v[62:63], v[118:119]
    buffer_store_dwordx4 v[60:63], v25, s[12:15], s52 offen
    v_lshlrev_b32 v112, 16, v136
    v_and_b32 v113, 0xffff0000, v136
    v_lshlrev_b32 v114, 16, v137
    v_and_b32 v115, 0xffff0000, v137
    v_pk_mul_f32 v[112:113], v[112:113], v[40:41]
    v_pk_mul_f32 v[114:115], v[114:115], v[42:43]
    s_add_u32 s52, s51, 0x40000
    v_cvt_pk_bf16_f32 v112, 0, v112
    v_cvt_pk_bf16_f32 v113, 0, v113
    v_cvt_pk_bf16_f32 v114, 0, v114
    v_cvt_pk_bf16_f32 v115, 0, v115
    v_pk_add_f32 v[64:65], v[64:65], v[112:113]
    v_pk_add_f32 v[66:67], v[66:67], v[114:115]
    buffer_store_dwordx4 v[64:67], v25, s[12:15], s52 offen
    v_lshlrev_b32 v116, 16, v138
    v_and_b32 v117, 0xffff0000, v138
    v_lshlrev_b32 v118, 16, v139
    v_and_b32 v119, 0xffff0000, v139
    v_pk_mul_f32 v[116:117], v[116:117], v[40:41]
    v_pk_mul_f32 v[118:119], v[118:119], v[42:43]
    s_add_u32 s52, s51, 0x44000
    v_cvt_pk_bf16_f32 v116, 0, v116
    v_cvt_pk_bf16_f32 v117, 0, v117
    v_cvt_pk_bf16_f32 v118, 0, v118
    v_cvt_pk_bf16_f32 v119, 0, v119
    v_pk_add_f32 v[68:69], v[68:69], v[116:117]
    v_pk_add_f32 v[70:71], v[70:71], v[118:119]
    buffer_store_dwordx4 v[68:71], v25, s[12:15], s52 offen
    v_lshlrev_b32 v112, 16, v140
    v_and_b32 v113, 0xffff0000, v140
    v_lshlrev_b32 v114, 16, v141
    v_and_b32 v115, 0xffff0000, v141
    v_pk_mul_f32 v[112:113], v[112:113], v[40:41]
    v_pk_mul_f32 v[114:115], v[114:115], v[42:43]
    s_add_u32 s52, s51, 0x48000
    v_cvt_pk_bf16_f32 v112, 0, v112
    v_cvt_pk_bf16_f32 v113, 0, v113
    v_cvt_pk_bf16_f32 v114, 0, v114
    v_cvt_pk_bf16_f32 v115, 0, v115
    v_pk_add_f32 v[72:73], v[72:73], v[112:113]
    v_pk_add_f32 v[74:75], v[74:75], v[114:115]
    buffer_store_dwordx4 v[72:75], v25, s[12:15], s52 offen
    v_lshlrev_b32 v116, 16, v142
    v_and_b32 v117, 0xffff0000, v142
    v_lshlrev_b32 v118, 16, v143
    v_and_b32 v119, 0xffff0000, v143
    v_pk_mul_f32 v[116:117], v[116:117], v[40:41]
    v_pk_mul_f32 v[118:119], v[118:119], v[42:43]
    s_add_u32 s52, s51, 0x4c000
    v_cvt_pk_bf16_f32 v116, 0, v116
    v_cvt_pk_bf16_f32 v117, 0, v117
    v_cvt_pk_bf16_f32 v118, 0, v118
    v_cvt_pk_bf16_f32 v119, 0, v119
    v_pk_add_f32 v[76:77], v[76:77], v[116:117]
    v_pk_add_f32 v[78:79], v[78:79], v[118:119]
    buffer_store_dwordx4 v[76:79], v25, s[12:15], s52 offen
    s_add_u32 s53, s50, 0x8000
    buffer_load_dwordx2 v[192:193], v24, s[8:11], s53 offen
    s_add_u32 s53, s50, 0x9000
    buffer_load_dwordx2 v[194:195], v24, s[8:11], s53 offen
    s_add_u32 s53, s50, 0xa000
    buffer_load_dwordx2 v[196:197], v24, s[8:11], s53 offen
    s_add_u32 s53, s50, 0xb000
    buffer_load_dwordx2 v[198:199], v24, s[8:11], s53 offen
    s_add_u32 s53, s50, 0x18000
    buffer_load_dwordx2 v[200:201], v24, s[8:11], s53 offen
    s_add_u32 s53, s50, 0x19000
    buffer_load_dwordx2 v[202:203], v24, s[8:11], s53 offen
    s_add_u32 s53, s50, 0x1a000
    buffer_load_dwordx2 v[204:205], v24, s[8:11], s53 offen
    s_add_u32 s53, s50, 0x1b000
    buffer_load_dwordx2 v[206:207], v24, s[8:11], s53 offen
    s_waitcnt vmcnt(32) lgkmcnt(8)
    ds_read_b128 v[48:51], v28 offset:16896
    ds_read_b128 v[52:55], v28 offset:17952
    ds_read_b128 v[56:59], v28 offset:19008
    ds_read_b128 v[60:63], v28 offset:20064
    ds_read_b128 v[64:67], v28 offset:21120
    ds_read_b128 v[68:71], v28 offset:22176
    ds_read_b128 v[72:75], v28 offset:23232
    ds_read_b128 v[76:79], v28 offset:24288
    ds_write_b128 v27, a[12:15] offset:25344
    ds_write_b128 v27, a[44:47] offset:25408
    ds_write_b128 v27, a[76:79] offset:25472
    ds_write_b128 v27, a[108:111] offset:25536
    ds_write_b128 v27, a[140:143] offset:25600
    ds_write_b128 v27, a[172:175] offset:25664
    ds_write_b128 v27, a[204:207] offset:25728
    ds_write_b128 v27, a[236:239] offset:25792
    v_lshlrev_b32 v112, 16, v144
    v_and_b32 v113, 0xffff0000, v144
    v_lshlrev_b32 v114, 16, v145
    v_and_b32 v115, 0xffff0000, v145
    v_pk_mul_f32 v[112:113], v[112:113], v[40:41]
    v_pk_mul_f32 v[114:115], v[114:115], v[42:43]
    s_add_u32 s52, s51, 0x80000
    v_cvt_pk_bf16_f32 v112, 0, v112
    v_cvt_pk_bf16_f32 v113, 0, v113
    v_cvt_pk_bf16_f32 v114, 0, v114
    v_cvt_pk_bf16_f32 v115, 0, v115
    v_pk_add_f32 v[80:81], v[80:81], v[112:113]
    v_pk_add_f32 v[82:83], v[82:83], v[114:115]
    buffer_store_dwordx4 v[80:83], v25, s[12:15], s52 offen
    v_lshlrev_b32 v116, 16, v146
    v_and_b32 v117, 0xffff0000, v146
    v_lshlrev_b32 v118, 16, v147
    v_and_b32 v119, 0xffff0000, v147
    v_pk_mul_f32 v[116:117], v[116:117], v[40:41]
    v_pk_mul_f32 v[118:119], v[118:119], v[42:43]
    s_add_u32 s52, s51, 0x84000
    v_cvt_pk_bf16_f32 v116, 0, v116
    v_cvt_pk_bf16_f32 v117, 0, v117
    v_cvt_pk_bf16_f32 v118, 0, v118
    v_cvt_pk_bf16_f32 v119, 0, v119
    v_pk_add_f32 v[84:85], v[84:85], v[116:117]
    v_pk_add_f32 v[86:87], v[86:87], v[118:119]
    buffer_store_dwordx4 v[84:87], v25, s[12:15], s52 offen
    v_lshlrev_b32 v112, 16, v148
    v_and_b32 v113, 0xffff0000, v148
    v_lshlrev_b32 v114, 16, v149
    v_and_b32 v115, 0xffff0000, v149
    v_pk_mul_f32 v[112:113], v[112:113], v[40:41]
    v_pk_mul_f32 v[114:115], v[114:115], v[42:43]
    s_add_u32 s52, s51, 0x88000
    v_cvt_pk_bf16_f32 v112, 0, v112
    v_cvt_pk_bf16_f32 v113, 0, v113
    v_cvt_pk_bf16_f32 v114, 0, v114
    v_cvt_pk_bf16_f32 v115, 0, v115
    v_pk_add_f32 v[88:89], v[88:89], v[112:113]
    v_pk_add_f32 v[90:91], v[90:91], v[114:115]
    buffer_store_dwordx4 v[88:91], v25, s[12:15], s52 offen
    v_lshlrev_b32 v116, 16, v150
    v_and_b32 v117, 0xffff0000, v150
    v_lshlrev_b32 v118, 16, v151
    v_and_b32 v119, 0xffff0000, v151
    v_pk_mul_f32 v[116:117], v[116:117], v[40:41]
    v_pk_mul_f32 v[118:119], v[118:119], v[42:43]
    s_add_u32 s52, s51, 0x8c000
    v_cvt_pk_bf16_f32 v116, 0, v116
    v_cvt_pk_bf16_f32 v117, 0, v117
    v_cvt_pk_bf16_f32 v118, 0, v118
    v_cvt_pk_bf16_f32 v119, 0, v119
    v_pk_add_f32 v[92:93], v[92:93], v[116:117]
    v_pk_add_f32 v[94:95], v[94:95], v[118:119]
    buffer_store_dwordx4 v[92:95], v25, s[12:15], s52 offen
    v_lshlrev_b32 v112, 16, v152
    v_and_b32 v113, 0xffff0000, v152
    v_lshlrev_b32 v114, 16, v153
    v_and_b32 v115, 0xffff0000, v153
    v_pk_mul_f32 v[112:113], v[112:113], v[40:41]
    v_pk_mul_f32 v[114:115], v[114:115], v[42:43]
    s_add_u32 s52, s51, 0xc0000
    v_cvt_pk_bf16_f32 v112, 0, v112
    v_cvt_pk_bf16_f32 v113, 0, v113
    v_cvt_pk_bf16_f32 v114, 0, v114
    v_cvt_pk_bf16_f32 v115, 0, v115
    v_pk_add_f32 v[96:97], v[96:97], v[112:113]
    v_pk_add_f32 v[98:99], v[98:99], v[114:115]
    buffer_store_dwordx4 v[96:99], v25, s[12:15], s52 offen
    v_lshlrev_b32 v116, 16, v154
    v_and_b32 v117, 0xffff0000, v154
    v_lshlrev_b32 v118, 16, v155
    v_and_b32 v119, 0xffff0000, v155
    v_pk_mul_f32 v[116:117], v[116:117], v[40:41]
    v_pk_mul_f32 v[118:119], v[118:119], v[42:43]
    s_add_u32 s52, s51, 0xc4000
    v_cvt_pk_bf16_f32 v116, 0, v116
    v_cvt_pk_bf16_f32 v117, 0, v117
    v_cvt_pk_bf16_f32 v118, 0, v118
    v_cvt_pk_bf16_f32 v119, 0, v119
    v_pk_add_f32 v[100:101], v[100:101], v[116:117]
    v_pk_add_f32 v[102:103], v[102:103], v[118:119]
    buffer_store_dwordx4 v[100:103], v25, s[12:15], s52 offen
    v_lshlrev_b32 v112, 16, v156
    v_and_b32 v113, 0xffff0000, v156
    v_lshlrev_b32 v114, 16, v157
    v_and_b32 v115, 0xffff0000, v157
    v_pk_mul_f32 v[112:113], v[112:113], v[40:41]
    v_pk_mul_f32 v[114:115], v[114:115], v[42:43]
    s_add_u32 s52, s51, 0xc8000
    v_cvt_pk_bf16_f32 v112, 0, v112
    v_cvt_pk_bf16_f32 v113, 0, v113
    v_cvt_pk_bf16_f32 v114, 0, v114
    v_cvt_pk_bf16_f32 v115, 0, v115
    v_pk_add_f32 v[104:105], v[104:105], v[112:113]
    v_pk_add_f32 v[106:107], v[106:107], v[114:115]
    buffer_store_dwordx4 v[104:107], v25, s[12:15], s52 offen
    v_lshlrev_b32 v116, 16, v158
    v_and_b32 v117, 0xffff0000, v158
    v_lshlrev_b32 v118, 16, v159
    v_and_b32 v119, 0xffff0000, v159
    v_pk_mul_f32 v[116:117], v[116:117], v[40:41]
    v_pk_mul_f32 v[118:119], v[118:119], v[42:43]
    s_add_u32 s52, s51, 0xcc000
    v_cvt_pk_bf16_f32 v116, 0, v116
    v_cvt_pk_bf16_f32 v117, 0, v117
    v_cvt_pk_bf16_f32 v118, 0, v118
    v_cvt_pk_bf16_f32 v119, 0, v119
    v_pk_add_f32 v[108:109], v[108:109], v[116:117]
    v_pk_add_f32 v[110:111], v[110:111], v[118:119]
    buffer_store_dwordx4 v[108:111], v25, s[12:15], s52 offen
    s_add_u32 s53, s50, 0x28000
    buffer_load_dwordx2 v[208:209], v24, s[8:11], s53 offen
    s_add_u32 s53, s50, 0x29000
    buffer_load_dwordx2 v[210:211], v24, s[8:11], s53 offen
    s_add_u32 s53, s50, 0x2a000
    buffer_load_dwordx2 v[212:213], v24, s[8:11], s53 offen
    s_add_u32 s53, s50, 0x2b000
    buffer_load_dwordx2 v[214:215], v24, s[8:11], s53 offen
    s_add_u32 s53, s50, 0x38000
    buffer_load_dwordx2 v[216:217], v24, s[8:11], s53 offen
    s_add_u32 s53, s50, 0x39000
    buffer_load_dwordx2 v[218:219], v24, s[8:11], s53 offen
    s_add_u32 s53, s50, 0x3a000
    buffer_load_dwordx2 v[220:221], v24, s[8:11], s53 offen
    s_add_u32 s53, s50, 0x3b000
    buffer_load_dwordx2 v[222:223], v24, s[8:11], s53 offen
    s_waitcnt vmcnt(40) lgkmcnt(8)
    ds_read_b128 v[80:83], v28 offset:25344
    ds_read_b128 v[84:87], v28 offset:26400
    ds_read_b128 v[88:91], v28 offset:27456
    ds_read_b128 v[92:95], v28 offset:28512
    ds_read_b128 v[96:99], v28 offset:29568
    ds_read_b128 v[100:103], v28 offset:30624
    ds_read_b128 v[104:107], v28 offset:31680
    ds_read_b128 v[108:111], v28 offset:32736
    ds_write_b128 v27, a[16:19] offset:0
    ds_write_b128 v27, a[48:51] offset:64
    ds_write_b128 v27, a[80:83] offset:128
    ds_write_b128 v27, a[112:115] offset:192
    ds_write_b128 v27, a[144:147] offset:256
    ds_write_b128 v27, a[176:179] offset:320
    ds_write_b128 v27, a[208:211] offset:384
    ds_write_b128 v27, a[240:243] offset:448
    v_lshlrev_b32 v112, 16, v160
    v_and_b32 v113, 0xffff0000, v160
    v_lshlrev_b32 v114, 16, v161
    v_and_b32 v115, 0xffff0000, v161
    v_pk_mul_f32 v[112:113], v[112:113], v[40:41]
    v_pk_mul_f32 v[114:115], v[114:115], v[42:43]
    s_add_u32 s52, s51, 0x10000
    v_cvt_pk_bf16_f32 v112, 0, v112
    v_cvt_pk_bf16_f32 v113, 0, v113
    v_cvt_pk_bf16_f32 v114, 0, v114
    v_cvt_pk_bf16_f32 v115, 0, v115
    v_pk_add_f32 v[48:49], v[48:49], v[112:113]
    v_pk_add_f32 v[50:51], v[50:51], v[114:115]
    buffer_store_dwordx4 v[48:51], v25, s[12:15], s52 offen
    v_lshlrev_b32 v116, 16, v162
    v_and_b32 v117, 0xffff0000, v162
    v_lshlrev_b32 v118, 16, v163
    v_and_b32 v119, 0xffff0000, v163
    v_pk_mul_f32 v[116:117], v[116:117], v[40:41]
    v_pk_mul_f32 v[118:119], v[118:119], v[42:43]
    s_add_u32 s52, s51, 0x14000
    v_cvt_pk_bf16_f32 v116, 0, v116
    v_cvt_pk_bf16_f32 v117, 0, v117
    v_cvt_pk_bf16_f32 v118, 0, v118
    v_cvt_pk_bf16_f32 v119, 0, v119
    v_pk_add_f32 v[52:53], v[52:53], v[116:117]
    v_pk_add_f32 v[54:55], v[54:55], v[118:119]
    buffer_store_dwordx4 v[52:55], v25, s[12:15], s52 offen
    v_lshlrev_b32 v112, 16, v164
    v_and_b32 v113, 0xffff0000, v164
    v_lshlrev_b32 v114, 16, v165
    v_and_b32 v115, 0xffff0000, v165
    v_pk_mul_f32 v[112:113], v[112:113], v[40:41]
    v_pk_mul_f32 v[114:115], v[114:115], v[42:43]
    s_add_u32 s52, s51, 0x18000
    v_cvt_pk_bf16_f32 v112, 0, v112
    v_cvt_pk_bf16_f32 v113, 0, v113
    v_cvt_pk_bf16_f32 v114, 0, v114
    v_cvt_pk_bf16_f32 v115, 0, v115
    v_pk_add_f32 v[56:57], v[56:57], v[112:113]
    v_pk_add_f32 v[58:59], v[58:59], v[114:115]
    buffer_store_dwordx4 v[56:59], v25, s[12:15], s52 offen
    v_lshlrev_b32 v116, 16, v166
    v_and_b32 v117, 0xffff0000, v166
    v_lshlrev_b32 v118, 16, v167
    v_and_b32 v119, 0xffff0000, v167
    v_pk_mul_f32 v[116:117], v[116:117], v[40:41]
    v_pk_mul_f32 v[118:119], v[118:119], v[42:43]
    s_add_u32 s52, s51, 0x1c000
    v_cvt_pk_bf16_f32 v116, 0, v116
    v_cvt_pk_bf16_f32 v117, 0, v117
    v_cvt_pk_bf16_f32 v118, 0, v118
    v_cvt_pk_bf16_f32 v119, 0, v119
    v_pk_add_f32 v[60:61], v[60:61], v[116:117]
    v_pk_add_f32 v[62:63], v[62:63], v[118:119]
    buffer_store_dwordx4 v[60:63], v25, s[12:15], s52 offen
    v_lshlrev_b32 v112, 16, v168
    v_and_b32 v113, 0xffff0000, v168
    v_lshlrev_b32 v114, 16, v169
    v_and_b32 v115, 0xffff0000, v169
    v_pk_mul_f32 v[112:113], v[112:113], v[40:41]
    v_pk_mul_f32 v[114:115], v[114:115], v[42:43]
    s_add_u32 s52, s51, 0x50000
    v_cvt_pk_bf16_f32 v112, 0, v112
    v_cvt_pk_bf16_f32 v113, 0, v113
    v_cvt_pk_bf16_f32 v114, 0, v114
    v_cvt_pk_bf16_f32 v115, 0, v115
    v_pk_add_f32 v[64:65], v[64:65], v[112:113]
    v_pk_add_f32 v[66:67], v[66:67], v[114:115]
    buffer_store_dwordx4 v[64:67], v25, s[12:15], s52 offen
    v_lshlrev_b32 v116, 16, v170
    v_and_b32 v117, 0xffff0000, v170
    v_lshlrev_b32 v118, 16, v171
    v_and_b32 v119, 0xffff0000, v171
    v_pk_mul_f32 v[116:117], v[116:117], v[40:41]
    v_pk_mul_f32 v[118:119], v[118:119], v[42:43]
    s_add_u32 s52, s51, 0x54000
    v_cvt_pk_bf16_f32 v116, 0, v116
    v_cvt_pk_bf16_f32 v117, 0, v117
    v_cvt_pk_bf16_f32 v118, 0, v118
    v_cvt_pk_bf16_f32 v119, 0, v119
    v_pk_add_f32 v[68:69], v[68:69], v[116:117]
    v_pk_add_f32 v[70:71], v[70:71], v[118:119]
    buffer_store_dwordx4 v[68:71], v25, s[12:15], s52 offen
    v_lshlrev_b32 v112, 16, v172
    v_and_b32 v113, 0xffff0000, v172
    v_lshlrev_b32 v114, 16, v173
    v_and_b32 v115, 0xffff0000, v173
    v_pk_mul_f32 v[112:113], v[112:113], v[40:41]
    v_pk_mul_f32 v[114:115], v[114:115], v[42:43]
    s_add_u32 s52, s51, 0x58000
    v_cvt_pk_bf16_f32 v112, 0, v112
    v_cvt_pk_bf16_f32 v113, 0, v113
    v_cvt_pk_bf16_f32 v114, 0, v114
    v_cvt_pk_bf16_f32 v115, 0, v115
    v_pk_add_f32 v[72:73], v[72:73], v[112:113]
    v_pk_add_f32 v[74:75], v[74:75], v[114:115]
    buffer_store_dwordx4 v[72:75], v25, s[12:15], s52 offen
    v_lshlrev_b32 v116, 16, v174
    v_and_b32 v117, 0xffff0000, v174
    v_lshlrev_b32 v118, 16, v175
    v_and_b32 v119, 0xffff0000, v175
    v_pk_mul_f32 v[116:117], v[116:117], v[40:41]
    v_pk_mul_f32 v[118:119], v[118:119], v[42:43]
    s_add_u32 s52, s51, 0x5c000
    v_cvt_pk_bf16_f32 v116, 0, v116
    v_cvt_pk_bf16_f32 v117, 0, v117
    v_cvt_pk_bf16_f32 v118, 0, v118
    v_cvt_pk_bf16_f32 v119, 0, v119
    v_pk_add_f32 v[76:77], v[76:77], v[116:117]
    v_pk_add_f32 v[78:79], v[78:79], v[118:119]
    buffer_store_dwordx4 v[76:79], v25, s[12:15], s52 offen
    s_add_u32 s53, s50, 0xc000
    buffer_load_dwordx2 v[224:225], v24, s[8:11], s53 offen
    s_add_u32 s53, s50, 0xd000
    buffer_load_dwordx2 v[226:227], v24, s[8:11], s53 offen
    s_add_u32 s53, s50, 0xe000
    buffer_load_dwordx2 v[228:229], v24, s[8:11], s53 offen
    s_add_u32 s53, s50, 0xf000
    buffer_load_dwordx2 v[230:231], v24, s[8:11], s53 offen
    s_add_u32 s53, s50, 0x1c000
    buffer_load_dwordx2 v[232:233], v24, s[8:11], s53 offen
    s_add_u32 s53, s50, 0x1d000
    buffer_load_dwordx2 v[234:235], v24, s[8:11], s53 offen
    s_add_u32 s53, s50, 0x1e000
    buffer_load_dwordx2 v[236:237], v24, s[8:11], s53 offen
    s_add_u32 s53, s50, 0x1f000
    buffer_load_dwordx2 v[238:239], v24, s[8:11], s53 offen
    s_waitcnt vmcnt(48) lgkmcnt(8)
    ds_read_b128 v[48:51], v28 offset:0
    ds_read_b128 v[52:55], v28 offset:1056
    ds_read_b128 v[56:59], v28 offset:2112
    ds_read_b128 v[60:63], v28 offset:3168
    ds_read_b128 v[64:67], v28 offset:4224
    ds_read_b128 v[68:71], v28 offset:5280
    ds_read_b128 v[72:75], v28 offset:6336
    ds_read_b128 v[76:79], v28 offset:7392
    ds_write_b128 v27, a[20:23] offset:8448
    ds_write_b128 v27, a[52:55] offset:8512
    ds_write_b128 v27, a[84:87] offset:8576
    ds_write_b128 v27, a[116:119] offset:8640
    ds_write_b128 v27, a[148:151] offset:8704
    ds_write_b128 v27, a[180:183] offset:8768
    ds_write_b128 v27, a[212:215] offset:8832
    ds_write_b128 v27, a[244:247] offset:8896
    v_lshlrev_b32 v112, 16, v176
    v_and_b32 v113, 0xffff0000, v176
    v_lshlrev_b32 v114, 16, v177
    v_and_b32 v115, 0xffff0000, v177
    v_pk_mul_f32 v[112:113], v[112:113], v[40:41]
    v_pk_mul_f32 v[114:115], v[114:115], v[42:43]
    s_add_u32 s52, s51, 0x90000
    v_cvt_pk_bf16_f32 v112, 0, v112
    v_cvt_pk_bf16_f32 v113, 0, v113
    v_cvt_pk_bf16_f32 v114, 0, v114
    v_cvt_pk_bf16_f32 v115, 0, v115
    v_pk_add_f32 v[80:81], v[80:81], v[112:113]
    v_pk_add_f32 v[82:83], v[82:83], v[114:115]
    buffer_store_dwordx4 v[80:83], v25, s[12:15], s52 offen
    v_lshlrev_b32 v116, 16, v178
    v_and_b32 v117, 0xffff0000, v178
    v_lshlrev_b32 v118, 16, v179
    v_and_b32 v119, 0xffff0000, v179
    v_pk_mul_f32 v[116:117], v[116:117], v[40:41]
    v_pk_mul_f32 v[118:119], v[118:119], v[42:43]
    s_add_u32 s52, s51, 0x94000
    v_cvt_pk_bf16_f32 v116, 0, v116
    v_cvt_pk_bf16_f32 v117, 0, v117
    v_cvt_pk_bf16_f32 v118, 0, v118
    v_cvt_pk_bf16_f32 v119, 0, v119
    v_pk_add_f32 v[84:85], v[84:85], v[116:117]
    v_pk_add_f32 v[86:87], v[86:87], v[118:119]
    buffer_store_dwordx4 v[84:87], v25, s[12:15], s52 offen
    v_lshlrev_b32 v112, 16, v180
    v_and_b32 v113, 0xffff0000, v180
    v_lshlrev_b32 v114, 16, v181
    v_and_b32 v115, 0xffff0000, v181
    v_pk_mul_f32 v[112:113], v[112:113], v[40:41]
    v_pk_mul_f32 v[114:115], v[114:115], v[42:43]
    s_add_u32 s52, s51, 0x98000
    v_cvt_pk_bf16_f32 v112, 0, v112
    v_cvt_pk_bf16_f32 v113, 0, v113
    v_cvt_pk_bf16_f32 v114, 0, v114
    v_cvt_pk_bf16_f32 v115, 0, v115
    v_pk_add_f32 v[88:89], v[88:89], v[112:113]
    v_pk_add_f32 v[90:91], v[90:91], v[114:115]
    buffer_store_dwordx4 v[88:91], v25, s[12:15], s52 offen
    v_lshlrev_b32 v116, 16, v182
    v_and_b32 v117, 0xffff0000, v182
    v_lshlrev_b32 v118, 16, v183
    v_and_b32 v119, 0xffff0000, v183
    v_pk_mul_f32 v[116:117], v[116:117], v[40:41]
    v_pk_mul_f32 v[118:119], v[118:119], v[42:43]
    s_add_u32 s52, s51, 0x9c000
    v_cvt_pk_bf16_f32 v116, 0, v116
    v_cvt_pk_bf16_f32 v117, 0, v117
    v_cvt_pk_bf16_f32 v118, 0, v118
    v_cvt_pk_bf16_f32 v119, 0, v119
    v_pk_add_f32 v[92:93], v[92:93], v[116:117]
    v_pk_add_f32 v[94:95], v[94:95], v[118:119]
    buffer_store_dwordx4 v[92:95], v25, s[12:15], s52 offen
    v_lshlrev_b32 v112, 16, v184
    v_and_b32 v113, 0xffff0000, v184
    v_lshlrev_b32 v114, 16, v185
    v_and_b32 v115, 0xffff0000, v185
    v_pk_mul_f32 v[112:113], v[112:113], v[40:41]
    v_pk_mul_f32 v[114:115], v[114:115], v[42:43]
    s_add_u32 s52, s51, 0xd0000
    v_cvt_pk_bf16_f32 v112, 0, v112
    v_cvt_pk_bf16_f32 v113, 0, v113
    v_cvt_pk_bf16_f32 v114, 0, v114
    v_cvt_pk_bf16_f32 v115, 0, v115
    v_pk_add_f32 v[96:97], v[96:97], v[112:113]
    v_pk_add_f32 v[98:99], v[98:99], v[114:115]
    buffer_store_dwordx4 v[96:99], v25, s[12:15], s52 offen
    v_lshlrev_b32 v116, 16, v186
    v_and_b32 v117, 0xffff0000, v186
    v_lshlrev_b32 v118, 16, v187
    v_and_b32 v119, 0xffff0000, v187
    v_pk_mul_f32 v[116:117], v[116:117], v[40:41]
    v_pk_mul_f32 v[118:119], v[118:119], v[42:43]
    s_add_u32 s52, s51, 0xd4000
    v_cvt_pk_bf16_f32 v116, 0, v116
    v_cvt_pk_bf16_f32 v117, 0, v117
    v_cvt_pk_bf16_f32 v118, 0, v118
    v_cvt_pk_bf16_f32 v119, 0, v119
    v_pk_add_f32 v[100:101], v[100:101], v[116:117]
    v_pk_add_f32 v[102:103], v[102:103], v[118:119]
    buffer_store_dwordx4 v[100:103], v25, s[12:15], s52 offen
    v_lshlrev_b32 v112, 16, v188
    v_and_b32 v113, 0xffff0000, v188
    v_lshlrev_b32 v114, 16, v189
    v_and_b32 v115, 0xffff0000, v189
    v_pk_mul_f32 v[112:113], v[112:113], v[40:41]
    v_pk_mul_f32 v[114:115], v[114:115], v[42:43]
    s_add_u32 s52, s51, 0xd8000
    v_cvt_pk_bf16_f32 v112, 0, v112
    v_cvt_pk_bf16_f32 v113, 0, v113
    v_cvt_pk_bf16_f32 v114, 0, v114
    v_cvt_pk_bf16_f32 v115, 0, v115
    v_pk_add_f32 v[104:105], v[104:105], v[112:113]
    v_pk_add_f32 v[106:107], v[106:107], v[114:115]
    buffer_store_dwordx4 v[104:107], v25, s[12:15], s52 offen
    v_lshlrev_b32 v116, 16, v190
    v_and_b32 v117, 0xffff0000, v190
    v_lshlrev_b32 v118, 16, v191
    v_and_b32 v119, 0xffff0000, v191
    v_pk_mul_f32 v[116:117], v[116:117], v[40:41]
    v_pk_mul_f32 v[118:119], v[118:119], v[42:43]
    s_add_u32 s52, s51, 0xdc000
    v_cvt_pk_bf16_f32 v116, 0, v116
    v_cvt_pk_bf16_f32 v117, 0, v117
    v_cvt_pk_bf16_f32 v118, 0, v118
    v_cvt_pk_bf16_f32 v119, 0, v119
    v_pk_add_f32 v[108:109], v[108:109], v[116:117]
    v_pk_add_f32 v[110:111], v[110:111], v[118:119]
    buffer_store_dwordx4 v[108:111], v25, s[12:15], s52 offen
    s_add_u32 s53, s50, 0x2c000
    buffer_load_dwordx2 v[240:241], v24, s[8:11], s53 offen
    s_add_u32 s53, s50, 0x2d000
    buffer_load_dwordx2 v[242:243], v24, s[8:11], s53 offen
    s_add_u32 s53, s50, 0x2e000
    buffer_load_dwordx2 v[244:245], v24, s[8:11], s53 offen
    s_add_u32 s53, s50, 0x2f000
    buffer_load_dwordx2 v[246:247], v24, s[8:11], s53 offen
    s_add_u32 s53, s50, 0x3c000
    buffer_load_dwordx2 v[248:249], v24, s[8:11], s53 offen
    s_add_u32 s53, s50, 0x3d000
    buffer_load_dwordx2 v[250:251], v24, s[8:11], s53 offen
    s_add_u32 s53, s50, 0x3e000
    buffer_load_dwordx2 v[252:253], v24, s[8:11], s53 offen
    s_add_u32 s53, s50, 0x3f000
    buffer_load_dwordx2 v[254:255], v24, s[8:11], s53 offen
    s_waitcnt vmcnt(48) lgkmcnt(8)
    ds_read_b128 v[80:83], v28 offset:8448
    ds_read_b128 v[84:87], v28 offset:9504
    ds_read_b128 v[88:91], v28 offset:10560
    ds_read_b128 v[92:95], v28 offset:11616
    ds_read_b128 v[96:99], v28 offset:12672
    ds_read_b128 v[100:103], v28 offset:13728
    ds_read_b128 v[104:107], v28 offset:14784
    ds_read_b128 v[108:111], v28 offset:15840
    ds_write_b128 v27, a[24:27] offset:16896
    ds_write_b128 v27, a[56:59] offset:16960
    ds_write_b128 v27, a[88:91] offset:17024
    ds_write_b128 v27, a[120:123] offset:17088
    ds_write_b128 v27, a[152:155] offset:17152
    ds_write_b128 v27, a[184:187] offset:17216
    ds_write_b128 v27, a[216:219] offset:17280
    ds_write_b128 v27, a[248:251] offset:17344
    v_lshlrev_b32 v112, 16, v192
    v_and_b32 v113, 0xffff0000, v192
    v_lshlrev_b32 v114, 16, v193
    v_and_b32 v115, 0xffff0000, v193
    v_pk_mul_f32 v[112:113], v[112:113], v[40:41]
    v_pk_mul_f32 v[114:115], v[114:115], v[42:43]
    s_add_u32 s52, s51, 0x20000
    v_cvt_pk_bf16_f32 v112, 0, v112
    v_cvt_pk_bf16_f32 v113, 0, v113
    v_cvt_pk_bf16_f32 v114, 0, v114
    v_cvt_pk_bf16_f32 v115, 0, v115
    v_pk_add_f32 v[48:49], v[48:49], v[112:113]
    v_pk_add_f32 v[50:51], v[50:51], v[114:115]
    buffer_store_dwordx4 v[48:51], v25, s[12:15], s52 offen
    v_lshlrev_b32 v116, 16, v194
    v_and_b32 v117, 0xffff0000, v194
    v_lshlrev_b32 v118, 16, v195
    v_and_b32 v119, 0xffff0000, v195
    v_pk_mul_f32 v[116:117], v[116:117], v[40:41]
    v_pk_mul_f32 v[118:119], v[118:119], v[42:43]
    s_add_u32 s52, s51, 0x24000
    v_cvt_pk_bf16_f32 v116, 0, v116
    v_cvt_pk_bf16_f32 v117, 0, v117
    v_cvt_pk_bf16_f32 v118, 0, v118
    v_cvt_pk_bf16_f32 v119, 0, v119
    v_pk_add_f32 v[52:53], v[52:53], v[116:117]
    v_pk_add_f32 v[54:55], v[54:55], v[118:119]
    buffer_store_dwordx4 v[52:55], v25, s[12:15], s52 offen
    v_lshlrev_b32 v112, 16, v196
    v_and_b32 v113, 0xffff0000, v196
    v_lshlrev_b32 v114, 16, v197
    v_and_b32 v115, 0xffff0000, v197
    v_pk_mul_f32 v[112:113], v[112:113], v[40:41]
    v_pk_mul_f32 v[114:115], v[114:115], v[42:43]
    s_add_u32 s52, s51, 0x28000
    v_cvt_pk_bf16_f32 v112, 0, v112
    v_cvt_pk_bf16_f32 v113, 0, v113
    v_cvt_pk_bf16_f32 v114, 0, v114
    v_cvt_pk_bf16_f32 v115, 0, v115
    v_pk_add_f32 v[56:57], v[56:57], v[112:113]
    v_pk_add_f32 v[58:59], v[58:59], v[114:115]
    buffer_store_dwordx4 v[56:59], v25, s[12:15], s52 offen
    v_lshlrev_b32 v116, 16, v198
    v_and_b32 v117, 0xffff0000, v198
    v_lshlrev_b32 v118, 16, v199
    v_and_b32 v119, 0xffff0000, v199
    v_pk_mul_f32 v[116:117], v[116:117], v[40:41]
    v_pk_mul_f32 v[118:119], v[118:119], v[42:43]
    s_add_u32 s52, s51, 0x2c000
    v_cvt_pk_bf16_f32 v116, 0, v116
    v_cvt_pk_bf16_f32 v117, 0, v117
    v_cvt_pk_bf16_f32 v118, 0, v118
    v_cvt_pk_bf16_f32 v119, 0, v119
    v_pk_add_f32 v[60:61], v[60:61], v[116:117]
    v_pk_add_f32 v[62:63], v[62:63], v[118:119]
    buffer_store_dwordx4 v[60:63], v25, s[12:15], s52 offen
    v_lshlrev_b32 v112, 16, v200
    v_and_b32 v113, 0xffff0000, v200
    v_lshlrev_b32 v114, 16, v201
    v_and_b32 v115, 0xffff0000, v201
    v_pk_mul_f32 v[112:113], v[112:113], v[40:41]
    v_pk_mul_f32 v[114:115], v[114:115], v[42:43]
    s_add_u32 s52, s51, 0x60000
    v_cvt_pk_bf16_f32 v112, 0, v112
    v_cvt_pk_bf16_f32 v113, 0, v113
    v_cvt_pk_bf16_f32 v114, 0, v114
    v_cvt_pk_bf16_f32 v115, 0, v115
    v_pk_add_f32 v[64:65], v[64:65], v[112:113]
    v_pk_add_f32 v[66:67], v[66:67], v[114:115]
    buffer_store_dwordx4 v[64:67], v25, s[12:15], s52 offen
    v_lshlrev_b32 v116, 16, v202
    v_and_b32 v117, 0xffff0000, v202
    v_lshlrev_b32 v118, 16, v203
    v_and_b32 v119, 0xffff0000, v203
    v_pk_mul_f32 v[116:117], v[116:117], v[40:41]
    v_pk_mul_f32 v[118:119], v[118:119], v[42:43]
    s_add_u32 s52, s51, 0x64000
    v_cvt_pk_bf16_f32 v116, 0, v116
    v_cvt_pk_bf16_f32 v117, 0, v117
    v_cvt_pk_bf16_f32 v118, 0, v118
    v_cvt_pk_bf16_f32 v119, 0, v119
    v_pk_add_f32 v[68:69], v[68:69], v[116:117]
    v_pk_add_f32 v[70:71], v[70:71], v[118:119]
    buffer_store_dwordx4 v[68:71], v25, s[12:15], s52 offen
    v_lshlrev_b32 v112, 16, v204
    v_and_b32 v113, 0xffff0000, v204
    v_lshlrev_b32 v114, 16, v205
    v_and_b32 v115, 0xffff0000, v205
    v_pk_mul_f32 v[112:113], v[112:113], v[40:41]
    v_pk_mul_f32 v[114:115], v[114:115], v[42:43]
    s_add_u32 s52, s51, 0x68000
    v_cvt_pk_bf16_f32 v112, 0, v112
    v_cvt_pk_bf16_f32 v113, 0, v113
    v_cvt_pk_bf16_f32 v114, 0, v114
    v_cvt_pk_bf16_f32 v115, 0, v115
    v_pk_add_f32 v[72:73], v[72:73], v[112:113]
    v_pk_add_f32 v[74:75], v[74:75], v[114:115]
    buffer_store_dwordx4 v[72:75], v25, s[12:15], s52 offen
    v_lshlrev_b32 v116, 16, v206
    v_and_b32 v117, 0xffff0000, v206
    v_lshlrev_b32 v118, 16, v207
    v_and_b32 v119, 0xffff0000, v207
    v_pk_mul_f32 v[116:117], v[116:117], v[40:41]
    v_pk_mul_f32 v[118:119], v[118:119], v[42:43]
    s_add_u32 s52, s51, 0x6c000
    v_cvt_pk_bf16_f32 v116, 0, v116
    v_cvt_pk_bf16_f32 v117, 0, v117
    v_cvt_pk_bf16_f32 v118, 0, v118
    v_cvt_pk_bf16_f32 v119, 0, v119
    v_pk_add_f32 v[76:77], v[76:77], v[116:117]
    v_pk_add_f32 v[78:79], v[78:79], v[118:119]
    buffer_store_dwordx4 v[76:79], v25, s[12:15], s52 offen
    s_waitcnt vmcnt(40) lgkmcnt(8)
    ds_read_b128 v[48:51], v28 offset:16896
    ds_read_b128 v[52:55], v28 offset:17952
    ds_read_b128 v[56:59], v28 offset:19008
    ds_read_b128 v[60:63], v28 offset:20064
    ds_read_b128 v[64:67], v28 offset:21120
    ds_read_b128 v[68:71], v28 offset:22176
    ds_read_b128 v[72:75], v28 offset:23232
    ds_read_b128 v[76:79], v28 offset:24288
    ds_write_b128 v27, a[28:31] offset:25344
    ds_write_b128 v27, a[60:63] offset:25408
    ds_write_b128 v27, a[92:95] offset:25472
    ds_write_b128 v27, a[124:127] offset:25536
    ds_write_b128 v27, a[156:159] offset:25600
    ds_write_b128 v27, a[188:191] offset:25664
    ds_write_b128 v27, a[220:223] offset:25728
    ds_write_b128 v27, a[252:255] offset:25792
    v_lshlrev_b32 v112, 16, v208
    v_and_b32 v113, 0xffff0000, v208
    v_lshlrev_b32 v114, 16, v209
    v_and_b32 v115, 0xffff0000, v209
    v_pk_mul_f32 v[112:113], v[112:113], v[40:41]
    v_pk_mul_f32 v[114:115], v[114:115], v[42:43]
    s_add_u32 s52, s51, 0xa0000
    v_cvt_pk_bf16_f32 v112, 0, v112
    v_cvt_pk_bf16_f32 v113, 0, v113
    v_cvt_pk_bf16_f32 v114, 0, v114
    v_cvt_pk_bf16_f32 v115, 0, v115
    v_pk_add_f32 v[80:81], v[80:81], v[112:113]
    v_pk_add_f32 v[82:83], v[82:83], v[114:115]
    buffer_store_dwordx4 v[80:83], v25, s[12:15], s52 offen
    v_lshlrev_b32 v116, 16, v210
    v_and_b32 v117, 0xffff0000, v210
    v_lshlrev_b32 v118, 16, v211
    v_and_b32 v119, 0xffff0000, v211
    v_pk_mul_f32 v[116:117], v[116:117], v[40:41]
    v_pk_mul_f32 v[118:119], v[118:119], v[42:43]
    s_add_u32 s52, s51, 0xa4000
    v_cvt_pk_bf16_f32 v116, 0, v116
    v_cvt_pk_bf16_f32 v117, 0, v117
    v_cvt_pk_bf16_f32 v118, 0, v118
    v_cvt_pk_bf16_f32 v119, 0, v119
    v_pk_add_f32 v[84:85], v[84:85], v[116:117]
    v_pk_add_f32 v[86:87], v[86:87], v[118:119]
    buffer_store_dwordx4 v[84:87], v25, s[12:15], s52 offen
    v_lshlrev_b32 v112, 16, v212
    v_and_b32 v113, 0xffff0000, v212
    v_lshlrev_b32 v114, 16, v213
    v_and_b32 v115, 0xffff0000, v213
    v_pk_mul_f32 v[112:113], v[112:113], v[40:41]
    v_pk_mul_f32 v[114:115], v[114:115], v[42:43]
    s_add_u32 s52, s51, 0xa8000
    v_cvt_pk_bf16_f32 v112, 0, v112
    v_cvt_pk_bf16_f32 v113, 0, v113
    v_cvt_pk_bf16_f32 v114, 0, v114
    v_cvt_pk_bf16_f32 v115, 0, v115
    v_pk_add_f32 v[88:89], v[88:89], v[112:113]
    v_pk_add_f32 v[90:91], v[90:91], v[114:115]
    buffer_store_dwordx4 v[88:91], v25, s[12:15], s52 offen
    v_lshlrev_b32 v116, 16, v214
    v_and_b32 v117, 0xffff0000, v214
    v_lshlrev_b32 v118, 16, v215
    v_and_b32 v119, 0xffff0000, v215
    v_pk_mul_f32 v[116:117], v[116:117], v[40:41]
    v_pk_mul_f32 v[118:119], v[118:119], v[42:43]
    s_add_u32 s52, s51, 0xac000
    v_cvt_pk_bf16_f32 v116, 0, v116
    v_cvt_pk_bf16_f32 v117, 0, v117
    v_cvt_pk_bf16_f32 v118, 0, v118
    v_cvt_pk_bf16_f32 v119, 0, v119
    v_pk_add_f32 v[92:93], v[92:93], v[116:117]
    v_pk_add_f32 v[94:95], v[94:95], v[118:119]
    buffer_store_dwordx4 v[92:95], v25, s[12:15], s52 offen
    v_lshlrev_b32 v112, 16, v216
    v_and_b32 v113, 0xffff0000, v216
    v_lshlrev_b32 v114, 16, v217
    v_and_b32 v115, 0xffff0000, v217
    v_pk_mul_f32 v[112:113], v[112:113], v[40:41]
    v_pk_mul_f32 v[114:115], v[114:115], v[42:43]
    s_add_u32 s52, s51, 0xe0000
    v_cvt_pk_bf16_f32 v112, 0, v112
    v_cvt_pk_bf16_f32 v113, 0, v113
    v_cvt_pk_bf16_f32 v114, 0, v114
    v_cvt_pk_bf16_f32 v115, 0, v115
    v_pk_add_f32 v[96:97], v[96:97], v[112:113]
    v_pk_add_f32 v[98:99], v[98:99], v[114:115]
    buffer_store_dwordx4 v[96:99], v25, s[12:15], s52 offen
    v_lshlrev_b32 v116, 16, v218
    v_and_b32 v117, 0xffff0000, v218
    v_lshlrev_b32 v118, 16, v219
    v_and_b32 v119, 0xffff0000, v219
    v_pk_mul_f32 v[116:117], v[116:117], v[40:41]
    v_pk_mul_f32 v[118:119], v[118:119], v[42:43]
    s_add_u32 s52, s51, 0xe4000
    v_cvt_pk_bf16_f32 v116, 0, v116
    v_cvt_pk_bf16_f32 v117, 0, v117
    v_cvt_pk_bf16_f32 v118, 0, v118
    v_cvt_pk_bf16_f32 v119, 0, v119
    v_pk_add_f32 v[100:101], v[100:101], v[116:117]
    v_pk_add_f32 v[102:103], v[102:103], v[118:119]
    buffer_store_dwordx4 v[100:103], v25, s[12:15], s52 offen
    v_lshlrev_b32 v112, 16, v220
    v_and_b32 v113, 0xffff0000, v220
    v_lshlrev_b32 v114, 16, v221
    v_and_b32 v115, 0xffff0000, v221
    v_pk_mul_f32 v[112:113], v[112:113], v[40:41]
    v_pk_mul_f32 v[114:115], v[114:115], v[42:43]
    s_add_u32 s52, s51, 0xe8000
    v_cvt_pk_bf16_f32 v112, 0, v112
    v_cvt_pk_bf16_f32 v113, 0, v113
    v_cvt_pk_bf16_f32 v114, 0, v114
    v_cvt_pk_bf16_f32 v115, 0, v115
    v_pk_add_f32 v[104:105], v[104:105], v[112:113]
    v_pk_add_f32 v[106:107], v[106:107], v[114:115]
    buffer_store_dwordx4 v[104:107], v25, s[12:15], s52 offen
    v_lshlrev_b32 v116, 16, v222
    v_and_b32 v117, 0xffff0000, v222
    v_lshlrev_b32 v118, 16, v223
    v_and_b32 v119, 0xffff0000, v223
    v_pk_mul_f32 v[116:117], v[116:117], v[40:41]
    v_pk_mul_f32 v[118:119], v[118:119], v[42:43]
    s_add_u32 s52, s51, 0xec000
    v_cvt_pk_bf16_f32 v116, 0, v116
    v_cvt_pk_bf16_f32 v117, 0, v117
    v_cvt_pk_bf16_f32 v118, 0, v118
    v_cvt_pk_bf16_f32 v119, 0, v119
    v_pk_add_f32 v[108:109], v[108:109], v[116:117]
    v_pk_add_f32 v[110:111], v[110:111], v[118:119]
    buffer_store_dwordx4 v[108:111], v25, s[12:15], s52 offen
    s_waitcnt vmcnt(32) lgkmcnt(8)
    ds_read_b128 v[80:83], v28 offset:25344
    ds_read_b128 v[84:87], v28 offset:26400
    ds_read_b128 v[88:91], v28 offset:27456
    ds_read_b128 v[92:95], v28 offset:28512
    ds_read_b128 v[96:99], v28 offset:29568
    ds_read_b128 v[100:103], v28 offset:30624
    ds_read_b128 v[104:107], v28 offset:31680
    ds_read_b128 v[108:111], v28 offset:32736
    v_lshlrev_b32 v112, 16, v224
    v_and_b32 v113, 0xffff0000, v224
    v_lshlrev_b32 v114, 16, v225
    v_and_b32 v115, 0xffff0000, v225
    v_pk_mul_f32 v[112:113], v[112:113], v[40:41]
    v_pk_mul_f32 v[114:115], v[114:115], v[42:43]
    s_add_u32 s52, s51, 0x30000
    v_cvt_pk_bf16_f32 v112, 0, v112
    v_cvt_pk_bf16_f32 v113, 0, v113
    v_cvt_pk_bf16_f32 v114, 0, v114
    v_cvt_pk_bf16_f32 v115, 0, v115
    v_pk_add_f32 v[48:49], v[48:49], v[112:113]
    v_pk_add_f32 v[50:51], v[50:51], v[114:115]
    buffer_store_dwordx4 v[48:51], v25, s[12:15], s52 offen
    v_lshlrev_b32 v116, 16, v226
    v_and_b32 v117, 0xffff0000, v226
    v_lshlrev_b32 v118, 16, v227
    v_and_b32 v119, 0xffff0000, v227
    v_pk_mul_f32 v[116:117], v[116:117], v[40:41]
    v_pk_mul_f32 v[118:119], v[118:119], v[42:43]
    s_add_u32 s52, s51, 0x34000
    v_cvt_pk_bf16_f32 v116, 0, v116
    v_cvt_pk_bf16_f32 v117, 0, v117
    v_cvt_pk_bf16_f32 v118, 0, v118
    v_cvt_pk_bf16_f32 v119, 0, v119
    v_pk_add_f32 v[52:53], v[52:53], v[116:117]
    v_pk_add_f32 v[54:55], v[54:55], v[118:119]
    buffer_store_dwordx4 v[52:55], v25, s[12:15], s52 offen
    v_lshlrev_b32 v112, 16, v228
    v_and_b32 v113, 0xffff0000, v228
    v_lshlrev_b32 v114, 16, v229
    v_and_b32 v115, 0xffff0000, v229
    v_pk_mul_f32 v[112:113], v[112:113], v[40:41]
    v_pk_mul_f32 v[114:115], v[114:115], v[42:43]
    s_add_u32 s52, s51, 0x38000
    v_cvt_pk_bf16_f32 v112, 0, v112
    v_cvt_pk_bf16_f32 v113, 0, v113
    v_cvt_pk_bf16_f32 v114, 0, v114
    v_cvt_pk_bf16_f32 v115, 0, v115
    v_pk_add_f32 v[56:57], v[56:57], v[112:113]
    v_pk_add_f32 v[58:59], v[58:59], v[114:115]
    buffer_store_dwordx4 v[56:59], v25, s[12:15], s52 offen
    v_lshlrev_b32 v116, 16, v230
    v_and_b32 v117, 0xffff0000, v230
    v_lshlrev_b32 v118, 16, v231
    v_and_b32 v119, 0xffff0000, v231
    v_pk_mul_f32 v[116:117], v[116:117], v[40:41]
    v_pk_mul_f32 v[118:119], v[118:119], v[42:43]
    s_add_u32 s52, s51, 0x3c000
    v_cvt_pk_bf16_f32 v116, 0, v116
    v_cvt_pk_bf16_f32 v117, 0, v117
    v_cvt_pk_bf16_f32 v118, 0, v118
    v_cvt_pk_bf16_f32 v119, 0, v119
    v_pk_add_f32 v[60:61], v[60:61], v[116:117]
    v_pk_add_f32 v[62:63], v[62:63], v[118:119]
    buffer_store_dwordx4 v[60:63], v25, s[12:15], s52 offen
    v_lshlrev_b32 v112, 16, v232
    v_and_b32 v113, 0xffff0000, v232
    v_lshlrev_b32 v114, 16, v233
    v_and_b32 v115, 0xffff0000, v233
    v_pk_mul_f32 v[112:113], v[112:113], v[40:41]
    v_pk_mul_f32 v[114:115], v[114:115], v[42:43]
    s_add_u32 s52, s51, 0x70000
    v_cvt_pk_bf16_f32 v112, 0, v112
    v_cvt_pk_bf16_f32 v113, 0, v113
    v_cvt_pk_bf16_f32 v114, 0, v114
    v_cvt_pk_bf16_f32 v115, 0, v115
    v_pk_add_f32 v[64:65], v[64:65], v[112:113]
    v_pk_add_f32 v[66:67], v[66:67], v[114:115]
    buffer_store_dwordx4 v[64:67], v25, s[12:15], s52 offen
    v_lshlrev_b32 v116, 16, v234
    v_and_b32 v117, 0xffff0000, v234
    v_lshlrev_b32 v118, 16, v235
    v_and_b32 v119, 0xffff0000, v235
    v_pk_mul_f32 v[116:117], v[116:117], v[40:41]
    v_pk_mul_f32 v[118:119], v[118:119], v[42:43]
    s_add_u32 s52, s51, 0x74000
    v_cvt_pk_bf16_f32 v116, 0, v116
    v_cvt_pk_bf16_f32 v117, 0, v117
    v_cvt_pk_bf16_f32 v118, 0, v118
    v_cvt_pk_bf16_f32 v119, 0, v119
    v_pk_add_f32 v[68:69], v[68:69], v[116:117]
    v_pk_add_f32 v[70:71], v[70:71], v[118:119]
    buffer_store_dwordx4 v[68:71], v25, s[12:15], s52 offen
    v_lshlrev_b32 v112, 16, v236
    v_and_b32 v113, 0xffff0000, v236
    v_lshlrev_b32 v114, 16, v237
    v_and_b32 v115, 0xffff0000, v237
    v_pk_mul_f32 v[112:113], v[112:113], v[40:41]
    v_pk_mul_f32 v[114:115], v[114:115], v[42:43]
    s_add_u32 s52, s51, 0x78000
    v_cvt_pk_bf16_f32 v112, 0, v112
    v_cvt_pk_bf16_f32 v113, 0, v113
    v_cvt_pk_bf16_f32 v114, 0, v114
    v_cvt_pk_bf16_f32 v115, 0, v115
    v_pk_add_f32 v[72:73], v[72:73], v[112:113]
    v_pk_add_f32 v[74:75], v[74:75], v[114:115]
    buffer_store_dwordx4 v[72:75], v25, s[12:15], s52 offen
    v_lshlrev_b32 v116, 16, v238
    v_and_b32 v117, 0xffff0000, v238
    v_lshlrev_b32 v118, 16, v239
    v_and_b32 v119, 0xffff0000, v239
    v_pk_mul_f32 v[116:117], v[116:117], v[40:41]
    v_pk_mul_f32 v[118:119], v[118:119], v[42:43]
    s_add_u32 s52, s51, 0x7c000
    v_cvt_pk_bf16_f32 v116, 0, v116
    v_cvt_pk_bf16_f32 v117, 0, v117
    v_cvt_pk_bf16_f32 v118, 0, v118
    v_cvt_pk_bf16_f32 v119, 0, v119
    v_pk_add_f32 v[76:77], v[76:77], v[116:117]
    v_pk_add_f32 v[78:79], v[78:79], v[118:119]
    buffer_store_dwordx4 v[76:79], v25, s[12:15], s52 offen
    s_waitcnt vmcnt(24) lgkmcnt(0)
    v_lshlrev_b32 v112, 16, v240
    v_and_b32 v113, 0xffff0000, v240
    v_lshlrev_b32 v114, 16, v241
    v_and_b32 v115, 0xffff0000, v241
    v_pk_mul_f32 v[112:113], v[112:113], v[40:41]
    v_pk_mul_f32 v[114:115], v[114:115], v[42:43]
    s_add_u32 s52, s51, 0xb0000
    v_cvt_pk_bf16_f32 v112, 0, v112
    v_cvt_pk_bf16_f32 v113, 0, v113
    v_cvt_pk_bf16_f32 v114, 0, v114
    v_cvt_pk_bf16_f32 v115, 0, v115
    v_pk_add_f32 v[80:81], v[80:81], v[112:113]
    v_pk_add_f32 v[82:83], v[82:83], v[114:115]
    buffer_store_dwordx4 v[80:83], v25, s[12:15], s52 offen
    v_lshlrev_b32 v116, 16, v242
    v_and_b32 v117, 0xffff0000, v242
    v_lshlrev_b32 v118, 16, v243
    v_and_b32 v119, 0xffff0000, v243
    v_pk_mul_f32 v[116:117], v[116:117], v[40:41]
    v_pk_mul_f32 v[118:119], v[118:119], v[42:43]
    s_add_u32 s52, s51, 0xb4000
    v_cvt_pk_bf16_f32 v116, 0, v116
    v_cvt_pk_bf16_f32 v117, 0, v117
    v_cvt_pk_bf16_f32 v118, 0, v118
    v_cvt_pk_bf16_f32 v119, 0, v119
    v_pk_add_f32 v[84:85], v[84:85], v[116:117]
    v_pk_add_f32 v[86:87], v[86:87], v[118:119]
    buffer_store_dwordx4 v[84:87], v25, s[12:15], s52 offen
    v_lshlrev_b32 v112, 16, v244
    v_and_b32 v113, 0xffff0000, v244
    v_lshlrev_b32 v114, 16, v245
    v_and_b32 v115, 0xffff0000, v245
    v_pk_mul_f32 v[112:113], v[112:113], v[40:41]
    v_pk_mul_f32 v[114:115], v[114:115], v[42:43]
    s_add_u32 s52, s51, 0xb8000
    v_cvt_pk_bf16_f32 v112, 0, v112
    v_cvt_pk_bf16_f32 v113, 0, v113
    v_cvt_pk_bf16_f32 v114, 0, v114
    v_cvt_pk_bf16_f32 v115, 0, v115
    v_pk_add_f32 v[88:89], v[88:89], v[112:113]
    v_pk_add_f32 v[90:91], v[90:91], v[114:115]
    buffer_store_dwordx4 v[88:91], v25, s[12:15], s52 offen
    v_lshlrev_b32 v116, 16, v246
    v_and_b32 v117, 0xffff0000, v246
    v_lshlrev_b32 v118, 16, v247
    v_and_b32 v119, 0xffff0000, v247
    v_pk_mul_f32 v[116:117], v[116:117], v[40:41]
    v_pk_mul_f32 v[118:119], v[118:119], v[42:43]
    s_add_u32 s52, s51, 0xbc000
    v_cvt_pk_bf16_f32 v116, 0, v116
    v_cvt_pk_bf16_f32 v117, 0, v117
    v_cvt_pk_bf16_f32 v118, 0, v118
    v_cvt_pk_bf16_f32 v119, 0, v119
    v_pk_add_f32 v[92:93], v[92:93], v[116:117]
    v_pk_add_f32 v[94:95], v[94:95], v[118:119]
    buffer_store_dwordx4 v[92:95], v25, s[12:15], s52 offen
    v_lshlrev_b32 v112, 16, v248
    v_and_b32 v113, 0xffff0000, v248
    v_lshlrev_b32 v114, 16, v249
    v_and_b32 v115, 0xffff0000, v249
    v_pk_mul_f32 v[112:113], v[112:113], v[40:41]
    v_pk_mul_f32 v[114:115], v[114:115], v[42:43]
    s_add_u32 s52, s51, 0xf0000
    v_cvt_pk_bf16_f32 v112, 0, v112
    v_cvt_pk_bf16_f32 v113, 0, v113
    v_cvt_pk_bf16_f32 v114, 0, v114
    v_cvt_pk_bf16_f32 v115, 0, v115
    v_pk_add_f32 v[96:97], v[96:97], v[112:113]
    v_pk_add_f32 v[98:99], v[98:99], v[114:115]
    buffer_store_dwordx4 v[96:99], v25, s[12:15], s52 offen
    v_lshlrev_b32 v116, 16, v250
    v_and_b32 v117, 0xffff0000, v250
    v_lshlrev_b32 v118, 16, v251
    v_and_b32 v119, 0xffff0000, v251
    v_pk_mul_f32 v[116:117], v[116:117], v[40:41]
    v_pk_mul_f32 v[118:119], v[118:119], v[42:43]
    s_add_u32 s52, s51, 0xf4000
    v_cvt_pk_bf16_f32 v116, 0, v116
    v_cvt_pk_bf16_f32 v117, 0, v117
    v_cvt_pk_bf16_f32 v118, 0, v118
    v_cvt_pk_bf16_f32 v119, 0, v119
    v_pk_add_f32 v[100:101], v[100:101], v[116:117]
    v_pk_add_f32 v[102:103], v[102:103], v[118:119]
    buffer_store_dwordx4 v[100:103], v25, s[12:15], s52 offen
    v_lshlrev_b32 v112, 16, v252
    v_and_b32 v113, 0xffff0000, v252
    v_lshlrev_b32 v114, 16, v253
    v_and_b32 v115, 0xffff0000, v253
    v_pk_mul_f32 v[112:113], v[112:113], v[40:41]
    v_pk_mul_f32 v[114:115], v[114:115], v[42:43]
    s_add_u32 s52, s51, 0xf8000
    v_cvt_pk_bf16_f32 v112, 0, v112
    v_cvt_pk_bf16_f32 v113, 0, v113
    v_cvt_pk_bf16_f32 v114, 0, v114
    v_cvt_pk_bf16_f32 v115, 0, v115
    v_pk_add_f32 v[104:105], v[104:105], v[112:113]
    v_pk_add_f32 v[106:107], v[106:107], v[114:115]
    buffer_store_dwordx4 v[104:107], v25, s[12:15], s52 offen
    v_lshlrev_b32 v116, 16, v254
    v_and_b32 v117, 0xffff0000, v254
    v_lshlrev_b32 v118, 16, v255
    v_and_b32 v119, 0xffff0000, v255
    v_pk_mul_f32 v[116:117], v[116:117], v[40:41]
    v_pk_mul_f32 v[118:119], v[118:119], v[42:43]
    s_add_u32 s52, s51, 0xfc000
    v_cvt_pk_bf16_f32 v116, 0, v116
    v_cvt_pk_bf16_f32 v117, 0, v117
    v_cvt_pk_bf16_f32 v118, 0, v118
    v_cvt_pk_bf16_f32 v119, 0, v119
    v_pk_add_f32 v[108:109], v[108:109], v[116:117]
    v_pk_add_f32 v[110:111], v[110:111], v[118:119]
    buffer_store_dwordx4 v[108:111], v25, s[12:15], s52 offen
chain_kernel_seg:
    s_xor_b32 s57, s57, 2
    s_waitcnt vmcnt(0) lgkmcnt(0)
    s_barrier
    s_mov_b32 s12, s92
    s_and_b32 s13, s93, 0xffff
    s_mov_b32 s14, 0x800000
    s_mov_b32 s15, 0x00020000
    s_lshr_b32 s60, s57, 3
    s_lshl_b32 s28, s60, 21
    s_and_b32 s60, s57, 7
    s_lshl_b32 s60, s60, 8
    s_add_u32 s28, s28, s60
    v_bfe_u32 v24, v0, 4, 3
    v_lshlrev_b32 v24, 1, v24
    v_and_b32 v25, 15, v0
    v_xor_b32 v24, v24, v25
    v_lshlrev_b32 v6, 4, v24
    v_bfe_u32 v24, v0, 4, 2
    v_lshl_add_u32 v6, v24, 11, v6
    v_bfe_u32 v24, v0, 6, 1
    v_lshl_add_u32 v6, v24, 13, v6
    v_bfe_u32 v24, v0, 7, 1
    v_lshl_add_u32 v6, v24, 15, v6
    s_and_b32 s60, s58, 1
    s_lshl_b32 s61, s60, 11
    s_lshr_b32 s60, s58, 1
    s_lshl_b32 s60, s60, 10
    s_add_u32 s32, s60, s61
    s_andn2_b32 s60, 8, s57
    s_lshl_b32 s60, s60, 2
    v_bfe_u32 v24, v0, 2, 3
    v_lshrrev_b32 v25, 6, v0
    v_lshlrev_b32 v25, 1, v25
    v_xor_b32 v24, v24, v25
    v_lshlrev_b32 v8, 5, v24
    v_bfe_u32 v24, v0, 0, 2
    v_lshl_add_u32 v8, v24, 3, v8
    v_bfe_u32 v24, v0, 2, 2
    v_lshl_add_u32 v8, v24, 8, v8
    v_bfe_u32 v24, v0, 4, 2
    v_lshl_add_u32 v8, v24, 11, v8
    v_xor_b32 v8, s60, v8
    v_xor_b32 v9, 32, v8
    s_cmp_eq_u32 s56, 0
    s_cbranch_scc1 seg_w0
    v_and_b32 v26, 63, v0
    v_lshl_add_u32 v26, v26, 4, s32
    s_add_u32 m0, s32, 32768
    s_add_u32 s61, s28, 0x100000
    buffer_load_dwordx4 v6, s[12:15], s61 offen nt lds
    s_add_u32 m0, s32, 36864
    s_add_u32 s61, s28, 0x104000
    buffer_load_dwordx4 v6, s[12:15], s61 offen nt lds
    s_add_u32 m0, s32, 40960
    s_add_u32 s61, s28, 0x110000
    buffer_load_dwordx4 v6, s[12:15], s61 offen nt lds
    s_add_u32 m0, s32, 45056
    s_add_u32 s61, s28, 0x114000
    buffer_load_dwordx4 v6, s[12:15], s61 offen nt lds
    s_add_u32 m0, s32, 49152
    s_add_u32 s61, s28, 0x120000
    buffer_load_dwordx4 v6, s[12:15], s61 offen nt lds
    s_add_u32 m0, s32, 53248
    s_add_u32 s61, s28, 0x124000
    buffer_load_dwordx4 v6, s[12:15], s61 offen nt lds
    s_add_u32 m0, s32, 57344
    s_add_u32 s61, s28, 0x130000
    buffer_load_dwordx4 v6, s[12:15], s61 offen nt lds
    s_add_u32 m0, s32, 61440
    s_add_u32 s61, s28, 0x134000
    buffer_load_dwordx4 v6, s[12:15], s61 offen nt lds
    ds_write_b128 v26, v[128:131] offset:0
    ds_write_b128 v26, v[132:135] offset:4096
    ds_write_b128 v26, v[136:139] offset:8192
    ds_write_b128 v26, v[140:143] offset:12288
    ds_write_b128 v26, v[144:147] offset:16384
    ds_write_b128 v26, v[148:151] offset:20480
    ds_write_b128 v26, v[152:155] offset:24576
    ds_write_b128 v26, v[156:159] offset:28672
    s_waitcnt lgkmcnt(0)
    s_barrier
    ds_read_b64_tr_b16 a[0:1], v8 offset:0
    ds_read_b64_tr_b16 a[2:3], v8 offset:1024
    ds_read_b64_tr_b16 a[4:5], v9 offset:0
    ds_read_b64_tr_b16 a[6:7], v9 offset:1024
    ds_read_b64_tr_b16 a[8:9], v8 offset:8192
    ds_read_b64_tr_b16 a[10:11], v8 offset:9216
    ds_read_b64_tr_b16 a[12:13], v9 offset:8192
    ds_read_b64_tr_b16 a[14:15], v9 offset:9216
    s_waitcnt lgkmcnt(0)
    ds_read_b64_tr_b16 a[16:17], v8 offset:16384
    ds_read_b64_tr_b16 a[18:19], v8 offset:17408
    ds_read_b64_tr_b16 a[20:21], v9 offset:16384
    ds_read_b64_tr_b16 a[22:23], v9 offset:17408
    ds_read_b64_tr_b16 a[24:25], v8 offset:24576
    ds_read_b64_tr_b16 a[26:27], v8 offset:25600
    ds_read_b64_tr_b16 a[28:29], v9 offset:24576
    ds_read_b64_tr_b16 a[30:31], v9 offset:25600
    s_waitcnt lgkmcnt(0)
    s_barrier
    s_add_u32 m0, s32, 65536
    s_add_u32 s61, s28, 0x140000
    buffer_load_dwordx4 v6, s[12:15], s61 offen nt lds
    s_add_u32 m0, s32, 69632
    s_add_u32 s61, s28, 0x144000
    buffer_load_dwordx4 v6, s[12:15], s61 offen nt lds
    s_add_u32 m0, s32, 73728
    s_add_u32 s61, s28, 0x150000
    buffer_load_dwordx4 v6, s[12:15], s61 offen nt lds
    s_add_u32 m0, s32, 77824
    s_add_u32 s61, s28, 0x154000
    buffer_load_dwordx4 v6, s[12:15], s61 offen nt lds
    s_add_u32 m0, s32, 81920
    s_add_u32 s61, s28, 0x160000
    buffer_load_dwordx4 v6, s[12:15], s61 offen nt lds
    s_add_u32 m0, s32, 86016
    s_add_u32 s61, s28, 0x164000
    buffer_load_dwordx4 v6, s[12:15], s61 offen nt lds
    s_add_u32 m0, s32, 90112
    s_add_u32 s61, s28, 0x170000
    buffer_load_dwordx4 v6, s[12:15], s61 offen nt lds
    s_add_u32 m0, s32, 94208
    s_add_u32 s61, s28, 0x174000
    buffer_load_dwordx4 v6, s[12:15], s61 offen nt lds
    ds_write_b128 v26, v[160:163] offset:0
    ds_write_b128 v26, v[164:167] offset:4096
    ds_write_b128 v26, v[168:171] offset:8192
    ds_write_b128 v26, v[172:175] offset:12288
    ds_write_b128 v26, v[176:179] offset:16384
    ds_write_b128 v26, v[180:183] offset:20480
    ds_write_b128 v26, v[184:187] offset:24576
    ds_write_b128 v26, v[188:191] offset:28672
    s_waitcnt lgkmcnt(0)
    s_barrier
    ds_read_b64_tr_b16 a[32:33], v8 offset:0
    ds_read_b64_tr_b16 a[34:35], v8 offset:1024
    ds_read_b64_tr_b16 a[36:37], v9 offset:0
    ds_read_b64_tr_b16 a[38:39], v9 offset:1024
    ds_read_b64_tr_b16 a[40:41], v8 offset:8192
    ds_read_b64_tr_b16 a[42:43], v8 offset:9216
    ds_read_b64_tr_b16 a[44:45], v9 offset:8192
    ds_read_b64_tr_b16 a[46:47], v9 offset:9216
    s_waitcnt lgkmcnt(0)
    ds_read_b64_tr_b16 a[48:49], v8 offset:16384
    ds_read_b64_tr_b16 a[50:51], v8 offset:17408
    ds_read_b64_tr_b16 a[52:53], v9 offset:16384
    ds_read_b64_tr_b16 a[54:55], v9 offset:17408
    ds_read_b64_tr_b16 a[56:57], v8 offset:24576
    ds_read_b64_tr_b16 a[58:59], v8 offset:25600
    ds_read_b64_tr_b16 a[60:61], v9 offset:24576
    ds_read_b64_tr_b16 a[62:63], v9 offset:25600
    s_waitcnt lgkmcnt(0)
    s_barrier
    s_add_u32 m0, s32, 98304
    s_add_u32 s61, s28, 0x180000
    buffer_load_dwordx4 v6, s[12:15], s61 offen nt lds
    s_add_u32 m0, s32, 102400
    s_add_u32 s61, s28, 0x184000
    buffer_load_dwordx4 v6, s[12:15], s61 offen nt lds
    s_add_u32 m0, s32, 106496
    s_add_u32 s61, s28, 0x190000
    buffer_load_dwordx4 v6, s[12:15], s61 offen nt lds
    s_add_u32 m0, s32, 110592
    s_add_u32 s61, s28, 0x194000
    buffer_load_dwordx4 v6, s[12:15], s61 offen nt lds
    s_add_u32 m0, s32, 114688
    s_add_u32 s61, s28, 0x1a0000
    buffer_load_dwordx4 v6, s[12:15], s61 offen nt lds
    s_add_u32 m0, s32, 118784
    s_add_u32 s61, s28, 0x1a4000
    buffer_load_dwordx4 v6, s[12:15], s61 offen nt lds
    s_add_u32 m0, s32, 122880
    s_add_u32 s61, s28, 0x1b0000
    buffer_load_dwordx4 v6, s[12:15], s61 offen nt lds
    s_add_u32 m0, s32, 126976
    s_add_u32 s61, s28, 0x1b4000
    buffer_load_dwordx4 v6, s[12:15], s61 offen nt lds
    ds_write_b128 v26, v[192:195] offset:0
    ds_write_b128 v26, v[196:199] offset:4096
    ds_write_b128 v26, v[200:203] offset:8192
    ds_write_b128 v26, v[204:207] offset:12288
    ds_write_b128 v26, v[208:211] offset:16384
    ds_write_b128 v26, v[212:215] offset:20480
    ds_write_b128 v26, v[216:219] offset:24576
    ds_write_b128 v26, v[220:223] offset:28672
    s_waitcnt lgkmcnt(0)
    s_barrier
    ds_read_b64_tr_b16 a[64:65], v8 offset:0
    ds_read_b64_tr_b16 a[66:67], v8 offset:1024
    ds_read_b64_tr_b16 a[68:69], v9 offset:0
    ds_read_b64_tr_b16 a[70:71], v9 offset:1024
    ds_read_b64_tr_b16 a[72:73], v8 offset:8192
    ds_read_b64_tr_b16 a[74:75], v8 offset:9216
    ds_read_b64_tr_b16 a[76:77], v9 offset:8192
    ds_read_b64_tr_b16 a[78:79], v9 offset:9216
    s_waitcnt lgkmcnt(0)
    ds_read_b64_tr_b16 a[80:81], v8 offset:16384
    ds_read_b64_tr_b16 a[82:83], v8 offset:17408
    ds_read_b64_tr_b16 a[84:85], v9 offset:16384
    ds_read_b64_tr_b16 a[86:87], v9 offset:17408
    ds_read_b64_tr_b16 a[88:89], v8 offset:24576
    ds_read_b64_tr_b16 a[90:91], v8 offset:25600
    ds_read_b64_tr_b16 a[92:93], v9 offset:24576
    ds_read_b64_tr_b16 a[94:95], v9 offset:25600
    s_waitcnt lgkmcnt(0)
    s_barrier
    s_add_u32 m0, s32, 131072
    s_add_u32 s61, s28, 0x1c0000
    buffer_load_dwordx4 v6, s[12:15], s61 offen nt lds
    s_add_u32 m0, s32, 135168
    s_add_u32 s61, s28, 0x1c4000
    buffer_load_dwordx4 v6, s[12:15], s61 offen nt lds
    s_add_u32 m0, s32, 139264
    s_add_u32 s61, s28, 0x1d0000
    buffer_load_dwordx4 v6, s[12:15], s61 offen nt lds
    s_add_u32 m0, s32, 143360
    s_add_u32 s61, s28, 0x1d4000
    buffer_load_dwordx4 v6, s[12:15], s61 offen nt lds
    s_add_u32 m0, s32, 147456
    s_add_u32 s61, s28, 0x1e0000
    buffer_load_dwordx4 v6, s[12:15], s61 offen nt lds
    s_add_u32 m0, s32, 151552
    s_add_u32 s61, s28, 0x1e4000
    buffer_load_dwordx4 v6, s[12:15], s61 offen nt lds
    s_add_u32 m0, s32, 155648
    s_add_u32 s61, s28, 0x1f0000
    buffer_load_dwordx4 v6, s[12:15], s61 offen nt lds
    s_add_u32 m0, s32, 159744
    s_add_u32 s61, s28, 0x1f4000
    buffer_load_dwordx4 v6, s[12:15], s61 offen nt lds
    ds_write_b128 v26, v[224:227] offset:0
    ds_write_b128 v26, v[228:231] offset:4096
    ds_write_b128 v26, v[232:235] offset:8192
    ds_write_b128 v26, v[236:239] offset:12288
    ds_write_b128 v26, v[240:243] offset:16384
    ds_write_b128 v26, v[244:247] offset:20480
    ds_write_b128 v26, v[248:251] offset:24576
    ds_write_b128 v26, v[252:255] offset:28672
    s_waitcnt lgkmcnt(0)
    s_barrier
    ds_read_b64_tr_b16 a[96:97], v8 offset:0
    ds_read_b64_tr_b16 a[98:99], v8 offset:1024
    ds_read_b64_tr_b16 a[100:101], v9 offset:0
    ds_read_b64_tr_b16 a[102:103], v9 offset:1024
    ds_read_b64_tr_b16 a[104:105], v8 offset:8192
    ds_read_b64_tr_b16 a[106:107], v8 offset:9216
    ds_read_b64_tr_b16 a[108:109], v9 offset:8192
    ds_read_b64_tr_b16 a[110:111], v9 offset:9216
    s_waitcnt lgkmcnt(0)
    ds_read_b64_tr_b16 a[112:113], v8 offset:16384
    ds_read_b64_tr_b16 a[114:115], v8 offset:17408
    ds_read_b64_tr_b16 a[116:117], v9 offset:16384
    ds_read_b64_tr_b16 a[118:119], v9 offset:17408
    ds_read_b64_tr_b16 a[120:121], v8 offset:24576
    ds_read_b64_tr_b16 a[122:123], v8 offset:25600
    ds_read_b64_tr_b16 a[124:125], v9 offset:24576
    ds_read_b64_tr_b16 a[126:127], v9 offset:25600
    s_waitcnt lgkmcnt(0)
    s_barrier
    s_mov_b32 s8, s100
    s_and_b32 s9, s101, 0xffff
    s_mov_b32 s10, 0xe000000
    s_mov_b32 s11, 0x00020000
    s_mov_b32 s16, s96
    s_and_b32 s17, s97, 0xffff
    s_mov_b32 s18, 0x1000000
    s_mov_b32 s19, 0x00020000
    v_and_b32 v24, 63, v0
    v_lshlrev_b32 v1, 4, v24
    v_add_u32 v2, 4096, v1
    v_lshlrev_b32 v10, 7, v24
    v_mov_b32 v11, 0
    s_lshl_b32 s60, s56, 8
    s_add_u32 s60, s60, 0xd200400
    s_lshl2_add_u32 s27, s57, s60
    s_and_b32 s38, s57, 7
    s_lshl_b32 s38, s38, 16
    s_cmp_eq_u32 s58, 0
    s_cselect_b32 s27, s27, 0xe000000
    s_cselect_b32 s38, s38, 0xe000000
    s_add_u32 s60, s60, s100
    s_addc_u32 s61, s101, 0
    v_and_b32 v25, 31, v0
    v_lshlrev_b32 v25, 2, v25
    v_add_u32 v16, s60, v25
    v_mov_b32 v17, s61
    s_add_u32 s60, s98, 208
    s_addc_u32 s61, s99, 0
    v_writelane_b32 v16, s60, 32
    v_writelane_b32 v17, s61, 32
    s_mov_b32 s26, 0
    s_mov_b32 s30, 0
    s_mov_b32 s40, 0
    s_mov_b32 s29, 32768
    v_and_b32 v24, 15, v0
    v_lshlrev_b32 v15, 13, v24
    v_bfe_u32 v24, v0, 4, 2
    v_lshl_add_u32 v15, v24, 4, v15
    s_lshr_b32 s60, s57, 4
    s_lshl_b32 s60, s60, 17
    s_and_b32 s61, s57, 7
    s_lshl_b32 s61, s61, 9
    s_add_u32 s60, s60, s61
    s_lshl_b32 s61, s58, 7
    s_add_u32 s60, s60, s61
    s_and_b32 s61, s57, 8
    s_lshl_b32 s61, s61, 3
    s_add_u32 s60, s60, s61
    s_add_u32 s60, s60, 4096
    v_add_u32 v15, s60, v15
    s_lshl_b32 s61, s58, 12
    s_xor_b32 s60, s57, 24
    s_lshl_b32 s60, s60, 14
    s_add_u32 s60, s60, s61
    s_add_u32 s60, s60, 0
    v_add_u32 v20, s60, v1
    s_xor_b32 s60, s57, 16
    s_lshl_b32 s60, s60, 14
    s_add_u32 s60, s60, s61
    s_add_u32 s60, s60, 1024
    v_add_u32 v21, s60, v1
    s_xor_b32 s60, s57, 8
    s_lshl_b32 s60, s60, 14
    s_add_u32 s60, s60, s61
    s_add_u32 s60, s60, 2048
    v_add_u32 v22, s60, v1
    s_xor_b32 s60, s57, 0
    s_lshl_b32 s60, s60, 14
    s_add_u32 s60, s60, s61
    s_add_u32 s60, s60, 0
    v_add_u32 v23, s60, v1
    s_lshl_b32 s24, s56, 20
    s_add_u32 s24, s24, 0xd800000
    s_and_b32 s60, s57, 24
    s_add_u32 s60, s60, s58
    s_lshl_b32 s31, s60, 16
    s_add_u32 s31, s31, 0xc000
    s_add_u32 s31, s31, s59
    s_mul_i32 s33, s56, 8
    s_lshr_b32 s33, 0x2010012, s33
    s_and_b32 s33, s33, 255
    s_mul_i32 s39, s56, 8
    s_lshr_b32 s39, 0xf10100a, s39
    s_and_b32 s39, s39, 255
    s_cmp_eq_u32 s56, 0
    s_cmov_b32 s36, 0x3c
    s_cmp_eq_u32 s56, 1
    s_cmov_b32 s36, 0x3d39
    s_cmp_eq_u32 s56, 2
    s_cmov_b32 s36, 0x3f3b
    s_cmp_eq_u32 s56, 3
    s_cmov_b32 s36, 0x3e3a
    s_waitcnt vmcnt(24)
    s_barrier
    ds_read_b64_tr_b16 a[128:129], v8 offset:32768
    ds_read_b64_tr_b16 a[130:131], v8 offset:33792
    ds_read_b64_tr_b16 a[132:133], v9 offset:32768
    ds_read_b64_tr_b16 a[134:135], v9 offset:33792
    ds_read_b64_tr_b16 a[136:137], v8 offset:40960
    ds_read_b64_tr_b16 a[138:139], v8 offset:41984
    ds_read_b64_tr_b16 a[140:141], v9 offset:40960
    ds_read_b64_tr_b16 a[142:143], v9 offset:41984
    s_waitcnt lgkmcnt(0)
    ds_read_b64_tr_b16 a[144:145], v8 offset:49152
    ds_read_b64_tr_b16 a[146:147], v8 offset:50176
    ds_read_b64_tr_b16 a[148:149], v9 offset:49152
    ds_read_b64_tr_b16 a[150:151], v9 offset:50176
    ds_read_b64_tr_b16 a[152:153], v8 offset:57344
    ds_read_b64_tr_b16 a[154:155], v8 offset:58368
    ds_read_b64_tr_b16 a[156:157], v9 offset:57344
    ds_read_b64_tr_b16 a[158:159], v9 offset:58368
    s_waitcnt lgkmcnt(0)
    s_waitcnt vmcnt(16)
    s_barrier
    v_add_u32 v8, 0x10000, v8
    v_add_u32 v9, 0x10000, v9
    ds_read_b64_tr_b16 a[160:161], v8 offset:0
    ds_read_b64_tr_b16 a[162:163], v8 offset:1024
    ds_read_b64_tr_b16 a[164:165], v9 offset:0
    ds_read_b64_tr_b16 a[166:167], v9 offset:1024
    ds_read_b64_tr_b16 a[168:169], v8 offset:8192
    ds_read_b64_tr_b16 a[170:171], v8 offset:9216
    ds_read_b64_tr_b16 a[172:173], v9 offset:8192
    ds_read_b64_tr_b16 a[174:175], v9 offset:9216
    s_waitcnt lgkmcnt(0)
    ds_read_b64_tr_b16 a[176:177], v8 offset:16384
    ds_read_b64_tr_b16 a[178:179], v8 offset:17408
    ds_read_b64_tr_b16 a[180:181], v9 offset:16384
    ds_read_b64_tr_b16 a[182:183], v9 offset:17408
    ds_read_b64_tr_b16 a[184:185], v8 offset:24576
    ds_read_b64_tr_b16 a[186:187], v8 offset:25600
    ds_read_b64_tr_b16 a[188:189], v9 offset:24576
    ds_read_b64_tr_b16 a[190:191], v9 offset:25600
    s_waitcnt lgkmcnt(0)
    s_waitcnt vmcnt(8)
    s_barrier
    ds_read_b64_tr_b16 a[192:193], v8 offset:32768
    ds_read_b64_tr_b16 a[194:195], v8 offset:33792
    ds_read_b64_tr_b16 a[196:197], v9 offset:32768
    ds_read_b64_tr_b16 a[198:199], v9 offset:33792
    ds_read_b64_tr_b16 a[200:201], v8 offset:40960
    ds_read_b64_tr_b16 a[202:203], v8 offset:41984
    ds_read_b64_tr_b16 a[204:205], v9 offset:40960
    ds_read_b64_tr_b16 a[206:207], v9 offset:41984
    s_waitcnt lgkmcnt(0)
    ds_read_b64_tr_b16 a[208:209], v8 offset:49152
    ds_read_b64_tr_b16 a[210:211], v8 offset:50176
    ds_read_b64_tr_b16 a[212:213], v9 offset:49152
    ds_read_b64_tr_b16 a[214:215], v9 offset:50176
    ds_read_b64_tr_b16 a[216:217], v8 offset:57344
    ds_read_b64_tr_b16 a[218:219], v8 offset:58368
    ds_read_b64_tr_b16 a[220:221], v9 offset:57344
    ds_read_b64_tr_b16 a[222:223], v9 offset:58368
    s_waitcnt lgkmcnt(0)
    s_waitcnt vmcnt(0)
    s_barrier
    v_add_u32 v8, 0x10000, v8
    v_add_u32 v9, 0x10000, v9
    ds_read_b64_tr_b16 a[224:225], v8 offset:0
    ds_read_b64_tr_b16 a[226:227], v8 offset:1024
    ds_read_b64_tr_b16 a[228:229], v9 offset:0
    ds_read_b64_tr_b16 a[230:231], v9 offset:1024
    ds_read_b64_tr_b16 a[232:233], v8 offset:8192
    ds_read_b64_tr_b16 a[234:235], v8 offset:9216
    ds_read_b64_tr_b16 a[236:237], v9 offset:8192
    ds_read_b64_tr_b16 a[238:239], v9 offset:9216
    s_waitcnt lgkmcnt(0)
    ds_read_b64_tr_b16 a[240:241], v8 offset:16384
    ds_read_b64_tr_b16 a[242:243], v8 offset:17408
    ds_read_b64_tr_b16 a[244:245], v9 offset:16384
    ds_read_b64_tr_b16 a[246:247], v9 offset:17408
    ds_read_b64_tr_b16 a[248:249], v8 offset:24576
    ds_read_b64_tr_b16 a[250:251], v8 offset:25600
    ds_read_b64_tr_b16 a[252:253], v9 offset:24576
    ds_read_b64_tr_b16 a[254:255], v9 offset:25600
    s_waitcnt lgkmcnt(0)
    s_branch seg_w1
seg_w0:
    s_add_u32 m0, s32, 0
    s_add_u32 s61, s28, 0x0
    buffer_load_dwordx4 v6, s[12:15], s61 offen nt lds
    s_add_u32 m0, s32, 4096
    s_add_u32 s61, s28, 0x4000
    buffer_load_dwordx4 v6, s[12:15], s61 offen nt lds
    s_add_u32 m0, s32, 8192
    s_add_u32 s61, s28, 0x10000
    buffer_load_dwordx4 v6, s[12:15], s61 offen nt lds
    s_add_u32 m0, s32, 12288
    s_add_u32 s61, s28, 0x14000
    buffer_load_dwordx4 v6, s[12:15], s61 offen nt lds
    s_add_u32 m0, s32, 16384
    s_add_u32 s61, s28, 0x20000
    buffer_load_dwordx4 v6, s[12:15], s61 offen nt lds
    s_add_u32 m0, s32, 20480
    s_add_u32 s61, s28, 0x24000
    buffer_load_dwordx4 v6, s[12:15], s61 offen nt lds
    s_add_u32 m0, s32, 24576
    s_add_u32 s61, s28, 0x30000
    buffer_load_dwordx4 v6, s[12:15], s61 offen nt lds
    s_add_u32 m0, s32, 28672
    s_add_u32 s61, s28, 0x34000
    buffer_load_dwordx4 v6, s[12:15], s61 offen nt lds
    s_add_u32 m0, s32, 32768
    s_add_u32 s61, s28, 0x40000
    buffer_load_dwordx4 v6, s[12:15], s61 offen nt lds
    s_add_u32 m0, s32, 36864
    s_add_u32 s61, s28, 0x44000
    buffer_load_dwordx4 v6, s[12:15], s61 offen nt lds
    s_add_u32 m0, s32, 40960
    s_add_u32 s61, s28, 0x50000
    buffer_load_dwordx4 v6, s[12:15], s61 offen nt lds
    s_add_u32 m0, s32, 45056
    s_add_u32 s61, s28, 0x54000
    buffer_load_dwordx4 v6, s[12:15], s61 offen nt lds
    s_add_u32 m0, s32, 49152
    s_add_u32 s61, s28, 0x60000
    buffer_load_dwordx4 v6, s[12:15], s61 offen nt lds
    s_add_u32 m0, s32, 53248
    s_add_u32 s61, s28, 0x64000
    buffer_load_dwordx4 v6, s[12:15], s61 offen nt lds
    s_add_u32 m0, s32, 57344
    s_add_u32 s61, s28, 0x70000
    buffer_load_dwordx4 v6, s[12:15], s61 offen nt lds
    s_add_u32 m0, s32, 61440
    s_add_u32 s61, s28, 0x74000
    buffer_load_dwordx4 v6, s[12:15], s61 offen nt lds
    s_add_u32 m0, s32, 65536
    s_add_u32 s61, s28, 0x80000
    buffer_load_dwordx4 v6, s[12:15], s61 offen nt lds
    s_add_u32 m0, s32, 69632
    s_add_u32 s61, s28, 0x84000
    buffer_load_dwordx4 v6, s[12:15], s61 offen nt lds
    s_add_u32 m0, s32, 73728
    s_add_u32 s61, s28, 0x90000
    buffer_load_dwordx4 v6, s[12:15], s61 offen nt lds
    s_add_u32 m0, s32, 77824
    s_add_u32 s61, s28, 0x94000
    buffer_load_dwordx4 v6, s[12:15], s61 offen nt lds
    s_add_u32 m0, s32, 81920
    s_add_u32 s61, s28, 0xa0000
    buffer_load_dwordx4 v6, s[12:15], s61 offen nt lds
    s_add_u32 m0, s32, 86016
    s_add_u32 s61, s28, 0xa4000
    buffer_load_dwordx4 v6, s[12:15], s61 offen nt lds
    s_add_u32 m0, s32, 90112
    s_add_u32 s61, s28, 0xb0000
    buffer_load_dwordx4 v6, s[12:15], s61 offen nt lds
    s_add_u32 m0, s32, 94208
    s_add_u32 s61, s28, 0xb4000
    buffer_load_dwordx4 v6, s[12:15], s61 offen nt lds
    s_add_u32 m0, s32, 98304
    s_add_u32 s61, s28, 0xc0000
    buffer_load_dwordx4 v6, s[12:15], s61 offen nt lds
    s_add_u32 m0, s32, 102400
    s_add_u32 s61, s28, 0xc4000
    buffer_load_dwordx4 v6, s[12:15], s61 offen nt lds
    s_add_u32 m0, s32, 106496
    s_add_u32 s61, s28, 0xd0000
    buffer_load_dwordx4 v6, s[12:15], s61 offen nt lds
    s_add_u32 m0, s32, 110592
    s_add_u32 s61, s28, 0xd4000
    buffer_load_dwordx4 v6, s[12:15], s61 offen nt lds
    s_add_u32 m0, s32, 114688
    s_add_u32 s61, s28, 0xe0000
    buffer_load_dwordx4 v6, s[12:15], s61 offen nt lds
    s_add_u32 m0, s32, 118784
    s_add_u32 s61, s28, 0xe4000
    buffer_load_dwordx4 v6, s[12:15], s61 offen nt lds
    s_add_u32 m0, s32, 122880
    s_add_u32 s61, s28, 0xf0000
    buffer_load_dwordx4 v6, s[12:15], s61 offen nt lds
    s_add_u32 m0, s32, 126976
    s_add_u32 s61, s28, 0xf4000
    buffer_load_dwordx4 v6, s[12:15], s61 offen nt lds
    s_add_u32 m0, s32, 131072
    s_add_u32 s61, s28, 0x100000
    buffer_load_dwordx4 v6, s[12:15], s61 offen nt lds
    s_add_u32 m0, s32, 135168
    s_add_u32 s61, s28, 0x104000
    buffer_load_dwordx4 v6, s[12:15], s61 offen nt lds
    s_add_u32 m0, s32, 139264
    s_add_u32 s61, s28, 0x110000
    buffer_load_dwordx4 v6, s[12:15], s61 offen nt lds
    s_add_u32 m0, s32, 143360
    s_add_u32 s61, s28, 0x114000
    buffer_load_dwordx4 v6, s[12:15], s61 offen nt lds
    s_add_u32 m0, s32, 147456
    s_add_u32 s61, s28, 0x120000
    buffer_load_dwordx4 v6, s[12:15], s61 offen nt lds
    s_add_u32 m0, s32, 151552
    s_add_u32 s61, s28, 0x124000
    buffer_load_dwordx4 v6, s[12:15], s61 offen nt lds
    s_add_u32 m0, s32, 155648
    s_add_u32 s61, s28, 0x130000
    buffer_load_dwordx4 v6, s[12:15], s61 offen nt lds
    s_add_u32 m0, s32, 159744
    s_add_u32 s61, s28, 0x134000
    buffer_load_dwordx4 v6, s[12:15], s61 offen nt lds
    s_mov_b32 s8, s100
    s_and_b32 s9, s101, 0xffff
    s_mov_b32 s10, 0xe000000
    s_mov_b32 s11, 0x00020000
    s_mov_b32 s16, s96
    s_and_b32 s17, s97, 0xffff
    s_mov_b32 s18, 0x1000000
    s_mov_b32 s19, 0x00020000
    v_and_b32 v24, 63, v0
    v_lshlrev_b32 v1, 4, v24
    v_add_u32 v2, 4096, v1
    v_lshlrev_b32 v10, 7, v24
    v_mov_b32 v11, 0
    s_lshl_b32 s60, s56, 8
    s_add_u32 s60, s60, 0xd200400
    s_lshl2_add_u32 s27, s57, s60
    s_and_b32 s38, s57, 7
    s_lshl_b32 s38, s38, 16
    s_cmp_eq_u32 s58, 0
    s_cselect_b32 s27, s27, 0xe000000
    s_cselect_b32 s38, s38, 0xe000000
    s_add_u32 s60, s60, s100
    s_addc_u32 s61, s101, 0
    v_and_b32 v25, 31, v0
    v_lshlrev_b32 v25, 2, v25
    v_add_u32 v16, s60, v25
    v_mov_b32 v17, s61
    s_add_u32 s60, s98, 208
    s_addc_u32 s61, s99, 0
    v_writelane_b32 v16, s60, 32
    v_writelane_b32 v17, s61, 32
    s_mov_b32 s26, 0
    s_mov_b32 s30, 0
    s_mov_b32 s40, 0
    s_mov_b32 s29, 32768
    v_and_b32 v24, 15, v0
    v_lshlrev_b32 v15, 13, v24
    v_bfe_u32 v24, v0, 4, 2
    v_lshl_add_u32 v15, v24, 4, v15
    s_lshr_b32 s60, s57, 4
    s_lshl_b32 s60, s60, 17
    s_and_b32 s61, s57, 7
    s_lshl_b32 s61, s61, 9
    s_add_u32 s60, s60, s61
    s_lshl_b32 s61, s58, 7
    s_add_u32 s60, s60, s61
    s_and_b32 s61, s57, 8
    s_lshl_b32 s61, s61, 3
    s_add_u32 s60, s60, s61
    s_add_u32 s60, s60, 4096
    v_add_u32 v15, s60, v15
    s_lshl_b32 s61, s58, 12
    s_xor_b32 s60, s57, 24
    s_lshl_b32 s60, s60, 14
    s_add_u32 s60, s60, s61
    s_add_u32 s60, s60, 0
    v_add_u32 v20, s60, v1
    s_xor_b32 s60, s57, 16
    s_lshl_b32 s60, s60, 14
    s_add_u32 s60, s60, s61
    s_add_u32 s60, s60, 1024
    v_add_u32 v21, s60, v1
    s_xor_b32 s60, s57, 8
    s_lshl_b32 s60, s60, 14
    s_add_u32 s60, s60, s61
    s_add_u32 s60, s60, 2048
    v_add_u32 v22, s60, v1
    s_xor_b32 s60, s57, 0
    s_lshl_b32 s60, s60, 14
    s_add_u32 s60, s60, s61
    s_add_u32 s60, s60, 0
    v_add_u32 v23, s60, v1
    s_lshl_b32 s24, s56, 20
    s_add_u32 s24, s24, 0xd800000
    s_and_b32 s60, s57, 24
    s_add_u32 s60, s60, s58
    s_lshl_b32 s31, s60, 16
    s_add_u32 s31, s31, 0xc000
    s_add_u32 s31, s31, s59
    s_mul_i32 s33, s56, 8
    s_lshr_b32 s33, 0x2010012, s33
    s_and_b32 s33, s33, 255
    s_mul_i32 s39, s56, 8
    s_lshr_b32 s39, 0xf10100a, s39
    s_and_b32 s39, s39, 255
    s_cmp_eq_u32 s56, 0
    s_cmov_b32 s36, 0x3c
    s_cmp_eq_u32 s56, 1
    s_cmov_b32 s36, 0x3d39
    s_cmp_eq_u32 s56, 2
    s_cmov_b32 s36, 0x3f3b
    s_cmp_eq_u32 s56, 3
    s_cmov_b32 s36, 0x3e3a
    s_waitcnt vmcnt(32)
    s_barrier
    ds_read_b64_tr_b16 a[0:1], v8 offset:0
    ds_read_b64_tr_b16 a[2:3], v8 offset:1024
    ds_read_b64_tr_b16 a[4:5], v9 offset:0
    ds_read_b64_tr_b16 a[6:7], v9 offset:1024
    ds_read_b64_tr_b16 a[8:9], v8 offset:8192
    ds_read_b64_tr_b16 a[10:11], v8 offset:9216
    ds_read_b64_tr_b16 a[12:13], v9 offset:8192
    ds_read_b64_tr_b16 a[14:15], v9 offset:9216
    s_waitcnt lgkmcnt(0)
    ds_read_b64_tr_b16 a[16:17], v8 offset:16384
    ds_read_b64_tr_b16 a[18:19], v8 offset:17408
    ds_read_b64_tr_b16 a[20:21], v9 offset:16384
    ds_read_b64_tr_b16 a[22:23], v9 offset:17408
    ds_read_b64_tr_b16 a[24:25], v8 offset:24576
    ds_read_b64_tr_b16 a[26:27], v8 offset:25600
    ds_read_b64_tr_b16 a[28:29], v9 offset:24576
    ds_read_b64_tr_b16 a[30:31], v9 offset:25600
    s_waitcnt lgkmcnt(0)
    s_waitcnt vmcnt(24)
    s_barrier
    s_add_u32 m0, s32, 0
    s_add_u32 s61, s28, 0x140000
    buffer_load_dwordx4 v6, s[12:15], s61 offen nt lds
    s_add_u32 m0, s32, 4096
    s_add_u32 s61, s28, 0x144000
    buffer_load_dwordx4 v6, s[12:15], s61 offen nt lds
    s_add_u32 m0, s32, 8192
    s_add_u32 s61, s28, 0x150000
    buffer_load_dwordx4 v6, s[12:15], s61 offen nt lds
    s_add_u32 m0, s32, 12288
    s_add_u32 s61, s28, 0x154000
    buffer_load_dwordx4 v6, s[12:15], s61 offen nt lds
    s_add_u32 m0, s32, 16384
    s_add_u32 s61, s28, 0x160000
    buffer_load_dwordx4 v6, s[12:15], s61 offen nt lds
    s_add_u32 m0, s32, 20480
    s_add_u32 s61, s28, 0x164000
    buffer_load_dwordx4 v6, s[12:15], s61 offen nt lds
    s_add_u32 m0, s32, 24576
    s_add_u32 s61, s28, 0x170000
    buffer_load_dwordx4 v6, s[12:15], s61 offen nt lds
    s_add_u32 m0, s32, 28672
    s_add_u32 s61, s28, 0x174000
    buffer_load_dwordx4 v6, s[12:15], s61 offen nt lds
    ds_read_b64_tr_b16 a[32:33], v8 offset:32768
    ds_read_b64_tr_b16 a[34:35], v8 offset:33792
    ds_read_b64_tr_b16 a[36:37], v9 offset:32768
    ds_read_b64_tr_b16 a[38:39], v9 offset:33792
    ds_read_b64_tr_b16 a[40:41], v8 offset:40960
    ds_read_b64_tr_b16 a[42:43], v8 offset:41984
    ds_read_b64_tr_b16 a[44:45], v9 offset:40960
    ds_read_b64_tr_b16 a[46:47], v9 offset:41984
    s_waitcnt lgkmcnt(0)
    ds_read_b64_tr_b16 a[48:49], v8 offset:49152
    ds_read_b64_tr_b16 a[50:51], v8 offset:50176
    ds_read_b64_tr_b16 a[52:53], v9 offset:49152
    ds_read_b64_tr_b16 a[54:55], v9 offset:50176
    ds_read_b64_tr_b16 a[56:57], v8 offset:57344
    ds_read_b64_tr_b16 a[58:59], v8 offset:58368
    ds_read_b64_tr_b16 a[60:61], v9 offset:57344
    ds_read_b64_tr_b16 a[62:63], v9 offset:58368
    s_waitcnt lgkmcnt(0)
    s_waitcnt vmcnt(24)
    s_barrier
    s_add_u32 m0, s32, 32768
    s_add_u32 s61, s28, 0x180000
    buffer_load_dwordx4 v6, s[12:15], s61 offen nt lds
    s_add_u32 m0, s32, 36864
    s_add_u32 s61, s28, 0x184000
    buffer_load_dwordx4 v6, s[12:15], s61 offen nt lds
    s_add_u32 m0, s32, 40960
    s_add_u32 s61, s28, 0x190000
    buffer_load_dwordx4 v6, s[12:15], s61 offen nt lds
    s_add_u32 m0, s32, 45056
    s_add_u32 s61, s28, 0x194000
    buffer_load_dwordx4 v6, s[12:15], s61 offen nt lds
    s_add_u32 m0, s32, 49152
    s_add_u32 s61, s28, 0x1a0000
    buffer_load_dwordx4 v6, s[12:15], s61 offen nt lds
    s_add_u32 m0, s32, 53248
    s_add_u32 s61, s28, 0x1a4000
    buffer_load_dwordx4 v6, s[12:15], s61 offen nt lds
    s_add_u32 m0, s32, 57344
    s_add_u32 s61, s28, 0x1b0000
    buffer_load_dwordx4 v6, s[12:15], s61 offen nt lds
    s_add_u32 m0, s32, 61440
    s_add_u32 s61, s28, 0x1b4000
    buffer_load_dwordx4 v6, s[12:15], s61 offen nt lds
    v_add_u32 v8, 0x10000, v8
    v_add_u32 v9, 0x10000, v9
    ds_read_b64_tr_b16 a[64:65], v8 offset:0
    ds_read_b64_tr_b16 a[66:67], v8 offset:1024
    ds_read_b64_tr_b16 a[68:69], v9 offset:0
    ds_read_b64_tr_b16 a[70:71], v9 offset:1024
    ds_read_b64_tr_b16 a[72:73], v8 offset:8192
    ds_read_b64_tr_b16 a[74:75], v8 offset:9216
    ds_read_b64_tr_b16 a[76:77], v9 offset:8192
    ds_read_b64_tr_b16 a[78:79], v9 offset:9216
    s_waitcnt lgkmcnt(0)
    ds_read_b64_tr_b16 a[80:81], v8 offset:16384
    ds_read_b64_tr_b16 a[82:83], v8 offset:17408
    ds_read_b64_tr_b16 a[84:85], v9 offset:16384
    ds_read_b64_tr_b16 a[86:87], v9 offset:17408
    ds_read_b64_tr_b16 a[88:89], v8 offset:24576
    ds_read_b64_tr_b16 a[90:91], v8 offset:25600
    ds_read_b64_tr_b16 a[92:93], v9 offset:24576
    ds_read_b64_tr_b16 a[94:95], v9 offset:25600
    s_waitcnt lgkmcnt(0)
    s_waitcnt vmcnt(24)
    s_barrier
    s_add_u32 m0, s32, 65536
    s_add_u32 s61, s28, 0x1c0000
    buffer_load_dwordx4 v6, s[12:15], s61 offen nt lds
    s_add_u32 m0, s32, 69632
    s_add_u32 s61, s28, 0x1c4000
    buffer_load_dwordx4 v6, s[12:15], s61 offen nt lds
    s_add_u32 m0, s32, 73728
    s_add_u32 s61, s28, 0x1d0000
    buffer_load_dwordx4 v6, s[12:15], s61 offen nt lds
    s_add_u32 m0, s32, 77824
    s_add_u32 s61, s28, 0x1d4000
    buffer_load_dwordx4 v6, s[12:15], s61 offen nt lds
    s_add_u32 m0, s32, 81920
    s_add_u32 s61, s28, 0x1e0000
    buffer_load_dwordx4 v6, s[12:15], s61 offen nt lds
    s_add_u32 m0, s32, 86016
    s_add_u32 s61, s28, 0x1e4000
    buffer_load_dwordx4 v6, s[12:15], s61 offen nt lds
    s_add_u32 m0, s32, 90112
    s_add_u32 s61, s28, 0x1f0000
    buffer_load_dwordx4 v6, s[12:15], s61 offen nt lds
    s_add_u32 m0, s32, 94208
    s_add_u32 s61, s28, 0x1f4000
    buffer_load_dwordx4 v6, s[12:15], s61 offen nt lds
    ds_read_b64_tr_b16 a[96:97], v8 offset:32768
    ds_read_b64_tr_b16 a[98:99], v8 offset:33792
    ds_read_b64_tr_b16 a[100:101], v9 offset:32768
    ds_read_b64_tr_b16 a[102:103], v9 offset:33792
    ds_read_b64_tr_b16 a[104:105], v8 offset:40960
    ds_read_b64_tr_b16 a[106:107], v8 offset:41984
    ds_read_b64_tr_b16 a[108:109], v9 offset:40960
    ds_read_b64_tr_b16 a[110:111], v9 offset:41984
    s_waitcnt lgkmcnt(0)
    ds_read_b64_tr_b16 a[112:113], v8 offset:49152
    ds_read_b64_tr_b16 a[114:115], v8 offset:50176
    ds_read_b64_tr_b16 a[116:117], v9 offset:49152
    ds_read_b64_tr_b16 a[118:119], v9 offset:50176
    ds_read_b64_tr_b16 a[120:121], v8 offset:57344
    ds_read_b64_tr_b16 a[122:123], v8 offset:58368
    ds_read_b64_tr_b16 a[124:125], v9 offset:57344
    ds_read_b64_tr_b16 a[126:127], v9 offset:58368
    s_waitcnt lgkmcnt(0)
    s_waitcnt vmcnt(24)
    s_barrier
    v_add_u32 v8, 0x10000, v8
    v_add_u32 v9, 0x10000, v9
    ds_read_b64_tr_b16 a[128:129], v8 offset:0
    ds_read_b64_tr_b16 a[130:131], v8 offset:1024
    ds_read_b64_tr_b16 a[132:133], v9 offset:0
    ds_read_b64_tr_b16 a[134:135], v9 offset:1024
    ds_read_b64_tr_b16 a[136:137], v8 offset:8192
    ds_read_b64_tr_b16 a[138:139], v8 offset:9216
    ds_read_b64_tr_b16 a[140:141], v9 offset:8192
    ds_read_b64_tr_b16 a[142:143], v9 offset:9216
    s_waitcnt lgkmcnt(0)
    ds_read_b64_tr_b16 a[144:145], v8 offset:16384
    ds_read_b64_tr_b16 a[146:147], v8 offset:17408
    ds_read_b64_tr_b16 a[148:149], v9 offset:16384
    ds_read_b64_tr_b16 a[150:151], v9 offset:17408
    ds_read_b64_tr_b16 a[152:153], v8 offset:24576
    ds_read_b64_tr_b16 a[154:155], v8 offset:25600
    ds_read_b64_tr_b16 a[156:157], v9 offset:24576
    ds_read_b64_tr_b16 a[158:159], v9 offset:25600
    s_waitcnt lgkmcnt(0)
    s_waitcnt vmcnt(16)
    s_barrier
    v_add_u32 v8, 0xfffe0000, v8
    v_add_u32 v9, 0xfffe0000, v9
    ds_read_b64_tr_b16 a[160:161], v8 offset:0
    ds_read_b64_tr_b16 a[162:163], v8 offset:1024
    ds_read_b64_tr_b16 a[164:165], v9 offset:0
    ds_read_b64_tr_b16 a[166:167], v9 offset:1024
    ds_read_b64_tr_b16 a[168:169], v8 offset:8192
    ds_read_b64_tr_b16 a[170:171], v8 offset:9216
    ds_read_b64_tr_b16 a[172:173], v9 offset:8192
    ds_read_b64_tr_b16 a[174:175], v9 offset:9216
    s_waitcnt lgkmcnt(0)
    ds_read_b64_tr_b16 a[176:177], v8 offset:16384
    ds_read_b64_tr_b16 a[178:179], v8 offset:17408
    ds_read_b64_tr_b16 a[180:181], v9 offset:16384
    ds_read_b64_tr_b16 a[182:183], v9 offset:17408
    ds_read_b64_tr_b16 a[184:185], v8 offset:24576
    ds_read_b64_tr_b16 a[186:187], v8 offset:25600
    ds_read_b64_tr_b16 a[188:189], v9 offset:24576
    ds_read_b64_tr_b16 a[190:191], v9 offset:25600
    s_waitcnt lgkmcnt(0)
    s_waitcnt vmcnt(8)
    s_barrier
    ds_read_b64_tr_b16 a[192:193], v8 offset:32768
    ds_read_b64_tr_b16 a[194:195], v8 offset:33792
    ds_read_b64_tr_b16 a[196:197], v9 offset:32768
    ds_read_b64_tr_b16 a[198:199], v9 offset:33792
    ds_read_b64_tr_b16 a[200:201], v8 offset:40960
    ds_read_b64_tr_b16 a[202:203], v8 offset:41984
    ds_read_b64_tr_b16 a[204:205], v9 offset:40960
    ds_read_b64_tr_b16 a[206:207], v9 offset:41984
    s_waitcnt lgkmcnt(0)
    ds_read_b64_tr_b16 a[208:209], v8 offset:49152
    ds_read_b64_tr_b16 a[210:211], v8 offset:50176
    ds_read_b64_tr_b16 a[212:213], v9 offset:49152
    ds_read_b64_tr_b16 a[214:215], v9 offset:50176
    ds_read_b64_tr_b16 a[216:217], v8 offset:57344
    ds_read_b64_tr_b16 a[218:219], v8 offset:58368
    ds_read_b64_tr_b16 a[220:221], v9 offset:57344
    ds_read_b64_tr_b16 a[222:223], v9 offset:58368
    s_waitcnt lgkmcnt(0)
    s_waitcnt vmcnt(0)
    s_barrier
    v_add_u32 v8, 0x10000, v8
    v_add_u32 v9, 0x10000, v9
    ds_read_b64_tr_b16 a[224:225], v8 offset:0
    ds_read_b64_tr_b16 a[226:227], v8 offset:1024
    ds_read_b64_tr_b16 a[228:229], v9 offset:0
    ds_read_b64_tr_b16 a[230:231], v9 offset:1024
    ds_read_b64_tr_b16 a[232:233], v8 offset:8192
    ds_read_b64_tr_b16 a[234:235], v8 offset:9216
    ds_read_b64_tr_b16 a[236:237], v9 offset:8192
    ds_read_b64_tr_b16 a[238:239], v9 offset:9216
    s_waitcnt lgkmcnt(0)
    ds_read_b64_tr_b16 a[240:241], v8 offset:16384
    ds_read_b64_tr_b16 a[242:243], v8 offset:17408
    ds_read_b64_tr_b16 a[244:245], v9 offset:16384
    ds_read_b64_tr_b16 a[246:247], v9 offset:17408
    ds_read_b64_tr_b16 a[248:249], v8 offset:24576
    ds_read_b64_tr_b16 a[250:251], v8 offset:25600
    ds_read_b64_tr_b16 a[252:253], v9 offset:24576
    ds_read_b64_tr_b16 a[254:255], v9 offset:25600
    s_waitcnt lgkmcnt(0)
seg_w1:
    s_barrier
    s_cmp_eq_u32 s39, 0
    s_cbranch_scc1 seg_t0
    s_lshl_b32 s20, s58, 13
    s_mov_b32 s21, 0
    s_lshr_b32 s60, s57, 4
    s_lshl_b32 s60, s60, 12
    v_add_u32 v5, s60, v1
    v_xor_b32 v4, 4096, v5
    s_mul_i32 s35, s56, 8
    s_lshr_b32 s35, 0x35383736, s35
    s_and_b32 s35, s35, 255
    s_add_u32 s34, s33, 11
    s_mov_b32 s25, 0
    s_mov_b32 s42, 0
    s_mov_b32 s18, 0
    v_mov_b32 v18, s26
    v_writelane_b32 v18, s34, 32
    v_writelane_b32 v18, s40, 33
L_sp_82:
    global_load_dword v19, v[16:17], off sc1
    s_add_u32 s30, s30, 1
    s_cmp_gt_u32 s30, 0x200000
    s_cbranch_scc1 chain_kernel_wabort
    s_waitcnt vmcnt(0)
    v_cmp_lt_u32 vcc, v19, v18
    s_cbranch_vccz L_spok_83
    s_sleep 4
    s_branch L_sp_82
L_spok_83:
    s_cmp_lt_u32 s33, 15
    s_cselect_b32 s41, 3, 4
    s_add_u32 s41, s41, s33
    s_lshl_b32 s61, s33, 13
    s_and_b32 s61, s61, 0x2000
    s_xor_b32 s61, s61, s31
    s_lshl_b32 s23, s33, 21
    s_add_u32 s23, s23, s61
    s_cmp_gt_u32 s33, s35
    s_cselect_b32 s23, 0xe000000, s23
    s_add_u32 m0, s20, 0
    s_nop 0
    buffer_load_dwordx4 v1, s[8:11], s23 offen offset:0 lds
    buffer_load_dwordx4 v1, s[8:11], s23 offen offset:1024 lds
    buffer_load_dwordx4 v1, s[8:11], s23 offen offset:2048 lds
    buffer_load_dwordx4 v1, s[8:11], s23 offen offset:3072 lds
    s_add_u32 m0, s20, 4096
    s_nop 0
    buffer_load_dwordx4 v2, s[8:11], s23 offen offset:0 lds
    buffer_load_dwordx4 v2, s[8:11], s23 offen offset:1024 lds
    buffer_load_dwordx4 v2, s[8:11], s23 offen offset:2048 lds
    buffer_load_dwordx4 v2, s[8:11], s23 offen offset:3072 lds
    s_add_u32 s20, s20, 32768
    s_cmp_ge_u32 s20, 163840
    s_cselect_b32 s60, 163840, 0
    s_sub_u32 s20, s20, s60
    s_add_u32 s23, s23, 0x40000
    s_add_u32 m0, s20, 0
    s_nop 0
    buffer_load_dwordx4 v1, s[8:11], s23 offen offset:0 lds
    buffer_load_dwordx4 v1, s[8:11], s23 offen offset:1024 lds
    buffer_load_dwordx4 v1, s[8:11], s23 offen offset:2048 lds
    buffer_load_dwordx4 v1, s[8:11], s23 offen offset:3072 lds
    s_add_u32 m0, s20, 4096
    s_nop 0
    buffer_load_dwordx4 v2, s[8:11], s23 offen offset:0 lds
    buffer_load_dwordx4 v2, s[8:11], s23 offen offset:1024 lds
    buffer_load_dwordx4 v2, s[8:11], s23 offen offset:2048 lds
    buffer_load_dwordx4 v2, s[8:11], s23 offen offset:3072 lds
    s_add_u32 s20, s20, 32768
    s_cmp_ge_u32 s20, 163840
    s_cselect_b32 s60, 163840, 0
    s_sub_u32 s20, s20, s60
    s_lshl_b32 s42, s42, 8
    s_or_b32 s42, s42, s33
    s_mov_b32 s33, s41
    s_cmp_lt_u32 s33, 15
    s_cselect_b32 s41, 3, 4
    s_add_u32 s41, s41, s33
    s_lshl_b32 s61, s33, 13
    s_and_b32 s61, s61, 0x2000
    s_xor_b32 s61, s61, s31
    s_lshl_b32 s23, s33, 21
    s_add_u32 s23, s23, s61
    s_cmp_gt_u32 s33, s35
    s_cselect_b32 s23, 0xe000000, s23
    s_add_u32 m0, s20, 0
    s_nop 0
    buffer_load_dwordx4 v1, s[8:11], s23 offen offset:0 lds
    buffer_load_dwordx4 v1, s[8:11], s23 offen offset:1024 lds
    buffer_load_dwordx4 v1, s[8:11], s23 offen offset:2048 lds
    buffer_load_dwordx4 v1, s[8:11], s23 offen offset:3072 lds
    s_add_u32 m0, s20, 4096
    s_nop 0
    buffer_load_dwordx4 v2, s[8:11], s23 offen offset:0 lds
    buffer_load_dwordx4 v2, s[8:11], s23 offen offset:1024 lds
    buffer_load_dwordx4 v2, s[8:11], s23 offen offset:2048 lds
    buffer_load_dwordx4 v2, s[8:11], s23 offen offset:3072 lds
    s_add_u32 s20, s20, 32768
    s_cmp_ge_u32 s20, 163840
    s_cselect_b32 s60, 163840, 0
    s_sub_u32 s20, s20, s60
    s_add_u32 s23, s23, 0x40000
    s_mov_b32 s37, 0xe000000
    s_waitcnt vmcnt(8)
    s_barrier
    ds_read_b128 v[72:75], v4 offset:0
    ds_read_b128 v[76:79], v5 offset:0
    ds_read_b128 v[80:83], v4 offset:1024
    ds_read_b128 v[84:87], v5 offset:1024
    ds_read_b128 v[88:91], v4 offset:2048
    ds_read_b128 v[92:95], v5 offset:2048
seg_p:
    s_waitcnt lgkmcnt(4)
    v_mfma_f32_16x16x32_bf16 v[32:35], a[0:3], v[72:75], 0
    ds_read_b128 v[96:99], v4 offset:3072
    s_waitcnt vmcnt(4)
    v_mfma_f32_16x16x32_bf16 v[36:39], a[4:7], v[72:75], 0
    ds_read_b128 v[100:103], v5 offset:3072
    v_pk_add_f32 v[104:105], v[104:105], v[64:65]
    v_mfma_f32_16x16x32_bf16 v[44:47], a[4:7], v[76:79], 0
    v_pk_add_f32 v[106:107], v[106:107], v[66:67]
    s_xor_b32 s24, s24, 0x80000
    v_mfma_f32_16x16x32_bf16 v[40:43], a[0:3], v[76:79], 0
    buffer_store_dwordx4 v[48:51], v20, s[8:11], s24 offen
    s_waitcnt lgkmcnt(4)
    v_mfma_f32_16x16x32_bf16 v[32:35], a[8:11], v[80:83], v[32:35]
    ds_read_b128 v[72:75], v4 offset:8192
    v_mfma_f32_16x16x32_bf16 v[36:39], a[12:15], v[80:83], v[36:39]
    ds_read_b128 v[76:79], v5 offset:8192
    buffer_store_dwordx4 v[52:55], v21, s[8:11], s24 offen
    v_mfma_f32_16x16x32_bf16 v[44:47], a[12:15], v[84:87], v[44:47]
    v_mfma_f32_16x16x32_bf16 v[40:43], a[8:11], v[84:87], v[40:43]
    buffer_store_dwordx4 v[56:59], v22, s[8:11], s24 offen
    s_waitcnt lgkmcnt(4)
    v_mfma_f32_16x16x32_bf16 v[32:35], a[16:19], v[88:91], v[32:35]
    ds_read_b128 v[80:83], v4 offset:9216
    buffer_load_dword v13, v10, s[8:11], s37 offen
    v_mfma_f32_16x16x32_bf16 v[36:39], a[20:23], v[88:91], v[36:39]
    ds_read_b128 v[84:87], v5 offset:9216
    v_pk_add_f32 v[108:109], v[108:109], v[112:113]
    v_mfma_f32_16x16x32_bf16 v[44:47], a[20:23], v[92:95], v[44:47]
    v_pk_add_f32 v[110:111], v[110:111], v[114:115]
    v_pk_add_f32 v[104:105], v[104:105], v[108:109]
    v_mfma_f32_16x16x32_bf16 v[40:43], a[16:19], v[92:95], v[40:43]
    v_pk_add_f32 v[106:107], v[106:107], v[110:111]
    s_waitcnt lgkmcnt(4)
    v_mfma_f32_16x16x32_bf16 v[32:35], a[24:27], v[96:99], v[32:35]
    ds_read_b128 v[88:91], v4 offset:10240
    v_cvt_pk_bf16_f32 v104, 0, v104
    v_mfma_f32_16x16x32_bf16 v[36:39], a[28:31], v[96:99], v[36:39]
    ds_read_b128 v[92:95], v5 offset:10240
    v_cvt_pk_bf16_f32 v105, 0, v105
    v_mfma_f32_16x16x32_bf16 v[44:47], a[28:31], v[100:103], v[44:47]
    v_cvt_pk_bf16_f32 v106, 0, v106
    v_cvt_pk_bf16_f32 v107, 0, v107
    v_mfma_f32_16x16x32_bf16 v[40:43], a[24:27], v[100:103], v[40:43]
    buffer_store_dwordx4 v[104:107], v15, s[16:19], s25 offen
    s_waitcnt lgkmcnt(4)
    v_mfma_f32_16x16x32_bf16 v[32:35], a[32:35], v[72:75], v[32:35]
    ds_read_b128 v[96:99], v4 offset:11264
    v_mov_b32 v64, v60
    v_mfma_f32_16x16x32_bf16 v[36:39], a[36:39], v[72:75], v[36:39]
    ds_read_b128 v[100:103], v5 offset:11264
    v_mov_b32 v65, v61
    v_mfma_f32_16x16x32_bf16 v[44:47], a[36:39], v[76:79], v[44:47]
    v_mov_b32 v66, v62
    v_mov_b32 v67, v63
    v_mfma_f32_16x16x32_bf16 v[40:43], a[32:35], v[76:79], v[40:43]
    s_waitcnt lgkmcnt(4)
    v_mfma_f32_16x16x32_bf16 v[32:35], a[40:43], v[80:83], v[32:35]
    ds_read_b128 v[72:75], v4 offset:16384
    v_mfma_f32_16x16x32_bf16 v[36:39], a[44:47], v[80:83], v[36:39]
    ds_read_b128 v[76:79], v5 offset:16384
    v_mfma_f32_16x16x32_bf16 v[44:47], a[44:47], v[84:87], v[44:47]
    v_mfma_f32_16x16x32_bf16 v[40:43], a[40:43], v[84:87], v[40:43]
    s_waitcnt lgkmcnt(4)
    v_mfma_f32_16x16x32_bf16 v[32:35], a[48:51], v[88:91], v[32:35]
    ds_read_b128 v[80:83], v4 offset:17408
    s_lshl_b32 s42, s42, 8
    v_mfma_f32_16x16x32_bf16 v[36:39], a[52:55], v[88:91], v[36:39]
    ds_read_b128 v[84:87], v5 offset:17408
    s_or_b32 s42, s42, s33
    v_mfma_f32_16x16x32_bf16 v[44:47], a[52:55], v[92:95], v[44:47]
    s_mov_b32 s33, s41
    s_cmp_lt_u32 s33, 15
    v_mfma_f32_16x16x32_bf16 v[40:43], a[48:51], v[92:95], v[40:43]
    s_cselect_b32 s41, 3, 4
    s_waitcnt lgkmcnt(4)
    v_mfma_f32_16x16x32_bf16 v[32:35], a[56:59], v[96:99], v[32:35]
    ds_read_b128 v[88:91], v4 offset:18432
    s_add_u32 s41, s41, s33
    v_mfma_f32_16x16x32_bf16 v[36:39], a[60:63], v[96:99], v[36:39]
    ds_read_b128 v[92:95], v5 offset:18432
    s_cmp_ge_u32 s21, 131072
    v_mfma_f32_16x16x32_bf16 v[44:47], a[60:63], v[100:103], v[44:47]
    s_cselect_b32 s22, 0xfffe0000, s29
    s_add_u32 s21, s21, s22
    v_mfma_f32_16x16x32_bf16 v[40:43], a[56:59], v[100:103], v[40:43]
    s_min_u32 s34, s41, s35
    s_waitcnt lgkmcnt(4)
    v_mfma_f32_16x16x32_bf16 v[32:35], a[64:67], v[72:75], v[32:35]
    ds_read_b128 v[96:99], v4 offset:19456
    s_add_u32 s34, s34, 3
    v_mfma_f32_16x16x32_bf16 v[36:39], a[68:71], v[72:75], v[36:39]
    ds_read_b128 v[100:103], v5 offset:19456
    s_bfe_u32 s25, s42, 0x80010
    v_mfma_f32_16x16x32_bf16 v[44:47], a[68:71], v[76:79], v[44:47]
    s_lshl_b32 s25, s25, 18
    s_cmp_ge_u32 s26, 1
    v_mfma_f32_16x16x32_bf16 v[40:43], a[64:67], v[76:79], v[40:43]
    s_cselect_b32 s18, 0x1000000, 0
    s_waitcnt lgkmcnt(4)
    v_mfma_f32_16x16x32_bf16 v[32:35], a[72:75], v[80:83], v[32:35]
    ds_read_b128 v[72:75], v4 offset:24576
    v_mfma_f32_16x16x32_bf16 v[36:39], a[76:79], v[80:83], v[36:39]
    ds_read_b128 v[76:79], v5 offset:24576
    v_mfma_f32_16x16x32_bf16 v[44:47], a[76:79], v[84:87], v[44:47]
    v_mfma_f32_16x16x32_bf16 v[40:43], a[72:75], v[84:87], v[40:43]
    s_waitcnt lgkmcnt(4)
    v_mfma_f32_16x16x32_bf16 v[32:35], a[80:83], v[88:91], v[32:35]
    ds_read_b128 v[80:83], v4 offset:25600
    s_add_u32 m0, s20, 0
    v_mfma_f32_16x16x32_bf16 v[36:39], a[84:87], v[88:91], v[36:39]
    ds_read_b128 v[84:87], v5 offset:25600
    buffer_load_dwordx4 v1, s[8:11], s23 offen offset:0 lds
    v_mfma_f32_16x16x32_bf16 v[44:47], a[84:87], v[92:95], v[44:47]
    v_mfma_f32_16x16x32_bf16 v[40:43], a[80:83], v[92:95], v[40:43]
    s_waitcnt lgkmcnt(4)
    v_mfma_f32_16x16x32_bf16 v[32:35], a[88:91], v[96:99], v[32:35]
    ds_read_b128 v[88:91], v4 offset:26624
    v_mfma_f32_16x16x32_bf16 v[36:39], a[92:95], v[96:99], v[36:39]
    ds_read_b128 v[92:95], v5 offset:26624
    buffer_load_dwordx4 v1, s[8:11], s23 offen offset:1024 lds
    v_mfma_f32_16x16x32_bf16 v[44:47], a[92:95], v[100:103], v[44:47]
    v_mfma_f32_16x16x32_bf16 v[40:43], a[88:91], v[100:103], v[40:43]
    s_waitcnt lgkmcnt(4)
    v_mfma_f32_16x16x32_bf16 v[32:35], a[96:99], v[72:75], v[32:35]
    ds_read_b128 v[96:99], v4 offset:27648
    v_mfma_f32_16x16x32_bf16 v[36:39], a[100:103], v[72:75], v[36:39]
    ds_read_b128 v[100:103], v5 offset:27648
    v_mfma_f32_16x16x32_bf16 v[44:47], a[100:103], v[76:79], v[44:47]
    v_add_u32 v4, s22, v4
    v_add_u32 v5, s22, v5
    v_mfma_f32_16x16x32_bf16 v[40:43], a[96:99], v[76:79], v[40:43]
    buffer_load_dwordx4 v1, s[8:11], s23 offen offset:2048 lds
    s_waitcnt vmcnt(5)
    s_barrier
    s_waitcnt lgkmcnt(4)
    v_mfma_f32_16x16x32_bf16 v[32:35], a[104:107], v[80:83], v[32:35]
    ds_read_b128 v[72:75], v4 offset:0
    s_add_u32 s26, s26, 1
    v_mfma_f32_16x16x32_bf16 v[36:39], a[108:111], v[80:83], v[36:39]
    ds_read_b128 v[76:79], v5 offset:0
    v_mov_b32 v12, s26
    v_mfma_f32_16x16x32_bf16 v[44:47], a[108:111], v[84:87], v[44:47]
    buffer_store_dword v12, v11, s[8:11], s27 offen
    v_mfma_f32_16x16x32_bf16 v[40:43], a[104:107], v[84:87], v[40:43]
    buffer_load_dwordx4 v1, s[8:11], s23 offen offset:3072 lds
    s_waitcnt lgkmcnt(4)
    v_mfma_f32_16x16x32_bf16 v[32:35], a[112:115], v[88:91], v[32:35]
    ds_read_b128 v[80:83], v4 offset:1024
    v_mfma_f32_16x16x32_bf16 v[36:39], a[116:119], v[88:91], v[36:39]
    ds_read_b128 v[84:87], v5 offset:1024
    v_mov_b32 v18, s26
    v_mfma_f32_16x16x32_bf16 v[44:47], a[116:119], v[92:95], v[44:47]
    v_writelane_b32 v18, s34, 32
    v_writelane_b32 v18, s40, 33
    v_mfma_f32_16x16x32_bf16 v[40:43], a[112:115], v[92:95], v[40:43]
    s_waitcnt lgkmcnt(4)
    v_mfma_f32_16x16x32_bf16 v[32:35], a[120:123], v[96:99], v[32:35]
    ds_read_b128 v[88:91], v4 offset:2048
    s_add_u32 m0, s20, 4096
    v_mfma_f32_16x16x32_bf16 v[36:39], a[124:127], v[96:99], v[36:39]
    ds_read_b128 v[92:95], v5 offset:2048
    buffer_load_dwordx4 v2, s[8:11], s23 offen offset:0 lds
    v_mfma_f32_16x16x32_bf16 v[44:47], a[124:127], v[100:103], v[44:47]
    s_cmp_ge_u32 s21, 131072
    s_cselect_b32 s22, 0xfffe0000, s29
    v_mfma_f32_16x16x32_bf16 v[40:43], a[120:123], v[100:103], v[40:43]
    s_add_u32 s21, s21, s22
    s_waitcnt lgkmcnt(4)
    v_mfma_f32_16x16x32_bf16 v[32:35], a[128:131], v[72:75], v[32:35]
    ds_read_b128 v[96:99], v4 offset:3072
    s_lshl_b32 s61, s41, 13
    v_mfma_f32_16x16x32_bf16 v[36:39], a[132:135], v[72:75], v[36:39]
    ds_read_b128 v[100:103], v5 offset:3072
    s_and_b32 s61, s61, 0x2000
    v_mfma_f32_16x16x32_bf16 v[44:47], a[132:135], v[76:79], v[44:47]
    s_xor_b32 s61, s61, s31
    s_lshl_b32 s37, s41, 21
    v_mfma_f32_16x16x32_bf16 v[40:43], a[128:131], v[76:79], v[40:43]
    s_add_u32 s37, s37, s61
    s_waitcnt lgkmcnt(4)
    v_mfma_f32_16x16x32_bf16 v[32:35], a[136:139], v[80:83], v[32:35]
    ds_read_b128 v[72:75], v4 offset:8192
    s_cmp_gt_u32 s41, s35
    v_mfma_f32_16x16x32_bf16 v[36:39], a[140:143], v[80:83], v[36:39]
    ds_read_b128 v[76:79], v5 offset:8192
    s_cselect_b32 s37, 0xe000000, s37
    v_mfma_f32_16x16x32_bf16 v[44:47], a[140:143], v[84:87], v[44:47]
    s_add_u32 s37, s37, s38
    buffer_load_dwordx4 v2, s[8:11], s23 offen offset:1024 lds
    v_mfma_f32_16x16x32_bf16 v[40:43], a[136:139], v[84:87], v[40:43]
    buffer_load_dwordx4 v2, s[8:11], s23 offen offset:2048 lds
    s_waitcnt lgkmcnt(4)
    v_mfma_f32_16x16x32_bf16 v[32:35], a[144:147], v[88:91], v[32:35]
    ds_read_b128 v[80:83], v4 offset:9216
    global_load_dword v19, v[16:17], off sc1
    v_mfma_f32_16x16x32_bf16 v[36:39], a[148:151], v[88:91], v[36:39]
    ds_read_b128 v[84:87], v5 offset:9216
    v_mfma_f32_16x16x32_bf16 v[44:47], a[148:151], v[92:95], v[44:47]
    v_mfma_f32_16x16x32_bf16 v[40:43], a[144:147], v[92:95], v[40:43]
    buffer_load_dwordx4 v2, s[8:11], s23 offen offset:3072 lds
    s_waitcnt lgkmcnt(4)
    v_mfma_f32_16x16x32_bf16 v[32:35], a[152:155], v[96:99], v[32:35]
    ds_read_b128 v[88:91], v4 offset:10240
    s_add_u32 s20, s20, 32768
    v_mfma_f32_16x16x32_bf16 v[36:39], a[156:159], v[96:99], v[36:39]
    ds_read_b128 v[92:95], v5 offset:10240
    s_cmp_ge_u32 s20, 163840
    v_mfma_f32_16x16x32_bf16 v[44:47], a[156:159], v[100:103], v[44:47]
    s_cselect_b32 s60, 163840, 0
    s_sub_u32 s20, s20, s60
    v_mfma_f32_16x16x32_bf16 v[40:43], a[152:155], v[100:103], v[40:43]
    s_lshl_b32 s61, s33, 13
    s_waitcnt lgkmcnt(4)
    v_mfma_f32_16x16x32_bf16 v[32:35], a[160:163], v[72:75], v[32:35]
    ds_read_b128 v[96:99], v4 offset:11264
    s_and_b32 s61, s61, 0x2000
    v_mfma_f32_16x16x32_bf16 v[36:39], a[164:167], v[72:75], v[36:39]
    ds_read_b128 v[100:103], v5 offset:11264
    s_xor_b32 s61, s61, s31
    v_mfma_f32_16x16x32_bf16 v[44:47], a[164:167], v[76:79], v[44:47]
    s_lshl_b32 s23, s33, 21
    s_add_u32 s23, s23, s61
    v_mfma_f32_16x16x32_bf16 v[40:43], a[160:163], v[76:79], v[40:43]
    s_cmp_gt_u32 s33, s35
    s_waitcnt lgkmcnt(4)
    v_mfma_f32_16x16x32_bf16 v[32:35], a[168:171], v[80:83], v[32:35]
    ds_read_b128 v[72:75], v4 offset:16384
    s_cselect_b32 s23, 0xe000000, s23
    v_mfma_f32_16x16x32_bf16 v[36:39], a[172:175], v[80:83], v[36:39]
    ds_read_b128 v[76:79], v5 offset:16384
    s_add_u32 m0, s20, 0
    v_mfma_f32_16x16x32_bf16 v[44:47], a[172:175], v[84:87], v[44:47]
    buffer_load_dwordx4 v1, s[8:11], s23 offen offset:0 lds
    v_mfma_f32_16x16x32_bf16 v[40:43], a[168:171], v[84:87], v[40:43]
    buffer_load_dwordx4 v1, s[8:11], s23 offen offset:1024 lds
    s_waitcnt lgkmcnt(4)
    v_mfma_f32_16x16x32_bf16 v[32:35], a[176:179], v[88:91], v[32:35]
    ds_read_b128 v[80:83], v4 offset:17408
    v_mfma_f32_16x16x32_bf16 v[36:39], a[180:183], v[88:91], v[36:39]
    ds_read_b128 v[84:87], v5 offset:17408
    v_mfma_f32_16x16x32_bf16 v[44:47], a[180:183], v[92:95], v[44:47]
    buffer_load_dwordx4 v1, s[8:11], s23 offen offset:2048 lds
    v_mfma_f32_16x16x32_bf16 v[40:43], a[176:179], v[92:95], v[40:43]
    s_waitcnt lgkmcnt(4)
    v_mfma_f32_16x16x32_bf16 v[32:35], a[184:187], v[96:99], v[32:35]
    ds_read_b128 v[88:91], v4 offset:18432
    v_mfma_f32_16x16x32_bf16 v[36:39], a[188:191], v[96:99], v[36:39]
    ds_read_b128 v[92:95], v5 offset:18432
    v_mfma_f32_16x16x32_bf16 v[44:47], a[188:191], v[100:103], v[44:47]
    v_mfma_f32_16x16x32_bf16 v[40:43], a[184:187], v[100:103], v[40:43]
    buffer_load_dwordx4 v1, s[8:11], s23 offen offset:3072 lds
    s_waitcnt lgkmcnt(4)
    v_mfma_f32_16x16x32_bf16 v[32:35], a[192:195], v[72:75], v[32:35]
    ds_read_b128 v[96:99], v4 offset:19456
    s_waitcnt vmcnt(5)
    v_cmp_lt_u32 vcc, v19, v18
    v_mfma_f32_16x16x32_bf16 v[36:39], a[196:199], v[72:75], v[36:39]
    ds_read_b128 v[100:103], v5 offset:19456
    v_mfma_f32_16x16x32_bf16 v[44:47], a[196:199], v[76:79], v[44:47]
    v_mfma_f32_16x16x32_bf16 v[40:43], a[192:195], v[76:79], v[40:43]
    s_cbranch_vccnz seg_pslow
seg_pok:
    s_waitcnt lgkmcnt(4)
    v_mfma_f32_16x16x32_bf16 v[32:35], a[200:203], v[80:83], v[32:35]
    ds_read_b128 v[72:75], v4 offset:24576
    buffer_load_dwordx4 v[104:107], v23, s[8:11], s24 offen offset:0 sc1
    v_mfma_f32_16x16x32_bf16 v[36:39], a[204:207], v[80:83], v[36:39]
    ds_read_b128 v[76:79], v5 offset:24576
    buffer_load_dwordx4 v[108:111], v23, s[8:11], s24 offen offset:1024 sc1
    v_mfma_f32_16x16x32_bf16 v[44:47], a[204:207], v[84:87], v[44:47]
    buffer_load_dwordx4 v[112:115], v23, s[8:11], s24 offen offset:2048 sc1
    v_mfma_f32_16x16x32_bf16 v[40:43], a[200:203], v[84:87], v[40:43]
    s_add_u32 m0, s20, 4096
    s_waitcnt lgkmcnt(4)
    v_mfma_f32_16x16x32_bf16 v[32:35], a[208:211], v[88:91], v[32:35]
    ds_read_b128 v[80:83], v4 offset:25600
    buffer_load_dwordx4 v2, s[8:11], s23 offen offset:0 lds
    v_mfma_f32_16x16x32_bf16 v[36:39], a[212:215], v[88:91], v[36:39]
    ds_read_b128 v[84:87], v5 offset:25600
    buffer_load_dwordx4 v2, s[8:11], s23 offen offset:1024 lds
    v_mfma_f32_16x16x32_bf16 v[44:47], a[212:215], v[92:95], v[44:47]
    v_mfma_f32_16x16x32_bf16 v[40:43], a[208:211], v[92:95], v[40:43]
    s_waitcnt lgkmcnt(4)
    v_mfma_f32_16x16x32_bf16 v[32:35], a[216:219], v[96:99], v[32:35]
    ds_read_b128 v[88:91], v4 offset:26624
    v_mfma_f32_16x16x32_bf16 v[36:39], a[220:223], v[96:99], v[36:39]
    ds_read_b128 v[92:95], v5 offset:26624
    v_mfma_f32_16x16x32_bf16 v[44:47], a[220:223], v[100:103], v[44:47]
    buffer_load_dwordx4 v2, s[8:11], s23 offen offset:2048 lds
    v_mfma_f32_16x16x32_bf16 v[40:43], a[216:219], v[100:103], v[40:43]
    s_waitcnt lgkmcnt(4)
    v_mfma_f32_16x16x32_bf16 v[32:35], a[224:227], v[72:75], v[32:35]
    ds_read_b128 v[96:99], v4 offset:27648
    v_mfma_f32_16x16x32_bf16 v[36:39], a[228:231], v[72:75], v[36:39]
    ds_read_b128 v[100:103], v5 offset:27648
    v_mfma_f32_16x16x32_bf16 v[44:47], a[228:231], v[76:79], v[44:47]
    v_add_u32 v4, s22, v4
    v_add_u32 v5, s22, v5
    v_mfma_f32_16x16x32_bf16 v[40:43], a[224:227], v[76:79], v[40:43]
    buffer_load_dwordx4 v2, s[8:11], s23 offen offset:3072 lds
    s_waitcnt vmcnt(26)
    s_barrier
    s_waitcnt lgkmcnt(4)
    v_mfma_f32_16x16x32_bf16 v[32:35], a[232:235], v[80:83], v[32:35]
    ds_read_b128 v[72:75], v4 offset:0
    s_add_u32 s20, s20, 32768
    s_cmp_ge_u32 s20, 163840
    v_mfma_f32_16x16x32_bf16 v[36:39], a[236:239], v[80:83], v[36:39]
    ds_read_b128 v[76:79], v5 offset:0
    s_cselect_b32 s60, 163840, 0
    s_sub_u32 s20, s20, s60
    v_mfma_f32_16x16x32_bf16 v[44:47], a[236:239], v[84:87], v[44:47]
    s_add_u32 s23, s23, 0x40000
    v_mfma_f32_16x16x32_bf16 v[40:43], a[232:235], v[84:87], v[40:43]
    s_waitcnt lgkmcnt(4)
    v_mfma_f32_16x16x32_bf16 v[32:35], a[240:243], v[88:91], v[32:35]
    ds_read_b128 v[80:83], v4 offset:1024
    v_mfma_f32_16x16x32_bf16 v[36:39], a[244:247], v[88:91], v[36:39]
    ds_read_b128 v[84:87], v5 offset:1024
    v_mfma_f32_16x16x32_bf16 v[44:47], a[244:247], v[92:95], v[44:47]
    v_mfma_f32_16x16x32_bf16 v[40:43], a[240:243], v[92:95], v[40:43]
    s_waitcnt lgkmcnt(4)
    v_mfma_f32_16x16x32_bf16 v[48:51], a[248:251], v[96:99], v[32:35]
    ds_read_b128 v[88:91], v4 offset:2048
    v_mfma_f32_16x16x32_bf16 v[52:55], a[252:255], v[96:99], v[36:39]
    ds_read_b128 v[92:95], v5 offset:2048
    v_mfma_f32_16x16x32_bf16 v[60:63], a[252:255], v[100:103], v[44:47]
    s_cmp_lt_u32 s26, s39
    v_mfma_f32_16x16x32_bf16 v[56:59], a[248:251], v[100:103], v[40:43]
    s_cbranch_scc1 seg_p
    s_xor_b32 s24, s24, 0x80000
    s_waitcnt vmcnt(0)
    v_pk_add_f32 v[104:105], v[104:105], v[64:65]
    v_pk_add_f32 v[106:107], v[106:107], v[66:67]
    v_pk_add_f32 v[108:109], v[108:109], v[112:113]
    v_pk_add_f32 v[110:111], v[110:111], v[114:115]
    v_pk_add_f32 v[104:105], v[104:105], v[108:109]
    v_pk_add_f32 v[106:107], v[106:107], v[110:111]
    v_cvt_pk_bf16_f32 v104, 0, v104
    v_cvt_pk_bf16_f32 v105, 0, v105
    v_cvt_pk_bf16_f32 v106, 0, v106
    v_cvt_pk_bf16_f32 v107, 0, v107
    buffer_store_dwordx4 v[104:107], v15, s[16:19], s25 offen
    buffer_store_dwordx4 v[48:51], v20, s[8:11], s24 offen
    buffer_store_dwordx4 v[52:55], v21, s[8:11], s24 offen
    buffer_store_dwordx4 v[56:59], v22, s[8:11], s24 offen
    s_lshl_b32 s25, s35, 18
    s_waitcnt vmcnt(0)
    s_barrier
    s_add_u32 s26, s26, 1
    v_mov_b32 v12, s26
    buffer_store_dword v12, v11, s[8:11], s27 offen
    v_mov_b32 v18, s26
    v_writelane_b32 v18, s34, 32
    v_writelane_b32 v18, s40, 33
L_sp_84:
    global_load_dword v19, v[16:17], off sc1
    s_add_u32 s30, s30, 1
    s_cmp_gt_u32 s30, 0x200000
    s_cbranch_scc1 chain_kernel_wabort
    s_waitcnt vmcnt(0)
    v_cmp_lt_u32 vcc, v19, v18
    s_cbranch_vccz L_spok_85
    s_branch L_sp_84
L_spok_85:
    buffer_load_dwordx4 v[104:107], v23, s[8:11], s24 offen offset:0 sc1
    buffer_load_dwordx4 v[108:111], v23, s[8:11], s24 offen offset:1024 sc1
    buffer_load_dwordx4 v[112:115], v23, s[8:11], s24 offen offset:2048 sc1
    s_waitcnt vmcnt(0) lgkmcnt(0)
    v_pk_add_f32 v[104:105], v[104:105], v[60:61]
    v_pk_add_f32 v[106:107], v[106:107], v[62:63]
    v_pk_add_f32 v[108:109], v[108:109], v[112:113]
    v_pk_add_f32 v[110:111], v[110:111], v[114:115]
    v_pk_add_f32 v[104:105], v[104:105], v[108:109]
    v_pk_add_f32 v[106:107], v[106:107], v[110:111]
    v_cvt_pk_bf16_f32 v104, 0, v104
    v_cvt_pk_bf16_f32 v105, 0, v105
    v_cvt_pk_bf16_f32 v106, 0, v106
    v_cvt_pk_bf16_f32 v107, 0, v107
    buffer_store_dwordx4 v[104:107], v15, s[16:19], s25 offen
seg_t0:
    s_mov_b32 s35, 63
    s_lshr_b32 s60, s57, 3
    s_lshl_b32 s60, s60, 8
    s_add_u32 s60, s60, 0xd201000
    s_add_u32 s37, s60, s100
    s_addc_u32 s38, s101, 0
seg_t:
    s_and_b32 s33, s36, 0xff
    s_cbranch_scc0 seg_end
    s_lshr_b32 s36, s36, 8
    s_lshl_b32 s20, s58, 13
    s_mov_b32 s21, 0
    s_lshr_b32 s60, s57, 4
    s_lshl_b32 s60, s60, 12
    v_add_u32 v5, s60, v1
    v_xor_b32 v4, 4096, v5
    s_lshl_b32 s61, s33, 13
    s_and_b32 s61, s61, 0x2000
    s_xor_b32 s61, s61, s31
    s_lshl_b32 s23, s33, 21
    s_add_u32 s23, s23, s61
    s_cmp_gt_u32 s33, s35
    s_cselect_b32 s23, 0xe000000, s23
    s_xor_b32 s24, s24, 0x80000
    s_lshl_b32 s25, s33, 18
    s_add_u32 s34, s33, 3
    s_min_u32 s34, s34, 64
    v_mov_b32 v18, s26
    v_writelane_b32 v18, s34, 32
    v_writelane_b32 v18, s40, 33
L_sp_86:
    global_load_dword v19, v[16:17], off sc1
    s_add_u32 s30, s30, 1
    s_cmp_gt_u32 s30, 0x200000
    s_cbranch_scc1 chain_kernel_wabort
    s_waitcnt vmcnt(0)
    v_cmp_lt_u32 vcc, v19, v18
    s_cbranch_vccz L_spok_87
    s_sleep 2
    s_branch L_sp_86
L_spok_87:
    s_cmp_lt_u32 s33, 62
    s_cbranch_scc1 L_tf_88
    v_writelane_b32 v16, s37, 33
    v_writelane_b32 v17, s38, 33
    s_mov_b32 s40, 32
    v_mov_b32 v18, s26
    v_writelane_b32 v18, s34, 32
    v_writelane_b32 v18, s40, 33
L_sp_89:
    global_load_dword v19, v[16:17], off sc1
    s_add_u32 s30, s30, 1
    s_cmp_gt_u32 s30, 0x200000
    s_cbranch_scc1 chain_kernel_wabort
    s_waitcnt vmcnt(0)
    v_cmp_lt_u32 vcc, v19, v18
    s_cbranch_vccz L_spok_90
    s_branch L_sp_89
L_spok_90:
L_tf_88:
    s_add_u32 m0, s20, 0
    s_nop 0
    buffer_load_dwordx4 v1, s[8:11], s23 offen offset:0 lds
    buffer_load_dwordx4 v1, s[8:11], s23 offen offset:1024 lds
    buffer_load_dwordx4 v1, s[8:11], s23 offen offset:2048 lds
    buffer_load_dwordx4 v1, s[8:11], s23 offen offset:3072 lds
    s_add_u32 m0, s20, 4096
    s_nop 0
    buffer_load_dwordx4 v2, s[8:11], s23 offen offset:0 lds
    buffer_load_dwordx4 v2, s[8:11], s23 offen offset:1024 lds
    buffer_load_dwordx4 v2, s[8:11], s23 offen offset:2048 lds
    buffer_load_dwordx4 v2, s[8:11], s23 offen offset:3072 lds
    s_add_u32 s20, s20, 32768
    s_cmp_ge_u32 s20, 163840
    s_cselect_b32 s60, 163840, 0
    s_sub_u32 s20, s20, s60
    s_add_u32 s23, s23, 0x40000
    s_add_u32 m0, s20, 0
    s_nop 0
    buffer_load_dwordx4 v1, s[8:11], s23 offen offset:0 lds
    buffer_load_dwordx4 v1, s[8:11], s23 offen offset:1024 lds
    buffer_load_dwordx4 v1, s[8:11], s23 offen offset:2048 lds
    buffer_load_dwordx4 v1, s[8:11], s23 offen offset:3072 lds
    s_add_u32 m0, s20, 4096
    s_nop 0
    buffer_load_dwordx4 v2, s[8:11], s23 offen offset:0 lds
    buffer_load_dwordx4 v2, s[8:11], s23 offen offset:1024 lds
    buffer_load_dwordx4 v2, s[8:11], s23 offen offset:2048 lds
    buffer_load_dwordx4 v2, s[8:11], s23 offen offset:3072 lds
    s_waitcnt vmcnt(8)
    s_barrier
    ds_read_b128 v[72:75], v4 offset:0
    ds_read_b128 v[76:79], v5 offset:0
    ds_read_b128 v[80:83], v4 offset:1024
    ds_read_b128 v[84:87], v5 offset:1024
    ds_read_b128 v[88:91], v4 offset:2048
    ds_read_b128 v[92:95], v5 offset:2048
    s_waitcnt lgkmcnt(4)
    v_mfma_f32_16x16x32_bf16 v[32:35], a[0:3], v[72:75], 0
    ds_read_b128 v[96:99], v4 offset:3072
    v_mfma_f32_16x16x32_bf16 v[36:39], a[4:7], v[72:75], 0
    ds_read_b128 v[100:103], v5 offset:3072
    v_mfma_f32_16x16x32_bf16 v[44:47], a[4:7], v[76:79], 0
    v_mfma_f32_16x16x32_bf16 v[40:43], a[0:3], v[76:79], 0
    s_waitcnt lgkmcnt(4)
    v_mfma_f32_16x16x32_bf16 v[32:35], a[8:11], v[80:83], v[32:35]
    ds_read_b128 v[72:75], v4 offset:8192
    v_mfma_f32_16x16x32_bf16 v[36:39], a[12:15], v[80:83], v[36:39]
    ds_read_b128 v[76:79], v5 offset:8192
    v_mfma_f32_16x16x32_bf16 v[44:47], a[12:15], v[84:87], v[44:47]
    v_mfma_f32_16x16x32_bf16 v[40:43], a[8:11], v[84:87], v[40:43]
    s_waitcnt lgkmcnt(4)
    v_mfma_f32_16x16x32_bf16 v[32:35], a[16:19], v[88:91], v[32:35]
    ds_read_b128 v[80:83], v4 offset:9216
    v_mfma_f32_16x16x32_bf16 v[36:39], a[20:23], v[88:91], v[36:39]
    ds_read_b128 v[84:87], v5 offset:9216
    v_mfma_f32_16x16x32_bf16 v[44:47], a[20:23], v[92:95], v[44:47]
    v_mfma_f32_16x16x32_bf16 v[40:43], a[16:19], v[92:95], v[40:43]
    s_waitcnt lgkmcnt(4)
    v_mfma_f32_16x16x32_bf16 v[32:35], a[24:27], v[96:99], v[32:35]
    ds_read_b128 v[88:91], v4 offset:10240
    v_mfma_f32_16x16x32_bf16 v[36:39], a[28:31], v[96:99], v[36:39]
    ds_read_b128 v[92:95], v5 offset:10240
    v_mfma_f32_16x16x32_bf16 v[44:47], a[28:31], v[100:103], v[44:47]
    v_mfma_f32_16x16x32_bf16 v[40:43], a[24:27], v[100:103], v[40:43]
    s_waitcnt lgkmcnt(4)
    v_mfma_f32_16x16x32_bf16 v[32:35], a[32:35], v[72:75], v[32:35]
    ds_read_b128 v[96:99], v4 offset:11264
    v_mfma_f32_16x16x32_bf16 v[36:39], a[36:39], v[72:75], v[36:39]
    ds_read_b128 v[100:103], v5 offset:11264
    v_mfma_f32_16x16x32_bf16 v[44:47], a[36:39], v[76:79], v[44:47]
    v_mfma_f32_16x16x32_bf16 v[40:43], a[32:35], v[76:79], v[40:43]
    s_waitcnt lgkmcnt(4)
    v_mfma_f32_16x16x32_bf16 v[32:35], a[40:43], v[80:83], v[32:35]
    ds_read_b128 v[72:75], v4 offset:16384
    v_mfma_f32_16x16x32_bf16 v[36:39], a[44:47], v[80:83], v[36:39]
    ds_read_b128 v[76:79], v5 offset:16384
    v_mfma_f32_16x16x32_bf16 v[44:47], a[44:47], v[84:87], v[44:47]
    v_mfma_f32_16x16x32_bf16 v[40:43], a[40:43], v[84:87], v[40:43]
    s_waitcnt lgkmcnt(4)
    v_mfma_f32_16x16x32_bf16 v[32:35], a[48:51], v[88:91], v[32:35]
    ds_read_b128 v[80:83], v4 offset:17408
    v_mfma_f32_16x16x32_bf16 v[36:39], a[52:55], v[88:91], v[36:39]
    ds_read_b128 v[84:87], v5 offset:17408
    v_mfma_f32_16x16x32_bf16 v[44:47], a[52:55], v[92:95], v[44:47]
    v_mfma_f32_16x16x32_bf16 v[40:43], a[48:51], v[92:95], v[40:43]
    s_waitcnt lgkmcnt(4)
    v_mfma_f32_16x16x32_bf16 v[32:35], a[56:59], v[96:99], v[32:35]
    ds_read_b128 v[88:91], v4 offset:18432
    v_mfma_f32_16x16x32_bf16 v[36:39], a[60:63], v[96:99], v[36:39]
    ds_read_b128 v[92:95], v5 offset:18432
    v_mfma_f32_16x16x32_bf16 v[44:47], a[60:63], v[100:103], v[44:47]
    v_mfma_f32_16x16x32_bf16 v[40:43], a[56:59], v[100:103], v[40:43]
    s_waitcnt lgkmcnt(4)
    v_mfma_f32_16x16x32_bf16 v[32:35], a[64:67], v[72:75], v[32:35]
    ds_read_b128 v[96:99], v4 offset:19456
    v_mfma_f32_16x16x32_bf16 v[36:39], a[68:71], v[72:75], v[36:39]
    ds_read_b128 v[100:103], v5 offset:19456
    v_mfma_f32_16x16x32_bf16 v[44:47], a[68:71], v[76:79], v[44:47]
    v_mfma_f32_16x16x32_bf16 v[40:43], a[64:67], v[76:79], v[40:43]
    s_waitcnt lgkmcnt(4)
    v_mfma_f32_16x16x32_bf16 v[32:35], a[72:75], v[80:83], v[32:35]
    ds_read_b128 v[72:75], v4 offset:24576
    v_mfma_f32_16x16x32_bf16 v[36:39], a[76:79], v[80:83], v[36:39]
    ds_read_b128 v[76:79], v5 offset:24576
    v_mfma_f32_16x16x32_bf16 v[44:47], a[76:79], v[84:87], v[44:47]
    v_mfma_f32_16x16x32_bf16 v[40:43], a[72:75], v[84:87], v[40:43]
    s_waitcnt lgkmcnt(4)
    v_mfma_f32_16x16x32_bf16 v[32:35], a[80:83], v[88:91], v[32:35]
    ds_read_b128 v[80:83], v4 offset:25600
    v_mfma_f32_16x16x32_bf16 v[36:39], a[84:87], v[88:91], v[36:39]
    ds_read_b128 v[84:87], v5 offset:25600
    v_mfma_f32_16x16x32_bf16 v[44:47], a[84:87], v[92:95], v[44:47]
    v_mfma_f32_16x16x32_bf16 v[40:43], a[80:83], v[92:95], v[40:43]
    s_waitcnt lgkmcnt(4)
    v_mfma_f32_16x16x32_bf16 v[32:35], a[88:91], v[96:99], v[32:35]
    ds_read_b128 v[88:91], v4 offset:26624
    v_mfma_f32_16x16x32_bf16 v[36:39], a[92:95], v[96:99], v[36:39]
    ds_read_b128 v[92:95], v5 offset:26624
    v_mfma_f32_16x16x32_bf16 v[44:47], a[92:95], v[100:103], v[44:47]
    v_mfma_f32_16x16x32_bf16 v[40:43], a[88:91], v[100:103], v[40:43]
    s_waitcnt lgkmcnt(4)
    v_mfma_f32_16x16x32_bf16 v[32:35], a[96:99], v[72:75], v[32:35]
    ds_read_b128 v[96:99], v4 offset:27648
    v_mfma_f32_16x16x32_bf16 v[36:39], a[100:103], v[72:75], v[36:39]
    ds_read_b128 v[100:103], v5 offset:27648
    v_mfma_f32_16x16x32_bf16 v[44:47], a[100:103], v[76:79], v[44:47]
    v_mfma_f32_16x16x32_bf16 v[40:43], a[96:99], v[76:79], v[40:43]
    s_waitcnt vmcnt(0)
    s_barrier
    s_waitcnt lgkmcnt(4)
    v_mfma_f32_16x16x32_bf16 v[32:35], a[104:107], v[80:83], v[32:35]
    ds_read_b128 v[72:75], v4 offset:32768
    v_mfma_f32_16x16x32_bf16 v[36:39], a[108:111], v[80:83], v[36:39]
    ds_read_b128 v[76:79], v5 offset:32768
    v_mfma_f32_16x16x32_bf16 v[44:47], a[108:111], v[84:87], v[44:47]
    v_mfma_f32_16x16x32_bf16 v[40:43], a[104:107], v[84:87], v[40:43]
    s_waitcnt lgkmcnt(4)
    v_mfma_f32_16x16x32_bf16 v[32:35], a[112:115], v[88:91], v[32:35]
    ds_read_b128 v[80:83], v4 offset:33792
    v_mfma_f32_16x16x32_bf16 v[36:39], a[116:119], v[88:91], v[36:39]
    ds_read_b128 v[84:87], v5 offset:33792
    v_mfma_f32_16x16x32_bf16 v[44:47], a[116:119], v[92:95], v[44:47]
    v_mfma_f32_16x16x32_bf16 v[40:43], a[112:115], v[92:95], v[40:43]
    s_waitcnt lgkmcnt(4)
    v_mfma_f32_16x16x32_bf16 v[32:35], a[120:123], v[96:99], v[32:35]
    ds_read_b128 v[88:91], v4 offset:34816
    v_mfma_f32_16x16x32_bf16 v[36:39], a[124:127], v[96:99], v[36:39]
    ds_read_b128 v[92:95], v5 offset:34816
    v_mfma_f32_16x16x32_bf16 v[44:47], a[124:127], v[100:103], v[44:47]
    v_mfma_f32_16x16x32_bf16 v[40:43], a[120:123], v[100:103], v[40:43]
    s_waitcnt lgkmcnt(4)
    v_mfma_f32_16x16x32_bf16 v[32:35], a[128:131], v[72:75], v[32:35]
    ds_read_b128 v[96:99], v4 offset:35840
    v_mfma_f32_16x16x32_bf16 v[36:39], a[132:135], v[72:75], v[36:39]
    ds_read_b128 v[100:103], v5 offset:35840
    v_mfma_f32_16x16x32_bf16 v[44:47], a[132:135], v[76:79], v[44:47]
    v_mfma_f32_16x16x32_bf16 v[40:43], a[128:131], v[76:79], v[40:43]
    s_waitcnt lgkmcnt(4)
    v_mfma_f32_16x16x32_bf16 v[32:35], a[136:139], v[80:83], v[32:35]
    ds_read_b128 v[72:75], v4 offset:40960
    v_mfma_f32_16x16x32_bf16 v[36:39], a[140:143], v[80:83], v[36:39]
    ds_read_b128 v[76:79], v5 offset:40960
    v_mfma_f32_16x16x32_bf16 v[44:47], a[140:143], v[84:87], v[44:47]
    v_mfma_f32_16x16x32_bf16 v[40:43], a[136:139], v[84:87], v[40:43]
    s_waitcnt lgkmcnt(4)
    v_mfma_f32_16x16x32_bf16 v[32:35], a[144:147], v[88:91], v[32:35]
    ds_read_b128 v[80:83], v4 offset:41984
    v_mfma_f32_16x16x32_bf16 v[36:39], a[148:151], v[88:91], v[36:39]
    ds_read_b128 v[84:87], v5 offset:41984
    v_mfma_f32_16x16x32_bf16 v[44:47], a[148:151], v[92:95], v[44:47]
    v_mfma_f32_16x16x32_bf16 v[40:43], a[144:147], v[92:95], v[40:43]
    s_waitcnt lgkmcnt(4)
    v_mfma_f32_16x16x32_bf16 v[32:35], a[152:155], v[96:99], v[32:35]
    ds_read_b128 v[88:91], v4 offset:43008
    v_mfma_f32_16x16x32_bf16 v[36:39], a[156:159], v[96:99], v[36:39]
    ds_read_b128 v[92:95], v5 offset:43008
    v_mfma_f32_16x16x32_bf16 v[44:47], a[156:159], v[100:103], v[44:47]
    v_mfma_f32_16x16x32_bf16 v[40:43], a[152:155], v[100:103], v[40:43]
    s_waitcnt lgkmcnt(4)
    v_mfma_f32_16x16x32_bf16 v[32:35], a[160:163], v[72:75], v[32:35]
    ds_read_b128 v[96:99], v4 offset:44032
    v_mfma_f32_16x16x32_bf16 v[36:39], a[164:167], v[72:75], v[36:39]
    ds_read_b128 v[100:103], v5 offset:44032
    v_mfma_f32_16x16x32_bf16 v[44:47], a[164:167], v[76:79], v[44:47]
    v_mfma_f32_16x16x32_bf16 v[40:43], a[160:163], v[76:79], v[40:43]
    s_waitcnt lgkmcnt(4)
    v_mfma_f32_16x16x32_bf16 v[32:35], a[168:171], v[80:83], v[32:35]
    ds_read_b128 v[72:75], v4 offset:49152
    v_mfma_f32_16x16x32_bf16 v[36:39], a[172:175], v[80:83], v[36:39]
    ds_read_b128 v[76:79], v5 offset:49152
    v_mfma_f32_16x16x32_bf16 v[44:47], a[172:175], v[84:87], v[44:47]
    v_mfma_f32_16x16x32_bf16 v[40:43], a[168:171], v[84:87], v[40:43]
    s_waitcnt lgkmcnt(4)
    v_mfma_f32_16x16x32_bf16 v[32:35], a[176:179], v[88:91], v[32:35]
    ds_read_b128 v[80:83], v4 offset:50176
    v_mfma_f32_16x16x32_bf16 v[36:39], a[180:183], v[88:91], v[36:39]
    ds_read_b128 v[84:87], v5 offset:50176
    v_mfma_f32_16x16x32_bf16 v[44:47], a[180:183], v[92:95], v[44:47]
    v_mfma_f32_16x16x32_bf16 v[40:43], a[176:179], v[92:95], v[40:43]
    s_waitcnt lgkmcnt(4)
    v_mfma_f32_16x16x32_bf16 v[32:35], a[184:187], v[96:99], v[32:35]
    ds_read_b128 v[88:91], v4 offset:51200
    v_mfma_f32_16x16x32_bf16 v[36:39], a[188:191], v[96:99], v[36:39]
    ds_read_b128 v[92:95], v5 offset:51200
    v_mfma_f32_16x16x32_bf16 v[44:47], a[188:191], v[100:103], v[44:47]
    v_mfma_f32_16x16x32_bf16 v[40:43], a[184:187], v[100:103], v[40:43]
    s_waitcnt lgkmcnt(4)
    v_mfma_f32_16x16x32_bf16 v[32:35], a[192:195], v[72:75], v[32:35]
    ds_read_b128 v[96:99], v4 offset:52224
    v_mfma_f32_16x16x32_bf16 v[36:39], a[196:199], v[72:75], v[36:39]
    ds_read_b128 v[100:103], v5 offset:52224
    v_mfma_f32_16x16x32_bf16 v[44:47], a[196:199], v[76:79], v[44:47]
    v_mfma_f32_16x16x32_bf16 v[40:43], a[192:195], v[76:79], v[40:43]
    s_waitcnt lgkmcnt(4)
    v_mfma_f32_16x16x32_bf16 v[32:35], a[200:203], v[80:83], v[32:35]
    ds_read_b128 v[72:75], v4 offset:57344
    v_mfma_f32_16x16x32_bf16 v[36:39], a[204:207], v[80:83], v[36:39]
    ds_read_b128 v[76:79], v5 offset:57344
    v_mfma_f32_16x16x32_bf16 v[44:47], a[204:207], v[84:87], v[44:47]
    v_mfma_f32_16x16x32_bf16 v[40:43], a[200:203], v[84:87], v[40:43]
    s_waitcnt lgkmcnt(4)
    v_mfma_f32_16x16x32_bf16 v[32:35], a[208:211], v[88:91], v[32:35]
    ds_read_b128 v[80:83], v4 offset:58368
    v_mfma_f32_16x16x32_bf16 v[36:39], a[212:215], v[88:91], v[36:39]
    ds_read_b128 v[84:87], v5 offset:58368
    v_mfma_f32_16x16x32_bf16 v[44:47], a[212:215], v[92:95], v[44:47]
    v_mfma_f32_16x16x32_bf16 v[40:43], a[208:211], v[92:95], v[40:43]
    s_waitcnt lgkmcnt(4)
    v_mfma_f32_16x16x32_bf16 v[32:35], a[216:219], v[96:99], v[32:35]
    ds_read_b128 v[88:91], v4 offset:59392
    v_mfma_f32_16x16x32_bf16 v[36:39], a[220:223], v[96:99], v[36:39]
    ds_read_b128 v[92:95], v5 offset:59392
    v_mfma_f32_16x16x32_bf16 v[44:47], a[220:223], v[100:103], v[44:47]
    v_mfma_f32_16x16x32_bf16 v[40:43], a[216:219], v[100:103], v[40:43]
    s_waitcnt lgkmcnt(4)
    v_mfma_f32_16x16x32_bf16 v[32:35], a[224:227], v[72:75], v[32:35]
    ds_read_b128 v[96:99], v4 offset:60416
    v_mfma_f32_16x16x32_bf16 v[36:39], a[228:231], v[72:75], v[36:39]
    ds_read_b128 v[100:103], v5 offset:60416
    v_mfma_f32_16x16x32_bf16 v[44:47], a[228:231], v[76:79], v[44:47]
    v_mfma_f32_16x16x32_bf16 v[40:43], a[224:227], v[76:79], v[40:43]
    s_waitcnt lgkmcnt(4)
    v_mfma_f32_16x16x32_bf16 v[32:35], a[232:235], v[80:83], v[32:35]
    v_mfma_f32_16x16x32_bf16 v[36:39], a[236:239], v[80:83], v[36:39]
    v_mfma_f32_16x16x32_bf16 v[44:47], a[236:239], v[84:87], v[44:47]
    v_mfma_f32_16x16x32_bf16 v[40:43], a[232:235], v[84:87], v[40:43]
    s_waitcnt lgkmcnt(2)
    v_mfma_f32_16x16x32_bf16 v[32:35], a[240:243], v[88:91], v[32:35]
    v_mfma_f32_16x16x32_bf16 v[36:39], a[244:247], v[88:91], v[36:39]
    v_mfma_f32_16x16x32_bf16 v[44:47], a[244:247], v[92:95], v[44:47]
    v_mfma_f32_16x16x32_bf16 v[40:43], a[240:243], v[92:95], v[40:43]
    s_waitcnt lgkmcnt(0)
    v_mfma_f32_16x16x32_bf16 v[48:51], a[248:251], v[96:99], v[32:35]
    v_mfma_f32_16x16x32_bf16 v[52:55], a[252:255], v[96:99], v[36:39]
    v_mfma_f32_16x16x32_bf16 v[60:63], a[252:255], v[100:103], v[44:47]
    v_mfma_f32_16x16x32_bf16 v[56:59], a[248:251], v[100:103], v[40:43]
    s_nop 7
    buffer_store_dwordx4 v[48:51], v20, s[8:11], s24 offen
    buffer_store_dwordx4 v[52:55], v21, s[8:11], s24 offen
    buffer_store_dwordx4 v[56:59], v22, s[8:11], s24 offen
    s_waitcnt vmcnt(0)
    s_barrier
    s_add_u32 s26, s26, 1
    v_mov_b32 v12, s26
    buffer_store_dword v12, v11, s[8:11], s27 offen
    v_mov_b32 v18, s26
    v_writelane_b32 v18, s34, 32
    v_writelane_b32 v18, s40, 33
L_sp_91:
    global_load_dword v19, v[16:17], off sc1
    s_add_u32 s30, s30, 1
    s_cmp_gt_u32 s30, 0x200000
    s_cbranch_scc1 chain_kernel_wabort
    s_waitcnt vmcnt(0)
    v_cmp_lt_u32 vcc, v19, v18
    s_cbranch_vccz L_spok_92
    s_branch L_sp_91
L_spok_92:
    buffer_load_dwordx4 v[104:107], v23, s[8:11], s24 offen offset:0 sc1
    buffer_load_dwordx4 v[108:111], v23, s[8:11], s24 offen offset:1024 sc1
    buffer_load_dwordx4 v[112:115], v23, s[8:11], s24 offen offset:2048 sc1
    s_waitcnt vmcnt(0)
    v_pk_add_f32 v[104:105], v[104:105], v[60:61]
    v_pk_add_f32 v[106:107], v[106:107], v[62:63]
    v_pk_add_f32 v[108:109], v[108:109], v[112:113]
    v_pk_add_f32 v[110:111], v[110:111], v[114:115]
    v_pk_add_f32 v[104:105], v[104:105], v[108:109]
    v_pk_add_f32 v[106:107], v[106:107], v[110:111]
    v_cvt_pk_bf16_f32 v104, 0, v104
    v_cvt_pk_bf16_f32 v105, 0, v105
    v_cvt_pk_bf16_f32 v106, 0, v106
    v_cvt_pk_bf16_f32 v107, 0, v107
    buffer_store_dwordx4 v[104:107], v15, s[16:19], s25 offen
    s_branch seg_t
seg_end:
    s_endpgm
seg_pslow:
L_sp_93:
    global_load_dword v19, v[16:17], off sc1
    s_add_u32 s30, s30, 1
    s_cmp_gt_u32 s30, 0x200000
    s_cbranch_scc1 chain_kernel_wabort
    s_waitcnt vmcnt(0)
    v_cmp_lt_u32 vcc, v19, v18
    s_cbranch_vccz L_spok_94
    s_sleep 2
    s_branch L_sp_93
L_spok_94:
    s_branch seg_pok
    s_endpgm
chain_kernel_wabort:
    s_mov_b64 exec, 1
    v_mov_b32 v1, 0xdeadbeef
    v_mov_b32 v2, 120
    global_store_dword v2, v1, s[98:99]
    s_endpgm
t_g2_c:
    s_mov_b32 s43, 0
    v_bfe_u32 v16, v0, 5, 1
    v_lshlrev_b32 v23, 13, v16
    v_bfe_u32 v16, v0, 7, 1
    v_lshl_add_u32 v23, v16, 12, v23
    v_bfe_u32 v16, v0, 1, 1
    v_lshl_add_u32 v23, v16, 8, v23
    v_bfe_u32 v16, v0, 1, 1
    v_lshl_add_u32 v23, v16, 6, v23
    v_bfe_u32 v16, v0, 4, 1
    v_lshl_add_u32 v23, v16, 7, v23
    v_bfe_u32 v16, v0, 2, 2
    v_lshl_add_u32 v23, v16, 4, v23
    v_bfe_u32 v16, v0, 0, 1
    v_lshl_add_u32 v23, v16, 3, v23
    v_add_u32 v14, s49, v23
    v_xor_b32 v15, 64, v14
    ds_read_b64_tr_b16 v[72:73], v14 offset:0
    ds_read_b64_tr_b16 v[74:75], v15 offset:0
    ds_read_b128 v[44:47], v12 offset:2048
    ds_read_b128 v[40:43], v12 offset:0
    ds_read_b64_tr_b16 v[76:77], v14 offset:512
    ds_read_b64_tr_b16 v[78:79], v15 offset:512
    ds_read_b128 v[52:55], v12 offset:6144
    ds_read_b128 v[48:51], v12 offset:4096
    ds_read_b128 v[60:63], v12 offset:10240
    ds_read_b128 v[56:59], v12 offset:8192
    ds_read_b128 v[68:71], v12 offset:14336
    ds_read_b128 v[64:67], v12 offset:12288
    s_branch t_g2_as
t_g2:
    s_mov_b32 s43, 0
    v_bfe_u32 v16, v0, 5, 1
    v_lshlrev_b32 v23, 13, v16
    v_bfe_u32 v16, v0, 7, 1
    v_lshl_add_u32 v23, v16, 12, v23
    v_bfe_u32 v16, v0, 1, 1
    v_lshl_add_u32 v23, v16, 8, v23
    v_bfe_u32 v16, v0, 1, 1
    v_lshl_add_u32 v23, v16, 6, v23
    v_bfe_u32 v16, v0, 4, 1
    v_lshl_add_u32 v23, v16, 7, v23
    v_bfe_u32 v16, v0, 2, 2
    v_lshl_add_u32 v23, v16, 4, v23
    v_bfe_u32 v16, v0, 0, 1
    v_lshl_add_u32 v23, v16, 3, v23
    v_add_u32 v14, s49, v23
    v_xor_b32 v15, 64, v14
    ds_read_b64_tr_b16 v[72:73], v14 offset:0
    ds_read_b64_tr_b16 v[74:75], v15 offset:0
    ds_read_b128 v[44:47], v12 offset:2048
    ds_read_b128 v[40:43], v12 offset:0
    ds_read_b64_tr_b16 v[76:77], v14 offset:512
    ds_read_b64_tr_b16 v[78:79], v15 offset:512
    ds_read_b128 v[52:55], v12 offset:6144
    ds_read_b128 v[48:51], v12 offset:4096
    ds_read_b128 v[60:63], v12 offset:10240
    ds_read_b128 v[56:59], v12 offset:8192
    ds_read_b128 v[68:71], v12 offset:14336
    ds_read_b128 v[64:67], v12 offset:12288
    s_waitcnt lgkmcnt(8)
    v_mfma_f32_16x16x32_bf16 a[0:3], v[40:43], v[72:75], 0
    s_xor_b32 m0, s44, 0
    v_mfma_f32_16x16x32_bf16 a[32:35], v[44:47], v[72:75], 0
    buffer_load_dwordx4 v4, s[8:11], s20 offen lds
    s_waitcnt lgkmcnt(6)
    v_mfma_f32_16x16x32_bf16 a[36:39], v[44:47], v[76:79], 0
    ds_read_b64_tr_b16 v[80:81], v14 offset:1024
    v_mfma_f32_16x16x32_bf16 a[4:7], v[40:43], v[76:79], 0
    s_waitcnt lgkmcnt(5)
    v_mfma_f32_16x16x32_bf16 a[64:67], v[48:51], v[72:75], 0
    ds_read_b64_tr_b16 v[82:83], v15 offset:1024
    s_xor_b32 m0, s44, 1024
    v_mfma_f32_16x16x32_bf16 a[96:99], v[52:55], v[72:75], 0
    buffer_load_dwordx4 v5, s[8:11], s20 offen lds
    v_mfma_f32_16x16x32_bf16 a[100:103], v[52:55], v[76:79], 0
    ds_read_b64_tr_b16 v[84:85], v14 offset:1536
    s_add_u32 s20, s20, 128
    v_mfma_f32_16x16x32_bf16 a[68:71], v[48:51], v[76:79], 0
    s_waitcnt lgkmcnt(5)
    v_mfma_f32_16x16x32_bf16 a[128:131], v[56:59], v[72:75], 0
    ds_read_b64_tr_b16 v[86:87], v15 offset:1536
    s_mov_b64 vcc, 0
    v_mfma_f32_16x16x32_bf16 a[160:163], v[60:63], v[72:75], 0
    s_xor_b32 m0, s44, 2048
    v_mfma_f32_16x16x32_bf16 a[164:167], v[60:63], v[76:79], 0
    buffer_load_dwordx4 v4, s[8:11], s21 offen lds
    v_mfma_f32_16x16x32_bf16 a[132:135], v[56:59], v[76:79], 0
    s_bitcmp1_b32 s43, 0
    s_waitcnt lgkmcnt(4)
    v_mfma_f32_16x16x32_bf16 a[192:195], v[64:67], v[72:75], 0
    s_cselect_b32 s61, s5, 0
    s_lshl1_add_u32 s53, s61, s50
    v_mfma_f32_16x16x32_bf16 a[224:227], v[68:71], v[72:75], 0
    s_bitcmp1_b32 s43, 1
    s_cselect_b32 s61, s51, 0
    v_mfma_f32_16x16x32_bf16 a[228:231], v[68:71], v[76:79], 0
    s_add_u32 s53, s53, s61
    s_bitcmp1_b32 s43, 2
    v_mfma_f32_16x16x32_bf16 a[196:199], v[64:67], v[76:79], 0
    s_cselect_b32 s61, s52, 0
    s_waitcnt lgkmcnt(2)
    v_mfma_f32_16x16x32_bf16 a[8:11], v[40:43], v[80:83], 0
    s_add_u32 s53, s53, s61
    s_lshl_b32 s29, s43, 4
    v_mfma_f32_16x16x32_bf16 a[40:43], v[44:47], v[80:83], 0
    s_mov_b64 vcc, -1
    s_waitcnt lgkmcnt(0)
    v_mfma_f32_16x16x32_bf16 a[44:47], v[44:47], v[84:87], 0
    ds_read_b64_tr_b16 v[72:73], v14 offset:2048
    s_xor_b32 m0, s44, 3072
    v_mfma_f32_16x16x32_bf16 a[12:15], v[40:43], v[84:87], 0
    buffer_load_dwordx4 v5, s[8:11], s21 offen lds
    v_mfma_f32_16x16x32_bf16 a[72:75], v[48:51], v[80:83], 0
    ds_read_b64_tr_b16 v[74:75], v15 offset:2048
    s_add_u32 s21, s21, 128
    v_mfma_f32_16x16x32_bf16 a[104:107], v[52:55], v[80:83], 0
    s_xor_b32 m0, s44, 16384
    v_mfma_f32_16x16x32_bf16 a[108:111], v[52:55], v[84:87], 0
    ds_read_b64_tr_b16 v[76:77], v14 offset:2560
    buffer_load_dwordx4 v4, s[8:11], s22 offen lds
    v_mfma_f32_16x16x32_bf16 a[76:79], v[48:51], v[84:87], 0
    s_xor_b32 m0, s44, 17408
    v_mfma_f32_16x16x32_bf16 a[136:139], v[56:59], v[80:83], 0
    ds_read_b64_tr_b16 v[78:79], v15 offset:2560
    buffer_load_dwordx4 v5, s[8:11], s22 offen lds
    v_mfma_f32_16x16x32_bf16 a[168:171], v[60:63], v[80:83], 0
    s_add_u32 s22, s22, 128
    s_xor_b32 m0, s44, 18432
    v_mfma_f32_16x16x32_bf16 a[172:175], v[60:63], v[84:87], 0
    buffer_load_dwordx4 v4, s[8:11], s23 offen lds
    v_mfma_f32_16x16x32_bf16 a[140:143], v[56:59], v[84:87], 0
    v_mfma_f32_16x16x32_bf16 a[200:203], v[64:67], v[80:83], 0
    s_xor_b32 m0, s44, 19456
    v_mfma_f32_16x16x32_bf16 a[232:235], v[68:71], v[80:83], 0
    buffer_load_dwordx4 v5, s[8:11], s23 offen lds
    v_mfma_f32_16x16x32_bf16 a[236:239], v[68:71], v[84:87], 0
    s_add_u32 s23, s23, 128
    s_cmp_ge_u32 s44, 98304
    v_mfma_f32_16x16x32_bf16 a[204:207], v[64:67], v[84:87], 0
    s_cselect_b32 s60, s6, s7
    s_waitcnt lgkmcnt(2)
    v_mfma_f32_16x16x32_bf16 a[16:19], v[40:43], v[72:75], 0
    s_add_u32 s44, s44, s60
    v_mfma_f32_16x16x32_bf16 a[48:51], v[44:47], v[72:75], 0
    s_waitcnt lgkmcnt(0)
    v_mfma_f32_16x16x32_bf16 a[52:55], v[44:47], v[76:79], 0
    ds_read_b64_tr_b16 v[80:81], v14 offset:3072
    v_mfma_f32_16x16x32_bf16 a[20:23], v[40:43], v[76:79], 0
    v_mfma_f32_16x16x32_bf16 a[80:83], v[48:51], v[72:75], 0
    ds_read_b64_tr_b16 v[82:83], v15 offset:3072
    s_set_gpr_idx_on s29, gpr_idx(SRC0)
    v_mov_b32 v24, v128
    v_mov_b32 v25, v129
    v_mov_b32 v26, v130
    v_mov_b32 v27, v131
    s_set_gpr_idx_off
    v_mfma_f32_16x16x32_bf16 a[112:115], v[52:55], v[72:75], 0
    v_mfma_f32_16x16x32_bf16 a[116:119], v[52:55], v[76:79], 0
    ds_read_b64_tr_b16 v[84:85], v14 offset:3584
    s_set_gpr_idx_on s29, gpr_idx(SRC0)
    v_mov_b32 v28, v132
    v_mov_b32 v29, v133
    v_mov_b32 v30, v134
    v_mov_b32 v31, v135
    s_set_gpr_idx_off
    v_mfma_f32_16x16x32_bf16 a[84:87], v[48:51], v[76:79], 0
    v_mfma_f32_16x16x32_bf16 a[144:147], v[56:59], v[72:75], 0
    ds_read_b64_tr_b16 v[86:87], v15 offset:3584
    s_set_gpr_idx_on s29, gpr_idx(SRC0)
    v_mov_b32 v32, v136
    v_mov_b32 v33, v137
    v_mov_b32 v34, v138
    v_mov_b32 v35, v139
    s_set_gpr_idx_off
    v_mfma_f32_16x16x32_bf16 a[176:179], v[60:63], v[72:75], 0
    v_mfma_f32_16x16x32_bf16 a[180:183], v[60:63], v[76:79], 0
    s_set_gpr_idx_on s29, gpr_idx(SRC0)
    v_mov_b32 v36, v140
    v_mov_b32 v37, v141
    v_mov_b32 v38, v142
    v_mov_b32 v39, v143
    s_set_gpr_idx_off
    v_mfma_f32_16x16x32_bf16 a[148:151], v[56:59], v[76:79], 0
    v_mfma_f32_16x16x32_bf16 a[208:211], v[64:67], v[72:75], 0
    buffer_store_dwordx4 v[24:27], v2, s[16:19], s53 offen sc1
    v_mfma_f32_16x16x32_bf16 a[240:243], v[68:71], v[72:75], 0
    v_mfma_f32_16x16x32_bf16 a[244:247], v[68:71], v[76:79], 0
    buffer_store_dwordx4 v[28:31], v3, s[16:19], s53 offen sc1
    v_mfma_f32_16x16x32_bf16 a[212:215], v[64:67], v[76:79], 0
    s_add_u32 s53, s53, s5
    s_waitcnt lgkmcnt(2)
    v_mfma_f32_16x16x32_bf16 a[24:27], v[40:43], v[80:83], 0
    ds_read_b64_tr_b16 v[72:73], v14 offset:16384
    buffer_store_dwordx4 v[32:35], v2, s[16:19], s53 offen sc1
    v_mfma_f32_16x16x32_bf16 a[56:59], v[44:47], v[80:83], 0
    ds_read_b64_tr_b16 v[74:75], v15 offset:16384
    s_waitcnt lgkmcnt(2)
    v_mfma_f32_16x16x32_bf16 a[60:63], v[44:47], v[84:87], 0
    ds_read_b128 v[44:47], v13 offset:2048
    buffer_store_dwordx4 v[36:39], v3, s[16:19], s53 offen sc1
    v_mfma_f32_16x16x32_bf16 a[28:31], v[40:43], v[84:87], 0
    ds_read_b128 v[40:43], v13 offset:0
    v_mfma_f32_16x16x32_bf16 a[88:91], v[48:51], v[80:83], 0
    ds_read_b64_tr_b16 v[76:77], v14 offset:16896
    v_mfma_f32_16x16x32_bf16 a[120:123], v[52:55], v[80:83], 0
    ds_read_b64_tr_b16 v[78:79], v15 offset:16896
    v_mfma_f32_16x16x32_bf16 a[124:127], v[52:55], v[84:87], 0
    ds_read_b128 v[52:55], v13 offset:6144
    v_mfma_f32_16x16x32_bf16 a[92:95], v[48:51], v[84:87], 0
    ds_read_b128 v[48:51], v13 offset:4096
    v_mfma_f32_16x16x32_bf16 a[152:155], v[56:59], v[80:83], 0
    v_mfma_f32_16x16x32_bf16 a[184:187], v[60:63], v[80:83], 0
    v_mfma_f32_16x16x32_bf16 a[188:191], v[60:63], v[84:87], 0
    ds_read_b128 v[60:63], v13 offset:10240
    v_mfma_f32_16x16x32_bf16 a[156:159], v[56:59], v[84:87], 0
    ds_read_b128 v[56:59], v13 offset:8192
    v_mfma_f32_16x16x32_bf16 a[216:219], v[64:67], v[80:83], 0
    v_mfma_f32_16x16x32_bf16 a[248:251], v[68:71], v[80:83], 0
    v_mfma_f32_16x16x32_bf16 a[252:255], v[68:71], v[84:87], 0
    ds_read_b128 v[68:71], v13 offset:14336
    v_mfma_f32_16x16x32_bf16 a[220:223], v[64:67], v[84:87], 0
    ds_read_b128 v[64:67], v13 offset:12288
    s_branch t_g2_b
t_g2_hook:
    s_cmp_eq_u32 s43, 1
    s_cbranch_scc1 t_g2_sig0
    s_cmp_eq_u32 s43, 6
    s_cbranch_scc1 t_g2_sws
    s_cmp_eq_u32 s43, 7
    s_cbranch_scc1 t_g2_swp
    s_cmp_lg_u32 s58, 0
    s_cbranch_scc1 t_g2_a
t_g2_wait:
    s_cmp_eq_u32 s3, 0
    s_cbranch_scc1 t_g2_a
    s_mov_b32 s62, 0
L_sw_95:
    s_load_dword s63, s[98:99], s3 glc
    s_add_u32 s62, s62, 1
    s_cmp_gt_u32 s62, 0x200000
    s_cbranch_scc1 chain_kernel_wabort
    s_waitcnt lgkmcnt(0)
    s_cmp_ge_u32 s63, 32
    s_cbranch_scc1 L_swok_96
    s_sleep 16
    s_branch L_sw_95
L_swok_96:
    s_branch t_g2_a
t_g2_sig0:
    s_cmp_eq_u32 s1, 0
    s_cbranch_scc1 t_g2_as
    v_mov_b32 v24, s1
    v_mov_b32 v25, 1
    s_mov_b64 exec, 1
    global_atomic_add v24, v25, s[98:99] sc1
    s_mov_b64 exec, -1
    s_mov_b32 s1, 0
    s_branch t_g2_as
t_g2_sws:
    s_mov_b32 s12, s36
    s_mov_b32 s13, s37
    s_mov_b32 s14, s38
    s_and_b32 s45, s45, 0xffffb7ff
    s_bitcmp1_b32 s0, 3
    s_cselect_b32 s24, s41, 0
    s_cselect_b32 s26, 0, s41
    s_cselect_b32 s60, 0x4000, 0
    s_or_b32 s45, s45, s60
    s_add_u32 s24, s24, s39
    s_add_u32 s26, s26, s39
    s_bitcmp1_b32 s0, 2
    s_cselect_b32 s61, s40, 0
    s_cselect_b32 s62, 0, s40
    s_cselect_b32 s60, 0x800, 0
    s_or_b32 s45, s45, s60
    s_add_u32 s25, s24, s62
    s_add_u32 s24, s24, s61
    s_add_u32 s27, s26, s62
    s_add_u32 s26, s26, s61
    s_mov_b32 s28, s42
    v_mov_b32 v6, v10
    v_mov_b32 v7, v11
    s_branch t_g2_a
t_g2_swp:
    s_mov_b32 s8, s30
    s_mov_b32 s9, s31
    s_mov_b32 s10, s32
    s_and_b32 s44, s44, 0xffffb7ff
    s_bitcmp1_b32 s0, 1
    s_cselect_b32 s20, s35, 0
    s_cselect_b32 s22, 0, s35
    s_cselect_b32 s60, 0x4000, 0
    s_or_b32 s44, s44, s60
    s_add_u32 s20, s20, s33
    s_add_u32 s22, s22, s33
    s_bitcmp1_b32 s0, 0
    s_cselect_b32 s61, s34, 0
    s_cselect_b32 s62, 0, s34
    s_cselect_b32 s60, 0x800, 0
    s_or_b32 s44, s44, s60
    s_add_u32 s21, s20, s62
    s_add_u32 s20, s20, s61
    s_add_u32 s23, s22, s62
    s_add_u32 s22, s22, s61
    v_mov_b32 v4, v8
    v_mov_b32 v5, v9
t_g2_a:
t_g2_as:
    s_waitcnt lgkmcnt(8)
    v_mfma_f32_16x16x32_bf16 a[0:3], v[40:43], v[72:75], a[0:3]
    s_xor_b32 m0, s44, 0
    v_mfma_f32_16x16x32_bf16 a[32:35], v[44:47], v[72:75], a[32:35]
    buffer_load_dwordx4 v4, s[8:11], s20 offen lds
    s_waitcnt lgkmcnt(6)
    v_mfma_f32_16x16x32_bf16 a[36:39], v[44:47], v[76:79], a[36:39]
    ds_read_b64_tr_b16 v[80:81], v14 offset:1024
    v_mfma_f32_16x16x32_bf16 a[4:7], v[40:43], v[76:79], a[4:7]
    s_waitcnt lgkmcnt(5)
    v_mfma_f32_16x16x32_bf16 a[64:67], v[48:51], v[72:75], a[64:67]
    ds_read_b64_tr_b16 v[82:83], v15 offset:1024
    s_xor_b32 m0, s44, 1024
    v_mfma_f32_16x16x32_bf16 a[96:99], v[52:55], v[72:75], a[96:99]
    buffer_load_dwordx4 v5, s[8:11], s20 offen lds
    v_mfma_f32_16x16x32_bf16 a[100:103], v[52:55], v[76:79], a[100:103]
    ds_read_b64_tr_b16 v[84:85], v14 offset:1536
    s_add_u32 s20, s20, 128
    v_mfma_f32_16x16x32_bf16 a[68:71], v[48:51], v[76:79], a[68:71]
    s_waitcnt lgkmcnt(5)
    v_mfma_f32_16x16x32_bf16 a[128:131], v[56:59], v[72:75], a[128:131]
    ds_read_b64_tr_b16 v[86:87], v15 offset:1536
    s_mov_b64 vcc, 0
    v_mfma_f32_16x16x32_bf16 a[160:163], v[60:63], v[72:75], a[160:163]
    s_xor_b32 m0, s44, 2048
    v_mfma_f32_16x16x32_bf16 a[164:167], v[60:63], v[76:79], a[164:167]
    buffer_load_dwordx4 v4, s[8:11], s21 offen lds
    v_mfma_f32_16x16x32_bf16 a[132:135], v[56:59], v[76:79], a[132:135]
    s_bitcmp1_b32 s43, 0
    s_waitcnt lgkmcnt(4)
    v_mfma_f32_16x16x32_bf16 a[192:195], v[64:67], v[72:75], a[192:195]
    s_cselect_b32 s61, s5, 0
    s_lshl1_add_u32 s53, s61, s50
    v_mfma_f32_16x16x32_bf16 a[224:227], v[68:71], v[72:75], a[224:227]
    s_bitcmp1_b32 s43, 1
    s_cselect_b32 s61, s51, 0
    v_mfma_f32_16x16x32_bf16 a[228:231], v[68:71], v[76:79], a[228:231]
    s_add_u32 s53, s53, s61
    s_bitcmp1_b32 s43, 2
    v_mfma_f32_16x16x32_bf16 a[196:199], v[64:67], v[76:79], a[196:199]
    s_cselect_b32 s61, s52, 0
    s_waitcnt lgkmcnt(2)
    v_mfma_f32_16x16x32_bf16 a[8:11], v[40:43], v[80:83], a[8:11]
    s_add_u32 s53, s53, s61
    s_lshl_b32 s29, s43, 4
    v_mfma_f32_16x16x32_bf16 a[40:43], v[44:47], v[80:83], a[40:43]
    s_mov_b64 vcc, -1
    s_waitcnt lgkmcnt(0)
    v_mfma_f32_16x16x32_bf16 a[44:47], v[44:47], v[84:87], a[44:47]
    ds_read_b64_tr_b16 v[72:73], v14 offset:2048
    s_xor_b32 m0, s44, 3072
    v_mfma_f32_16x16x32_bf16 a[12:15], v[40:43], v[84:87], a[12:15]
    buffer_load_dwordx4 v5, s[8:11], s21 offen lds
    v_mfma_f32_16x16x32_bf16 a[72:75], v[48:51], v[80:83], a[72:75]
    ds_read_b64_tr_b16 v[74:75], v15 offset:2048
    s_add_u32 s21, s21, 128
    v_mfma_f32_16x16x32_bf16 a[104:107], v[52:55], v[80:83], a[104:107]
    s_xor_b32 m0, s44, 16384
    v_mfma_f32_16x16x32_bf16 a[108:111], v[52:55], v[84:87], a[108:111]
    ds_read_b64_tr_b16 v[76:77], v14 offset:2560
    buffer_load_dwordx4 v4, s[8:11], s22 offen lds
    v_mfma_f32_16x16x32_bf16 a[76:79], v[48:51], v[84:87], a[76:79]
    s_xor_b32 m0, s44, 17408
    v_mfma_f32_16x16x32_bf16 a[136:139], v[56:59], v[80:83], a[136:139]
    ds_read_b64_tr_b16 v[78:79], v15 offset:2560
    buffer_load_dwordx4 v5, s[8:11], s22 offen lds
    v_mfma_f32_16x16x32_bf16 a[168:171], v[60:63], v[80:83], a[168:171]
    s_add_u32 s22, s22, 128
    s_xor_b32 m0, s44, 18432
    v_mfma_f32_16x16x32_bf16 a[172:175], v[60:63], v[84:87], a[172:175]
    buffer_load_dwordx4 v4, s[8:11], s23 offen lds
    v_mfma_f32_16x16x32_bf16 a[140:143], v[56:59], v[84:87], a[140:143]
    v_mfma_f32_16x16x32_bf16 a[200:203], v[64:67], v[80:83], a[200:203]
    s_xor_b32 m0, s44, 19456
    v_mfma_f32_16x16x32_bf16 a[232:235], v[68:71], v[80:83], a[232:235]
    buffer_load_dwordx4 v5, s[8:11], s23 offen lds
    v_mfma_f32_16x16x32_bf16 a[236:239], v[68:71], v[84:87], a[236:239]
    s_add_u32 s23, s23, 128
    s_cmp_ge_u32 s44, 98304
    v_mfma_f32_16x16x32_bf16 a[204:207], v[64:67], v[84:87], a[204:207]
    s_cselect_b32 s60, s6, s7
    s_waitcnt lgkmcnt(2)
    v_mfma_f32_16x16x32_bf16 a[16:19], v[40:43], v[72:75], a[16:19]
    s_add_u32 s44, s44, s60
    v_mfma_f32_16x16x32_bf16 a[48:51], v[44:47], v[72:75], a[48:51]
    s_waitcnt lgkmcnt(0)
    v_mfma_f32_16x16x32_bf16 a[52:55], v[44:47], v[76:79], a[52:55]
    ds_read_b64_tr_b16 v[80:81], v14 offset:3072
    v_mfma_f32_16x16x32_bf16 a[20:23], v[40:43], v[76:79], a[20:23]
    v_mfma_f32_16x16x32_bf16 a[80:83], v[48:51], v[72:75], a[80:83]
    ds_read_b64_tr_b16 v[82:83], v15 offset:3072
    s_set_gpr_idx_on s29, gpr_idx(SRC0)
    v_mov_b32 v24, v128
    v_mov_b32 v25, v129
    v_mov_b32 v26, v130
    v_mov_b32 v27, v131
    s_set_gpr_idx_off
    v_mfma_f32_16x16x32_bf16 a[112:115], v[52:55], v[72:75], a[112:115]
    v_mfma_f32_16x16x32_bf16 a[116:119], v[52:55], v[76:79], a[116:119]
    ds_read_b64_tr_b16 v[84:85], v14 offset:3584
    s_set_gpr_idx_on s29, gpr_idx(SRC0)
    v_mov_b32 v28, v132
    v_mov_b32 v29, v133
    v_mov_b32 v30, v134
    v_mov_b32 v31, v135
    s_set_gpr_idx_off
    v_mfma_f32_16x16x32_bf16 a[84:87], v[48:51], v[76:79], a[84:87]
    v_mfma_f32_16x16x32_bf16 a[144:147], v[56:59], v[72:75], a[144:147]
    ds_read_b64_tr_b16 v[86:87], v15 offset:3584
    s_set_gpr_idx_on s29, gpr_idx(SRC0)
    v_mov_b32 v32, v136
    v_mov_b32 v33, v137
    v_mov_b32 v34, v138
    v_mov_b32 v35, v139
    s_set_gpr_idx_off
    v_mfma_f32_16x16x32_bf16 a[176:179], v[60:63], v[72:75], a[176:179]
    v_mfma_f32_16x16x32_bf16 a[180:183], v[60:63], v[76:79], a[180:183]
    s_set_gpr_idx_on s29, gpr_idx(SRC0)
    v_mov_b32 v36, v140
    v_mov_b32 v37, v141
    v_mov_b32 v38, v142
    v_mov_b32 v39, v143
    s_set_gpr_idx_off
    v_mfma_f32_16x16x32_bf16 a[148:151], v[56:59], v[76:79], a[148:151]
    v_mfma_f32_16x16x32_bf16 a[208:211], v[64:67], v[72:75], a[208:211]
    buffer_store_dwordx4 v[24:27], v2, s[16:19], s53 offen sc1
    v_mfma_f32_16x16x32_bf16 a[240:243], v[68:71], v[72:75], a[240:243]
    v_mfma_f32_16x16x32_bf16 a[244:247], v[68:71], v[76:79], a[244:247]
    buffer_store_dwordx4 v[28:31], v3, s[16:19], s53 offen sc1
    v_mfma_f32_16x16x32_bf16 a[212:215], v[64:67], v[76:79], a[212:215]
    s_add_u32 s53, s53, s5
    s_waitcnt lgkmcnt(2)
    v_mfma_f32_16x16x32_bf16 a[24:27], v[40:43], v[80:83], a[24:27]
    ds_read_b64_tr_b16 v[72:73], v14 offset:16384
    buffer_store_dwordx4 v[32:35], v2, s[16:19], s53 offen sc1
    v_mfma_f32_16x16x32_bf16 a[56:59], v[44:47], v[80:83], a[56:59]
    ds_read_b64_tr_b16 v[74:75], v15 offset:16384
    s_waitcnt lgkmcnt(2)
    v_mfma_f32_16x16x32_bf16 a[60:63], v[44:47], v[84:87], a[60:63]
    ds_read_b128 v[44:47], v13 offset:2048
    buffer_store_dwordx4 v[36:39], v3, s[16:19], s53 offen sc1
    v_mfma_f32_16x16x32_bf16 a[28:31], v[40:43], v[84:87], a[28:31]
    ds_read_b128 v[40:43], v13 offset:0
    v_mfma_f32_16x16x32_bf16 a[88:91], v[48:51], v[80:83], a[88:91]
    ds_read_b64_tr_b16 v[76:77], v14 offset:16896
    v_mfma_f32_16x16x32_bf16 a[120:123], v[52:55], v[80:83], a[120:123]
    ds_read_b64_tr_b16 v[78:79], v15 offset:16896
    v_mfma_f32_16x16x32_bf16 a[124:127], v[52:55], v[84:87], a[124:127]
    ds_read_b128 v[52:55], v13 offset:6144
    v_mfma_f32_16x16x32_bf16 a[92:95], v[48:51], v[84:87], a[92:95]
    ds_read_b128 v[48:51], v13 offset:4096
    v_mfma_f32_16x16x32_bf16 a[152:155], v[56:59], v[80:83], a[152:155]
    v_mfma_f32_16x16x32_bf16 a[184:187], v[60:63], v[80:83], a[184:187]
    v_mfma_f32_16x16x32_bf16 a[188:191], v[60:63], v[84:87], a[188:191]
    ds_read_b128 v[60:63], v13 offset:10240
    v_mfma_f32_16x16x32_bf16 a[156:159], v[56:59], v[84:87], a[156:159]
    ds_read_b128 v[56:59], v13 offset:8192
    v_mfma_f32_16x16x32_bf16 a[216:219], v[64:67], v[80:83], a[216:219]
    v_mfma_f32_16x16x32_bf16 a[248:251], v[68:71], v[80:83], a[248:251]
    v_mfma_f32_16x16x32_bf16 a[252:255], v[68:71], v[84:87], a[252:255]
    ds_read_b128 v[68:71], v13 offset:14336
    v_mfma_f32_16x16x32_bf16 a[220:223], v[64:67], v[84:87], a[220:223]
    ds_read_b128 v[64:67], v13 offset:12288
t_g2_b:
    s_waitcnt lgkmcnt(8)
    v_mfma_f32_16x16x32_bf16 a[0:3], v[40:43], v[72:75], a[0:3]
    v_mfma_f32_16x16x32_bf16 a[32:35], v[44:47], v[72:75], a[32:35]
    s_waitcnt lgkmcnt(6)
    v_mfma_f32_16x16x32_bf16 a[36:39], v[44:47], v[76:79], a[36:39]
    ds_read_b64_tr_b16 v[80:81], v14 offset:17408
    v_mfma_f32_16x16x32_bf16 a[4:7], v[40:43], v[76:79], a[4:7]
    s_cmp_ge_u32 s48, 98304
    s_waitcnt lgkmcnt(5)
    v_mfma_f32_16x16x32_bf16 a[64:67], v[48:51], v[72:75], a[64:67]
    ds_read_b64_tr_b16 v[82:83], v15 offset:17408
    s_cselect_b32 s46, s6, s7
    v_mfma_f32_16x16x32_bf16 a[96:99], v[52:55], v[72:75], a[96:99]
    s_add_u32 s48, s48, s46
    v_mfma_f32_16x16x32_bf16 a[100:103], v[52:55], v[76:79], a[100:103]
    ds_read_b64_tr_b16 v[84:85], v14 offset:17920
    v_mfma_f32_16x16x32_bf16 a[68:71], v[48:51], v[76:79], a[68:71]
    s_cmp_ge_u32 s49, 98304
    s_waitcnt lgkmcnt(5)
    v_mfma_f32_16x16x32_bf16 a[128:131], v[56:59], v[72:75], a[128:131]
    ds_read_b64_tr_b16 v[86:87], v15 offset:17920
    s_cselect_b32 s47, s6, s7
    v_mfma_f32_16x16x32_bf16 a[160:163], v[60:63], v[72:75], a[160:163]
    s_add_u32 s49, s49, s47
    v_mfma_f32_16x16x32_bf16 a[164:167], v[60:63], v[76:79], a[164:167]
    v_mfma_f32_16x16x32_bf16 a[132:135], v[56:59], v[76:79], a[132:135]
    s_waitcnt lgkmcnt(4)
    v_mfma_f32_16x16x32_bf16 a[192:195], v[64:67], v[72:75], a[192:195]
    v_mfma_f32_16x16x32_bf16 a[224:227], v[68:71], v[72:75], a[224:227]
    v_mfma_f32_16x16x32_bf16 a[228:231], v[68:71], v[76:79], a[228:231]
    v_mfma_f32_16x16x32_bf16 a[196:199], v[64:67], v[76:79], a[196:199]
    s_waitcnt lgkmcnt(2)
    v_mfma_f32_16x16x32_bf16 a[8:11], v[40:43], v[80:83], a[8:11]
    s_xor_b32 m0, s45, 0
    v_mfma_f32_16x16x32_bf16 a[40:43], v[44:47], v[80:83], a[40:43]
    buffer_load_dwordx4 v6, s[12:15], s24 offen lds
    s_waitcnt lgkmcnt(0)
    v_mfma_f32_16x16x32_bf16 a[44:47], v[44:47], v[84:87], a[44:47]
    ds_read_b64_tr_b16 v[72:73], v14 offset:18432
    v_add_u32 v12, s46, v12
    v_mfma_f32_16x16x32_bf16 a[12:15], v[40:43], v[84:87], a[12:15]
    v_add_u32 v13, s46, v13
    v_mfma_f32_16x16x32_bf16 a[72:75], v[48:51], v[80:83], a[72:75]
    ds_read_b64_tr_b16 v[74:75], v15 offset:18432
    s_xor_b32 m0, s45, 1024
    v_mfma_f32_16x16x32_bf16 a[104:107], v[52:55], v[80:83], a[104:107]
    buffer_load_dwordx4 v7, s[12:15], s24 offen lds
    v_mfma_f32_16x16x32_bf16 a[108:111], v[52:55], v[84:87], a[108:111]
    ds_read_b64_tr_b16 v[76:77], v14 offset:18944
    s_add_u32 s24, s24, s28
    v_mfma_f32_16x16x32_bf16 a[76:79], v[48:51], v[84:87], a[76:79]
    v_mfma_f32_16x16x32_bf16 a[136:139], v[56:59], v[80:83], a[136:139]
    ds_read_b64_tr_b16 v[78:79], v15 offset:18944
    s_xor_b32 m0, s45, 2048
    v_mfma_f32_16x16x32_bf16 a[168:171], v[60:63], v[80:83], a[168:171]
    buffer_load_dwordx4 v6, s[12:15], s25 offen lds
    v_mfma_f32_16x16x32_bf16 a[172:175], v[60:63], v[84:87], a[172:175]
    v_mfma_f32_16x16x32_bf16 a[140:143], v[56:59], v[84:87], a[140:143]
    v_mfma_f32_16x16x32_bf16 a[200:203], v[64:67], v[80:83], a[200:203]
    s_xor_b32 m0, s45, 3072
    v_mfma_f32_16x16x32_bf16 a[232:235], v[68:71], v[80:83], a[232:235]
    buffer_load_dwordx4 v7, s[12:15], s25 offen lds
    v_mfma_f32_16x16x32_bf16 a[236:239], v[68:71], v[84:87], a[236:239]
    s_add_u32 s25, s25, s28
    v_mfma_f32_16x16x32_bf16 a[204:207], v[64:67], v[84:87], a[204:207]
    s_waitcnt lgkmcnt(2)
    v_mfma_f32_16x16x32_bf16 a[16:19], v[40:43], v[72:75], a[16:19]
    s_xor_b32 m0, s45, 16384
    v_mfma_f32_16x16x32_bf16 a[48:51], v[44:47], v[72:75], a[48:51]
    buffer_load_dwordx4 v6, s[12:15], s26 offen lds
    s_waitcnt lgkmcnt(0)
    v_mfma_f32_16x16x32_bf16 a[52:55], v[44:47], v[76:79], a[52:55]
    ds_read_b64_tr_b16 v[80:81], v14 offset:19456
    v_mfma_f32_16x16x32_bf16 a[20:23], v[40:43], v[76:79], a[20:23]
    s_xor_b32 m0, s45, 17408
    v_mfma_f32_16x16x32_bf16 a[80:83], v[48:51], v[72:75], a[80:83]
    ds_read_b64_tr_b16 v[82:83], v15 offset:19456
    buffer_load_dwordx4 v7, s[12:15], s26 offen lds
    v_mfma_f32_16x16x32_bf16 a[112:115], v[52:55], v[72:75], a[112:115]
    s_add_u32 s26, s26, s28
    s_xor_b32 m0, s45, 18432
    v_mfma_f32_16x16x32_bf16 a[116:119], v[52:55], v[76:79], a[116:119]
    ds_read_b64_tr_b16 v[84:85], v14 offset:19968
    buffer_load_dwordx4 v6, s[12:15], s27 offen lds
    v_mfma_f32_16x16x32_bf16 a[84:87], v[48:51], v[76:79], a[84:87]
    s_xor_b32 m0, s45, 19456
    v_mfma_f32_16x16x32_bf16 a[144:147], v[56:59], v[72:75], a[144:147]
    ds_read_b64_tr_b16 v[86:87], v15 offset:19968
    buffer_load_dwordx4 v7, s[12:15], s27 offen lds
    v_mfma_f32_16x16x32_bf16 a[176:179], v[60:63], v[72:75], a[176:179]
    s_add_u32 s27, s27, s28
    s_cmp_ge_u32 s45, 98304
    v_mfma_f32_16x16x32_bf16 a[180:183], v[60:63], v[76:79], a[180:183]
    s_cselect_b32 s60, s6, s7
    s_add_u32 s45, s45, s60
    v_mfma_f32_16x16x32_bf16 a[148:151], v[56:59], v[76:79], a[148:151]
    v_add_u32 v14, s47, v14
    v_add_u32 v15, s47, v15
    v_mfma_f32_16x16x32_bf16 a[208:211], v[64:67], v[72:75], a[208:211]
    s_add_u32 s43, s43, 1
    s_cmp_eq_u32 s43, 8
    v_mfma_f32_16x16x32_bf16 a[240:243], v[68:71], v[72:75], a[240:243]
    v_mfma_f32_16x16x32_bf16 a[244:247], v[68:71], v[76:79], a[244:247]
    v_mfma_f32_16x16x32_bf16 a[212:215], v[64:67], v[76:79], a[212:215]
    s_waitcnt vmcnt(12) lgkmcnt(0)
    s_cbranch_vccnz t_g2_bar
    s_waitcnt vmcnt(8)
t_g2_bar:
    s_barrier
    s_cbranch_scc1 t_g2_last
    v_mfma_f32_16x16x32_bf16 a[24:27], v[40:43], v[80:83], a[24:27]
    ds_read_b64_tr_b16 v[72:73], v14 offset:0
    v_mfma_f32_16x16x32_bf16 a[56:59], v[44:47], v[80:83], a[56:59]
    ds_read_b64_tr_b16 v[74:75], v15 offset:0
    v_mfma_f32_16x16x32_bf16 a[60:63], v[44:47], v[84:87], a[60:63]
    ds_read_b128 v[44:47], v12 offset:2048
    v_mfma_f32_16x16x32_bf16 a[28:31], v[40:43], v[84:87], a[28:31]
    ds_read_b128 v[40:43], v12 offset:0
    v_mfma_f32_16x16x32_bf16 a[88:91], v[48:51], v[80:83], a[88:91]
    ds_read_b64_tr_b16 v[76:77], v14 offset:512
    v_mfma_f32_16x16x32_bf16 a[120:123], v[52:55], v[80:83], a[120:123]
    ds_read_b64_tr_b16 v[78:79], v15 offset:512
    v_mfma_f32_16x16x32_bf16 a[124:127], v[52:55], v[84:87], a[124:127]
    ds_read_b128 v[52:55], v12 offset:6144
    v_mfma_f32_16x16x32_bf16 a[92:95], v[48:51], v[84:87], a[92:95]
    ds_read_b128 v[48:51], v12 offset:4096
    v_mfma_f32_16x16x32_bf16 a[152:155], v[56:59], v[80:83], a[152:155]
    v_mfma_f32_16x16x32_bf16 a[184:187], v[60:63], v[80:83], a[184:187]
    v_mfma_f32_16x16x32_bf16 a[188:191], v[60:63], v[84:87], a[188:191]
    ds_read_b128 v[60:63], v12 offset:10240
    v_mfma_f32_16x16x32_bf16 a[156:159], v[56:59], v[84:87], a[156:159]
    ds_read_b128 v[56:59], v12 offset:8192
    v_mfma_f32_16x16x32_bf16 a[216:219], v[64:67], v[80:83], a[216:219]
    s_sub_u32 s61, s43, 2
    s_cmp_lt_u32 s61, 3
    v_mfma_f32_16x16x32_bf16 a[248:251], v[68:71], v[80:83], a[248:251]
    v_mfma_f32_16x16x32_bf16 a[252:255], v[68:71], v[84:87], a[252:255]
    ds_read_b128 v[68:71], v12 offset:14336
    v_mfma_f32_16x16x32_bf16 a[220:223], v[64:67], v[84:87], a[220:223]
    ds_read_b128 v[64:67], v12 offset:12288
    s_cbranch_scc1 t_g2_a
    s_branch t_g2_hook
t_g2_last:
    v_mfma_f32_16x16x32_bf16 a[24:27], v[40:43], v[80:83], a[24:27]
    v_mfma_f32_16x16x32_bf16 a[56:59], v[44:47], v[80:83], a[56:59]
    v_mfma_f32_16x16x32_bf16 a[60:63], v[44:47], v[84:87], a[60:63]
    v_mfma_f32_16x16x32_bf16 a[28:31], v[40:43], v[84:87], a[28:31]
    v_mfma_f32_16x16x32_bf16 a[88:91], v[48:51], v[80:83], a[88:91]
    v_mfma_f32_16x16x32_bf16 a[120:123], v[52:55], v[80:83], a[120:123]
    v_mfma_f32_16x16x32_bf16 a[124:127], v[52:55], v[84:87], a[124:127]
    v_mfma_f32_16x16x32_bf16 a[92:95], v[48:51], v[84:87], a[92:95]
    v_mfma_f32_16x16x32_bf16 a[152:155], v[56:59], v[80:83], a[152:155]
    v_mfma_f32_16x16x32_bf16 a[184:187], v[60:63], v[80:83], a[184:187]
    v_mfma_f32_16x16x32_bf16 a[188:191], v[60:63], v[84:87], a[188:191]
    v_mfma_f32_16x16x32_bf16 a[156:159], v[56:59], v[84:87], a[156:159]
    v_mfma_f32_16x16x32_bf16 a[216:219], v[64:67], v[80:83], a[216:219]
    v_mfma_f32_16x16x32_bf16 a[248:251], v[68:71], v[80:83], a[248:251]
    v_mfma_f32_16x16x32_bf16 a[252:255], v[68:71], v[84:87], a[252:255]
    v_mfma_f32_16x16x32_bf16 a[220:223], v[64:67], v[84:87], a[220:223]
    s_setpc_b64 s[54:55]
t_g1:
    s_mov_b32 s43, 0
    v_add_u32 v14, s49, v23
    v_xor_b32 v15, 64, v14
    ds_read_b128 v[72:75], v14 offset:0
    ds_read_b128 v[76:79], v14 offset:2048
    ds_read_b128 v[44:47], v12 offset:2048
    ds_read_b128 v[40:43], v12 offset:0
    ds_read_b128 v[52:55], v12 offset:6144
    ds_read_b128 v[48:51], v12 offset:4096
    ds_read_b128 v[60:63], v12 offset:10240
    ds_read_b128 v[56:59], v12 offset:8192
    ds_read_b128 v[68:71], v12 offset:14336
    ds_read_b128 v[64:67], v12 offset:12288
    s_waitcnt lgkmcnt(6)
    v_mfma_f32_16x16x32_bf16 a[0:3], v[40:43], v[72:75], 0
    s_xor_b32 m0, s44, 0
    v_mfma_f32_16x16x32_bf16 a[32:35], v[44:47], v[72:75], 0
    buffer_load_dwordx4 v4, s[8:11], s20 offen lds
    v_mfma_f32_16x16x32_bf16 a[36:39], v[44:47], v[76:79], 0
    ds_read_b128 v[80:83], v14 offset:4096
    v_mfma_f32_16x16x32_bf16 a[4:7], v[40:43], v[76:79], 0
    s_waitcnt lgkmcnt(5)
    v_mfma_f32_16x16x32_bf16 a[64:67], v[48:51], v[72:75], 0
    ds_read_b128 v[84:87], v14 offset:6144
    s_xor_b32 m0, s44, 1024
    v_mfma_f32_16x16x32_bf16 a[96:99], v[52:55], v[72:75], 0
    buffer_load_dwordx4 v5, s[8:11], s20 offen lds
    v_mfma_f32_16x16x32_bf16 a[100:103], v[52:55], v[76:79], 0
    s_add_u32 s20, s20, 128
    v_mfma_f32_16x16x32_bf16 a[68:71], v[48:51], v[76:79], 0
    s_waitcnt lgkmcnt(4)
    v_mfma_f32_16x16x32_bf16 a[128:131], v[56:59], v[72:75], 0
    s_mov_b64 vcc, 0
    s_xor_b32 m0, s44, 2048
    v_mfma_f32_16x16x32_bf16 a[160:163], v[60:63], v[72:75], 0
    buffer_load_dwordx4 v4, s[8:11], s21 offen lds
    v_mfma_f32_16x16x32_bf16 a[164:167], v[60:63], v[76:79], 0
    s_bitcmp1_b32 s43, 0
    s_cselect_b32 s61, s5, 0
    v_mfma_f32_16x16x32_bf16 a[132:135], v[56:59], v[76:79], 0
    s_lshl1_add_u32 s53, s61, s50
    s_waitcnt lgkmcnt(2)
    v_mfma_f32_16x16x32_bf16 a[192:195], v[64:67], v[72:75], 0
    s_bitcmp1_b32 s43, 1
    s_cselect_b32 s61, s51, 0
    v_mfma_f32_16x16x32_bf16 a[224:227], v[68:71], v[72:75], 0
    s_add_u32 s53, s53, s61
    s_bitcmp1_b32 s43, 2
    v_mfma_f32_16x16x32_bf16 a[228:231], v[68:71], v[76:79], 0
    s_cselect_b32 s61, s52, 0
    s_add_u32 s53, s53, s61
    v_mfma_f32_16x16x32_bf16 a[196:199], v[64:67], v[76:79], 0
    s_lshl_b32 s29, s43, 4
    s_waitcnt lgkmcnt(1)
    v_mfma_f32_16x16x32_bf16 a[8:11], v[40:43], v[80:83], 0
    s_mov_b64 vcc, -1
    s_xor_b32 m0, s44, 3072
    v_mfma_f32_16x16x32_bf16 a[40:43], v[44:47], v[80:83], 0
    buffer_load_dwordx4 v5, s[8:11], s21 offen lds
    s_waitcnt lgkmcnt(0)
    v_mfma_f32_16x16x32_bf16 a[44:47], v[44:47], v[84:87], 0
    ds_read_b128 v[72:75], v14 offset:8192
    s_add_u32 s21, s21, 128
    v_mfma_f32_16x16x32_bf16 a[12:15], v[40:43], v[84:87], 0
    s_xor_b32 m0, s44, 16384
    v_mfma_f32_16x16x32_bf16 a[72:75], v[48:51], v[80:83], 0
    ds_read_b128 v[76:79], v14 offset:10240
    buffer_load_dwordx4 v4, s[8:11], s22 offen lds
    v_mfma_f32_16x16x32_bf16 a[104:107], v[52:55], v[80:83], 0
    s_xor_b32 m0, s44, 17408
    v_mfma_f32_16x16x32_bf16 a[108:111], v[52:55], v[84:87], 0
    buffer_load_dwordx4 v5, s[8:11], s22 offen lds
    v_mfma_f32_16x16x32_bf16 a[76:79], v[48:51], v[84:87], 0
    s_add_u32 s22, s22, 128
    v_mfma_f32_16x16x32_bf16 a[136:139], v[56:59], v[80:83], 0
    s_xor_b32 m0, s44, 18432
    v_mfma_f32_16x16x32_bf16 a[168:171], v[60:63], v[80:83], 0
    buffer_load_dwordx4 v4, s[8:11], s23 offen lds
    v_mfma_f32_16x16x32_bf16 a[172:175], v[60:63], v[84:87], 0
    v_mfma_f32_16x16x32_bf16 a[140:143], v[56:59], v[84:87], 0
    v_mfma_f32_16x16x32_bf16 a[200:203], v[64:67], v[80:83], 0
    s_xor_b32 m0, s44, 19456
    v_mfma_f32_16x16x32_bf16 a[232:235], v[68:71], v[80:83], 0
    buffer_load_dwordx4 v5, s[8:11], s23 offen lds
    v_mfma_f32_16x16x32_bf16 a[236:239], v[68:71], v[84:87], 0
    s_add_u32 s23, s23, 128
    s_cmp_ge_u32 s44, 98304
    v_mfma_f32_16x16x32_bf16 a[204:207], v[64:67], v[84:87], 0
    s_cselect_b32 s60, s6, s7
    s_waitcnt lgkmcnt(1)
    v_mfma_f32_16x16x32_bf16 a[16:19], v[40:43], v[72:75], 0
    s_add_u32 s44, s44, s60
    v_mfma_f32_16x16x32_bf16 a[48:51], v[44:47], v[72:75], 0
    s_waitcnt lgkmcnt(0)
    v_mfma_f32_16x16x32_bf16 a[52:55], v[44:47], v[76:79], 0
    ds_read_b128 v[80:83], v14 offset:12288
    v_mfma_f32_16x16x32_bf16 a[20:23], v[40:43], v[76:79], 0
    v_mfma_f32_16x16x32_bf16 a[80:83], v[48:51], v[72:75], 0
    ds_read_b128 v[84:87], v14 offset:14336
    s_set_gpr_idx_on s29, gpr_idx(SRC0)
    v_mov_b32 v24, v128
    v_mov_b32 v25, v129
    v_mov_b32 v26, v130
    v_mov_b32 v27, v131
    s_set_gpr_idx_off
    v_mfma_f32_16x16x32_bf16 a[112:115], v[52:55], v[72:75], 0
    v_mfma_f32_16x16x32_bf16 a[116:119], v[52:55], v[76:79], 0
    s_set_gpr_idx_on s29, gpr_idx(SRC0)
    v_mov_b32 v28, v132
    v_mov_b32 v29, v133
    v_mov_b32 v30, v134
    v_mov_b32 v31, v135
    s_set_gpr_idx_off
    v_mfma_f32_16x16x32_bf16 a[84:87], v[48:51], v[76:79], 0
    v_mfma_f32_16x16x32_bf16 a[144:147], v[56:59], v[72:75], 0
    s_set_gpr_idx_on s29, gpr_idx(SRC0)
    v_mov_b32 v32, v136
    v_mov_b32 v33, v137
    v_mov_b32 v34, v138
    v_mov_b32 v35, v139
    s_set_gpr_idx_off
    v_mfma_f32_16x16x32_bf16 a[176:179], v[60:63], v[72:75], 0
    v_mfma_f32_16x16x32_bf16 a[180:183], v[60:63], v[76:79], 0
    s_set_gpr_idx_on s29, gpr_idx(SRC0)
    v_mov_b32 v36, v140
    v_mov_b32 v37, v141
    v_mov_b32 v38, v142
    v_mov_b32 v39, v143
    s_set_gpr_idx_off
    v_mfma_f32_16x16x32_bf16 a[148:151], v[56:59], v[76:79], 0
    v_mfma_f32_16x16x32_bf16 a[208:211], v[64:67], v[72:75], 0
    buffer_store_dwordx4 v[24:27], v2, s[16:19], s53 offen sc1
    v_mfma_f32_16x16x32_bf16 a[240:243], v[68:71], v[72:75], 0
    v_mfma_f32_16x16x32_bf16 a[244:247], v[68:71], v[76:79], 0
    buffer_store_dwordx4 v[28:31], v3, s[16:19], s53 offen sc1
    v_mfma_f32_16x16x32_bf16 a[212:215], v[64:67], v[76:79], 0
    s_add_u32 s53, s53, s5
    s_waitcnt lgkmcnt(1)
    v_mfma_f32_16x16x32_bf16 a[24:27], v[40:43], v[80:83], 0
    ds_read_b128 v[72:75], v15 offset:0
    buffer_store_dwordx4 v[32:35], v2, s[16:19], s53 offen sc1
    v_mfma_f32_16x16x32_bf16 a[56:59], v[44:47], v[80:83], 0
    ds_read_b128 v[76:79], v15 offset:2048
    s_waitcnt lgkmcnt(2)
    v_mfma_f32_16x16x32_bf16 a[60:63], v[44:47], v[84:87], 0
    ds_read_b128 v[44:47], v13 offset:2048
    buffer_store_dwordx4 v[36:39], v3, s[16:19], s53 offen sc1
    v_mfma_f32_16x16x32_bf16 a[28:31], v[40:43], v[84:87], 0
    ds_read_b128 v[40:43], v13 offset:0
    v_mfma_f32_16x16x32_bf16 a[88:91], v[48:51], v[80:83], 0
    v_mfma_f32_16x16x32_bf16 a[120:123], v[52:55], v[80:83], 0
    v_mfma_f32_16x16x32_bf16 a[124:127], v[52:55], v[84:87], 0
    ds_read_b128 v[52:55], v13 offset:6144
    v_mfma_f32_16x16x32_bf16 a[92:95], v[48:51], v[84:87], 0
    ds_read_b128 v[48:51], v13 offset:4096
    v_mfma_f32_16x16x32_bf16 a[152:155], v[56:59], v[80:83], 0
    v_mfma_f32_16x16x32_bf16 a[184:187], v[60:63], v[80:83], 0
    v_mfma_f32_16x16x32_bf16 a[188:191], v[60:63], v[84:87], 0
    ds_read_b128 v[60:63], v13 offset:10240
    v_mfma_f32_16x16x32_bf16 a[156:159], v[56:59], v[84:87], 0
    ds_read_b128 v[56:59], v13 offset:8192
    v_mfma_f32_16x16x32_bf16 a[216:219], v[64:67], v[80:83], 0
    v_mfma_f32_16x16x32_bf16 a[248:251], v[68:71], v[80:83], 0
    v_mfma_f32_16x16x32_bf16 a[252:255], v[68:71], v[84:87], 0
    ds_read_b128 v[68:71], v13 offset:14336
    v_mfma_f32_16x16x32_bf16 a[220:223], v[64:67], v[84:87], 0
    ds_read_b128 v[64:67], v13 offset:12288
    s_branch t_g1_b
t_g1_as:
    s_waitcnt lgkmcnt(6)
    v_mfma_f32_16x16x32_bf16 a[0:3], v[40:43], v[72:75], a[0:3]
    s_xor_b32 m0, s44, 0
    v_mfma_f32_16x16x32_bf16 a[32:35], v[44:47], v[72:75], a[32:35]
    buffer_load_dwordx4 v4, s[8:11], s20 offen lds
    v_mfma_f32_16x16x32_bf16 a[36:39], v[44:47], v[76:79], a[36:39]
    ds_read_b128 v[80:83], v14 offset:4096
    v_mfma_f32_16x16x32_bf16 a[4:7], v[40:43], v[76:79], a[4:7]
    s_waitcnt lgkmcnt(5)
    v_mfma_f32_16x16x32_bf16 a[64:67], v[48:51], v[72:75], a[64:67]
    ds_read_b128 v[84:87], v14 offset:6144
    s_xor_b32 m0, s44, 1024
    v_mfma_f32_16x16x32_bf16 a[96:99], v[52:55], v[72:75], a[96:99]
    buffer_load_dwordx4 v5, s[8:11], s20 offen lds
    v_mfma_f32_16x16x32_bf16 a[100:103], v[52:55], v[76:79], a[100:103]
    s_add_u32 s20, s20, 128
    v_mfma_f32_16x16x32_bf16 a[68:71], v[48:51], v[76:79], a[68:71]
    s_waitcnt lgkmcnt(4)
    v_mfma_f32_16x16x32_bf16 a[128:131], v[56:59], v[72:75], a[128:131]
    s_mov_b64 vcc, 0
    s_xor_b32 m0, s44, 2048
    v_mfma_f32_16x16x32_bf16 a[160:163], v[60:63], v[72:75], a[160:163]
    buffer_load_dwordx4 v4, s[8:11], s21 offen lds
    v_mfma_f32_16x16x32_bf16 a[164:167], v[60:63], v[76:79], a[164:167]
    s_bitcmp1_b32 s43, 0
    s_cselect_b32 s61, s5, 0
    v_mfma_f32_16x16x32_bf16 a[132:135], v[56:59], v[76:79], a[132:135]
    s_lshl1_add_u32 s53, s61, s50
    s_waitcnt lgkmcnt(2)
    v_mfma_f32_16x16x32_bf16 a[192:195], v[64:67], v[72:75], a[192:195]
    s_bitcmp1_b32 s43, 1
    s_cselect_b32 s61, s51, 0
    v_mfma_f32_16x16x32_bf16 a[224:227], v[68:71], v[72:75], a[224:227]
    s_add_u32 s53, s53, s61
    s_bitcmp1_b32 s43, 2
    v_mfma_f32_16x16x32_bf16 a[228:231], v[68:71], v[76:79], a[228:231]
    s_cselect_b32 s61, s52, 0
    s_add_u32 s53, s53, s61
    v_mfma_f32_16x16x32_bf16 a[196:199], v[64:67], v[76:79], a[196:199]
    s_lshl_b32 s29, s43, 4
    s_waitcnt lgkmcnt(1)
    v_mfma_f32_16x16x32_bf16 a[8:11], v[40:43], v[80:83], a[8:11]
    s_mov_b64 vcc, -1
    s_xor_b32 m0, s44, 3072
    v_mfma_f32_16x16x32_bf16 a[40:43], v[44:47], v[80:83], a[40:43]
    buffer_load_dwordx4 v5, s[8:11], s21 offen lds
    s_waitcnt lgkmcnt(0)
    v_mfma_f32_16x16x32_bf16 a[44:47], v[44:47], v[84:87], a[44:47]
    ds_read_b128 v[72:75], v14 offset:8192
    s_add_u32 s21, s21, 128
    v_mfma_f32_16x16x32_bf16 a[12:15], v[40:43], v[84:87], a[12:15]
    s_xor_b32 m0, s44, 16384
    v_mfma_f32_16x16x32_bf16 a[72:75], v[48:51], v[80:83], a[72:75]
    ds_read_b128 v[76:79], v14 offset:10240
    buffer_load_dwordx4 v4, s[8:11], s22 offen lds
    v_mfma_f32_16x16x32_bf16 a[104:107], v[52:55], v[80:83], a[104:107]
    s_xor_b32 m0, s44, 17408
    v_mfma_f32_16x16x32_bf16 a[108:111], v[52:55], v[84:87], a[108:111]
    buffer_load_dwordx4 v5, s[8:11], s22 offen lds
    v_mfma_f32_16x16x32_bf16 a[76:79], v[48:51], v[84:87], a[76:79]
    s_add_u32 s22, s22, 128
    v_mfma_f32_16x16x32_bf16 a[136:139], v[56:59], v[80:83], a[136:139]
    s_xor_b32 m0, s44, 18432
    v_mfma_f32_16x16x32_bf16 a[168:171], v[60:63], v[80:83], a[168:171]
    buffer_load_dwordx4 v4, s[8:11], s23 offen lds
    v_mfma_f32_16x16x32_bf16 a[172:175], v[60:63], v[84:87], a[172:175]
    v_mfma_f32_16x16x32_bf16 a[140:143], v[56:59], v[84:87], a[140:143]
    v_mfma_f32_16x16x32_bf16 a[200:203], v[64:67], v[80:83], a[200:203]
    s_xor_b32 m0, s44, 19456
    v_mfma_f32_16x16x32_bf16 a[232:235], v[68:71], v[80:83], a[232:235]
    buffer_load_dwordx4 v5, s[8:11], s23 offen lds
    v_mfma_f32_16x16x32_bf16 a[236:239], v[68:71], v[84:87], a[236:239]
    s_add_u32 s23, s23, 128
    s_cmp_ge_u32 s44, 98304
    v_mfma_f32_16x16x32_bf16 a[204:207], v[64:67], v[84:87], a[204:207]
    s_cselect_b32 s60, s6, s7
    s_waitcnt lgkmcnt(1)
    v_mfma_f32_16x16x32_bf16 a[16:19], v[40:43], v[72:75], a[16:19]
    s_add_u32 s44, s44, s60
    v_mfma_f32_16x16x32_bf16 a[48:51], v[44:47], v[72:75], a[48:51]
    s_waitcnt lgkmcnt(0)
    v_mfma_f32_16x16x32_bf16 a[52:55], v[44:47], v[76:79], a[52:55]
    ds_read_b128 v[80:83], v14 offset:12288
    v_mfma_f32_16x16x32_bf16 a[20:23], v[40:43], v[76:79], a[20:23]
    v_mfma_f32_16x16x32_bf16 a[80:83], v[48:51], v[72:75], a[80:83]
    ds_read_b128 v[84:87], v14 offset:14336
    s_set_gpr_idx_on s29, gpr_idx(SRC0)
    v_mov_b32 v24, v128
    v_mov_b32 v25, v129
    v_mov_b32 v26, v130
    v_mov_b32 v27, v131
    s_set_gpr_idx_off
    v_mfma_f32_16x16x32_bf16 a[112:115], v[52:55], v[72:75], a[112:115]
    v_mfma_f32_16x16x32_bf16 a[116:119], v[52:55], v[76:79], a[116:119]
    s_set_gpr_idx_on s29, gpr_idx(SRC0)
    v_mov_b32 v28, v132
    v_mov_b32 v29, v133
    v_mov_b32 v30, v134
    v_mov_b32 v31, v135
    s_set_gpr_idx_off
    v_mfma_f32_16x16x32_bf16 a[84:87], v[48:51], v[76:79], a[84:87]
    v_mfma_f32_16x16x32_bf16 a[144:147], v[56:59], v[72:75], a[144:147]
    s_set_gpr_idx_on s29, gpr_idx(SRC0)
    v_mov_b32 v32, v136
    v_mov_b32 v33, v137
    v_mov_b32 v34, v138
    v_mov_b32 v35, v139
    s_set_gpr_idx_off
    v_mfma_f32_16x16x32_bf16 a[176:179], v[60:63], v[72:75], a[176:179]
    v_mfma_f32_16x16x32_bf16 a[180:183], v[60:63], v[76:79], a[180:183]
    s_set_gpr_idx_on s29, gpr_idx(SRC0)
    v_mov_b32 v36, v140
    v_mov_b32 v37, v141
    v_mov_b32 v38, v142
    v_mov_b32 v39, v143
    s_set_gpr_idx_off
    v_mfma_f32_16x16x32_bf16 a[148:151], v[56:59], v[76:79], a[148:151]
    v_mfma_f32_16x16x32_bf16 a[208:211], v[64:67], v[72:75], a[208:211]
    buffer_store_dwordx4 v[24:27], v2, s[16:19], s53 offen sc1
    v_mfma_f32_16x16x32_bf16 a[240:243], v[68:71], v[72:75], a[240:243]
    v_mfma_f32_16x16x32_bf16 a[244:247], v[68:71], v[76:79], a[244:247]
    buffer_store_dwordx4 v[28:31], v3, s[16:19], s53 offen sc1
    v_mfma_f32_16x16x32_bf16 a[212:215], v[64:67], v[76:79], a[212:215]
    s_add_u32 s53, s53, s5
    s_waitcnt lgkmcnt(1)
    v_mfma_f32_16x16x32_bf16 a[24:27], v[40:43], v[80:83], a[24:27]
    ds_read_b128 v[72:75], v15 offset:0
    buffer_store_dwordx4 v[32:35], v2, s[16:19], s53 offen sc1
    v_mfma_f32_16x16x32_bf16 a[56:59], v[44:47], v[80:83], a[56:59]
    ds_read_b128 v[76:79], v15 offset:2048
    s_waitcnt lgkmcnt(2)
    v_mfma_f32_16x16x32_bf16 a[60:63], v[44:47], v[84:87], a[60:63]
    ds_read_b128 v[44:47], v13 offset:2048
    buffer_store_dwordx4 v[36:39], v3, s[16:19], s53 offen sc1
    v_mfma_f32_16x16x32_bf16 a[28:31], v[40:43], v[84:87], a[28:31]
    ds_read_b128 v[40:43], v13 offset:0
    v_mfma_f32_16x16x32_bf16 a[88:91], v[48:51], v[80:83], a[88:91]
    v_mfma_f32_16x16x32_bf16 a[120:123], v[52:55], v[80:83], a[120:123]
    v_mfma_f32_16x16x32_bf16 a[124:127], v[52:55], v[84:87], a[124:127]
    ds_read_b128 v[52:55], v13 offset:6144
    v_mfma_f32_16x16x32_bf16 a[92:95], v[48:51], v[84:87], a[92:95]
    ds_read_b128 v[48:51], v13 offset:4096
    v_mfma_f32_16x16x32_bf16 a[152:155], v[56:59], v[80:83], a[152:155]
    v_mfma_f32_16x16x32_bf16 a[184:187], v[60:63], v[80:83], a[184:187]
    v_mfma_f32_16x16x32_bf16 a[188:191], v[60:63], v[84:87], a[188:191]
    ds_read_b128 v[60:63], v13 offset:10240
    v_mfma_f32_16x16x32_bf16 a[156:159], v[56:59], v[84:87], a[156:159]
    ds_read_b128 v[56:59], v13 offset:8192
    v_mfma_f32_16x16x32_bf16 a[216:219], v[64:67], v[80:83], a[216:219]
    v_mfma_f32_16x16x32_bf16 a[248:251], v[68:71], v[80:83], a[248:251]
    v_mfma_f32_16x16x32_bf16 a[252:255], v[68:71], v[84:87], a[252:255]
    ds_read_b128 v[68:71], v13 offset:14336
    v_mfma_f32_16x16x32_bf16 a[220:223], v[64:67], v[84:87], a[220:223]
    ds_read_b128 v[64:67], v13 offset:12288
    s_branch t_g1_b
t_g1_hook:
    s_cmp_eq_u32 s43, 1
    s_cbranch_scc1 t_g1_sig0
    s_cmp_lt_u32 s43, 8
    s_cbranch_scc1 t_g1_as
    s_cmp_eq_u32 s43, 14
    s_cbranch_scc1 t_g1_sws
    s_cmp_eq_u32 s43, 15
    s_cbranch_scc1 t_g1_swp
    s_cmp_lg_u32 s58, 0
    s_cbranch_scc1 t_g1_a
    s_cmp_eq_u32 s43, 13
    s_cbranch_scc1 t_g1_wait
    s_cmp_lg_u32 s43, 9
    s_cbranch_scc1 t_g1_a
    s_cmp_eq_u32 s4, 0
    s_cbranch_scc1 t_g1_a
    v_mov_b32 v24, s4
    v_mov_b32 v25, 1
    s_mov_b64 exec, 1
    global_atomic_add v24, v25, s[98:99] sc1
    s_mov_b64 exec, -1
    s_branch t_g1_a
t_g1_wait:
    s_cmp_eq_u32 s3, 0
    s_cbranch_scc1 t_g1_a
    s_mov_b32 s62, 0
L_sw_97:
    s_load_dword s63, s[98:99], s3 glc
    s_add_u32 s62, s62, 1
    s_cmp_gt_u32 s62, 0x200000
    s_cbranch_scc1 chain_kernel_wabort
    s_waitcnt lgkmcnt(0)
    s_cmp_ge_u32 s63, 32
    s_cbranch_scc1 L_swok_98
    s_sleep 16
    s_branch L_sw_97
L_swok_98:
    s_branch t_g1_a
t_g1_sig0:
    s_cmp_eq_u32 s1, 0
    s_cbranch_scc1 t_g1_as
    v_mov_b32 v24, s1
    v_mov_b32 v25, 1
    s_mov_b64 exec, 1
    global_atomic_add v24, v25, s[98:99] sc1
    s_mov_b64 exec, -1
    s_mov_b32 s1, 0
    s_branch t_g1_as
t_g1_sws:
    s_mov_b32 s12, s36
    s_mov_b32 s13, s37
    s_mov_b32 s14, s38
    s_and_b32 s45, s45, 0xffffb7ff
    s_bitcmp1_b32 s0, 3
    s_cselect_b32 s24, s41, 0
    s_cselect_b32 s26, 0, s41
    s_cselect_b32 s60, 0x4000, 0
    s_or_b32 s45, s45, s60
    s_add_u32 s24, s24, s39
    s_add_u32 s26, s26, s39
    s_bitcmp1_b32 s0, 2
    s_cselect_b32 s61, s40, 0
    s_cselect_b32 s62, 0, s40
    s_cselect_b32 s60, 0x800, 0
    s_or_b32 s45, s45, s60
    s_add_u32 s25, s24, s62
    s_add_u32 s24, s24, s61
    s_add_u32 s27, s26, s62
    s_add_u32 s26, s26, s61
    s_mov_b32 s28, s42
    v_mov_b32 v6, v10
    v_mov_b32 v7, v11
    s_branch t_g1_a
t_g1_swp:
    s_mov_b32 s8, s30
    s_mov_b32 s9, s31
    s_mov_b32 s10, s32
    s_and_b32 s44, s44, 0xffffb7ff
    s_bitcmp1_b32 s0, 1
    s_cselect_b32 s20, s35, 0
    s_cselect_b32 s22, 0, s35
    s_cselect_b32 s60, 0x4000, 0
    s_or_b32 s44, s44, s60
    s_add_u32 s20, s20, s33
    s_add_u32 s22, s22, s33
    s_bitcmp1_b32 s0, 0
    s_cselect_b32 s61, s34, 0
    s_cselect_b32 s62, 0, s34
    s_cselect_b32 s60, 0x800, 0
    s_or_b32 s44, s44, s60
    s_add_u32 s21, s20, s62
    s_add_u32 s20, s20, s61
    s_add_u32 s23, s22, s62
    s_add_u32 s22, s22, s61
    v_mov_b32 v4, v8
    v_mov_b32 v5, v9
t_g1_a:
    s_waitcnt lgkmcnt(6)
    v_mfma_f32_16x16x32_bf16 a[0:3], v[40:43], v[72:75], a[0:3]
    s_xor_b32 m0, s44, 0
    v_mfma_f32_16x16x32_bf16 a[32:35], v[44:47], v[72:75], a[32:35]
    buffer_load_dwordx4 v4, s[8:11], s20 offen lds
    v_mfma_f32_16x16x32_bf16 a[36:39], v[44:47], v[76:79], a[36:39]
    ds_read_b128 v[80:83], v14 offset:4096
    v_mfma_f32_16x16x32_bf16 a[4:7], v[40:43], v[76:79], a[4:7]
    s_waitcnt lgkmcnt(5)
    v_mfma_f32_16x16x32_bf16 a[64:67], v[48:51], v[72:75], a[64:67]
    ds_read_b128 v[84:87], v14 offset:6144
    s_xor_b32 m0, s44, 1024
    v_mfma_f32_16x16x32_bf16 a[96:99], v[52:55], v[72:75], a[96:99]
    buffer_load_dwordx4 v5, s[8:11], s20 offen lds
    v_mfma_f32_16x16x32_bf16 a[100:103], v[52:55], v[76:79], a[100:103]
    s_add_u32 s20, s20, 128
    v_mfma_f32_16x16x32_bf16 a[68:71], v[48:51], v[76:79], a[68:71]
    s_waitcnt lgkmcnt(4)
    v_mfma_f32_16x16x32_bf16 a[128:131], v[56:59], v[72:75], a[128:131]
    s_mov_b64 vcc, 0
    s_xor_b32 m0, s44, 2048
    v_mfma_f32_16x16x32_bf16 a[160:163], v[60:63], v[72:75], a[160:163]
    buffer_load_dwordx4 v4, s[8:11], s21 offen lds
    v_mfma_f32_16x16x32_bf16 a[164:167], v[60:63], v[76:79], a[164:167]
    v_mfma_f32_16x16x32_bf16 a[132:135], v[56:59], v[76:79], a[132:135]
    s_waitcnt lgkmcnt(2)
    v_mfma_f32_16x16x32_bf16 a[192:195], v[64:67], v[72:75], a[192:195]
    s_xor_b32 m0, s44, 3072
    v_mfma_f32_16x16x32_bf16 a[224:227], v[68:71], v[72:75], a[224:227]
    buffer_load_dwordx4 v5, s[8:11], s21 offen lds
    v_mfma_f32_16x16x32_bf16 a[228:231], v[68:71], v[76:79], a[228:231]
    s_add_u32 s21, s21, 128
    v_mfma_f32_16x16x32_bf16 a[196:199], v[64:67], v[76:79], a[196:199]
    s_waitcnt lgkmcnt(1)
    v_mfma_f32_16x16x32_bf16 a[8:11], v[40:43], v[80:83], a[8:11]
    s_xor_b32 m0, s44, 16384
    v_mfma_f32_16x16x32_bf16 a[40:43], v[44:47], v[80:83], a[40:43]
    buffer_load_dwordx4 v4, s[8:11], s22 offen lds
    s_waitcnt lgkmcnt(0)
    v_mfma_f32_16x16x32_bf16 a[44:47], v[44:47], v[84:87], a[44:47]
    ds_read_b128 v[72:75], v14 offset:8192
    v_mfma_f32_16x16x32_bf16 a[12:15], v[40:43], v[84:87], a[12:15]
    v_mfma_f32_16x16x32_bf16 a[72:75], v[48:51], v[80:83], a[72:75]
    ds_read_b128 v[76:79], v14 offset:10240
    s_xor_b32 m0, s44, 17408
    v_mfma_f32_16x16x32_bf16 a[104:107], v[52:55], v[80:83], a[104:107]
    buffer_load_dwordx4 v5, s[8:11], s22 offen lds
    v_mfma_f32_16x16x32_bf16 a[108:111], v[52:55], v[84:87], a[108:111]
    s_add_u32 s22, s22, 128
    v_mfma_f32_16x16x32_bf16 a[76:79], v[48:51], v[84:87], a[76:79]
    v_mfma_f32_16x16x32_bf16 a[136:139], v[56:59], v[80:83], a[136:139]
    s_xor_b32 m0, s44, 18432
    v_mfma_f32_16x16x32_bf16 a[168:171], v[60:63], v[80:83], a[168:171]
    buffer_load_dwordx4 v4, s[8:11], s23 offen lds
    v_mfma_f32_16x16x32_bf16 a[172:175], v[60:63], v[84:87], a[172:175]
    v_mfma_f32_16x16x32_bf16 a[140:143], v[56:59], v[84:87], a[140:143]
    v_mfma_f32_16x16x32_bf16 a[200:203], v[64:67], v[80:83], a[200:203]
    s_xor_b32 m0, s44, 19456
    v_mfma_f32_16x16x32_bf16 a[232:235], v[68:71], v[80:83], a[232:235]
    buffer_load_dwordx4 v5, s[8:11], s23 offen lds
    v_mfma_f32_16x16x32_bf16 a[236:239], v[68:71], v[84:87], a[236:239]
    s_add_u32 s23, s23, 128
    s_cmp_ge_u32 s44, 98304
    v_mfma_f32_16x16x32_bf16 a[204:207], v[64:67], v[84:87], a[204:207]
    s_cselect_b32 s60, s6, s7
    s_waitcnt lgkmcnt(1)
    v_mfma_f32_16x16x32_bf16 a[16:19], v[40:43], v[72:75], a[16:19]
    s_add_u32 s44, s44, s60
    v_mfma_f32_16x16x32_bf16 a[48:51], v[44:47], v[72:75], a[48:51]
    s_waitcnt lgkmcnt(0)
    v_mfma_f32_16x16x32_bf16 a[52:55], v[44:47], v[76:79], a[52:55]
    ds_read_b128 v[80:83], v14 offset:12288
    v_mfma_f32_16x16x32_bf16 a[20:23], v[40:43], v[76:79], a[20:23]
    v_mfma_f32_16x16x32_bf16 a[80:83], v[48:51], v[72:75], a[80:83]
    ds_read_b128 v[84:87], v14 offset:14336
    v_mfma_f32_16x16x32_bf16 a[112:115], v[52:55], v[72:75], a[112:115]
    v_mfma_f32_16x16x32_bf16 a[116:119], v[52:55], v[76:79], a[116:119]
    v_mfma_f32_16x16x32_bf16 a[84:87], v[48:51], v[76:79], a[84:87]
    v_mfma_f32_16x16x32_bf16 a[144:147], v[56:59], v[72:75], a[144:147]
    v_mfma_f32_16x16x32_bf16 a[176:179], v[60:63], v[72:75], a[176:179]
    v_mfma_f32_16x16x32_bf16 a[180:183], v[60:63], v[76:79], a[180:183]
    v_mfma_f32_16x16x32_bf16 a[148:151], v[56:59], v[76:79], a[148:151]
    v_mfma_f32_16x16x32_bf16 a[208:211], v[64:67], v[72:75], a[208:211]
    v_mfma_f32_16x16x32_bf16 a[240:243], v[68:71], v[72:75], a[240:243]
    v_mfma_f32_16x16x32_bf16 a[244:247], v[68:71], v[76:79], a[244:247]
    v_mfma_f32_16x16x32_bf16 a[212:215], v[64:67], v[76:79], a[212:215]
    s_waitcnt lgkmcnt(1)
    v_mfma_f32_16x16x32_bf16 a[24:27], v[40:43], v[80:83], a[24:27]
    ds_read_b128 v[72:75], v15 offset:0
    v_mfma_f32_16x16x32_bf16 a[56:59], v[44:47], v[80:83], a[56:59]
    ds_read_b128 v[76:79], v15 offset:2048
    s_waitcnt lgkmcnt(2)
    v_mfma_f32_16x16x32_bf16 a[60:63], v[44:47], v[84:87], a[60:63]
    ds_read_b128 v[44:47], v13 offset:2048
    v_mfma_f32_16x16x32_bf16 a[28:31], v[40:43], v[84:87], a[28:31]
    ds_read_b128 v[40:43], v13 offset:0
    v_mfma_f32_16x16x32_bf16 a[88:91], v[48:51], v[80:83], a[88:91]
    v_mfma_f32_16x16x32_bf16 a[120:123], v[52:55], v[80:83], a[120:123]
    v_mfma_f32_16x16x32_bf16 a[124:127], v[52:55], v[84:87], a[124:127]
    ds_read_b128 v[52:55], v13 offset:6144
    v_mfma_f32_16x16x32_bf16 a[92:95], v[48:51], v[84:87], a[92:95]
    ds_read_b128 v[48:51], v13 offset:4096
    v_mfma_f32_16x16x32_bf16 a[152:155], v[56:59], v[80:83], a[152:155]
    v_mfma_f32_16x16x32_bf16 a[184:187], v[60:63], v[80:83], a[184:187]
    v_mfma_f32_16x16x32_bf16 a[188:191], v[60:63], v[84:87], a[188:191]
    ds_read_b128 v[60:63], v13 offset:10240
    v_mfma_f32_16x16x32_bf16 a[156:159], v[56:59], v[84:87], a[156:159]
    ds_read_b128 v[56:59], v13 offset:8192
    v_mfma_f32_16x16x32_bf16 a[216:219], v[64:67], v[80:83], a[216:219]
    v_mfma_f32_16x16x32_bf16 a[248:251], v[68:71], v[80:83], a[248:251]
    v_mfma_f32_16x16x32_bf16 a[252:255], v[68:71], v[84:87], a[252:255]
    ds_read_b128 v[68:71], v13 offset:14336
    v_mfma_f32_16x16x32_bf16 a[220:223], v[64:67], v[84:87], a[220:223]
    ds_read_b128 v[64:67], v13 offset:12288
t_g1_b:
    s_waitcnt lgkmcnt(6)
    v_mfma_f32_16x16x32_bf16 a[0:3], v[40:43], v[72:75], a[0:3]
    v_mfma_f32_16x16x32_bf16 a[32:35], v[44:47], v[72:75], a[32:35]
    v_mfma_f32_16x16x32_bf16 a[36:39], v[44:47], v[76:79], a[36:39]
    ds_read_b128 v[80:83], v15 offset:4096
    v_mfma_f32_16x16x32_bf16 a[4:7], v[40:43], v[76:79], a[4:7]
    s_cmp_ge_u32 s48, 98304
    s_waitcnt lgkmcnt(5)
    v_mfma_f32_16x16x32_bf16 a[64:67], v[48:51], v[72:75], a[64:67]
    ds_read_b128 v[84:87], v15 offset:6144
    s_cselect_b32 s46, s6, s7
    v_mfma_f32_16x16x32_bf16 a[96:99], v[52:55], v[72:75], a[96:99]
    s_add_u32 s48, s48, s46
    v_mfma_f32_16x16x32_bf16 a[100:103], v[52:55], v[76:79], a[100:103]
    v_mfma_f32_16x16x32_bf16 a[68:71], v[48:51], v[76:79], a[68:71]
    s_cmp_ge_u32 s49, 98304
    s_waitcnt lgkmcnt(4)
    v_mfma_f32_16x16x32_bf16 a[128:131], v[56:59], v[72:75], a[128:131]
    s_cselect_b32 s47, s6, s7
    s_add_u32 s49, s49, s47
    v_mfma_f32_16x16x32_bf16 a[160:163], v[60:63], v[72:75], a[160:163]
    v_mfma_f32_16x16x32_bf16 a[164:167], v[60:63], v[76:79], a[164:167]
    v_mfma_f32_16x16x32_bf16 a[132:135], v[56:59], v[76:79], a[132:135]
    s_waitcnt lgkmcnt(2)
    v_mfma_f32_16x16x32_bf16 a[192:195], v[64:67], v[72:75], a[192:195]
    v_mfma_f32_16x16x32_bf16 a[224:227], v[68:71], v[72:75], a[224:227]
    v_mfma_f32_16x16x32_bf16 a[228:231], v[68:71], v[76:79], a[228:231]
    v_mfma_f32_16x16x32_bf16 a[196:199], v[64:67], v[76:79], a[196:199]
    s_waitcnt lgkmcnt(1)
    v_mfma_f32_16x16x32_bf16 a[8:11], v[40:43], v[80:83], a[8:11]
    s_xor_b32 m0, s45, 0
    v_mfma_f32_16x16x32_bf16 a[40:43], v[44:47], v[80:83], a[40:43]
    buffer_load_dwordx4 v6, s[12:15], s24 offen lds
    s_waitcnt lgkmcnt(0)
    v_mfma_f32_16x16x32_bf16 a[44:47], v[44:47], v[84:87], a[44:47]
    ds_read_b128 v[72:75], v15 offset:8192
    v_add_u32 v12, s46, v12
    v_mfma_f32_16x16x32_bf16 a[12:15], v[40:43], v[84:87], a[12:15]
    v_add_u32 v13, s46, v13
    v_add_u32 v14, s47, v14
    v_mfma_f32_16x16x32_bf16 a[72:75], v[48:51], v[80:83], a[72:75]
    ds_read_b128 v[76:79], v15 offset:10240
    s_xor_b32 m0, s45, 1024
    v_mfma_f32_16x16x32_bf16 a[104:107], v[52:55], v[80:83], a[104:107]
    buffer_load_dwordx4 v7, s[12:15], s24 offen lds
    v_mfma_f32_16x16x32_bf16 a[108:111], v[52:55], v[84:87], a[108:111]
    s_add_u32 s24, s24, s28
    v_mfma_f32_16x16x32_bf16 a[76:79], v[48:51], v[84:87], a[76:79]
    v_mfma_f32_16x16x32_bf16 a[136:139], v[56:59], v[80:83], a[136:139]
    s_xor_b32 m0, s45, 2048
    v_mfma_f32_16x16x32_bf16 a[168:171], v[60:63], v[80:83], a[168:171]
    buffer_load_dwordx4 v6, s[12:15], s25 offen lds
    v_mfma_f32_16x16x32_bf16 a[172:175], v[60:63], v[84:87], a[172:175]
    v_mfma_f32_16x16x32_bf16 a[140:143], v[56:59], v[84:87], a[140:143]
    v_mfma_f32_16x16x32_bf16 a[200:203], v[64:67], v[80:83], a[200:203]
    s_xor_b32 m0, s45, 3072
    v_mfma_f32_16x16x32_bf16 a[232:235], v[68:71], v[80:83], a[232:235]
    buffer_load_dwordx4 v7, s[12:15], s25 offen lds
    v_mfma_f32_16x16x32_bf16 a[236:239], v[68:71], v[84:87], a[236:239]
    s_add_u32 s25, s25, s28
    v_mfma_f32_16x16x32_bf16 a[204:207], v[64:67], v[84:87], a[204:207]
    s_waitcnt lgkmcnt(1)
    v_mfma_f32_16x16x32_bf16 a[16:19], v[40:43], v[72:75], a[16:19]
    s_xor_b32 m0, s45, 16384
    v_mfma_f32_16x16x32_bf16 a[48:51], v[44:47], v[72:75], a[48:51]
    buffer_load_dwordx4 v6, s[12:15], s26 offen lds
    s_waitcnt lgkmcnt(0)
    v_mfma_f32_16x16x32_bf16 a[52:55], v[44:47], v[76:79], a[52:55]
    ds_read_b128 v[80:83], v15 offset:12288
    v_mfma_f32_16x16x32_bf16 a[20:23], v[40:43], v[76:79], a[20:23]
    s_xor_b32 m0, s45, 17408
    v_mfma_f32_16x16x32_bf16 a[80:83], v[48:51], v[72:75], a[80:83]
    ds_read_b128 v[84:87], v15 offset:14336
    buffer_load_dwordx4 v7, s[12:15], s26 offen lds
    v_mfma_f32_16x16x32_bf16 a[112:115], v[52:55], v[72:75], a[112:115]
    s_add_u32 s26, s26, s28
    s_xor_b32 m0, s45, 18432
    v_mfma_f32_16x16x32_bf16 a[116:119], v[52:55], v[76:79], a[116:119]
    buffer_load_dwordx4 v6, s[12:15], s27 offen lds
    v_mfma_f32_16x16x32_bf16 a[84:87], v[48:51], v[76:79], a[84:87]
    s_xor_b32 m0, s45, 19456
    v_mfma_f32_16x16x32_bf16 a[144:147], v[56:59], v[72:75], a[144:147]
    buffer_load_dwordx4 v7, s[12:15], s27 offen lds
    v_mfma_f32_16x16x32_bf16 a[176:179], v[60:63], v[72:75], a[176:179]
    s_add_u32 s27, s27, s28
    s_cmp_ge_u32 s45, 98304
    v_mfma_f32_16x16x32_bf16 a[180:183], v[60:63], v[76:79], a[180:183]
    s_cselect_b32 s60, s6, s7
    s_add_u32 s45, s45, s60
    v_mfma_f32_16x16x32_bf16 a[148:151], v[56:59], v[76:79], a[148:151]
    v_add_u32 v15, s47, v15
    v_mfma_f32_16x16x32_bf16 a[208:211], v[64:67], v[72:75], a[208:211]
    s_add_u32 s43, s43, 1
    s_cmp_eq_u32 s43, 16
    v_mfma_f32_16x16x32_bf16 a[240:243], v[68:71], v[72:75], a[240:243]
    v_mfma_f32_16x16x32_bf16 a[244:247], v[68:71], v[76:79], a[244:247]
    v_mfma_f32_16x16x32_bf16 a[212:215], v[64:67], v[76:79], a[212:215]
    s_waitcnt vmcnt(12) lgkmcnt(0)
    s_cbranch_vccnz t_g1_bar
    s_waitcnt vmcnt(8)
t_g1_bar:
    s_barrier
    s_cbranch_scc1 t_g1_last
    v_mfma_f32_16x16x32_bf16 a[24:27], v[40:43], v[80:83], a[24:27]
    ds_read_b128 v[72:75], v14 offset:0
    v_mfma_f32_16x16x32_bf16 a[56:59], v[44:47], v[80:83], a[56:59]
    ds_read_b128 v[76:79], v14 offset:2048
    v_mfma_f32_16x16x32_bf16 a[60:63], v[44:47], v[84:87], a[60:63]
    ds_read_b128 v[44:47], v12 offset:2048
    v_mfma_f32_16x16x32_bf16 a[28:31], v[40:43], v[84:87], a[28:31]
    ds_read_b128 v[40:43], v12 offset:0
    v_mfma_f32_16x16x32_bf16 a[88:91], v[48:51], v[80:83], a[88:91]
    v_mfma_f32_16x16x32_bf16 a[120:123], v[52:55], v[80:83], a[120:123]
    v_mfma_f32_16x16x32_bf16 a[124:127], v[52:55], v[84:87], a[124:127]
    ds_read_b128 v[52:55], v12 offset:6144
    v_mfma_f32_16x16x32_bf16 a[92:95], v[48:51], v[84:87], a[92:95]
    ds_read_b128 v[48:51], v12 offset:4096
    v_mfma_f32_16x16x32_bf16 a[152:155], v[56:59], v[80:83], a[152:155]
    v_mfma_f32_16x16x32_bf16 a[184:187], v[60:63], v[80:83], a[184:187]
    v_mfma_f32_16x16x32_bf16 a[188:191], v[60:63], v[84:87], a[188:191]
    ds_read_b128 v[60:63], v12 offset:10240
    v_mfma_f32_16x16x32_bf16 a[156:159], v[56:59], v[84:87], a[156:159]
    ds_read_b128 v[56:59], v12 offset:8192
    v_mfma_f32_16x16x32_bf16 a[216:219], v[64:67], v[80:83], a[216:219]
    s_sub_u32 s61, s43, 10
    s_cmp_lt_u32 s61, 3
    v_mfma_f32_16x16x32_bf16 a[248:251], v[68:71], v[80:83], a[248:251]
    v_mfma_f32_16x16x32_bf16 a[252:255], v[68:71], v[84:87], a[252:255]
    ds_read_b128 v[68:71], v12 offset:14336
    v_mfma_f32_16x16x32_bf16 a[220:223], v[64:67], v[84:87], a[220:223]
    ds_read_b128 v[64:67], v12 offset:12288
    s_cbranch_scc1 t_g1_a
    s_branch t_g1_hook
t_g1_last:
    v_mfma_f32_16x16x32_bf16 a[24:27], v[40:43], v[80:83], a[24:27]
    v_mfma_f32_16x16x32_bf16 a[56:59], v[44:47], v[80:83], a[56:59]
    v_mfma_f32_16x16x32_bf16 a[60:63], v[44:47], v[84:87], a[60:63]
    v_mfma_f32_16x16x32_bf16 a[28:31], v[40:43], v[84:87], a[28:31]
    v_mfma_f32_16x16x32_bf16 a[88:91], v[48:51], v[80:83], a[88:91]
    v_mfma_f32_16x16x32_bf16 a[120:123], v[52:55], v[80:83], a[120:123]
    v_mfma_f32_16x16x32_bf16 a[124:127], v[52:55], v[84:87], a[124:127]
    v_mfma_f32_16x16x32_bf16 a[92:95], v[48:51], v[84:87], a[92:95]
    v_mfma_f32_16x16x32_bf16 a[152:155], v[56:59], v[80:83], a[152:155]
    v_mfma_f32_16x16x32_bf16 a[184:187], v[60:63], v[80:83], a[184:187]
    v_mfma_f32_16x16x32_bf16 a[188:191], v[60:63], v[84:87], a[188:191]
    v_mfma_f32_16x16x32_bf16 a[156:159], v[56:59], v[84:87], a[156:159]
    v_mfma_f32_16x16x32_bf16 a[216:219], v[64:67], v[80:83], a[216:219]
    v_mfma_f32_16x16x32_bf16 a[248:251], v[68:71], v[80:83], a[248:251]
    v_mfma_f32_16x16x32_bf16 a[252:255], v[68:71], v[84:87], a[252:255]
    v_mfma_f32_16x16x32_bf16 a[220:223], v[64:67], v[84:87], a[220:223]
    s_setpc_b64 s[54:55]
t_scan:
    s_nop 7
    v_accvgpr_read_b32 v40, a0
    v_accvgpr_read_b32 v42, a4
    v_accvgpr_read_b32 v44, a8
    v_accvgpr_read_b32 v46, a12
    v_accvgpr_read_b32 v41, a16
    v_accvgpr_read_b32 v43, a20
    v_accvgpr_read_b32 v45, a24
    v_accvgpr_read_b32 v47, a28
    v_accvgpr_read_b32 v48, a1
    v_accvgpr_read_b32 v50, a5
    v_accvgpr_read_b32 v52, a9
    v_accvgpr_read_b32 v54, a13
    v_accvgpr_read_b32 v49, a17
    v_accvgpr_read_b32 v51, a21
    v_accvgpr_read_b32 v53, a25
    v_accvgpr_read_b32 v55, a29
    v_pk_fma_f32 v[56:57], v[88:89], v[40:41], v[48:49] op_sel:[0,0,0] op_sel_hi:[0,1,1]
    v_pk_fma_f32 v[58:59], v[90:91], v[42:43], v[50:51] op_sel:[0,0,0] op_sel_hi:[0,1,1]
    v_pk_fma_f32 v[60:61], v[92:93], v[44:45], v[52:53] op_sel:[0,0,0] op_sel_hi:[0,1,1]
    v_pk_fma_f32 v[62:63], v[94:95], v[46:47], v[54:55] op_sel:[0,0,0] op_sel_hi:[0,1,1]
    v_pk_fma_f32 v[40:41], v[88:89], v[40:41], v[56:57] op_sel:[1,1,0] op_sel_hi:[1,0,1] neg_lo:[1,0,0]
    v_pk_fma_f32 v[42:43], v[90:91], v[42:43], v[58:59] op_sel:[1,1,0] op_sel_hi:[1,0,1] neg_lo:[1,0,0]
    v_pk_fma_f32 v[44:45], v[92:93], v[44:45], v[60:61] op_sel:[1,1,0] op_sel_hi:[1,0,1] neg_lo:[1,0,0]
    v_pk_fma_f32 v[46:47], v[94:95], v[46:47], v[62:63] op_sel:[1,1,0] op_sel_hi:[1,0,1] neg_lo:[1,0,0]
    v_accvgpr_read_b32 v64, a2
    v_accvgpr_read_b32 v66, a6
    v_accvgpr_read_b32 v68, a10
    v_accvgpr_read_b32 v70, a14
    v_accvgpr_read_b32 v65, a18
    v_accvgpr_read_b32 v67, a22
    v_accvgpr_read_b32 v69, a26
    v_accvgpr_read_b32 v71, a30
    v_pk_fma_f32 v[56:57], v[88:89], v[40:41], v[64:65] op_sel:[0,0,0] op_sel_hi:[0,1,1]
    v_pk_fma_f32 v[58:59], v[90:91], v[42:43], v[66:67] op_sel:[0,0,0] op_sel_hi:[0,1,1]
    v_pk_fma_f32 v[60:61], v[92:93], v[44:45], v[68:69] op_sel:[0,0,0] op_sel_hi:[0,1,1]
    v_pk_fma_f32 v[62:63], v[94:95], v[46:47], v[70:71] op_sel:[0,0,0] op_sel_hi:[0,1,1]
    v_pk_fma_f32 v[40:41], v[88:89], v[40:41], v[56:57] op_sel:[1,1,0] op_sel_hi:[1,0,1] neg_lo:[1,0,0]
    v_pk_fma_f32 v[42:43], v[90:91], v[42:43], v[58:59] op_sel:[1,1,0] op_sel_hi:[1,0,1] neg_lo:[1,0,0]
    v_pk_fma_f32 v[44:45], v[92:93], v[44:45], v[60:61] op_sel:[1,1,0] op_sel_hi:[1,0,1] neg_lo:[1,0,0]
    v_pk_fma_f32 v[46:47], v[94:95], v[46:47], v[62:63] op_sel:[1,1,0] op_sel_hi:[1,0,1] neg_lo:[1,0,0]
    v_accvgpr_read_b32 v48, a3
    v_accvgpr_read_b32 v50, a7
    v_accvgpr_read_b32 v52, a11
    v_accvgpr_read_b32 v54, a15
    v_accvgpr_read_b32 v49, a19
    v_accvgpr_read_b32 v51, a23
    v_accvgpr_read_b32 v53, a27
    v_accvgpr_read_b32 v55, a31
    v_pk_fma_f32 v[56:57], v[88:89], v[40:41], v[48:49] op_sel:[0,0,0] op_sel_hi:[0,1,1]
    v_pk_fma_f32 v[58:59], v[90:91], v[42:43], v[50:51] op_sel:[0,0,0] op_sel_hi:[0,1,1]
    v_pk_fma_f32 v[60:61], v[92:93], v[44:45], v[52:53] op_sel:[0,0,0] op_sel_hi:[0,1,1]
    v_pk_fma_f32 v[62:63], v[94:95], v[46:47], v[54:55] op_sel:[0,0,0] op_sel_hi:[0,1,1]
    v_pk_fma_f32 v[40:41], v[88:89], v[40:41], v[56:57] op_sel:[1,1,0] op_sel_hi:[1,0,1] neg_lo:[1,0,0]
    v_pk_fma_f32 v[42:43], v[90:91], v[42:43], v[58:59] op_sel:[1,1,0] op_sel_hi:[1,0,1] neg_lo:[1,0,0]
    v_pk_fma_f32 v[44:45], v[92:93], v[44:45], v[60:61] op_sel:[1,1,0] op_sel_hi:[1,0,1] neg_lo:[1,0,0]
    v_pk_fma_f32 v[46:47], v[94:95], v[46:47], v[62:63] op_sel:[1,1,0] op_sel_hi:[1,0,1] neg_lo:[1,0,0]
    v_accvgpr_read_b32 v64, a32
    v_accvgpr_read_b32 v66, a36
    v_accvgpr_read_b32 v68, a40
    v_accvgpr_read_b32 v70, a44
    v_accvgpr_read_b32 v65, a48
    v_accvgpr_read_b32 v67, a52
    v_accvgpr_read_b32 v69, a56
    v_accvgpr_read_b32 v71, a60
    v_pk_fma_f32 v[56:57], v[88:89], v[40:41], v[64:65] op_sel:[0,0,0] op_sel_hi:[0,1,1]
    v_pk_fma_f32 v[58:59], v[90:91], v[42:43], v[66:67] op_sel:[0,0,0] op_sel_hi:[0,1,1]
    v_pk_fma_f32 v[60:61], v[92:93], v[44:45], v[68:69] op_sel:[0,0,0] op_sel_hi:[0,1,1]
    v_pk_fma_f32 v[62:63], v[94:95], v[46:47], v[70:71] op_sel:[0,0,0] op_sel_hi:[0,1,1]
    v_pk_fma_f32 v[40:41], v[88:89], v[40:41], v[56:57] op_sel:[1,1,0] op_sel_hi:[1,0,1] neg_lo:[1,0,0]
    v_pk_fma_f32 v[42:43], v[90:91], v[42:43], v[58:59] op_sel:[1,1,0] op_sel_hi:[1,0,1] neg_lo:[1,0,0]
    v_pk_fma_f32 v[44:45], v[92:93], v[44:45], v[60:61] op_sel:[1,1,0] op_sel_hi:[1,0,1] neg_lo:[1,0,0]
    v_pk_fma_f32 v[46:47], v[94:95], v[46:47], v[62:63] op_sel:[1,1,0] op_sel_hi:[1,0,1] neg_lo:[1,0,0]
    v_accvgpr_read_b32 v48, a33
    v_accvgpr_read_b32 v50, a37
    v_accvgpr_read_b32 v52, a41
    v_accvgpr_read_b32 v54, a45
    v_accvgpr_read_b32 v49, a49
    v_accvgpr_read_b32 v51, a53
    v_accvgpr_read_b32 v53, a57
    v_accvgpr_read_b32 v55, a61
    v_pk_fma_f32 v[56:57], v[88:89], v[40:41], v[48:49] op_sel:[0,0,0] op_sel_hi:[0,1,1]
    v_pk_fma_f32 v[58:59], v[90:91], v[42:43], v[50:51] op_sel:[0,0,0] op_sel_hi:[0,1,1]
    v_pk_fma_f32 v[60:61], v[92:93], v[44:45], v[52:53] op_sel:[0,0,0] op_sel_hi:[0,1,1]
    v_pk_fma_f32 v[62:63], v[94:95], v[46:47], v[54:55] op_sel:[0,0,0] op_sel_hi:[0,1,1]
    v_pk_fma_f32 v[40:41], v[88:89], v[40:41], v[56:57] op_sel:[1,1,0] op_sel_hi:[1,0,1] neg_lo:[1,0,0]
    v_pk_fma_f32 v[42:43], v[90:91], v[42:43], v[58:59] op_sel:[1,1,0] op_sel_hi:[1,0,1] neg_lo:[1,0,0]
    v_pk_fma_f32 v[44:45], v[92:93], v[44:45], v[60:61] op_sel:[1,1,0] op_sel_hi:[1,0,1] neg_lo:[1,0,0]
    v_pk_fma_f32 v[46:47], v[94:95], v[46:47], v[62:63] op_sel:[1,1,0] op_sel_hi:[1,0,1] neg_lo:[1,0,0]
    v_accvgpr_read_b32 v64, a34
    v_accvgpr_read_b32 v66, a38
    v_accvgpr_read_b32 v68, a42
    v_accvgpr_read_b32 v70, a46
    v_accvgpr_read_b32 v65, a50
    v_accvgpr_read_b32 v67, a54
    v_accvgpr_read_b32 v69, a58
    v_accvgpr_read_b32 v71, a62
    v_pk_fma_f32 v[56:57], v[88:89], v[40:41], v[64:65] op_sel:[0,0,0] op_sel_hi:[0,1,1]
    v_pk_fma_f32 v[58:59], v[90:91], v[42:43], v[66:67] op_sel:[0,0,0] op_sel_hi:[0,1,1]
    v_pk_fma_f32 v[60:61], v[92:93], v[44:45], v[68:69] op_sel:[0,0,0] op_sel_hi:[0,1,1]
    v_pk_fma_f32 v[62:63], v[94:95], v[46:47], v[70:71] op_sel:[0,0,0] op_sel_hi:[0,1,1]
    v_pk_fma_f32 v[40:41], v[88:89], v[40:41], v[56:57] op_sel:[1,1,0] op_sel_hi:[1,0,1] neg_lo:[1,0,0]
    v_pk_fma_f32 v[42:43], v[90:91], v[42:43], v[58:59] op_sel:[1,1,0] op_sel_hi:[1,0,1] neg_lo:[1,0,0]
    v_pk_fma_f32 v[44:45], v[92:93], v[44:45], v[60:61] op_sel:[1,1,0] op_sel_hi:[1,0,1] neg_lo:[1,0,0]
    v_pk_fma_f32 v[46:47], v[94:95], v[46:47], v[62:63] op_sel:[1,1,0] op_sel_hi:[1,0,1] neg_lo:[1,0,0]
    v_accvgpr_read_b32 v48, a35
    v_accvgpr_read_b32 v50, a39
    v_accvgpr_read_b32 v52, a43
    v_accvgpr_read_b32 v54, a47
    v_accvgpr_read_b32 v49, a51
    v_accvgpr_read_b32 v51, a55
    v_accvgpr_read_b32 v53, a59
    v_accvgpr_read_b32 v55, a63
    v_pk_fma_f32 v[56:57], v[88:89], v[40:41], v[48:49] op_sel:[0,0,0] op_sel_hi:[0,1,1]
    v_pk_fma_f32 v[58:59], v[90:91], v[42:43], v[50:51] op_sel:[0,0,0] op_sel_hi:[0,1,1]
    v_pk_fma_f32 v[60:61], v[92:93], v[44:45], v[52:53] op_sel:[0,0,0] op_sel_hi:[0,1,1]
    v_pk_fma_f32 v[62:63], v[94:95], v[46:47], v[54:55] op_sel:[0,0,0] op_sel_hi:[0,1,1]
    v_pk_fma_f32 v[40:41], v[88:89], v[40:41], v[56:57] op_sel:[1,1,0] op_sel_hi:[1,0,1] neg_lo:[1,0,0]
    v_pk_fma_f32 v[42:43], v[90:91], v[42:43], v[58:59] op_sel:[1,1,0] op_sel_hi:[1,0,1] neg_lo:[1,0,0]
    v_pk_fma_f32 v[44:45], v[92:93], v[44:45], v[60:61] op_sel:[1,1,0] op_sel_hi:[1,0,1] neg_lo:[1,0,0]
    v_pk_fma_f32 v[46:47], v[94:95], v[46:47], v[62:63] op_sel:[1,1,0] op_sel_hi:[1,0,1] neg_lo:[1,0,0]
    v_accvgpr_read_b32 v64, a64
    v_accvgpr_read_b32 v66, a68
    v_accvgpr_read_b32 v68, a72
    v_accvgpr_read_b32 v70, a76
    v_accvgpr_read_b32 v65, a80
    v_accvgpr_read_b32 v67, a84
    v_accvgpr_read_b32 v69, a88
    v_accvgpr_read_b32 v71, a92
    v_pk_fma_f32 v[56:57], v[88:89], v[40:41], v[64:65] op_sel:[0,0,0] op_sel_hi:[0,1,1]
    v_pk_fma_f32 v[58:59], v[90:91], v[42:43], v[66:67] op_sel:[0,0,0] op_sel_hi:[0,1,1]
    v_pk_fma_f32 v[60:61], v[92:93], v[44:45], v[68:69] op_sel:[0,0,0] op_sel_hi:[0,1,1]
    v_pk_fma_f32 v[62:63], v[94:95], v[46:47], v[70:71] op_sel:[0,0,0] op_sel_hi:[0,1,1]
    v_pk_fma_f32 v[40:41], v[88:89], v[40:41], v[56:57] op_sel:[1,1,0] op_sel_hi:[1,0,1] neg_lo:[1,0,0]
    v_pk_fma_f32 v[42:43], v[90:91], v[42:43], v[58:59] op_sel:[1,1,0] op_sel_hi:[1,0,1] neg_lo:[1,0,0]
    v_pk_fma_f32 v[44:45], v[92:93], v[44:45], v[60:61] op_sel:[1,1,0] op_sel_hi:[1,0,1] neg_lo:[1,0,0]
    v_pk_fma_f32 v[46:47], v[94:95], v[46:47], v[62:63] op_sel:[1,1,0] op_sel_hi:[1,0,1] neg_lo:[1,0,0]
    v_accvgpr_read_b32 v48, a65
    v_accvgpr_read_b32 v50, a69
    v_accvgpr_read_b32 v52, a73
    v_accvgpr_read_b32 v54, a77
    v_accvgpr_read_b32 v49, a81
    v_accvgpr_read_b32 v51, a85
    v_accvgpr_read_b32 v53, a89
    v_accvgpr_read_b32 v55, a93
    v_pk_fma_f32 v[56:57], v[88:89], v[40:41], v[48:49] op_sel:[0,0,0] op_sel_hi:[0,1,1]
    v_pk_fma_f32 v[58:59], v[90:91], v[42:43], v[50:51] op_sel:[0,0,0] op_sel_hi:[0,1,1]
    v_pk_fma_f32 v[60:61], v[92:93], v[44:45], v[52:53] op_sel:[0,0,0] op_sel_hi:[0,1,1]
    v_pk_fma_f32 v[62:63], v[94:95], v[46:47], v[54:55] op_sel:[0,0,0] op_sel_hi:[0,1,1]
    v_pk_fma_f32 v[40:41], v[88:89], v[40:41], v[56:57] op_sel:[1,1,0] op_sel_hi:[1,0,1] neg_lo:[1,0,0]
    v_pk_fma_f32 v[42:43], v[90:91], v[42:43], v[58:59] op_sel:[1,1,0] op_sel_hi:[1,0,1] neg_lo:[1,0,0]
    v_pk_fma_f32 v[44:45], v[92:93], v[44:45], v[60:61] op_sel:[1,1,0] op_sel_hi:[1,0,1] neg_lo:[1,0,0]
    v_pk_fma_f32 v[46:47], v[94:95], v[46:47], v[62:63] op_sel:[1,1,0] op_sel_hi:[1,0,1] neg_lo:[1,0,0]
    v_accvgpr_read_b32 v64, a66
    v_accvgpr_read_b32 v66, a70
    v_accvgpr_read_b32 v68, a74
    v_accvgpr_read_b32 v70, a78
    v_accvgpr_read_b32 v65, a82
    v_accvgpr_read_b32 v67, a86
    v_accvgpr_read_b32 v69, a90
    v_accvgpr_read_b32 v71, a94
    v_pk_fma_f32 v[56:57], v[88:89], v[40:41], v[64:65] op_sel:[0,0,0] op_sel_hi:[0,1,1]
    v_pk_fma_f32 v[58:59], v[90:91], v[42:43], v[66:67] op_sel:[0,0,0] op_sel_hi:[0,1,1]
    v_pk_fma_f32 v[60:61], v[92:93], v[44:45], v[68:69] op_sel:[0,0,0] op_sel_hi:[0,1,1]
    v_pk_fma_f32 v[62:63], v[94:95], v[46:47], v[70:71] op_sel:[0,0,0] op_sel_hi:[0,1,1]
    v_pk_fma_f32 v[40:41], v[88:89], v[40:41], v[56:57] op_sel:[1,1,0] op_sel_hi:[1,0,1] neg_lo:[1,0,0]
    v_pk_fma_f32 v[42:43], v[90:91], v[42:43], v[58:59] op_sel:[1,1,0] op_sel_hi:[1,0,1] neg_lo:[1,0,0]
    v_pk_fma_f32 v[44:45], v[92:93], v[44:45], v[60:61] op_sel:[1,1,0] op_sel_hi:[1,0,1] neg_lo:[1,0,0]
    v_pk_fma_f32 v[46:47], v[94:95], v[46:47], v[62:63] op_sel:[1,1,0] op_sel_hi:[1,0,1] neg_lo:[1,0,0]
    v_accvgpr_read_b32 v48, a67
    v_accvgpr_read_b32 v50, a71
    v_accvgpr_read_b32 v52, a75
    v_accvgpr_read_b32 v54, a79
    v_accvgpr_read_b32 v49, a83
    v_accvgpr_read_b32 v51, a87
    v_accvgpr_read_b32 v53, a91
    v_accvgpr_read_b32 v55, a95
    v_pk_fma_f32 v[56:57], v[88:89], v[40:41], v[48:49] op_sel:[0,0,0] op_sel_hi:[0,1,1]
    v_pk_fma_f32 v[58:59], v[90:91], v[42:43], v[50:51] op_sel:[0,0,0] op_sel_hi:[0,1,1]
    v_pk_fma_f32 v[60:61], v[92:93], v[44:45], v[52:53] op_sel:[0,0,0] op_sel_hi:[0,1,1]
    v_pk_fma_f32 v[62:63], v[94:95], v[46:47], v[54:55] op_sel:[0,0,0] op_sel_hi:[0,1,1]
    v_pk_fma_f32 v[40:41], v[88:89], v[40:41], v[56:57] op_sel:[1,1,0] op_sel_hi:[1,0,1] neg_lo:[1,0,0]
    v_pk_fma_f32 v[42:43], v[90:91], v[42:43], v[58:59] op_sel:[1,1,0] op_sel_hi:[1,0,1] neg_lo:[1,0,0]
    v_pk_fma_f32 v[44:45], v[92:93], v[44:45], v[60:61] op_sel:[1,1,0] op_sel_hi:[1,0,1] neg_lo:[1,0,0]
    v_pk_fma_f32 v[46:47], v[94:95], v[46:47], v[62:63] op_sel:[1,1,0] op_sel_hi:[1,0,1] neg_lo:[1,0,0]
    v_accvgpr_read_b32 v64, a96
    v_accvgpr_read_b32 v66, a100
    v_accvgpr_read_b32 v68, a104
    v_accvgpr_read_b32 v70, a108
    v_accvgpr_read_b32 v65, a112
    v_accvgpr_read_b32 v67, a116
    v_accvgpr_read_b32 v69, a120
    v_accvgpr_read_b32 v71, a124
    v_pk_fma_f32 v[56:57], v[88:89], v[40:41], v[64:65] op_sel:[0,0,0] op_sel_hi:[0,1,1]
    v_pk_fma_f32 v[58:59], v[90:91], v[42:43], v[66:67] op_sel:[0,0,0] op_sel_hi:[0,1,1]
    v_pk_fma_f32 v[60:61], v[92:93], v[44:45], v[68:69] op_sel:[0,0,0] op_sel_hi:[0,1,1]
    v_pk_fma_f32 v[62:63], v[94:95], v[46:47], v[70:71] op_sel:[0,0,0] op_sel_hi:[0,1,1]
    v_pk_fma_f32 v[40:41], v[88:89], v[40:41], v[56:57] op_sel:[1,1,0] op_sel_hi:[1,0,1] neg_lo:[1,0,0]
    v_pk_fma_f32 v[42:43], v[90:91], v[42:43], v[58:59] op_sel:[1,1,0] op_sel_hi:[1,0,1] neg_lo:[1,0,0]
    v_pk_fma_f32 v[44:45], v[92:93], v[44:45], v[60:61] op_sel:[1,1,0] op_sel_hi:[1,0,1] neg_lo:[1,0,0]
    v_pk_fma_f32 v[46:47], v[94:95], v[46:47], v[62:63] op_sel:[1,1,0] op_sel_hi:[1,0,1] neg_lo:[1,0,0]
    v_accvgpr_read_b32 v48, a97
    v_accvgpr_read_b32 v50, a101
    v_accvgpr_read_b32 v52, a105
    v_accvgpr_read_b32 v54, a109
    v_accvgpr_read_b32 v49, a113
    v_accvgpr_read_b32 v51, a117
    v_accvgpr_read_b32 v53, a121
    v_accvgpr_read_b32 v55, a125
    v_pk_fma_f32 v[56:57], v[88:89], v[40:41], v[48:49] op_sel:[0,0,0] op_sel_hi:[0,1,1]
    v_pk_fma_f32 v[58:59], v[90:91], v[42:43], v[50:51] op_sel:[0,0,0] op_sel_hi:[0,1,1]
    v_pk_fma_f32 v[60:61], v[92:93], v[44:45], v[52:53] op_sel:[0,0,0] op_sel_hi:[0,1,1]
    v_pk_fma_f32 v[62:63], v[94:95], v[46:47], v[54:55] op_sel:[0,0,0] op_sel_hi:[0,1,1]
    v_pk_fma_f32 v[40:41], v[88:89], v[40:41], v[56:57] op_sel:[1,1,0] op_sel_hi:[1,0,1] neg_lo:[1,0,0]
    v_pk_fma_f32 v[42:43], v[90:91], v[42:43], v[58:59] op_sel:[1,1,0] op_sel_hi:[1,0,1] neg_lo:[1,0,0]
    v_pk_fma_f32 v[44:45], v[92:93], v[44:45], v[60:61] op_sel:[1,1,0] op_sel_hi:[1,0,1] neg_lo:[1,0,0]
    v_pk_fma_f32 v[46:47], v[94:95], v[46:47], v[62:63] op_sel:[1,1,0] op_sel_hi:[1,0,1] neg_lo:[1,0,0]
    v_accvgpr_read_b32 v64, a98
    v_accvgpr_read_b32 v66, a102
    v_accvgpr_read_b32 v68, a106
    v_accvgpr_read_b32 v70, a110
    v_accvgpr_read_b32 v65, a114
    v_accvgpr_read_b32 v67, a118
    v_accvgpr_read_b32 v69, a122
    v_accvgpr_read_b32 v71, a126
    v_pk_fma_f32 v[56:57], v[88:89], v[40:41], v[64:65] op_sel:[0,0,0] op_sel_hi:[0,1,1]
    v_pk_fma_f32 v[58:59], v[90:91], v[42:43], v[66:67] op_sel:[0,0,0] op_sel_hi:[0,1,1]
    v_pk_fma_f32 v[60:61], v[92:93], v[44:45], v[68:69] op_sel:[0,0,0] op_sel_hi:[0,1,1]
    v_pk_fma_f32 v[62:63], v[94:95], v[46:47], v[70:71] op_sel:[0,0,0] op_sel_hi:[0,1,1]
    v_pk_fma_f32 v[40:41], v[88:89], v[40:41], v[56:57] op_sel:[1,1,0] op_sel_hi:[1,0,1] neg_lo:[1,0,0]
    v_pk_fma_f32 v[42:43], v[90:91], v[42:43], v[58:59] op_sel:[1,1,0] op_sel_hi:[1,0,1] neg_lo:[1,0,0]
    v_pk_fma_f32 v[44:45], v[92:93], v[44:45], v[60:61] op_sel:[1,1,0] op_sel_hi:[1,0,1] neg_lo:[1,0,0]
    v_pk_fma_f32 v[46:47], v[94:95], v[46:47], v[62:63] op_sel:[1,1,0] op_sel_hi:[1,0,1] neg_lo:[1,0,0]
    v_accvgpr_read_b32 v48, a99
    v_accvgpr_read_b32 v50, a103
    v_accvgpr_read_b32 v52, a107
    v_accvgpr_read_b32 v54, a111
    v_accvgpr_read_b32 v49, a115
    v_accvgpr_read_b32 v51, a119
    v_accvgpr_read_b32 v53, a123
    v_accvgpr_read_b32 v55, a127
    v_pk_fma_f32 v[56:57], v[88:89], v[40:41], v[48:49] op_sel:[0,0,0] op_sel_hi:[0,1,1]
    v_pk_fma_f32 v[58:59], v[90:91], v[42:43], v[50:51] op_sel:[0,0,0] op_sel_hi:[0,1,1]
    v_pk_fma_f32 v[60:61], v[92:93], v[44:45], v[52:53] op_sel:[0,0,0] op_sel_hi:[0,1,1]
    v_pk_fma_f32 v[62:63], v[94:95], v[46:47], v[54:55] op_sel:[0,0,0] op_sel_hi:[0,1,1]
    v_pk_fma_f32 v[40:41], v[88:89], v[40:41], v[56:57] op_sel:[1,1,0] op_sel_hi:[1,0,1] neg_lo:[1,0,0]
    v_pk_fma_f32 v[42:43], v[90:91], v[42:43], v[58:59] op_sel:[1,1,0] op_sel_hi:[1,0,1] neg_lo:[1,0,0]
    v_pk_fma_f32 v[44:45], v[92:93], v[44:45], v[60:61] op_sel:[1,1,0] op_sel_hi:[1,0,1] neg_lo:[1,0,0]
    v_pk_fma_f32 v[46:47], v[94:95], v[46:47], v[62:63] op_sel:[1,1,0] op_sel_hi:[1,0,1] neg_lo:[1,0,0]
    v_accvgpr_read_b32 v64, a128
    v_accvgpr_read_b32 v66, a132
    v_accvgpr_read_b32 v68, a136
    v_accvgpr_read_b32 v70, a140
    v_accvgpr_read_b32 v65, a144
    v_accvgpr_read_b32 v67, a148
    v_accvgpr_read_b32 v69, a152
    v_accvgpr_read_b32 v71, a156
    v_pk_fma_f32 v[56:57], v[88:89], v[40:41], v[64:65] op_sel:[0,0,0] op_sel_hi:[0,1,1]
    v_pk_fma_f32 v[58:59], v[90:91], v[42:43], v[66:67] op_sel:[0,0,0] op_sel_hi:[0,1,1]
    v_pk_fma_f32 v[60:61], v[92:93], v[44:45], v[68:69] op_sel:[0,0,0] op_sel_hi:[0,1,1]
    v_pk_fma_f32 v[62:63], v[94:95], v[46:47], v[70:71] op_sel:[0,0,0] op_sel_hi:[0,1,1]
    v_pk_fma_f32 v[40:41], v[88:89], v[40:41], v[56:57] op_sel:[1,1,0] op_sel_hi:[1,0,1] neg_lo:[1,0,0]
    v_pk_fma_f32 v[42:43], v[90:91], v[42:43], v[58:59] op_sel:[1,1,0] op_sel_hi:[1,0,1] neg_lo:[1,0,0]
    v_pk_fma_f32 v[44:45], v[92:93], v[44:45], v[60:61] op_sel:[1,1,0] op_sel_hi:[1,0,1] neg_lo:[1,0,0]
    v_pk_fma_f32 v[46:47], v[94:95], v[46:47], v[62:63] op_sel:[1,1,0] op_sel_hi:[1,0,1] neg_lo:[1,0,0]
    v_accvgpr_read_b32 v48, a129
    v_accvgpr_read_b32 v50, a133
    v_accvgpr_read_b32 v52, a137
    v_accvgpr_read_b32 v54, a141
    v_accvgpr_read_b32 v49, a145
    v_accvgpr_read_b32 v51, a149
    v_accvgpr_read_b32 v53, a153
    v_accvgpr_read_b32 v55, a157
    v_pk_fma_f32 v[56:57], v[88:89], v[40:41], v[48:49] op_sel:[0,0,0] op_sel_hi:[0,1,1]
    v_pk_fma_f32 v[58:59], v[90:91], v[42:43], v[50:51] op_sel:[0,0,0] op_sel_hi:[0,1,1]
    v_pk_fma_f32 v[60:61], v[92:93], v[44:45], v[52:53] op_sel:[0,0,0] op_sel_hi:[0,1,1]
    v_pk_fma_f32 v[62:63], v[94:95], v[46:47], v[54:55] op_sel:[0,0,0] op_sel_hi:[0,1,1]
    v_pk_fma_f32 v[40:41], v[88:89], v[40:41], v[56:57] op_sel:[1,1,0] op_sel_hi:[1,0,1] neg_lo:[1,0,0]
    v_pk_fma_f32 v[42:43], v[90:91], v[42:43], v[58:59] op_sel:[1,1,0] op_sel_hi:[1,0,1] neg_lo:[1,0,0]
    v_pk_fma_f32 v[44:45], v[92:93], v[44:45], v[60:61] op_sel:[1,1,0] op_sel_hi:[1,0,1] neg_lo:[1,0,0]
    v_pk_fma_f32 v[46:47], v[94:95], v[46:47], v[62:63] op_sel:[1,1,0] op_sel_hi:[1,0,1] neg_lo:[1,0,0]
    v_accvgpr_read_b32 v64, a130
    v_accvgpr_read_b32 v66, a134
    v_accvgpr_read_b32 v68, a138
    v_accvgpr_read_b32 v70, a142
    v_accvgpr_read_b32 v65, a146
    v_accvgpr_read_b32 v67, a150
    v_accvgpr_read_b32 v69, a154
    v_accvgpr_read_b32 v71, a158
    v_pk_fma_f32 v[56:57], v[88:89], v[40:41], v[64:65] op_sel:[0,0,0] op_sel_hi:[0,1,1]
    v_pk_fma_f32 v[58:59], v[90:91], v[42:43], v[66:67] op_sel:[0,0,0] op_sel_hi:[0,1,1]
    v_pk_fma_f32 v[60:61], v[92:93], v[44:45], v[68:69] op_sel:[0,0,0] op_sel_hi:[0,1,1]
    v_pk_fma_f32 v[62:63], v[94:95], v[46:47], v[70:71] op_sel:[0,0,0] op_sel_hi:[0,1,1]
    v_pk_fma_f32 v[40:41], v[88:89], v[40:41], v[56:57] op_sel:[1,1,0] op_sel_hi:[1,0,1] neg_lo:[1,0,0]
    v_pk_fma_f32 v[42:43], v[90:91], v[42:43], v[58:59] op_sel:[1,1,0] op_sel_hi:[1,0,1] neg_lo:[1,0,0]
    v_pk_fma_f32 v[44:45], v[92:93], v[44:45], v[60:61] op_sel:[1,1,0] op_sel_hi:[1,0,1] neg_lo:[1,0,0]
    v_pk_fma_f32 v[46:47], v[94:95], v[46:47], v[62:63] op_sel:[1,1,0] op_sel_hi:[1,0,1] neg_lo:[1,0,0]
    v_accvgpr_read_b32 v48, a131
    v_accvgpr_read_b32 v50, a135
    v_accvgpr_read_b32 v52, a139
    v_accvgpr_read_b32 v54, a143
    v_accvgpr_read_b32 v49, a147
    v_accvgpr_read_b32 v51, a151
    v_accvgpr_read_b32 v53, a155
    v_accvgpr_read_b32 v55, a159
    v_pk_fma_f32 v[56:57], v[88:89], v[40:41], v[48:49] op_sel:[0,0,0] op_sel_hi:[0,1,1]
    v_pk_fma_f32 v[58:59], v[90:91], v[42:43], v[50:51] op_sel:[0,0,0] op_sel_hi:[0,1,1]
    v_pk_fma_f32 v[60:61], v[92:93], v[44:45], v[52:53] op_sel:[0,0,0] op_sel_hi:[0,1,1]
    v_pk_fma_f32 v[62:63], v[94:95], v[46:47], v[54:55] op_sel:[0,0,0] op_sel_hi:[0,1,1]
    v_pk_fma_f32 v[40:41], v[88:89], v[40:41], v[56:57] op_sel:[1,1,0] op_sel_hi:[1,0,1] neg_lo:[1,0,0]
    v_pk_fma_f32 v[42:43], v[90:91], v[42:43], v[58:59] op_sel:[1,1,0] op_sel_hi:[1,0,1] neg_lo:[1,0,0]
    v_pk_fma_f32 v[44:45], v[92:93], v[44:45], v[60:61] op_sel:[1,1,0] op_sel_hi:[1,0,1] neg_lo:[1,0,0]
    v_pk_fma_f32 v[46:47], v[94:95], v[46:47], v[62:63] op_sel:[1,1,0] op_sel_hi:[1,0,1] neg_lo:[1,0,0]
    v_accvgpr_read_b32 v64, a160
    v_accvgpr_read_b32 v66, a164
    v_accvgpr_read_b32 v68, a168
    v_accvgpr_read_b32 v70, a172
    v_accvgpr_read_b32 v65, a176
    v_accvgpr_read_b32 v67, a180
    v_accvgpr_read_b32 v69, a184
    v_accvgpr_read_b32 v71, a188
    v_pk_fma_f32 v[56:57], v[88:89], v[40:41], v[64:65] op_sel:[0,0,0] op_sel_hi:[0,1,1]
    v_pk_fma_f32 v[58:59], v[90:91], v[42:43], v[66:67] op_sel:[0,0,0] op_sel_hi:[0,1,1]
    v_pk_fma_f32 v[60:61], v[92:93], v[44:45], v[68:69] op_sel:[0,0,0] op_sel_hi:[0,1,1]
    v_pk_fma_f32 v[62:63], v[94:95], v[46:47], v[70:71] op_sel:[0,0,0] op_sel_hi:[0,1,1]
    v_pk_fma_f32 v[40:41], v[88:89], v[40:41], v[56:57] op_sel:[1,1,0] op_sel_hi:[1,0,1] neg_lo:[1,0,0]
    v_pk_fma_f32 v[42:43], v[90:91], v[42:43], v[58:59] op_sel:[1,1,0] op_sel_hi:[1,0,1] neg_lo:[1,0,0]
    v_pk_fma_f32 v[44:45], v[92:93], v[44:45], v[60:61] op_sel:[1,1,0] op_sel_hi:[1,0,1] neg_lo:[1,0,0]
    v_pk_fma_f32 v[46:47], v[94:95], v[46:47], v[62:63] op_sel:[1,1,0] op_sel_hi:[1,0,1] neg_lo:[1,0,0]
    v_accvgpr_read_b32 v48, a161
    v_accvgpr_read_b32 v50, a165
    v_accvgpr_read_b32 v52, a169
    v_accvgpr_read_b32 v54, a173
    v_accvgpr_read_b32 v49, a177
    v_accvgpr_read_b32 v51, a181
    v_accvgpr_read_b32 v53, a185
    v_accvgpr_read_b32 v55, a189
    v_pk_fma_f32 v[56:57], v[88:89], v[40:41], v[48:49] op_sel:[0,0,0] op_sel_hi:[0,1,1]
    v_pk_fma_f32 v[58:59], v[90:91], v[42:43], v[50:51] op_sel:[0,0,0] op_sel_hi:[0,1,1]
    v_pk_fma_f32 v[60:61], v[92:93], v[44:45], v[52:53] op_sel:[0,0,0] op_sel_hi:[0,1,1]
    v_pk_fma_f32 v[62:63], v[94:95], v[46:47], v[54:55] op_sel:[0,0,0] op_sel_hi:[0,1,1]
    v_pk_fma_f32 v[40:41], v[88:89], v[40:41], v[56:57] op_sel:[1,1,0] op_sel_hi:[1,0,1] neg_lo:[1,0,0]
    v_pk_fma_f32 v[42:43], v[90:91], v[42:43], v[58:59] op_sel:[1,1,0] op_sel_hi:[1,0,1] neg_lo:[1,0,0]
    v_pk_fma_f32 v[44:45], v[92:93], v[44:45], v[60:61] op_sel:[1,1,0] op_sel_hi:[1,0,1] neg_lo:[1,0,0]
    v_pk_fma_f32 v[46:47], v[94:95], v[46:47], v[62:63] op_sel:[1,1,0] op_sel_hi:[1,0,1] neg_lo:[1,0,0]
    v_accvgpr_read_b32 v64, a162
    v_accvgpr_read_b32 v66, a166
    v_accvgpr_read_b32 v68, a170
    v_accvgpr_read_b32 v70, a174
    v_accvgpr_read_b32 v65, a178
    v_accvgpr_read_b32 v67, a182
    v_accvgpr_read_b32 v69, a186
    v_accvgpr_read_b32 v71, a190
    v_pk_fma_f32 v[56:57], v[88:89], v[40:41], v[64:65] op_sel:[0,0,0] op_sel_hi:[0,1,1]
    v_pk_fma_f32 v[58:59], v[90:91], v[42:43], v[66:67] op_sel:[0,0,0] op_sel_hi:[0,1,1]
    v_pk_fma_f32 v[60:61], v[92:93], v[44:45], v[68:69] op_sel:[0,0,0] op_sel_hi:[0,1,1]
    v_pk_fma_f32 v[62:63], v[94:95], v[46:47], v[70:71] op_sel:[0,0,0] op_sel_hi:[0,1,1]
    v_pk_fma_f32 v[40:41], v[88:89], v[40:41], v[56:57] op_sel:[1,1,0] op_sel_hi:[1,0,1] neg_lo:[1,0,0]
    v_pk_fma_f32 v[42:43], v[90:91], v[42:43], v[58:59] op_sel:[1,1,0] op_sel_hi:[1,0,1] neg_lo:[1,0,0]
    v_pk_fma_f32 v[44:45], v[92:93], v[44:45], v[60:61] op_sel:[1,1,0] op_sel_hi:[1,0,1] neg_lo:[1,0,0]
    v_pk_fma_f32 v[46:47], v[94:95], v[46:47], v[62:63] op_sel:[1,1,0] op_sel_hi:[1,0,1] neg_lo:[1,0,0]
    v_accvgpr_read_b32 v48, a163
    v_accvgpr_read_b32 v50, a167
    v_accvgpr_read_b32 v52, a171
    v_accvgpr_read_b32 v54, a175
    v_accvgpr_read_b32 v49, a179
    v_accvgpr_read_b32 v51, a183
    v_accvgpr_read_b32 v53, a187
    v_accvgpr_read_b32 v55, a191
    v_pk_fma_f32 v[56:57], v[88:89], v[40:41], v[48:49] op_sel:[0,0,0] op_sel_hi:[0,1,1]
    v_pk_fma_f32 v[58:59], v[90:91], v[42:43], v[50:51] op_sel:[0,0,0] op_sel_hi:[0,1,1]
    v_pk_fma_f32 v[60:61], v[92:93], v[44:45], v[52:53] op_sel:[0,0,0] op_sel_hi:[0,1,1]
    v_pk_fma_f32 v[62:63], v[94:95], v[46:47], v[54:55] op_sel:[0,0,0] op_sel_hi:[0,1,1]
    v_pk_fma_f32 v[40:41], v[88:89], v[40:41], v[56:57] op_sel:[1,1,0] op_sel_hi:[1,0,1] neg_lo:[1,0,0]
    v_pk_fma_f32 v[42:43], v[90:91], v[42:43], v[58:59] op_sel:[1,1,0] op_sel_hi:[1,0,1] neg_lo:[1,0,0]
    v_pk_fma_f32 v[44:45], v[92:93], v[44:45], v[60:61] op_sel:[1,1,0] op_sel_hi:[1,0,1] neg_lo:[1,0,0]
    v_pk_fma_f32 v[46:47], v[94:95], v[46:47], v[62:63] op_sel:[1,1,0] op_sel_hi:[1,0,1] neg_lo:[1,0,0]
    v_accvgpr_read_b32 v64, a192
    v_accvgpr_read_b32 v66, a196
    v_accvgpr_read_b32 v68, a200
    v_accvgpr_read_b32 v70, a204
    v_accvgpr_read_b32 v65, a208
    v_accvgpr_read_b32 v67, a212
    v_accvgpr_read_b32 v69, a216
    v_accvgpr_read_b32 v71, a220
    v_pk_fma_f32 v[56:57], v[88:89], v[40:41], v[64:65] op_sel:[0,0,0] op_sel_hi:[0,1,1]
    v_pk_fma_f32 v[58:59], v[90:91], v[42:43], v[66:67] op_sel:[0,0,0] op_sel_hi:[0,1,1]
    v_pk_fma_f32 v[60:61], v[92:93], v[44:45], v[68:69] op_sel:[0,0,0] op_sel_hi:[0,1,1]
    v_pk_fma_f32 v[62:63], v[94:95], v[46:47], v[70:71] op_sel:[0,0,0] op_sel_hi:[0,1,1]
    v_pk_fma_f32 v[40:41], v[88:89], v[40:41], v[56:57] op_sel:[1,1,0] op_sel_hi:[1,0,1] neg_lo:[1,0,0]
    v_pk_fma_f32 v[42:43], v[90:91], v[42:43], v[58:59] op_sel:[1,1,0] op_sel_hi:[1,0,1] neg_lo:[1,0,0]
    v_pk_fma_f32 v[44:45], v[92:93], v[44:45], v[60:61] op_sel:[1,1,0] op_sel_hi:[1,0,1] neg_lo:[1,0,0]
    v_pk_fma_f32 v[46:47], v[94:95], v[46:47], v[62:63] op_sel:[1,1,0] op_sel_hi:[1,0,1] neg_lo:[1,0,0]
    v_accvgpr_read_b32 v48, a193
    v_accvgpr_read_b32 v50, a197
    v_accvgpr_read_b32 v52, a201
    v_accvgpr_read_b32 v54, a205
    v_accvgpr_read_b32 v49, a209
    v_accvgpr_read_b32 v51, a213
    v_accvgpr_read_b32 v53, a217
    v_accvgpr_read_b32 v55, a221
    v_pk_fma_f32 v[56:57], v[88:89], v[40:41], v[48:49] op_sel:[0,0,0] op_sel_hi:[0,1,1]
    v_pk_fma_f32 v[58:59], v[90:91], v[42:43], v[50:51] op_sel:[0,0,0] op_sel_hi:[0,1,1]
    v_pk_fma_f32 v[60:61], v[92:93], v[44:45], v[52:53] op_sel:[0,0,0] op_sel_hi:[0,1,1]
    v_pk_fma_f32 v[62:63], v[94:95], v[46:47], v[54:55] op_sel:[0,0,0] op_sel_hi:[0,1,1]
    v_pk_fma_f32 v[40:41], v[88:89], v[40:41], v[56:57] op_sel:[1,1,0] op_sel_hi:[1,0,1] neg_lo:[1,0,0]
    v_pk_fma_f32 v[42:43], v[90:91], v[42:43], v[58:59] op_sel:[1,1,0] op_sel_hi:[1,0,1] neg_lo:[1,0,0]
    v_pk_fma_f32 v[44:45], v[92:93], v[44:45], v[60:61] op_sel:[1,1,0] op_sel_hi:[1,0,1] neg_lo:[1,0,0]
    v_pk_fma_f32 v[46:47], v[94:95], v[46:47], v[62:63] op_sel:[1,1,0] op_sel_hi:[1,0,1] neg_lo:[1,0,0]
    v_accvgpr_read_b32 v64, a194
    v_accvgpr_read_b32 v66, a198
    v_accvgpr_read_b32 v68, a202
    v_accvgpr_read_b32 v70, a206
    v_accvgpr_read_b32 v65, a210
    v_accvgpr_read_b32 v67, a214
    v_accvgpr_read_b32 v69, a218
    v_accvgpr_read_b32 v71, a222
    v_pk_fma_f32 v[56:57], v[88:89], v[40:41], v[64:65] op_sel:[0,0,0] op_sel_hi:[0,1,1]
    v_pk_fma_f32 v[58:59], v[90:91], v[42:43], v[66:67] op_sel:[0,0,0] op_sel_hi:[0,1,1]
    v_pk_fma_f32 v[60:61], v[92:93], v[44:45], v[68:69] op_sel:[0,0,0] op_sel_hi:[0,1,1]
    v_pk_fma_f32 v[62:63], v[94:95], v[46:47], v[70:71] op_sel:[0,0,0] op_sel_hi:[0,1,1]
    v_pk_fma_f32 v[40:41], v[88:89], v[40:41], v[56:57] op_sel:[1,1,0] op_sel_hi:[1,0,1] neg_lo:[1,0,0]
    v_pk_fma_f32 v[42:43], v[90:91], v[42:43], v[58:59] op_sel:[1,1,0] op_sel_hi:[1,0,1] neg_lo:[1,0,0]
    v_pk_fma_f32 v[44:45], v[92:93], v[44:45], v[60:61] op_sel:[1,1,0] op_sel_hi:[1,0,1] neg_lo:[1,0,0]
    v_pk_fma_f32 v[46:47], v[94:95], v[46:47], v[62:63] op_sel:[1,1,0] op_sel_hi:[1,0,1] neg_lo:[1,0,0]
    v_accvgpr_read_b32 v48, a195
    v_accvgpr_read_b32 v50, a199
    v_accvgpr_read_b32 v52, a203
    v_accvgpr_read_b32 v54, a207
    v_accvgpr_read_b32 v49, a211
    v_accvgpr_read_b32 v51, a215
    v_accvgpr_read_b32 v53, a219
    v_accvgpr_read_b32 v55, a223
    v_pk_fma_f32 v[56:57], v[88:89], v[40:41], v[48:49] op_sel:[0,0,0] op_sel_hi:[0,1,1]
    v_pk_fma_f32 v[58:59], v[90:91], v[42:43], v[50:51] op_sel:[0,0,0] op_sel_hi:[0,1,1]
    v_pk_fma_f32 v[60:61], v[92:93], v[44:45], v[52:53] op_sel:[0,0,0] op_sel_hi:[0,1,1]
    v_pk_fma_f32 v[62:63], v[94:95], v[46:47], v[54:55] op_sel:[0,0,0] op_sel_hi:[0,1,1]
    v_pk_fma_f32 v[40:41], v[88:89], v[40:41], v[56:57] op_sel:[1,1,0] op_sel_hi:[1,0,1] neg_lo:[1,0,0]
    v_pk_fma_f32 v[42:43], v[90:91], v[42:43], v[58:59] op_sel:[1,1,0] op_sel_hi:[1,0,1] neg_lo:[1,0,0]
    v_pk_fma_f32 v[44:45], v[92:93], v[44:45], v[60:61] op_sel:[1,1,0] op_sel_hi:[1,0,1] neg_lo:[1,0,0]
    v_pk_fma_f32 v[46:47], v[94:95], v[46:47], v[62:63] op_sel:[1,1,0] op_sel_hi:[1,0,1] neg_lo:[1,0,0]
    v_accvgpr_read_b32 v64, a224
    v_accvgpr_read_b32 v66, a228
    v_accvgpr_read_b32 v68, a232
    v_accvgpr_read_b32 v70, a236
    v_accvgpr_read_b32 v65, a240
    v_accvgpr_read_b32 v67, a244
    v_accvgpr_read_b32 v69, a248
    v_accvgpr_read_b32 v71, a252
    v_pk_fma_f32 v[56:57], v[88:89], v[40:41], v[64:65] op_sel:[0,0,0] op_sel_hi:[0,1,1]
    v_pk_fma_f32 v[58:59], v[90:91], v[42:43], v[66:67] op_sel:[0,0,0] op_sel_hi:[0,1,1]
    v_pk_fma_f32 v[60:61], v[92:93], v[44:45], v[68:69] op_sel:[0,0,0] op_sel_hi:[0,1,1]
    v_pk_fma_f32 v[62:63], v[94:95], v[46:47], v[70:71] op_sel:[0,0,0] op_sel_hi:[0,1,1]
    v_pk_fma_f32 v[40:41], v[88:89], v[40:41], v[56:57] op_sel:[1,1,0] op_sel_hi:[1,0,1] neg_lo:[1,0,0]
    v_pk_fma_f32 v[42:43], v[90:91], v[42:43], v[58:59] op_sel:[1,1,0] op_sel_hi:[1,0,1] neg_lo:[1,0,0]
    v_pk_fma_f32 v[44:45], v[92:93], v[44:45], v[60:61] op_sel:[1,1,0] op_sel_hi:[1,0,1] neg_lo:[1,0,0]
    v_pk_fma_f32 v[46:47], v[94:95], v[46:47], v[62:63] op_sel:[1,1,0] op_sel_hi:[1,0,1] neg_lo:[1,0,0]
    v_accvgpr_read_b32 v48, a225
    v_accvgpr_read_b32 v50, a229
    v_accvgpr_read_b32 v52, a233
    v_accvgpr_read_b32 v54, a237
    v_accvgpr_read_b32 v49, a241
    v_accvgpr_read_b32 v51, a245
    v_accvgpr_read_b32 v53, a249
    v_accvgpr_read_b32 v55, a253
    v_pk_fma_f32 v[56:57], v[88:89], v[40:41], v[48:49] op_sel:[0,0,0] op_sel_hi:[0,1,1]
    v_pk_fma_f32 v[58:59], v[90:91], v[42:43], v[50:51] op_sel:[0,0,0] op_sel_hi:[0,1,1]
    v_pk_fma_f32 v[60:61], v[92:93], v[44:45], v[52:53] op_sel:[0,0,0] op_sel_hi:[0,1,1]
    v_pk_fma_f32 v[62:63], v[94:95], v[46:47], v[54:55] op_sel:[0,0,0] op_sel_hi:[0,1,1]
    v_pk_fma_f32 v[40:41], v[88:89], v[40:41], v[56:57] op_sel:[1,1,0] op_sel_hi:[1,0,1] neg_lo:[1,0,0]
    v_pk_fma_f32 v[42:43], v[90:91], v[42:43], v[58:59] op_sel:[1,1,0] op_sel_hi:[1,0,1] neg_lo:[1,0,0]
    v_pk_fma_f32 v[44:45], v[92:93], v[44:45], v[60:61] op_sel:[1,1,0] op_sel_hi:[1,0,1] neg_lo:[1,0,0]
    v_pk_fma_f32 v[46:47], v[94:95], v[46:47], v[62:63] op_sel:[1,1,0] op_sel_hi:[1,0,1] neg_lo:[1,0,0]
    v_accvgpr_read_b32 v64, a226
    v_accvgpr_read_b32 v66, a230
    v_accvgpr_read_b32 v68, a234
    v_accvgpr_read_b32 v70, a238
    v_accvgpr_read_b32 v65, a242
    v_accvgpr_read_b32 v67, a246
    v_accvgpr_read_b32 v69, a250
    v_accvgpr_read_b32 v71, a254
    v_pk_fma_f32 v[56:57], v[88:89], v[40:41], v[64:65] op_sel:[0,0,0] op_sel_hi:[0,1,1]
    v_pk_fma_f32 v[58:59], v[90:91], v[42:43], v[66:67] op_sel:[0,0,0] op_sel_hi:[0,1,1]
    v_pk_fma_f32 v[60:61], v[92:93], v[44:45], v[68:69] op_sel:[0,0,0] op_sel_hi:[0,1,1]
    v_pk_fma_f32 v[62:63], v[94:95], v[46:47], v[70:71] op_sel:[0,0,0] op_sel_hi:[0,1,1]
    v_pk_fma_f32 v[40:41], v[88:89], v[40:41], v[56:57] op_sel:[1,1,0] op_sel_hi:[1,0,1] neg_lo:[1,0,0]
    v_pk_fma_f32 v[42:43], v[90:91], v[42:43], v[58:59] op_sel:[1,1,0] op_sel_hi:[1,0,1] neg_lo:[1,0,0]
    v_pk_fma_f32 v[44:45], v[92:93], v[44:45], v[60:61] op_sel:[1,1,0] op_sel_hi:[1,0,1] neg_lo:[1,0,0]
    v_pk_fma_f32 v[46:47], v[94:95], v[46:47], v[62:63] op_sel:[1,1,0] op_sel_hi:[1,0,1] neg_lo:[1,0,0]
    v_accvgpr_read_b32 v48, a227
    v_accvgpr_read_b32 v50, a231
    v_accvgpr_read_b32 v52, a235
    v_accvgpr_read_b32 v54, a239
    v_accvgpr_read_b32 v49, a243
    v_accvgpr_read_b32 v51, a247
    v_accvgpr_read_b32 v53, a251
    v_accvgpr_read_b32 v55, a255
    v_pk_fma_f32 v[56:57], v[88:89], v[40:41], v[48:49] op_sel:[0,0,0] op_sel_hi:[0,1,1]
    v_pk_fma_f32 v[58:59], v[90:91], v[42:43], v[50:51] op_sel:[0,0,0] op_sel_hi:[0,1,1]
    v_pk_fma_f32 v[60:61], v[92:93], v[44:45], v[52:53] op_sel:[0,0,0] op_sel_hi:[0,1,1]
    v_pk_fma_f32 v[62:63], v[94:95], v[46:47], v[54:55] op_sel:[0,0,0] op_sel_hi:[0,1,1]
    v_pk_fma_f32 v[40:41], v[88:89], v[40:41], v[56:57] op_sel:[1,1,0] op_sel_hi:[1,0,1] neg_lo:[1,0,0]
    v_pk_fma_f32 v[42:43], v[90:91], v[42:43], v[58:59] op_sel:[1,1,0] op_sel_hi:[1,0,1] neg_lo:[1,0,0]
    v_pk_fma_f32 v[44:45], v[92:93], v[44:45], v[60:61] op_sel:[1,1,0] op_sel_hi:[1,0,1] neg_lo:[1,0,0]
    v_pk_fma_f32 v[46:47], v[94:95], v[46:47], v[62:63] op_sel:[1,1,0] op_sel_hi:[1,0,1] neg_lo:[1,0,0]
    v_mov_b32 v64, v40
    v_mov_b32 v72, v40
    v_mov_b32 v65, v41
    v_mov_b32 v73, v41
    v_mov_b32 v66, v42
    v_mov_b32 v74, v42
    v_mov_b32 v67, v43
    v_mov_b32 v75, v43
    v_mov_b32 v68, v44
    v_mov_b32 v76, v44
    v_mov_b32 v69, v45
    v_mov_b32 v77, v45
    v_mov_b32 v70, v46
    v_mov_b32 v78, v46
    v_mov_b32 v71, v47
    v_mov_b32 v79, v47
    s_nop 1
    v_permlane16_swap_b32 v64, v72
    v_permlane16_swap_b32 v65, v73
    v_permlane16_swap_b32 v66, v74
    v_permlane16_swap_b32 v67, v75
    v_permlane16_swap_b32 v68, v76
    v_permlane16_swap_b32 v69, v77
    v_permlane16_swap_b32 v70, v78
    v_permlane16_swap_b32 v71, v79
    v_pk_fma_f32 v[56:57], v[104:105], v[64:65], v[72:73] op_sel:[0,0,0] op_sel_hi:[0,1,1]
    v_pk_fma_f32 v[58:59], v[106:107], v[66:67], v[74:75] op_sel:[0,0,0] op_sel_hi:[0,1,1]
    v_pk_fma_f32 v[60:61], v[108:109], v[68:69], v[76:77] op_sel:[0,0,0] op_sel_hi:[0,1,1]
    v_pk_fma_f32 v[62:63], v[110:111], v[70:71], v[78:79] op_sel:[0,0,0] op_sel_hi:[0,1,1]
    v_pk_fma_f32 v[80:81], v[104:105], v[64:65], v[56:57] op_sel:[1,1,0] op_sel_hi:[1,0,1] neg_lo:[1,0,0]
    v_pk_fma_f32 v[82:83], v[106:107], v[66:67], v[58:59] op_sel:[1,1,0] op_sel_hi:[1,0,1] neg_lo:[1,0,0]
    v_pk_fma_f32 v[84:85], v[108:109], v[68:69], v[60:61] op_sel:[1,1,0] op_sel_hi:[1,0,1] neg_lo:[1,0,0]
    v_pk_fma_f32 v[86:87], v[110:111], v[70:71], v[62:63] op_sel:[1,1,0] op_sel_hi:[1,0,1] neg_lo:[1,0,0]
    v_mov_b32 v24, v80
    v_mov_b32 v25, v81
    v_mov_b32 v26, v82
    v_mov_b32 v27, v83
    v_mov_b32 v28, v84
    v_mov_b32 v29, v85
    v_mov_b32 v30, v86
    v_mov_b32 v31, v87
    s_nop 1
    v_permlane32_swap_b32 v80, v24
    v_permlane32_swap_b32 v81, v25
    v_permlane32_swap_b32 v82, v26
    v_permlane32_swap_b32 v83, v27
    v_permlane32_swap_b32 v84, v28
    v_permlane32_swap_b32 v85, v29
    v_permlane32_swap_b32 v86, v30
    v_permlane32_swap_b32 v87, v31
    v_pk_fma_f32 v[56:57], v[112:113], v[80:81], v[24:25] op_sel:[0,0,0] op_sel_hi:[0,1,1]
    v_pk_fma_f32 v[58:59], v[114:115], v[82:83], v[26:27] op_sel:[0,0,0] op_sel_hi:[0,1,1]
    v_pk_fma_f32 v[60:61], v[116:117], v[84:85], v[28:29] op_sel:[0,0,0] op_sel_hi:[0,1,1]
    v_pk_fma_f32 v[62:63], v[118:119], v[86:87], v[30:31] op_sel:[0,0,0] op_sel_hi:[0,1,1]
    v_pk_fma_f32 v[40:41], v[112:113], v[80:81], v[56:57] op_sel:[1,1,0] op_sel_hi:[1,0,1] neg_lo:[1,0,0]
    v_pk_fma_f32 v[42:43], v[114:115], v[82:83], v[58:59] op_sel:[1,1,0] op_sel_hi:[1,0,1] neg_lo:[1,0,0]
    v_pk_fma_f32 v[44:45], v[116:117], v[84:85], v[60:61] op_sel:[1,1,0] op_sel_hi:[1,0,1] neg_lo:[1,0,0]
    v_pk_fma_f32 v[46:47], v[118:119], v[86:87], v[62:63] op_sel:[1,1,0] op_sel_hi:[1,0,1] neg_lo:[1,0,0]
    s_mov_b32 exec_lo, 0xffffffff
    s_mov_b32 exec_hi, 0xffffffff
    v_mov_b32 v122, v40
    v_mov_b32 v123, v41
    s_mov_b32 exec_lo, 0xffff0000
    s_mov_b32 exec_hi, 0xffffffff
    v_mov_b32 v122, v42
    v_mov_b32 v123, v43
    s_mov_b32 exec_lo, 0x0
    s_mov_b32 exec_hi, 0xffffffff
    v_mov_b32 v122, v44
    v_mov_b32 v123, v45
    s_mov_b32 exec_lo, 0x0
    s_mov_b32 exec_hi, 0xffff0000
    v_mov_b32 v122, v46
    v_mov_b32 v123, v47
    s_mov_b64 exec, -1
    s_and_b32 s53, s58, 1
    s_lshl1_add_u32 s53, s85, s53
    s_lshl_b32 s53, s53, 13
    s_lshr_b32 s29, s58, 1
    s_lshl1_add_u32 s29, s82, s29
    s_lshl_b32 s29, s29, 9
    s_add_u32 s53, s53, s29
    v_lshrrev_b32 v126, 1, v1
    v_add_u32 v126, s53, v126
    s_add_u32 s60, s100, 0xd100000
    s_addc_u32 s61, s101, 0
    s_and_b32 s61, s61, 0xffff
    s_mov_b32 s62, 0x20000
    s_mov_b32 s63, 0x00020000
    buffer_store_dwordx2 v[122:123], v126, s[60:63], 0 offen
    v_subrev_u32 v160, 8192, v126
    v_subrev_u32 v161, 16384, v126
    v_subrev_u32 v162, 24576, v126
    v_subrev_u32 v163, 32768, v126
    v_subrev_u32 v164, 40960, v126
    v_subrev_u32 v165, 49152, v126
    v_subrev_u32 v166, 57344, v126
    v_subrev_u32 v167, 65536, v126
    v_subrev_u32 v168, 73728, v126
    v_subrev_u32 v169, 81920, v126
    v_subrev_u32 v170, 90112, v126
    v_subrev_u32 v171, 98304, v126
    v_subrev_u32 v172, 106496, v126
    v_subrev_u32 v173, 114688, v126
    v_subrev_u32 v174, 122880, v126
    s_lshr_b32 s53, s82, 2
    s_add_u32 s53, s53, 1
    v_mov_b32 v177, s53
    s_lshl_b32 s50, s57, 2
    s_add_u32 s50, s50, 0xd200480
    v_mov_b32 v176, s50
    s_waitcnt vmcnt(0)
    s_barrier
    global_store_dword v176, v177, s[100:101]
    v_and_b32 v178, 7, v0
    v_min_u32 v178, s85, v178
    v_lshlrev_b32 v178, 4, v178
    v_sub_u32 v176, v176, v178
    s_mov_b32 s50, 0
L_lb_99:
    global_load_dword v178, v176, s[100:101] sc1
    s_add_u32 s50, s50, 1
    s_cmp_gt_u32 s50, 0x200000
    s_cbranch_scc1 chain_kernel_wabort
    s_waitcnt vmcnt(0)
    v_cmp_lt_u32 vcc, v178, v177
    s_cbranch_vccnz L_lb_99
    buffer_load_dwordx2 v[128:129], v160, s[60:63], 0 offen sc1
    buffer_load_dwordx2 v[130:131], v161, s[60:63], 0 offen sc1
    buffer_load_dwordx2 v[132:133], v162, s[60:63], 0 offen sc1
    buffer_load_dwordx2 v[134:135], v163, s[60:63], 0 offen sc1
    buffer_load_dwordx2 v[136:137], v164, s[60:63], 0 offen sc1
    buffer_load_dwordx2 v[138:139], v165, s[60:63], 0 offen sc1
    buffer_load_dwordx2 v[140:141], v166, s[60:63], 0 offen sc1
    buffer_load_dwordx2 v[142:143], v167, s[60:63], 0 offen sc1
    buffer_load_dwordx2 v[144:145], v168, s[60:63], 0 offen sc1
    buffer_load_dwordx2 v[146:147], v169, s[60:63], 0 offen sc1
    buffer_load_dwordx2 v[148:149], v170, s[60:63], 0 offen sc1
    buffer_load_dwordx2 v[150:151], v171, s[60:63], 0 offen sc1
    buffer_load_dwordx2 v[152:153], v172, s[60:63], 0 offen sc1
    buffer_load_dwordx2 v[154:155], v173, s[60:63], 0 offen sc1
    buffer_load_dwordx2 v[156:157], v174, s[60:63], 0 offen sc1
    s_waitcnt vmcnt(0)
    v_pk_fma_f32 v[56:57], v[120:121], v[156:157], v[154:155] op_sel:[0,0,0] op_sel_hi:[0,1,1]
    v_pk_fma_f32 v[154:155], v[120:121], v[156:157], v[56:57] op_sel:[1,1,0] op_sel_hi:[1,0,1] neg_lo:[1,0,0]
    v_pk_fma_f32 v[56:57], v[120:121], v[154:155], v[152:153] op_sel:[0,0,0] op_sel_hi:[0,1,1]
    v_pk_fma_f32 v[152:153], v[120:121], v[154:155], v[56:57] op_sel:[1,1,0] op_sel_hi:[1,0,1] neg_lo:[1,0,0]
    v_pk_fma_f32 v[56:57], v[120:121], v[152:153], v[150:151] op_sel:[0,0,0] op_sel_hi:[0,1,1]
    v_pk_fma_f32 v[150:151], v[120:121], v[152:153], v[56:57] op_sel:[1,1,0] op_sel_hi:[1,0,1] neg_lo:[1,0,0]
    v_pk_fma_f32 v[56:57], v[120:121], v[150:151], v[148:149] op_sel:[0,0,0] op_sel_hi:[0,1,1]
    v_pk_fma_f32 v[148:149], v[120:121], v[150:151], v[56:57] op_sel:[1,1,0] op_sel_hi:[1,0,1] neg_lo:[1,0,0]
    v_pk_fma_f32 v[56:57], v[120:121], v[148:149], v[146:147] op_sel:[0,0,0] op_sel_hi:[0,1,1]
    v_pk_fma_f32 v[146:147], v[120:121], v[148:149], v[56:57] op_sel:[1,1,0] op_sel_hi:[1,0,1] neg_lo:[1,0,0]
    v_pk_fma_f32 v[56:57], v[120:121], v[146:147], v[144:145] op_sel:[0,0,0] op_sel_hi:[0,1,1]
    v_pk_fma_f32 v[144:145], v[120:121], v[146:147], v[56:57] op_sel:[1,1,0] op_sel_hi:[1,0,1] neg_lo:[1,0,0]
    v_pk_fma_f32 v[56:57], v[120:121], v[144:145], v[142:143] op_sel:[0,0,0] op_sel_hi:[0,1,1]
    v_pk_fma_f32 v[142:143], v[120:121], v[144:145], v[56:57] op_sel:[1,1,0] op_sel_hi:[1,0,1] neg_lo:[1,0,0]
    v_pk_fma_f32 v[56:57], v[120:121], v[142:143], v[140:141] op_sel:[0,0,0] op_sel_hi:[0,1,1]
    v_pk_fma_f32 v[140:141], v[120:121], v[142:143], v[56:57] op_sel:[1,1,0] op_sel_hi:[1,0,1] neg_lo:[1,0,0]
    v_pk_fma_f32 v[56:57], v[120:121], v[140:141], v[138:139] op_sel:[0,0,0] op_sel_hi:[0,1,1]
    v_pk_fma_f32 v[138:139], v[120:121], v[140:141], v[56:57] op_sel:[1,1,0] op_sel_hi:[1,0,1] neg_lo:[1,0,0]
    v_pk_fma_f32 v[56:57], v[120:121], v[138:139], v[136:137] op_sel:[0,0,0] op_sel_hi:[0,1,1]
    v_pk_fma_f32 v[136:137], v[120:121], v[138:139], v[56:57] op_sel:[1,1,0] op_sel_hi:[1,0,1] neg_lo:[1,0,0]
    v_pk_fma_f32 v[56:57], v[120:121], v[136:137], v[134:135] op_sel:[0,0,0] op_sel_hi:[0,1,1]
    v_pk_fma_f32 v[134:135], v[120:121], v[136:137], v[56:57] op_sel:[1,1,0] op_sel_hi:[1,0,1] neg_lo:[1,0,0]
    v_pk_fma_f32 v[56:57], v[120:121], v[134:135], v[132:133] op_sel:[0,0,0] op_sel_hi:[0,1,1]
    v_pk_fma_f32 v[132:133], v[120:121], v[134:135], v[56:57] op_sel:[1,1,0] op_sel_hi:[1,0,1] neg_lo:[1,0,0]
    v_pk_fma_f32 v[56:57], v[120:121], v[132:133], v[130:131] op_sel:[0,0,0] op_sel_hi:[0,1,1]
    v_pk_fma_f32 v[130:131], v[120:121], v[132:133], v[56:57] op_sel:[1,1,0] op_sel_hi:[1,0,1] neg_lo:[1,0,0]
    v_pk_fma_f32 v[56:57], v[120:121], v[130:131], v[128:129] op_sel:[0,0,0] op_sel_hi:[0,1,1]
    v_pk_fma_f32 v[128:129], v[120:121], v[130:131], v[56:57] op_sel:[1,1,0] op_sel_hi:[1,0,1] neg_lo:[1,0,0]
    v_mov_b32 v32, v128
    v_mov_b32 v34, v128
    v_mov_b32 v33, v129
    v_mov_b32 v35, v129
    s_nop 1
    v_permlane16_swap_b32 v32, v34
    v_permlane16_swap_b32 v33, v35
    v_mov_b32 v36, v32
    v_mov_b32 v37, v33
    v_mov_b32 v38, v34
    v_mov_b32 v39, v35
    s_nop 1
    v_permlane32_swap_b32 v32, v36
    v_permlane32_swap_b32 v33, v37
    v_permlane32_swap_b32 v34, v38
    v_permlane32_swap_b32 v35, v39
    s_mov_b32 exec_lo, 0
    v_pk_fma_f32 v[56:57], v[112:113], v[32:33], v[80:81] op_sel:[0,0,0] op_sel_hi:[0,1,1]
    v_pk_fma_f32 v[58:59], v[114:115], v[34:35], v[82:83] op_sel:[0,0,0] op_sel_hi:[0,1,1]
    v_pk_fma_f32 v[60:61], v[116:117], v[36:37], v[84:85] op_sel:[0,0,0] op_sel_hi:[0,1,1]
    v_pk_fma_f32 v[62:63], v[118:119], v[38:39], v[86:87] op_sel:[0,0,0] op_sel_hi:[0,1,1]
    v_pk_fma_f32 v[32:33], v[112:113], v[32:33], v[56:57] op_sel:[1,1,0] op_sel_hi:[1,0,1] neg_lo:[1,0,0]
    v_pk_fma_f32 v[34:35], v[114:115], v[34:35], v[58:59] op_sel:[1,1,0] op_sel_hi:[1,0,1] neg_lo:[1,0,0]
    v_pk_fma_f32 v[36:37], v[116:117], v[36:37], v[60:61] op_sel:[1,1,0] op_sel_hi:[1,0,1] neg_lo:[1,0,0]
    v_pk_fma_f32 v[38:39], v[118:119], v[38:39], v[62:63] op_sel:[1,1,0] op_sel_hi:[1,0,1] neg_lo:[1,0,0]
    s_mov_b32 exec_lo, 0xffff0000
    s_mov_b32 exec_hi, 0xffff0000
    v_pk_fma_f32 v[56:57], v[104:105], v[32:33], v[64:65] op_sel:[0,0,0] op_sel_hi:[0,1,1]
    v_pk_fma_f32 v[58:59], v[106:107], v[34:35], v[66:67] op_sel:[0,0,0] op_sel_hi:[0,1,1]
    v_pk_fma_f32 v[60:61], v[108:109], v[36:37], v[68:69] op_sel:[0,0,0] op_sel_hi:[0,1,1]
    v_pk_fma_f32 v[62:63], v[110:111], v[38:39], v[70:71] op_sel:[0,0,0] op_sel_hi:[0,1,1]
    v_pk_fma_f32 v[32:33], v[104:105], v[32:33], v[56:57] op_sel:[1,1,0] op_sel_hi:[1,0,1] neg_lo:[1,0,0]
    v_pk_fma_f32 v[34:35], v[106:107], v[34:35], v[58:59] op_sel:[1,1,0] op_sel_hi:[1,0,1] neg_lo:[1,0,0]
    v_pk_fma_f32 v[36:37], v[108:109], v[36:37], v[60:61] op_sel:[1,1,0] op_sel_hi:[1,0,1] neg_lo:[1,0,0]
    v_pk_fma_f32 v[38:39], v[110:111], v[38:39], v[62:63] op_sel:[1,1,0] op_sel_hi:[1,0,1] neg_lo:[1,0,0]
    s_mov_b64 exec, -1
    v_accvgpr_read_b32 v64, a0
    v_accvgpr_read_b32 v66, a4
    v_accvgpr_read_b32 v68, a8
    v_accvgpr_read_b32 v70, a12
    v_accvgpr_read_b32 v65, a16
    v_accvgpr_read_b32 v67, a20
    v_accvgpr_read_b32 v69, a24
    v_accvgpr_read_b32 v71, a28
    v_pk_fma_f32 v[56:57], v[88:89], v[32:33], v[64:65] op_sel:[0,0,0] op_sel_hi:[0,1,1]
    v_pk_fma_f32 v[58:59], v[90:91], v[34:35], v[66:67] op_sel:[0,0,0] op_sel_hi:[0,1,1]
    v_pk_fma_f32 v[60:61], v[92:93], v[36:37], v[68:69] op_sel:[0,0,0] op_sel_hi:[0,1,1]
    v_pk_fma_f32 v[62:63], v[94:95], v[38:39], v[70:71] op_sel:[0,0,0] op_sel_hi:[0,1,1]
    v_pk_fma_f32 v[32:33], v[88:89], v[32:33], v[56:57] op_sel:[1,1,0] op_sel_hi:[1,0,1] neg_lo:[1,0,0]
    v_pk_fma_f32 v[34:35], v[90:91], v[34:35], v[58:59] op_sel:[1,1,0] op_sel_hi:[1,0,1] neg_lo:[1,0,0]
    v_pk_fma_f32 v[36:37], v[92:93], v[36:37], v[60:61] op_sel:[1,1,0] op_sel_hi:[1,0,1] neg_lo:[1,0,0]
    v_pk_fma_f32 v[38:39], v[94:95], v[38:39], v[62:63] op_sel:[1,1,0] op_sel_hi:[1,0,1] neg_lo:[1,0,0]
    v_pk_mul_f32 v[40:41], v[96:97], v[32:33] op_sel:[0,0] op_sel_hi:[0,1]
    v_pk_mul_f32 v[42:43], v[98:99], v[34:35] op_sel:[0,0] op_sel_hi:[0,1]
    v_pk_mul_f32 v[44:45], v[100:101], v[36:37] op_sel:[0,0] op_sel_hi:[0,1]
    v_pk_mul_f32 v[46:47], v[102:103], v[38:39] op_sel:[0,0] op_sel_hi:[0,1]
    v_pk_fma_f32 v[72:73], v[96:97], v[32:33], v[40:41] op_sel:[1,1,0] op_sel_hi:[1,0,1] neg_lo:[1,0,0] neg_hi:[1,0,1]
    v_pk_fma_f32 v[74:75], v[98:99], v[34:35], v[42:43] op_sel:[1,1,0] op_sel_hi:[1,0,1] neg_lo:[1,0,0] neg_hi:[1,0,1]
    v_pk_fma_f32 v[76:77], v[100:101], v[36:37], v[44:45] op_sel:[1,1,0] op_sel_hi:[1,0,1] neg_lo:[1,0,0] neg_hi:[1,0,1]
    v_pk_fma_f32 v[78:79], v[102:103], v[38:39], v[46:47] op_sel:[1,1,0] op_sel_hi:[1,0,1] neg_lo:[1,0,0] neg_hi:[1,0,1]
    v_accvgpr_read_b32 v48, a1
    v_accvgpr_read_b32 v50, a5
    v_accvgpr_read_b32 v52, a9
    v_accvgpr_read_b32 v54, a13
    v_accvgpr_read_b32 v49, a17
    v_accvgpr_read_b32 v51, a21
    v_accvgpr_read_b32 v53, a25
    v_accvgpr_read_b32 v55, a29
    v_pk_fma_f32 v[56:57], v[88:89], v[32:33], v[48:49] op_sel:[0,0,0] op_sel_hi:[0,1,1]
    v_pk_fma_f32 v[58:59], v[90:91], v[34:35], v[50:51] op_sel:[0,0,0] op_sel_hi:[0,1,1]
    v_pk_fma_f32 v[60:61], v[92:93], v[36:37], v[52:53] op_sel:[0,0,0] op_sel_hi:[0,1,1]
    v_pk_fma_f32 v[62:63], v[94:95], v[38:39], v[54:55] op_sel:[0,0,0] op_sel_hi:[0,1,1]
    v_pk_fma_f32 v[32:33], v[88:89], v[32:33], v[56:57] op_sel:[1,1,0] op_sel_hi:[1,0,1] neg_lo:[1,0,0]
    v_pk_fma_f32 v[34:35], v[90:91], v[34:35], v[58:59] op_sel:[1,1,0] op_sel_hi:[1,0,1] neg_lo:[1,0,0]
    v_pk_fma_f32 v[36:37], v[92:93], v[36:37], v[60:61] op_sel:[1,1,0] op_sel_hi:[1,0,1] neg_lo:[1,0,0]
    v_pk_fma_f32 v[38:39], v[94:95], v[38:39], v[62:63] op_sel:[1,1,0] op_sel_hi:[1,0,1] neg_lo:[1,0,0]
    v_pk_mul_f32 v[40:41], v[96:97], v[32:33] op_sel:[0,0] op_sel_hi:[0,1]
    v_pk_mul_f32 v[42:43], v[98:99], v[34:35] op_sel:[0,0] op_sel_hi:[0,1]
    v_pk_mul_f32 v[44:45], v[100:101], v[36:37] op_sel:[0,0] op_sel_hi:[0,1]
    v_pk_mul_f32 v[46:47], v[102:103], v[38:39] op_sel:[0,0] op_sel_hi:[0,1]
    v_pk_fma_f32 v[80:81], v[96:97], v[32:33], v[40:41] op_sel:[1,1,0] op_sel_hi:[1,0,1] neg_lo:[1,0,0] neg_hi:[1,0,1]
    v_pk_fma_f32 v[82:83], v[98:99], v[34:35], v[42:43] op_sel:[1,1,0] op_sel_hi:[1,0,1] neg_lo:[1,0,0] neg_hi:[1,0,1]
    v_pk_fma_f32 v[84:85], v[100:101], v[36:37], v[44:45] op_sel:[1,1,0] op_sel_hi:[1,0,1] neg_lo:[1,0,0] neg_hi:[1,0,1]
    v_pk_fma_f32 v[86:87], v[102:103], v[38:39], v[46:47] op_sel:[1,1,0] op_sel_hi:[1,0,1] neg_lo:[1,0,0] neg_hi:[1,0,1]
    v_cvt_pk_bf16_f32 v128, v72, v80
    v_cvt_pk_bf16_f32 v136, v74, v82
    v_cvt_pk_bf16_f32 v144, v76, v84
    v_cvt_pk_bf16_f32 v152, v78, v86
    v_cvt_pk_bf16_f32 v192, v73, v81
    v_cvt_pk_bf16_f32 v200, v75, v83
    v_cvt_pk_bf16_f32 v208, v77, v85
    v_cvt_pk_bf16_f32 v216, v79, v87
    v_accvgpr_read_b32 v64, a2
    v_accvgpr_read_b32 v66, a6
    v_accvgpr_read_b32 v68, a10
    v_accvgpr_read_b32 v70, a14
    v_accvgpr_read_b32 v65, a18
    v_accvgpr_read_b32 v67, a22
    v_accvgpr_read_b32 v69, a26
    v_accvgpr_read_b32 v71, a30
    v_pk_fma_f32 v[56:57], v[88:89], v[32:33], v[64:65] op_sel:[0,0,0] op_sel_hi:[0,1,1]
    v_pk_fma_f32 v[58:59], v[90:91], v[34:35], v[66:67] op_sel:[0,0,0] op_sel_hi:[0,1,1]
    v_pk_fma_f32 v[60:61], v[92:93], v[36:37], v[68:69] op_sel:[0,0,0] op_sel_hi:[0,1,1]
    v_pk_fma_f32 v[62:63], v[94:95], v[38:39], v[70:71] op_sel:[0,0,0] op_sel_hi:[0,1,1]
    v_pk_fma_f32 v[32:33], v[88:89], v[32:33], v[56:57] op_sel:[1,1,0] op_sel_hi:[1,0,1] neg_lo:[1,0,0]
    v_pk_fma_f32 v[34:35], v[90:91], v[34:35], v[58:59] op_sel:[1,1,0] op_sel_hi:[1,0,1] neg_lo:[1,0,0]
    v_pk_fma_f32 v[36:37], v[92:93], v[36:37], v[60:61] op_sel:[1,1,0] op_sel_hi:[1,0,1] neg_lo:[1,0,0]
    v_pk_fma_f32 v[38:39], v[94:95], v[38:39], v[62:63] op_sel:[1,1,0] op_sel_hi:[1,0,1] neg_lo:[1,0,0]
    v_pk_mul_f32 v[40:41], v[96:97], v[32:33] op_sel:[0,0] op_sel_hi:[0,1]
    v_pk_mul_f32 v[42:43], v[98:99], v[34:35] op_sel:[0,0] op_sel_hi:[0,1]
    v_pk_mul_f32 v[44:45], v[100:101], v[36:37] op_sel:[0,0] op_sel_hi:[0,1]
    v_pk_mul_f32 v[46:47], v[102:103], v[38:39] op_sel:[0,0] op_sel_hi:[0,1]
    v_pk_fma_f32 v[72:73], v[96:97], v[32:33], v[40:41] op_sel:[1,1,0] op_sel_hi:[1,0,1] neg_lo:[1,0,0] neg_hi:[1,0,1]
    v_pk_fma_f32 v[74:75], v[98:99], v[34:35], v[42:43] op_sel:[1,1,0] op_sel_hi:[1,0,1] neg_lo:[1,0,0] neg_hi:[1,0,1]
    v_pk_fma_f32 v[76:77], v[100:101], v[36:37], v[44:45] op_sel:[1,1,0] op_sel_hi:[1,0,1] neg_lo:[1,0,0] neg_hi:[1,0,1]
    v_pk_fma_f32 v[78:79], v[102:103], v[38:39], v[46:47] op_sel:[1,1,0] op_sel_hi:[1,0,1] neg_lo:[1,0,0] neg_hi:[1,0,1]
    v_accvgpr_read_b32 v48, a3
    v_accvgpr_read_b32 v50, a7
    v_accvgpr_read_b32 v52, a11
    v_accvgpr_read_b32 v54, a15
    v_accvgpr_read_b32 v49, a19
    v_accvgpr_read_b32 v51, a23
    v_accvgpr_read_b32 v53, a27
    v_accvgpr_read_b32 v55, a31
    v_pk_fma_f32 v[56:57], v[88:89], v[32:33], v[48:49] op_sel:[0,0,0] op_sel_hi:[0,1,1]
    v_pk_fma_f32 v[58:59], v[90:91], v[34:35], v[50:51] op_sel:[0,0,0] op_sel_hi:[0,1,1]
    v_pk_fma_f32 v[60:61], v[92:93], v[36:37], v[52:53] op_sel:[0,0,0] op_sel_hi:[0,1,1]
    v_pk_fma_f32 v[62:63], v[94:95], v[38:39], v[54:55] op_sel:[0,0,0] op_sel_hi:[0,1,1]
    v_pk_fma_f32 v[32:33], v[88:89], v[32:33], v[56:57] op_sel:[1,1,0] op_sel_hi:[1,0,1] neg_lo:[1,0,0]
    v_pk_fma_f32 v[34:35], v[90:91], v[34:35], v[58:59] op_sel:[1,1,0] op_sel_hi:[1,0,1] neg_lo:[1,0,0]
    v_pk_fma_f32 v[36:37], v[92:93], v[36:37], v[60:61] op_sel:[1,1,0] op_sel_hi:[1,0,1] neg_lo:[1,0,0]
    v_pk_fma_f32 v[38:39], v[94:95], v[38:39], v[62:63] op_sel:[1,1,0] op_sel_hi:[1,0,1] neg_lo:[1,0,0]
    v_pk_mul_f32 v[40:41], v[96:97], v[32:33] op_sel:[0,0] op_sel_hi:[0,1]
    v_pk_mul_f32 v[42:43], v[98:99], v[34:35] op_sel:[0,0] op_sel_hi:[0,1]
    v_pk_mul_f32 v[44:45], v[100:101], v[36:37] op_sel:[0,0] op_sel_hi:[0,1]
    v_pk_mul_f32 v[46:47], v[102:103], v[38:39] op_sel:[0,0] op_sel_hi:[0,1]
    v_pk_fma_f32 v[80:81], v[96:97], v[32:33], v[40:41] op_sel:[1,1,0] op_sel_hi:[1,0,1] neg_lo:[1,0,0] neg_hi:[1,0,1]
    v_pk_fma_f32 v[82:83], v[98:99], v[34:35], v[42:43] op_sel:[1,1,0] op_sel_hi:[1,0,1] neg_lo:[1,0,0] neg_hi:[1,0,1]
    v_pk_fma_f32 v[84:85], v[100:101], v[36:37], v[44:45] op_sel:[1,1,0] op_sel_hi:[1,0,1] neg_lo:[1,0,0] neg_hi:[1,0,1]
    v_pk_fma_f32 v[86:87], v[102:103], v[38:39], v[46:47] op_sel:[1,1,0] op_sel_hi:[1,0,1] neg_lo:[1,0,0] neg_hi:[1,0,1]
    v_cvt_pk_bf16_f32 v129, v72, v80
    v_cvt_pk_bf16_f32 v137, v74, v82
    v_cvt_pk_bf16_f32 v145, v76, v84
    v_cvt_pk_bf16_f32 v153, v78, v86
    v_cvt_pk_bf16_f32 v193, v73, v81
    v_cvt_pk_bf16_f32 v201, v75, v83
    v_cvt_pk_bf16_f32 v209, v77, v85
    v_cvt_pk_bf16_f32 v217, v79, v87
    v_accvgpr_read_b32 v64, a32
    v_accvgpr_read_b32 v66, a36
    v_accvgpr_read_b32 v68, a40
    v_accvgpr_read_b32 v70, a44
    v_accvgpr_read_b32 v65, a48
    v_accvgpr_read_b32 v67, a52
    v_accvgpr_read_b32 v69, a56
    v_accvgpr_read_b32 v71, a60
    v_pk_fma_f32 v[56:57], v[88:89], v[32:33], v[64:65] op_sel:[0,0,0] op_sel_hi:[0,1,1]
    v_pk_fma_f32 v[58:59], v[90:91], v[34:35], v[66:67] op_sel:[0,0,0] op_sel_hi:[0,1,1]
    v_pk_fma_f32 v[60:61], v[92:93], v[36:37], v[68:69] op_sel:[0,0,0] op_sel_hi:[0,1,1]
    v_pk_fma_f32 v[62:63], v[94:95], v[38:39], v[70:71] op_sel:[0,0,0] op_sel_hi:[0,1,1]
    v_pk_fma_f32 v[32:33], v[88:89], v[32:33], v[56:57] op_sel:[1,1,0] op_sel_hi:[1,0,1] neg_lo:[1,0,0]
    v_pk_fma_f32 v[34:35], v[90:91], v[34:35], v[58:59] op_sel:[1,1,0] op_sel_hi:[1,0,1] neg_lo:[1,0,0]
    v_pk_fma_f32 v[36:37], v[92:93], v[36:37], v[60:61] op_sel:[1,1,0] op_sel_hi:[1,0,1] neg_lo:[1,0,0]
    v_pk_fma_f32 v[38:39], v[94:95], v[38:39], v[62:63] op_sel:[1,1,0] op_sel_hi:[1,0,1] neg_lo:[1,0,0]
    v_pk_mul_f32 v[40:41], v[96:97], v[32:33] op_sel:[0,0] op_sel_hi:[0,1]
    v_pk_mul_f32 v[42:43], v[98:99], v[34:35] op_sel:[0,0] op_sel_hi:[0,1]
    v_pk_mul_f32 v[44:45], v[100:101], v[36:37] op_sel:[0,0] op_sel_hi:[0,1]
    v_pk_mul_f32 v[46:47], v[102:103], v[38:39] op_sel:[0,0] op_sel_hi:[0,1]
    v_pk_fma_f32 v[72:73], v[96:97], v[32:33], v[40:41] op_sel:[1,1,0] op_sel_hi:[1,0,1] neg_lo:[1,0,0] neg_hi:[1,0,1]
    v_pk_fma_f32 v[74:75], v[98:99], v[34:35], v[42:43] op_sel:[1,1,0] op_sel_hi:[1,0,1] neg_lo:[1,0,0] neg_hi:[1,0,1]
    v_pk_fma_f32 v[76:77], v[100:101], v[36:37], v[44:45] op_sel:[1,1,0] op_sel_hi:[1,0,1] neg_lo:[1,0,0] neg_hi:[1,0,1]
    v_pk_fma_f32 v[78:79], v[102:103], v[38:39], v[46:47] op_sel:[1,1,0] op_sel_hi:[1,0,1] neg_lo:[1,0,0] neg_hi:[1,0,1]
    v_accvgpr_read_b32 v48, a33
    v_accvgpr_read_b32 v50, a37
    v_accvgpr_read_b32 v52, a41
    v_accvgpr_read_b32 v54, a45
    v_accvgpr_read_b32 v49, a49
    v_accvgpr_read_b32 v51, a53
    v_accvgpr_read_b32 v53, a57
    v_accvgpr_read_b32 v55, a61
    v_pk_fma_f32 v[56:57], v[88:89], v[32:33], v[48:49] op_sel:[0,0,0] op_sel_hi:[0,1,1]
    v_pk_fma_f32 v[58:59], v[90:91], v[34:35], v[50:51] op_sel:[0,0,0] op_sel_hi:[0,1,1]
    v_pk_fma_f32 v[60:61], v[92:93], v[36:37], v[52:53] op_sel:[0,0,0] op_sel_hi:[0,1,1]
    v_pk_fma_f32 v[62:63], v[94:95], v[38:39], v[54:55] op_sel:[0,0,0] op_sel_hi:[0,1,1]
    v_pk_fma_f32 v[32:33], v[88:89], v[32:33], v[56:57] op_sel:[1,1,0] op_sel_hi:[1,0,1] neg_lo:[1,0,0]
    v_pk_fma_f32 v[34:35], v[90:91], v[34:35], v[58:59] op_sel:[1,1,0] op_sel_hi:[1,0,1] neg_lo:[1,0,0]
    v_pk_fma_f32 v[36:37], v[92:93], v[36:37], v[60:61] op_sel:[1,1,0] op_sel_hi:[1,0,1] neg_lo:[1,0,0]
    v_pk_fma_f32 v[38:39], v[94:95], v[38:39], v[62:63] op_sel:[1,1,0] op_sel_hi:[1,0,1] neg_lo:[1,0,0]
    v_pk_mul_f32 v[40:41], v[96:97], v[32:33] op_sel:[0,0] op_sel_hi:[0,1]
    v_pk_mul_f32 v[42:43], v[98:99], v[34:35] op_sel:[0,0] op_sel_hi:[0,1]
    v_pk_mul_f32 v[44:45], v[100:101], v[36:37] op_sel:[0,0] op_sel_hi:[0,1]
    v_pk_mul_f32 v[46:47], v[102:103], v[38:39] op_sel:[0,0] op_sel_hi:[0,1]
    v_pk_fma_f32 v[80:81], v[96:97], v[32:33], v[40:41] op_sel:[1,1,0] op_sel_hi:[1,0,1] neg_lo:[1,0,0] neg_hi:[1,0,1]
    v_pk_fma_f32 v[82:83], v[98:99], v[34:35], v[42:43] op_sel:[1,1,0] op_sel_hi:[1,0,1] neg_lo:[1,0,0] neg_hi:[1,0,1]
    v_pk_fma_f32 v[84:85], v[100:101], v[36:37], v[44:45] op_sel:[1,1,0] op_sel_hi:[1,0,1] neg_lo:[1,0,0] neg_hi:[1,0,1]
    v_pk_fma_f32 v[86:87], v[102:103], v[38:39], v[46:47] op_sel:[1,1,0] op_sel_hi:[1,0,1] neg_lo:[1,0,0] neg_hi:[1,0,1]
    v_cvt_pk_bf16_f32 v130, v72, v80
    v_cvt_pk_bf16_f32 v138, v74, v82
    v_cvt_pk_bf16_f32 v146, v76, v84
    v_cvt_pk_bf16_f32 v154, v78, v86
    v_cvt_pk_bf16_f32 v194, v73, v81
    v_cvt_pk_bf16_f32 v202, v75, v83
    v_cvt_pk_bf16_f32 v210, v77, v85
    v_cvt_pk_bf16_f32 v218, v79, v87
    v_accvgpr_read_b32 v64, a34
    v_accvgpr_read_b32 v66, a38
    v_accvgpr_read_b32 v68, a42
    v_accvgpr_read_b32 v70, a46
    v_accvgpr_read_b32 v65, a50
    v_accvgpr_read_b32 v67, a54
    v_accvgpr_read_b32 v69, a58
    v_accvgpr_read_b32 v71, a62
    v_pk_fma_f32 v[56:57], v[88:89], v[32:33], v[64:65] op_sel:[0,0,0] op_sel_hi:[0,1,1]
    v_pk_fma_f32 v[58:59], v[90:91], v[34:35], v[66:67] op_sel:[0,0,0] op_sel_hi:[0,1,1]
    v_pk_fma_f32 v[60:61], v[92:93], v[36:37], v[68:69] op_sel:[0,0,0] op_sel_hi:[0,1,1]
    v_pk_fma_f32 v[62:63], v[94:95], v[38:39], v[70:71] op_sel:[0,0,0] op_sel_hi:[0,1,1]
    v_pk_fma_f32 v[32:33], v[88:89], v[32:33], v[56:57] op_sel:[1,1,0] op_sel_hi:[1,0,1] neg_lo:[1,0,0]
    v_pk_fma_f32 v[34:35], v[90:91], v[34:35], v[58:59] op_sel:[1,1,0] op_sel_hi:[1,0,1] neg_lo:[1,0,0]
    v_pk_fma_f32 v[36:37], v[92:93], v[36:37], v[60:61] op_sel:[1,1,0] op_sel_hi:[1,0,1] neg_lo:[1,0,0]
    v_pk_fma_f32 v[38:39], v[94:95], v[38:39], v[62:63] op_sel:[1,1,0] op_sel_hi:[1,0,1] neg_lo:[1,0,0]
    v_pk_mul_f32 v[40:41], v[96:97], v[32:33] op_sel:[0,0] op_sel_hi:[0,1]
    v_pk_mul_f32 v[42:43], v[98:99], v[34:35] op_sel:[0,0] op_sel_hi:[0,1]
    v_pk_mul_f32 v[44:45], v[100:101], v[36:37] op_sel:[0,0] op_sel_hi:[0,1]
    v_pk_mul_f32 v[46:47], v[102:103], v[38:39] op_sel:[0,0] op_sel_hi:[0,1]
    v_pk_fma_f32 v[72:73], v[96:97], v[32:33], v[40:41] op_sel:[1,1,0] op_sel_hi:[1,0,1] neg_lo:[1,0,0] neg_hi:[1,0,1]
    v_pk_fma_f32 v[74:75], v[98:99], v[34:35], v[42:43] op_sel:[1,1,0] op_sel_hi:[1,0,1] neg_lo:[1,0,0] neg_hi:[1,0,1]
    v_pk_fma_f32 v[76:77], v[100:101], v[36:37], v[44:45] op_sel:[1,1,0] op_sel_hi:[1,0,1] neg_lo:[1,0,0] neg_hi:[1,0,1]
    v_pk_fma_f32 v[78:79], v[102:103], v[38:39], v[46:47] op_sel:[1,1,0] op_sel_hi:[1,0,1] neg_lo:[1,0,0] neg_hi:[1,0,1]
    v_accvgpr_read_b32 v48, a35
    v_accvgpr_read_b32 v50, a39
    v_accvgpr_read_b32 v52, a43
    v_accvgpr_read_b32 v54, a47
    v_accvgpr_read_b32 v49, a51
    v_accvgpr_read_b32 v51, a55
    v_accvgpr_read_b32 v53, a59
    v_accvgpr_read_b32 v55, a63
    v_pk_fma_f32 v[56:57], v[88:89], v[32:33], v[48:49] op_sel:[0,0,0] op_sel_hi:[0,1,1]
    v_pk_fma_f32 v[58:59], v[90:91], v[34:35], v[50:51] op_sel:[0,0,0] op_sel_hi:[0,1,1]
    v_pk_fma_f32 v[60:61], v[92:93], v[36:37], v[52:53] op_sel:[0,0,0] op_sel_hi:[0,1,1]
    v_pk_fma_f32 v[62:63], v[94:95], v[38:39], v[54:55] op_sel:[0,0,0] op_sel_hi:[0,1,1]
    v_pk_fma_f32 v[32:33], v[88:89], v[32:33], v[56:57] op_sel:[1,1,0] op_sel_hi:[1,0,1] neg_lo:[1,0,0]
    v_pk_fma_f32 v[34:35], v[90:91], v[34:35], v[58:59] op_sel:[1,1,0] op_sel_hi:[1,0,1] neg_lo:[1,0,0]
    v_pk_fma_f32 v[36:37], v[92:93], v[36:37], v[60:61] op_sel:[1,1,0] op_sel_hi:[1,0,1] neg_lo:[1,0,0]
    v_pk_fma_f32 v[38:39], v[94:95], v[38:39], v[62:63] op_sel:[1,1,0] op_sel_hi:[1,0,1] neg_lo:[1,0,0]
    v_pk_mul_f32 v[40:41], v[96:97], v[32:33] op_sel:[0,0] op_sel_hi:[0,1]
    v_pk_mul_f32 v[42:43], v[98:99], v[34:35] op_sel:[0,0] op_sel_hi:[0,1]
    v_pk_mul_f32 v[44:45], v[100:101], v[36:37] op_sel:[0,0] op_sel_hi:[0,1]
    v_pk_mul_f32 v[46:47], v[102:103], v[38:39] op_sel:[0,0] op_sel_hi:[0,1]
    v_pk_fma_f32 v[80:81], v[96:97], v[32:33], v[40:41] op_sel:[1,1,0] op_sel_hi:[1,0,1] neg_lo:[1,0,0] neg_hi:[1,0,1]
    v_pk_fma_f32 v[82:83], v[98:99], v[34:35], v[42:43] op_sel:[1,1,0] op_sel_hi:[1,0,1] neg_lo:[1,0,0] neg_hi:[1,0,1]
    v_pk_fma_f32 v[84:85], v[100:101], v[36:37], v[44:45] op_sel:[1,1,0] op_sel_hi:[1,0,1] neg_lo:[1,0,0] neg_hi:[1,0,1]
    v_pk_fma_f32 v[86:87], v[102:103], v[38:39], v[46:47] op_sel:[1,1,0] op_sel_hi:[1,0,1] neg_lo:[1,0,0] neg_hi:[1,0,1]
    v_cvt_pk_bf16_f32 v131, v72, v80
    v_cvt_pk_bf16_f32 v139, v74, v82
    v_cvt_pk_bf16_f32 v147, v76, v84
    v_cvt_pk_bf16_f32 v155, v78, v86
    v_cvt_pk_bf16_f32 v195, v73, v81
    v_cvt_pk_bf16_f32 v203, v75, v83
    v_cvt_pk_bf16_f32 v211, v77, v85
    v_cvt_pk_bf16_f32 v219, v79, v87
    v_accvgpr_read_b32 v64, a64
    v_accvgpr_read_b32 v66, a68
    v_accvgpr_read_b32 v68, a72
    v_accvgpr_read_b32 v70, a76
    v_accvgpr_read_b32 v65, a80
    v_accvgpr_read_b32 v67, a84
    v_accvgpr_read_b32 v69, a88
    v_accvgpr_read_b32 v71, a92
    v_pk_fma_f32 v[56:57], v[88:89], v[32:33], v[64:65] op_sel:[0,0,0] op_sel_hi:[0,1,1]
    v_pk_fma_f32 v[58:59], v[90:91], v[34:35], v[66:67] op_sel:[0,0,0] op_sel_hi:[0,1,1]
    v_pk_fma_f32 v[60:61], v[92:93], v[36:37], v[68:69] op_sel:[0,0,0] op_sel_hi:[0,1,1]
    v_pk_fma_f32 v[62:63], v[94:95], v[38:39], v[70:71] op_sel:[0,0,0] op_sel_hi:[0,1,1]
    v_pk_fma_f32 v[32:33], v[88:89], v[32:33], v[56:57] op_sel:[1,1,0] op_sel_hi:[1,0,1] neg_lo:[1,0,0]
    v_pk_fma_f32 v[34:35], v[90:91], v[34:35], v[58:59] op_sel:[1,1,0] op_sel_hi:[1,0,1] neg_lo:[1,0,0]
    v_pk_fma_f32 v[36:37], v[92:93], v[36:37], v[60:61] op_sel:[1,1,0] op_sel_hi:[1,0,1] neg_lo:[1,0,0]
    v_pk_fma_f32 v[38:39], v[94:95], v[38:39], v[62:63] op_sel:[1,1,0] op_sel_hi:[1,0,1] neg_lo:[1,0,0]
    v_pk_mul_f32 v[40:41], v[96:97], v[32:33] op_sel:[0,0] op_sel_hi:[0,1]
    v_pk_mul_f32 v[42:43], v[98:99], v[34:35] op_sel:[0,0] op_sel_hi:[0,1]
    v_pk_mul_f32 v[44:45], v[100:101], v[36:37] op_sel:[0,0] op_sel_hi:[0,1]
    v_pk_mul_f32 v[46:47], v[102:103], v[38:39] op_sel:[0,0] op_sel_hi:[0,1]
    v_pk_fma_f32 v[72:73], v[96:97], v[32:33], v[40:41] op_sel:[1,1,0] op_sel_hi:[1,0,1] neg_lo:[1,0,0] neg_hi:[1,0,1]
    v_pk_fma_f32 v[74:75], v[98:99], v[34:35], v[42:43] op_sel:[1,1,0] op_sel_hi:[1,0,1] neg_lo:[1,0,0] neg_hi:[1,0,1]
    v_pk_fma_f32 v[76:77], v[100:101], v[36:37], v[44:45] op_sel:[1,1,0] op_sel_hi:[1,0,1] neg_lo:[1,0,0] neg_hi:[1,0,1]
    v_pk_fma_f32 v[78:79], v[102:103], v[38:39], v[46:47] op_sel:[1,1,0] op_sel_hi:[1,0,1] neg_lo:[1,0,0] neg_hi:[1,0,1]
    v_accvgpr_read_b32 v48, a65
    v_accvgpr_read_b32 v50, a69
    v_accvgpr_read_b32 v52, a73
    v_accvgpr_read_b32 v54, a77
    v_accvgpr_read_b32 v49, a81
    v_accvgpr_read_b32 v51, a85
    v_accvgpr_read_b32 v53, a89
    v_accvgpr_read_b32 v55, a93
    v_pk_fma_f32 v[56:57], v[88:89], v[32:33], v[48:49] op_sel:[0,0,0] op_sel_hi:[0,1,1]
    v_pk_fma_f32 v[58:59], v[90:91], v[34:35], v[50:51] op_sel:[0,0,0] op_sel_hi:[0,1,1]
    v_pk_fma_f32 v[60:61], v[92:93], v[36:37], v[52:53] op_sel:[0,0,0] op_sel_hi:[0,1,1]
    v_pk_fma_f32 v[62:63], v[94:95], v[38:39], v[54:55] op_sel:[0,0,0] op_sel_hi:[0,1,1]
    v_pk_fma_f32 v[32:33], v[88:89], v[32:33], v[56:57] op_sel:[1,1,0] op_sel_hi:[1,0,1] neg_lo:[1,0,0]
    v_pk_fma_f32 v[34:35], v[90:91], v[34:35], v[58:59] op_sel:[1,1,0] op_sel_hi:[1,0,1] neg_lo:[1,0,0]
    v_pk_fma_f32 v[36:37], v[92:93], v[36:37], v[60:61] op_sel:[1,1,0] op_sel_hi:[1,0,1] neg_lo:[1,0,0]
    v_pk_fma_f32 v[38:39], v[94:95], v[38:39], v[62:63] op_sel:[1,1,0] op_sel_hi:[1,0,1] neg_lo:[1,0,0]
    v_pk_mul_f32 v[40:41], v[96:97], v[32:33] op_sel:[0,0] op_sel_hi:[0,1]
    v_pk_mul_f32 v[42:43], v[98:99], v[34:35] op_sel:[0,0] op_sel_hi:[0,1]
    v_pk_mul_f32 v[44:45], v[100:101], v[36:37] op_sel:[0,0] op_sel_hi:[0,1]
    v_pk_mul_f32 v[46:47], v[102:103], v[38:39] op_sel:[0,0] op_sel_hi:[0,1]
    v_pk_fma_f32 v[80:81], v[96:97], v[32:33], v[40:41] op_sel:[1,1,0] op_sel_hi:[1,0,1] neg_lo:[1,0,0] neg_hi:[1,0,1]
    v_pk_fma_f32 v[82:83], v[98:99], v[34:35], v[42:43] op_sel:[1,1,0] op_sel_hi:[1,0,1] neg_lo:[1,0,0] neg_hi:[1,0,1]
    v_pk_fma_f32 v[84:85], v[100:101], v[36:37], v[44:45] op_sel:[1,1,0] op_sel_hi:[1,0,1] neg_lo:[1,0,0] neg_hi:[1,0,1]
    v_pk_fma_f32 v[86:87], v[102:103], v[38:39], v[46:47] op_sel:[1,1,0] op_sel_hi:[1,0,1] neg_lo:[1,0,0] neg_hi:[1,0,1]
    v_cvt_pk_bf16_f32 v132, v72, v80
    v_cvt_pk_bf16_f32 v140, v74, v82
    v_cvt_pk_bf16_f32 v148, v76, v84
    v_cvt_pk_bf16_f32 v156, v78, v86
    v_cvt_pk_bf16_f32 v196, v73, v81
    v_cvt_pk_bf16_f32 v204, v75, v83
    v_cvt_pk_bf16_f32 v212, v77, v85
    v_cvt_pk_bf16_f32 v220, v79, v87
    v_accvgpr_read_b32 v64, a66
    v_accvgpr_read_b32 v66, a70
    v_accvgpr_read_b32 v68, a74
    v_accvgpr_read_b32 v70, a78
    v_accvgpr_read_b32 v65, a82
    v_accvgpr_read_b32 v67, a86
    v_accvgpr_read_b32 v69, a90
    v_accvgpr_read_b32 v71, a94
    v_pk_fma_f32 v[56:57], v[88:89], v[32:33], v[64:65] op_sel:[0,0,0] op_sel_hi:[0,1,1]
    v_pk_fma_f32 v[58:59], v[90:91], v[34:35], v[66:67] op_sel:[0,0,0] op_sel_hi:[0,1,1]
    v_pk_fma_f32 v[60:61], v[92:93], v[36:37], v[68:69] op_sel:[0,0,0] op_sel_hi:[0,1,1]
    v_pk_fma_f32 v[62:63], v[94:95], v[38:39], v[70:71] op_sel:[0,0,0] op_sel_hi:[0,1,1]
    v_pk_fma_f32 v[32:33], v[88:89], v[32:33], v[56:57] op_sel:[1,1,0] op_sel_hi:[1,0,1] neg_lo:[1,0,0]
    v_pk_fma_f32 v[34:35], v[90:91], v[34:35], v[58:59] op_sel:[1,1,0] op_sel_hi:[1,0,1] neg_lo:[1,0,0]
    v_pk_fma_f32 v[36:37], v[92:93], v[36:37], v[60:61] op_sel:[1,1,0] op_sel_hi:[1,0,1] neg_lo:[1,0,0]
    v_pk_fma_f32 v[38:39], v[94:95], v[38:39], v[62:63] op_sel:[1,1,0] op_sel_hi:[1,0,1] neg_lo:[1,0,0]
    v_pk_mul_f32 v[40:41], v[96:97], v[32:33] op_sel:[0,0] op_sel_hi:[0,1]
    v_pk_mul_f32 v[42:43], v[98:99], v[34:35] op_sel:[0,0] op_sel_hi:[0,1]
    v_pk_mul_f32 v[44:45], v[100:101], v[36:37] op_sel:[0,0] op_sel_hi:[0,1]
    v_pk_mul_f32 v[46:47], v[102:103], v[38:39] op_sel:[0,0] op_sel_hi:[0,1]
    v_pk_fma_f32 v[72:73], v[96:97], v[32:33], v[40:41] op_sel:[1,1,0] op_sel_hi:[1,0,1] neg_lo:[1,0,0] neg_hi:[1,0,1]
    v_pk_fma_f32 v[74:75], v[98:99], v[34:35], v[42:43] op_sel:[1,1,0] op_sel_hi:[1,0,1] neg_lo:[1,0,0] neg_hi:[1,0,1]
    v_pk_fma_f32 v[76:77], v[100:101], v[36:37], v[44:45] op_sel:[1,1,0] op_sel_hi:[1,0,1] neg_lo:[1,0,0] neg_hi:[1,0,1]
    v_pk_fma_f32 v[78:79], v[102:103], v[38:39], v[46:47] op_sel:[1,1,0] op_sel_hi:[1,0,1] neg_lo:[1,0,0] neg_hi:[1,0,1]
    v_accvgpr_read_b32 v48, a67
    v_accvgpr_read_b32 v50, a71
    v_accvgpr_read_b32 v52, a75
    v_accvgpr_read_b32 v54, a79
    v_accvgpr_read_b32 v49, a83
    v_accvgpr_read_b32 v51, a87
    v_accvgpr_read_b32 v53, a91
    v_accvgpr_read_b32 v55, a95
    v_pk_fma_f32 v[56:57], v[88:89], v[32:33], v[48:49] op_sel:[0,0,0] op_sel_hi:[0,1,1]
    v_pk_fma_f32 v[58:59], v[90:91], v[34:35], v[50:51] op_sel:[0,0,0] op_sel_hi:[0,1,1]
    v_pk_fma_f32 v[60:61], v[92:93], v[36:37], v[52:53] op_sel:[0,0,0] op_sel_hi:[0,1,1]
    v_pk_fma_f32 v[62:63], v[94:95], v[38:39], v[54:55] op_sel:[0,0,0] op_sel_hi:[0,1,1]
    v_pk_fma_f32 v[32:33], v[88:89], v[32:33], v[56:57] op_sel:[1,1,0] op_sel_hi:[1,0,1] neg_lo:[1,0,0]
    v_pk_fma_f32 v[34:35], v[90:91], v[34:35], v[58:59] op_sel:[1,1,0] op_sel_hi:[1,0,1] neg_lo:[1,0,0]
    v_pk_fma_f32 v[36:37], v[92:93], v[36:37], v[60:61] op_sel:[1,1,0] op_sel_hi:[1,0,1] neg_lo:[1,0,0]
    v_pk_fma_f32 v[38:39], v[94:95], v[38:39], v[62:63] op_sel:[1,1,0] op_sel_hi:[1,0,1] neg_lo:[1,0,0]
    v_pk_mul_f32 v[40:41], v[96:97], v[32:33] op_sel:[0,0] op_sel_hi:[0,1]
    v_pk_mul_f32 v[42:43], v[98:99], v[34:35] op_sel:[0,0] op_sel_hi:[0,1]
    v_pk_mul_f32 v[44:45], v[100:101], v[36:37] op_sel:[0,0] op_sel_hi:[0,1]
    v_pk_mul_f32 v[46:47], v[102:103], v[38:39] op_sel:[0,0] op_sel_hi:[0,1]
    v_pk_fma_f32 v[80:81], v[96:97], v[32:33], v[40:41] op_sel:[1,1,0] op_sel_hi:[1,0,1] neg_lo:[1,0,0] neg_hi:[1,0,1]
    v_pk_fma_f32 v[82:83], v[98:99], v[34:35], v[42:43] op_sel:[1,1,0] op_sel_hi:[1,0,1] neg_lo:[1,0,0] neg_hi:[1,0,1]
    v_pk_fma_f32 v[84:85], v[100:101], v[36:37], v[44:45] op_sel:[1,1,0] op_sel_hi:[1,0,1] neg_lo:[1,0,0] neg_hi:[1,0,1]
    v_pk_fma_f32 v[86:87], v[102:103], v[38:39], v[46:47] op_sel:[1,1,0] op_sel_hi:[1,0,1] neg_lo:[1,0,0] neg_hi:[1,0,1]
    v_cvt_pk_bf16_f32 v133, v72, v80
    v_cvt_pk_bf16_f32 v141, v74, v82
    v_cvt_pk_bf16_f32 v149, v76, v84
    v_cvt_pk_bf16_f32 v157, v78, v86
    v_cvt_pk_bf16_f32 v197, v73, v81
    v_cvt_pk_bf16_f32 v205, v75, v83
    v_cvt_pk_bf16_f32 v213, v77, v85
    v_cvt_pk_bf16_f32 v221, v79, v87
    v_accvgpr_read_b32 v64, a96
    v_accvgpr_read_b32 v66, a100
    v_accvgpr_read_b32 v68, a104
    v_accvgpr_read_b32 v70, a108
    v_accvgpr_read_b32 v65, a112
    v_accvgpr_read_b32 v67, a116
    v_accvgpr_read_b32 v69, a120
    v_accvgpr_read_b32 v71, a124
    v_pk_fma_f32 v[56:57], v[88:89], v[32:33], v[64:65] op_sel:[0,0,0] op_sel_hi:[0,1,1]
    v_pk_fma_f32 v[58:59], v[90:91], v[34:35], v[66:67] op_sel:[0,0,0] op_sel_hi:[0,1,1]
    v_pk_fma_f32 v[60:61], v[92:93], v[36:37], v[68:69] op_sel:[0,0,0] op_sel_hi:[0,1,1]
    v_pk_fma_f32 v[62:63], v[94:95], v[38:39], v[70:71] op_sel:[0,0,0] op_sel_hi:[0,1,1]
    v_pk_fma_f32 v[32:33], v[88:89], v[32:33], v[56:57] op_sel:[1,1,0] op_sel_hi:[1,0,1] neg_lo:[1,0,0]
    v_pk_fma_f32 v[34:35], v[90:91], v[34:35], v[58:59] op_sel:[1,1,0] op_sel_hi:[1,0,1] neg_lo:[1,0,0]
    v_pk_fma_f32 v[36:37], v[92:93], v[36:37], v[60:61] op_sel:[1,1,0] op_sel_hi:[1,0,1] neg_lo:[1,0,0]
    v_pk_fma_f32 v[38:39], v[94:95], v[38:39], v[62:63] op_sel:[1,1,0] op_sel_hi:[1,0,1] neg_lo:[1,0,0]
    v_pk_mul_f32 v[40:41], v[96:97], v[32:33] op_sel:[0,0] op_sel_hi:[0,1]
    v_pk_mul_f32 v[42:43], v[98:99], v[34:35] op_sel:[0,0] op_sel_hi:[0,1]
    v_pk_mul_f32 v[44:45], v[100:101], v[36:37] op_sel:[0,0] op_sel_hi:[0,1]
    v_pk_mul_f32 v[46:47], v[102:103], v[38:39] op_sel:[0,0] op_sel_hi:[0,1]
    v_pk_fma_f32 v[72:73], v[96:97], v[32:33], v[40:41] op_sel:[1,1,0] op_sel_hi:[1,0,1] neg_lo:[1,0,0] neg_hi:[1,0,1]
    v_pk_fma_f32 v[74:75], v[98:99], v[34:35], v[42:43] op_sel:[1,1,0] op_sel_hi:[1,0,1] neg_lo:[1,0,0] neg_hi:[1,0,1]
    v_pk_fma_f32 v[76:77], v[100:101], v[36:37], v[44:45] op_sel:[1,1,0] op_sel_hi:[1,0,1] neg_lo:[1,0,0] neg_hi:[1,0,1]
    v_pk_fma_f32 v[78:79], v[102:103], v[38:39], v[46:47] op_sel:[1,1,0] op_sel_hi:[1,0,1] neg_lo:[1,0,0] neg_hi:[1,0,1]
    v_accvgpr_read_b32 v48, a97
    v_accvgpr_read_b32 v50, a101
    v_accvgpr_read_b32 v52, a105
    v_accvgpr_read_b32 v54, a109
    v_accvgpr_read_b32 v49, a113
    v_accvgpr_read_b32 v51, a117
    v_accvgpr_read_b32 v53, a121
    v_accvgpr_read_b32 v55, a125
    v_pk_fma_f32 v[56:57], v[88:89], v[32:33], v[48:49] op_sel:[0,0,0] op_sel_hi:[0,1,1]
    v_pk_fma_f32 v[58:59], v[90:91], v[34:35], v[50:51] op_sel:[0,0,0] op_sel_hi:[0,1,1]
    v_pk_fma_f32 v[60:61], v[92:93], v[36:37], v[52:53] op_sel:[0,0,0] op_sel_hi:[0,1,1]
    v_pk_fma_f32 v[62:63], v[94:95], v[38:39], v[54:55] op_sel:[0,0,0] op_sel_hi:[0,1,1]
    v_pk_fma_f32 v[32:33], v[88:89], v[32:33], v[56:57] op_sel:[1,1,0] op_sel_hi:[1,0,1] neg_lo:[1,0,0]
    v_pk_fma_f32 v[34:35], v[90:91], v[34:35], v[58:59] op_sel:[1,1,0] op_sel_hi:[1,0,1] neg_lo:[1,0,0]
    v_pk_fma_f32 v[36:37], v[92:93], v[36:37], v[60:61] op_sel:[1,1,0] op_sel_hi:[1,0,1] neg_lo:[1,0,0]
    v_pk_fma_f32 v[38:39], v[94:95], v[38:39], v[62:63] op_sel:[1,1,0] op_sel_hi:[1,0,1] neg_lo:[1,0,0]
    v_pk_mul_f32 v[40:41], v[96:97], v[32:33] op_sel:[0,0] op_sel_hi:[0,1]
    v_pk_mul_f32 v[42:43], v[98:99], v[34:35] op_sel:[0,0] op_sel_hi:[0,1]
    v_pk_mul_f32 v[44:45], v[100:101], v[36:37] op_sel:[0,0] op_sel_hi:[0,1]
    v_pk_mul_f32 v[46:47], v[102:103], v[38:39] op_sel:[0,0] op_sel_hi:[0,1]
    v_pk_fma_f32 v[80:81], v[96:97], v[32:33], v[40:41] op_sel:[1,1,0] op_sel_hi:[1,0,1] neg_lo:[1,0,0] neg_hi:[1,0,1]
    v_pk_fma_f32 v[82:83], v[98:99], v[34:35], v[42:43] op_sel:[1,1,0] op_sel_hi:[1,0,1] neg_lo:[1,0,0] neg_hi:[1,0,1]
    v_pk_fma_f32 v[84:85], v[100:101], v[36:37], v[44:45] op_sel:[1,1,0] op_sel_hi:[1,0,1] neg_lo:[1,0,0] neg_hi:[1,0,1]
    v_pk_fma_f32 v[86:87], v[102:103], v[38:39], v[46:47] op_sel:[1,1,0] op_sel_hi:[1,0,1] neg_lo:[1,0,0] neg_hi:[1,0,1]
    v_cvt_pk_bf16_f32 v134, v72, v80
    v_cvt_pk_bf16_f32 v142, v74, v82
    v_cvt_pk_bf16_f32 v150, v76, v84
    v_cvt_pk_bf16_f32 v158, v78, v86
    v_cvt_pk_bf16_f32 v198, v73, v81
    v_cvt_pk_bf16_f32 v206, v75, v83
    v_cvt_pk_bf16_f32 v214, v77, v85
    v_cvt_pk_bf16_f32 v222, v79, v87
    v_accvgpr_read_b32 v64, a98
    v_accvgpr_read_b32 v66, a102
    v_accvgpr_read_b32 v68, a106
    v_accvgpr_read_b32 v70, a110
    v_accvgpr_read_b32 v65, a114
    v_accvgpr_read_b32 v67, a118
    v_accvgpr_read_b32 v69, a122
    v_accvgpr_read_b32 v71, a126
    v_pk_fma_f32 v[56:57], v[88:89], v[32:33], v[64:65] op_sel:[0,0,0] op_sel_hi:[0,1,1]
    v_pk_fma_f32 v[58:59], v[90:91], v[34:35], v[66:67] op_sel:[0,0,0] op_sel_hi:[0,1,1]
    v_pk_fma_f32 v[60:61], v[92:93], v[36:37], v[68:69] op_sel:[0,0,0] op_sel_hi:[0,1,1]
    v_pk_fma_f32 v[62:63], v[94:95], v[38:39], v[70:71] op_sel:[0,0,0] op_sel_hi:[0,1,1]
    v_pk_fma_f32 v[32:33], v[88:89], v[32:33], v[56:57] op_sel:[1,1,0] op_sel_hi:[1,0,1] neg_lo:[1,0,0]
    v_pk_fma_f32 v[34:35], v[90:91], v[34:35], v[58:59] op_sel:[1,1,0] op_sel_hi:[1,0,1] neg_lo:[1,0,0]
    v_pk_fma_f32 v[36:37], v[92:93], v[36:37], v[60:61] op_sel:[1,1,0] op_sel_hi:[1,0,1] neg_lo:[1,0,0]
    v_pk_fma_f32 v[38:39], v[94:95], v[38:39], v[62:63] op_sel:[1,1,0] op_sel_hi:[1,0,1] neg_lo:[1,0,0]
    v_pk_mul_f32 v[40:41], v[96:97], v[32:33] op_sel:[0,0] op_sel_hi:[0,1]
    v_pk_mul_f32 v[42:43], v[98:99], v[34:35] op_sel:[0,0] op_sel_hi:[0,1]
    v_pk_mul_f32 v[44:45], v[100:101], v[36:37] op_sel:[0,0] op_sel_hi:[0,1]
    v_pk_mul_f32 v[46:47], v[102:103], v[38:39] op_sel:[0,0] op_sel_hi:[0,1]
    v_pk_fma_f32 v[72:73], v[96:97], v[32:33], v[40:41] op_sel:[1,1,0] op_sel_hi:[1,0,1] neg_lo:[1,0,0] neg_hi:[1,0,1]
    v_pk_fma_f32 v[74:75], v[98:99], v[34:35], v[42:43] op_sel:[1,1,0] op_sel_hi:[1,0,1] neg_lo:[1,0,0] neg_hi:[1,0,1]
    v_pk_fma_f32 v[76:77], v[100:101], v[36:37], v[44:45] op_sel:[1,1,0] op_sel_hi:[1,0,1] neg_lo:[1,0,0] neg_hi:[1,0,1]
    v_pk_fma_f32 v[78:79], v[102:103], v[38:39], v[46:47] op_sel:[1,1,0] op_sel_hi:[1,0,1] neg_lo:[1,0,0] neg_hi:[1,0,1]
    v_accvgpr_read_b32 v48, a99
    v_accvgpr_read_b32 v50, a103
    v_accvgpr_read_b32 v52, a107
    v_accvgpr_read_b32 v54, a111
    v_accvgpr_read_b32 v49, a115
    v_accvgpr_read_b32 v51, a119
    v_accvgpr_read_b32 v53, a123
    v_accvgpr_read_b32 v55, a127
    v_pk_fma_f32 v[56:57], v[88:89], v[32:33], v[48:49] op_sel:[0,0,0] op_sel_hi:[0,1,1]
    v_pk_fma_f32 v[58:59], v[90:91], v[34:35], v[50:51] op_sel:[0,0,0] op_sel_hi:[0,1,1]
    v_pk_fma_f32 v[60:61], v[92:93], v[36:37], v[52:53] op_sel:[0,0,0] op_sel_hi:[0,1,1]
    v_pk_fma_f32 v[62:63], v[94:95], v[38:39], v[54:55] op_sel:[0,0,0] op_sel_hi:[0,1,1]
    v_pk_fma_f32 v[32:33], v[88:89], v[32:33], v[56:57] op_sel:[1,1,0] op_sel_hi:[1,0,1] neg_lo:[1,0,0]
    v_pk_fma_f32 v[34:35], v[90:91], v[34:35], v[58:59] op_sel:[1,1,0] op_sel_hi:[1,0,1] neg_lo:[1,0,0]
    v_pk_fma_f32 v[36:37], v[92:93], v[36:37], v[60:61] op_sel:[1,1,0] op_sel_hi:[1,0,1] neg_lo:[1,0,0]
    v_pk_fma_f32 v[38:39], v[94:95], v[38:39], v[62:63] op_sel:[1,1,0] op_sel_hi:[1,0,1] neg_lo:[1,0,0]
    v_pk_mul_f32 v[40:41], v[96:97], v[32:33] op_sel:[0,0] op_sel_hi:[0,1]
    v_pk_mul_f32 v[42:43], v[98:99], v[34:35] op_sel:[0,0] op_sel_hi:[0,1]
    v_pk_mul_f32 v[44:45], v[100:101], v[36:37] op_sel:[0,0] op_sel_hi:[0,1]
    v_pk_mul_f32 v[46:47], v[102:103], v[38:39] op_sel:[0,0] op_sel_hi:[0,1]
    v_pk_fma_f32 v[80:81], v[96:97], v[32:33], v[40:41] op_sel:[1,1,0] op_sel_hi:[1,0,1] neg_lo:[1,0,0] neg_hi:[1,0,1]
    v_pk_fma_f32 v[82:83], v[98:99], v[34:35], v[42:43] op_sel:[1,1,0] op_sel_hi:[1,0,1] neg_lo:[1,0,0] neg_hi:[1,0,1]
    v_pk_fma_f32 v[84:85], v[100:101], v[36:37], v[44:45] op_sel:[1,1,0] op_sel_hi:[1,0,1] neg_lo:[1,0,0] neg_hi:[1,0,1]
    v_pk_fma_f32 v[86:87], v[102:103], v[38:39], v[46:47] op_sel:[1,1,0] op_sel_hi:[1,0,1] neg_lo:[1,0,0] neg_hi:[1,0,1]
    v_cvt_pk_bf16_f32 v135, v72, v80
    v_cvt_pk_bf16_f32 v143, v74, v82
    v_cvt_pk_bf16_f32 v151, v76, v84
    v_cvt_pk_bf16_f32 v159, v78, v86
    v_cvt_pk_bf16_f32 v199, v73, v81
    v_cvt_pk_bf16_f32 v207, v75, v83
    v_cvt_pk_bf16_f32 v215, v77, v85
    v_cvt_pk_bf16_f32 v223, v79, v87
    v_accvgpr_read_b32 v64, a128
    v_accvgpr_read_b32 v66, a132
    v_accvgpr_read_b32 v68, a136
    v_accvgpr_read_b32 v70, a140
    v_accvgpr_read_b32 v65, a144
    v_accvgpr_read_b32 v67, a148
    v_accvgpr_read_b32 v69, a152
    v_accvgpr_read_b32 v71, a156
    v_pk_fma_f32 v[56:57], v[88:89], v[32:33], v[64:65] op_sel:[0,0,0] op_sel_hi:[0,1,1]
    v_pk_fma_f32 v[58:59], v[90:91], v[34:35], v[66:67] op_sel:[0,0,0] op_sel_hi:[0,1,1]
    v_pk_fma_f32 v[60:61], v[92:93], v[36:37], v[68:69] op_sel:[0,0,0] op_sel_hi:[0,1,1]
    v_pk_fma_f32 v[62:63], v[94:95], v[38:39], v[70:71] op_sel:[0,0,0] op_sel_hi:[0,1,1]
    v_pk_fma_f32 v[32:33], v[88:89], v[32:33], v[56:57] op_sel:[1,1,0] op_sel_hi:[1,0,1] neg_lo:[1,0,0]
    v_pk_fma_f32 v[34:35], v[90:91], v[34:35], v[58:59] op_sel:[1,1,0] op_sel_hi:[1,0,1] neg_lo:[1,0,0]
    v_pk_fma_f32 v[36:37], v[92:93], v[36:37], v[60:61] op_sel:[1,1,0] op_sel_hi:[1,0,1] neg_lo:[1,0,0]
    v_pk_fma_f32 v[38:39], v[94:95], v[38:39], v[62:63] op_sel:[1,1,0] op_sel_hi:[1,0,1] neg_lo:[1,0,0]
    v_pk_mul_f32 v[40:41], v[96:97], v[32:33] op_sel:[0,0] op_sel_hi:[0,1]
    v_pk_mul_f32 v[42:43], v[98:99], v[34:35] op_sel:[0,0] op_sel_hi:[0,1]
    v_pk_mul_f32 v[44:45], v[100:101], v[36:37] op_sel:[0,0] op_sel_hi:[0,1]
    v_pk_mul_f32 v[46:47], v[102:103], v[38:39] op_sel:[0,0] op_sel_hi:[0,1]
    v_pk_fma_f32 v[72:73], v[96:97], v[32:33], v[40:41] op_sel:[1,1,0] op_sel_hi:[1,0,1] neg_lo:[1,0,0] neg_hi:[1,0,1]
    v_pk_fma_f32 v[74:75], v[98:99], v[34:35], v[42:43] op_sel:[1,1,0] op_sel_hi:[1,0,1] neg_lo:[1,0,0] neg_hi:[1,0,1]
    v_pk_fma_f32 v[76:77], v[100:101], v[36:37], v[44:45] op_sel:[1,1,0] op_sel_hi:[1,0,1] neg_lo:[1,0,0] neg_hi:[1,0,1]
    v_pk_fma_f32 v[78:79], v[102:103], v[38:39], v[46:47] op_sel:[1,1,0] op_sel_hi:[1,0,1] neg_lo:[1,0,0] neg_hi:[1,0,1]
    v_accvgpr_read_b32 v48, a129
    v_accvgpr_read_b32 v50, a133
    v_accvgpr_read_b32 v52, a137
    v_accvgpr_read_b32 v54, a141
    v_accvgpr_read_b32 v49, a145
    v_accvgpr_read_b32 v51, a149
    v_accvgpr_read_b32 v53, a153
    v_accvgpr_read_b32 v55, a157
    v_pk_fma_f32 v[56:57], v[88:89], v[32:33], v[48:49] op_sel:[0,0,0] op_sel_hi:[0,1,1]
    v_pk_fma_f32 v[58:59], v[90:91], v[34:35], v[50:51] op_sel:[0,0,0] op_sel_hi:[0,1,1]
    v_pk_fma_f32 v[60:61], v[92:93], v[36:37], v[52:53] op_sel:[0,0,0] op_sel_hi:[0,1,1]
    v_pk_fma_f32 v[62:63], v[94:95], v[38:39], v[54:55] op_sel:[0,0,0] op_sel_hi:[0,1,1]
    v_pk_fma_f32 v[32:33], v[88:89], v[32:33], v[56:57] op_sel:[1,1,0] op_sel_hi:[1,0,1] neg_lo:[1,0,0]
    v_pk_fma_f32 v[34:35], v[90:91], v[34:35], v[58:59] op_sel:[1,1,0] op_sel_hi:[1,0,1] neg_lo:[1,0,0]
    v_pk_fma_f32 v[36:37], v[92:93], v[36:37], v[60:61] op_sel:[1,1,0] op_sel_hi:[1,0,1] neg_lo:[1,0,0]
    v_pk_fma_f32 v[38:39], v[94:95], v[38:39], v[62:63] op_sel:[1,1,0] op_sel_hi:[1,0,1] neg_lo:[1,0,0]
    v_pk_mul_f32 v[40:41], v[96:97], v[32:33] op_sel:[0,0] op_sel_hi:[0,1]
    v_pk_mul_f32 v[42:43], v[98:99], v[34:35] op_sel:[0,0] op_sel_hi:[0,1]
    v_pk_mul_f32 v[44:45], v[100:101], v[36:37] op_sel:[0,0] op_sel_hi:[0,1]
    v_pk_mul_f32 v[46:47], v[102:103], v[38:39] op_sel:[0,0] op_sel_hi:[0,1]
    v_pk_fma_f32 v[80:81], v[96:97], v[32:33], v[40:41] op_sel:[1,1,0] op_sel_hi:[1,0,1] neg_lo:[1,0,0] neg_hi:[1,0,1]
    v_pk_fma_f32 v[82:83], v[98:99], v[34:35], v[42:43] op_sel:[1,1,0] op_sel_hi:[1,0,1] neg_lo:[1,0,0] neg_hi:[1,0,1]
    v_pk_fma_f32 v[84:85], v[100:101], v[36:37], v[44:45] op_sel:[1,1,0] op_sel_hi:[1,0,1] neg_lo:[1,0,0] neg_hi:[1,0,1]
    v_pk_fma_f32 v[86:87], v[102:103], v[38:39], v[46:47] op_sel:[1,1,0] op_sel_hi:[1,0,1] neg_lo:[1,0,0] neg_hi:[1,0,1]
    v_cvt_pk_bf16_f32 v160, v72, v80
    v_cvt_pk_bf16_f32 v168, v74, v82
    v_cvt_pk_bf16_f32 v176, v76, v84
    v_cvt_pk_bf16_f32 v184, v78, v86
    v_cvt_pk_bf16_f32 v224, v73, v81
    v_cvt_pk_bf16_f32 v232, v75, v83
    v_cvt_pk_bf16_f32 v240, v77, v85
    v_cvt_pk_bf16_f32 v248, v79, v87
    v_accvgpr_read_b32 v64, a130
    v_accvgpr_read_b32 v66, a134
    v_accvgpr_read_b32 v68, a138
    v_accvgpr_read_b32 v70, a142
    v_accvgpr_read_b32 v65, a146
    v_accvgpr_read_b32 v67, a150
    v_accvgpr_read_b32 v69, a154
    v_accvgpr_read_b32 v71, a158
    v_pk_fma_f32 v[56:57], v[88:89], v[32:33], v[64:65] op_sel:[0,0,0] op_sel_hi:[0,1,1]
    v_pk_fma_f32 v[58:59], v[90:91], v[34:35], v[66:67] op_sel:[0,0,0] op_sel_hi:[0,1,1]
    v_pk_fma_f32 v[60:61], v[92:93], v[36:37], v[68:69] op_sel:[0,0,0] op_sel_hi:[0,1,1]
    v_pk_fma_f32 v[62:63], v[94:95], v[38:39], v[70:71] op_sel:[0,0,0] op_sel_hi:[0,1,1]
    v_pk_fma_f32 v[32:33], v[88:89], v[32:33], v[56:57] op_sel:[1,1,0] op_sel_hi:[1,0,1] neg_lo:[1,0,0]
    v_pk_fma_f32 v[34:35], v[90:91], v[34:35], v[58:59] op_sel:[1,1,0] op_sel_hi:[1,0,1] neg_lo:[1,0,0]
    v_pk_fma_f32 v[36:37], v[92:93], v[36:37], v[60:61] op_sel:[1,1,0] op_sel_hi:[1,0,1] neg_lo:[1,0,0]
    v_pk_fma_f32 v[38:39], v[94:95], v[38:39], v[62:63] op_sel:[1,1,0] op_sel_hi:[1,0,1] neg_lo:[1,0,0]
    v_pk_mul_f32 v[40:41], v[96:97], v[32:33] op_sel:[0,0] op_sel_hi:[0,1]
    v_pk_mul_f32 v[42:43], v[98:99], v[34:35] op_sel:[0,0] op_sel_hi:[0,1]
    v_pk_mul_f32 v[44:45], v[100:101], v[36:37] op_sel:[0,0] op_sel_hi:[0,1]
    v_pk_mul_f32 v[46:47], v[102:103], v[38:39] op_sel:[0,0] op_sel_hi:[0,1]
    v_pk_fma_f32 v[72:73], v[96:97], v[32:33], v[40:41] op_sel:[1,1,0] op_sel_hi:[1,0,1] neg_lo:[1,0,0] neg_hi:[1,0,1]
    v_pk_fma_f32 v[74:75], v[98:99], v[34:35], v[42:43] op_sel:[1,1,0] op_sel_hi:[1,0,1] neg_lo:[1,0,0] neg_hi:[1,0,1]
    v_pk_fma_f32 v[76:77], v[100:101], v[36:37], v[44:45] op_sel:[1,1,0] op_sel_hi:[1,0,1] neg_lo:[1,0,0] neg_hi:[1,0,1]
    v_pk_fma_f32 v[78:79], v[102:103], v[38:39], v[46:47] op_sel:[1,1,0] op_sel_hi:[1,0,1] neg_lo:[1,0,0] neg_hi:[1,0,1]
    v_accvgpr_read_b32 v48, a131
    v_accvgpr_read_b32 v50, a135
    v_accvgpr_read_b32 v52, a139
    v_accvgpr_read_b32 v54, a143
    v_accvgpr_read_b32 v49, a147
    v_accvgpr_read_b32 v51, a151
    v_accvgpr_read_b32 v53, a155
    v_accvgpr_read_b32 v55, a159
    v_pk_fma_f32 v[56:57], v[88:89], v[32:33], v[48:49] op_sel:[0,0,0] op_sel_hi:[0,1,1]
    v_pk_fma_f32 v[58:59], v[90:91], v[34:35], v[50:51] op_sel:[0,0,0] op_sel_hi:[0,1,1]
    v_pk_fma_f32 v[60:61], v[92:93], v[36:37], v[52:53] op_sel:[0,0,0] op_sel_hi:[0,1,1]
    v_pk_fma_f32 v[62:63], v[94:95], v[38:39], v[54:55] op_sel:[0,0,0] op_sel_hi:[0,1,1]
    v_pk_fma_f32 v[32:33], v[88:89], v[32:33], v[56:57] op_sel:[1,1,0] op_sel_hi:[1,0,1] neg_lo:[1,0,0]
    v_pk_fma_f32 v[34:35], v[90:91], v[34:35], v[58:59] op_sel:[1,1,0] op_sel_hi:[1,0,1] neg_lo:[1,0,0]
    v_pk_fma_f32 v[36:37], v[92:93], v[36:37], v[60:61] op_sel:[1,1,0] op_sel_hi:[1,0,1] neg_lo:[1,0,0]
    v_pk_fma_f32 v[38:39], v[94:95], v[38:39], v[62:63] op_sel:[1,1,0] op_sel_hi:[1,0,1] neg_lo:[1,0,0]
    v_pk_mul_f32 v[40:41], v[96:97], v[32:33] op_sel:[0,0] op_sel_hi:[0,1]
    v_pk_mul_f32 v[42:43], v[98:99], v[34:35] op_sel:[0,0] op_sel_hi:[0,1]
    v_pk_mul_f32 v[44:45], v[100:101], v[36:37] op_sel:[0,0] op_sel_hi:[0,1]
    v_pk_mul_f32 v[46:47], v[102:103], v[38:39] op_sel:[0,0] op_sel_hi:[0,1]
    v_pk_fma_f32 v[80:81], v[96:97], v[32:33], v[40:41] op_sel:[1,1,0] op_sel_hi:[1,0,1] neg_lo:[1,0,0] neg_hi:[1,0,1]
    v_pk_fma_f32 v[82:83], v[98:99], v[34:35], v[42:43] op_sel:[1,1,0] op_sel_hi:[1,0,1] neg_lo:[1,0,0] neg_hi:[1,0,1]
    v_pk_fma_f32 v[84:85], v[100:101], v[36:37], v[44:45] op_sel:[1,1,0] op_sel_hi:[1,0,1] neg_lo:[1,0,0] neg_hi:[1,0,1]
    v_pk_fma_f32 v[86:87], v[102:103], v[38:39], v[46:47] op_sel:[1,1,0] op_sel_hi:[1,0,1] neg_lo:[1,0,0] neg_hi:[1,0,1]
    v_cvt_pk_bf16_f32 v161, v72, v80
    v_cvt_pk_bf16_f32 v169, v74, v82
    v_cvt_pk_bf16_f32 v177, v76, v84
    v_cvt_pk_bf16_f32 v185, v78, v86
    v_cvt_pk_bf16_f32 v225, v73, v81
    v_cvt_pk_bf16_f32 v233, v75, v83
    v_cvt_pk_bf16_f32 v241, v77, v85
    v_cvt_pk_bf16_f32 v249, v79, v87
    v_accvgpr_read_b32 v64, a160
    v_accvgpr_read_b32 v66, a164
    v_accvgpr_read_b32 v68, a168
    v_accvgpr_read_b32 v70, a172
    v_accvgpr_read_b32 v65, a176
    v_accvgpr_read_b32 v67, a180
    v_accvgpr_read_b32 v69, a184
    v_accvgpr_read_b32 v71, a188
    v_pk_fma_f32 v[56:57], v[88:89], v[32:33], v[64:65] op_sel:[0,0,0] op_sel_hi:[0,1,1]
    v_pk_fma_f32 v[58:59], v[90:91], v[34:35], v[66:67] op_sel:[0,0,0] op_sel_hi:[0,1,1]
    v_pk_fma_f32 v[60:61], v[92:93], v[36:37], v[68:69] op_sel:[0,0,0] op_sel_hi:[0,1,1]
    v_pk_fma_f32 v[62:63], v[94:95], v[38:39], v[70:71] op_sel:[0,0,0] op_sel_hi:[0,1,1]
    v_pk_fma_f32 v[32:33], v[88:89], v[32:33], v[56:57] op_sel:[1,1,0] op_sel_hi:[1,0,1] neg_lo:[1,0,0]
    v_pk_fma_f32 v[34:35], v[90:91], v[34:35], v[58:59] op_sel:[1,1,0] op_sel_hi:[1,0,1] neg_lo:[1,0,0]
    v_pk_fma_f32 v[36:37], v[92:93], v[36:37], v[60:61] op_sel:[1,1,0] op_sel_hi:[1,0,1] neg_lo:[1,0,0]
    v_pk_fma_f32 v[38:39], v[94:95], v[38:39], v[62:63] op_sel:[1,1,0] op_sel_hi:[1,0,1] neg_lo:[1,0,0]
    v_pk_mul_f32 v[40:41], v[96:97], v[32:33] op_sel:[0,0] op_sel_hi:[0,1]
    v_pk_mul_f32 v[42:43], v[98:99], v[34:35] op_sel:[0,0] op_sel_hi:[0,1]
    v_pk_mul_f32 v[44:45], v[100:101], v[36:37] op_sel:[0,0] op_sel_hi:[0,1]
    v_pk_mul_f32 v[46:47], v[102:103], v[38:39] op_sel:[0,0] op_sel_hi:[0,1]
    v_pk_fma_f32 v[72:73], v[96:97], v[32:33], v[40:41] op_sel:[1,1,0] op_sel_hi:[1,0,1] neg_lo:[1,0,0] neg_hi:[1,0,1]
    v_pk_fma_f32 v[74:75], v[98:99], v[34:35], v[42:43] op_sel:[1,1,0] op_sel_hi:[1,0,1] neg_lo:[1,0,0] neg_hi:[1,0,1]
    v_pk_fma_f32 v[76:77], v[100:101], v[36:37], v[44:45] op_sel:[1,1,0] op_sel_hi:[1,0,1] neg_lo:[1,0,0] neg_hi:[1,0,1]
    v_pk_fma_f32 v[78:79], v[102:103], v[38:39], v[46:47] op_sel:[1,1,0] op_sel_hi:[1,0,1] neg_lo:[1,0,0] neg_hi:[1,0,1]
    v_accvgpr_read_b32 v48, a161
    v_accvgpr_read_b32 v50, a165
    v_accvgpr_read_b32 v52, a169
    v_accvgpr_read_b32 v54, a173
    v_accvgpr_read_b32 v49, a177
    v_accvgpr_read_b32 v51, a181
    v_accvgpr_read_b32 v53, a185
    v_accvgpr_read_b32 v55, a189
    v_pk_fma_f32 v[56:57], v[88:89], v[32:33], v[48:49] op_sel:[0,0,0] op_sel_hi:[0,1,1]
    v_pk_fma_f32 v[58:59], v[90:91], v[34:35], v[50:51] op_sel:[0,0,0] op_sel_hi:[0,1,1]
    v_pk_fma_f32 v[60:61], v[92:93], v[36:37], v[52:53] op_sel:[0,0,0] op_sel_hi:[0,1,1]
    v_pk_fma_f32 v[62:63], v[94:95], v[38:39], v[54:55] op_sel:[0,0,0] op_sel_hi:[0,1,1]
    v_pk_fma_f32 v[32:33], v[88:89], v[32:33], v[56:57] op_sel:[1,1,0] op_sel_hi:[1,0,1] neg_lo:[1,0,0]
    v_pk_fma_f32 v[34:35], v[90:91], v[34:35], v[58:59] op_sel:[1,1,0] op_sel_hi:[1,0,1] neg_lo:[1,0,0]
    v_pk_fma_f32 v[36:37], v[92:93], v[36:37], v[60:61] op_sel:[1,1,0] op_sel_hi:[1,0,1] neg_lo:[1,0,0]
    v_pk_fma_f32 v[38:39], v[94:95], v[38:39], v[62:63] op_sel:[1,1,0] op_sel_hi:[1,0,1] neg_lo:[1,0,0]
    v_pk_mul_f32 v[40:41], v[96:97], v[32:33] op_sel:[0,0] op_sel_hi:[0,1]
    v_pk_mul_f32 v[42:43], v[98:99], v[34:35] op_sel:[0,0] op_sel_hi:[0,1]
    v_pk_mul_f32 v[44:45], v[100:101], v[36:37] op_sel:[0,0] op_sel_hi:[0,1]
    v_pk_mul_f32 v[46:47], v[102:103], v[38:39] op_sel:[0,0] op_sel_hi:[0,1]
    v_pk_fma_f32 v[80:81], v[96:97], v[32:33], v[40:41] op_sel:[1,1,0] op_sel_hi:[1,0,1] neg_lo:[1,0,0] neg_hi:[1,0,1]
    v_pk_fma_f32 v[82:83], v[98:99], v[34:35], v[42:43] op_sel:[1,1,0] op_sel_hi:[1,0,1] neg_lo:[1,0,0] neg_hi:[1,0,1]
    v_pk_fma_f32 v[84:85], v[100:101], v[36:37], v[44:45] op_sel:[1,1,0] op_sel_hi:[1,0,1] neg_lo:[1,0,0] neg_hi:[1,0,1]
    v_pk_fma_f32 v[86:87], v[102:103], v[38:39], v[46:47] op_sel:[1,1,0] op_sel_hi:[1,0,1] neg_lo:[1,0,0] neg_hi:[1,0,1]
    v_cvt_pk_bf16_f32 v162, v72, v80
    v_cvt_pk_bf16_f32 v170, v74, v82
    v_cvt_pk_bf16_f32 v178, v76, v84
    v_cvt_pk_bf16_f32 v186, v78, v86
    v_cvt_pk_bf16_f32 v226, v73, v81
    v_cvt_pk_bf16_f32 v234, v75, v83
    v_cvt_pk_bf16_f32 v242, v77, v85
    v_cvt_pk_bf16_f32 v250, v79, v87
    v_accvgpr_read_b32 v64, a162
    v_accvgpr_read_b32 v66, a166
    v_accvgpr_read_b32 v68, a170
    v_accvgpr_read_b32 v70, a174
    v_accvgpr_read_b32 v65, a178
    v_accvgpr_read_b32 v67, a182
    v_accvgpr_read_b32 v69, a186
    v_accvgpr_read_b32 v71, a190
    v_pk_fma_f32 v[56:57], v[88:89], v[32:33], v[64:65] op_sel:[0,0,0] op_sel_hi:[0,1,1]
    v_pk_fma_f32 v[58:59], v[90:91], v[34:35], v[66:67] op_sel:[0,0,0] op_sel_hi:[0,1,1]
    v_pk_fma_f32 v[60:61], v[92:93], v[36:37], v[68:69] op_sel:[0,0,0] op_sel_hi:[0,1,1]
    v_pk_fma_f32 v[62:63], v[94:95], v[38:39], v[70:71] op_sel:[0,0,0] op_sel_hi:[0,1,1]
    v_pk_fma_f32 v[32:33], v[88:89], v[32:33], v[56:57] op_sel:[1,1,0] op_sel_hi:[1,0,1] neg_lo:[1,0,0]
    v_pk_fma_f32 v[34:35], v[90:91], v[34:35], v[58:59] op_sel:[1,1,0] op_sel_hi:[1,0,1] neg_lo:[1,0,0]
    v_pk_fma_f32 v[36:37], v[92:93], v[36:37], v[60:61] op_sel:[1,1,0] op_sel_hi:[1,0,1] neg_lo:[1,0,0]
    v_pk_fma_f32 v[38:39], v[94:95], v[38:39], v[62:63] op_sel:[1,1,0] op_sel_hi:[1,0,1] neg_lo:[1,0,0]
    v_pk_mul_f32 v[40:41], v[96:97], v[32:33] op_sel:[0,0] op_sel_hi:[0,1]
    v_pk_mul_f32 v[42:43], v[98:99], v[34:35] op_sel:[0,0] op_sel_hi:[0,1]
    v_pk_mul_f32 v[44:45], v[100:101], v[36:37] op_sel:[0,0] op_sel_hi:[0,1]
    v_pk_mul_f32 v[46:47], v[102:103], v[38:39] op_sel:[0,0] op_sel_hi:[0,1]
    v_pk_fma_f32 v[72:73], v[96:97], v[32:33], v[40:41] op_sel:[1,1,0] op_sel_hi:[1,0,1] neg_lo:[1,0,0] neg_hi:[1,0,1]
    v_pk_fma_f32 v[74:75], v[98:99], v[34:35], v[42:43] op_sel:[1,1,0] op_sel_hi:[1,0,1] neg_lo:[1,0,0] neg_hi:[1,0,1]
    v_pk_fma_f32 v[76:77], v[100:101], v[36:37], v[44:45] op_sel:[1,1,0] op_sel_hi:[1,0,1] neg_lo:[1,0,0] neg_hi:[1,0,1]
    v_pk_fma_f32 v[78:79], v[102:103], v[38:39], v[46:47] op_sel:[1,1,0] op_sel_hi:[1,0,1] neg_lo:[1,0,0] neg_hi:[1,0,1]
    v_accvgpr_read_b32 v48, a163
    v_accvgpr_read_b32 v50, a167
    v_accvgpr_read_b32 v52, a171
    v_accvgpr_read_b32 v54, a175
    v_accvgpr_read_b32 v49, a179
    v_accvgpr_read_b32 v51, a183
    v_accvgpr_read_b32 v53, a187
    v_accvgpr_read_b32 v55, a191
    v_pk_fma_f32 v[56:57], v[88:89], v[32:33], v[48:49] op_sel:[0,0,0] op_sel_hi:[0,1,1]
    v_pk_fma_f32 v[58:59], v[90:91], v[34:35], v[50:51] op_sel:[0,0,0] op_sel_hi:[0,1,1]
    v_pk_fma_f32 v[60:61], v[92:93], v[36:37], v[52:53] op_sel:[0,0,0] op_sel_hi:[0,1,1]
    v_pk_fma_f32 v[62:63], v[94:95], v[38:39], v[54:55] op_sel:[0,0,0] op_sel_hi:[0,1,1]
    v_pk_fma_f32 v[32:33], v[88:89], v[32:33], v[56:57] op_sel:[1,1,0] op_sel_hi:[1,0,1] neg_lo:[1,0,0]
    v_pk_fma_f32 v[34:35], v[90:91], v[34:35], v[58:59] op_sel:[1,1,0] op_sel_hi:[1,0,1] neg_lo:[1,0,0]
    v_pk_fma_f32 v[36:37], v[92:93], v[36:37], v[60:61] op_sel:[1,1,0] op_sel_hi:[1,0,1] neg_lo:[1,0,0]
    v_pk_fma_f32 v[38:39], v[94:95], v[38:39], v[62:63] op_sel:[1,1,0] op_sel_hi:[1,0,1] neg_lo:[1,0,0]
    v_pk_mul_f32 v[40:41], v[96:97], v[32:33] op_sel:[0,0] op_sel_hi:[0,1]
    v_pk_mul_f32 v[42:43], v[98:99], v[34:35] op_sel:[0,0] op_sel_hi:[0,1]
    v_pk_mul_f32 v[44:45], v[100:101], v[36:37] op_sel:[0,0] op_sel_hi:[0,1]
    v_pk_mul_f32 v[46:47], v[102:103], v[38:39] op_sel:[0,0] op_sel_hi:[0,1]
    v_pk_fma_f32 v[80:81], v[96:97], v[32:33], v[40:41] op_sel:[1,1,0] op_sel_hi:[1,0,1] neg_lo:[1,0,0] neg_hi:[1,0,1]
    v_pk_fma_f32 v[82:83], v[98:99], v[34:35], v[42:43] op_sel:[1,1,0] op_sel_hi:[1,0,1] neg_lo:[1,0,0] neg_hi:[1,0,1]
    v_pk_fma_f32 v[84:85], v[100:101], v[36:37], v[44:45] op_sel:[1,1,0] op_sel_hi:[1,0,1] neg_lo:[1,0,0] neg_hi:[1,0,1]
    v_pk_fma_f32 v[86:87], v[102:103], v[38:39], v[46:47] op_sel:[1,1,0] op_sel_hi:[1,0,1] neg_lo:[1,0,0] neg_hi:[1,0,1]
    v_cvt_pk_bf16_f32 v163, v72, v80
    v_cvt_pk_bf16_f32 v171, v74, v82
    v_cvt_pk_bf16_f32 v179, v76, v84
    v_cvt_pk_bf16_f32 v187, v78, v86
    v_cvt_pk_bf16_f32 v227, v73, v81
    v_cvt_pk_bf16_f32 v235, v75, v83
    v_cvt_pk_bf16_f32 v243, v77, v85
    v_cvt_pk_bf16_f32 v251, v79, v87
    v_accvgpr_read_b32 v64, a192
    v_accvgpr_read_b32 v66, a196
    v_accvgpr_read_b32 v68, a200
    v_accvgpr_read_b32 v70, a204
    v_accvgpr_read_b32 v65, a208
    v_accvgpr_read_b32 v67, a212
    v_accvgpr_read_b32 v69, a216
    v_accvgpr_read_b32 v71, a220
    v_pk_fma_f32 v[56:57], v[88:89], v[32:33], v[64:65] op_sel:[0,0,0] op_sel_hi:[0,1,1]
    v_pk_fma_f32 v[58:59], v[90:91], v[34:35], v[66:67] op_sel:[0,0,0] op_sel_hi:[0,1,1]
    v_pk_fma_f32 v[60:61], v[92:93], v[36:37], v[68:69] op_sel:[0,0,0] op_sel_hi:[0,1,1]
    v_pk_fma_f32 v[62:63], v[94:95], v[38:39], v[70:71] op_sel:[0,0,0] op_sel_hi:[0,1,1]
    v_pk_fma_f32 v[32:33], v[88:89], v[32:33], v[56:57] op_sel:[1,1,0] op_sel_hi:[1,0,1] neg_lo:[1,0,0]
    v_pk_fma_f32 v[34:35], v[90:91], v[34:35], v[58:59] op_sel:[1,1,0] op_sel_hi:[1,0,1] neg_lo:[1,0,0]
    v_pk_fma_f32 v[36:37], v[92:93], v[36:37], v[60:61] op_sel:[1,1,0] op_sel_hi:[1,0,1] neg_lo:[1,0,0]
    v_pk_fma_f32 v[38:39], v[94:95], v[38:39], v[62:63] op_sel:[1,1,0] op_sel_hi:[1,0,1] neg_lo:[1,0,0]
    v_pk_mul_f32 v[40:41], v[96:97], v[32:33] op_sel:[0,0] op_sel_hi:[0,1]
    v_pk_mul_f32 v[42:43], v[98:99], v[34:35] op_sel:[0,0] op_sel_hi:[0,1]
    v_pk_mul_f32 v[44:45], v[100:101], v[36:37] op_sel:[0,0] op_sel_hi:[0,1]
    v_pk_mul_f32 v[46:47], v[102:103], v[38:39] op_sel:[0,0] op_sel_hi:[0,1]
    v_pk_fma_f32 v[72:73], v[96:97], v[32:33], v[40:41] op_sel:[1,1,0] op_sel_hi:[1,0,1] neg_lo:[1,0,0] neg_hi:[1,0,1]
    v_pk_fma_f32 v[74:75], v[98:99], v[34:35], v[42:43] op_sel:[1,1,0] op_sel_hi:[1,0,1] neg_lo:[1,0,0] neg_hi:[1,0,1]
    v_pk_fma_f32 v[76:77], v[100:101], v[36:37], v[44:45] op_sel:[1,1,0] op_sel_hi:[1,0,1] neg_lo:[1,0,0] neg_hi:[1,0,1]
    v_pk_fma_f32 v[78:79], v[102:103], v[38:39], v[46:47] op_sel:[1,1,0] op_sel_hi:[1,0,1] neg_lo:[1,0,0] neg_hi:[1,0,1]
    v_accvgpr_read_b32 v48, a193
    v_accvgpr_read_b32 v50, a197
    v_accvgpr_read_b32 v52, a201
    v_accvgpr_read_b32 v54, a205
    v_accvgpr_read_b32 v49, a209
    v_accvgpr_read_b32 v51, a213
    v_accvgpr_read_b32 v53, a217
    v_accvgpr_read_b32 v55, a221
    v_pk_fma_f32 v[56:57], v[88:89], v[32:33], v[48:49] op_sel:[0,0,0] op_sel_hi:[0,1,1]
    v_pk_fma_f32 v[58:59], v[90:91], v[34:35], v[50:51] op_sel:[0,0,0] op_sel_hi:[0,1,1]
    v_pk_fma_f32 v[60:61], v[92:93], v[36:37], v[52:53] op_sel:[0,0,0] op_sel_hi:[0,1,1]
    v_pk_fma_f32 v[62:63], v[94:95], v[38:39], v[54:55] op_sel:[0,0,0] op_sel_hi:[0,1,1]
    v_pk_fma_f32 v[32:33], v[88:89], v[32:33], v[56:57] op_sel:[1,1,0] op_sel_hi:[1,0,1] neg_lo:[1,0,0]
    v_pk_fma_f32 v[34:35], v[90:91], v[34:35], v[58:59] op_sel:[1,1,0] op_sel_hi:[1,0,1] neg_lo:[1,0,0]
    v_pk_fma_f32 v[36:37], v[92:93], v[36:37], v[60:61] op_sel:[1,1,0] op_sel_hi:[1,0,1] neg_lo:[1,0,0]
    v_pk_fma_f32 v[38:39], v[94:95], v[38:39], v[62:63] op_sel:[1,1,0] op_sel_hi:[1,0,1] neg_lo:[1,0,0]
    v_pk_mul_f32 v[40:41], v[96:97], v[32:33] op_sel:[0,0] op_sel_hi:[0,1]
    v_pk_mul_f32 v[42:43], v[98:99], v[34:35] op_sel:[0,0] op_sel_hi:[0,1]
    v_pk_mul_f32 v[44:45], v[100:101], v[36:37] op_sel:[0,0] op_sel_hi:[0,1]
    v_pk_mul_f32 v[46:47], v[102:103], v[38:39] op_sel:[0,0] op_sel_hi:[0,1]
    v_pk_fma_f32 v[80:81], v[96:97], v[32:33], v[40:41] op_sel:[1,1,0] op_sel_hi:[1,0,1] neg_lo:[1,0,0] neg_hi:[1,0,1]
    v_pk_fma_f32 v[82:83], v[98:99], v[34:35], v[42:43] op_sel:[1,1,0] op_sel_hi:[1,0,1] neg_lo:[1,0,0] neg_hi:[1,0,1]
    v_pk_fma_f32 v[84:85], v[100:101], v[36:37], v[44:45] op_sel:[1,1,0] op_sel_hi:[1,0,1] neg_lo:[1,0,0] neg_hi:[1,0,1]
    v_pk_fma_f32 v[86:87], v[102:103], v[38:39], v[46:47] op_sel:[1,1,0] op_sel_hi:[1,0,1] neg_lo:[1,0,0] neg_hi:[1,0,1]
    v_cvt_pk_bf16_f32 v164, v72, v80
    v_cvt_pk_bf16_f32 v172, v74, v82
    v_cvt_pk_bf16_f32 v180, v76, v84
    v_cvt_pk_bf16_f32 v188, v78, v86
    v_cvt_pk_bf16_f32 v228, v73, v81
    v_cvt_pk_bf16_f32 v236, v75, v83
    v_cvt_pk_bf16_f32 v244, v77, v85
    v_cvt_pk_bf16_f32 v252, v79, v87
    v_accvgpr_read_b32 v64, a194
    v_accvgpr_read_b32 v66, a198
    v_accvgpr_read_b32 v68, a202
    v_accvgpr_read_b32 v70, a206
    v_accvgpr_read_b32 v65, a210
    v_accvgpr_read_b32 v67, a214
    v_accvgpr_read_b32 v69, a218
    v_accvgpr_read_b32 v71, a222
    v_pk_fma_f32 v[56:57], v[88:89], v[32:33], v[64:65] op_sel:[0,0,0] op_sel_hi:[0,1,1]
    v_pk_fma_f32 v[58:59], v[90:91], v[34:35], v[66:67] op_sel:[0,0,0] op_sel_hi:[0,1,1]
    v_pk_fma_f32 v[60:61], v[92:93], v[36:37], v[68:69] op_sel:[0,0,0] op_sel_hi:[0,1,1]
    v_pk_fma_f32 v[62:63], v[94:95], v[38:39], v[70:71] op_sel:[0,0,0] op_sel_hi:[0,1,1]
    v_pk_fma_f32 v[32:33], v[88:89], v[32:33], v[56:57] op_sel:[1,1,0] op_sel_hi:[1,0,1] neg_lo:[1,0,0]
    v_pk_fma_f32 v[34:35], v[90:91], v[34:35], v[58:59] op_sel:[1,1,0] op_sel_hi:[1,0,1] neg_lo:[1,0,0]
    v_pk_fma_f32 v[36:37], v[92:93], v[36:37], v[60:61] op_sel:[1,1,0] op_sel_hi:[1,0,1] neg_lo:[1,0,0]
    v_pk_fma_f32 v[38:39], v[94:95], v[38:39], v[62:63] op_sel:[1,1,0] op_sel_hi:[1,0,1] neg_lo:[1,0,0]
    v_pk_mul_f32 v[40:41], v[96:97], v[32:33] op_sel:[0,0] op_sel_hi:[0,1]
    v_pk_mul_f32 v[42:43], v[98:99], v[34:35] op_sel:[0,0] op_sel_hi:[0,1]
    v_pk_mul_f32 v[44:45], v[100:101], v[36:37] op_sel:[0,0] op_sel_hi:[0,1]
    v_pk_mul_f32 v[46:47], v[102:103], v[38:39] op_sel:[0,0] op_sel_hi:[0,1]
    v_pk_fma_f32 v[72:73], v[96:97], v[32:33], v[40:41] op_sel:[1,1,0] op_sel_hi:[1,0,1] neg_lo:[1,0,0] neg_hi:[1,0,1]
    v_pk_fma_f32 v[74:75], v[98:99], v[34:35], v[42:43] op_sel:[1,1,0] op_sel_hi:[1,0,1] neg_lo:[1,0,0] neg_hi:[1,0,1]
    v_pk_fma_f32 v[76:77], v[100:101], v[36:37], v[44:45] op_sel:[1,1,0] op_sel_hi:[1,0,1] neg_lo:[1,0,0] neg_hi:[1,0,1]
    v_pk_fma_f32 v[78:79], v[102:103], v[38:39], v[46:47] op_sel:[1,1,0] op_sel_hi:[1,0,1] neg_lo:[1,0,0] neg_hi:[1,0,1]
    v_accvgpr_read_b32 v48, a195
    v_accvgpr_read_b32 v50, a199
    v_accvgpr_read_b32 v52, a203
    v_accvgpr_read_b32 v54, a207
    v_accvgpr_read_b32 v49, a211
    v_accvgpr_read_b32 v51, a215
    v_accvgpr_read_b32 v53, a219
    v_accvgpr_read_b32 v55, a223
    v_pk_fma_f32 v[56:57], v[88:89], v[32:33], v[48:49] op_sel:[0,0,0] op_sel_hi:[0,1,1]
    v_pk_fma_f32 v[58:59], v[90:91], v[34:35], v[50:51] op_sel:[0,0,0] op_sel_hi:[0,1,1]
    v_pk_fma_f32 v[60:61], v[92:93], v[36:37], v[52:53] op_sel:[0,0,0] op_sel_hi:[0,1,1]
    v_pk_fma_f32 v[62:63], v[94:95], v[38:39], v[54:55] op_sel:[0,0,0] op_sel_hi:[0,1,1]
    v_pk_fma_f32 v[32:33], v[88:89], v[32:33], v[56:57] op_sel:[1,1,0] op_sel_hi:[1,0,1] neg_lo:[1,0,0]
    v_pk_fma_f32 v[34:35], v[90:91], v[34:35], v[58:59] op_sel:[1,1,0] op_sel_hi:[1,0,1] neg_lo:[1,0,0]
    v_pk_fma_f32 v[36:37], v[92:93], v[36:37], v[60:61] op_sel:[1,1,0] op_sel_hi:[1,0,1] neg_lo:[1,0,0]
    v_pk_fma_f32 v[38:39], v[94:95], v[38:39], v[62:63] op_sel:[1,1,0] op_sel_hi:[1,0,1] neg_lo:[1,0,0]
    v_pk_mul_f32 v[40:41], v[96:97], v[32:33] op_sel:[0,0] op_sel_hi:[0,1]
    v_pk_mul_f32 v[42:43], v[98:99], v[34:35] op_sel:[0,0] op_sel_hi:[0,1]
    v_pk_mul_f32 v[44:45], v[100:101], v[36:37] op_sel:[0,0] op_sel_hi:[0,1]
    v_pk_mul_f32 v[46:47], v[102:103], v[38:39] op_sel:[0,0] op_sel_hi:[0,1]
    v_pk_fma_f32 v[80:81], v[96:97], v[32:33], v[40:41] op_sel:[1,1,0] op_sel_hi:[1,0,1] neg_lo:[1,0,0] neg_hi:[1,0,1]
    v_pk_fma_f32 v[82:83], v[98:99], v[34:35], v[42:43] op_sel:[1,1,0] op_sel_hi:[1,0,1] neg_lo:[1,0,0] neg_hi:[1,0,1]
    v_pk_fma_f32 v[84:85], v[100:101], v[36:37], v[44:45] op_sel:[1,1,0] op_sel_hi:[1,0,1] neg_lo:[1,0,0] neg_hi:[1,0,1]
    v_pk_fma_f32 v[86:87], v[102:103], v[38:39], v[46:47] op_sel:[1,1,0] op_sel_hi:[1,0,1] neg_lo:[1,0,0] neg_hi:[1,0,1]
    v_cvt_pk_bf16_f32 v165, v72, v80
    v_cvt_pk_bf16_f32 v173, v74, v82
    v_cvt_pk_bf16_f32 v181, v76, v84
    v_cvt_pk_bf16_f32 v189, v78, v86
    v_cvt_pk_bf16_f32 v229, v73, v81
    v_cvt_pk_bf16_f32 v237, v75, v83
    v_cvt_pk_bf16_f32 v245, v77, v85
    v_cvt_pk_bf16_f32 v253, v79, v87
    v_accvgpr_read_b32 v64, a224
    v_accvgpr_read_b32 v66, a228
    v_accvgpr_read_b32 v68, a232
    v_accvgpr_read_b32 v70, a236
    v_accvgpr_read_b32 v65, a240
    v_accvgpr_read_b32 v67, a244
    v_accvgpr_read_b32 v69, a248
    v_accvgpr_read_b32 v71, a252
    v_pk_fma_f32 v[56:57], v[88:89], v[32:33], v[64:65] op_sel:[0,0,0] op_sel_hi:[0,1,1]
    v_pk_fma_f32 v[58:59], v[90:91], v[34:35], v[66:67] op_sel:[0,0,0] op_sel_hi:[0,1,1]
    v_pk_fma_f32 v[60:61], v[92:93], v[36:37], v[68:69] op_sel:[0,0,0] op_sel_hi:[0,1,1]
    v_pk_fma_f32 v[62:63], v[94:95], v[38:39], v[70:71] op_sel:[0,0,0] op_sel_hi:[0,1,1]
    v_pk_fma_f32 v[32:33], v[88:89], v[32:33], v[56:57] op_sel:[1,1,0] op_sel_hi:[1,0,1] neg_lo:[1,0,0]
    v_pk_fma_f32 v[34:35], v[90:91], v[34:35], v[58:59] op_sel:[1,1,0] op_sel_hi:[1,0,1] neg_lo:[1,0,0]
    v_pk_fma_f32 v[36:37], v[92:93], v[36:37], v[60:61] op_sel:[1,1,0] op_sel_hi:[1,0,1] neg_lo:[1,0,0]
    v_pk_fma_f32 v[38:39], v[94:95], v[38:39], v[62:63] op_sel:[1,1,0] op_sel_hi:[1,0,1] neg_lo:[1,0,0]
    v_pk_mul_f32 v[40:41], v[96:97], v[32:33] op_sel:[0,0] op_sel_hi:[0,1]
    v_pk_mul_f32 v[42:43], v[98:99], v[34:35] op_sel:[0,0] op_sel_hi:[0,1]
    v_pk_mul_f32 v[44:45], v[100:101], v[36:37] op_sel:[0,0] op_sel_hi:[0,1]
    v_pk_mul_f32 v[46:47], v[102:103], v[38:39] op_sel:[0,0] op_sel_hi:[0,1]
    v_pk_fma_f32 v[72:73], v[96:97], v[32:33], v[40:41] op_sel:[1,1,0] op_sel_hi:[1,0,1] neg_lo:[1,0,0] neg_hi:[1,0,1]
    v_pk_fma_f32 v[74:75], v[98:99], v[34:35], v[42:43] op_sel:[1,1,0] op_sel_hi:[1,0,1] neg_lo:[1,0,0] neg_hi:[1,0,1]
    v_pk_fma_f32 v[76:77], v[100:101], v[36:37], v[44:45] op_sel:[1,1,0] op_sel_hi:[1,0,1] neg_lo:[1,0,0] neg_hi:[1,0,1]
    v_pk_fma_f32 v[78:79], v[102:103], v[38:39], v[46:47] op_sel:[1,1,0] op_sel_hi:[1,0,1] neg_lo:[1,0,0] neg_hi:[1,0,1]
    v_accvgpr_read_b32 v48, a225
    v_accvgpr_read_b32 v50, a229
    v_accvgpr_read_b32 v52, a233
    v_accvgpr_read_b32 v54, a237
    v_accvgpr_read_b32 v49, a241
    v_accvgpr_read_b32 v51, a245
    v_accvgpr_read_b32 v53, a249
    v_accvgpr_read_b32 v55, a253
    v_pk_fma_f32 v[56:57], v[88:89], v[32:33], v[48:49] op_sel:[0,0,0] op_sel_hi:[0,1,1]
    v_pk_fma_f32 v[58:59], v[90:91], v[34:35], v[50:51] op_sel:[0,0,0] op_sel_hi:[0,1,1]
    v_pk_fma_f32 v[60:61], v[92:93], v[36:37], v[52:53] op_sel:[0,0,0] op_sel_hi:[0,1,1]
    v_pk_fma_f32 v[62:63], v[94:95], v[38:39], v[54:55] op_sel:[0,0,0] op_sel_hi:[0,1,1]
    v_pk_fma_f32 v[32:33], v[88:89], v[32:33], v[56:57] op_sel:[1,1,0] op_sel_hi:[1,0,1] neg_lo:[1,0,0]
    v_pk_fma_f32 v[34:35], v[90:91], v[34:35], v[58:59] op_sel:[1,1,0] op_sel_hi:[1,0,1] neg_lo:[1,0,0]
    v_pk_fma_f32 v[36:37], v[92:93], v[36:37], v[60:61] op_sel:[1,1,0] op_sel_hi:[1,0,1] neg_lo:[1,0,0]
    v_pk_fma_f32 v[38:39], v[94:95], v[38:39], v[62:63] op_sel:[1,1,0] op_sel_hi:[1,0,1] neg_lo:[1,0,0]
    v_pk_mul_f32 v[40:41], v[96:97], v[32:33] op_sel:[0,0] op_sel_hi:[0,1]
    v_pk_mul_f32 v[42:43], v[98:99], v[34:35] op_sel:[0,0] op_sel_hi:[0,1]
    v_pk_mul_f32 v[44:45], v[100:101], v[36:37] op_sel:[0,0] op_sel_hi:[0,1]
    v_pk_mul_f32 v[46:47], v[102:103], v[38:39] op_sel:[0,0] op_sel_hi:[0,1]
    v_pk_fma_f32 v[80:81], v[96:97], v[32:33], v[40:41] op_sel:[1,1,0] op_sel_hi:[1,0,1] neg_lo:[1,0,0] neg_hi:[1,0,1]
    v_pk_fma_f32 v[82:83], v[98:99], v[34:35], v[42:43] op_sel:[1,1,0] op_sel_hi:[1,0,1] neg_lo:[1,0,0] neg_hi:[1,0,1]
    v_pk_fma_f32 v[84:85], v[100:101], v[36:37], v[44:45] op_sel:[1,1,0] op_sel_hi:[1,0,1] neg_lo:[1,0,0] neg_hi:[1,0,1]
    v_pk_fma_f32 v[86:87], v[102:103], v[38:39], v[46:47] op_sel:[1,1,0] op_sel_hi:[1,0,1] neg_lo:[1,0,0] neg_hi:[1,0,1]
    v_cvt_pk_bf16_f32 v166, v72, v80
    v_cvt_pk_bf16_f32 v174, v74, v82
    v_cvt_pk_bf16_f32 v182, v76, v84
    v_cvt_pk_bf16_f32 v190, v78, v86
    v_cvt_pk_bf16_f32 v230, v73, v81
    v_cvt_pk_bf16_f32 v238, v75, v83
    v_cvt_pk_bf16_f32 v246, v77, v85
    v_cvt_pk_bf16_f32 v254, v79, v87
    v_accvgpr_read_b32 v64, a226
    v_accvgpr_read_b32 v66, a230
    v_accvgpr_read_b32 v68, a234
    v_accvgpr_read_b32 v70, a238
    v_accvgpr_read_b32 v65, a242
    v_accvgpr_read_b32 v67, a246
    v_accvgpr_read_b32 v69, a250
    v_accvgpr_read_b32 v71, a254
    v_pk_fma_f32 v[56:57], v[88:89], v[32:33], v[64:65] op_sel:[0,0,0] op_sel_hi:[0,1,1]
    v_pk_fma_f32 v[58:59], v[90:91], v[34:35], v[66:67] op_sel:[0,0,0] op_sel_hi:[0,1,1]
    v_pk_fma_f32 v[60:61], v[92:93], v[36:37], v[68:69] op_sel:[0,0,0] op_sel_hi:[0,1,1]
    v_pk_fma_f32 v[62:63], v[94:95], v[38:39], v[70:71] op_sel:[0,0,0] op_sel_hi:[0,1,1]
    v_pk_fma_f32 v[32:33], v[88:89], v[32:33], v[56:57] op_sel:[1,1,0] op_sel_hi:[1,0,1] neg_lo:[1,0,0]
    v_pk_fma_f32 v[34:35], v[90:91], v[34:35], v[58:59] op_sel:[1,1,0] op_sel_hi:[1,0,1] neg_lo:[1,0,0]
    v_pk_fma_f32 v[36:37], v[92:93], v[36:37], v[60:61] op_sel:[1,1,0] op_sel_hi:[1,0,1] neg_lo:[1,0,0]
    v_pk_fma_f32 v[38:39], v[94:95], v[38:39], v[62:63] op_sel:[1,1,0] op_sel_hi:[1,0,1] neg_lo:[1,0,0]
    v_pk_mul_f32 v[40:41], v[96:97], v[32:33] op_sel:[0,0] op_sel_hi:[0,1]
    v_pk_mul_f32 v[42:43], v[98:99], v[34:35] op_sel:[0,0] op_sel_hi:[0,1]
    v_pk_mul_f32 v[44:45], v[100:101], v[36:37] op_sel:[0,0] op_sel_hi:[0,1]
    v_pk_mul_f32 v[46:47], v[102:103], v[38:39] op_sel:[0,0] op_sel_hi:[0,1]
    v_pk_fma_f32 v[72:73], v[96:97], v[32:33], v[40:41] op_sel:[1,1,0] op_sel_hi:[1,0,1] neg_lo:[1,0,0] neg_hi:[1,0,1]
    v_pk_fma_f32 v[74:75], v[98:99], v[34:35], v[42:43] op_sel:[1,1,0] op_sel_hi:[1,0,1] neg_lo:[1,0,0] neg_hi:[1,0,1]
    v_pk_fma_f32 v[76:77], v[100:101], v[36:37], v[44:45] op_sel:[1,1,0] op_sel_hi:[1,0,1] neg_lo:[1,0,0] neg_hi:[1,0,1]
    v_pk_fma_f32 v[78:79], v[102:103], v[38:39], v[46:47] op_sel:[1,1,0] op_sel_hi:[1,0,1] neg_lo:[1,0,0] neg_hi:[1,0,1]
    v_accvgpr_read_b32 v48, a227
    v_accvgpr_read_b32 v50, a231
    v_accvgpr_read_b32 v52, a235
    v_accvgpr_read_b32 v54, a239
    v_accvgpr_read_b32 v49, a243
    v_accvgpr_read_b32 v51, a247
    v_accvgpr_read_b32 v53, a251
    v_accvgpr_read_b32 v55, a255
    v_pk_fma_f32 v[56:57], v[88:89], v[32:33], v[48:49] op_sel:[0,0,0] op_sel_hi:[0,1,1]
    v_pk_fma_f32 v[58:59], v[90:91], v[34:35], v[50:51] op_sel:[0,0,0] op_sel_hi:[0,1,1]
    v_pk_fma_f32 v[60:61], v[92:93], v[36:37], v[52:53] op_sel:[0,0,0] op_sel_hi:[0,1,1]
    v_pk_fma_f32 v[62:63], v[94:95], v[38:39], v[54:55] op_sel:[0,0,0] op_sel_hi:[0,1,1]
    v_pk_fma_f32 v[32:33], v[88:89], v[32:33], v[56:57] op_sel:[1,1,0] op_sel_hi:[1,0,1] neg_lo:[1,0,0]
    v_pk_fma_f32 v[34:35], v[90:91], v[34:35], v[58:59] op_sel:[1,1,0] op_sel_hi:[1,0,1] neg_lo:[1,0,0]
    v_pk_fma_f32 v[36:37], v[92:93], v[36:37], v[60:61] op_sel:[1,1,0] op_sel_hi:[1,0,1] neg_lo:[1,0,0]
    v_pk_fma_f32 v[38:39], v[94:95], v[38:39], v[62:63] op_sel:[1,1,0] op_sel_hi:[1,0,1] neg_lo:[1,0,0]
    v_pk_mul_f32 v[40:41], v[96:97], v[32:33] op_sel:[0,0] op_sel_hi:[0,1]
    v_pk_mul_f32 v[42:43], v[98:99], v[34:35] op_sel:[0,0] op_sel_hi:[0,1]
    v_pk_mul_f32 v[44:45], v[100:101], v[36:37] op_sel:[0,0] op_sel_hi:[0,1]
    v_pk_mul_f32 v[46:47], v[102:103], v[38:39] op_sel:[0,0] op_sel_hi:[0,1]
    v_pk_fma_f32 v[80:81], v[96:97], v[32:33], v[40:41] op_sel:[1,1,0] op_sel_hi:[1,0,1] neg_lo:[1,0,0] neg_hi:[1,0,1]
    v_pk_fma_f32 v[82:83], v[98:99], v[34:35], v[42:43] op_sel:[1,1,0] op_sel_hi:[1,0,1] neg_lo:[1,0,0] neg_hi:[1,0,1]
    v_pk_fma_f32 v[84:85], v[100:101], v[36:37], v[44:45] op_sel:[1,1,0] op_sel_hi:[1,0,1] neg_lo:[1,0,0] neg_hi:[1,0,1]
    v_pk_fma_f32 v[86:87], v[102:103], v[38:39], v[46:47] op_sel:[1,1,0] op_sel_hi:[1,0,1] neg_lo:[1,0,0] neg_hi:[1,0,1]
    v_cvt_pk_bf16_f32 v167, v72, v80
    v_cvt_pk_bf16_f32 v175, v74, v82
    v_cvt_pk_bf16_f32 v183, v76, v84
    v_cvt_pk_bf16_f32 v191, v78, v86
    v_cvt_pk_bf16_f32 v231, v73, v81
    v_cvt_pk_bf16_f32 v239, v75, v83
    v_cvt_pk_bf16_f32 v247, v77, v85
    v_cvt_pk_bf16_f32 v255, v79, v87
    s_lshl_b32 s61, s85, 13
    s_andn2_b32 s61, 0x2000, s61
    s_xor_b32 s61, s61, s59
    s_lshl_b32 s50, s85, 21
    s_add_u32 s50, s50, s61
    s_lshr_b32 s60, s82, 2
    s_lshl_b32 s60, s60, 20
    s_add_u32 s50, s50, s60
    s_lshl_b32 s29, s29, 7
    s_and_b32 s29, s29, 0x7ffff
    s_add_u32 s50, s50, s29
    s_and_b32 s60, s58, 1
    s_lshl_b32 s60, s60, 12
    s_add_u32 s50, s50, s60
    s_add_u32 s50, s50, 0xc000000
    s_mov_b32 s5, 16384
    s_mov_b32 s51, 2048
    s_mov_b32 s52, 0x80000
    v_bfe_u32 v2, v0, 4, 1
    v_lshlrev_b32 v2, 6, v2
    v_xor_b32 v2, v2, v1
    v_add_u32 v3, 1024, v2
    s_setpc_b64 s[54:55]
code_end:
    s_endpgm
.section .rodata,"a"
.p2align 6
.amdhsa_kernel chain_kernel
  .amdhsa_next_free_vgpr 512
  .amdhsa_next_free_sgpr 102
  .amdhsa_accum_offset 256
  .amdhsa_group_segment_fixed_size 0
  .amdhsa_kernarg_size 152
  .amdhsa_user_sgpr_count 2
  .amdhsa_user_sgpr_kernarg_segment_ptr 1
  .amdhsa_system_sgpr_workgroup_id_x 1
  .amdhsa_float_denorm_mode_32 3
  .amdhsa_float_denorm_mode_16_64 3
.end_amdhsa_kernel
```
